```python
import torch

def _softmax(x, axis=-1):
    return torch.softmax(x, dim=axis)

def _gelu(x):
    return torch.nn.functional.gelu(x, approximate='tanh')

def _silu(x):
    return torch.nn.functional.silu(x)

def _sigmoid(x):
    return torch.sigmoid(x)

def _layernorm(x, axis=-1, eps=1e-05):
    m = x.mean(dim=axis, keepdim=True)
    v = x.var(dim=axis, keepdim=True, unbiased=False)
    return (x - m) / torch.sqrt(v + eps)

def _scatter_add(tgt, idx, src, axis=0):
    return tgt.clone().index_add_(axis, idx, src)

def _segment_sum(src, seg, n):
    out = torch.zeros((n,) + src.shape[1:], dtype=src.dtype)
    return out.index_add_(0, seg, src)

def _pad(x, pw):
    flat = tuple((v for pair in reversed(pw) for v in pair))
    return torch.nn.functional.pad(x, flat)
kernel_name = 'parallel_sum__compressed_kv_cla__mixer_gmlp__prompt'

def setup_inputs():

    _w = lambda a: (lambda t: t.to(torch.bfloat16) if t.is_floating_point() else t)(torch.as_tensor(a))

    def _A_setup():
        B, H, Sq, Sk, D, M = (1, 32, 2048, 2048, 128, 640)
        Dc = 4 * D
        return {'x': _w((lambda *s: torch.randn(*s, dtype=torch.bfloat16) * 0.05)(B, Sq, M)), 'c_kv': _w((lambda *s: torch.randn(*s, dtype=torch.bfloat16) * 1.6)(B, Sk, Dc)), 'w_q': _w((lambda *s: torch.randn(*s, dtype=torch.bfloat16) * 1.6)(M, H, D) * M ** (-0.5)), 'w_uk': _w((lambda *s: torch.randn(*s, dtype=torch.bfloat16) * 1.6)(Dc, H, D) * Dc ** (-0.5)), 'w_uv': _w((lambda *s: torch.randn(*s, dtype=torch.bfloat16) * 1.6)(Dc, H, D) * Dc ** (-0.5)), 'w_o': _w((lambda *s: torch.randn(*s, dtype=torch.bfloat16) * 1.6)(H, D, M) * (H * D) ** (-0.5))}
    _A_in = _A_setup()

    def _B_setup():
        B, S, D, F = (1, 2048, 640, 1728)
        Fh = F // 2
        return {'x': _w((lambda *s: torch.randn(*s, dtype=torch.bfloat16) * 0.05)(B, S, D)), 'w_in': _w((lambda *s: torch.randn(*s, dtype=torch.bfloat16) * 0.4)(D, 2 * Fh)), 'w_sp': _w(0.01 * (lambda *s: torch.randn(*s, dtype=torch.bfloat16) * 0.4)(S, S)), 'b_sp': _w(1.0 + 0.01 * (lambda *s: torch.randn(*s, dtype=torch.bfloat16) * 0.05)(S)), 'w_out': _w((lambda *s: torch.randn(*s, dtype=torch.bfloat16) * 0.05)(Fh, D))}
    _B_in = _B_setup()
    return {'A_x': _A_in['x'], 'A_c_kv': _A_in['c_kv'], 'A_w_q': _A_in['w_q'], 'A_w_uk': _A_in['w_uk'], 'A_w_uv': _A_in['w_uv'], 'A_w_o': _A_in['w_o'], 'B_x': _B_in['x'], 'B_w_in': _B_in['w_in'], 'B_w_sp': _B_in['w_sp'], 'B_b_sp': _B_in['b_sp'], 'B_w_out': _B_in['w_out']}

def reference(A_x, A_c_kv, A_w_q, A_w_uk, A_w_uv, A_w_o, B_x, B_w_in, B_w_sp, B_b_sp, B_w_out):

    def _A_ref(x, c_kv, w_q, w_uk, w_uv, w_o):
        B, Sq, M = (x.shape[0], x.shape[1], x.shape[2])
        Sk = c_kv.shape[1]
        H, D = (w_q.shape[1], w_q.shape[2])
        q = torch.einsum('bqm,mhd->bhqd', x, w_q)
        k = torch.einsum('bkc,chd->bhkd', c_kv, w_uk)
        v = torch.einsum('bkc,chd->bhkd', c_kv, w_uv)
        scores = torch.einsum('bhqd,bhkd->bhqk', q, k) * D ** (-0.5)
        off = Sk - Sq
        qi = torch.arange(Sq)[:, None]
        kj = torch.arange(Sk)[None, :]
        cmask = kj <= qi + off
        scores = torch.where(cmask[None, None], scores, -1000000000.0)
        p = _softmax(scores, axis=-1)
        ctx = torch.einsum('bhqk,bhkd->bhqd', p, v)
        return torch.einsum('bhqd,hdm->bqm', ctx, w_o)

    def _B_ref(x, w_in, w_sp, b_sp, w_out):
        B, S, D = x.shape
        F = w_in.shape[-1]
        Fh = F // 2
        z = _gelu(torch.einsum('bsd,df->bsf', x, w_in))
        z1 = z[..., :Fh].clone()
        z2 = _layernorm(z[..., Fh:], axis=-1)
        g = torch.einsum('ts,bsf->btf', w_sp, z2) + b_sp[None, :, None]
        return torch.einsum('bsf,fd->bsd', z1 * g, w_out)
    x = A_x
    xn = _layernorm(x, axis=-1)
    return x + _A_ref(xn, A_c_kv, A_w_q, A_w_uk, A_w_uv, A_w_o) + _B_ref(xn, B_w_in, B_w_sp, B_b_sp, B_w_out)
```

```asm
; @launch kernel=kf_kernel grid=(256,1,1) block=(256,1,1) lds=163840
.amdgcn_target "amdgcn-amd-amdhsa--gfx950"
.text
.globl kf_kernel
.p2align 12
.p2align 8
.type kf_kernel,@function
kf_kernel:
s_cmp_lt_u32 s2, 256
s_cbranch_scc1 kf_kernel_go
s_endpgm
kf_kernel_go:
s_load_dwordx8 s[48:55], s[0:1], 0
s_load_dwordx2 s[56:57], s[0:1], 32
s_load_dwordx2 s[58:59], s[0:1], 56
s_load_dwordx4 s[4:7], s[0:1], 96
s_load_dwordx2 s[86:87], s[0:1], 88
v_lshrrev_b32 v1, 6, v0
s_and_b32 s23, s2, 7
v_readfirstlane_b32 s20, v1
s_lshr_b32 s24, s2, 3
s_getpc_b64 s[38:39]
kf_kernel_pc:
s_lshl_b32 s34, s24, 12
v_and_b32 v2, 7, v0
v_lshl_or_b32 v1, v1, 3, v2
v_lshl_add_u32 v1, v1, 7, s34
v_min_u32 v1, kf_kernel_last-kf_kernel_pc, v1
global_load_dword a255, v1, s[38:39]
v_and_b32 v4, 63, v0
v_lshlrev_b32 v4, 4, v4
v_lshrrev_b32 v1, 5, v0
v_and_b32 v2, 31, v0
v_mul_u32_u24 v3, 1280, v1
v_lshl_add_u32 v32, v2, 3, v3
v_and_b32 v1, 1, v1
v_lshlrev_b32 v3, 1, v1
v_xor_b32 v2, v2, v3
v_lshlrev_b32 v2, 4, v2
v_lshl_add_u32 v9, v1, 13, v2
v_xor_b32 v1, 64, v9
v_xor_b32 v2, 128, v9
v_xor_b32 v3, 192, v9
v_add_u32 v10, 15360, v1
v_add_u32 v11, 30720, v9
v_add_u32 v12, 46080, v1
v_add_u32 v13, 65536, v2
v_add_u32 v14, 80896, v3
v_add_u32 v15, 96256, v2
v_add_u32 v16, 111616, v3
s_lshl_b32 s30, s23, 5
s_add_u32 s30, s30, s24
s_mul_i32 s31, s30, 10240
s_lshr_b32 s21, s20, 1
s_and_b32 s22, s20, 1
s_lshl_b32 s25, s20, 13
s_lshl_b32 s28, s20, 12
s_lshl_b32 s26, s20, 15
s_lshl_b32 s27, s20, 17
s_and_b32 s32, s24, 7
s_lshl_b32 s33, s32, 17
s_bfe_u32 s35, s24, 0x10003
s_xor_b32 s35, s35, 1
s_lshl_b32 s36, s23, 1
s_add_u32 s35, s35, s36
s_lshl_b32 s36, s35, 9
s_sub_u32 s14, 4194304, s36
s_mov_b32 s15, 0x20000
s_mov_b32 s42, 2621440
s_mov_b32 s43, 0x20000
s_mov_b32 s10, 1179648
s_mov_b32 s11, 0x20000
s_mul_i32 s34, s23, 256
s_and_b32 s34, s34, 896
s_or_b32 s26, s26, s34
s_lshl_b32 s34, s34, 12
s_or_b32 s27, s27, s34
v_and_b32 v1, 63, v0
v_lshrrev_b32 v2, 3, v1
v_mul_u32_u24 v2, 1024, v2
v_lshrrev_b32 v3, 4, v1
v_and_b32 v1, 7, v1
v_xor_b32 v1, v1, v3
v_lshl_add_u32 v2, v1, 4, v2
v_mov_b32 v5, v2
v_xor_b32 v6, 64, v2
v_add_u32 v6, 7168, v6
v_mov_b32 v7, v2
v_add_u32 v7, 14336, v7
v_xor_b32 v8, 64, v2
v_add_u32 v8, 21504, v8
v_lshlrev_b32 v1, 8, v0
v_mov_b32 v2, 0
s_cmp_eq_u32 s2, 250
s_cselect_b32 s62, 256, 0
s_cselect_b32 s18, 3211264, 0
s_mov_b32 s19, 0x20000
s_mov_b32 s34, 3145728
s_waitcnt lgkmcnt(0)
s_mov_b64 s[40:41], s[48:49]
s_mov_b64 s[16:17], s[6:7]
buffer_store_dword v2, v1, s[16:19], s34 offen sc1
buffer_load_dwordx2 v[34:35], v32, s[40:43], s31 offen offset:0
buffer_load_dwordx2 v[36:37], v32, s[40:43], s31 offen offset:256
buffer_load_dwordx2 v[38:39], v32, s[40:43], s31 offen offset:512
buffer_load_dwordx2 v[40:41], v32, s[40:43], s31 offen offset:768
buffer_load_dwordx2 v[42:43], v32, s[40:43], s31 offen offset:1024
s_add_u32 s8, s50, s33
s_addc_u32 s9, s51, 0
s_cmp_ge_u32 s24, 16
s_cselect_b32 s12, s56, s54
s_cselect_b32 s13, s57, s55
s_add_u32 s12, s12, s36
s_addc_u32 s13, s13, 0
s_add_u32 m0, s28, 0
s_xor_b32 s29, s26, 0
buffer_load_dwordx4 v5, s[8:11], s29 offen offset:0 lds
buffer_load_dwordx4 v6, s[8:11], s29 offen offset:1024 lds
buffer_load_dwordx4 v7, s[8:11], s29 offen offset:2048 lds
buffer_load_dwordx4 v8, s[8:11], s29 offen offset:3072 lds
s_add_u32 m0, s25, 98304
s_xor_b32 s29, s27, 0
buffer_load_dwordx4 v9, s[12:15], s29 offen offset:0 nt lds
buffer_load_dwordx4 v10, s[12:15], s29 offen offset:1024 nt lds
buffer_load_dwordx4 v11, s[12:15], s29 offen offset:2048 nt lds
buffer_load_dwordx4 v12, s[12:15], s29 offen offset:3072 nt lds
s_lshl2_add_u32 s34, s24, s20
s_and_b32 s34, s34, 63
s_lshl_b32 s34, s34, 10
s_add_u32 s34, s34, kf_kernel_z-kf_kernel_pc
s_add_u32 s98, s38, s34
s_addc_u32 s99, s39, 0
s_mov_b64 s[60:61], s[4:5]
s_mov_b32 s63, 0x20000
s_add_u32 s16, s6, 4194304
s_addc_u32 s17, s7, 0
s_mov_b32 s18, 34078720
s_mov_b32 s19, 0x20000
s_mov_b32 s48, s6
s_mov_b32 s49, s7
s_mov_b32 s50, 134217728
s_mov_b32 s51, 0x20000
v_cmp_eq_u32 vcc, 0, v0
v_mov_b32 v1, 1073741824
s_nop 0
v_cndmask_b32 v29, v1, 0, vcc
s_lshl_b32 s56, s35, 1
s_add_u32 s56, s56, s22
s_mul_i32 s56, s56, 65
s_lshl2_add_u32 s56, s32, s56
s_lshl1_add_u32 s56, s21, s56
s_lshl_b32 s56, s56, 14
s_lshl_b32 s3, s35, 8
s_add_u32 s3, s3, 3203072
s_lshl_b32 s34, s21, 13
v_bfe_u32 v1, v0, 1, 4
v_lshlrev_b32 v33, 7, v1
v_lshrrev_b32 v1, 5, v0
v_lshl_add_u32 v33, v1, 4, v33
v_and_b32 v3, 1, v0
v_lshl_add_u32 v33, v3, 3, v33
v_add_u32 v33, 131072, v33
v_and_b32 v1, 15, v0
v_bfe_u32 v2, v0, 4, 2
v_lshrrev_b32 v3, 1, v1
v_xor_b32 v2, v2, v3
v_lshlrev_b32 v2, 4, v2
v_lshl_add_u32 v2, v1, 7, v2
v_add_u32 v17, s34, v2
v_xor_b32 v18, 64, v17
s_lshl_b32 s34, s22, 8
s_add_u32 s34, s34, 65536
v_bfe_u32 v1, v0, 2, 2
v_bfe_u32 v2, v0, 4, 2
v_lshl_add_u32 v3, v2, 3, v1
v_lshlrev_b32 v3, 9, v3
v_bfe_u32 v1, v0, 2, 3
v_lshl_add_u32 v3, v1, 5, v3
v_and_b32 v1, 3, v0
v_lshl_add_u32 v3, v1, 3, v3
v_add_u32 v21, s34, v3
v_xor_b32 v22, 32, v21
v_xor_b32 v23, 64, v21
v_xor_b32 v24, 96, v21
v_xor_b32 v25, 128, v21
v_xor_b32 v26, 160, v21
v_xor_b32 v27, 192, v21
v_xor_b32 v28, 224, v21
s_lshr_b32 s34, s30, 1
s_mul_i32 s34, s34, 20480
s_and_b32 s39, s30, 1
s_lshl_b32 s39, s39, 7
s_add_u32 s39, s39, s34
s_lshl_b32 s35, s20, 11
s_add_u32 s39, s39, s35
s_lshl_b32 s55, s23, 8
s_add_u32 s55, s55, 3174400
v_bfe_u32 v1, v0, 5, 1
v_bfe_u32 v2, v0, 3, 2
v_and_b32 v3, 7, v0
v_lshlrev_b32 v3, 4, v3
v_lshl_add_u32 v3, v2, 8, v3
v_lshl_add_u32 v31, v1, 10, v3
v_lshlrev_b32 v30, 4, v0
v_add_u32 v30, 131072, v30
s_lshl_b32 s21, s23, 2
s_and_b32 s34, s24, 3
s_add_u32 s21, s21, s34
s_lshr_b32 s22, s24, 2
s_lshl_b32 s34, s21, 8
s_sub_u32 s38, 5242880, s34
s_add_u32 s44, s52, s34
s_addc_u32 s45, s53, 0
s_mov_b32 s46, s38
s_mov_b32 s47, 0x20000
s_bfm_b32 s34, s21, 0
s_andn2_b32 s34, s34, 0xf01000
s_bcnt1_i32_b32 s34, s34
s_bitcmp1_b32 0xf01000, s21
s_cselect_b32 s100, 27, s34
s_lshl_b32 s34, s100, 7
s_sub_u32 s38, 2211840, s34
s_cmp_ge_u32 s34, 3456
s_cselect_b32 s38, 0, s38
s_add_u32 s40, s58, s34
s_addc_u32 s41, s59, 0
s_mov_b32 s42, s38
s_mov_b32 s43, 0x20000
s_sub_u32 s34, 15, s22
s_lshl_b32 s30, s34, 3
s_lshl_b32 s38, s20, 1
s_add_u32 s30, s30, s38
s_lshl_b32 s31, s22, 3
s_add_u32 s31, s31, s38
s_mul_i32 s32, s30, 20480
s_mul_i32 s33, s31, 20480
s_lshl_b32 s36, s34, 2
s_add_u32 s36, s36, 4
s_lshl_b32 s36, s36, 14
s_add_u32 s36, s36, s28
s_mul_i32 s54, s20, 55296
s_lshr_b32 s34, s21, 1
s_lshl_b32 s52, s34, 8
s_add_u32 s52, s52, 3203072
s_getreg_b32 s34, hwreg(HW_REG_XCC_ID, 0, 4)
s_mul_i32 s57, s34, s34
s_lshl_b32 s57, s57, 10
s_add_u32 s57, s57, s34
s_lshl_b32 s57, s57, 6
s_add_u32 s57, s57, 1
v_mov_b32 v19, s57
v_lshlrev_b32 v20, 20, v4
v_mov_b32 v1, 1
s_add_u32 m0, s25, 102400
s_xor_b32 s29, s27, 0
buffer_load_dwordx4 v13, s[12:15], s29 offen offset:0 nt lds
buffer_load_dwordx4 v14, s[12:15], s29 offen offset:1024 nt lds
buffer_load_dwordx4 v15, s[12:15], s29 offen offset:2048 nt lds
buffer_load_dwordx4 v16, s[12:15], s29 offen offset:3072 nt lds
s_waitcnt vmcnt(12)
buffer_atomic_add v1, v20, s[60:63], 0 offen sc1
s_mov_b32 s62, 256
v_mov_b64 v[48:49], 0
v_mov_b64 v[50:51], 0
v_dot2c_f32_bf16 v48, 0x3f803f80, v34
v_dot2c_f32_bf16 v49, 0x3f803f80, v35
v_dot2c_f32_bf16 v50, 0x3f803f80, v36
v_dot2c_f32_bf16 v51, 0x3f803f80, v37
v_dot2c_f32_bf16 v48, 0x3f803f80, v38
v_dot2c_f32_bf16 v49, 0x3f803f80, v39
v_dot2c_f32_bf16 v50, 0x3f803f80, v40
v_dot2c_f32_bf16 v51, 0x3f803f80, v41
v_dot2c_f32_bf16 v48, 0x3f803f80, v42
v_dot2c_f32_bf16 v49, 0x3f803f80, v43
s_nop 2
v_pk_add_f32 v[48:49], v[48:49], v[50:51]
v_add_f32 v48, v48, v49
s_nop 1
v_add_f32_dpp v48, v48, v48 quad_perm:[1,0,3,2] row_mask:0xf bank_mask:0xf
s_nop 1
v_add_f32_dpp v48, v48, v48 quad_perm:[2,3,0,1] row_mask:0xf bank_mask:0xf
s_nop 1
v_add_f32_dpp v48, v48, v48 row_half_mirror row_mask:0xf bank_mask:0xf
s_nop 1
v_add_f32_dpp v48, v48, v48 row_mirror row_mask:0xf bank_mask:0xf
v_mov_b32 v58, v48
s_nop 1
v_permlane16_swap_b32 v58, v48
v_add_f32 v48, v48, v58
v_mul_f32 v59, 0x3acccccd, v48
v_cvt_pk_bf16_f32 v52, v59, v59
v_and_b32 v52, 0xffff0000, v52
v_mov_b64 v[48:49], 0
v_mov_b64 v[50:51], 0
v_sub_f32 v59, v59, v52
v_lshlrev_b32 v54, 16, v34
v_and_b32 v55, 0xffff0000, v34
v_lshlrev_b32 v56, 16, v35
v_and_b32 v57, 0xffff0000, v35
v_pk_add_f32 v[54:55], v[54:55], v[52:53] op_sel_hi:[1,0] neg_lo:[0,1] neg_hi:[0,1]
v_pk_add_f32 v[56:57], v[56:57], v[52:53] op_sel_hi:[1,0] neg_lo:[0,1] neg_hi:[0,1]
s_add_u32 m0, s28, 16384
s_xor_b32 s29, s26, 1048576
buffer_load_dwordx4 v5, s[8:11], s29 offen offset:0 lds
v_pk_fma_f32 v[48:49], v[54:55], v[54:55], v[48:49]
v_pk_fma_f32 v[50:51], v[56:57], v[56:57], v[50:51]
v_cvt_pk_bf16_f32 v34, v54, v55
v_cvt_pk_bf16_f32 v35, v56, v57
v_lshlrev_b32 v54, 16, v36
v_and_b32 v55, 0xffff0000, v36
v_lshlrev_b32 v56, 16, v37
v_and_b32 v57, 0xffff0000, v37
v_pk_add_f32 v[54:55], v[54:55], v[52:53] op_sel_hi:[1,0] neg_lo:[0,1] neg_hi:[0,1]
v_pk_add_f32 v[56:57], v[56:57], v[52:53] op_sel_hi:[1,0] neg_lo:[0,1] neg_hi:[0,1]
v_pk_fma_f32 v[48:49], v[54:55], v[54:55], v[48:49]
v_pk_fma_f32 v[50:51], v[56:57], v[56:57], v[50:51]
buffer_load_dwordx4 v6, s[8:11], s29 offen offset:1024 lds
v_cvt_pk_bf16_f32 v36, v54, v55
v_cvt_pk_bf16_f32 v37, v56, v57
v_lshlrev_b32 v54, 16, v38
v_and_b32 v55, 0xffff0000, v38
v_lshlrev_b32 v56, 16, v39
v_and_b32 v57, 0xffff0000, v39
v_pk_add_f32 v[54:55], v[54:55], v[52:53] op_sel_hi:[1,0] neg_lo:[0,1] neg_hi:[0,1]
v_pk_add_f32 v[56:57], v[56:57], v[52:53] op_sel_hi:[1,0] neg_lo:[0,1] neg_hi:[0,1]
v_pk_fma_f32 v[48:49], v[54:55], v[54:55], v[48:49]
v_pk_fma_f32 v[50:51], v[56:57], v[56:57], v[50:51]
v_cvt_pk_bf16_f32 v38, v54, v55
v_cvt_pk_bf16_f32 v39, v56, v57
v_lshlrev_b32 v54, 16, v40
buffer_load_dwordx4 v7, s[8:11], s29 offen offset:2048 lds
v_and_b32 v55, 0xffff0000, v40
v_lshlrev_b32 v56, 16, v41
v_and_b32 v57, 0xffff0000, v41
v_pk_add_f32 v[54:55], v[54:55], v[52:53] op_sel_hi:[1,0] neg_lo:[0,1] neg_hi:[0,1]
v_pk_add_f32 v[56:57], v[56:57], v[52:53] op_sel_hi:[1,0] neg_lo:[0,1] neg_hi:[0,1]
v_pk_fma_f32 v[48:49], v[54:55], v[54:55], v[48:49]
v_pk_fma_f32 v[50:51], v[56:57], v[56:57], v[50:51]
v_cvt_pk_bf16_f32 v40, v54, v55
v_cvt_pk_bf16_f32 v41, v56, v57
v_lshlrev_b32 v54, 16, v42
v_and_b32 v55, 0xffff0000, v42
v_lshlrev_b32 v56, 16, v43
buffer_load_dwordx4 v8, s[8:11], s29 offen offset:3072 lds
v_and_b32 v57, 0xffff0000, v43
v_pk_add_f32 v[54:55], v[54:55], v[52:53] op_sel_hi:[1,0] neg_lo:[0,1] neg_hi:[0,1]
v_pk_add_f32 v[56:57], v[56:57], v[52:53] op_sel_hi:[1,0] neg_lo:[0,1] neg_hi:[0,1]
v_pk_fma_f32 v[48:49], v[54:55], v[54:55], v[48:49]
v_pk_fma_f32 v[50:51], v[56:57], v[56:57], v[50:51]
v_cvt_pk_bf16_f32 v42, v54, v55
v_cvt_pk_bf16_f32 v43, v56, v57
v_pk_add_f32 v[48:49], v[48:49], v[50:51]
v_add_f32 v48, v48, v49
s_nop 1
v_add_f32_dpp v48, v48, v48 quad_perm:[1,0,3,2] row_mask:0xf bank_mask:0xf
s_nop 1
v_add_f32_dpp v48, v48, v48 quad_perm:[2,3,0,1] row_mask:0xf bank_mask:0xf
s_nop 1
v_add_f32_dpp v48, v48, v48 row_half_mirror row_mask:0xf bank_mask:0xf
s_nop 1
v_add_f32_dpp v48, v48, v48 row_mirror row_mask:0xf bank_mask:0xf
s_add_u32 m0, s25, 65536
s_xor_b32 s29, s27, 524288
buffer_load_dwordx4 v9, s[12:15], s29 offen offset:0 nt lds
v_mov_b32 v58, v48
s_nop 1
v_permlane16_swap_b32 v58, v48
v_add_f32 v48, v48, v58
v_mul_f32 v59, v59, v59
v_mul_f32 v48, 0x3acccccd, v48
v_sub_f32 v48, v48, v59
v_max_f32 v48, 0, v48
v_cvt_pk_bf16_f32 v48, v48, v48
v_and_b32 v48, 0xffff0000, v48
v_add_f32 v48, 0x3727c5ac, v48
v_cvt_pk_bf16_f32 v48, v48, v48
v_and_b32 v48, 0xffff0000, v48
buffer_load_dwordx4 v10, s[12:15], s29 offen offset:1024 nt lds
v_sqrt_f32 v48, v48
s_nop 0
v_cvt_pk_bf16_f32 v48, v48, v48
v_and_b32 v48, 0xffff0000, v48
v_rcp_f32 v52, v48
v_lshlrev_b32 v54, 16, v34
v_and_b32 v55, 0xffff0000, v34
v_lshlrev_b32 v56, 16, v35
v_and_b32 v57, 0xffff0000, v35
v_pk_mul_f32 v[54:55], v[54:55], v[52:53] op_sel_hi:[1,0]
v_pk_mul_f32 v[56:57], v[56:57], v[52:53] op_sel_hi:[1,0]
v_cvt_pk_bf16_f32 v34, v54, v55
v_cvt_pk_bf16_f32 v35, v56, v57
v_lshlrev_b32 v54, 16, v36
buffer_load_dwordx4 v11, s[12:15], s29 offen offset:2048 nt lds
v_and_b32 v55, 0xffff0000, v36
v_lshlrev_b32 v56, 16, v37
v_and_b32 v57, 0xffff0000, v37
v_pk_mul_f32 v[54:55], v[54:55], v[52:53] op_sel_hi:[1,0]
v_pk_mul_f32 v[56:57], v[56:57], v[52:53] op_sel_hi:[1,0]
v_cvt_pk_bf16_f32 v36, v54, v55
v_cvt_pk_bf16_f32 v37, v56, v57
v_lshlrev_b32 v54, 16, v38
v_and_b32 v55, 0xffff0000, v38
v_lshlrev_b32 v56, 16, v39
v_and_b32 v57, 0xffff0000, v39
v_pk_mul_f32 v[54:55], v[54:55], v[52:53] op_sel_hi:[1,0]
buffer_load_dwordx4 v12, s[12:15], s29 offen offset:3072 nt lds
v_pk_mul_f32 v[56:57], v[56:57], v[52:53] op_sel_hi:[1,0]
v_cvt_pk_bf16_f32 v38, v54, v55
v_cvt_pk_bf16_f32 v39, v56, v57
v_lshlrev_b32 v54, 16, v40
v_and_b32 v55, 0xffff0000, v40
v_lshlrev_b32 v56, 16, v41
v_and_b32 v57, 0xffff0000, v41
v_pk_mul_f32 v[54:55], v[54:55], v[52:53] op_sel_hi:[1,0]
v_pk_mul_f32 v[56:57], v[56:57], v[52:53] op_sel_hi:[1,0]
v_cvt_pk_bf16_f32 v40, v54, v55
v_cvt_pk_bf16_f32 v41, v56, v57
v_lshlrev_b32 v54, 16, v42
v_and_b32 v55, 0xffff0000, v42
v_lshlrev_b32 v56, 16, v43
v_and_b32 v57, 0xffff0000, v43
v_pk_mul_f32 v[54:55], v[54:55], v[52:53] op_sel_hi:[1,0]
v_pk_mul_f32 v[56:57], v[56:57], v[52:53] op_sel_hi:[1,0]
v_cvt_pk_bf16_f32 v42, v54, v55
v_cvt_pk_bf16_f32 v43, v56, v57
ds_write_b64 v33, v[34:35] offset:0
ds_write_b64 v33, v[36:37] offset:2048
ds_write_b64 v33, v[38:39] offset:4096
ds_write_b64 v33, v[40:41] offset:6144
ds_write_b64 v33, v[42:43] offset:8192
s_add_u32 m0, s25, 69632
s_xor_b32 s29, s27, 524288
buffer_load_dwordx4 v13, s[12:15], s29 offen offset:0 nt lds
buffer_load_dwordx4 v14, s[12:15], s29 offen offset:1024 nt lds
buffer_load_dwordx4 v15, s[12:15], s29 offen offset:2048 nt lds
buffer_load_dwordx4 v16, s[12:15], s29 offen offset:3072 nt lds
s_add_u32 m0, s28, 32768
s_xor_b32 s29, s26, 128
buffer_load_dwordx4 v5, s[8:11], s29 offen offset:0 lds
buffer_load_dwordx4 v6, s[8:11], s29 offen offset:1024 lds
buffer_load_dwordx4 v7, s[8:11], s29 offen offset:2048 lds
buffer_load_dwordx4 v8, s[8:11], s29 offen offset:3072 lds
s_cmp_ge_u32 s24, 16
s_cbranch_scc1 kf_kernel_y0
s_cmp_eq_u32 s20, 0
s_cbranch_scc1 kf_kernel_pd0
s_cmp_eq_u32 s20, 1
s_cbranch_scc1 kf_kernel_pd1
s_cmp_eq_u32 s20, 2
s_cbranch_scc1 kf_kernel_pd2
s_branch kf_kernel_pd3
kf_kernel_y0:
s_cmp_eq_u32 s20, 0
s_cbranch_scc1 kf_kernel_pd4
s_cmp_eq_u32 s20, 1
s_cbranch_scc1 kf_kernel_pd5
s_cmp_eq_u32 s20, 2
s_cbranch_scc1 kf_kernel_pd6
s_branch kf_kernel_pd7
kf_kernel_r0:
s_waitcnt vmcnt(12) lgkmcnt(0)
s_barrier
ds_read_b128 a[160:163], v17 offset:0
ds_read_b128 a[164:167], v18 offset:0
ds_read_b128 a[168:171], v17 offset:2048
ds_read_b128 a[172:175], v18 offset:2048
ds_read_b64_tr_b16 a[32:33], v21 offset:32768
ds_read_b64_tr_b16 a[34:35], v21 offset:34816
ds_read_b64_tr_b16 a[36:37], v21 offset:49152
ds_read_b64_tr_b16 a[38:39], v21 offset:51200
ds_read_b128 a[176:179], v17 offset:4096
ds_read_b128 a[180:183], v18 offset:4096
ds_read_b128 a[184:187], v17 offset:6144
ds_read_b128 a[188:191], v18 offset:6144
ds_read_b64_tr_b16 a[40:41], v22 offset:32768
ds_read_b64_tr_b16 a[42:43], v22 offset:34816
ds_read_b64_tr_b16 a[44:45], v22 offset:49152
ds_read_b64_tr_b16 a[46:47], v22 offset:51200
ds_read_b128 a[224:227], v30 offset:0
ds_read_b128 a[228:231], v30 offset:4096
ds_read_b128 a[232:235], v30 offset:8192
s_cmp_ge_u32 s24, 16
s_cbranch_scc1 kf_kernel_v
s_branch kf_kernel_k
.p2align 12
kf_kernel_pd0:
s_branch kf_kernel_pd12
kf_kernel_k:
s_add_u32 s56, s56, 16384
s_waitcnt lgkmcnt(11)
v_mfma_f32_16x16x32_bf16 v[32:35], a[32:35], a[160:163], 0
ds_read_b64_tr_b16 a[48:49], v23 offset:32768
v_mfma_f32_16x16x32_bf16 v[32:35], a[36:39], a[164:167], v[32:35]
v_mfma_f32_16x16x32_bf16 v[64:67], a[32:35], a[168:171], 0
ds_read_b64_tr_b16 a[50:51], v23 offset:34816
v_mfma_f32_16x16x32_bf16 v[64:67], a[36:39], a[172:175], v[64:67]
s_waitcnt lgkmcnt(9)
v_mfma_f32_16x16x32_bf16 v[96:99], a[32:35], a[176:179], 0
ds_read_b64_tr_b16 a[52:53], v23 offset:49152
v_mfma_f32_16x16x32_bf16 v[96:99], a[36:39], a[180:183], v[96:99]
v_mfma_f32_16x16x32_bf16 v[128:131], a[32:35], a[184:187], 0
ds_read_b64_tr_b16 a[54:55], v23 offset:51200
v_mfma_f32_16x16x32_bf16 v[128:131], a[36:39], a[188:191], v[128:131]
s_waitcnt lgkmcnt(7)
v_mfma_f32_16x16x32_bf16 v[36:39], a[40:43], a[160:163], 0
ds_read_b64_tr_b16 a[56:57], v24 offset:32768
v_mfma_f32_16x16x32_bf16 v[36:39], a[44:47], a[164:167], v[36:39]
v_mfma_f32_16x16x32_bf16 v[68:71], a[40:43], a[168:171], 0
ds_read_b64_tr_b16 a[58:59], v24 offset:34816
v_mfma_f32_16x16x32_bf16 v[68:71], a[44:47], a[172:175], v[68:71]
s_add_u32 m0, s28, 49152
s_xor_b32 s29, s26, 1048704
buffer_load_dwordx4 v5, s[8:11], s29 offen offset:0 lds
v_mfma_f32_16x16x32_bf16 v[100:103], a[40:43], a[176:179], 0
ds_read_b64_tr_b16 a[60:61], v24 offset:49152
v_mfma_f32_16x16x32_bf16 v[100:103], a[44:47], a[180:183], v[100:103]
v_mfma_f32_16x16x32_bf16 v[132:135], a[40:43], a[184:187], 0
ds_read_b64_tr_b16 a[62:63], v24 offset:51200
v_mfma_f32_16x16x32_bf16 v[132:135], a[44:47], a[188:191], v[132:135]
s_waitcnt lgkmcnt(4)
v_mfma_f32_16x16x32_bf16 v[40:43], a[48:51], a[160:163], 0
ds_read_b64_tr_b16 a[64:65], v25 offset:32768
v_mfma_f32_16x16x32_bf16 v[40:43], a[52:55], a[164:167], v[40:43]
v_mfma_f32_16x16x32_bf16 v[72:75], a[48:51], a[168:171], 0
ds_read_b64_tr_b16 a[66:67], v25 offset:34816
v_mfma_f32_16x16x32_bf16 v[72:75], a[52:55], a[172:175], v[72:75]
buffer_load_dwordx4 v6, s[8:11], s29 offen offset:1024 lds
v_mfma_f32_16x16x32_bf16 v[104:107], a[48:51], a[176:179], 0
ds_read_b64_tr_b16 a[68:69], v25 offset:49152
v_mfma_f32_16x16x32_bf16 v[104:107], a[52:55], a[180:183], v[104:107]
v_mfma_f32_16x16x32_bf16 v[136:139], a[48:51], a[184:187], 0
ds_read_b64_tr_b16 a[70:71], v25 offset:51200
v_mfma_f32_16x16x32_bf16 v[136:139], a[52:55], a[188:191], v[136:139]
s_waitcnt lgkmcnt(4)
v_mfma_f32_16x16x32_bf16 v[44:47], a[56:59], a[160:163], 0
ds_read_b64_tr_b16 a[72:73], v26 offset:32768
v_mfma_f32_16x16x32_bf16 v[44:47], a[60:63], a[164:167], v[44:47]
v_mfma_f32_16x16x32_bf16 v[76:79], a[56:59], a[168:171], 0
ds_read_b64_tr_b16 a[74:75], v26 offset:34816
v_mfma_f32_16x16x32_bf16 v[76:79], a[60:63], a[172:175], v[76:79]
buffer_load_dwordx4 v7, s[8:11], s29 offen offset:2048 lds
v_mfma_f32_16x16x32_bf16 v[108:111], a[56:59], a[176:179], 0
ds_read_b64_tr_b16 a[76:77], v26 offset:49152
v_mfma_f32_16x16x32_bf16 v[108:111], a[60:63], a[180:183], v[108:111]
v_mfma_f32_16x16x32_bf16 v[140:143], a[56:59], a[184:187], 0
ds_read_b64_tr_b16 a[78:79], v26 offset:51200
v_mfma_f32_16x16x32_bf16 v[140:143], a[60:63], a[188:191], v[140:143]
s_waitcnt lgkmcnt(4)
v_mfma_f32_16x16x32_bf16 v[48:51], a[64:67], a[160:163], 0
ds_read_b64_tr_b16 a[80:81], v27 offset:32768
v_mfma_f32_16x16x32_bf16 v[48:51], a[68:71], a[164:167], v[48:51]
v_mfma_f32_16x16x32_bf16 v[80:83], a[64:67], a[168:171], 0
ds_read_b64_tr_b16 a[82:83], v27 offset:34816
v_mfma_f32_16x16x32_bf16 v[80:83], a[68:71], a[172:175], v[80:83]
buffer_load_dwordx4 v8, s[8:11], s29 offen offset:3072 lds
v_mfma_f32_16x16x32_bf16 v[112:115], a[64:67], a[176:179], 0
ds_read_b64_tr_b16 a[84:85], v27 offset:49152
v_mfma_f32_16x16x32_bf16 v[112:115], a[68:71], a[180:183], v[112:115]
v_mfma_f32_16x16x32_bf16 v[144:147], a[64:67], a[184:187], 0
ds_read_b64_tr_b16 a[86:87], v27 offset:51200
v_mfma_f32_16x16x32_bf16 v[144:147], a[68:71], a[188:191], v[144:147]
s_waitcnt lgkmcnt(4)
v_mfma_f32_16x16x32_bf16 v[52:55], a[72:75], a[160:163], 0
ds_read_b64_tr_b16 a[88:89], v28 offset:32768
v_mfma_f32_16x16x32_bf16 v[52:55], a[76:79], a[164:167], v[52:55]
v_mfma_f32_16x16x32_bf16 v[84:87], a[72:75], a[168:171], 0
ds_read_b64_tr_b16 a[90:91], v28 offset:34816
v_mfma_f32_16x16x32_bf16 v[84:87], a[76:79], a[172:175], v[84:87]
buffer_store_dwordx4 a[224:227], v31, s[48:51], s39 offen sc1
v_mfma_f32_16x16x32_bf16 v[116:119], a[72:75], a[176:179], 0
ds_read_b64_tr_b16 a[92:93], v28 offset:49152
ds_read_b128 a[192:195], v17 offset:16384
v_mfma_f32_16x16x32_bf16 v[116:119], a[76:79], a[180:183], v[116:119]
v_mfma_f32_16x16x32_bf16 v[148:151], a[72:75], a[184:187], 0
ds_read_b64_tr_b16 a[94:95], v28 offset:51200
ds_read_b128 a[196:199], v18 offset:16384
v_mfma_f32_16x16x32_bf16 v[148:151], a[76:79], a[188:191], v[148:151]
s_waitcnt lgkmcnt(6)
v_mfma_f32_16x16x32_bf16 v[56:59], a[80:83], a[160:163], 0
ds_read_b128 a[200:203], v17 offset:18432
v_mfma_f32_16x16x32_bf16 v[56:59], a[84:87], a[164:167], v[56:59]
v_mfma_f32_16x16x32_bf16 v[88:91], a[80:83], a[168:171], 0
ds_read_b128 a[204:207], v18 offset:18432
v_mfma_f32_16x16x32_bf16 v[88:91], a[84:87], a[172:175], v[88:91]
s_add_u32 s39, s39, 8192
buffer_store_dwordx4 a[228:231], v31, s[48:51], s39 offen sc1
v_mfma_f32_16x16x32_bf16 v[120:123], a[80:83], a[176:179], 0
ds_read_b128 a[208:211], v17 offset:20480
v_mfma_f32_16x16x32_bf16 v[120:123], a[84:87], a[180:183], v[120:123]
v_mfma_f32_16x16x32_bf16 v[152:155], a[80:83], a[184:187], 0
ds_read_b128 a[212:215], v18 offset:20480
v_mfma_f32_16x16x32_bf16 v[152:155], a[84:87], a[188:191], v[152:155]
s_waitcnt lgkmcnt(5)
v_mfma_f32_16x16x32_bf16 v[60:63], a[88:91], a[160:163], 0
ds_read_b128 a[216:219], v17 offset:22528
v_mfma_f32_16x16x32_bf16 v[60:63], a[92:95], a[164:167], v[60:63]
v_mfma_f32_16x16x32_bf16 v[92:95], a[88:91], a[168:171], 0
ds_read_b128 a[220:223], v18 offset:22528
v_mfma_f32_16x16x32_bf16 v[92:95], a[92:95], a[172:175], v[92:95]
s_add_u32 s39, s39, 8192
s_cmp_ge_u32 s20, 2
s_cselect_b32 s39, 1073741824, s39
buffer_store_dwordx4 a[232:235], v31, s[48:51], s39 offen sc1
v_mfma_f32_16x16x32_bf16 v[124:127], a[88:91], a[176:179], 0
v_mfma_f32_16x16x32_bf16 v[124:127], a[92:95], a[180:183], v[124:127]
v_mfma_f32_16x16x32_bf16 v[156:159], a[88:91], a[184:187], 0
v_mfma_f32_16x16x32_bf16 v[156:159], a[92:95], a[188:191], v[156:159]
s_waitcnt vmcnt(7) lgkmcnt(0)
s_barrier
v_mfma_f32_16x16x32_bf16 v[160:163], a[32:35], a[192:195], 0
v_mfma_f32_16x16x32_bf16 v[160:163], a[36:39], a[196:199], v[160:163]
ds_read_b128 a[160:163], v17 offset:32768
v_mfma_f32_16x16x32_bf16 v[164:167], a[40:43], a[192:195], 0
ds_read_b128 a[164:167], v18 offset:32768
v_mfma_f32_16x16x32_bf16 v[164:167], a[44:47], a[196:199], v[164:167]
s_add_u32 m0, s25, 98304
s_xor_b32 s29, s27, 1048576
buffer_load_dwordx4 v9, s[12:15], s29 offen offset:0 nt lds
v_mfma_f32_16x16x32_bf16 v[168:171], a[48:51], a[192:195], 0
ds_read_b128 a[168:171], v17 offset:34816
v_mfma_f32_16x16x32_bf16 v[168:171], a[52:55], a[196:199], v[168:171]
ds_read_b128 a[172:175], v18 offset:34816
v_mfma_f32_16x16x32_bf16 v[172:175], a[56:59], a[192:195], 0
ds_read_b128 a[176:179], v17 offset:36864
v_mfma_f32_16x16x32_bf16 v[172:175], a[60:63], a[196:199], v[172:175]
v_mfma_f32_16x16x32_bf16 v[176:179], a[64:67], a[192:195], 0
buffer_load_dwordx4 v10, s[12:15], s29 offen offset:1024 nt lds
v_mfma_f32_16x16x32_bf16 v[176:179], a[68:71], a[196:199], v[176:179]
ds_read_b128 a[180:183], v18 offset:36864
v_mfma_f32_16x16x32_bf16 v[180:183], a[72:75], a[192:195], 0
ds_read_b128 a[184:187], v17 offset:38912
v_mfma_f32_16x16x32_bf16 v[180:183], a[76:79], a[196:199], v[180:183]
ds_read_b128 a[188:191], v18 offset:38912
v_mfma_f32_16x16x32_bf16 v[184:187], a[80:83], a[192:195], 0
buffer_load_dwordx4 v11, s[12:15], s29 offen offset:2048 nt lds
v_mfma_f32_16x16x32_bf16 v[184:187], a[84:87], a[196:199], v[184:187]
ds_read_b64_tr_b16 a[96:97], v21 offset:0
v_mfma_f32_16x16x32_bf16 v[188:191], a[88:91], a[192:195], 0
ds_read_b64_tr_b16 a[98:99], v21 offset:2048
v_mfma_f32_16x16x32_bf16 v[188:191], a[92:95], a[196:199], v[188:191]
v_mfma_f32_16x16x32_bf16 v[192:195], a[32:35], a[200:203], 0
ds_read_b64_tr_b16 a[100:101], v21 offset:16384
v_mfma_f32_16x16x32_bf16 v[192:195], a[36:39], a[204:207], v[192:195]
ds_read_b64_tr_b16 a[102:103], v21 offset:18432
v_mfma_f32_16x16x32_bf16 v[196:199], a[40:43], a[200:203], 0
buffer_load_dwordx4 v12, s[12:15], s29 offen offset:3072 nt lds
v_mfma_f32_16x16x32_bf16 v[196:199], a[44:47], a[204:207], v[196:199]
ds_read_b64_tr_b16 a[104:105], v22 offset:0
v_mfma_f32_16x16x32_bf16 v[200:203], a[48:51], a[200:203], 0
ds_read_b64_tr_b16 a[106:107], v22 offset:2048
v_mfma_f32_16x16x32_bf16 v[200:203], a[52:55], a[204:207], v[200:203]
ds_read_b64_tr_b16 a[108:109], v22 offset:16384
v_mfma_f32_16x16x32_bf16 v[204:207], a[56:59], a[200:203], 0
v_mfma_f32_16x16x32_bf16 v[204:207], a[60:63], a[204:207], v[204:207]
s_add_u32 m0, s25, 102400
s_xor_b32 s29, s27, 1048576
buffer_load_dwordx4 v13, s[12:15], s29 offen offset:0 nt lds
v_mfma_f32_16x16x32_bf16 v[208:211], a[64:67], a[200:203], 0
ds_read_b64_tr_b16 a[110:111], v22 offset:18432
v_mfma_f32_16x16x32_bf16 v[208:211], a[68:71], a[204:207], v[208:211]
ds_read_b64_tr_b16 a[112:113], v23 offset:0
v_mfma_f32_16x16x32_bf16 v[212:215], a[72:75], a[200:203], 0
ds_read_b64_tr_b16 a[114:115], v23 offset:2048
v_mfma_f32_16x16x32_bf16 v[212:215], a[76:79], a[204:207], v[212:215]
buffer_load_dwordx4 v14, s[12:15], s29 offen offset:1024 nt lds
v_mfma_f32_16x16x32_bf16 v[216:219], a[80:83], a[200:203], 0
ds_read_b64_tr_b16 a[116:117], v23 offset:16384
v_mfma_f32_16x16x32_bf16 v[216:219], a[84:87], a[204:207], v[216:219]
ds_read_b64_tr_b16 a[118:119], v23 offset:18432
v_mfma_f32_16x16x32_bf16 v[220:223], a[88:91], a[200:203], 0
v_mfma_f32_16x16x32_bf16 v[220:223], a[92:95], a[204:207], v[220:223]
ds_read_b64_tr_b16 a[120:121], v24 offset:0
v_mfma_f32_16x16x32_bf16 v[224:227], a[32:35], a[208:211], 0
ds_read_b64_tr_b16 a[122:123], v24 offset:2048
v_mfma_f32_16x16x32_bf16 v[224:227], a[36:39], a[212:215], v[224:227]
buffer_load_dwordx4 v15, s[12:15], s29 offen offset:2048 nt lds
v_mfma_f32_16x16x32_bf16 v[228:231], a[40:43], a[208:211], 0
ds_read_b64_tr_b16 a[124:125], v24 offset:16384
v_mfma_f32_16x16x32_bf16 v[228:231], a[44:47], a[212:215], v[228:231]
ds_read_b64_tr_b16 a[126:127], v24 offset:18432
v_mfma_f32_16x16x32_bf16 v[232:235], a[48:51], a[208:211], 0
ds_read_b64_tr_b16 a[128:129], v25 offset:0
v_mfma_f32_16x16x32_bf16 v[232:235], a[52:55], a[212:215], v[232:235]
v_mfma_f32_16x16x32_bf16 v[236:239], a[56:59], a[208:211], 0
buffer_load_dwordx4 v16, s[12:15], s29 offen offset:3072 nt lds
v_mfma_f32_16x16x32_bf16 v[236:239], a[60:63], a[212:215], v[236:239]
ds_read_b64_tr_b16 a[130:131], v25 offset:2048
v_mfma_f32_16x16x32_bf16 v[240:243], a[64:67], a[208:211], 0
ds_read_b64_tr_b16 a[132:133], v25 offset:16384
v_mfma_f32_16x16x32_bf16 v[240:243], a[68:71], a[212:215], v[240:243]
ds_read_b64_tr_b16 a[134:135], v25 offset:18432
v_mfma_f32_16x16x32_bf16 v[244:247], a[72:75], a[208:211], 0
s_add_u32 m0, s28, 0
s_xor_b32 s29, s26, 256
buffer_load_dwordx4 v5, s[8:11], s29 offen offset:0 lds
v_mfma_f32_16x16x32_bf16 v[244:247], a[76:79], a[212:215], v[244:247]
ds_read_b64_tr_b16 a[136:137], v26 offset:0
v_mfma_f32_16x16x32_bf16 v[248:251], a[80:83], a[208:211], 0
ds_read_b64_tr_b16 a[138:139], v26 offset:2048
v_mfma_f32_16x16x32_bf16 v[248:251], a[84:87], a[212:215], v[248:251]
v_mfma_f32_16x16x32_bf16 v[252:255], a[88:91], a[208:211], 0
ds_read_b64_tr_b16 a[140:141], v26 offset:16384
v_mfma_f32_16x16x32_bf16 v[252:255], a[92:95], a[212:215], v[252:255]
ds_read_b64_tr_b16 a[142:143], v26 offset:18432
v_mfma_f32_16x16x32_bf16 a[0:3], a[32:35], a[216:219], 0
buffer_load_dwordx4 v6, s[8:11], s29 offen offset:1024 lds
v_mfma_f32_16x16x32_bf16 a[0:3], a[36:39], a[220:223], a[0:3]
ds_read_b64_tr_b16 a[144:145], v27 offset:0
v_mfma_f32_16x16x32_bf16 a[4:7], a[40:43], a[216:219], 0
ds_read_b64_tr_b16 a[146:147], v27 offset:2048
v_mfma_f32_16x16x32_bf16 a[4:7], a[44:47], a[220:223], a[4:7]
ds_read_b64_tr_b16 a[148:149], v27 offset:16384
v_mfma_f32_16x16x32_bf16 a[8:11], a[48:51], a[216:219], 0
v_mfma_f32_16x16x32_bf16 a[8:11], a[52:55], a[220:223], a[8:11]
buffer_load_dwordx4 v7, s[8:11], s29 offen offset:2048 lds
v_mfma_f32_16x16x32_bf16 a[12:15], a[56:59], a[216:219], 0
ds_read_b64_tr_b16 a[150:151], v27 offset:18432
v_mfma_f32_16x16x32_bf16 a[12:15], a[60:63], a[220:223], a[12:15]
ds_read_b64_tr_b16 a[152:153], v28 offset:0
v_mfma_f32_16x16x32_bf16 a[16:19], a[64:67], a[216:219], 0
ds_read_b64_tr_b16 a[154:155], v28 offset:2048
v_mfma_f32_16x16x32_bf16 a[16:19], a[68:71], a[220:223], a[16:19]
buffer_load_dwordx4 v8, s[8:11], s29 offen offset:3072 lds
v_mfma_f32_16x16x32_bf16 a[20:23], a[72:75], a[216:219], 0
ds_read_b64_tr_b16 a[156:157], v28 offset:16384
v_mfma_f32_16x16x32_bf16 a[20:23], a[76:79], a[220:223], a[20:23]
ds_read_b64_tr_b16 a[158:159], v28 offset:18432
v_mfma_f32_16x16x32_bf16 a[24:27], a[80:83], a[216:219], 0
v_mfma_f32_16x16x32_bf16 a[24:27], a[84:87], a[220:223], a[24:27]
v_mfma_f32_16x16x32_bf16 a[28:31], a[88:91], a[216:219], 0
v_mfma_f32_16x16x32_bf16 a[28:31], a[92:95], a[220:223], a[28:31]
s_waitcnt vmcnt(15) lgkmcnt(0)
s_barrier
v_mfma_f32_16x16x32_bf16 v[32:35], a[96:99], a[160:163], v[32:35]
v_mfma_f32_16x16x32_bf16 v[32:35], a[100:103], a[164:167], v[32:35]
v_mfma_f32_16x16x32_bf16 v[36:39], a[104:107], a[160:163], v[36:39]
ds_read_b128 a[192:195], v17 offset:49152
v_mfma_f32_16x16x32_bf16 v[36:39], a[108:111], a[164:167], v[36:39]
v_mfma_f32_16x16x32_bf16 v[40:43], a[112:115], a[160:163], v[40:43]
v_mfma_f32_16x16x32_bf16 v[40:43], a[116:119], a[164:167], v[40:43]
buffer_load_dword v30, off, s[60:63], 0 sc1
v_mfma_f32_16x16x32_bf16 v[44:47], a[120:123], a[160:163], v[44:47]
v_mfma_f32_16x16x32_bf16 v[44:47], a[124:127], a[164:167], v[44:47]
v_mfma_f32_16x16x32_bf16 v[48:51], a[128:131], a[160:163], v[48:51]
ds_read_b128 a[196:199], v18 offset:49152
v_mfma_f32_16x16x32_bf16 v[48:51], a[132:135], a[164:167], v[48:51]
v_mfma_f32_16x16x32_bf16 v[52:55], a[136:139], a[160:163], v[52:55]
v_mfma_f32_16x16x32_bf16 v[52:55], a[140:143], a[164:167], v[52:55]
s_add_u32 m0, s28, 16384
s_xor_b32 s29, s26, 1048832
buffer_load_dwordx4 v5, s[8:11], s29 offen offset:0 lds
v_mfma_f32_16x16x32_bf16 v[56:59], a[144:147], a[160:163], v[56:59]
v_mfma_f32_16x16x32_bf16 v[56:59], a[148:151], a[164:167], v[56:59]
v_mfma_f32_16x16x32_bf16 v[60:63], a[152:155], a[160:163], v[60:63]
ds_read_b128 a[200:203], v17 offset:51200
v_mfma_f32_16x16x32_bf16 v[60:63], a[156:159], a[164:167], v[60:63]
v_mfma_f32_16x16x32_bf16 v[64:67], a[96:99], a[168:171], v[64:67]
v_mfma_f32_16x16x32_bf16 v[64:67], a[100:103], a[172:175], v[64:67]
buffer_load_dwordx4 v6, s[8:11], s29 offen offset:1024 lds
v_mfma_f32_16x16x32_bf16 v[68:71], a[104:107], a[168:171], v[68:71]
v_mfma_f32_16x16x32_bf16 v[68:71], a[108:111], a[172:175], v[68:71]
ds_read_b128 a[204:207], v18 offset:51200
v_mfma_f32_16x16x32_bf16 v[72:75], a[112:115], a[168:171], v[72:75]
v_mfma_f32_16x16x32_bf16 v[72:75], a[116:119], a[172:175], v[72:75]
v_mfma_f32_16x16x32_bf16 v[76:79], a[120:123], a[168:171], v[76:79]
ds_read_b128 a[208:211], v17 offset:53248
v_mfma_f32_16x16x32_bf16 v[76:79], a[124:127], a[172:175], v[76:79]
v_mfma_f32_16x16x32_bf16 v[80:83], a[128:131], a[168:171], v[80:83]
v_mfma_f32_16x16x32_bf16 v[80:83], a[132:135], a[172:175], v[80:83]
buffer_load_dwordx4 v7, s[8:11], s29 offen offset:2048 lds
v_mfma_f32_16x16x32_bf16 v[84:87], a[136:139], a[168:171], v[84:87]
v_mfma_f32_16x16x32_bf16 v[84:87], a[140:143], a[172:175], v[84:87]
v_mfma_f32_16x16x32_bf16 v[88:91], a[144:147], a[168:171], v[88:91]
ds_read_b128 a[212:215], v18 offset:53248
v_mfma_f32_16x16x32_bf16 v[88:91], a[148:151], a[172:175], v[88:91]
v_mfma_f32_16x16x32_bf16 v[92:95], a[152:155], a[168:171], v[92:95]
v_mfma_f32_16x16x32_bf16 v[92:95], a[156:159], a[172:175], v[92:95]
buffer_load_dwordx4 v8, s[8:11], s29 offen offset:3072 lds
v_mfma_f32_16x16x32_bf16 v[96:99], a[96:99], a[176:179], v[96:99]
v_mfma_f32_16x16x32_bf16 v[96:99], a[100:103], a[180:183], v[96:99]
v_mfma_f32_16x16x32_bf16 v[100:103], a[104:107], a[176:179], v[100:103]
ds_read_b128 a[216:219], v17 offset:55296
v_mfma_f32_16x16x32_bf16 v[100:103], a[108:111], a[180:183], v[100:103]
v_mfma_f32_16x16x32_bf16 v[104:107], a[112:115], a[176:179], v[104:107]
v_mfma_f32_16x16x32_bf16 v[104:107], a[116:119], a[180:183], v[104:107]
s_add_u32 m0, s25, 65536
s_xor_b32 s29, s27, 1572864
buffer_load_dwordx4 v9, s[12:15], s29 offen offset:0 nt lds
v_mfma_f32_16x16x32_bf16 v[108:111], a[120:123], a[176:179], v[108:111]
v_mfma_f32_16x16x32_bf16 v[108:111], a[124:127], a[180:183], v[108:111]
ds_read_b128 a[220:223], v18 offset:55296
v_mfma_f32_16x16x32_bf16 v[112:115], a[128:131], a[176:179], v[112:115]
v_mfma_f32_16x16x32_bf16 v[112:115], a[132:135], a[180:183], v[112:115]
v_mfma_f32_16x16x32_bf16 v[116:119], a[136:139], a[176:179], v[116:119]
v_mfma_f32_16x16x32_bf16 v[116:119], a[140:143], a[180:183], v[116:119]
v_mfma_f32_16x16x32_bf16 v[120:123], a[144:147], a[176:179], v[120:123]
v_mfma_f32_16x16x32_bf16 v[120:123], a[148:151], a[180:183], v[120:123]
buffer_load_dwordx4 v10, s[12:15], s29 offen offset:1024 nt lds
v_mfma_f32_16x16x32_bf16 v[124:127], a[152:155], a[176:179], v[124:127]
v_mfma_f32_16x16x32_bf16 v[124:127], a[156:159], a[180:183], v[124:127]
v_mfma_f32_16x16x32_bf16 v[128:131], a[96:99], a[184:187], v[128:131]
v_mfma_f32_16x16x32_bf16 v[128:131], a[100:103], a[188:191], v[128:131]
v_mfma_f32_16x16x32_bf16 v[132:135], a[104:107], a[184:187], v[132:135]
v_mfma_f32_16x16x32_bf16 v[132:135], a[108:111], a[188:191], v[132:135]
buffer_load_dwordx4 v11, s[12:15], s29 offen offset:2048 nt lds
v_mfma_f32_16x16x32_bf16 v[136:139], a[112:115], a[184:187], v[136:139]
v_mfma_f32_16x16x32_bf16 v[136:139], a[116:119], a[188:191], v[136:139]
v_mfma_f32_16x16x32_bf16 v[140:143], a[120:123], a[184:187], v[140:143]
v_mfma_f32_16x16x32_bf16 v[140:143], a[124:127], a[188:191], v[140:143]
v_mfma_f32_16x16x32_bf16 v[144:147], a[128:131], a[184:187], v[144:147]
v_mfma_f32_16x16x32_bf16 v[144:147], a[132:135], a[188:191], v[144:147]
buffer_load_dwordx4 v12, s[12:15], s29 offen offset:3072 nt lds
v_mfma_f32_16x16x32_bf16 v[148:151], a[136:139], a[184:187], v[148:151]
v_mfma_f32_16x16x32_bf16 v[148:151], a[140:143], a[188:191], v[148:151]
v_mfma_f32_16x16x32_bf16 v[152:155], a[144:147], a[184:187], v[152:155]
v_mfma_f32_16x16x32_bf16 v[152:155], a[148:151], a[188:191], v[152:155]
v_mfma_f32_16x16x32_bf16 v[156:159], a[152:155], a[184:187], v[156:159]
v_mfma_f32_16x16x32_bf16 v[156:159], a[156:159], a[188:191], v[156:159]
s_waitcnt vmcnt(9) lgkmcnt(0)
s_barrier
v_mfma_f32_16x16x32_bf16 v[160:163], a[96:99], a[192:195], v[160:163]
ds_read_b128 a[160:163], v17 offset:0
v_mfma_f32_16x16x32_bf16 v[160:163], a[100:103], a[196:199], v[160:163]
ds_read_b128 a[164:167], v18 offset:0
v_mfma_f32_16x16x32_bf16 v[164:167], a[104:107], a[192:195], v[164:167]
v_bfe_u32 v1, v0, 1, 5
v_mfma_f32_16x16x32_bf16 v[164:167], a[108:111], a[196:199], v[164:167]
s_add_u32 m0, s25, 69632
s_xor_b32 s29, s27, 1572864
buffer_load_dwordx4 v13, s[12:15], s29 offen offset:0 nt lds
v_mfma_f32_16x16x32_bf16 v[168:171], a[112:115], a[192:195], v[168:171]
ds_read_b128 a[168:171], v17 offset:2048
v_mfma_f32_16x16x32_bf16 v[168:171], a[116:119], a[196:199], v[168:171]
ds_read_b128 a[172:175], v18 offset:2048
v_mfma_f32_16x16x32_bf16 v[172:175], a[120:123], a[192:195], v[172:175]
ds_read_b128 a[176:179], v17 offset:4096
v_mfma_f32_16x16x32_bf16 v[172:175], a[124:127], a[196:199], v[172:175]
v_cmp_gt_u32 vcc, 5, v1
v_mfma_f32_16x16x32_bf16 v[176:179], a[128:131], a[192:195], v[176:179]
ds_read_b128 a[180:183], v18 offset:4096
v_mfma_f32_16x16x32_bf16 v[176:179], a[132:135], a[196:199], v[176:179]
ds_read_b128 a[184:187], v17 offset:6144
v_mfma_f32_16x16x32_bf16 v[180:183], a[136:139], a[192:195], v[180:183]
buffer_load_dwordx4 v14, s[12:15], s29 offen offset:1024 nt lds
v_mfma_f32_16x16x32_bf16 v[180:183], a[140:143], a[196:199], v[180:183]
ds_read_b128 a[188:191], v18 offset:6144
v_mfma_f32_16x16x32_bf16 v[184:187], a[144:147], a[192:195], v[184:187]
v_mul_u32_u24 v1, 8192, v1
v_mfma_f32_16x16x32_bf16 v[184:187], a[148:151], a[196:199], v[184:187]
ds_read_b64_tr_b16 a[32:33], v21 offset:32768
v_mfma_f32_16x16x32_bf16 v[188:191], a[152:155], a[192:195], v[188:191]
ds_read_b64_tr_b16 a[34:35], v21 offset:34816
v_mfma_f32_16x16x32_bf16 v[188:191], a[156:159], a[196:199], v[188:191]
ds_read_b64_tr_b16 a[36:37], v21 offset:49152
v_mfma_f32_16x16x32_bf16 v[192:195], a[96:99], a[200:203], v[192:195]
ds_read_b64_tr_b16 a[38:39], v21 offset:51200
v_mfma_f32_16x16x32_bf16 v[192:195], a[100:103], a[204:207], v[192:195]
v_and_b32 v2, 1, v0
v_mfma_f32_16x16x32_bf16 v[196:199], a[104:107], a[200:203], v[196:199]
buffer_load_dwordx4 v15, s[12:15], s29 offen offset:2048 nt lds
v_mfma_f32_16x16x32_bf16 v[196:199], a[108:111], a[204:207], v[196:199]
ds_read_b64_tr_b16 a[40:41], v22 offset:32768
v_mfma_f32_16x16x32_bf16 v[200:203], a[112:115], a[200:203], v[200:203]
ds_read_b64_tr_b16 a[42:43], v22 offset:34816
v_mfma_f32_16x16x32_bf16 v[200:203], a[116:119], a[204:207], v[200:203]
ds_read_b64_tr_b16 a[44:45], v22 offset:49152
v_mfma_f32_16x16x32_bf16 v[204:207], a[120:123], a[200:203], v[204:207]
v_lshl_add_u32 v1, v2, 7, v1
v_mfma_f32_16x16x32_bf16 v[204:207], a[124:127], a[204:207], v[204:207]
ds_read_b64_tr_b16 a[46:47], v22 offset:51200
v_mfma_f32_16x16x32_bf16 v[208:211], a[128:131], a[200:203], v[208:211]
ds_read_b64_tr_b16 a[48:49], v23 offset:32768
v_mfma_f32_16x16x32_bf16 v[208:211], a[132:135], a[204:207], v[208:211]
buffer_load_dwordx4 v16, s[12:15], s29 offen offset:3072 nt lds
v_mfma_f32_16x16x32_bf16 v[212:215], a[136:139], a[200:203], v[212:215]
ds_read_b64_tr_b16 a[50:51], v23 offset:34816
v_mfma_f32_16x16x32_bf16 v[212:215], a[140:143], a[204:207], v[212:215]
v_mov_b32 v2, 1073741824
v_mfma_f32_16x16x32_bf16 v[216:219], a[144:147], a[200:203], v[216:219]
ds_read_b64_tr_b16 a[52:53], v23 offset:49152
v_mfma_f32_16x16x32_bf16 v[216:219], a[148:151], a[204:207], v[216:219]
ds_read_b64_tr_b16 a[54:55], v23 offset:51200
v_mfma_f32_16x16x32_bf16 v[220:223], a[152:155], a[200:203], v[220:223]
ds_read_b64_tr_b16 a[56:57], v24 offset:32768
v_mfma_f32_16x16x32_bf16 v[220:223], a[156:159], a[204:207], v[220:223]
ds_read_b64_tr_b16 a[58:59], v24 offset:34816
v_mfma_f32_16x16x32_bf16 v[224:227], a[96:99], a[208:211], v[224:227]
s_mov_b32 s34, s22
v_mfma_f32_16x16x32_bf16 v[224:227], a[100:103], a[212:215], v[224:227]
s_add_u32 m0, s28, 32768
s_xor_b32 s29, s26, 384
buffer_load_dwordx4 v5, s[8:11], s29 offen offset:0 lds
v_mfma_f32_16x16x32_bf16 v[228:231], a[104:107], a[208:211], v[228:231]
ds_read_b64_tr_b16 a[60:61], v24 offset:49152
v_mfma_f32_16x16x32_bf16 v[228:231], a[108:111], a[212:215], v[228:231]
ds_read_b64_tr_b16 a[62:63], v24 offset:51200
v_mfma_f32_16x16x32_bf16 v[232:235], a[112:115], a[208:211], v[232:235]
ds_read_b64_tr_b16 a[64:65], v25 offset:32768
v_mfma_f32_16x16x32_bf16 v[232:235], a[116:119], a[212:215], v[232:235]
s_lshl2_add_u32 s34, s34, s20
v_mfma_f32_16x16x32_bf16 v[236:239], a[120:123], a[208:211], v[236:239]
ds_read_b64_tr_b16 a[66:67], v25 offset:34816
v_mfma_f32_16x16x32_bf16 v[236:239], a[124:127], a[212:215], v[236:239]
ds_read_b64_tr_b16 a[68:69], v25 offset:49152
v_mfma_f32_16x16x32_bf16 v[240:243], a[128:131], a[208:211], v[240:243]
buffer_load_dwordx4 v6, s[8:11], s29 offen offset:1024 lds
v_mfma_f32_16x16x32_bf16 v[240:243], a[132:135], a[212:215], v[240:243]
ds_read_b64_tr_b16 a[70:71], v25 offset:51200
v_mfma_f32_16x16x32_bf16 v[244:247], a[136:139], a[208:211], v[244:247]
v_cndmask_b32 v1, v2, v1, vcc
v_mfma_f32_16x16x32_bf16 v[244:247], a[140:143], a[212:215], v[244:247]
ds_read_b64_tr_b16 a[72:73], v26 offset:32768
v_mfma_f32_16x16x32_bf16 v[248:251], a[144:147], a[208:211], v[248:251]
ds_read_b64_tr_b16 a[74:75], v26 offset:34816
v_mfma_f32_16x16x32_bf16 v[248:251], a[148:151], a[212:215], v[248:251]
ds_read_b64_tr_b16 a[76:77], v26 offset:49152
v_mfma_f32_16x16x32_bf16 v[252:255], a[152:155], a[208:211], v[252:255]
ds_read_b64_tr_b16 a[78:79], v26 offset:51200
v_mfma_f32_16x16x32_bf16 v[252:255], a[156:159], a[212:215], v[252:255]
s_mul_i32 s34, s34, 40960
v_mfma_f32_16x16x32_bf16 a[0:3], a[96:99], a[216:219], a[0:3]
buffer_load_dwordx4 v7, s[8:11], s29 offen offset:2048 lds
v_mfma_f32_16x16x32_bf16 a[0:3], a[100:103], a[220:223], a[0:3]
ds_read_b64_tr_b16 a[80:81], v27 offset:32768
v_mfma_f32_16x16x32_bf16 a[4:7], a[104:107], a[216:219], a[4:7]
ds_read_b64_tr_b16 a[82:83], v27 offset:34816
v_mfma_f32_16x16x32_bf16 a[4:7], a[108:111], a[220:223], a[4:7]
ds_read_b64_tr_b16 a[84:85], v27 offset:49152
v_mfma_f32_16x16x32_bf16 a[8:11], a[112:115], a[216:219], a[8:11]
s_add_u32 s34, s34, 0
v_mfma_f32_16x16x32_bf16 a[8:11], a[116:119], a[220:223], a[8:11]
ds_read_b64_tr_b16 a[86:87], v27 offset:51200
v_mfma_f32_16x16x32_bf16 a[12:15], a[120:123], a[216:219], a[12:15]
ds_read_b64_tr_b16 a[88:89], v28 offset:32768
v_mfma_f32_16x16x32_bf16 a[12:15], a[124:127], a[220:223], a[12:15]
buffer_load_dwordx4 v8, s[8:11], s29 offen offset:3072 lds
v_mfma_f32_16x16x32_bf16 a[16:19], a[128:131], a[216:219], a[16:19]
ds_read_b64_tr_b16 a[90:91], v28 offset:34816
v_mfma_f32_16x16x32_bf16 a[16:19], a[132:135], a[220:223], a[16:19]
buffer_load_dword a236, v1, s[44:47], s34 offen
v_mfma_f32_16x16x32_bf16 a[20:23], a[136:139], a[216:219], a[20:23]
ds_read_b64_tr_b16 a[92:93], v28 offset:49152
v_mfma_f32_16x16x32_bf16 a[20:23], a[140:143], a[220:223], a[20:23]
ds_read_b64_tr_b16 a[94:95], v28 offset:51200
v_mfma_f32_16x16x32_bf16 a[24:27], a[144:147], a[216:219], a[24:27]
v_mfma_f32_16x16x32_bf16 a[24:27], a[148:151], a[220:223], a[24:27]
v_mfma_f32_16x16x32_bf16 a[28:31], a[152:155], a[216:219], a[28:31]
v_mfma_f32_16x16x32_bf16 a[28:31], a[156:159], a[220:223], a[28:31]
s_waitcnt vmcnt(13) lgkmcnt(0)
s_barrier
v_cmp_gt_u32 vcc, 4, v30
s_cmp_lg_u64 vcc, 0
s_cbranch_scc1 kf_kernel_spin_bk
kf_kernel_ret_bk:
v_mfma_f32_16x16x32_bf16 v[32:35], a[32:35], a[160:163], v[32:35]
v_mfma_f32_16x16x32_bf16 v[32:35], a[36:39], a[164:167], v[32:35]
ds_read_b128 a[192:195], v17 offset:16384
v_mfma_f32_16x16x32_bf16 v[36:39], a[40:43], a[160:163], v[36:39]
v_mfma_f32_16x16x32_bf16 v[36:39], a[44:47], a[164:167], v[36:39]
v_bfe_u32 v1, v0, 0, 6
v_mfma_f32_16x16x32_bf16 v[40:43], a[48:51], a[160:163], v[40:43]
v_mfma_f32_16x16x32_bf16 v[40:43], a[52:55], a[164:167], v[40:43]
buffer_atomic_add v19, v29, s[48:51], s55 offen sc1
v_mfma_f32_16x16x32_bf16 v[44:47], a[56:59], a[160:163], v[44:47]
v_mfma_f32_16x16x32_bf16 v[44:47], a[60:63], a[164:167], v[44:47]
ds_read_b128 a[196:199], v18 offset:16384
v_mfma_f32_16x16x32_bf16 v[48:51], a[64:67], a[160:163], v[48:51]
v_mfma_f32_16x16x32_bf16 v[48:51], a[68:71], a[164:167], v[48:51]
v_cmp_gt_u32 vcc, 10, v1
v_mfma_f32_16x16x32_bf16 v[52:55], a[72:75], a[160:163], v[52:55]
v_mfma_f32_16x16x32_bf16 v[52:55], a[76:79], a[164:167], v[52:55]
s_add_u32 m0, s28, 49152
s_xor_b32 s29, s26, 1048960
buffer_load_dwordx4 v5, s[8:11], s29 offen offset:0 lds
v_mfma_f32_16x16x32_bf16 v[56:59], a[80:83], a[160:163], v[56:59]
v_mfma_f32_16x16x32_bf16 v[56:59], a[84:87], a[164:167], v[56:59]
ds_read_b128 a[200:203], v17 offset:18432
v_mfma_f32_16x16x32_bf16 v[60:63], a[88:91], a[160:163], v[60:63]
v_mfma_f32_16x16x32_bf16 v[60:63], a[92:95], a[164:167], v[60:63]
v_mul_u32_u24 v1, 3456, v1
v_mfma_f32_16x16x32_bf16 v[64:67], a[32:35], a[168:171], v[64:67]
v_mfma_f32_16x16x32_bf16 v[64:67], a[36:39], a[172:175], v[64:67]
buffer_load_dwordx4 v6, s[8:11], s29 offen offset:1024 lds
v_mfma_f32_16x16x32_bf16 v[68:71], a[40:43], a[168:171], v[68:71]
v_mfma_f32_16x16x32_bf16 v[68:71], a[44:47], a[172:175], v[68:71]
ds_read_b128 a[204:207], v18 offset:18432
v_mfma_f32_16x16x32_bf16 v[72:75], a[48:51], a[168:171], v[72:75]
v_mfma_f32_16x16x32_bf16 v[72:75], a[52:55], a[172:175], v[72:75]
v_mov_b32 v2, 1073741824
v_mfma_f32_16x16x32_bf16 v[76:79], a[56:59], a[168:171], v[76:79]
v_mfma_f32_16x16x32_bf16 v[76:79], a[60:63], a[172:175], v[76:79]
ds_read_b128 a[208:211], v17 offset:20480
v_mfma_f32_16x16x32_bf16 v[80:83], a[64:67], a[168:171], v[80:83]
v_mfma_f32_16x16x32_bf16 v[80:83], a[68:71], a[172:175], v[80:83]
buffer_load_dwordx4 v7, s[8:11], s29 offen offset:2048 lds
v_mfma_f32_16x16x32_bf16 v[84:87], a[72:75], a[168:171], v[84:87]
v_mfma_f32_16x16x32_bf16 v[84:87], a[76:79], a[172:175], v[84:87]
s_mov_b32 s34, s22
v_mfma_f32_16x16x32_bf16 v[88:91], a[80:83], a[168:171], v[88:91]
v_mfma_f32_16x16x32_bf16 v[88:91], a[84:87], a[172:175], v[88:91]
ds_read_b128 a[212:215], v18 offset:20480
v_mfma_f32_16x16x32_bf16 v[92:95], a[88:91], a[168:171], v[92:95]
buffer_load_dwordx4 v8, s[8:11], s29 offen offset:3072 lds
v_mfma_f32_16x16x32_bf16 v[92:95], a[92:95], a[172:175], v[92:95]
v_mfma_f32_16x16x32_bf16 v[96:99], a[32:35], a[176:179], v[96:99]
ds_read_b128 a[216:219], v17 offset:22528
v_mfma_f32_16x16x32_bf16 v[96:99], a[36:39], a[180:183], v[96:99]
v_mfma_f32_16x16x32_bf16 v[100:103], a[40:43], a[176:179], v[100:103]
s_lshl2_add_u32 s34, s34, s20
v_mfma_f32_16x16x32_bf16 v[100:103], a[44:47], a[180:183], v[100:103]
v_mfma_f32_16x16x32_bf16 v[104:107], a[48:51], a[176:179], v[104:107]
s_add_u32 m0, s25, 98304
s_xor_b32 s29, s27, 2097152
buffer_load_dwordx4 v9, s[12:15], s29 offen offset:0 nt lds
v_mfma_f32_16x16x32_bf16 v[104:107], a[52:55], a[180:183], v[104:107]
v_mfma_f32_16x16x32_bf16 v[108:111], a[56:59], a[176:179], v[108:111]
ds_read_b128 a[220:223], v18 offset:22528
v_mfma_f32_16x16x32_bf16 v[108:111], a[60:63], a[180:183], v[108:111]
s_branch kf_kernel_pl1
kf_kernel_pd1:
s_branch kf_kernel_pd11
kf_kernel_pl1:
v_mfma_f32_16x16x32_bf16 v[112:115], a[64:67], a[176:179], v[112:115]
v_cndmask_b32 v1, v2, v1, vcc
v_mfma_f32_16x16x32_bf16 v[112:115], a[68:71], a[180:183], v[112:115]
v_mfma_f32_16x16x32_bf16 v[116:119], a[72:75], a[176:179], v[116:119]
v_mfma_f32_16x16x32_bf16 v[116:119], a[76:79], a[180:183], v[116:119]
v_mfma_f32_16x16x32_bf16 v[120:123], a[80:83], a[176:179], v[120:123]
buffer_load_dwordx4 v10, s[12:15], s29 offen offset:1024 nt lds
v_mfma_f32_16x16x32_bf16 v[120:123], a[84:87], a[180:183], v[120:123]
v_mfma_f32_16x16x32_bf16 v[124:127], a[88:91], a[176:179], v[124:127]
s_mul_i32 s34, s34, 34560
v_mfma_f32_16x16x32_bf16 v[124:127], a[92:95], a[180:183], v[124:127]
v_mfma_f32_16x16x32_bf16 v[128:131], a[32:35], a[184:187], v[128:131]
v_mfma_f32_16x16x32_bf16 v[128:131], a[36:39], a[188:191], v[128:131]
v_mfma_f32_16x16x32_bf16 v[132:135], a[40:43], a[184:187], v[132:135]
buffer_load_dwordx4 v11, s[12:15], s29 offen offset:2048 nt lds
v_mfma_f32_16x16x32_bf16 v[132:135], a[44:47], a[188:191], v[132:135]
v_mfma_f32_16x16x32_bf16 v[136:139], a[48:51], a[184:187], v[136:139]
s_add_u32 s34, s34, 0
v_mfma_f32_16x16x32_bf16 v[136:139], a[52:55], a[188:191], v[136:139]
v_mfma_f32_16x16x32_bf16 v[140:143], a[56:59], a[184:187], v[140:143]
v_mfma_f32_16x16x32_bf16 v[140:143], a[60:63], a[188:191], v[140:143]
v_mfma_f32_16x16x32_bf16 v[144:147], a[64:67], a[184:187], v[144:147]
buffer_load_dwordx4 v12, s[12:15], s29 offen offset:3072 nt lds
v_mfma_f32_16x16x32_bf16 v[144:147], a[68:71], a[188:191], v[144:147]
v_mfma_f32_16x16x32_bf16 v[148:151], a[72:75], a[184:187], v[148:151]
buffer_load_dword a237, v1, s[40:43], s34 offen
v_mfma_f32_16x16x32_bf16 v[148:151], a[76:79], a[188:191], v[148:151]
v_mfma_f32_16x16x32_bf16 v[152:155], a[80:83], a[184:187], v[152:155]
v_mfma_f32_16x16x32_bf16 v[152:155], a[84:87], a[188:191], v[152:155]
v_mfma_f32_16x16x32_bf16 v[156:159], a[88:91], a[184:187], v[156:159]
v_mfma_f32_16x16x32_bf16 v[156:159], a[92:95], a[188:191], v[156:159]
s_waitcnt vmcnt(11) lgkmcnt(0)
s_barrier
v_mfma_f32_16x16x32_bf16 v[160:163], a[32:35], a[192:195], v[160:163]
ds_read_b128 a[160:163], v17 offset:32768
v_mfma_f32_16x16x32_bf16 v[160:163], a[36:39], a[196:199], v[160:163]
ds_read_b128 a[164:167], v18 offset:32768
v_mfma_f32_16x16x32_bf16 v[164:167], a[40:43], a[192:195], v[164:167]
v_bfe_u32 v1, v0, 1, 5
v_mfma_f32_16x16x32_bf16 v[164:167], a[44:47], a[196:199], v[164:167]
s_add_u32 m0, s25, 102400
s_xor_b32 s29, s27, 2097152
buffer_load_dwordx4 v13, s[12:15], s29 offen offset:0 nt lds
v_mfma_f32_16x16x32_bf16 v[168:171], a[48:51], a[192:195], v[168:171]
ds_read_b128 a[168:171], v17 offset:34816
v_mfma_f32_16x16x32_bf16 v[168:171], a[52:55], a[196:199], v[168:171]
ds_read_b128 a[172:175], v18 offset:34816
v_mfma_f32_16x16x32_bf16 v[172:175], a[56:59], a[192:195], v[172:175]
ds_read_b128 a[176:179], v17 offset:36864
v_mfma_f32_16x16x32_bf16 v[172:175], a[60:63], a[196:199], v[172:175]
v_cmp_gt_u32 vcc, 5, v1
v_mfma_f32_16x16x32_bf16 v[176:179], a[64:67], a[192:195], v[176:179]
ds_read_b128 a[180:183], v18 offset:36864
v_mfma_f32_16x16x32_bf16 v[176:179], a[68:71], a[196:199], v[176:179]
ds_read_b128 a[184:187], v17 offset:38912
v_mfma_f32_16x16x32_bf16 v[180:183], a[72:75], a[192:195], v[180:183]
buffer_load_dwordx4 v14, s[12:15], s29 offen offset:1024 nt lds
v_mfma_f32_16x16x32_bf16 v[180:183], a[76:79], a[196:199], v[180:183]
ds_read_b128 a[188:191], v18 offset:38912
v_mfma_f32_16x16x32_bf16 v[184:187], a[80:83], a[192:195], v[184:187]
v_mul_u32_u24 v1, 8192, v1
v_mfma_f32_16x16x32_bf16 v[184:187], a[84:87], a[196:199], v[184:187]
ds_read_b64_tr_b16 a[96:97], v21 offset:0
v_mfma_f32_16x16x32_bf16 v[188:191], a[88:91], a[192:195], v[188:191]
ds_read_b64_tr_b16 a[98:99], v21 offset:2048
v_mfma_f32_16x16x32_bf16 v[188:191], a[92:95], a[196:199], v[188:191]
ds_read_b64_tr_b16 a[100:101], v21 offset:16384
v_mfma_f32_16x16x32_bf16 v[192:195], a[32:35], a[200:203], v[192:195]
ds_read_b64_tr_b16 a[102:103], v21 offset:18432
v_mfma_f32_16x16x32_bf16 v[192:195], a[36:39], a[204:207], v[192:195]
v_and_b32 v2, 1, v0
v_mfma_f32_16x16x32_bf16 v[196:199], a[40:43], a[200:203], v[196:199]
buffer_load_dwordx4 v15, s[12:15], s29 offen offset:2048 nt lds
v_mfma_f32_16x16x32_bf16 v[196:199], a[44:47], a[204:207], v[196:199]
ds_read_b64_tr_b16 a[104:105], v22 offset:0
v_mfma_f32_16x16x32_bf16 v[200:203], a[48:51], a[200:203], v[200:203]
ds_read_b64_tr_b16 a[106:107], v22 offset:2048
v_mfma_f32_16x16x32_bf16 v[200:203], a[52:55], a[204:207], v[200:203]
ds_read_b64_tr_b16 a[108:109], v22 offset:16384
v_mfma_f32_16x16x32_bf16 v[204:207], a[56:59], a[200:203], v[204:207]
v_lshl_add_u32 v1, v2, 7, v1
v_mfma_f32_16x16x32_bf16 v[204:207], a[60:63], a[204:207], v[204:207]
ds_read_b64_tr_b16 a[110:111], v22 offset:18432
v_mfma_f32_16x16x32_bf16 v[208:211], a[64:67], a[200:203], v[208:211]
ds_read_b64_tr_b16 a[112:113], v23 offset:0
v_mfma_f32_16x16x32_bf16 v[208:211], a[68:71], a[204:207], v[208:211]
buffer_load_dwordx4 v16, s[12:15], s29 offen offset:3072 nt lds
v_mfma_f32_16x16x32_bf16 v[212:215], a[72:75], a[200:203], v[212:215]
ds_read_b64_tr_b16 a[114:115], v23 offset:2048
v_mfma_f32_16x16x32_bf16 v[212:215], a[76:79], a[204:207], v[212:215]
v_mov_b32 v2, 1073741824
v_mfma_f32_16x16x32_bf16 v[216:219], a[80:83], a[200:203], v[216:219]
ds_read_b64_tr_b16 a[116:117], v23 offset:16384
v_mfma_f32_16x16x32_bf16 v[216:219], a[84:87], a[204:207], v[216:219]
ds_read_b64_tr_b16 a[118:119], v23 offset:18432
v_mfma_f32_16x16x32_bf16 v[220:223], a[88:91], a[200:203], v[220:223]
ds_read_b64_tr_b16 a[120:121], v24 offset:0
v_mfma_f32_16x16x32_bf16 v[220:223], a[92:95], a[204:207], v[220:223]
ds_read_b64_tr_b16 a[122:123], v24 offset:2048
v_mfma_f32_16x16x32_bf16 v[224:227], a[32:35], a[208:211], v[224:227]
s_mov_b32 s34, s22
v_mfma_f32_16x16x32_bf16 v[224:227], a[36:39], a[212:215], v[224:227]
s_add_u32 m0, s28, 0
s_xor_b32 s29, s26, 512
buffer_load_dwordx4 v5, s[8:11], s29 offen offset:0 lds
v_mfma_f32_16x16x32_bf16 v[228:231], a[40:43], a[208:211], v[228:231]
ds_read_b64_tr_b16 a[124:125], v24 offset:16384
v_mfma_f32_16x16x32_bf16 v[228:231], a[44:47], a[212:215], v[228:231]
ds_read_b64_tr_b16 a[126:127], v24 offset:18432
v_mfma_f32_16x16x32_bf16 v[232:235], a[48:51], a[208:211], v[232:235]
ds_read_b64_tr_b16 a[128:129], v25 offset:0
v_mfma_f32_16x16x32_bf16 v[232:235], a[52:55], a[212:215], v[232:235]
s_lshl2_add_u32 s34, s34, s20
v_mfma_f32_16x16x32_bf16 v[236:239], a[56:59], a[208:211], v[236:239]
ds_read_b64_tr_b16 a[130:131], v25 offset:2048
v_mfma_f32_16x16x32_bf16 v[236:239], a[60:63], a[212:215], v[236:239]
ds_read_b64_tr_b16 a[132:133], v25 offset:16384
v_mfma_f32_16x16x32_bf16 v[240:243], a[64:67], a[208:211], v[240:243]
buffer_load_dwordx4 v6, s[8:11], s29 offen offset:1024 lds
v_mfma_f32_16x16x32_bf16 v[240:243], a[68:71], a[212:215], v[240:243]
ds_read_b64_tr_b16 a[134:135], v25 offset:18432
v_mfma_f32_16x16x32_bf16 v[244:247], a[72:75], a[208:211], v[244:247]
v_cndmask_b32 v1, v2, v1, vcc
v_mfma_f32_16x16x32_bf16 v[244:247], a[76:79], a[212:215], v[244:247]
ds_read_b64_tr_b16 a[136:137], v26 offset:0
v_mfma_f32_16x16x32_bf16 v[248:251], a[80:83], a[208:211], v[248:251]
ds_read_b64_tr_b16 a[138:139], v26 offset:2048
v_mfma_f32_16x16x32_bf16 v[248:251], a[84:87], a[212:215], v[248:251]
ds_read_b64_tr_b16 a[140:141], v26 offset:16384
v_mfma_f32_16x16x32_bf16 v[252:255], a[88:91], a[208:211], v[252:255]
ds_read_b64_tr_b16 a[142:143], v26 offset:18432
v_mfma_f32_16x16x32_bf16 v[252:255], a[92:95], a[212:215], v[252:255]
s_mul_i32 s34, s34, 40960
v_mfma_f32_16x16x32_bf16 a[0:3], a[32:35], a[216:219], a[0:3]
buffer_load_dwordx4 v7, s[8:11], s29 offen offset:2048 lds
v_mfma_f32_16x16x32_bf16 a[0:3], a[36:39], a[220:223], a[0:3]
ds_read_b64_tr_b16 a[144:145], v27 offset:0
v_mfma_f32_16x16x32_bf16 a[4:7], a[40:43], a[216:219], a[4:7]
ds_read_b64_tr_b16 a[146:147], v27 offset:2048
v_mfma_f32_16x16x32_bf16 a[4:7], a[44:47], a[220:223], a[4:7]
ds_read_b64_tr_b16 a[148:149], v27 offset:16384
v_mfma_f32_16x16x32_bf16 a[8:11], a[48:51], a[216:219], a[8:11]
s_add_u32 s34, s34, 1310720
v_mfma_f32_16x16x32_bf16 a[8:11], a[52:55], a[220:223], a[8:11]
ds_read_b64_tr_b16 a[150:151], v27 offset:18432
v_mfma_f32_16x16x32_bf16 a[12:15], a[56:59], a[216:219], a[12:15]
ds_read_b64_tr_b16 a[152:153], v28 offset:0
v_mfma_f32_16x16x32_bf16 a[12:15], a[60:63], a[220:223], a[12:15]
buffer_load_dwordx4 v8, s[8:11], s29 offen offset:3072 lds
v_mfma_f32_16x16x32_bf16 a[16:19], a[64:67], a[216:219], a[16:19]
ds_read_b64_tr_b16 a[154:155], v28 offset:2048
v_mfma_f32_16x16x32_bf16 a[16:19], a[68:71], a[220:223], a[16:19]
buffer_load_dword a238, v1, s[44:47], s34 offen
v_mfma_f32_16x16x32_bf16 a[20:23], a[72:75], a[216:219], a[20:23]
ds_read_b64_tr_b16 a[156:157], v28 offset:16384
v_mfma_f32_16x16x32_bf16 a[20:23], a[76:79], a[220:223], a[20:23]
ds_read_b64_tr_b16 a[158:159], v28 offset:18432
v_mfma_f32_16x16x32_bf16 a[24:27], a[80:83], a[216:219], a[24:27]
v_mfma_f32_16x16x32_bf16 a[24:27], a[84:87], a[220:223], a[24:27]
v_mfma_f32_16x16x32_bf16 a[28:31], a[88:91], a[216:219], a[28:31]
v_mfma_f32_16x16x32_bf16 a[28:31], a[92:95], a[220:223], a[28:31]
s_waitcnt vmcnt(14) lgkmcnt(0)
s_barrier
v_mfma_f32_16x16x32_bf16 v[32:35], a[96:99], a[160:163], v[32:35]
v_mfma_f32_16x16x32_bf16 v[32:35], a[100:103], a[164:167], v[32:35]
ds_read_b128 a[192:195], v17 offset:49152
v_mfma_f32_16x16x32_bf16 v[36:39], a[104:107], a[160:163], v[36:39]
v_mfma_f32_16x16x32_bf16 v[36:39], a[108:111], a[164:167], v[36:39]
v_bfe_u32 v1, v0, 1, 5
v_mfma_f32_16x16x32_bf16 v[40:43], a[112:115], a[160:163], v[40:43]
v_mfma_f32_16x16x32_bf16 v[40:43], a[116:119], a[164:167], v[40:43]
s_add_u32 m0, s28, 16384
s_xor_b32 s29, s26, 1049088
buffer_load_dwordx4 v5, s[8:11], s29 offen offset:0 lds
v_mfma_f32_16x16x32_bf16 v[44:47], a[120:123], a[160:163], v[44:47]
v_mfma_f32_16x16x32_bf16 v[44:47], a[124:127], a[164:167], v[44:47]
ds_read_b128 a[196:199], v18 offset:49152
v_mfma_f32_16x16x32_bf16 v[48:51], a[128:131], a[160:163], v[48:51]
v_mfma_f32_16x16x32_bf16 v[48:51], a[132:135], a[164:167], v[48:51]
v_cmp_gt_u32 vcc, 5, v1
v_mfma_f32_16x16x32_bf16 v[52:55], a[136:139], a[160:163], v[52:55]
v_mfma_f32_16x16x32_bf16 v[52:55], a[140:143], a[164:167], v[52:55]
buffer_load_dwordx4 v6, s[8:11], s29 offen offset:1024 lds
v_mfma_f32_16x16x32_bf16 v[56:59], a[144:147], a[160:163], v[56:59]
v_mfma_f32_16x16x32_bf16 v[56:59], a[148:151], a[164:167], v[56:59]
ds_read_b128 a[200:203], v17 offset:51200
v_mfma_f32_16x16x32_bf16 v[60:63], a[152:155], a[160:163], v[60:63]
v_mul_u32_u24 v1, 8192, v1
v_mfma_f32_16x16x32_bf16 v[60:63], a[156:159], a[164:167], v[60:63]
v_mfma_f32_16x16x32_bf16 v[64:67], a[96:99], a[168:171], v[64:67]
ds_read_b128 a[204:207], v18 offset:51200
v_mfma_f32_16x16x32_bf16 v[64:67], a[100:103], a[172:175], v[64:67]
v_mfma_f32_16x16x32_bf16 v[68:71], a[104:107], a[168:171], v[68:71]
v_and_b32 v2, 1, v0
v_mfma_f32_16x16x32_bf16 v[68:71], a[108:111], a[172:175], v[68:71]
v_mfma_f32_16x16x32_bf16 v[72:75], a[112:115], a[168:171], v[72:75]
buffer_load_dwordx4 v7, s[8:11], s29 offen offset:2048 lds
v_mfma_f32_16x16x32_bf16 v[72:75], a[116:119], a[172:175], v[72:75]
v_mfma_f32_16x16x32_bf16 v[76:79], a[120:123], a[168:171], v[76:79]
ds_read_b128 a[208:211], v17 offset:53248
v_mfma_f32_16x16x32_bf16 v[76:79], a[124:127], a[172:175], v[76:79]
v_mfma_f32_16x16x32_bf16 v[80:83], a[128:131], a[168:171], v[80:83]
v_lshl_add_u32 v1, v2, 7, v1
v_mfma_f32_16x16x32_bf16 v[80:83], a[132:135], a[172:175], v[80:83]
v_mfma_f32_16x16x32_bf16 v[84:87], a[136:139], a[168:171], v[84:87]
buffer_load_dwordx4 v8, s[8:11], s29 offen offset:3072 lds
v_mfma_f32_16x16x32_bf16 v[84:87], a[140:143], a[172:175], v[84:87]
v_mfma_f32_16x16x32_bf16 v[88:91], a[144:147], a[168:171], v[88:91]
ds_read_b128 a[212:215], v18 offset:53248
v_mfma_f32_16x16x32_bf16 v[88:91], a[148:151], a[172:175], v[88:91]
v_mov_b32 v2, 1073741824
v_mfma_f32_16x16x32_bf16 v[92:95], a[152:155], a[168:171], v[92:95]
v_mfma_f32_16x16x32_bf16 v[92:95], a[156:159], a[172:175], v[92:95]
ds_read_b128 a[216:219], v17 offset:55296
v_mfma_f32_16x16x32_bf16 v[96:99], a[96:99], a[176:179], v[96:99]
v_mfma_f32_16x16x32_bf16 v[96:99], a[100:103], a[180:183], v[96:99]
s_mov_b32 s34, s22
v_mfma_f32_16x16x32_bf16 v[100:103], a[104:107], a[176:179], v[100:103]
v_mfma_f32_16x16x32_bf16 v[100:103], a[108:111], a[180:183], v[100:103]
s_add_u32 m0, s25, 65536
s_xor_b32 s29, s27, 2621440
buffer_load_dwordx4 v9, s[12:15], s29 offen offset:0 nt lds
v_mfma_f32_16x16x32_bf16 v[104:107], a[112:115], a[176:179], v[104:107]
v_mfma_f32_16x16x32_bf16 v[104:107], a[116:119], a[180:183], v[104:107]
ds_read_b128 a[220:223], v18 offset:55296
v_mfma_f32_16x16x32_bf16 v[108:111], a[120:123], a[176:179], v[108:111]
v_mfma_f32_16x16x32_bf16 v[108:111], a[124:127], a[180:183], v[108:111]
s_lshl2_add_u32 s34, s34, s20
v_mfma_f32_16x16x32_bf16 v[112:115], a[128:131], a[176:179], v[112:115]
v_mfma_f32_16x16x32_bf16 v[112:115], a[132:135], a[180:183], v[112:115]
buffer_load_dwordx4 v10, s[12:15], s29 offen offset:1024 nt lds
v_mfma_f32_16x16x32_bf16 v[116:119], a[136:139], a[176:179], v[116:119]
v_mfma_f32_16x16x32_bf16 v[116:119], a[140:143], a[180:183], v[116:119]
v_mfma_f32_16x16x32_bf16 v[120:123], a[144:147], a[176:179], v[120:123]
v_cndmask_b32 v1, v2, v1, vcc
v_mfma_f32_16x16x32_bf16 v[120:123], a[148:151], a[180:183], v[120:123]
v_mfma_f32_16x16x32_bf16 v[124:127], a[152:155], a[176:179], v[124:127]
v_mfma_f32_16x16x32_bf16 v[124:127], a[156:159], a[180:183], v[124:127]
v_mfma_f32_16x16x32_bf16 v[128:131], a[96:99], a[184:187], v[128:131]
s_mul_i32 s34, s34, 40960
v_mfma_f32_16x16x32_bf16 v[128:131], a[100:103], a[188:191], v[128:131]
v_mfma_f32_16x16x32_bf16 v[132:135], a[104:107], a[184:187], v[132:135]
buffer_load_dwordx4 v11, s[12:15], s29 offen offset:2048 nt lds
v_mfma_f32_16x16x32_bf16 v[132:135], a[108:111], a[188:191], v[132:135]
v_mfma_f32_16x16x32_bf16 v[136:139], a[112:115], a[184:187], v[136:139]
v_mfma_f32_16x16x32_bf16 v[136:139], a[116:119], a[188:191], v[136:139]
v_mfma_f32_16x16x32_bf16 v[140:143], a[120:123], a[184:187], v[140:143]
s_add_u32 s34, s34, 2621440
v_mfma_f32_16x16x32_bf16 v[140:143], a[124:127], a[188:191], v[140:143]
v_mfma_f32_16x16x32_bf16 v[144:147], a[128:131], a[184:187], v[144:147]
buffer_load_dwordx4 v12, s[12:15], s29 offen offset:3072 nt lds
v_mfma_f32_16x16x32_bf16 v[144:147], a[132:135], a[188:191], v[144:147]
v_mfma_f32_16x16x32_bf16 v[148:151], a[136:139], a[184:187], v[148:151]
v_mfma_f32_16x16x32_bf16 v[148:151], a[140:143], a[188:191], v[148:151]
buffer_load_dword a239, v1, s[44:47], s34 offen
v_mfma_f32_16x16x32_bf16 v[152:155], a[144:147], a[184:187], v[152:155]
v_mfma_f32_16x16x32_bf16 v[152:155], a[148:151], a[188:191], v[152:155]
v_mfma_f32_16x16x32_bf16 v[156:159], a[152:155], a[184:187], v[156:159]
v_mfma_f32_16x16x32_bf16 v[156:159], a[156:159], a[188:191], v[156:159]
s_waitcnt vmcnt(10) lgkmcnt(0)
s_barrier
v_mfma_f32_16x16x32_bf16 v[160:163], a[96:99], a[192:195], v[160:163]
v_mfma_f32_16x16x32_bf16 v[160:163], a[100:103], a[196:199], v[160:163]
ds_read_b128 a[160:163], v17 offset:0
v_mfma_f32_16x16x32_bf16 v[164:167], a[104:107], a[192:195], v[164:167]
ds_read_b128 a[164:167], v18 offset:0
v_mfma_f32_16x16x32_bf16 v[164:167], a[108:111], a[196:199], v[164:167]
v_bfe_u32 v1, v0, 0, 6
v_mfma_f32_16x16x32_bf16 v[168:171], a[112:115], a[192:195], v[168:171]
s_add_u32 m0, s25, 69632
s_xor_b32 s29, s27, 2621440
buffer_load_dwordx4 v13, s[12:15], s29 offen offset:0 nt lds
v_mfma_f32_16x16x32_bf16 v[168:171], a[116:119], a[196:199], v[168:171]
ds_read_b128 a[168:171], v17 offset:2048
v_mfma_f32_16x16x32_bf16 v[172:175], a[120:123], a[192:195], v[172:175]
ds_read_b128 a[172:175], v18 offset:2048
v_mfma_f32_16x16x32_bf16 v[172:175], a[124:127], a[196:199], v[172:175]
ds_read_b128 a[176:179], v17 offset:4096
v_mfma_f32_16x16x32_bf16 v[176:179], a[128:131], a[192:195], v[176:179]
ds_read_b128 a[180:183], v18 offset:4096
v_mfma_f32_16x16x32_bf16 v[176:179], a[132:135], a[196:199], v[176:179]
v_cmp_gt_u32 vcc, 10, v1
v_mfma_f32_16x16x32_bf16 v[180:183], a[136:139], a[192:195], v[180:183]
ds_read_b128 a[184:187], v17 offset:6144
v_mfma_f32_16x16x32_bf16 v[180:183], a[140:143], a[196:199], v[180:183]
buffer_load_dwordx4 v14, s[12:15], s29 offen offset:1024 nt lds
v_mfma_f32_16x16x32_bf16 v[184:187], a[144:147], a[192:195], v[184:187]
ds_read_b128 a[188:191], v18 offset:6144
v_mfma_f32_16x16x32_bf16 v[184:187], a[148:151], a[196:199], v[184:187]
ds_read_b64_tr_b16 a[32:33], v21 offset:32768
v_mfma_f32_16x16x32_bf16 v[188:191], a[152:155], a[192:195], v[188:191]
ds_read_b64_tr_b16 a[34:35], v21 offset:34816
v_mfma_f32_16x16x32_bf16 v[188:191], a[156:159], a[196:199], v[188:191]
v_mul_u32_u24 v1, 3456, v1
v_mfma_f32_16x16x32_bf16 v[192:195], a[96:99], a[200:203], v[192:195]
ds_read_b64_tr_b16 a[36:37], v21 offset:49152
v_mfma_f32_16x16x32_bf16 v[192:195], a[100:103], a[204:207], v[192:195]
ds_read_b64_tr_b16 a[38:39], v21 offset:51200
v_mfma_f32_16x16x32_bf16 v[196:199], a[104:107], a[200:203], v[196:199]
buffer_load_dwordx4 v15, s[12:15], s29 offen offset:2048 nt lds
v_mfma_f32_16x16x32_bf16 v[196:199], a[108:111], a[204:207], v[196:199]
ds_read_b64_tr_b16 a[40:41], v22 offset:32768
v_mfma_f32_16x16x32_bf16 v[200:203], a[112:115], a[200:203], v[200:203]
ds_read_b64_tr_b16 a[42:43], v22 offset:34816
v_mfma_f32_16x16x32_bf16 v[200:203], a[116:119], a[204:207], v[200:203]
v_mov_b32 v2, 1073741824
v_mfma_f32_16x16x32_bf16 v[204:207], a[120:123], a[200:203], v[204:207]
ds_read_b64_tr_b16 a[44:45], v22 offset:49152
v_mfma_f32_16x16x32_bf16 v[204:207], a[124:127], a[204:207], v[204:207]
ds_read_b64_tr_b16 a[46:47], v22 offset:51200
v_mfma_f32_16x16x32_bf16 v[208:211], a[128:131], a[200:203], v[208:211]
ds_read_b64_tr_b16 a[48:49], v23 offset:32768
v_mfma_f32_16x16x32_bf16 v[208:211], a[132:135], a[204:207], v[208:211]
buffer_load_dwordx4 v16, s[12:15], s29 offen offset:3072 nt lds
v_mfma_f32_16x16x32_bf16 v[212:215], a[136:139], a[200:203], v[212:215]
ds_read_b64_tr_b16 a[50:51], v23 offset:34816
v_mfma_f32_16x16x32_bf16 v[212:215], a[140:143], a[204:207], v[212:215]
s_mov_b32 s34, s22
v_mfma_f32_16x16x32_bf16 v[216:219], a[144:147], a[200:203], v[216:219]
ds_read_b64_tr_b16 a[52:53], v23 offset:49152
v_mfma_f32_16x16x32_bf16 v[216:219], a[148:151], a[204:207], v[216:219]
ds_read_b64_tr_b16 a[54:55], v23 offset:51200
v_mfma_f32_16x16x32_bf16 v[220:223], a[152:155], a[200:203], v[220:223]
v_mfma_f32_16x16x32_bf16 v[220:223], a[156:159], a[204:207], v[220:223]
ds_read_b64_tr_b16 a[56:57], v24 offset:32768
v_mfma_f32_16x16x32_bf16 v[224:227], a[96:99], a[208:211], v[224:227]
ds_read_b64_tr_b16 a[58:59], v24 offset:34816
v_mfma_f32_16x16x32_bf16 v[224:227], a[100:103], a[212:215], v[224:227]
s_lshl2_add_u32 s34, s34, s20
v_mfma_f32_16x16x32_bf16 v[228:231], a[104:107], a[208:211], v[228:231]
s_add_u32 m0, s28, 32768
s_xor_b32 s29, s26, 640
buffer_load_dwordx4 v5, s[8:11], s29 offen offset:0 lds
v_mfma_f32_16x16x32_bf16 v[228:231], a[108:111], a[212:215], v[228:231]
ds_read_b64_tr_b16 a[60:61], v24 offset:49152
v_mfma_f32_16x16x32_bf16 v[232:235], a[112:115], a[208:211], v[232:235]
ds_read_b64_tr_b16 a[62:63], v24 offset:51200
v_mfma_f32_16x16x32_bf16 v[232:235], a[116:119], a[212:215], v[232:235]
ds_read_b64_tr_b16 a[64:65], v25 offset:32768
v_mfma_f32_16x16x32_bf16 v[236:239], a[120:123], a[208:211], v[236:239]
ds_read_b64_tr_b16 a[66:67], v25 offset:34816
v_mfma_f32_16x16x32_bf16 v[236:239], a[124:127], a[212:215], v[236:239]
v_cndmask_b32 v1, v2, v1, vcc
v_mfma_f32_16x16x32_bf16 v[240:243], a[128:131], a[208:211], v[240:243]
ds_read_b64_tr_b16 a[68:69], v25 offset:49152
v_mfma_f32_16x16x32_bf16 v[240:243], a[132:135], a[212:215], v[240:243]
buffer_load_dwordx4 v6, s[8:11], s29 offen offset:1024 lds
v_mfma_f32_16x16x32_bf16 v[244:247], a[136:139], a[208:211], v[244:247]
ds_read_b64_tr_b16 a[70:71], v25 offset:51200
v_mfma_f32_16x16x32_bf16 v[244:247], a[140:143], a[212:215], v[244:247]
ds_read_b64_tr_b16 a[72:73], v26 offset:32768
v_mfma_f32_16x16x32_bf16 v[248:251], a[144:147], a[208:211], v[248:251]
ds_read_b64_tr_b16 a[74:75], v26 offset:34816
v_mfma_f32_16x16x32_bf16 v[248:251], a[148:151], a[212:215], v[248:251]
s_mul_i32 s34, s34, 34560
v_mfma_f32_16x16x32_bf16 v[252:255], a[152:155], a[208:211], v[252:255]
ds_read_b64_tr_b16 a[76:77], v26 offset:49152
v_mfma_f32_16x16x32_bf16 v[252:255], a[156:159], a[212:215], v[252:255]
ds_read_b64_tr_b16 a[78:79], v26 offset:51200
v_mfma_f32_16x16x32_bf16 a[0:3], a[96:99], a[216:219], a[0:3]
buffer_load_dwordx4 v7, s[8:11], s29 offen offset:2048 lds
v_mfma_f32_16x16x32_bf16 a[0:3], a[100:103], a[220:223], a[0:3]
ds_read_b64_tr_b16 a[80:81], v27 offset:32768
v_mfma_f32_16x16x32_bf16 a[4:7], a[104:107], a[216:219], a[4:7]
ds_read_b64_tr_b16 a[82:83], v27 offset:34816
v_mfma_f32_16x16x32_bf16 a[4:7], a[108:111], a[220:223], a[4:7]
s_add_u32 s34, s34, 1105920
v_mfma_f32_16x16x32_bf16 a[8:11], a[112:115], a[216:219], a[8:11]
ds_read_b64_tr_b16 a[84:85], v27 offset:49152
v_mfma_f32_16x16x32_bf16 a[8:11], a[116:119], a[220:223], a[8:11]
ds_read_b64_tr_b16 a[86:87], v27 offset:51200
v_mfma_f32_16x16x32_bf16 a[12:15], a[120:123], a[216:219], a[12:15]
ds_read_b64_tr_b16 a[88:89], v28 offset:32768
v_mfma_f32_16x16x32_bf16 a[12:15], a[124:127], a[220:223], a[12:15]
buffer_load_dwordx4 v8, s[8:11], s29 offen offset:3072 lds
v_mfma_f32_16x16x32_bf16 a[16:19], a[128:131], a[216:219], a[16:19]
ds_read_b64_tr_b16 a[90:91], v28 offset:34816
v_mfma_f32_16x16x32_bf16 a[16:19], a[132:135], a[220:223], a[16:19]
buffer_load_dword a240, v1, s[40:43], s34 offen
v_mfma_f32_16x16x32_bf16 a[20:23], a[136:139], a[216:219], a[20:23]
ds_read_b64_tr_b16 a[92:93], v28 offset:49152
v_mfma_f32_16x16x32_bf16 a[20:23], a[140:143], a[220:223], a[20:23]
ds_read_b64_tr_b16 a[94:95], v28 offset:51200
v_mfma_f32_16x16x32_bf16 a[24:27], a[144:147], a[216:219], a[24:27]
v_mfma_f32_16x16x32_bf16 a[24:27], a[148:151], a[220:223], a[24:27]
v_mfma_f32_16x16x32_bf16 a[28:31], a[152:155], a[216:219], a[28:31]
v_mfma_f32_16x16x32_bf16 a[28:31], a[156:159], a[220:223], a[28:31]
s_waitcnt vmcnt(14) lgkmcnt(0)
s_barrier
v_mfma_f32_16x16x32_bf16 v[32:35], a[32:35], a[160:163], v[32:35]
v_mfma_f32_16x16x32_bf16 v[32:35], a[36:39], a[164:167], v[32:35]
ds_read_b128 a[192:195], v17 offset:16384
v_mfma_f32_16x16x32_bf16 v[36:39], a[40:43], a[160:163], v[36:39]
v_mfma_f32_16x16x32_bf16 v[36:39], a[44:47], a[164:167], v[36:39]
v_bfe_u32 v1, v0, 1, 5
v_mfma_f32_16x16x32_bf16 v[40:43], a[48:51], a[160:163], v[40:43]
v_mfma_f32_16x16x32_bf16 v[40:43], a[52:55], a[164:167], v[40:43]
s_add_u32 m0, s28, 49152
s_xor_b32 s29, s26, 1049216
buffer_load_dwordx4 v5, s[8:11], s29 offen offset:0 lds
v_mfma_f32_16x16x32_bf16 v[44:47], a[56:59], a[160:163], v[44:47]
v_mfma_f32_16x16x32_bf16 v[44:47], a[60:63], a[164:167], v[44:47]
ds_read_b128 a[196:199], v18 offset:16384
v_mfma_f32_16x16x32_bf16 v[48:51], a[64:67], a[160:163], v[48:51]
v_mfma_f32_16x16x32_bf16 v[48:51], a[68:71], a[164:167], v[48:51]
v_cmp_gt_u32 vcc, 5, v1
v_mfma_f32_16x16x32_bf16 v[52:55], a[72:75], a[160:163], v[52:55]
v_mfma_f32_16x16x32_bf16 v[52:55], a[76:79], a[164:167], v[52:55]
buffer_load_dwordx4 v6, s[8:11], s29 offen offset:1024 lds
v_mfma_f32_16x16x32_bf16 v[56:59], a[80:83], a[160:163], v[56:59]
v_mfma_f32_16x16x32_bf16 v[56:59], a[84:87], a[164:167], v[56:59]
ds_read_b128 a[200:203], v17 offset:18432
v_mfma_f32_16x16x32_bf16 v[60:63], a[88:91], a[160:163], v[60:63]
v_mul_u32_u24 v1, 8192, v1
v_mfma_f32_16x16x32_bf16 v[60:63], a[92:95], a[164:167], v[60:63]
v_mfma_f32_16x16x32_bf16 v[64:67], a[32:35], a[168:171], v[64:67]
ds_read_b128 a[204:207], v18 offset:18432
v_mfma_f32_16x16x32_bf16 v[64:67], a[36:39], a[172:175], v[64:67]
v_mfma_f32_16x16x32_bf16 v[68:71], a[40:43], a[168:171], v[68:71]
v_and_b32 v2, 1, v0
v_mfma_f32_16x16x32_bf16 v[68:71], a[44:47], a[172:175], v[68:71]
v_mfma_f32_16x16x32_bf16 v[72:75], a[48:51], a[168:171], v[72:75]
buffer_load_dwordx4 v7, s[8:11], s29 offen offset:2048 lds
v_mfma_f32_16x16x32_bf16 v[72:75], a[52:55], a[172:175], v[72:75]
v_mfma_f32_16x16x32_bf16 v[76:79], a[56:59], a[168:171], v[76:79]
ds_read_b128 a[208:211], v17 offset:20480
v_mfma_f32_16x16x32_bf16 v[76:79], a[60:63], a[172:175], v[76:79]
v_mfma_f32_16x16x32_bf16 v[80:83], a[64:67], a[168:171], v[80:83]
v_lshl_add_u32 v1, v2, 7, v1
v_mfma_f32_16x16x32_bf16 v[80:83], a[68:71], a[172:175], v[80:83]
v_mfma_f32_16x16x32_bf16 v[84:87], a[72:75], a[168:171], v[84:87]
buffer_load_dwordx4 v8, s[8:11], s29 offen offset:3072 lds
v_mfma_f32_16x16x32_bf16 v[84:87], a[76:79], a[172:175], v[84:87]
v_mfma_f32_16x16x32_bf16 v[88:91], a[80:83], a[168:171], v[88:91]
ds_read_b128 a[212:215], v18 offset:20480
v_mfma_f32_16x16x32_bf16 v[88:91], a[84:87], a[172:175], v[88:91]
v_mov_b32 v2, 1073741824
v_mfma_f32_16x16x32_bf16 v[92:95], a[88:91], a[168:171], v[92:95]
v_mfma_f32_16x16x32_bf16 v[92:95], a[92:95], a[172:175], v[92:95]
ds_read_b128 a[216:219], v17 offset:22528
v_mfma_f32_16x16x32_bf16 v[96:99], a[32:35], a[176:179], v[96:99]
v_mfma_f32_16x16x32_bf16 v[96:99], a[36:39], a[180:183], v[96:99]
s_mov_b32 s34, s22
v_mfma_f32_16x16x32_bf16 v[100:103], a[40:43], a[176:179], v[100:103]
v_mfma_f32_16x16x32_bf16 v[100:103], a[44:47], a[180:183], v[100:103]
s_add_u32 m0, s25, 98304
s_xor_b32 s29, s27, 3145728
buffer_load_dwordx4 v9, s[12:15], s29 offen offset:0 nt lds
v_mfma_f32_16x16x32_bf16 v[104:107], a[48:51], a[176:179], v[104:107]
v_mfma_f32_16x16x32_bf16 v[104:107], a[52:55], a[180:183], v[104:107]
ds_read_b128 a[220:223], v18 offset:22528
v_mfma_f32_16x16x32_bf16 v[108:111], a[56:59], a[176:179], v[108:111]
v_mfma_f32_16x16x32_bf16 v[108:111], a[60:63], a[180:183], v[108:111]
s_lshl2_add_u32 s34, s34, s20
v_mfma_f32_16x16x32_bf16 v[112:115], a[64:67], a[176:179], v[112:115]
v_mfma_f32_16x16x32_bf16 v[112:115], a[68:71], a[180:183], v[112:115]
buffer_load_dwordx4 v10, s[12:15], s29 offen offset:1024 nt lds
v_mfma_f32_16x16x32_bf16 v[116:119], a[72:75], a[176:179], v[116:119]
v_mfma_f32_16x16x32_bf16 v[116:119], a[76:79], a[180:183], v[116:119]
v_mfma_f32_16x16x32_bf16 v[120:123], a[80:83], a[176:179], v[120:123]
v_cndmask_b32 v1, v2, v1, vcc
v_mfma_f32_16x16x32_bf16 v[120:123], a[84:87], a[180:183], v[120:123]
v_mfma_f32_16x16x32_bf16 v[124:127], a[88:91], a[176:179], v[124:127]
v_mfma_f32_16x16x32_bf16 v[124:127], a[92:95], a[180:183], v[124:127]
v_mfma_f32_16x16x32_bf16 v[128:131], a[32:35], a[184:187], v[128:131]
s_mul_i32 s34, s34, 40960
v_mfma_f32_16x16x32_bf16 v[128:131], a[36:39], a[188:191], v[128:131]
v_mfma_f32_16x16x32_bf16 v[132:135], a[40:43], a[184:187], v[132:135]
buffer_load_dwordx4 v11, s[12:15], s29 offen offset:2048 nt lds
v_mfma_f32_16x16x32_bf16 v[132:135], a[44:47], a[188:191], v[132:135]
v_mfma_f32_16x16x32_bf16 v[136:139], a[48:51], a[184:187], v[136:139]
v_mfma_f32_16x16x32_bf16 v[136:139], a[52:55], a[188:191], v[136:139]
v_mfma_f32_16x16x32_bf16 v[140:143], a[56:59], a[184:187], v[140:143]
s_add_u32 s34, s34, 3932160
v_mfma_f32_16x16x32_bf16 v[140:143], a[60:63], a[188:191], v[140:143]
v_mfma_f32_16x16x32_bf16 v[144:147], a[64:67], a[184:187], v[144:147]
buffer_load_dwordx4 v12, s[12:15], s29 offen offset:3072 nt lds
v_mfma_f32_16x16x32_bf16 v[144:147], a[68:71], a[188:191], v[144:147]
v_mfma_f32_16x16x32_bf16 v[148:151], a[72:75], a[184:187], v[148:151]
v_mfma_f32_16x16x32_bf16 v[148:151], a[76:79], a[188:191], v[148:151]
buffer_load_dword a241, v1, s[44:47], s34 offen
v_mfma_f32_16x16x32_bf16 v[152:155], a[80:83], a[184:187], v[152:155]
v_mfma_f32_16x16x32_bf16 v[152:155], a[84:87], a[188:191], v[152:155]
v_mfma_f32_16x16x32_bf16 v[156:159], a[88:91], a[184:187], v[156:159]
v_mfma_f32_16x16x32_bf16 v[156:159], a[92:95], a[188:191], v[156:159]
s_waitcnt vmcnt(10) lgkmcnt(0)
s_barrier
v_mfma_f32_16x16x32_bf16 v[160:163], a[32:35], a[192:195], v[160:163]
v_mfma_f32_16x16x32_bf16 v[160:163], a[36:39], a[196:199], v[160:163]
ds_read_b128 a[160:163], v17 offset:32768
v_mfma_f32_16x16x32_bf16 v[164:167], a[40:43], a[192:195], v[164:167]
ds_read_b128 a[164:167], v18 offset:32768
v_mfma_f32_16x16x32_bf16 v[164:167], a[44:47], a[196:199], v[164:167]
s_add_u32 m0, s25, 102400
s_xor_b32 s29, s27, 3145728
buffer_load_dwordx4 v13, s[12:15], s29 offen offset:0 nt lds
v_mfma_f32_16x16x32_bf16 v[168:171], a[48:51], a[192:195], v[168:171]
ds_read_b128 a[168:171], v17 offset:34816
v_mfma_f32_16x16x32_bf16 v[168:171], a[52:55], a[196:199], v[168:171]
v_mfma_f32_16x16x32_bf16 v[172:175], a[56:59], a[192:195], v[172:175]
ds_read_b128 a[172:175], v18 offset:34816
v_mfma_f32_16x16x32_bf16 v[172:175], a[60:63], a[196:199], v[172:175]
ds_read_b128 a[176:179], v17 offset:36864
v_mfma_f32_16x16x32_bf16 v[176:179], a[64:67], a[192:195], v[176:179]
ds_read_b128 a[180:183], v18 offset:36864
v_mfma_f32_16x16x32_bf16 v[176:179], a[68:71], a[196:199], v[176:179]
ds_read_b128 a[184:187], v17 offset:38912
v_mfma_f32_16x16x32_bf16 v[180:183], a[72:75], a[192:195], v[180:183]
v_mfma_f32_16x16x32_bf16 v[180:183], a[76:79], a[196:199], v[180:183]
buffer_load_dwordx4 v14, s[12:15], s29 offen offset:1024 nt lds
v_mfma_f32_16x16x32_bf16 v[184:187], a[80:83], a[192:195], v[184:187]
ds_read_b128 a[188:191], v18 offset:38912
v_mfma_f32_16x16x32_bf16 v[184:187], a[84:87], a[196:199], v[184:187]
ds_read_b64_tr_b16 a[96:97], v21 offset:0
v_mfma_f32_16x16x32_bf16 v[188:191], a[88:91], a[192:195], v[188:191]
ds_read_b64_tr_b16 a[98:99], v21 offset:2048
v_mfma_f32_16x16x32_bf16 v[188:191], a[92:95], a[196:199], v[188:191]
ds_read_b64_tr_b16 a[100:101], v21 offset:16384
v_mfma_f32_16x16x32_bf16 v[192:195], a[32:35], a[200:203], v[192:195]
v_mfma_f32_16x16x32_bf16 v[192:195], a[36:39], a[204:207], v[192:195]
buffer_load_dwordx4 v15, s[12:15], s29 offen offset:2048 nt lds
v_mfma_f32_16x16x32_bf16 v[196:199], a[40:43], a[200:203], v[196:199]
ds_read_b64_tr_b16 a[102:103], v21 offset:18432
v_mfma_f32_16x16x32_bf16 v[196:199], a[44:47], a[204:207], v[196:199]
ds_read_b64_tr_b16 a[104:105], v22 offset:0
v_mfma_f32_16x16x32_bf16 v[200:203], a[48:51], a[200:203], v[200:203]
ds_read_b64_tr_b16 a[106:107], v22 offset:2048
v_mfma_f32_16x16x32_bf16 v[200:203], a[52:55], a[204:207], v[200:203]
s_branch kf_kernel_pl2
kf_kernel_pd2:
s_branch kf_kernel_pd10
kf_kernel_pl2:
v_mfma_f32_16x16x32_bf16 v[204:207], a[56:59], a[200:203], v[204:207]
ds_read_b64_tr_b16 a[108:109], v22 offset:16384
v_mfma_f32_16x16x32_bf16 v[204:207], a[60:63], a[204:207], v[204:207]
ds_read_b64_tr_b16 a[110:111], v22 offset:18432
v_mfma_f32_16x16x32_bf16 v[208:211], a[64:67], a[200:203], v[208:211]
buffer_load_dwordx4 v16, s[12:15], s29 offen offset:3072 nt lds
v_mfma_f32_16x16x32_bf16 v[208:211], a[68:71], a[204:207], v[208:211]
ds_read_b64_tr_b16 a[112:113], v23 offset:0
v_mfma_f32_16x16x32_bf16 v[212:215], a[72:75], a[200:203], v[212:215]
ds_read_b64_tr_b16 a[114:115], v23 offset:2048
v_mfma_f32_16x16x32_bf16 v[212:215], a[76:79], a[204:207], v[212:215]
v_mfma_f32_16x16x32_bf16 v[216:219], a[80:83], a[200:203], v[216:219]
ds_read_b64_tr_b16 a[116:117], v23 offset:16384
v_mfma_f32_16x16x32_bf16 v[216:219], a[84:87], a[204:207], v[216:219]
ds_read_b64_tr_b16 a[118:119], v23 offset:18432
v_mfma_f32_16x16x32_bf16 v[220:223], a[88:91], a[200:203], v[220:223]
s_add_u32 m0, s28, 0
s_xor_b32 s29, s26, 768
buffer_load_dwordx4 v5, s[8:11], s29 offen offset:0 lds
v_mfma_f32_16x16x32_bf16 v[220:223], a[92:95], a[204:207], v[220:223]
ds_read_b64_tr_b16 a[120:121], v24 offset:0
v_mfma_f32_16x16x32_bf16 v[224:227], a[32:35], a[208:211], v[224:227]
v_mfma_f32_16x16x32_bf16 v[224:227], a[36:39], a[212:215], v[224:227]
ds_read_b64_tr_b16 a[122:123], v24 offset:2048
v_mfma_f32_16x16x32_bf16 v[228:231], a[40:43], a[208:211], v[228:231]
ds_read_b64_tr_b16 a[124:125], v24 offset:16384
v_mfma_f32_16x16x32_bf16 v[228:231], a[44:47], a[212:215], v[228:231]
ds_read_b64_tr_b16 a[126:127], v24 offset:18432
v_mfma_f32_16x16x32_bf16 v[232:235], a[48:51], a[208:211], v[232:235]
buffer_load_dwordx4 v6, s[8:11], s29 offen offset:1024 lds
v_mfma_f32_16x16x32_bf16 v[232:235], a[52:55], a[212:215], v[232:235]
ds_read_b64_tr_b16 a[128:129], v25 offset:0
v_mfma_f32_16x16x32_bf16 v[236:239], a[56:59], a[208:211], v[236:239]
v_mfma_f32_16x16x32_bf16 v[236:239], a[60:63], a[212:215], v[236:239]
ds_read_b64_tr_b16 a[130:131], v25 offset:2048
v_mfma_f32_16x16x32_bf16 v[240:243], a[64:67], a[208:211], v[240:243]
ds_read_b64_tr_b16 a[132:133], v25 offset:16384
v_mfma_f32_16x16x32_bf16 v[240:243], a[68:71], a[212:215], v[240:243]
ds_read_b64_tr_b16 a[134:135], v25 offset:18432
v_mfma_f32_16x16x32_bf16 v[244:247], a[72:75], a[208:211], v[244:247]
ds_read_b64_tr_b16 a[136:137], v26 offset:0
v_mfma_f32_16x16x32_bf16 v[244:247], a[76:79], a[212:215], v[244:247]
v_mfma_f32_16x16x32_bf16 v[248:251], a[80:83], a[208:211], v[248:251]
buffer_load_dwordx4 v7, s[8:11], s29 offen offset:2048 lds
v_mfma_f32_16x16x32_bf16 v[248:251], a[84:87], a[212:215], v[248:251]
ds_read_b64_tr_b16 a[138:139], v26 offset:2048
v_mfma_f32_16x16x32_bf16 v[252:255], a[88:91], a[208:211], v[252:255]
ds_read_b64_tr_b16 a[140:141], v26 offset:16384
v_mfma_f32_16x16x32_bf16 v[252:255], a[92:95], a[212:215], v[252:255]
ds_read_b64_tr_b16 a[142:143], v26 offset:18432
v_mfma_f32_16x16x32_bf16 a[0:3], a[32:35], a[216:219], a[0:3]
ds_read_b64_tr_b16 a[144:145], v27 offset:0
v_mfma_f32_16x16x32_bf16 a[0:3], a[36:39], a[220:223], a[0:3]
v_mfma_f32_16x16x32_bf16 a[4:7], a[40:43], a[216:219], a[4:7]
buffer_load_dwordx4 v8, s[8:11], s29 offen offset:3072 lds
v_mfma_f32_16x16x32_bf16 a[4:7], a[44:47], a[220:223], a[4:7]
ds_read_b64_tr_b16 a[146:147], v27 offset:2048
v_mfma_f32_16x16x32_bf16 a[8:11], a[48:51], a[216:219], a[8:11]
ds_read_b64_tr_b16 a[148:149], v27 offset:16384
v_mfma_f32_16x16x32_bf16 a[8:11], a[52:55], a[220:223], a[8:11]
ds_read_b64_tr_b16 a[150:151], v27 offset:18432
v_mfma_f32_16x16x32_bf16 a[12:15], a[56:59], a[216:219], a[12:15]
v_mfma_f32_16x16x32_bf16 a[12:15], a[60:63], a[220:223], a[12:15]
ds_read_b64_tr_b16 a[152:153], v28 offset:0
v_mfma_f32_16x16x32_bf16 a[16:19], a[64:67], a[216:219], a[16:19]
ds_read_b64_tr_b16 a[154:155], v28 offset:2048
v_mfma_f32_16x16x32_bf16 a[16:19], a[68:71], a[220:223], a[16:19]
global_load_dword v31, v4, s[98:99]
v_mfma_f32_16x16x32_bf16 a[20:23], a[72:75], a[216:219], a[20:23]
ds_read_b64_tr_b16 a[156:157], v28 offset:16384
v_mfma_f32_16x16x32_bf16 a[20:23], a[76:79], a[220:223], a[20:23]
ds_read_b64_tr_b16 a[158:159], v28 offset:18432
v_mfma_f32_16x16x32_bf16 a[24:27], a[80:83], a[216:219], a[24:27]
v_mfma_f32_16x16x32_bf16 a[24:27], a[84:87], a[220:223], a[24:27]
v_mfma_f32_16x16x32_bf16 a[28:31], a[88:91], a[216:219], a[28:31]
v_mfma_f32_16x16x32_bf16 a[28:31], a[92:95], a[220:223], a[28:31]
s_waitcnt vmcnt(14) lgkmcnt(0)
s_barrier
v_mfma_f32_16x16x32_bf16 v[32:35], a[96:99], a[160:163], v[32:35]
v_mfma_f32_16x16x32_bf16 v[32:35], a[100:103], a[164:167], v[32:35]
v_mfma_f32_16x16x32_bf16 v[36:39], a[104:107], a[160:163], v[36:39]
s_add_u32 m0, s25, 65536
s_xor_b32 s29, s27, 3670016
buffer_load_dwordx4 v9, s[12:15], s29 offen offset:0 nt lds
v_mfma_f32_16x16x32_bf16 v[36:39], a[108:111], a[164:167], v[36:39]
v_mfma_f32_16x16x32_bf16 v[40:43], a[112:115], a[160:163], v[40:43]
ds_read_b128 a[192:195], v17 offset:49152
v_mfma_f32_16x16x32_bf16 v[40:43], a[116:119], a[164:167], v[40:43]
v_mfma_f32_16x16x32_bf16 v[44:47], a[120:123], a[160:163], v[44:47]
v_mfma_f32_16x16x32_bf16 v[44:47], a[124:127], a[164:167], v[44:47]
buffer_load_dwordx4 v10, s[12:15], s29 offen offset:1024 nt lds
v_mfma_f32_16x16x32_bf16 v[48:51], a[128:131], a[160:163], v[48:51]
v_mfma_f32_16x16x32_bf16 v[48:51], a[132:135], a[164:167], v[48:51]
ds_read_b128 a[196:199], v18 offset:49152
v_mfma_f32_16x16x32_bf16 v[52:55], a[136:139], a[160:163], v[52:55]
v_mfma_f32_16x16x32_bf16 v[52:55], a[140:143], a[164:167], v[52:55]
v_mfma_f32_16x16x32_bf16 v[56:59], a[144:147], a[160:163], v[56:59]
buffer_load_dwordx4 v11, s[12:15], s29 offen offset:2048 nt lds
v_mfma_f32_16x16x32_bf16 v[56:59], a[148:151], a[164:167], v[56:59]
v_mfma_f32_16x16x32_bf16 v[60:63], a[152:155], a[160:163], v[60:63]
ds_read_b128 a[200:203], v17 offset:51200
v_mfma_f32_16x16x32_bf16 v[60:63], a[156:159], a[164:167], v[60:63]
v_mfma_f32_16x16x32_bf16 v[64:67], a[96:99], a[168:171], v[64:67]
v_mfma_f32_16x16x32_bf16 v[64:67], a[100:103], a[172:175], v[64:67]
buffer_load_dwordx4 v12, s[12:15], s29 offen offset:3072 nt lds
v_mfma_f32_16x16x32_bf16 v[68:71], a[104:107], a[168:171], v[68:71]
v_mfma_f32_16x16x32_bf16 v[68:71], a[108:111], a[172:175], v[68:71]
ds_read_b128 a[204:207], v18 offset:51200
v_mfma_f32_16x16x32_bf16 v[72:75], a[112:115], a[168:171], v[72:75]
v_mfma_f32_16x16x32_bf16 v[72:75], a[116:119], a[172:175], v[72:75]
v_mfma_f32_16x16x32_bf16 v[76:79], a[120:123], a[168:171], v[76:79]
s_add_u32 m0, s25, 69632
s_xor_b32 s29, s27, 3670016
buffer_load_dwordx4 v13, s[12:15], s29 offen offset:0 nt lds
v_mfma_f32_16x16x32_bf16 v[76:79], a[124:127], a[172:175], v[76:79]
v_mfma_f32_16x16x32_bf16 v[80:83], a[128:131], a[168:171], v[80:83]
ds_read_b128 a[208:211], v17 offset:53248
v_mfma_f32_16x16x32_bf16 v[80:83], a[132:135], a[172:175], v[80:83]
v_mfma_f32_16x16x32_bf16 v[84:87], a[136:139], a[168:171], v[84:87]
v_mfma_f32_16x16x32_bf16 v[84:87], a[140:143], a[172:175], v[84:87]
buffer_load_dwordx4 v14, s[12:15], s29 offen offset:1024 nt lds
v_mfma_f32_16x16x32_bf16 v[88:91], a[144:147], a[168:171], v[88:91]
v_mfma_f32_16x16x32_bf16 v[88:91], a[148:151], a[172:175], v[88:91]
ds_read_b128 a[212:215], v18 offset:53248
v_mfma_f32_16x16x32_bf16 v[92:95], a[152:155], a[168:171], v[92:95]
v_mfma_f32_16x16x32_bf16 v[92:95], a[156:159], a[172:175], v[92:95]
v_mfma_f32_16x16x32_bf16 v[96:99], a[96:99], a[176:179], v[96:99]
buffer_load_dwordx4 v15, s[12:15], s29 offen offset:2048 nt lds
v_mfma_f32_16x16x32_bf16 v[96:99], a[100:103], a[180:183], v[96:99]
v_mfma_f32_16x16x32_bf16 v[100:103], a[104:107], a[176:179], v[100:103]
ds_read_b128 a[216:219], v17 offset:55296
v_mfma_f32_16x16x32_bf16 v[100:103], a[108:111], a[180:183], v[100:103]
v_mfma_f32_16x16x32_bf16 v[104:107], a[112:115], a[176:179], v[104:107]
v_mfma_f32_16x16x32_bf16 v[104:107], a[116:119], a[180:183], v[104:107]
buffer_load_dwordx4 v16, s[12:15], s29 offen offset:3072 nt lds
v_mfma_f32_16x16x32_bf16 v[108:111], a[120:123], a[176:179], v[108:111]
v_mfma_f32_16x16x32_bf16 v[108:111], a[124:127], a[180:183], v[108:111]
ds_read_b128 a[220:223], v18 offset:55296
v_mfma_f32_16x16x32_bf16 v[112:115], a[128:131], a[176:179], v[112:115]
v_mfma_f32_16x16x32_bf16 v[112:115], a[132:135], a[180:183], v[112:115]
v_mfma_f32_16x16x32_bf16 v[116:119], a[136:139], a[176:179], v[116:119]
s_add_u32 m0, s28, 16384
s_xor_b32 s29, s26, 896
buffer_load_dwordx4 v5, s[8:11], s29 offen offset:0 lds
v_mfma_f32_16x16x32_bf16 v[116:119], a[140:143], a[180:183], v[116:119]
v_mfma_f32_16x16x32_bf16 v[120:123], a[144:147], a[176:179], v[120:123]
v_mfma_f32_16x16x32_bf16 v[120:123], a[148:151], a[180:183], v[120:123]
v_mfma_f32_16x16x32_bf16 v[124:127], a[152:155], a[176:179], v[124:127]
v_mfma_f32_16x16x32_bf16 v[124:127], a[156:159], a[180:183], v[124:127]
buffer_load_dwordx4 v6, s[8:11], s29 offen offset:1024 lds
v_mfma_f32_16x16x32_bf16 v[128:131], a[96:99], a[184:187], v[128:131]
v_mfma_f32_16x16x32_bf16 v[128:131], a[100:103], a[188:191], v[128:131]
v_mfma_f32_16x16x32_bf16 v[132:135], a[104:107], a[184:187], v[132:135]
v_mfma_f32_16x16x32_bf16 v[132:135], a[108:111], a[188:191], v[132:135]
v_mfma_f32_16x16x32_bf16 v[136:139], a[112:115], a[184:187], v[136:139]
buffer_load_dwordx4 v7, s[8:11], s29 offen offset:2048 lds
v_mfma_f32_16x16x32_bf16 v[136:139], a[116:119], a[188:191], v[136:139]
v_mfma_f32_16x16x32_bf16 v[140:143], a[120:123], a[184:187], v[140:143]
v_mfma_f32_16x16x32_bf16 v[140:143], a[124:127], a[188:191], v[140:143]
v_mfma_f32_16x16x32_bf16 v[144:147], a[128:131], a[184:187], v[144:147]
v_mfma_f32_16x16x32_bf16 v[144:147], a[132:135], a[188:191], v[144:147]
buffer_load_dwordx4 v8, s[8:11], s29 offen offset:3072 lds
v_mfma_f32_16x16x32_bf16 v[148:151], a[136:139], a[184:187], v[148:151]
v_mfma_f32_16x16x32_bf16 v[148:151], a[140:143], a[188:191], v[148:151]
v_mfma_f32_16x16x32_bf16 v[152:155], a[144:147], a[184:187], v[152:155]
v_mfma_f32_16x16x32_bf16 v[152:155], a[148:151], a[188:191], v[152:155]
v_mfma_f32_16x16x32_bf16 v[156:159], a[152:155], a[184:187], v[156:159]
v_mfma_f32_16x16x32_bf16 v[156:159], a[156:159], a[188:191], v[156:159]
s_waitcnt vmcnt(13) lgkmcnt(0)
s_barrier
v_mfma_f32_16x16x32_bf16 v[160:163], a[96:99], a[192:195], v[160:163]
s_lshl_b32 s27, s20, 17
v_mfma_f32_16x16x32_bf16 v[160:163], a[100:103], a[196:199], v[160:163]
ds_read_b128 a[160:163], v17 offset:0
v_bfe_u32 v1, v0, 4, 2
v_mfma_f32_16x16x32_bf16 v[164:167], a[104:107], a[192:195], v[164:167]
ds_read_b128 a[164:167], v18 offset:0
v_mfma_f32_16x16x32_bf16 v[164:167], a[108:111], a[196:199], v[164:167]
s_add_u32 m0, s28, 32768
s_xor_b32 s29, s26, 1049344
buffer_load_dwordx4 v5, s[8:11], s29 offen offset:0 lds
v_lshlrev_b32 v2, 1, v1
v_mfma_f32_16x16x32_bf16 v[168:171], a[112:115], a[192:195], v[168:171]
ds_read_b128 a[168:171], v17 offset:2048
v_mfma_f32_16x16x32_bf16 v[168:171], a[116:119], a[196:199], v[168:171]
v_and_b32 v3, 15, v0
ds_read_b128 a[172:175], v18 offset:2048
v_mfma_f32_16x16x32_bf16 v[172:175], a[120:123], a[192:195], v[172:175]
v_xor_b32 v3, v3, v2
ds_read_b128 a[176:179], v17 offset:4096
v_mfma_f32_16x16x32_bf16 v[172:175], a[124:127], a[196:199], v[172:175]
buffer_load_dwordx4 v6, s[8:11], s29 offen offset:1024 lds
v_mfma_f32_16x16x32_bf16 v[176:179], a[128:131], a[192:195], v[176:179]
v_lshlrev_b32 v3, 4, v3
ds_read_b128 a[180:183], v18 offset:4096
v_mfma_f32_16x16x32_bf16 v[176:179], a[132:135], a[196:199], v[176:179]
v_lshl_add_u32 v9, v1, 13, v3
v_mfma_f32_16x16x32_bf16 v[180:183], a[136:139], a[192:195], v[180:183]
ds_read_b128 a[184:187], v17 offset:6144
v_xor_b32 v3, 128, v9
v_mfma_f32_16x16x32_bf16 v[180:183], a[140:143], a[196:199], v[180:183]
ds_read_b128 a[188:191], v18 offset:6144
v_add_u32 v10, 31744, v9
v_mfma_f32_16x16x32_bf16 v[184:187], a[144:147], a[192:195], v[184:187]
buffer_load_dwordx4 v7, s[8:11], s29 offen offset:2048 lds
v_mfma_f32_16x16x32_bf16 v[184:187], a[148:151], a[196:199], v[184:187]
ds_read_b64_tr_b16 a[32:33], v21 offset:32768
v_add_u32 v11, 63488, v3
v_mfma_f32_16x16x32_bf16 v[188:191], a[152:155], a[192:195], v[188:191]
ds_read_b64_tr_b16 a[34:35], v21 offset:34816
v_mfma_f32_16x16x32_bf16 v[188:191], a[156:159], a[196:199], v[188:191]
v_add_u32 v12, 95232, v3
ds_read_b64_tr_b16 a[36:37], v21 offset:49152
v_mfma_f32_16x16x32_bf16 v[192:195], a[96:99], a[200:203], v[192:195]
v_and_b32 v2, 2, v2
v_mfma_f32_16x16x32_bf16 v[192:195], a[100:103], a[204:207], v[192:195]
ds_read_b64_tr_b16 a[38:39], v21 offset:51200
v_and_b32 v3, 7, v0
v_mfma_f32_16x16x32_bf16 v[196:199], a[104:107], a[200:203], v[196:199]
buffer_load_dwordx4 v8, s[8:11], s29 offen offset:3072 lds
ds_read_b64_tr_b16 a[40:41], v22 offset:32768
v_mfma_f32_16x16x32_bf16 v[196:199], a[108:111], a[204:207], v[196:199]
v_xor_b32 v3, v3, v2
v_mfma_f32_16x16x32_bf16 v[200:203], a[112:115], a[200:203], v[200:203]
v_bfe_u32 v1, v0, 3, 3
ds_read_b64_tr_b16 a[42:43], v22 offset:34816
v_mfma_f32_16x16x32_bf16 v[200:203], a[116:119], a[204:207], v[200:203]
v_mul_u32_u24 v1, 3456, v1
v_mfma_f32_16x16x32_bf16 v[204:207], a[120:123], a[200:203], v[204:207]
ds_read_b64_tr_b16 a[44:45], v22 offset:49152
s_add_u32 m0, s28, 49152
s_xor_b32 s29, s26, 1049472
buffer_load_dwordx4 v5, s[8:11], s29 offen offset:0 lds
v_mfma_f32_16x16x32_bf16 v[204:207], a[124:127], a[204:207], v[204:207]
v_lshl_add_u32 v13, v3, 4, v1
ds_read_b64_tr_b16 a[46:47], v22 offset:51200
v_mfma_f32_16x16x32_bf16 v[208:211], a[128:131], a[200:203], v[208:211]
v_xor_b32 v14, 64, v13
v_mfma_f32_16x16x32_bf16 v[208:211], a[132:135], a[204:207], v[208:211]
ds_read_b64_tr_b16 a[48:49], v23 offset:32768
v_add_u32 v14, 26624, v14
v_mfma_f32_16x16x32_bf16 v[212:215], a[136:139], a[200:203], v[212:215]
ds_read_b64_tr_b16 a[50:51], v23 offset:34816
v_mfma_f32_16x16x32_bf16 v[212:215], a[140:143], a[204:207], v[212:215]
buffer_load_dwordx4 v6, s[8:11], s29 offen offset:1024 lds
v_mfma_f32_16x16x32_bf16 v[216:219], a[144:147], a[200:203], v[216:219]
ds_read_b64_tr_b16 a[52:53], v23 offset:49152
v_mfma_f32_16x16x32_bf16 v[216:219], a[148:151], a[204:207], v[216:219]
ds_read_b64_tr_b16 a[54:55], v23 offset:51200
v_mfma_f32_16x16x32_bf16 v[220:223], a[152:155], a[200:203], v[220:223]
ds_read_b64_tr_b16 a[56:57], v24 offset:32768
v_mfma_f32_16x16x32_bf16 v[220:223], a[156:159], a[204:207], v[220:223]
v_mfma_f32_16x16x32_bf16 v[224:227], a[96:99], a[208:211], v[224:227]
ds_read_b64_tr_b16 a[58:59], v24 offset:34816
buffer_load_dwordx4 v7, s[8:11], s29 offen offset:2048 lds
v_mfma_f32_16x16x32_bf16 v[224:227], a[100:103], a[212:215], v[224:227]
v_mfma_f32_16x16x32_bf16 v[228:231], a[104:107], a[208:211], v[228:231]
ds_read_b64_tr_b16 a[60:61], v24 offset:49152
v_mfma_f32_16x16x32_bf16 v[228:231], a[108:111], a[212:215], v[228:231]
ds_read_b64_tr_b16 a[62:63], v24 offset:51200
v_mfma_f32_16x16x32_bf16 v[232:235], a[112:115], a[208:211], v[232:235]
ds_read_b64_tr_b16 a[64:65], v25 offset:32768
v_mfma_f32_16x16x32_bf16 v[232:235], a[116:119], a[212:215], v[232:235]
buffer_load_dwordx4 v8, s[8:11], s29 offen offset:3072 lds
v_mfma_f32_16x16x32_bf16 v[236:239], a[120:123], a[208:211], v[236:239]
ds_read_b64_tr_b16 a[66:67], v25 offset:34816
v_mfma_f32_16x16x32_bf16 v[236:239], a[124:127], a[212:215], v[236:239]
ds_read_b64_tr_b16 a[68:69], v25 offset:49152
v_mfma_f32_16x16x32_bf16 v[240:243], a[128:131], a[208:211], v[240:243]
v_mfma_f32_16x16x32_bf16 v[240:243], a[132:135], a[212:215], v[240:243]
ds_read_b64_tr_b16 a[70:71], v25 offset:51200
v_mfma_f32_16x16x32_bf16 v[244:247], a[136:139], a[208:211], v[244:247]
s_add_u32 m0, s35, 131072
s_add_u32 s29, s54, 0
buffer_load_dwordx4 v13, s[40:43], s29 offen offset:0 lds
v_mfma_f32_16x16x32_bf16 v[244:247], a[140:143], a[212:215], v[244:247]
ds_read_b64_tr_b16 a[72:73], v26 offset:32768
v_mfma_f32_16x16x32_bf16 v[248:251], a[144:147], a[208:211], v[248:251]
ds_read_b64_tr_b16 a[74:75], v26 offset:34816
v_mfma_f32_16x16x32_bf16 v[248:251], a[148:151], a[212:215], v[248:251]
v_mfma_f32_16x16x32_bf16 v[252:255], a[152:155], a[208:211], v[252:255]
ds_read_b64_tr_b16 a[76:77], v26 offset:49152
v_mfma_f32_16x16x32_bf16 v[252:255], a[156:159], a[212:215], v[252:255]
ds_read_b64_tr_b16 a[78:79], v26 offset:51200
buffer_load_dwordx4 v14, s[40:43], s29 offen offset:1024 lds
v_mfma_f32_16x16x32_bf16 a[0:3], a[96:99], a[216:219], a[0:3]
v_mfma_f32_16x16x32_bf16 a[0:3], a[100:103], a[220:223], a[0:3]
ds_read_b64_tr_b16 a[80:81], v27 offset:32768
v_mfma_f32_16x16x32_bf16 a[4:7], a[104:107], a[216:219], a[4:7]
ds_read_b64_tr_b16 a[82:83], v27 offset:34816
v_mfma_f32_16x16x32_bf16 a[4:7], a[108:111], a[220:223], a[4:7]
ds_read_b64_tr_b16 a[84:85], v27 offset:49152
v_mfma_f32_16x16x32_bf16 a[8:11], a[112:115], a[216:219], a[8:11]
v_mfma_f32_16x16x32_bf16 a[8:11], a[116:119], a[220:223], a[8:11]
s_add_u32 m0, s35, 139264
s_add_u32 s29, s54, 221184
buffer_load_dwordx4 v13, s[40:43], s29 offen offset:0 lds
ds_read_b64_tr_b16 a[86:87], v27 offset:51200
v_mfma_f32_16x16x32_bf16 a[12:15], a[120:123], a[216:219], a[12:15]
ds_read_b64_tr_b16 a[88:89], v28 offset:32768
v_mfma_f32_16x16x32_bf16 a[12:15], a[124:127], a[220:223], a[12:15]
v_mfma_f32_16x16x32_bf16 a[16:19], a[128:131], a[216:219], a[16:19]
ds_read_b64_tr_b16 a[90:91], v28 offset:34816
v_mfma_f32_16x16x32_bf16 a[16:19], a[132:135], a[220:223], a[16:19]
buffer_load_dwordx4 v14, s[40:43], s29 offen offset:1024 lds
v_mfma_f32_16x16x32_bf16 a[20:23], a[136:139], a[216:219], a[20:23]
ds_read_b64_tr_b16 a[92:93], v28 offset:49152
v_mfma_f32_16x16x32_bf16 a[20:23], a[140:143], a[220:223], a[20:23]
ds_read_b64_tr_b16 a[94:95], v28 offset:51200
v_mfma_f32_16x16x32_bf16 a[24:27], a[144:147], a[216:219], a[24:27]
v_mfma_f32_16x16x32_bf16 a[24:27], a[148:151], a[220:223], a[24:27]
v_mfma_f32_16x16x32_bf16 a[28:31], a[152:155], a[216:219], a[28:31]
v_mfma_f32_16x16x32_bf16 a[28:31], a[156:159], a[220:223], a[28:31]
s_waitcnt vmcnt(12) lgkmcnt(0)
s_barrier
v_mfma_f32_16x16x32_bf16 v[32:35], a[32:35], a[160:163], v[32:35]
v_mfma_f32_16x16x32_bf16 v[32:35], a[36:39], a[164:167], v[32:35]
ds_read_b128 a[192:195], v17 offset:16384
v_mfma_f32_16x16x32_bf16 v[36:39], a[40:43], a[160:163], v[36:39]
ds_read_b128 a[196:199], v18 offset:16384
v_mfma_f32_16x16x32_bf16 v[36:39], a[44:47], a[164:167], v[36:39]
s_add_u32 m0, s28, 98304
s_add_u32 s29, s27, 0
buffer_load_dwordx4 v9, s[44:47], s29 offen offset:0 lds
v_mfma_f32_16x16x32_bf16 v[40:43], a[48:51], a[160:163], v[40:43]
ds_read_b128 a[200:203], v17 offset:18432
v_mfma_f32_16x16x32_bf16 v[40:43], a[52:55], a[164:167], v[40:43]
v_mfma_f32_16x16x32_bf16 v[44:47], a[56:59], a[160:163], v[44:47]
ds_read_b128 a[204:207], v18 offset:18432
v_mfma_f32_16x16x32_bf16 v[44:47], a[60:63], a[164:167], v[44:47]
ds_read_b128 a[208:211], v17 offset:20480
v_mfma_f32_16x16x32_bf16 v[48:51], a[64:67], a[160:163], v[48:51]
ds_read_b128 a[212:215], v18 offset:20480
v_mfma_f32_16x16x32_bf16 v[48:51], a[68:71], a[164:167], v[48:51]
ds_read_b128 a[216:219], v17 offset:22528
v_mfma_f32_16x16x32_bf16 v[52:55], a[72:75], a[160:163], v[52:55]
v_mfma_f32_16x16x32_bf16 v[52:55], a[76:79], a[164:167], v[52:55]
buffer_load_dwordx4 v10, s[44:47], s29 offen offset:1024 lds
v_mfma_f32_16x16x32_bf16 v[56:59], a[80:83], a[160:163], v[56:59]
ds_read_b128 a[220:223], v18 offset:22528
v_mfma_f32_16x16x32_bf16 v[56:59], a[84:87], a[164:167], v[56:59]
ds_read_b64_tr_b16 a[96:97], v21 offset:0
v_mfma_f32_16x16x32_bf16 v[60:63], a[88:91], a[160:163], v[60:63]
ds_read_b64_tr_b16 a[98:99], v21 offset:2048
v_mfma_f32_16x16x32_bf16 v[60:63], a[92:95], a[164:167], v[60:63]
v_mfma_f32_16x16x32_bf16 v[64:67], a[32:35], a[168:171], v[64:67]
ds_read_b64_tr_b16 a[100:101], v21 offset:16384
v_mfma_f32_16x16x32_bf16 v[64:67], a[36:39], a[172:175], v[64:67]
ds_read_b64_tr_b16 a[102:103], v21 offset:18432
v_mfma_f32_16x16x32_bf16 v[68:71], a[40:43], a[168:171], v[68:71]
buffer_load_dwordx4 v11, s[44:47], s29 offen offset:2048 lds
v_mfma_f32_16x16x32_bf16 v[68:71], a[44:47], a[172:175], v[68:71]
ds_read_b64_tr_b16 a[104:105], v22 offset:0
v_mfma_f32_16x16x32_bf16 v[72:75], a[48:51], a[168:171], v[72:75]
v_mfma_f32_16x16x32_bf16 v[72:75], a[52:55], a[172:175], v[72:75]
ds_read_b64_tr_b16 a[106:107], v22 offset:2048
v_mfma_f32_16x16x32_bf16 v[76:79], a[56:59], a[168:171], v[76:79]
ds_read_b64_tr_b16 a[108:109], v22 offset:16384
v_mfma_f32_16x16x32_bf16 v[76:79], a[60:63], a[172:175], v[76:79]
ds_read_b64_tr_b16 a[110:111], v22 offset:18432
v_mfma_f32_16x16x32_bf16 v[80:83], a[64:67], a[168:171], v[80:83]
ds_read_b64_tr_b16 a[112:113], v23 offset:0
v_mfma_f32_16x16x32_bf16 v[80:83], a[68:71], a[172:175], v[80:83]
v_mfma_f32_16x16x32_bf16 v[84:87], a[72:75], a[168:171], v[84:87]
buffer_load_dwordx4 v12, s[44:47], s29 offen offset:3072 lds
v_mfma_f32_16x16x32_bf16 v[84:87], a[76:79], a[172:175], v[84:87]
ds_read_b64_tr_b16 a[114:115], v23 offset:2048
v_mfma_f32_16x16x32_bf16 v[88:91], a[80:83], a[168:171], v[88:91]
ds_read_b64_tr_b16 a[116:117], v23 offset:16384
v_mfma_f32_16x16x32_bf16 v[88:91], a[84:87], a[172:175], v[88:91]
ds_read_b64_tr_b16 a[118:119], v23 offset:18432
v_mfma_f32_16x16x32_bf16 v[92:95], a[88:91], a[168:171], v[92:95]
v_mfma_f32_16x16x32_bf16 v[92:95], a[92:95], a[172:175], v[92:95]
ds_read_b64_tr_b16 a[120:121], v24 offset:0
v_mfma_f32_16x16x32_bf16 v[96:99], a[32:35], a[176:179], v[96:99]
ds_read_b64_tr_b16 a[122:123], v24 offset:2048
v_mfma_f32_16x16x32_bf16 v[96:99], a[36:39], a[180:183], v[96:99]
s_add_u32 m0, s28, 114688
s_add_u32 s29, s27, 524288
buffer_load_dwordx4 v9, s[44:47], s29 offen offset:0 lds
v_mfma_f32_16x16x32_bf16 v[100:103], a[40:43], a[176:179], v[100:103]
ds_read_b64_tr_b16 a[124:125], v24 offset:16384
v_mfma_f32_16x16x32_bf16 v[100:103], a[44:47], a[180:183], v[100:103]
v_mfma_f32_16x16x32_bf16 v[104:107], a[48:51], a[176:179], v[104:107]
ds_read_b64_tr_b16 a[126:127], v24 offset:18432
v_mfma_f32_16x16x32_bf16 v[104:107], a[52:55], a[180:183], v[104:107]
ds_read_b64_tr_b16 a[128:129], v25 offset:0
v_mfma_f32_16x16x32_bf16 v[108:111], a[56:59], a[176:179], v[108:111]
ds_read_b64_tr_b16 a[130:131], v25 offset:2048
v_mfma_f32_16x16x32_bf16 v[108:111], a[60:63], a[180:183], v[108:111]
ds_read_b64_tr_b16 a[132:133], v25 offset:16384
v_mfma_f32_16x16x32_bf16 v[112:115], a[64:67], a[176:179], v[112:115]
v_mfma_f32_16x16x32_bf16 v[112:115], a[68:71], a[180:183], v[112:115]
buffer_load_dwordx4 v10, s[44:47], s29 offen offset:1024 lds
v_mfma_f32_16x16x32_bf16 v[116:119], a[72:75], a[176:179], v[116:119]
ds_read_b64_tr_b16 a[134:135], v25 offset:18432
v_mfma_f32_16x16x32_bf16 v[116:119], a[76:79], a[180:183], v[116:119]
ds_read_b64_tr_b16 a[136:137], v26 offset:0
v_mfma_f32_16x16x32_bf16 v[120:123], a[80:83], a[176:179], v[120:123]
ds_read_b64_tr_b16 a[138:139], v26 offset:2048
v_mfma_f32_16x16x32_bf16 v[120:123], a[84:87], a[180:183], v[120:123]
v_mfma_f32_16x16x32_bf16 v[124:127], a[88:91], a[176:179], v[124:127]
ds_read_b64_tr_b16 a[140:141], v26 offset:16384
v_mfma_f32_16x16x32_bf16 v[124:127], a[92:95], a[180:183], v[124:127]
ds_read_b64_tr_b16 a[142:143], v26 offset:18432
v_mfma_f32_16x16x32_bf16 v[128:131], a[32:35], a[184:187], v[128:131]
buffer_load_dwordx4 v11, s[44:47], s29 offen offset:2048 lds
v_mfma_f32_16x16x32_bf16 v[128:131], a[36:39], a[188:191], v[128:131]
ds_read_b64_tr_b16 a[144:145], v27 offset:0
v_mfma_f32_16x16x32_bf16 v[132:135], a[40:43], a[184:187], v[132:135]
v_mfma_f32_16x16x32_bf16 v[132:135], a[44:47], a[188:191], v[132:135]
ds_read_b64_tr_b16 a[146:147], v27 offset:2048
v_mfma_f32_16x16x32_bf16 v[136:139], a[48:51], a[184:187], v[136:139]
ds_read_b64_tr_b16 a[148:149], v27 offset:16384
v_mfma_f32_16x16x32_bf16 v[136:139], a[52:55], a[188:191], v[136:139]
ds_read_b64_tr_b16 a[150:151], v27 offset:18432
v_mfma_f32_16x16x32_bf16 v[140:143], a[56:59], a[184:187], v[140:143]
ds_read_b64_tr_b16 a[152:153], v28 offset:0
v_mfma_f32_16x16x32_bf16 v[140:143], a[60:63], a[188:191], v[140:143]
v_mfma_f32_16x16x32_bf16 v[144:147], a[64:67], a[184:187], v[144:147]
buffer_load_dwordx4 v12, s[44:47], s29 offen offset:3072 lds
v_mfma_f32_16x16x32_bf16 v[144:147], a[68:71], a[188:191], v[144:147]
ds_read_b64_tr_b16 a[154:155], v28 offset:2048
v_mfma_f32_16x16x32_bf16 v[148:151], a[72:75], a[184:187], v[148:151]
ds_read_b64_tr_b16 a[156:157], v28 offset:16384
v_mfma_f32_16x16x32_bf16 v[148:151], a[76:79], a[188:191], v[148:151]
ds_read_b64_tr_b16 a[158:159], v28 offset:18432
v_mfma_f32_16x16x32_bf16 v[152:155], a[80:83], a[184:187], v[152:155]
v_mfma_f32_16x16x32_bf16 v[152:155], a[84:87], a[188:191], v[152:155]
v_mfma_f32_16x16x32_bf16 v[156:159], a[88:91], a[184:187], v[156:159]
v_mfma_f32_16x16x32_bf16 v[156:159], a[92:95], a[188:191], v[156:159]
s_waitcnt vmcnt(16) lgkmcnt(0)
s_barrier
v_mfma_f32_16x16x32_bf16 v[32:35], a[96:99], a[192:195], v[32:35]
v_mfma_f32_16x16x32_bf16 v[32:35], a[100:103], a[196:199], v[32:35]
v_and_b32 v20, 7, v0
v_lshlrev_b32 v20, 8, v20
s_mov_b32 s55, 3174400
buffer_load_dword v30, v20, s[48:51], s55 offen sc1
v_mfma_f32_16x16x32_bf16 v[36:39], a[104:107], a[192:195], v[36:39]
v_mfma_f32_16x16x32_bf16 v[36:39], a[108:111], a[196:199], v[36:39]
ds_read_b128 a[160:163], v17 offset:32768
v_mfma_f32_16x16x32_bf16 v[40:43], a[112:115], a[192:195], v[40:43]
v_mfma_f32_16x16x32_bf16 v[40:43], a[116:119], a[196:199], v[40:43]
v_mfma_f32_16x16x32_bf16 v[44:47], a[120:123], a[192:195], v[44:47]
s_add_u32 m0, s28, 65536
s_add_u32 s29, s27, 1048576
buffer_load_dwordx4 v9, s[44:47], s29 offen offset:0 lds
v_mfma_f32_16x16x32_bf16 v[44:47], a[124:127], a[196:199], v[44:47]
v_bfe_u32 v1, v0, 2, 2
v_mfma_f32_16x16x32_bf16 v[48:51], a[128:131], a[192:195], v[48:51]
ds_read_b128 a[164:167], v18 offset:32768
v_bfe_u32 v2, v0, 4, 2
v_mfma_f32_16x16x32_bf16 v[48:51], a[132:135], a[196:199], v[48:51]
v_lshl_add_u32 v3, v2, 3, v1
v_mfma_f32_16x16x32_bf16 v[52:55], a[136:139], a[192:195], v[52:55]
buffer_load_dwordx4 v10, s[44:47], s29 offen offset:1024 lds
v_mfma_f32_16x16x32_bf16 v[52:55], a[140:143], a[196:199], v[52:55]
v_lshlrev_b32 v3, 8, v3
v_mfma_f32_16x16x32_bf16 v[56:59], a[144:147], a[192:195], v[56:59]
v_bfe_u32 v1, v0, 2, 3
v_mfma_f32_16x16x32_bf16 v[56:59], a[148:151], a[196:199], v[56:59]
ds_read_b128 a[168:171], v17 offset:34816
v_mfma_f32_16x16x32_bf16 v[60:63], a[152:155], a[192:195], v[60:63]
v_lshl_add_u32 v3, v1, 5, v3
v_mfma_f32_16x16x32_bf16 v[60:63], a[156:159], a[196:199], v[60:63]
buffer_load_dwordx4 v11, s[44:47], s29 offen offset:2048 lds
v_mfma_f32_16x16x32_bf16 v[64:67], a[96:99], a[200:203], v[64:67]
v_and_b32 v1, 3, v0
v_mfma_f32_16x16x32_bf16 v[64:67], a[100:103], a[204:207], v[64:67]
v_lshl_add_u32 v3, v1, 3, v3
ds_read_b128 a[172:175], v18 offset:34816
v_mfma_f32_16x16x32_bf16 v[68:71], a[104:107], a[200:203], v[68:71]
v_add_u32 v21, 65536, v3
v_mfma_f32_16x16x32_bf16 v[68:71], a[108:111], a[204:207], v[68:71]
buffer_load_dwordx4 v12, s[44:47], s29 offen offset:3072 lds
v_mfma_f32_16x16x32_bf16 v[72:75], a[112:115], a[200:203], v[72:75]
v_xor_b32 v22, 32, v21
v_mfma_f32_16x16x32_bf16 v[72:75], a[116:119], a[204:207], v[72:75]
v_xor_b32 v23, 64, v21
v_mfma_f32_16x16x32_bf16 v[76:79], a[120:123], a[200:203], v[76:79]
ds_read_b128 a[176:179], v17 offset:36864
v_mfma_f32_16x16x32_bf16 v[76:79], a[124:127], a[204:207], v[76:79]
v_xor_b32 v24, 96, v21
v_mfma_f32_16x16x32_bf16 v[80:83], a[128:131], a[200:203], v[80:83]
s_add_u32 m0, s28, 81920
s_add_u32 s29, s27, 1572864
buffer_load_dwordx4 v9, s[44:47], s29 offen offset:0 lds
v_mfma_f32_16x16x32_bf16 v[80:83], a[132:135], a[204:207], v[80:83]
v_xor_b32 v25, 128, v21
v_xor_b32 v26, 160, v21
v_mfma_f32_16x16x32_bf16 v[84:87], a[136:139], a[200:203], v[84:87]
v_xor_b32 v27, 192, v21
v_mfma_f32_16x16x32_bf16 v[84:87], a[140:143], a[204:207], v[84:87]
ds_read_b128 a[180:183], v18 offset:36864
v_mfma_f32_16x16x32_bf16 v[88:91], a[144:147], a[200:203], v[88:91]
buffer_load_dwordx4 v10, s[44:47], s29 offen offset:1024 lds
v_mfma_f32_16x16x32_bf16 v[88:91], a[148:151], a[204:207], v[88:91]
v_xor_b32 v28, 224, v21
v_mfma_f32_16x16x32_bf16 v[92:95], a[152:155], a[200:203], v[92:95]
v_bfe_u32 v1, v0, 2, 2
v_mfma_f32_16x16x32_bf16 v[92:95], a[156:159], a[204:207], v[92:95]
v_bfe_u32 v2, v0, 4, 2
v_mfma_f32_16x16x32_bf16 v[96:99], a[96:99], a[208:211], v[96:99]
buffer_load_dwordx4 v11, s[44:47], s29 offen offset:2048 lds
v_mfma_f32_16x16x32_bf16 v[96:99], a[100:103], a[212:215], v[96:99]
ds_read_b128 a[184:187], v17 offset:38912
v_mfma_f32_16x16x32_bf16 v[100:103], a[104:107], a[208:211], v[100:103]
v_lshl_add_u32 v3, v2, 3, v1
v_lshlrev_b32 v3, 7, v3
v_mfma_f32_16x16x32_bf16 v[100:103], a[108:111], a[212:215], v[100:103]
v_bfe_u32 v1, v0, 3, 2
v_mfma_f32_16x16x32_bf16 v[104:107], a[112:115], a[208:211], v[104:107]
buffer_load_dwordx4 v12, s[44:47], s29 offen offset:3072 lds
v_mfma_f32_16x16x32_bf16 v[104:107], a[116:119], a[212:215], v[104:107]
v_lshl_add_u32 v3, v1, 5, v3
v_mfma_f32_16x16x32_bf16 v[108:111], a[120:123], a[208:211], v[108:111]
ds_read_b128 a[188:191], v18 offset:38912
v_mfma_f32_16x16x32_bf16 v[108:111], a[124:127], a[212:215], v[108:111]
v_and_b32 v1, 3, v0
v_mfma_f32_16x16x32_bf16 v[112:115], a[128:131], a[208:211], v[112:115]
v_lshl_add_u32 v3, v1, 3, v3
v_mfma_f32_16x16x32_bf16 v[112:115], a[132:135], a[212:215], v[112:115]
s_add_u32 m0, s35, 147456
s_add_u32 s29, s54, 442368
buffer_load_dwordx4 v13, s[40:43], s29 offen offset:0 lds
v_mfma_f32_16x16x32_bf16 v[116:119], a[136:139], a[208:211], v[116:119]
s_branch kf_kernel_pl3
kf_kernel_pd3:
s_branch kf_kernel_pd9
kf_kernel_pl3:
v_add_u32 v5, 131072, v3
v_mfma_f32_16x16x32_bf16 v[116:119], a[140:143], a[212:215], v[116:119]
v_xor_b32 v6, 32, v5
v_mfma_f32_16x16x32_bf16 v[120:123], a[144:147], a[208:211], v[120:123]
v_xor_b32 v7, 64, v5
v_mfma_f32_16x16x32_bf16 v[120:123], a[148:151], a[212:215], v[120:123]
buffer_load_dwordx4 v14, s[40:43], s29 offen offset:1024 lds
v_mfma_f32_16x16x32_bf16 v[124:127], a[152:155], a[208:211], v[124:127]
v_xor_b32 v8, 96, v5
v_mfma_f32_16x16x32_bf16 v[124:127], a[156:159], a[212:215], v[124:127]
v_mfma_f32_16x16x32_bf16 v[128:131], a[96:99], a[216:219], v[128:131]
s_mul_i32 s39, s21, 1064960
v_mfma_f32_16x16x32_bf16 v[128:131], a[100:103], a[220:223], v[128:131]
s_add_u32 s39, s39, 4194304
v_mfma_f32_16x16x32_bf16 v[132:135], a[104:107], a[216:219], v[132:135]
s_add_u32 m0, s35, 155648
s_add_u32 s29, s54, 663552
buffer_load_dwordx4 v13, s[40:43], s29 offen offset:0 lds
v_mfma_f32_16x16x32_bf16 v[132:135], a[108:111], a[220:223], v[132:135]
s_add_u32 s8, s6, s39
s_addc_u32 s9, s7, 0
s_mov_b32 s10, 1064960
v_mfma_f32_16x16x32_bf16 v[136:139], a[112:115], a[216:219], v[136:139]
v_mfma_f32_16x16x32_bf16 v[136:139], a[116:119], a[220:223], v[136:139]
s_mov_b32 s11, 0x20000
v_mfma_f32_16x16x32_bf16 v[140:143], a[120:123], a[216:219], v[140:143]
buffer_load_dwordx4 v14, s[40:43], s29 offen offset:1024 lds
v_mfma_f32_16x16x32_bf16 v[140:143], a[124:127], a[220:223], v[140:143]
s_cmp_eq_u32 s20, 3
s_cselect_b32 s10, 1044480, s10
v_mfma_f32_16x16x32_bf16 v[144:147], a[128:131], a[216:219], v[144:147]
s_mov_b32 s12, s56
v_mfma_f32_16x16x32_bf16 v[144:147], a[132:135], a[220:223], v[144:147]
v_mfma_f32_16x16x32_bf16 v[148:151], a[136:139], a[216:219], v[148:151]
s_mov_b32 s13, s56
v_mfma_f32_16x16x32_bf16 v[148:151], a[140:143], a[220:223], v[148:151]
global_load_dword v31, v4, s[98:99]
s_mov_b32 s14, s56
v_mfma_f32_16x16x32_bf16 v[152:155], a[144:147], a[216:219], v[152:155]
v_mfma_f32_16x16x32_bf16 v[152:155], a[148:151], a[220:223], v[152:155]
v_mfma_f32_16x16x32_bf16 v[156:159], a[152:155], a[216:219], v[156:159]
v_mfma_f32_16x16x32_bf16 v[156:159], a[156:159], a[220:223], v[156:159]
s_waitcnt vmcnt(13) lgkmcnt(0)
s_barrier
v_and_b32 v1, 63, v30
v_cmp_gt_u32 vcc, 32, v1
s_cmp_lg_u64 vcc, 0
s_cbranch_scc1 kf_kernel_spin_xnk
kf_kernel_ret_xnk:
v_mfma_f32_16x16x32_bf16 v[160:163], a[32:35], a[160:163], v[160:163]
v_readlane_b32 s4, v30, s23
v_mfma_f32_16x16x32_bf16 v[160:163], a[36:39], a[164:167], v[160:163]
s_lshl_b32 s57, s57, 5
v_mfma_f32_16x16x32_bf16 v[164:167], a[40:43], a[160:163], v[164:167]
ds_read_b128 a[192:195], v17 offset:49152
v_mfma_f32_16x16x32_bf16 v[164:167], a[44:47], a[164:167], v[164:167]
v_cvt_pk_bf16_f32 v32, v32, v33
v_mfma_f32_16x16x32_bf16 v[168:171], a[48:51], a[160:163], v[168:171]
s_add_u32 s34, s32, 0
buffer_load_dwordx4 a[224:227], v4, s[48:51], s34 offen sc1
v_mfma_f32_16x16x32_bf16 v[168:171], a[52:55], a[164:167], v[168:171]
v_cvt_pk_bf16_f32 v33, v34, v35
v_mfma_f32_16x16x32_bf16 v[172:175], a[56:59], a[160:163], v[172:175]
v_cvt_pk_bf16_f32 v34, v36, v37
v_mfma_f32_16x16x32_bf16 v[172:175], a[60:63], a[164:167], v[172:175]
ds_read_b128 a[196:199], v18 offset:49152
v_mfma_f32_16x16x32_bf16 v[176:179], a[64:67], a[160:163], v[176:179]
v_cvt_pk_bf16_f32 v35, v38, v39
v_mfma_f32_16x16x32_bf16 v[176:179], a[68:71], a[164:167], v[176:179]
s_add_u32 s53, s14, 0
buffer_store_dwordx4 v[32:35], v4, s[16:19], s53 offen offset:0
v_mfma_f32_16x16x32_bf16 v[180:183], a[72:75], a[160:163], v[180:183]
v_cvt_pk_bf16_f32 v40, v40, v41
v_mfma_f32_16x16x32_bf16 v[180:183], a[76:79], a[164:167], v[180:183]
buffer_load_dwordx4 a[228:231], v4, s[48:51], s34 offen offset:1024 sc1
v_mfma_f32_16x16x32_bf16 v[184:187], a[80:83], a[160:163], v[184:187]
v_cvt_pk_bf16_f32 v41, v42, v43
v_mfma_f32_16x16x32_bf16 v[184:187], a[84:87], a[164:167], v[184:187]
ds_read_b128 a[200:203], v17 offset:51200
v_mfma_f32_16x16x32_bf16 v[188:191], a[88:91], a[160:163], v[188:191]
v_cvt_pk_bf16_f32 v42, v44, v45
v_mfma_f32_16x16x32_bf16 v[188:191], a[92:95], a[164:167], v[188:191]
v_cvt_pk_bf16_f32 v43, v46, v47
v_mfma_f32_16x16x32_bf16 v[192:195], a[32:35], a[168:171], v[192:195]
buffer_store_dwordx4 v[40:43], v4, s[16:19], s53 offen offset:1024
v_mfma_f32_16x16x32_bf16 v[192:195], a[36:39], a[172:175], v[192:195]
ds_read_b128 a[204:207], v18 offset:51200
v_mfma_f32_16x16x32_bf16 v[196:199], a[40:43], a[168:171], v[196:199]
v_cvt_pk_bf16_f32 v48, v48, v49
v_mfma_f32_16x16x32_bf16 v[196:199], a[44:47], a[172:175], v[196:199]
s_add_u32 s34, s32, 20480
buffer_load_dwordx4 a[232:235], v4, s[48:51], s34 offen sc1
v_mfma_f32_16x16x32_bf16 v[200:203], a[48:51], a[168:171], v[200:203]
v_cvt_pk_bf16_f32 v49, v50, v51
v_mfma_f32_16x16x32_bf16 v[200:203], a[52:55], a[172:175], v[200:203]
v_cvt_pk_bf16_f32 v50, v52, v53
v_mfma_f32_16x16x32_bf16 v[204:207], a[56:59], a[168:171], v[204:207]
v_cvt_pk_bf16_f32 v51, v54, v55
v_mfma_f32_16x16x32_bf16 v[204:207], a[60:63], a[172:175], v[204:207]
ds_read_b128 a[208:211], v17 offset:53248
v_mfma_f32_16x16x32_bf16 v[208:211], a[64:67], a[168:171], v[208:211]
buffer_store_dwordx4 v[48:51], v4, s[16:19], s53 offen offset:2048
v_mfma_f32_16x16x32_bf16 v[208:211], a[68:71], a[172:175], v[208:211]
v_cvt_pk_bf16_f32 v56, v56, v57
v_mfma_f32_16x16x32_bf16 v[212:215], a[72:75], a[168:171], v[212:215]
buffer_load_dwordx4 a[236:239], v4, s[48:51], s34 offen offset:1024 sc1
v_mfma_f32_16x16x32_bf16 v[212:215], a[76:79], a[172:175], v[212:215]
v_cvt_pk_bf16_f32 v57, v58, v59
v_mfma_f32_16x16x32_bf16 v[216:219], a[80:83], a[168:171], v[216:219]
ds_read_b128 a[212:215], v18 offset:53248
v_mfma_f32_16x16x32_bf16 v[216:219], a[84:87], a[172:175], v[216:219]
v_cvt_pk_bf16_f32 v58, v60, v61
v_cvt_pk_bf16_f32 v59, v62, v63
v_mfma_f32_16x16x32_bf16 v[220:223], a[88:91], a[168:171], v[220:223]
buffer_store_dwordx4 v[56:59], v4, s[16:19], s53 offen offset:3072
v_mfma_f32_16x16x32_bf16 v[220:223], a[92:95], a[172:175], v[220:223]
v_cvt_pk_bf16_f32 v64, v64, v65
v_mfma_f32_16x16x32_bf16 v[224:227], a[32:35], a[176:179], v[224:227]
ds_read_b128 a[216:219], v17 offset:55296
v_mfma_f32_16x16x32_bf16 v[224:227], a[36:39], a[180:183], v[224:227]
v_cvt_pk_bf16_f32 v65, v66, v67
v_mfma_f32_16x16x32_bf16 v[228:231], a[40:43], a[176:179], v[228:231]
s_add_u32 s34, s33, 0
buffer_load_dwordx4 a[240:243], v4, s[48:51], s34 offen sc1
v_mfma_f32_16x16x32_bf16 v[228:231], a[44:47], a[180:183], v[228:231]
v_cvt_pk_bf16_f32 v66, v68, v69
v_mfma_f32_16x16x32_bf16 v[232:235], a[48:51], a[176:179], v[232:235]
v_cvt_pk_bf16_f32 v67, v70, v71
v_mfma_f32_16x16x32_bf16 v[232:235], a[52:55], a[180:183], v[232:235]
ds_read_b128 a[220:223], v18 offset:55296
v_mfma_f32_16x16x32_bf16 v[236:239], a[56:59], a[176:179], v[236:239]
s_add_u32 s53, s56, 4096
buffer_store_dwordx4 v[64:67], v4, s[16:19], s53 offen offset:0
v_mfma_f32_16x16x32_bf16 v[236:239], a[60:63], a[180:183], v[236:239]
v_cvt_pk_bf16_f32 v72, v72, v73
v_mfma_f32_16x16x32_bf16 v[240:243], a[64:67], a[176:179], v[240:243]
v_cvt_pk_bf16_f32 v73, v74, v75
v_mfma_f32_16x16x32_bf16 v[240:243], a[68:71], a[180:183], v[240:243]
buffer_load_dwordx4 a[244:247], v4, s[48:51], s34 offen offset:1024 sc1
v_mfma_f32_16x16x32_bf16 v[244:247], a[72:75], a[176:179], v[244:247]
v_cvt_pk_bf16_f32 v74, v76, v77
v_mfma_f32_16x16x32_bf16 v[244:247], a[76:79], a[180:183], v[244:247]
v_mfma_f32_16x16x32_bf16 v[248:251], a[80:83], a[176:179], v[248:251]
v_cvt_pk_bf16_f32 v75, v78, v79
v_mfma_f32_16x16x32_bf16 v[248:251], a[84:87], a[180:183], v[248:251]
buffer_store_dwordx4 v[72:75], v4, s[16:19], s53 offen offset:1024
v_mfma_f32_16x16x32_bf16 v[252:255], a[88:91], a[176:179], v[252:255]
v_cvt_pk_bf16_f32 v80, v80, v81
v_mfma_f32_16x16x32_bf16 v[252:255], a[92:95], a[180:183], v[252:255]
v_mfma_f32_16x16x32_bf16 a[0:3], a[32:35], a[184:187], a[0:3]
v_cvt_pk_bf16_f32 v81, v82, v83
v_mfma_f32_16x16x32_bf16 a[0:3], a[36:39], a[188:191], a[0:3]
s_add_u32 s34, s33, 20480
buffer_load_dwordx4 a[248:251], v4, s[48:51], s34 offen sc1
v_mfma_f32_16x16x32_bf16 a[4:7], a[40:43], a[184:187], a[4:7]
v_cvt_pk_bf16_f32 v82, v84, v85
v_mfma_f32_16x16x32_bf16 a[4:7], a[44:47], a[188:191], a[4:7]
v_cvt_pk_bf16_f32 v83, v86, v87
v_mfma_f32_16x16x32_bf16 a[8:11], a[48:51], a[184:187], a[8:11]
buffer_store_dwordx4 v[80:83], v4, s[16:19], s53 offen offset:2048
v_mfma_f32_16x16x32_bf16 a[8:11], a[52:55], a[188:191], a[8:11]
v_mfma_f32_16x16x32_bf16 a[12:15], a[56:59], a[184:187], a[12:15]
v_cvt_pk_bf16_f32 v88, v88, v89
v_mfma_f32_16x16x32_bf16 a[12:15], a[60:63], a[188:191], a[12:15]
v_cvt_pk_bf16_f32 v89, v90, v91
v_mfma_f32_16x16x32_bf16 a[16:19], a[64:67], a[184:187], a[16:19]
buffer_load_dwordx4 a[252:255], v4, s[48:51], s34 offen offset:1024 sc1
v_mfma_f32_16x16x32_bf16 a[16:19], a[68:71], a[188:191], a[16:19]
v_cvt_pk_bf16_f32 v90, v92, v93
v_mfma_f32_16x16x32_bf16 a[20:23], a[72:75], a[184:187], a[20:23]
v_mfma_f32_16x16x32_bf16 a[20:23], a[76:79], a[188:191], a[20:23]
v_cvt_pk_bf16_f32 v91, v94, v95
buffer_store_dwordx4 v[88:91], v4, s[16:19], s53 offen offset:3072
v_mfma_f32_16x16x32_bf16 a[24:27], a[80:83], a[184:187], a[24:27]
v_mfma_f32_16x16x32_bf16 a[24:27], a[84:87], a[188:191], a[24:27]
v_mfma_f32_16x16x32_bf16 a[28:31], a[88:91], a[184:187], a[28:31]
v_mfma_f32_16x16x32_bf16 a[28:31], a[92:95], a[188:191], a[28:31]
s_waitcnt vmcnt(34) lgkmcnt(0)
s_barrier
v_mfma_f32_16x16x32_bf16 v[160:163], a[96:99], a[192:195], v[160:163]
v_cvt_pk_bf16_f32 v96, v96, v97
v_mfma_f32_16x16x32_bf16 v[160:163], a[100:103], a[196:199], v[160:163]
ds_read_b64_tr_b16 a[64:65], v21 offset:32768
v_mfma_f32_16x16x32_bf16 v[164:167], a[104:107], a[192:195], v[164:167]
v_cvt_pk_bf16_f32 v97, v98, v99
v_mfma_f32_16x16x32_bf16 v[164:167], a[108:111], a[196:199], v[164:167]
s_add_u32 s34, s32, 2048
buffer_load_dwordx4 a[160:163], v4, s[48:51], s34 offen sc1
v_mfma_f32_16x16x32_bf16 v[168:171], a[112:115], a[192:195], v[168:171]
v_cvt_pk_bf16_f32 v98, v100, v101
v_mfma_f32_16x16x32_bf16 v[168:171], a[116:119], a[196:199], v[168:171]
ds_read_b64_tr_b16 a[66:67], v21 offset:33792
v_mfma_f32_16x16x32_bf16 v[172:175], a[120:123], a[192:195], v[172:175]
v_cvt_pk_bf16_f32 v99, v102, v103
v_mfma_f32_16x16x32_bf16 v[172:175], a[124:127], a[196:199], v[172:175]
s_add_u32 s53, s56, 16384
buffer_store_dwordx4 v[96:99], v4, s[16:19], s53 offen offset:0
ds_read_b64_tr_b16 a[68:69], v21 offset:40960
v_mfma_f32_16x16x32_bf16 v[176:179], a[128:131], a[192:195], v[176:179]
v_cvt_pk_bf16_f32 v104, v104, v105
v_mfma_f32_16x16x32_bf16 v[176:179], a[132:135], a[196:199], v[176:179]
v_cvt_pk_bf16_f32 v105, v106, v107
v_mfma_f32_16x16x32_bf16 v[180:183], a[136:139], a[192:195], v[180:183]
ds_read_b64_tr_b16 a[70:71], v21 offset:41984
v_mfma_f32_16x16x32_bf16 v[180:183], a[140:143], a[196:199], v[180:183]
buffer_load_dwordx4 a[164:167], v4, s[48:51], s34 offen offset:1024 sc1
v_mfma_f32_16x16x32_bf16 v[184:187], a[144:147], a[192:195], v[184:187]
v_cvt_pk_bf16_f32 v106, v108, v109
v_mfma_f32_16x16x32_bf16 v[184:187], a[148:151], a[196:199], v[184:187]
v_cvt_pk_bf16_f32 v107, v110, v111
v_mfma_f32_16x16x32_bf16 v[188:191], a[152:155], a[192:195], v[188:191]
ds_read_b64_tr_b16 a[72:73], v22 offset:32768
buffer_store_dwordx4 v[104:107], v4, s[16:19], s53 offen offset:1024
v_mfma_f32_16x16x32_bf16 v[188:191], a[156:159], a[196:199], v[188:191]
v_cvt_pk_bf16_f32 v112, v112, v113
v_mfma_f32_16x16x32_bf16 v[192:195], a[96:99], a[200:203], v[192:195]
ds_read_b64_tr_b16 a[74:75], v22 offset:33792
v_mfma_f32_16x16x32_bf16 v[192:195], a[100:103], a[204:207], v[192:195]
v_cvt_pk_bf16_f32 v113, v114, v115
v_mfma_f32_16x16x32_bf16 v[196:199], a[104:107], a[200:203], v[196:199]
s_add_u32 s34, s32, 22528
buffer_load_dwordx4 a[168:171], v4, s[48:51], s34 offen sc1
v_mfma_f32_16x16x32_bf16 v[196:199], a[108:111], a[204:207], v[196:199]
v_cvt_pk_bf16_f32 v114, v116, v117
v_mfma_f32_16x16x32_bf16 v[200:203], a[112:115], a[200:203], v[200:203]
ds_read_b64_tr_b16 a[76:77], v22 offset:40960
v_mfma_f32_16x16x32_bf16 v[200:203], a[116:119], a[204:207], v[200:203]
v_cvt_pk_bf16_f32 v115, v118, v119
v_mfma_f32_16x16x32_bf16 v[204:207], a[120:123], a[200:203], v[204:207]
buffer_store_dwordx4 v[112:115], v4, s[16:19], s53 offen offset:2048
ds_read_b64_tr_b16 a[78:79], v22 offset:41984
v_mfma_f32_16x16x32_bf16 v[204:207], a[124:127], a[204:207], v[204:207]
v_cvt_pk_bf16_f32 v120, v120, v121
v_mfma_f32_16x16x32_bf16 v[208:211], a[128:131], a[200:203], v[208:211]
v_cvt_pk_bf16_f32 v121, v122, v123
v_mfma_f32_16x16x32_bf16 v[208:211], a[132:135], a[204:207], v[208:211]
ds_read_b64_tr_b16 a[80:81], v23 offset:32768
v_mfma_f32_16x16x32_bf16 v[212:215], a[136:139], a[200:203], v[212:215]
buffer_load_dwordx4 a[172:175], v4, s[48:51], s34 offen offset:1024 sc1
v_mfma_f32_16x16x32_bf16 v[212:215], a[140:143], a[204:207], v[212:215]
v_cvt_pk_bf16_f32 v122, v124, v125
v_mfma_f32_16x16x32_bf16 v[216:219], a[144:147], a[200:203], v[216:219]
v_cvt_pk_bf16_f32 v123, v126, v127
v_mfma_f32_16x16x32_bf16 v[216:219], a[148:151], a[204:207], v[216:219]
ds_read_b64_tr_b16 a[82:83], v23 offset:33792
buffer_store_dwordx4 v[120:123], v4, s[16:19], s53 offen offset:3072
v_mfma_f32_16x16x32_bf16 v[220:223], a[152:155], a[200:203], v[220:223]
v_cvt_pk_bf16_f32 v128, v128, v129
v_mfma_f32_16x16x32_bf16 v[220:223], a[156:159], a[204:207], v[220:223]
ds_read_b64_tr_b16 a[84:85], v23 offset:40960
v_mfma_f32_16x16x32_bf16 v[224:227], a[96:99], a[208:211], v[224:227]
v_cvt_pk_bf16_f32 v129, v130, v131
v_mfma_f32_16x16x32_bf16 v[224:227], a[100:103], a[212:215], v[224:227]
s_add_u32 s34, s33, 2048
buffer_load_dwordx4 a[176:179], v4, s[48:51], s34 offen sc1
v_mfma_f32_16x16x32_bf16 v[228:231], a[104:107], a[208:211], v[228:231]
v_cvt_pk_bf16_f32 v130, v132, v133
v_mfma_f32_16x16x32_bf16 v[228:231], a[108:111], a[212:215], v[228:231]
ds_read_b64_tr_b16 a[86:87], v23 offset:41984
v_mfma_f32_16x16x32_bf16 v[232:235], a[112:115], a[208:211], v[232:235]
v_cvt_pk_bf16_f32 v131, v134, v135
v_mfma_f32_16x16x32_bf16 v[232:235], a[116:119], a[212:215], v[232:235]
s_add_u32 s53, s13, 20480
buffer_store_dwordx4 v[128:131], v4, s[16:19], s53 offen offset:0
ds_read_b64_tr_b16 a[88:89], v24 offset:32768
v_mfma_f32_16x16x32_bf16 v[236:239], a[120:123], a[208:211], v[236:239]
v_cvt_pk_bf16_f32 v136, v136, v137
v_mfma_f32_16x16x32_bf16 v[236:239], a[124:127], a[212:215], v[236:239]
v_cvt_pk_bf16_f32 v137, v138, v139
v_mfma_f32_16x16x32_bf16 v[240:243], a[128:131], a[208:211], v[240:243]
ds_read_b64_tr_b16 a[90:91], v24 offset:33792
v_mfma_f32_16x16x32_bf16 v[240:243], a[132:135], a[212:215], v[240:243]
buffer_load_dwordx4 a[180:183], v4, s[48:51], s34 offen offset:1024 sc1
v_mfma_f32_16x16x32_bf16 v[244:247], a[136:139], a[208:211], v[244:247]
v_cvt_pk_bf16_f32 v138, v140, v141
v_mfma_f32_16x16x32_bf16 v[244:247], a[140:143], a[212:215], v[244:247]
v_cvt_pk_bf16_f32 v139, v142, v143
v_mfma_f32_16x16x32_bf16 v[248:251], a[144:147], a[208:211], v[248:251]
ds_read_b64_tr_b16 a[92:93], v24 offset:40960
buffer_store_dwordx4 v[136:139], v4, s[16:19], s53 offen offset:1024
v_mfma_f32_16x16x32_bf16 v[248:251], a[148:151], a[212:215], v[248:251]
v_cvt_pk_bf16_f32 v144, v144, v145
v_mfma_f32_16x16x32_bf16 v[252:255], a[152:155], a[208:211], v[252:255]
ds_read_b64_tr_b16 a[94:95], v24 offset:41984
v_mfma_f32_16x16x32_bf16 v[252:255], a[156:159], a[212:215], v[252:255]
v_cvt_pk_bf16_f32 v145, v146, v147
v_mfma_f32_16x16x32_bf16 a[0:3], a[96:99], a[216:219], a[0:3]
s_add_u32 s34, s33, 22528
buffer_load_dwordx4 a[184:187], v4, s[48:51], s34 offen sc1
v_mfma_f32_16x16x32_bf16 a[0:3], a[100:103], a[220:223], a[0:3]
v_cvt_pk_bf16_f32 v146, v148, v149
v_mfma_f32_16x16x32_bf16 a[4:7], a[104:107], a[216:219], a[4:7]
v_mfma_f32_16x16x32_bf16 a[4:7], a[108:111], a[220:223], a[4:7]
v_cvt_pk_bf16_f32 v147, v150, v151
v_mfma_f32_16x16x32_bf16 a[8:11], a[112:115], a[216:219], a[8:11]
buffer_store_dwordx4 v[144:147], v4, s[16:19], s53 offen offset:2048
v_mfma_f32_16x16x32_bf16 a[8:11], a[116:119], a[220:223], a[8:11]
v_cvt_pk_bf16_f32 v152, v152, v153
v_mfma_f32_16x16x32_bf16 a[12:15], a[120:123], a[216:219], a[12:15]
v_cvt_pk_bf16_f32 v153, v154, v155
v_mfma_f32_16x16x32_bf16 a[12:15], a[124:127], a[220:223], a[12:15]
v_mfma_f32_16x16x32_bf16 a[16:19], a[128:131], a[216:219], a[16:19]
buffer_load_dwordx4 a[188:191], v4, s[48:51], s34 offen offset:1024 sc1
v_mfma_f32_16x16x32_bf16 a[16:19], a[132:135], a[220:223], a[16:19]
v_cvt_pk_bf16_f32 v154, v156, v157
v_mfma_f32_16x16x32_bf16 a[20:23], a[136:139], a[216:219], a[20:23]
v_cvt_pk_bf16_f32 v155, v158, v159
v_mfma_f32_16x16x32_bf16 a[20:23], a[140:143], a[220:223], a[20:23]
buffer_store_dwordx4 v[152:155], v4, s[16:19], s53 offen offset:3072
v_mfma_f32_16x16x32_bf16 a[24:27], a[144:147], a[216:219], a[24:27]
v_mfma_f32_16x16x32_bf16 a[24:27], a[148:151], a[220:223], a[24:27]
v_mfma_f32_16x16x32_bf16 a[28:31], a[152:155], a[216:219], a[28:31]
v_mfma_f32_16x16x32_bf16 a[28:31], a[156:159], a[220:223], a[28:31]
s_branch kf_kernel_z
kf_kernel_pd4:
s_branch kf_kernel_pd8
kf_kernel_v:
s_add_u32 s56, s56, 8192
s_waitcnt lgkmcnt(11)
v_mfma_f32_16x16x32_bf16 v[32:35], a[160:163], a[32:35], 0
ds_read_b64_tr_b16 a[48:49], v23 offset:32768
v_mfma_f32_16x16x32_bf16 v[32:35], a[164:167], a[36:39], v[32:35]
v_mfma_f32_16x16x32_bf16 v[36:39], a[168:171], a[32:35], 0
ds_read_b64_tr_b16 a[50:51], v23 offset:34816
v_mfma_f32_16x16x32_bf16 v[36:39], a[172:175], a[36:39], v[36:39]
s_waitcnt lgkmcnt(9)
v_mfma_f32_16x16x32_bf16 v[96:99], a[176:179], a[32:35], 0
ds_read_b64_tr_b16 a[52:53], v23 offset:49152
v_mfma_f32_16x16x32_bf16 v[96:99], a[180:183], a[36:39], v[96:99]
v_mfma_f32_16x16x32_bf16 v[100:103], a[184:187], a[32:35], 0
ds_read_b64_tr_b16 a[54:55], v23 offset:51200
v_mfma_f32_16x16x32_bf16 v[100:103], a[188:191], a[36:39], v[100:103]
s_waitcnt lgkmcnt(7)
v_mfma_f32_16x16x32_bf16 v[40:43], a[160:163], a[40:43], 0
ds_read_b64_tr_b16 a[56:57], v24 offset:32768
v_mfma_f32_16x16x32_bf16 v[40:43], a[164:167], a[44:47], v[40:43]
v_mfma_f32_16x16x32_bf16 v[44:47], a[168:171], a[40:43], 0
ds_read_b64_tr_b16 a[58:59], v24 offset:34816
v_mfma_f32_16x16x32_bf16 v[44:47], a[172:175], a[44:47], v[44:47]
s_add_u32 m0, s28, 49152
s_xor_b32 s29, s26, 1048704
buffer_load_dwordx4 v5, s[8:11], s29 offen offset:0 lds
v_mfma_f32_16x16x32_bf16 v[104:107], a[176:179], a[40:43], 0
ds_read_b64_tr_b16 a[60:61], v24 offset:49152
v_mfma_f32_16x16x32_bf16 v[104:107], a[180:183], a[44:47], v[104:107]
v_mfma_f32_16x16x32_bf16 v[108:111], a[184:187], a[40:43], 0
ds_read_b64_tr_b16 a[62:63], v24 offset:51200
v_mfma_f32_16x16x32_bf16 v[108:111], a[188:191], a[44:47], v[108:111]
s_waitcnt lgkmcnt(4)
v_mfma_f32_16x16x32_bf16 v[48:51], a[160:163], a[48:51], 0
ds_read_b64_tr_b16 a[64:65], v25 offset:32768
v_mfma_f32_16x16x32_bf16 v[48:51], a[164:167], a[52:55], v[48:51]
v_mfma_f32_16x16x32_bf16 v[52:55], a[168:171], a[48:51], 0
ds_read_b64_tr_b16 a[66:67], v25 offset:34816
v_mfma_f32_16x16x32_bf16 v[52:55], a[172:175], a[52:55], v[52:55]
buffer_load_dwordx4 v6, s[8:11], s29 offen offset:1024 lds
v_mfma_f32_16x16x32_bf16 v[112:115], a[176:179], a[48:51], 0
ds_read_b64_tr_b16 a[68:69], v25 offset:49152
v_mfma_f32_16x16x32_bf16 v[112:115], a[180:183], a[52:55], v[112:115]
v_mfma_f32_16x16x32_bf16 v[116:119], a[184:187], a[48:51], 0
ds_read_b64_tr_b16 a[70:71], v25 offset:51200
v_mfma_f32_16x16x32_bf16 v[116:119], a[188:191], a[52:55], v[116:119]
s_waitcnt lgkmcnt(4)
v_mfma_f32_16x16x32_bf16 v[56:59], a[160:163], a[56:59], 0
ds_read_b64_tr_b16 a[72:73], v26 offset:32768
v_mfma_f32_16x16x32_bf16 v[56:59], a[164:167], a[60:63], v[56:59]
v_mfma_f32_16x16x32_bf16 v[60:63], a[168:171], a[56:59], 0
ds_read_b64_tr_b16 a[74:75], v26 offset:34816
v_mfma_f32_16x16x32_bf16 v[60:63], a[172:175], a[60:63], v[60:63]
buffer_load_dwordx4 v7, s[8:11], s29 offen offset:2048 lds
v_mfma_f32_16x16x32_bf16 v[120:123], a[176:179], a[56:59], 0
ds_read_b64_tr_b16 a[76:77], v26 offset:49152
v_mfma_f32_16x16x32_bf16 v[120:123], a[180:183], a[60:63], v[120:123]
v_mfma_f32_16x16x32_bf16 v[124:127], a[184:187], a[56:59], 0
ds_read_b64_tr_b16 a[78:79], v26 offset:51200
v_mfma_f32_16x16x32_bf16 v[124:127], a[188:191], a[60:63], v[124:127]
s_waitcnt lgkmcnt(4)
v_mfma_f32_16x16x32_bf16 v[64:67], a[160:163], a[64:67], 0
ds_read_b64_tr_b16 a[80:81], v27 offset:32768
v_mfma_f32_16x16x32_bf16 v[64:67], a[164:167], a[68:71], v[64:67]
v_mfma_f32_16x16x32_bf16 v[68:71], a[168:171], a[64:67], 0
ds_read_b64_tr_b16 a[82:83], v27 offset:34816
v_mfma_f32_16x16x32_bf16 v[68:71], a[172:175], a[68:71], v[68:71]
buffer_load_dwordx4 v8, s[8:11], s29 offen offset:3072 lds
v_mfma_f32_16x16x32_bf16 v[128:131], a[176:179], a[64:67], 0
ds_read_b64_tr_b16 a[84:85], v27 offset:49152
v_mfma_f32_16x16x32_bf16 v[128:131], a[180:183], a[68:71], v[128:131]
v_mfma_f32_16x16x32_bf16 v[132:135], a[184:187], a[64:67], 0
ds_read_b64_tr_b16 a[86:87], v27 offset:51200
v_mfma_f32_16x16x32_bf16 v[132:135], a[188:191], a[68:71], v[132:135]
s_waitcnt lgkmcnt(4)
v_mfma_f32_16x16x32_bf16 v[72:75], a[160:163], a[72:75], 0
ds_read_b64_tr_b16 a[88:89], v28 offset:32768
v_mfma_f32_16x16x32_bf16 v[72:75], a[164:167], a[76:79], v[72:75]
v_mfma_f32_16x16x32_bf16 v[76:79], a[168:171], a[72:75], 0
ds_read_b64_tr_b16 a[90:91], v28 offset:34816
v_mfma_f32_16x16x32_bf16 v[76:79], a[172:175], a[76:79], v[76:79]
buffer_store_dwordx4 a[224:227], v31, s[48:51], s39 offen sc1
v_mfma_f32_16x16x32_bf16 v[136:139], a[176:179], a[72:75], 0
ds_read_b64_tr_b16 a[92:93], v28 offset:49152
ds_read_b128 a[192:195], v17 offset:16384
v_mfma_f32_16x16x32_bf16 v[136:139], a[180:183], a[76:79], v[136:139]
v_mfma_f32_16x16x32_bf16 v[140:143], a[184:187], a[72:75], 0
ds_read_b64_tr_b16 a[94:95], v28 offset:51200
ds_read_b128 a[196:199], v18 offset:16384
v_mfma_f32_16x16x32_bf16 v[140:143], a[188:191], a[76:79], v[140:143]
s_waitcnt lgkmcnt(6)
v_mfma_f32_16x16x32_bf16 v[80:83], a[160:163], a[80:83], 0
ds_read_b128 a[200:203], v17 offset:18432
v_mfma_f32_16x16x32_bf16 v[80:83], a[164:167], a[84:87], v[80:83]
v_mfma_f32_16x16x32_bf16 v[84:87], a[168:171], a[80:83], 0
ds_read_b128 a[204:207], v18 offset:18432
v_mfma_f32_16x16x32_bf16 v[84:87], a[172:175], a[84:87], v[84:87]
s_add_u32 s39, s39, 8192
buffer_store_dwordx4 a[228:231], v31, s[48:51], s39 offen sc1
v_mfma_f32_16x16x32_bf16 v[144:147], a[176:179], a[80:83], 0
ds_read_b128 a[208:211], v17 offset:20480
v_mfma_f32_16x16x32_bf16 v[144:147], a[180:183], a[84:87], v[144:147]
v_mfma_f32_16x16x32_bf16 v[148:151], a[184:187], a[80:83], 0
ds_read_b128 a[212:215], v18 offset:20480
v_mfma_f32_16x16x32_bf16 v[148:151], a[188:191], a[84:87], v[148:151]
s_waitcnt lgkmcnt(5)
v_mfma_f32_16x16x32_bf16 v[88:91], a[160:163], a[88:91], 0
ds_read_b128 a[216:219], v17 offset:22528
v_mfma_f32_16x16x32_bf16 v[88:91], a[164:167], a[92:95], v[88:91]
v_mfma_f32_16x16x32_bf16 v[92:95], a[168:171], a[88:91], 0
ds_read_b128 a[220:223], v18 offset:22528
v_mfma_f32_16x16x32_bf16 v[92:95], a[172:175], a[92:95], v[92:95]
s_add_u32 s39, s39, 8192
s_cmp_ge_u32 s20, 2
s_cselect_b32 s39, 1073741824, s39
buffer_store_dwordx4 a[232:235], v31, s[48:51], s39 offen sc1
v_mfma_f32_16x16x32_bf16 v[152:155], a[176:179], a[88:91], 0
v_mfma_f32_16x16x32_bf16 v[152:155], a[180:183], a[92:95], v[152:155]
v_mfma_f32_16x16x32_bf16 v[156:159], a[184:187], a[88:91], 0
v_mfma_f32_16x16x32_bf16 v[156:159], a[188:191], a[92:95], v[156:159]
s_waitcnt vmcnt(7) lgkmcnt(0)
s_barrier
v_mfma_f32_16x16x32_bf16 v[160:163], a[192:195], a[32:35], 0
v_mfma_f32_16x16x32_bf16 v[160:163], a[196:199], a[36:39], v[160:163]
ds_read_b128 a[160:163], v17 offset:32768
v_mfma_f32_16x16x32_bf16 v[168:171], a[192:195], a[40:43], 0
ds_read_b128 a[164:167], v18 offset:32768
v_mfma_f32_16x16x32_bf16 v[168:171], a[196:199], a[44:47], v[168:171]
s_add_u32 m0, s25, 98304
s_xor_b32 s29, s27, 1048576
buffer_load_dwordx4 v9, s[12:15], s29 offen offset:0 nt lds
v_mfma_f32_16x16x32_bf16 v[176:179], a[192:195], a[48:51], 0
ds_read_b128 a[168:171], v17 offset:34816
v_mfma_f32_16x16x32_bf16 v[176:179], a[196:199], a[52:55], v[176:179]
ds_read_b128 a[172:175], v18 offset:34816
v_mfma_f32_16x16x32_bf16 v[184:187], a[192:195], a[56:59], 0
ds_read_b128 a[176:179], v17 offset:36864
v_mfma_f32_16x16x32_bf16 v[184:187], a[196:199], a[60:63], v[184:187]
v_mfma_f32_16x16x32_bf16 v[192:195], a[192:195], a[64:67], 0
buffer_load_dwordx4 v10, s[12:15], s29 offen offset:1024 nt lds
v_mfma_f32_16x16x32_bf16 v[192:195], a[196:199], a[68:71], v[192:195]
ds_read_b128 a[180:183], v18 offset:36864
v_mfma_f32_16x16x32_bf16 v[200:203], a[192:195], a[72:75], 0
ds_read_b128 a[184:187], v17 offset:38912
v_mfma_f32_16x16x32_bf16 v[200:203], a[196:199], a[76:79], v[200:203]
ds_read_b128 a[188:191], v18 offset:38912
v_mfma_f32_16x16x32_bf16 v[208:211], a[192:195], a[80:83], 0
buffer_load_dwordx4 v11, s[12:15], s29 offen offset:2048 nt lds
v_mfma_f32_16x16x32_bf16 v[208:211], a[196:199], a[84:87], v[208:211]
ds_read_b64_tr_b16 a[96:97], v21 offset:0
v_mfma_f32_16x16x32_bf16 v[216:219], a[192:195], a[88:91], 0
ds_read_b64_tr_b16 a[98:99], v21 offset:2048
v_mfma_f32_16x16x32_bf16 v[216:219], a[196:199], a[92:95], v[216:219]
v_mfma_f32_16x16x32_bf16 v[164:167], a[200:203], a[32:35], 0
ds_read_b64_tr_b16 a[100:101], v21 offset:16384
v_mfma_f32_16x16x32_bf16 v[164:167], a[204:207], a[36:39], v[164:167]
ds_read_b64_tr_b16 a[102:103], v21 offset:18432
v_mfma_f32_16x16x32_bf16 v[172:175], a[200:203], a[40:43], 0
buffer_load_dwordx4 v12, s[12:15], s29 offen offset:3072 nt lds
v_mfma_f32_16x16x32_bf16 v[172:175], a[204:207], a[44:47], v[172:175]
ds_read_b64_tr_b16 a[104:105], v22 offset:0
v_mfma_f32_16x16x32_bf16 v[180:183], a[200:203], a[48:51], 0
ds_read_b64_tr_b16 a[106:107], v22 offset:2048
v_mfma_f32_16x16x32_bf16 v[180:183], a[204:207], a[52:55], v[180:183]
ds_read_b64_tr_b16 a[108:109], v22 offset:16384
v_mfma_f32_16x16x32_bf16 v[188:191], a[200:203], a[56:59], 0
v_mfma_f32_16x16x32_bf16 v[188:191], a[204:207], a[60:63], v[188:191]
s_add_u32 m0, s25, 102400
s_xor_b32 s29, s27, 1048576
buffer_load_dwordx4 v13, s[12:15], s29 offen offset:0 nt lds
v_mfma_f32_16x16x32_bf16 v[196:199], a[200:203], a[64:67], 0
ds_read_b64_tr_b16 a[110:111], v22 offset:18432
v_mfma_f32_16x16x32_bf16 v[196:199], a[204:207], a[68:71], v[196:199]
ds_read_b64_tr_b16 a[112:113], v23 offset:0
v_mfma_f32_16x16x32_bf16 v[204:207], a[200:203], a[72:75], 0
ds_read_b64_tr_b16 a[114:115], v23 offset:2048
v_mfma_f32_16x16x32_bf16 v[204:207], a[204:207], a[76:79], v[204:207]
buffer_load_dwordx4 v14, s[12:15], s29 offen offset:1024 nt lds
v_mfma_f32_16x16x32_bf16 v[212:215], a[200:203], a[80:83], 0
ds_read_b64_tr_b16 a[116:117], v23 offset:16384
v_mfma_f32_16x16x32_bf16 v[212:215], a[204:207], a[84:87], v[212:215]
ds_read_b64_tr_b16 a[118:119], v23 offset:18432
v_mfma_f32_16x16x32_bf16 v[220:223], a[200:203], a[88:91], 0
v_mfma_f32_16x16x32_bf16 v[220:223], a[204:207], a[92:95], v[220:223]
ds_read_b64_tr_b16 a[120:121], v24 offset:0
v_mfma_f32_16x16x32_bf16 v[224:227], a[208:211], a[32:35], 0
ds_read_b64_tr_b16 a[122:123], v24 offset:2048
v_mfma_f32_16x16x32_bf16 v[224:227], a[212:215], a[36:39], v[224:227]
buffer_load_dwordx4 v15, s[12:15], s29 offen offset:2048 nt lds
v_mfma_f32_16x16x32_bf16 v[232:235], a[208:211], a[40:43], 0
ds_read_b64_tr_b16 a[124:125], v24 offset:16384
v_mfma_f32_16x16x32_bf16 v[232:235], a[212:215], a[44:47], v[232:235]
ds_read_b64_tr_b16 a[126:127], v24 offset:18432
v_mfma_f32_16x16x32_bf16 v[240:243], a[208:211], a[48:51], 0
ds_read_b64_tr_b16 a[128:129], v25 offset:0
v_mfma_f32_16x16x32_bf16 v[240:243], a[212:215], a[52:55], v[240:243]
v_mfma_f32_16x16x32_bf16 v[248:251], a[208:211], a[56:59], 0
buffer_load_dwordx4 v16, s[12:15], s29 offen offset:3072 nt lds
v_mfma_f32_16x16x32_bf16 v[248:251], a[212:215], a[60:63], v[248:251]
ds_read_b64_tr_b16 a[130:131], v25 offset:2048
v_mfma_f32_16x16x32_bf16 a[0:3], a[208:211], a[64:67], 0
ds_read_b64_tr_b16 a[132:133], v25 offset:16384
v_mfma_f32_16x16x32_bf16 a[0:3], a[212:215], a[68:71], a[0:3]
ds_read_b64_tr_b16 a[134:135], v25 offset:18432
v_mfma_f32_16x16x32_bf16 a[8:11], a[208:211], a[72:75], 0
s_add_u32 m0, s28, 0
s_xor_b32 s29, s26, 256
buffer_load_dwordx4 v5, s[8:11], s29 offen offset:0 lds
v_mfma_f32_16x16x32_bf16 a[8:11], a[212:215], a[76:79], a[8:11]
ds_read_b64_tr_b16 a[136:137], v26 offset:0
v_mfma_f32_16x16x32_bf16 a[16:19], a[208:211], a[80:83], 0
ds_read_b64_tr_b16 a[138:139], v26 offset:2048
v_mfma_f32_16x16x32_bf16 a[16:19], a[212:215], a[84:87], a[16:19]
v_mfma_f32_16x16x32_bf16 a[24:27], a[208:211], a[88:91], 0
s_branch kf_kernel_pl5
kf_kernel_pd5:
s_branch kf_kernel_pd11
kf_kernel_pl5:
ds_read_b64_tr_b16 a[140:141], v26 offset:16384
v_mfma_f32_16x16x32_bf16 a[24:27], a[212:215], a[92:95], a[24:27]
ds_read_b64_tr_b16 a[142:143], v26 offset:18432
v_mfma_f32_16x16x32_bf16 v[228:231], a[216:219], a[32:35], 0
buffer_load_dwordx4 v6, s[8:11], s29 offen offset:1024 lds
v_mfma_f32_16x16x32_bf16 v[228:231], a[220:223], a[36:39], v[228:231]
ds_read_b64_tr_b16 a[144:145], v27 offset:0
v_mfma_f32_16x16x32_bf16 v[236:239], a[216:219], a[40:43], 0
ds_read_b64_tr_b16 a[146:147], v27 offset:2048
v_mfma_f32_16x16x32_bf16 v[236:239], a[220:223], a[44:47], v[236:239]
ds_read_b64_tr_b16 a[148:149], v27 offset:16384
v_mfma_f32_16x16x32_bf16 v[244:247], a[216:219], a[48:51], 0
v_mfma_f32_16x16x32_bf16 v[244:247], a[220:223], a[52:55], v[244:247]
buffer_load_dwordx4 v7, s[8:11], s29 offen offset:2048 lds
v_mfma_f32_16x16x32_bf16 v[252:255], a[216:219], a[56:59], 0
ds_read_b64_tr_b16 a[150:151], v27 offset:18432
v_mfma_f32_16x16x32_bf16 v[252:255], a[220:223], a[60:63], v[252:255]
ds_read_b64_tr_b16 a[152:153], v28 offset:0
v_mfma_f32_16x16x32_bf16 a[4:7], a[216:219], a[64:67], 0
ds_read_b64_tr_b16 a[154:155], v28 offset:2048
v_mfma_f32_16x16x32_bf16 a[4:7], a[220:223], a[68:71], a[4:7]
buffer_load_dwordx4 v8, s[8:11], s29 offen offset:3072 lds
v_mfma_f32_16x16x32_bf16 a[12:15], a[216:219], a[72:75], 0
ds_read_b64_tr_b16 a[156:157], v28 offset:16384
v_mfma_f32_16x16x32_bf16 a[12:15], a[220:223], a[76:79], a[12:15]
ds_read_b64_tr_b16 a[158:159], v28 offset:18432
v_mfma_f32_16x16x32_bf16 a[20:23], a[216:219], a[80:83], 0
v_mfma_f32_16x16x32_bf16 a[20:23], a[220:223], a[84:87], a[20:23]
v_mfma_f32_16x16x32_bf16 a[28:31], a[216:219], a[88:91], 0
v_mfma_f32_16x16x32_bf16 a[28:31], a[220:223], a[92:95], a[28:31]
s_waitcnt vmcnt(15) lgkmcnt(0)
s_barrier
v_mfma_f32_16x16x32_bf16 v[32:35], a[160:163], a[96:99], v[32:35]
v_mfma_f32_16x16x32_bf16 v[32:35], a[164:167], a[100:103], v[32:35]
v_mfma_f32_16x16x32_bf16 v[40:43], a[160:163], a[104:107], v[40:43]
ds_read_b128 a[192:195], v17 offset:49152
v_mfma_f32_16x16x32_bf16 v[40:43], a[164:167], a[108:111], v[40:43]
v_mfma_f32_16x16x32_bf16 v[48:51], a[160:163], a[112:115], v[48:51]
v_mfma_f32_16x16x32_bf16 v[48:51], a[164:167], a[116:119], v[48:51]
buffer_load_dword v30, off, s[60:63], 0 sc1
v_mfma_f32_16x16x32_bf16 v[56:59], a[160:163], a[120:123], v[56:59]
v_mfma_f32_16x16x32_bf16 v[56:59], a[164:167], a[124:127], v[56:59]
v_mfma_f32_16x16x32_bf16 v[64:67], a[160:163], a[128:131], v[64:67]
ds_read_b128 a[196:199], v18 offset:49152
v_mfma_f32_16x16x32_bf16 v[64:67], a[164:167], a[132:135], v[64:67]
v_mfma_f32_16x16x32_bf16 v[72:75], a[160:163], a[136:139], v[72:75]
v_mfma_f32_16x16x32_bf16 v[72:75], a[164:167], a[140:143], v[72:75]
s_add_u32 m0, s28, 16384
s_xor_b32 s29, s26, 1048832
buffer_load_dwordx4 v5, s[8:11], s29 offen offset:0 lds
v_mfma_f32_16x16x32_bf16 v[80:83], a[160:163], a[144:147], v[80:83]
v_mfma_f32_16x16x32_bf16 v[80:83], a[164:167], a[148:151], v[80:83]
v_mfma_f32_16x16x32_bf16 v[88:91], a[160:163], a[152:155], v[88:91]
ds_read_b128 a[200:203], v17 offset:51200
v_mfma_f32_16x16x32_bf16 v[88:91], a[164:167], a[156:159], v[88:91]
v_mfma_f32_16x16x32_bf16 v[36:39], a[168:171], a[96:99], v[36:39]
v_mfma_f32_16x16x32_bf16 v[36:39], a[172:175], a[100:103], v[36:39]
buffer_load_dwordx4 v6, s[8:11], s29 offen offset:1024 lds
v_mfma_f32_16x16x32_bf16 v[44:47], a[168:171], a[104:107], v[44:47]
v_mfma_f32_16x16x32_bf16 v[44:47], a[172:175], a[108:111], v[44:47]
ds_read_b128 a[204:207], v18 offset:51200
v_mfma_f32_16x16x32_bf16 v[52:55], a[168:171], a[112:115], v[52:55]
v_mfma_f32_16x16x32_bf16 v[52:55], a[172:175], a[116:119], v[52:55]
v_mfma_f32_16x16x32_bf16 v[60:63], a[168:171], a[120:123], v[60:63]
ds_read_b128 a[208:211], v17 offset:53248
v_mfma_f32_16x16x32_bf16 v[60:63], a[172:175], a[124:127], v[60:63]
v_mfma_f32_16x16x32_bf16 v[68:71], a[168:171], a[128:131], v[68:71]
v_mfma_f32_16x16x32_bf16 v[68:71], a[172:175], a[132:135], v[68:71]
buffer_load_dwordx4 v7, s[8:11], s29 offen offset:2048 lds
v_mfma_f32_16x16x32_bf16 v[76:79], a[168:171], a[136:139], v[76:79]
v_mfma_f32_16x16x32_bf16 v[76:79], a[172:175], a[140:143], v[76:79]
v_mfma_f32_16x16x32_bf16 v[84:87], a[168:171], a[144:147], v[84:87]
ds_read_b128 a[212:215], v18 offset:53248
v_mfma_f32_16x16x32_bf16 v[84:87], a[172:175], a[148:151], v[84:87]
v_mfma_f32_16x16x32_bf16 v[92:95], a[168:171], a[152:155], v[92:95]
v_mfma_f32_16x16x32_bf16 v[92:95], a[172:175], a[156:159], v[92:95]
buffer_load_dwordx4 v8, s[8:11], s29 offen offset:3072 lds
v_mfma_f32_16x16x32_bf16 v[96:99], a[176:179], a[96:99], v[96:99]
v_mfma_f32_16x16x32_bf16 v[96:99], a[180:183], a[100:103], v[96:99]
v_mfma_f32_16x16x32_bf16 v[104:107], a[176:179], a[104:107], v[104:107]
ds_read_b128 a[216:219], v17 offset:55296
v_mfma_f32_16x16x32_bf16 v[104:107], a[180:183], a[108:111], v[104:107]
v_mfma_f32_16x16x32_bf16 v[112:115], a[176:179], a[112:115], v[112:115]
v_mfma_f32_16x16x32_bf16 v[112:115], a[180:183], a[116:119], v[112:115]
s_add_u32 m0, s25, 65536
s_xor_b32 s29, s27, 1572864
buffer_load_dwordx4 v9, s[12:15], s29 offen offset:0 nt lds
v_mfma_f32_16x16x32_bf16 v[120:123], a[176:179], a[120:123], v[120:123]
v_mfma_f32_16x16x32_bf16 v[120:123], a[180:183], a[124:127], v[120:123]
ds_read_b128 a[220:223], v18 offset:55296
v_mfma_f32_16x16x32_bf16 v[128:131], a[176:179], a[128:131], v[128:131]
v_mfma_f32_16x16x32_bf16 v[128:131], a[180:183], a[132:135], v[128:131]
v_mfma_f32_16x16x32_bf16 v[136:139], a[176:179], a[136:139], v[136:139]
v_mfma_f32_16x16x32_bf16 v[136:139], a[180:183], a[140:143], v[136:139]
v_mfma_f32_16x16x32_bf16 v[144:147], a[176:179], a[144:147], v[144:147]
v_mfma_f32_16x16x32_bf16 v[144:147], a[180:183], a[148:151], v[144:147]
buffer_load_dwordx4 v10, s[12:15], s29 offen offset:1024 nt lds
v_mfma_f32_16x16x32_bf16 v[152:155], a[176:179], a[152:155], v[152:155]
v_mfma_f32_16x16x32_bf16 v[152:155], a[180:183], a[156:159], v[152:155]
v_mfma_f32_16x16x32_bf16 v[100:103], a[184:187], a[96:99], v[100:103]
v_mfma_f32_16x16x32_bf16 v[100:103], a[188:191], a[100:103], v[100:103]
v_mfma_f32_16x16x32_bf16 v[108:111], a[184:187], a[104:107], v[108:111]
v_mfma_f32_16x16x32_bf16 v[108:111], a[188:191], a[108:111], v[108:111]
buffer_load_dwordx4 v11, s[12:15], s29 offen offset:2048 nt lds
v_mfma_f32_16x16x32_bf16 v[116:119], a[184:187], a[112:115], v[116:119]
v_mfma_f32_16x16x32_bf16 v[116:119], a[188:191], a[116:119], v[116:119]
v_mfma_f32_16x16x32_bf16 v[124:127], a[184:187], a[120:123], v[124:127]
v_mfma_f32_16x16x32_bf16 v[124:127], a[188:191], a[124:127], v[124:127]
v_mfma_f32_16x16x32_bf16 v[132:135], a[184:187], a[128:131], v[132:135]
v_mfma_f32_16x16x32_bf16 v[132:135], a[188:191], a[132:135], v[132:135]
buffer_load_dwordx4 v12, s[12:15], s29 offen offset:3072 nt lds
v_mfma_f32_16x16x32_bf16 v[140:143], a[184:187], a[136:139], v[140:143]
v_mfma_f32_16x16x32_bf16 v[140:143], a[188:191], a[140:143], v[140:143]
v_mfma_f32_16x16x32_bf16 v[148:151], a[184:187], a[144:147], v[148:151]
v_mfma_f32_16x16x32_bf16 v[148:151], a[188:191], a[148:151], v[148:151]
v_mfma_f32_16x16x32_bf16 v[156:159], a[184:187], a[152:155], v[156:159]
v_mfma_f32_16x16x32_bf16 v[156:159], a[188:191], a[156:159], v[156:159]
s_waitcnt vmcnt(9) lgkmcnt(0)
s_barrier
v_mfma_f32_16x16x32_bf16 v[160:163], a[192:195], a[96:99], v[160:163]
ds_read_b128 a[160:163], v17 offset:0
v_mfma_f32_16x16x32_bf16 v[160:163], a[196:199], a[100:103], v[160:163]
ds_read_b128 a[164:167], v18 offset:0
v_mfma_f32_16x16x32_bf16 v[168:171], a[192:195], a[104:107], v[168:171]
v_bfe_u32 v1, v0, 1, 5
v_mfma_f32_16x16x32_bf16 v[168:171], a[196:199], a[108:111], v[168:171]
s_add_u32 m0, s25, 69632
s_xor_b32 s29, s27, 1572864
buffer_load_dwordx4 v13, s[12:15], s29 offen offset:0 nt lds
v_mfma_f32_16x16x32_bf16 v[176:179], a[192:195], a[112:115], v[176:179]
ds_read_b128 a[168:171], v17 offset:2048
v_mfma_f32_16x16x32_bf16 v[176:179], a[196:199], a[116:119], v[176:179]
ds_read_b128 a[172:175], v18 offset:2048
v_mfma_f32_16x16x32_bf16 v[184:187], a[192:195], a[120:123], v[184:187]
ds_read_b128 a[176:179], v17 offset:4096
v_mfma_f32_16x16x32_bf16 v[184:187], a[196:199], a[124:127], v[184:187]
v_cmp_gt_u32 vcc, 5, v1
v_mfma_f32_16x16x32_bf16 v[192:195], a[192:195], a[128:131], v[192:195]
ds_read_b128 a[180:183], v18 offset:4096
v_mfma_f32_16x16x32_bf16 v[192:195], a[196:199], a[132:135], v[192:195]
ds_read_b128 a[184:187], v17 offset:6144
v_mfma_f32_16x16x32_bf16 v[200:203], a[192:195], a[136:139], v[200:203]
buffer_load_dwordx4 v14, s[12:15], s29 offen offset:1024 nt lds
v_mfma_f32_16x16x32_bf16 v[200:203], a[196:199], a[140:143], v[200:203]
ds_read_b128 a[188:191], v18 offset:6144
v_mfma_f32_16x16x32_bf16 v[208:211], a[192:195], a[144:147], v[208:211]
v_mul_u32_u24 v1, 8192, v1
v_mfma_f32_16x16x32_bf16 v[208:211], a[196:199], a[148:151], v[208:211]
ds_read_b64_tr_b16 a[32:33], v21 offset:32768
v_mfma_f32_16x16x32_bf16 v[216:219], a[192:195], a[152:155], v[216:219]
ds_read_b64_tr_b16 a[34:35], v21 offset:34816
v_mfma_f32_16x16x32_bf16 v[216:219], a[196:199], a[156:159], v[216:219]
ds_read_b64_tr_b16 a[36:37], v21 offset:49152
v_mfma_f32_16x16x32_bf16 v[164:167], a[200:203], a[96:99], v[164:167]
ds_read_b64_tr_b16 a[38:39], v21 offset:51200
v_mfma_f32_16x16x32_bf16 v[164:167], a[204:207], a[100:103], v[164:167]
v_and_b32 v2, 1, v0
v_mfma_f32_16x16x32_bf16 v[172:175], a[200:203], a[104:107], v[172:175]
buffer_load_dwordx4 v15, s[12:15], s29 offen offset:2048 nt lds
v_mfma_f32_16x16x32_bf16 v[172:175], a[204:207], a[108:111], v[172:175]
ds_read_b64_tr_b16 a[40:41], v22 offset:32768
v_mfma_f32_16x16x32_bf16 v[180:183], a[200:203], a[112:115], v[180:183]
ds_read_b64_tr_b16 a[42:43], v22 offset:34816
v_mfma_f32_16x16x32_bf16 v[180:183], a[204:207], a[116:119], v[180:183]
ds_read_b64_tr_b16 a[44:45], v22 offset:49152
v_mfma_f32_16x16x32_bf16 v[188:191], a[200:203], a[120:123], v[188:191]
v_lshl_add_u32 v1, v2, 7, v1
v_mfma_f32_16x16x32_bf16 v[188:191], a[204:207], a[124:127], v[188:191]
ds_read_b64_tr_b16 a[46:47], v22 offset:51200
v_mfma_f32_16x16x32_bf16 v[196:199], a[200:203], a[128:131], v[196:199]
ds_read_b64_tr_b16 a[48:49], v23 offset:32768
v_mfma_f32_16x16x32_bf16 v[196:199], a[204:207], a[132:135], v[196:199]
buffer_load_dwordx4 v16, s[12:15], s29 offen offset:3072 nt lds
v_mfma_f32_16x16x32_bf16 v[204:207], a[200:203], a[136:139], v[204:207]
ds_read_b64_tr_b16 a[50:51], v23 offset:34816
v_mfma_f32_16x16x32_bf16 v[204:207], a[204:207], a[140:143], v[204:207]
v_mov_b32 v2, 1073741824
v_mfma_f32_16x16x32_bf16 v[212:215], a[200:203], a[144:147], v[212:215]
ds_read_b64_tr_b16 a[52:53], v23 offset:49152
v_mfma_f32_16x16x32_bf16 v[212:215], a[204:207], a[148:151], v[212:215]
ds_read_b64_tr_b16 a[54:55], v23 offset:51200
v_mfma_f32_16x16x32_bf16 v[220:223], a[200:203], a[152:155], v[220:223]
ds_read_b64_tr_b16 a[56:57], v24 offset:32768
v_mfma_f32_16x16x32_bf16 v[220:223], a[204:207], a[156:159], v[220:223]
ds_read_b64_tr_b16 a[58:59], v24 offset:34816
v_mfma_f32_16x16x32_bf16 v[224:227], a[208:211], a[96:99], v[224:227]
s_mov_b32 s34, s22
v_mfma_f32_16x16x32_bf16 v[224:227], a[212:215], a[100:103], v[224:227]
s_add_u32 m0, s28, 32768
s_xor_b32 s29, s26, 384
buffer_load_dwordx4 v5, s[8:11], s29 offen offset:0 lds
v_mfma_f32_16x16x32_bf16 v[232:235], a[208:211], a[104:107], v[232:235]
ds_read_b64_tr_b16 a[60:61], v24 offset:49152
v_mfma_f32_16x16x32_bf16 v[232:235], a[212:215], a[108:111], v[232:235]
ds_read_b64_tr_b16 a[62:63], v24 offset:51200
v_mfma_f32_16x16x32_bf16 v[240:243], a[208:211], a[112:115], v[240:243]
ds_read_b64_tr_b16 a[64:65], v25 offset:32768
v_mfma_f32_16x16x32_bf16 v[240:243], a[212:215], a[116:119], v[240:243]
s_lshl2_add_u32 s34, s34, s20
v_mfma_f32_16x16x32_bf16 v[248:251], a[208:211], a[120:123], v[248:251]
ds_read_b64_tr_b16 a[66:67], v25 offset:34816
v_mfma_f32_16x16x32_bf16 v[248:251], a[212:215], a[124:127], v[248:251]
ds_read_b64_tr_b16 a[68:69], v25 offset:49152
v_mfma_f32_16x16x32_bf16 a[0:3], a[208:211], a[128:131], a[0:3]
buffer_load_dwordx4 v6, s[8:11], s29 offen offset:1024 lds
v_mfma_f32_16x16x32_bf16 a[0:3], a[212:215], a[132:135], a[0:3]
ds_read_b64_tr_b16 a[70:71], v25 offset:51200
v_mfma_f32_16x16x32_bf16 a[8:11], a[208:211], a[136:139], a[8:11]
v_cndmask_b32 v1, v2, v1, vcc
v_mfma_f32_16x16x32_bf16 a[8:11], a[212:215], a[140:143], a[8:11]
ds_read_b64_tr_b16 a[72:73], v26 offset:32768
v_mfma_f32_16x16x32_bf16 a[16:19], a[208:211], a[144:147], a[16:19]
ds_read_b64_tr_b16 a[74:75], v26 offset:34816
v_mfma_f32_16x16x32_bf16 a[16:19], a[212:215], a[148:151], a[16:19]
ds_read_b64_tr_b16 a[76:77], v26 offset:49152
v_mfma_f32_16x16x32_bf16 a[24:27], a[208:211], a[152:155], a[24:27]
ds_read_b64_tr_b16 a[78:79], v26 offset:51200
v_mfma_f32_16x16x32_bf16 a[24:27], a[212:215], a[156:159], a[24:27]
s_mul_i32 s34, s34, 40960
v_mfma_f32_16x16x32_bf16 v[228:231], a[216:219], a[96:99], v[228:231]
buffer_load_dwordx4 v7, s[8:11], s29 offen offset:2048 lds
v_mfma_f32_16x16x32_bf16 v[228:231], a[220:223], a[100:103], v[228:231]
ds_read_b64_tr_b16 a[80:81], v27 offset:32768
v_mfma_f32_16x16x32_bf16 v[236:239], a[216:219], a[104:107], v[236:239]
ds_read_b64_tr_b16 a[82:83], v27 offset:34816
v_mfma_f32_16x16x32_bf16 v[236:239], a[220:223], a[108:111], v[236:239]
ds_read_b64_tr_b16 a[84:85], v27 offset:49152
v_mfma_f32_16x16x32_bf16 v[244:247], a[216:219], a[112:115], v[244:247]
s_add_u32 s34, s34, 0
v_mfma_f32_16x16x32_bf16 v[244:247], a[220:223], a[116:119], v[244:247]
ds_read_b64_tr_b16 a[86:87], v27 offset:51200
v_mfma_f32_16x16x32_bf16 v[252:255], a[216:219], a[120:123], v[252:255]
ds_read_b64_tr_b16 a[88:89], v28 offset:32768
v_mfma_f32_16x16x32_bf16 v[252:255], a[220:223], a[124:127], v[252:255]
buffer_load_dwordx4 v8, s[8:11], s29 offen offset:3072 lds
v_mfma_f32_16x16x32_bf16 a[4:7], a[216:219], a[128:131], a[4:7]
ds_read_b64_tr_b16 a[90:91], v28 offset:34816
v_mfma_f32_16x16x32_bf16 a[4:7], a[220:223], a[132:135], a[4:7]
buffer_load_dword a242, v1, s[44:47], s34 offen
v_mfma_f32_16x16x32_bf16 a[12:15], a[216:219], a[136:139], a[12:15]
ds_read_b64_tr_b16 a[92:93], v28 offset:49152
v_mfma_f32_16x16x32_bf16 a[12:15], a[220:223], a[140:143], a[12:15]
ds_read_b64_tr_b16 a[94:95], v28 offset:51200
v_mfma_f32_16x16x32_bf16 a[20:23], a[216:219], a[144:147], a[20:23]
v_mfma_f32_16x16x32_bf16 a[20:23], a[220:223], a[148:151], a[20:23]
v_mfma_f32_16x16x32_bf16 a[28:31], a[216:219], a[152:155], a[28:31]
v_mfma_f32_16x16x32_bf16 a[28:31], a[220:223], a[156:159], a[28:31]
s_waitcnt vmcnt(13) lgkmcnt(0)
s_barrier
v_cmp_gt_u32 vcc, 4, v30
s_cmp_lg_u64 vcc, 0
s_cbranch_scc1 kf_kernel_spin_bv
kf_kernel_ret_bv:
v_mfma_f32_16x16x32_bf16 v[32:35], a[160:163], a[32:35], v[32:35]
v_mfma_f32_16x16x32_bf16 v[32:35], a[164:167], a[36:39], v[32:35]
ds_read_b128 a[192:195], v17 offset:16384
v_mfma_f32_16x16x32_bf16 v[40:43], a[160:163], a[40:43], v[40:43]
v_mfma_f32_16x16x32_bf16 v[40:43], a[164:167], a[44:47], v[40:43]
v_bfe_u32 v1, v0, 0, 6
v_mfma_f32_16x16x32_bf16 v[48:51], a[160:163], a[48:51], v[48:51]
v_mfma_f32_16x16x32_bf16 v[48:51], a[164:167], a[52:55], v[48:51]
buffer_atomic_add v19, v29, s[48:51], s55 offen sc1
v_mfma_f32_16x16x32_bf16 v[56:59], a[160:163], a[56:59], v[56:59]
v_mfma_f32_16x16x32_bf16 v[56:59], a[164:167], a[60:63], v[56:59]
ds_read_b128 a[196:199], v18 offset:16384
v_mfma_f32_16x16x32_bf16 v[64:67], a[160:163], a[64:67], v[64:67]
v_mfma_f32_16x16x32_bf16 v[64:67], a[164:167], a[68:71], v[64:67]
v_cmp_gt_u32 vcc, 10, v1
v_mfma_f32_16x16x32_bf16 v[72:75], a[160:163], a[72:75], v[72:75]
v_mfma_f32_16x16x32_bf16 v[72:75], a[164:167], a[76:79], v[72:75]
s_add_u32 m0, s28, 49152
s_xor_b32 s29, s26, 1048960
buffer_load_dwordx4 v5, s[8:11], s29 offen offset:0 lds
v_mfma_f32_16x16x32_bf16 v[80:83], a[160:163], a[80:83], v[80:83]
v_mfma_f32_16x16x32_bf16 v[80:83], a[164:167], a[84:87], v[80:83]
ds_read_b128 a[200:203], v17 offset:18432
v_mfma_f32_16x16x32_bf16 v[88:91], a[160:163], a[88:91], v[88:91]
v_mfma_f32_16x16x32_bf16 v[88:91], a[164:167], a[92:95], v[88:91]
v_mul_u32_u24 v1, 3456, v1
v_mfma_f32_16x16x32_bf16 v[36:39], a[168:171], a[32:35], v[36:39]
v_mfma_f32_16x16x32_bf16 v[36:39], a[172:175], a[36:39], v[36:39]
buffer_load_dwordx4 v6, s[8:11], s29 offen offset:1024 lds
v_mfma_f32_16x16x32_bf16 v[44:47], a[168:171], a[40:43], v[44:47]
v_mfma_f32_16x16x32_bf16 v[44:47], a[172:175], a[44:47], v[44:47]
ds_read_b128 a[204:207], v18 offset:18432
v_mfma_f32_16x16x32_bf16 v[52:55], a[168:171], a[48:51], v[52:55]
v_mfma_f32_16x16x32_bf16 v[52:55], a[172:175], a[52:55], v[52:55]
v_mov_b32 v2, 1073741824
v_mfma_f32_16x16x32_bf16 v[60:63], a[168:171], a[56:59], v[60:63]
v_mfma_f32_16x16x32_bf16 v[60:63], a[172:175], a[60:63], v[60:63]
ds_read_b128 a[208:211], v17 offset:20480
v_mfma_f32_16x16x32_bf16 v[68:71], a[168:171], a[64:67], v[68:71]
v_mfma_f32_16x16x32_bf16 v[68:71], a[172:175], a[68:71], v[68:71]
buffer_load_dwordx4 v7, s[8:11], s29 offen offset:2048 lds
v_mfma_f32_16x16x32_bf16 v[76:79], a[168:171], a[72:75], v[76:79]
v_mfma_f32_16x16x32_bf16 v[76:79], a[172:175], a[76:79], v[76:79]
s_mov_b32 s34, s22
v_mfma_f32_16x16x32_bf16 v[84:87], a[168:171], a[80:83], v[84:87]
v_mfma_f32_16x16x32_bf16 v[84:87], a[172:175], a[84:87], v[84:87]
ds_read_b128 a[212:215], v18 offset:20480
v_mfma_f32_16x16x32_bf16 v[92:95], a[168:171], a[88:91], v[92:95]
buffer_load_dwordx4 v8, s[8:11], s29 offen offset:3072 lds
v_mfma_f32_16x16x32_bf16 v[92:95], a[172:175], a[92:95], v[92:95]
v_mfma_f32_16x16x32_bf16 v[96:99], a[176:179], a[32:35], v[96:99]
ds_read_b128 a[216:219], v17 offset:22528
v_mfma_f32_16x16x32_bf16 v[96:99], a[180:183], a[36:39], v[96:99]
v_mfma_f32_16x16x32_bf16 v[104:107], a[176:179], a[40:43], v[104:107]
s_lshl2_add_u32 s34, s34, s20
v_mfma_f32_16x16x32_bf16 v[104:107], a[180:183], a[44:47], v[104:107]
v_mfma_f32_16x16x32_bf16 v[112:115], a[176:179], a[48:51], v[112:115]
s_add_u32 m0, s25, 98304
s_xor_b32 s29, s27, 2097152
buffer_load_dwordx4 v9, s[12:15], s29 offen offset:0 nt lds
v_mfma_f32_16x16x32_bf16 v[112:115], a[180:183], a[52:55], v[112:115]
v_mfma_f32_16x16x32_bf16 v[120:123], a[176:179], a[56:59], v[120:123]
ds_read_b128 a[220:223], v18 offset:22528
v_mfma_f32_16x16x32_bf16 v[120:123], a[180:183], a[60:63], v[120:123]
v_mfma_f32_16x16x32_bf16 v[128:131], a[176:179], a[64:67], v[128:131]
v_cndmask_b32 v1, v2, v1, vcc
v_mfma_f32_16x16x32_bf16 v[128:131], a[180:183], a[68:71], v[128:131]
v_mfma_f32_16x16x32_bf16 v[136:139], a[176:179], a[72:75], v[136:139]
v_mfma_f32_16x16x32_bf16 v[136:139], a[180:183], a[76:79], v[136:139]
v_mfma_f32_16x16x32_bf16 v[144:147], a[176:179], a[80:83], v[144:147]
buffer_load_dwordx4 v10, s[12:15], s29 offen offset:1024 nt lds
v_mfma_f32_16x16x32_bf16 v[144:147], a[180:183], a[84:87], v[144:147]
v_mfma_f32_16x16x32_bf16 v[152:155], a[176:179], a[88:91], v[152:155]
s_mul_i32 s34, s34, 34560
v_mfma_f32_16x16x32_bf16 v[152:155], a[180:183], a[92:95], v[152:155]
v_mfma_f32_16x16x32_bf16 v[100:103], a[184:187], a[32:35], v[100:103]
v_mfma_f32_16x16x32_bf16 v[100:103], a[188:191], a[36:39], v[100:103]
v_mfma_f32_16x16x32_bf16 v[108:111], a[184:187], a[40:43], v[108:111]
buffer_load_dwordx4 v11, s[12:15], s29 offen offset:2048 nt lds
v_mfma_f32_16x16x32_bf16 v[108:111], a[188:191], a[44:47], v[108:111]
v_mfma_f32_16x16x32_bf16 v[116:119], a[184:187], a[48:51], v[116:119]
s_add_u32 s34, s34, 0
v_mfma_f32_16x16x32_bf16 v[116:119], a[188:191], a[52:55], v[116:119]
v_mfma_f32_16x16x32_bf16 v[124:127], a[184:187], a[56:59], v[124:127]
v_mfma_f32_16x16x32_bf16 v[124:127], a[188:191], a[60:63], v[124:127]
v_mfma_f32_16x16x32_bf16 v[132:135], a[184:187], a[64:67], v[132:135]
buffer_load_dwordx4 v12, s[12:15], s29 offen offset:3072 nt lds
v_mfma_f32_16x16x32_bf16 v[132:135], a[188:191], a[68:71], v[132:135]
v_mfma_f32_16x16x32_bf16 v[140:143], a[184:187], a[72:75], v[140:143]
buffer_load_dword a243, v1, s[40:43], s34 offen
v_mfma_f32_16x16x32_bf16 v[140:143], a[188:191], a[76:79], v[140:143]
v_mfma_f32_16x16x32_bf16 v[148:151], a[184:187], a[80:83], v[148:151]
v_mfma_f32_16x16x32_bf16 v[148:151], a[188:191], a[84:87], v[148:151]
v_mfma_f32_16x16x32_bf16 v[156:159], a[184:187], a[88:91], v[156:159]
v_mfma_f32_16x16x32_bf16 v[156:159], a[188:191], a[92:95], v[156:159]
s_waitcnt vmcnt(11) lgkmcnt(0)
s_barrier
v_mfma_f32_16x16x32_bf16 v[160:163], a[192:195], a[32:35], v[160:163]
ds_read_b128 a[160:163], v17 offset:32768
v_mfma_f32_16x16x32_bf16 v[160:163], a[196:199], a[36:39], v[160:163]
ds_read_b128 a[164:167], v18 offset:32768
v_mfma_f32_16x16x32_bf16 v[168:171], a[192:195], a[40:43], v[168:171]
v_bfe_u32 v1, v0, 1, 5
v_mfma_f32_16x16x32_bf16 v[168:171], a[196:199], a[44:47], v[168:171]
s_add_u32 m0, s25, 102400
s_xor_b32 s29, s27, 2097152
buffer_load_dwordx4 v13, s[12:15], s29 offen offset:0 nt lds
v_mfma_f32_16x16x32_bf16 v[176:179], a[192:195], a[48:51], v[176:179]
ds_read_b128 a[168:171], v17 offset:34816
v_mfma_f32_16x16x32_bf16 v[176:179], a[196:199], a[52:55], v[176:179]
ds_read_b128 a[172:175], v18 offset:34816
v_mfma_f32_16x16x32_bf16 v[184:187], a[192:195], a[56:59], v[184:187]
ds_read_b128 a[176:179], v17 offset:36864
v_mfma_f32_16x16x32_bf16 v[184:187], a[196:199], a[60:63], v[184:187]
v_cmp_gt_u32 vcc, 5, v1
v_mfma_f32_16x16x32_bf16 v[192:195], a[192:195], a[64:67], v[192:195]
ds_read_b128 a[180:183], v18 offset:36864
v_mfma_f32_16x16x32_bf16 v[192:195], a[196:199], a[68:71], v[192:195]
ds_read_b128 a[184:187], v17 offset:38912
v_mfma_f32_16x16x32_bf16 v[200:203], a[192:195], a[72:75], v[200:203]
buffer_load_dwordx4 v14, s[12:15], s29 offen offset:1024 nt lds
v_mfma_f32_16x16x32_bf16 v[200:203], a[196:199], a[76:79], v[200:203]
ds_read_b128 a[188:191], v18 offset:38912
v_mfma_f32_16x16x32_bf16 v[208:211], a[192:195], a[80:83], v[208:211]
v_mul_u32_u24 v1, 8192, v1
v_mfma_f32_16x16x32_bf16 v[208:211], a[196:199], a[84:87], v[208:211]
ds_read_b64_tr_b16 a[96:97], v21 offset:0
v_mfma_f32_16x16x32_bf16 v[216:219], a[192:195], a[88:91], v[216:219]
ds_read_b64_tr_b16 a[98:99], v21 offset:2048
v_mfma_f32_16x16x32_bf16 v[216:219], a[196:199], a[92:95], v[216:219]
ds_read_b64_tr_b16 a[100:101], v21 offset:16384
v_mfma_f32_16x16x32_bf16 v[164:167], a[200:203], a[32:35], v[164:167]
ds_read_b64_tr_b16 a[102:103], v21 offset:18432
v_mfma_f32_16x16x32_bf16 v[164:167], a[204:207], a[36:39], v[164:167]
v_and_b32 v2, 1, v0
v_mfma_f32_16x16x32_bf16 v[172:175], a[200:203], a[40:43], v[172:175]
buffer_load_dwordx4 v15, s[12:15], s29 offen offset:2048 nt lds
v_mfma_f32_16x16x32_bf16 v[172:175], a[204:207], a[44:47], v[172:175]
ds_read_b64_tr_b16 a[104:105], v22 offset:0
v_mfma_f32_16x16x32_bf16 v[180:183], a[200:203], a[48:51], v[180:183]
ds_read_b64_tr_b16 a[106:107], v22 offset:2048
v_mfma_f32_16x16x32_bf16 v[180:183], a[204:207], a[52:55], v[180:183]
ds_read_b64_tr_b16 a[108:109], v22 offset:16384
v_mfma_f32_16x16x32_bf16 v[188:191], a[200:203], a[56:59], v[188:191]
v_lshl_add_u32 v1, v2, 7, v1
v_mfma_f32_16x16x32_bf16 v[188:191], a[204:207], a[60:63], v[188:191]
ds_read_b64_tr_b16 a[110:111], v22 offset:18432
v_mfma_f32_16x16x32_bf16 v[196:199], a[200:203], a[64:67], v[196:199]
ds_read_b64_tr_b16 a[112:113], v23 offset:0
v_mfma_f32_16x16x32_bf16 v[196:199], a[204:207], a[68:71], v[196:199]
buffer_load_dwordx4 v16, s[12:15], s29 offen offset:3072 nt lds
v_mfma_f32_16x16x32_bf16 v[204:207], a[200:203], a[72:75], v[204:207]
ds_read_b64_tr_b16 a[114:115], v23 offset:2048
v_mfma_f32_16x16x32_bf16 v[204:207], a[204:207], a[76:79], v[204:207]
v_mov_b32 v2, 1073741824
v_mfma_f32_16x16x32_bf16 v[212:215], a[200:203], a[80:83], v[212:215]
ds_read_b64_tr_b16 a[116:117], v23 offset:16384
v_mfma_f32_16x16x32_bf16 v[212:215], a[204:207], a[84:87], v[212:215]
ds_read_b64_tr_b16 a[118:119], v23 offset:18432
v_mfma_f32_16x16x32_bf16 v[220:223], a[200:203], a[88:91], v[220:223]
ds_read_b64_tr_b16 a[120:121], v24 offset:0
v_mfma_f32_16x16x32_bf16 v[220:223], a[204:207], a[92:95], v[220:223]
ds_read_b64_tr_b16 a[122:123], v24 offset:2048
v_mfma_f32_16x16x32_bf16 v[224:227], a[208:211], a[32:35], v[224:227]
s_mov_b32 s34, s22
v_mfma_f32_16x16x32_bf16 v[224:227], a[212:215], a[36:39], v[224:227]
s_add_u32 m0, s28, 0
s_xor_b32 s29, s26, 512
buffer_load_dwordx4 v5, s[8:11], s29 offen offset:0 lds
v_mfma_f32_16x16x32_bf16 v[232:235], a[208:211], a[40:43], v[232:235]
ds_read_b64_tr_b16 a[124:125], v24 offset:16384
v_mfma_f32_16x16x32_bf16 v[232:235], a[212:215], a[44:47], v[232:235]
ds_read_b64_tr_b16 a[126:127], v24 offset:18432
v_mfma_f32_16x16x32_bf16 v[240:243], a[208:211], a[48:51], v[240:243]
ds_read_b64_tr_b16 a[128:129], v25 offset:0
v_mfma_f32_16x16x32_bf16 v[240:243], a[212:215], a[52:55], v[240:243]
s_lshl2_add_u32 s34, s34, s20
v_mfma_f32_16x16x32_bf16 v[248:251], a[208:211], a[56:59], v[248:251]
ds_read_b64_tr_b16 a[130:131], v25 offset:2048
v_mfma_f32_16x16x32_bf16 v[248:251], a[212:215], a[60:63], v[248:251]
ds_read_b64_tr_b16 a[132:133], v25 offset:16384
v_mfma_f32_16x16x32_bf16 a[0:3], a[208:211], a[64:67], a[0:3]
buffer_load_dwordx4 v6, s[8:11], s29 offen offset:1024 lds
v_mfma_f32_16x16x32_bf16 a[0:3], a[212:215], a[68:71], a[0:3]
ds_read_b64_tr_b16 a[134:135], v25 offset:18432
v_mfma_f32_16x16x32_bf16 a[8:11], a[208:211], a[72:75], a[8:11]
v_cndmask_b32 v1, v2, v1, vcc
v_mfma_f32_16x16x32_bf16 a[8:11], a[212:215], a[76:79], a[8:11]
ds_read_b64_tr_b16 a[136:137], v26 offset:0
v_mfma_f32_16x16x32_bf16 a[16:19], a[208:211], a[80:83], a[16:19]
ds_read_b64_tr_b16 a[138:139], v26 offset:2048
v_mfma_f32_16x16x32_bf16 a[16:19], a[212:215], a[84:87], a[16:19]
ds_read_b64_tr_b16 a[140:141], v26 offset:16384
v_mfma_f32_16x16x32_bf16 a[24:27], a[208:211], a[88:91], a[24:27]
ds_read_b64_tr_b16 a[142:143], v26 offset:18432
v_mfma_f32_16x16x32_bf16 a[24:27], a[212:215], a[92:95], a[24:27]
s_mul_i32 s34, s34, 40960
v_mfma_f32_16x16x32_bf16 v[228:231], a[216:219], a[32:35], v[228:231]
buffer_load_dwordx4 v7, s[8:11], s29 offen offset:2048 lds
v_mfma_f32_16x16x32_bf16 v[228:231], a[220:223], a[36:39], v[228:231]
ds_read_b64_tr_b16 a[144:145], v27 offset:0
v_mfma_f32_16x16x32_bf16 v[236:239], a[216:219], a[40:43], v[236:239]
ds_read_b64_tr_b16 a[146:147], v27 offset:2048
v_mfma_f32_16x16x32_bf16 v[236:239], a[220:223], a[44:47], v[236:239]
ds_read_b64_tr_b16 a[148:149], v27 offset:16384
v_mfma_f32_16x16x32_bf16 v[244:247], a[216:219], a[48:51], v[244:247]
s_add_u32 s34, s34, 1310720
v_mfma_f32_16x16x32_bf16 v[244:247], a[220:223], a[52:55], v[244:247]
ds_read_b64_tr_b16 a[150:151], v27 offset:18432
v_mfma_f32_16x16x32_bf16 v[252:255], a[216:219], a[56:59], v[252:255]
ds_read_b64_tr_b16 a[152:153], v28 offset:0
v_mfma_f32_16x16x32_bf16 v[252:255], a[220:223], a[60:63], v[252:255]
buffer_load_dwordx4 v8, s[8:11], s29 offen offset:3072 lds
v_mfma_f32_16x16x32_bf16 a[4:7], a[216:219], a[64:67], a[4:7]
ds_read_b64_tr_b16 a[154:155], v28 offset:2048
v_mfma_f32_16x16x32_bf16 a[4:7], a[220:223], a[68:71], a[4:7]
buffer_load_dword a244, v1, s[44:47], s34 offen
v_mfma_f32_16x16x32_bf16 a[12:15], a[216:219], a[72:75], a[12:15]
ds_read_b64_tr_b16 a[156:157], v28 offset:16384
v_mfma_f32_16x16x32_bf16 a[12:15], a[220:223], a[76:79], a[12:15]
ds_read_b64_tr_b16 a[158:159], v28 offset:18432
v_mfma_f32_16x16x32_bf16 a[20:23], a[216:219], a[80:83], a[20:23]
v_mfma_f32_16x16x32_bf16 a[20:23], a[220:223], a[84:87], a[20:23]
v_mfma_f32_16x16x32_bf16 a[28:31], a[216:219], a[88:91], a[28:31]
v_mfma_f32_16x16x32_bf16 a[28:31], a[220:223], a[92:95], a[28:31]
s_waitcnt vmcnt(14) lgkmcnt(0)
s_barrier
v_mfma_f32_16x16x32_bf16 v[32:35], a[160:163], a[96:99], v[32:35]
v_mfma_f32_16x16x32_bf16 v[32:35], a[164:167], a[100:103], v[32:35]
ds_read_b128 a[192:195], v17 offset:49152
v_mfma_f32_16x16x32_bf16 v[40:43], a[160:163], a[104:107], v[40:43]
v_mfma_f32_16x16x32_bf16 v[40:43], a[164:167], a[108:111], v[40:43]
v_bfe_u32 v1, v0, 1, 5
v_mfma_f32_16x16x32_bf16 v[48:51], a[160:163], a[112:115], v[48:51]
v_mfma_f32_16x16x32_bf16 v[48:51], a[164:167], a[116:119], v[48:51]
s_add_u32 m0, s28, 16384
s_xor_b32 s29, s26, 1049088
buffer_load_dwordx4 v5, s[8:11], s29 offen offset:0 lds
v_mfma_f32_16x16x32_bf16 v[56:59], a[160:163], a[120:123], v[56:59]
v_mfma_f32_16x16x32_bf16 v[56:59], a[164:167], a[124:127], v[56:59]
ds_read_b128 a[196:199], v18 offset:49152
v_mfma_f32_16x16x32_bf16 v[64:67], a[160:163], a[128:131], v[64:67]
v_mfma_f32_16x16x32_bf16 v[64:67], a[164:167], a[132:135], v[64:67]
v_cmp_gt_u32 vcc, 5, v1
v_mfma_f32_16x16x32_bf16 v[72:75], a[160:163], a[136:139], v[72:75]
v_mfma_f32_16x16x32_bf16 v[72:75], a[164:167], a[140:143], v[72:75]
buffer_load_dwordx4 v6, s[8:11], s29 offen offset:1024 lds
v_mfma_f32_16x16x32_bf16 v[80:83], a[160:163], a[144:147], v[80:83]
v_mfma_f32_16x16x32_bf16 v[80:83], a[164:167], a[148:151], v[80:83]
ds_read_b128 a[200:203], v17 offset:51200
v_mfma_f32_16x16x32_bf16 v[88:91], a[160:163], a[152:155], v[88:91]
v_mul_u32_u24 v1, 8192, v1
v_mfma_f32_16x16x32_bf16 v[88:91], a[164:167], a[156:159], v[88:91]
v_mfma_f32_16x16x32_bf16 v[36:39], a[168:171], a[96:99], v[36:39]
ds_read_b128 a[204:207], v18 offset:51200
v_mfma_f32_16x16x32_bf16 v[36:39], a[172:175], a[100:103], v[36:39]
v_mfma_f32_16x16x32_bf16 v[44:47], a[168:171], a[104:107], v[44:47]
v_and_b32 v2, 1, v0
v_mfma_f32_16x16x32_bf16 v[44:47], a[172:175], a[108:111], v[44:47]
v_mfma_f32_16x16x32_bf16 v[52:55], a[168:171], a[112:115], v[52:55]
buffer_load_dwordx4 v7, s[8:11], s29 offen offset:2048 lds
v_mfma_f32_16x16x32_bf16 v[52:55], a[172:175], a[116:119], v[52:55]
v_mfma_f32_16x16x32_bf16 v[60:63], a[168:171], a[120:123], v[60:63]
ds_read_b128 a[208:211], v17 offset:53248
v_mfma_f32_16x16x32_bf16 v[60:63], a[172:175], a[124:127], v[60:63]
v_mfma_f32_16x16x32_bf16 v[68:71], a[168:171], a[128:131], v[68:71]
v_lshl_add_u32 v1, v2, 7, v1
v_mfma_f32_16x16x32_bf16 v[68:71], a[172:175], a[132:135], v[68:71]
v_mfma_f32_16x16x32_bf16 v[76:79], a[168:171], a[136:139], v[76:79]
buffer_load_dwordx4 v8, s[8:11], s29 offen offset:3072 lds
v_mfma_f32_16x16x32_bf16 v[76:79], a[172:175], a[140:143], v[76:79]
v_mfma_f32_16x16x32_bf16 v[84:87], a[168:171], a[144:147], v[84:87]
ds_read_b128 a[212:215], v18 offset:53248
v_mfma_f32_16x16x32_bf16 v[84:87], a[172:175], a[148:151], v[84:87]
v_mov_b32 v2, 1073741824
v_mfma_f32_16x16x32_bf16 v[92:95], a[168:171], a[152:155], v[92:95]
v_mfma_f32_16x16x32_bf16 v[92:95], a[172:175], a[156:159], v[92:95]
ds_read_b128 a[216:219], v17 offset:55296
v_mfma_f32_16x16x32_bf16 v[96:99], a[176:179], a[96:99], v[96:99]
s_branch kf_kernel_pl6
kf_kernel_pd6:
s_branch kf_kernel_pd10
kf_kernel_pl6:
v_mfma_f32_16x16x32_bf16 v[96:99], a[180:183], a[100:103], v[96:99]
s_mov_b32 s34, s22
v_mfma_f32_16x16x32_bf16 v[104:107], a[176:179], a[104:107], v[104:107]
v_mfma_f32_16x16x32_bf16 v[104:107], a[180:183], a[108:111], v[104:107]
s_add_u32 m0, s25, 65536
s_xor_b32 s29, s27, 2621440
buffer_load_dwordx4 v9, s[12:15], s29 offen offset:0 nt lds
v_mfma_f32_16x16x32_bf16 v[112:115], a[176:179], a[112:115], v[112:115]
v_mfma_f32_16x16x32_bf16 v[112:115], a[180:183], a[116:119], v[112:115]
ds_read_b128 a[220:223], v18 offset:55296
v_mfma_f32_16x16x32_bf16 v[120:123], a[176:179], a[120:123], v[120:123]
v_mfma_f32_16x16x32_bf16 v[120:123], a[180:183], a[124:127], v[120:123]
s_lshl2_add_u32 s34, s34, s20
v_mfma_f32_16x16x32_bf16 v[128:131], a[176:179], a[128:131], v[128:131]
v_mfma_f32_16x16x32_bf16 v[128:131], a[180:183], a[132:135], v[128:131]
buffer_load_dwordx4 v10, s[12:15], s29 offen offset:1024 nt lds
v_mfma_f32_16x16x32_bf16 v[136:139], a[176:179], a[136:139], v[136:139]
v_mfma_f32_16x16x32_bf16 v[136:139], a[180:183], a[140:143], v[136:139]
v_mfma_f32_16x16x32_bf16 v[144:147], a[176:179], a[144:147], v[144:147]
v_cndmask_b32 v1, v2, v1, vcc
v_mfma_f32_16x16x32_bf16 v[144:147], a[180:183], a[148:151], v[144:147]
v_mfma_f32_16x16x32_bf16 v[152:155], a[176:179], a[152:155], v[152:155]
v_mfma_f32_16x16x32_bf16 v[152:155], a[180:183], a[156:159], v[152:155]
v_mfma_f32_16x16x32_bf16 v[100:103], a[184:187], a[96:99], v[100:103]
s_mul_i32 s34, s34, 40960
v_mfma_f32_16x16x32_bf16 v[100:103], a[188:191], a[100:103], v[100:103]
v_mfma_f32_16x16x32_bf16 v[108:111], a[184:187], a[104:107], v[108:111]
buffer_load_dwordx4 v11, s[12:15], s29 offen offset:2048 nt lds
v_mfma_f32_16x16x32_bf16 v[108:111], a[188:191], a[108:111], v[108:111]
v_mfma_f32_16x16x32_bf16 v[116:119], a[184:187], a[112:115], v[116:119]
v_mfma_f32_16x16x32_bf16 v[116:119], a[188:191], a[116:119], v[116:119]
v_mfma_f32_16x16x32_bf16 v[124:127], a[184:187], a[120:123], v[124:127]
s_add_u32 s34, s34, 2621440
v_mfma_f32_16x16x32_bf16 v[124:127], a[188:191], a[124:127], v[124:127]
v_mfma_f32_16x16x32_bf16 v[132:135], a[184:187], a[128:131], v[132:135]
buffer_load_dwordx4 v12, s[12:15], s29 offen offset:3072 nt lds
v_mfma_f32_16x16x32_bf16 v[132:135], a[188:191], a[132:135], v[132:135]
v_mfma_f32_16x16x32_bf16 v[140:143], a[184:187], a[136:139], v[140:143]
v_mfma_f32_16x16x32_bf16 v[140:143], a[188:191], a[140:143], v[140:143]
buffer_load_dword a245, v1, s[44:47], s34 offen
v_mfma_f32_16x16x32_bf16 v[148:151], a[184:187], a[144:147], v[148:151]
v_mfma_f32_16x16x32_bf16 v[148:151], a[188:191], a[148:151], v[148:151]
v_mfma_f32_16x16x32_bf16 v[156:159], a[184:187], a[152:155], v[156:159]
v_mfma_f32_16x16x32_bf16 v[156:159], a[188:191], a[156:159], v[156:159]
s_waitcnt vmcnt(10) lgkmcnt(0)
s_barrier
v_mfma_f32_16x16x32_bf16 v[160:163], a[192:195], a[96:99], v[160:163]
v_mfma_f32_16x16x32_bf16 v[160:163], a[196:199], a[100:103], v[160:163]
ds_read_b128 a[160:163], v17 offset:0
v_mfma_f32_16x16x32_bf16 v[168:171], a[192:195], a[104:107], v[168:171]
ds_read_b128 a[164:167], v18 offset:0
v_mfma_f32_16x16x32_bf16 v[168:171], a[196:199], a[108:111], v[168:171]
v_bfe_u32 v1, v0, 0, 6
v_mfma_f32_16x16x32_bf16 v[176:179], a[192:195], a[112:115], v[176:179]
s_add_u32 m0, s25, 69632
s_xor_b32 s29, s27, 2621440
buffer_load_dwordx4 v13, s[12:15], s29 offen offset:0 nt lds
v_mfma_f32_16x16x32_bf16 v[176:179], a[196:199], a[116:119], v[176:179]
ds_read_b128 a[168:171], v17 offset:2048
v_mfma_f32_16x16x32_bf16 v[184:187], a[192:195], a[120:123], v[184:187]
ds_read_b128 a[172:175], v18 offset:2048
v_mfma_f32_16x16x32_bf16 v[184:187], a[196:199], a[124:127], v[184:187]
ds_read_b128 a[176:179], v17 offset:4096
v_mfma_f32_16x16x32_bf16 v[192:195], a[192:195], a[128:131], v[192:195]
ds_read_b128 a[180:183], v18 offset:4096
v_mfma_f32_16x16x32_bf16 v[192:195], a[196:199], a[132:135], v[192:195]
v_cmp_gt_u32 vcc, 10, v1
v_mfma_f32_16x16x32_bf16 v[200:203], a[192:195], a[136:139], v[200:203]
ds_read_b128 a[184:187], v17 offset:6144
v_mfma_f32_16x16x32_bf16 v[200:203], a[196:199], a[140:143], v[200:203]
buffer_load_dwordx4 v14, s[12:15], s29 offen offset:1024 nt lds
v_mfma_f32_16x16x32_bf16 v[208:211], a[192:195], a[144:147], v[208:211]
ds_read_b128 a[188:191], v18 offset:6144
v_mfma_f32_16x16x32_bf16 v[208:211], a[196:199], a[148:151], v[208:211]
ds_read_b64_tr_b16 a[32:33], v21 offset:32768
v_mfma_f32_16x16x32_bf16 v[216:219], a[192:195], a[152:155], v[216:219]
ds_read_b64_tr_b16 a[34:35], v21 offset:34816
v_mfma_f32_16x16x32_bf16 v[216:219], a[196:199], a[156:159], v[216:219]
v_mul_u32_u24 v1, 3456, v1
v_mfma_f32_16x16x32_bf16 v[164:167], a[200:203], a[96:99], v[164:167]
ds_read_b64_tr_b16 a[36:37], v21 offset:49152
v_mfma_f32_16x16x32_bf16 v[164:167], a[204:207], a[100:103], v[164:167]
ds_read_b64_tr_b16 a[38:39], v21 offset:51200
v_mfma_f32_16x16x32_bf16 v[172:175], a[200:203], a[104:107], v[172:175]
buffer_load_dwordx4 v15, s[12:15], s29 offen offset:2048 nt lds
v_mfma_f32_16x16x32_bf16 v[172:175], a[204:207], a[108:111], v[172:175]
ds_read_b64_tr_b16 a[40:41], v22 offset:32768
v_mfma_f32_16x16x32_bf16 v[180:183], a[200:203], a[112:115], v[180:183]
ds_read_b64_tr_b16 a[42:43], v22 offset:34816
v_mfma_f32_16x16x32_bf16 v[180:183], a[204:207], a[116:119], v[180:183]
v_mov_b32 v2, 1073741824
v_mfma_f32_16x16x32_bf16 v[188:191], a[200:203], a[120:123], v[188:191]
ds_read_b64_tr_b16 a[44:45], v22 offset:49152
v_mfma_f32_16x16x32_bf16 v[188:191], a[204:207], a[124:127], v[188:191]
ds_read_b64_tr_b16 a[46:47], v22 offset:51200
v_mfma_f32_16x16x32_bf16 v[196:199], a[200:203], a[128:131], v[196:199]
ds_read_b64_tr_b16 a[48:49], v23 offset:32768
v_mfma_f32_16x16x32_bf16 v[196:199], a[204:207], a[132:135], v[196:199]
buffer_load_dwordx4 v16, s[12:15], s29 offen offset:3072 nt lds
v_mfma_f32_16x16x32_bf16 v[204:207], a[200:203], a[136:139], v[204:207]
ds_read_b64_tr_b16 a[50:51], v23 offset:34816
v_mfma_f32_16x16x32_bf16 v[204:207], a[204:207], a[140:143], v[204:207]
s_mov_b32 s34, s22
v_mfma_f32_16x16x32_bf16 v[212:215], a[200:203], a[144:147], v[212:215]
ds_read_b64_tr_b16 a[52:53], v23 offset:49152
v_mfma_f32_16x16x32_bf16 v[212:215], a[204:207], a[148:151], v[212:215]
ds_read_b64_tr_b16 a[54:55], v23 offset:51200
v_mfma_f32_16x16x32_bf16 v[220:223], a[200:203], a[152:155], v[220:223]
v_mfma_f32_16x16x32_bf16 v[220:223], a[204:207], a[156:159], v[220:223]
ds_read_b64_tr_b16 a[56:57], v24 offset:32768
v_mfma_f32_16x16x32_bf16 v[224:227], a[208:211], a[96:99], v[224:227]
ds_read_b64_tr_b16 a[58:59], v24 offset:34816
v_mfma_f32_16x16x32_bf16 v[224:227], a[212:215], a[100:103], v[224:227]
s_lshl2_add_u32 s34, s34, s20
v_mfma_f32_16x16x32_bf16 v[232:235], a[208:211], a[104:107], v[232:235]
s_add_u32 m0, s28, 32768
s_xor_b32 s29, s26, 640
buffer_load_dwordx4 v5, s[8:11], s29 offen offset:0 lds
v_mfma_f32_16x16x32_bf16 v[232:235], a[212:215], a[108:111], v[232:235]
ds_read_b64_tr_b16 a[60:61], v24 offset:49152
v_mfma_f32_16x16x32_bf16 v[240:243], a[208:211], a[112:115], v[240:243]
ds_read_b64_tr_b16 a[62:63], v24 offset:51200
v_mfma_f32_16x16x32_bf16 v[240:243], a[212:215], a[116:119], v[240:243]
ds_read_b64_tr_b16 a[64:65], v25 offset:32768
v_mfma_f32_16x16x32_bf16 v[248:251], a[208:211], a[120:123], v[248:251]
ds_read_b64_tr_b16 a[66:67], v25 offset:34816
v_mfma_f32_16x16x32_bf16 v[248:251], a[212:215], a[124:127], v[248:251]
v_cndmask_b32 v1, v2, v1, vcc
v_mfma_f32_16x16x32_bf16 a[0:3], a[208:211], a[128:131], a[0:3]
ds_read_b64_tr_b16 a[68:69], v25 offset:49152
v_mfma_f32_16x16x32_bf16 a[0:3], a[212:215], a[132:135], a[0:3]
buffer_load_dwordx4 v6, s[8:11], s29 offen offset:1024 lds
v_mfma_f32_16x16x32_bf16 a[8:11], a[208:211], a[136:139], a[8:11]
ds_read_b64_tr_b16 a[70:71], v25 offset:51200
v_mfma_f32_16x16x32_bf16 a[8:11], a[212:215], a[140:143], a[8:11]
ds_read_b64_tr_b16 a[72:73], v26 offset:32768
v_mfma_f32_16x16x32_bf16 a[16:19], a[208:211], a[144:147], a[16:19]
ds_read_b64_tr_b16 a[74:75], v26 offset:34816
v_mfma_f32_16x16x32_bf16 a[16:19], a[212:215], a[148:151], a[16:19]
s_mul_i32 s34, s34, 34560
v_mfma_f32_16x16x32_bf16 a[24:27], a[208:211], a[152:155], a[24:27]
ds_read_b64_tr_b16 a[76:77], v26 offset:49152
v_mfma_f32_16x16x32_bf16 a[24:27], a[212:215], a[156:159], a[24:27]
ds_read_b64_tr_b16 a[78:79], v26 offset:51200
v_mfma_f32_16x16x32_bf16 v[228:231], a[216:219], a[96:99], v[228:231]
buffer_load_dwordx4 v7, s[8:11], s29 offen offset:2048 lds
v_mfma_f32_16x16x32_bf16 v[228:231], a[220:223], a[100:103], v[228:231]
ds_read_b64_tr_b16 a[80:81], v27 offset:32768
v_mfma_f32_16x16x32_bf16 v[236:239], a[216:219], a[104:107], v[236:239]
ds_read_b64_tr_b16 a[82:83], v27 offset:34816
v_mfma_f32_16x16x32_bf16 v[236:239], a[220:223], a[108:111], v[236:239]
s_add_u32 s34, s34, 1105920
v_mfma_f32_16x16x32_bf16 v[244:247], a[216:219], a[112:115], v[244:247]
ds_read_b64_tr_b16 a[84:85], v27 offset:49152
v_mfma_f32_16x16x32_bf16 v[244:247], a[220:223], a[116:119], v[244:247]
ds_read_b64_tr_b16 a[86:87], v27 offset:51200
v_mfma_f32_16x16x32_bf16 v[252:255], a[216:219], a[120:123], v[252:255]
ds_read_b64_tr_b16 a[88:89], v28 offset:32768
v_mfma_f32_16x16x32_bf16 v[252:255], a[220:223], a[124:127], v[252:255]
buffer_load_dwordx4 v8, s[8:11], s29 offen offset:3072 lds
v_mfma_f32_16x16x32_bf16 a[4:7], a[216:219], a[128:131], a[4:7]
ds_read_b64_tr_b16 a[90:91], v28 offset:34816
v_mfma_f32_16x16x32_bf16 a[4:7], a[220:223], a[132:135], a[4:7]
buffer_load_dword a246, v1, s[40:43], s34 offen
v_mfma_f32_16x16x32_bf16 a[12:15], a[216:219], a[136:139], a[12:15]
ds_read_b64_tr_b16 a[92:93], v28 offset:49152
v_mfma_f32_16x16x32_bf16 a[12:15], a[220:223], a[140:143], a[12:15]
ds_read_b64_tr_b16 a[94:95], v28 offset:51200
v_mfma_f32_16x16x32_bf16 a[20:23], a[216:219], a[144:147], a[20:23]
v_mfma_f32_16x16x32_bf16 a[20:23], a[220:223], a[148:151], a[20:23]
v_mfma_f32_16x16x32_bf16 a[28:31], a[216:219], a[152:155], a[28:31]
v_mfma_f32_16x16x32_bf16 a[28:31], a[220:223], a[156:159], a[28:31]
s_waitcnt vmcnt(14) lgkmcnt(0)
s_barrier
v_mfma_f32_16x16x32_bf16 v[32:35], a[160:163], a[32:35], v[32:35]
v_mfma_f32_16x16x32_bf16 v[32:35], a[164:167], a[36:39], v[32:35]
ds_read_b128 a[192:195], v17 offset:16384
v_mfma_f32_16x16x32_bf16 v[40:43], a[160:163], a[40:43], v[40:43]
v_mfma_f32_16x16x32_bf16 v[40:43], a[164:167], a[44:47], v[40:43]
v_bfe_u32 v1, v0, 1, 5
v_mfma_f32_16x16x32_bf16 v[48:51], a[160:163], a[48:51], v[48:51]
v_mfma_f32_16x16x32_bf16 v[48:51], a[164:167], a[52:55], v[48:51]
s_add_u32 m0, s28, 49152
s_xor_b32 s29, s26, 1049216
buffer_load_dwordx4 v5, s[8:11], s29 offen offset:0 lds
v_mfma_f32_16x16x32_bf16 v[56:59], a[160:163], a[56:59], v[56:59]
v_mfma_f32_16x16x32_bf16 v[56:59], a[164:167], a[60:63], v[56:59]
ds_read_b128 a[196:199], v18 offset:16384
v_mfma_f32_16x16x32_bf16 v[64:67], a[160:163], a[64:67], v[64:67]
v_mfma_f32_16x16x32_bf16 v[64:67], a[164:167], a[68:71], v[64:67]
v_cmp_gt_u32 vcc, 5, v1
v_mfma_f32_16x16x32_bf16 v[72:75], a[160:163], a[72:75], v[72:75]
v_mfma_f32_16x16x32_bf16 v[72:75], a[164:167], a[76:79], v[72:75]
buffer_load_dwordx4 v6, s[8:11], s29 offen offset:1024 lds
v_mfma_f32_16x16x32_bf16 v[80:83], a[160:163], a[80:83], v[80:83]
v_mfma_f32_16x16x32_bf16 v[80:83], a[164:167], a[84:87], v[80:83]
ds_read_b128 a[200:203], v17 offset:18432
v_mfma_f32_16x16x32_bf16 v[88:91], a[160:163], a[88:91], v[88:91]
v_mul_u32_u24 v1, 8192, v1
v_mfma_f32_16x16x32_bf16 v[88:91], a[164:167], a[92:95], v[88:91]
v_mfma_f32_16x16x32_bf16 v[36:39], a[168:171], a[32:35], v[36:39]
ds_read_b128 a[204:207], v18 offset:18432
v_mfma_f32_16x16x32_bf16 v[36:39], a[172:175], a[36:39], v[36:39]
v_mfma_f32_16x16x32_bf16 v[44:47], a[168:171], a[40:43], v[44:47]
v_and_b32 v2, 1, v0
v_mfma_f32_16x16x32_bf16 v[44:47], a[172:175], a[44:47], v[44:47]
v_mfma_f32_16x16x32_bf16 v[52:55], a[168:171], a[48:51], v[52:55]
buffer_load_dwordx4 v7, s[8:11], s29 offen offset:2048 lds
v_mfma_f32_16x16x32_bf16 v[52:55], a[172:175], a[52:55], v[52:55]
v_mfma_f32_16x16x32_bf16 v[60:63], a[168:171], a[56:59], v[60:63]
ds_read_b128 a[208:211], v17 offset:20480
v_mfma_f32_16x16x32_bf16 v[60:63], a[172:175], a[60:63], v[60:63]
v_mfma_f32_16x16x32_bf16 v[68:71], a[168:171], a[64:67], v[68:71]
v_lshl_add_u32 v1, v2, 7, v1
v_mfma_f32_16x16x32_bf16 v[68:71], a[172:175], a[68:71], v[68:71]
v_mfma_f32_16x16x32_bf16 v[76:79], a[168:171], a[72:75], v[76:79]
buffer_load_dwordx4 v8, s[8:11], s29 offen offset:3072 lds
v_mfma_f32_16x16x32_bf16 v[76:79], a[172:175], a[76:79], v[76:79]
v_mfma_f32_16x16x32_bf16 v[84:87], a[168:171], a[80:83], v[84:87]
ds_read_b128 a[212:215], v18 offset:20480
v_mfma_f32_16x16x32_bf16 v[84:87], a[172:175], a[84:87], v[84:87]
v_mov_b32 v2, 1073741824
v_mfma_f32_16x16x32_bf16 v[92:95], a[168:171], a[88:91], v[92:95]
v_mfma_f32_16x16x32_bf16 v[92:95], a[172:175], a[92:95], v[92:95]
ds_read_b128 a[216:219], v17 offset:22528
v_mfma_f32_16x16x32_bf16 v[96:99], a[176:179], a[32:35], v[96:99]
v_mfma_f32_16x16x32_bf16 v[96:99], a[180:183], a[36:39], v[96:99]
s_mov_b32 s34, s22
v_mfma_f32_16x16x32_bf16 v[104:107], a[176:179], a[40:43], v[104:107]
v_mfma_f32_16x16x32_bf16 v[104:107], a[180:183], a[44:47], v[104:107]
s_add_u32 m0, s25, 98304
s_xor_b32 s29, s27, 3145728
buffer_load_dwordx4 v9, s[12:15], s29 offen offset:0 nt lds
v_mfma_f32_16x16x32_bf16 v[112:115], a[176:179], a[48:51], v[112:115]
v_mfma_f32_16x16x32_bf16 v[112:115], a[180:183], a[52:55], v[112:115]
ds_read_b128 a[220:223], v18 offset:22528
v_mfma_f32_16x16x32_bf16 v[120:123], a[176:179], a[56:59], v[120:123]
v_mfma_f32_16x16x32_bf16 v[120:123], a[180:183], a[60:63], v[120:123]
s_lshl2_add_u32 s34, s34, s20
v_mfma_f32_16x16x32_bf16 v[128:131], a[176:179], a[64:67], v[128:131]
v_mfma_f32_16x16x32_bf16 v[128:131], a[180:183], a[68:71], v[128:131]
buffer_load_dwordx4 v10, s[12:15], s29 offen offset:1024 nt lds
v_mfma_f32_16x16x32_bf16 v[136:139], a[176:179], a[72:75], v[136:139]
v_mfma_f32_16x16x32_bf16 v[136:139], a[180:183], a[76:79], v[136:139]
v_mfma_f32_16x16x32_bf16 v[144:147], a[176:179], a[80:83], v[144:147]
v_cndmask_b32 v1, v2, v1, vcc
v_mfma_f32_16x16x32_bf16 v[144:147], a[180:183], a[84:87], v[144:147]
v_mfma_f32_16x16x32_bf16 v[152:155], a[176:179], a[88:91], v[152:155]
v_mfma_f32_16x16x32_bf16 v[152:155], a[180:183], a[92:95], v[152:155]
v_mfma_f32_16x16x32_bf16 v[100:103], a[184:187], a[32:35], v[100:103]
s_mul_i32 s34, s34, 40960
v_mfma_f32_16x16x32_bf16 v[100:103], a[188:191], a[36:39], v[100:103]
v_mfma_f32_16x16x32_bf16 v[108:111], a[184:187], a[40:43], v[108:111]
buffer_load_dwordx4 v11, s[12:15], s29 offen offset:2048 nt lds
v_mfma_f32_16x16x32_bf16 v[108:111], a[188:191], a[44:47], v[108:111]
v_mfma_f32_16x16x32_bf16 v[116:119], a[184:187], a[48:51], v[116:119]
v_mfma_f32_16x16x32_bf16 v[116:119], a[188:191], a[52:55], v[116:119]
v_mfma_f32_16x16x32_bf16 v[124:127], a[184:187], a[56:59], v[124:127]
s_add_u32 s34, s34, 3932160
v_mfma_f32_16x16x32_bf16 v[124:127], a[188:191], a[60:63], v[124:127]
v_mfma_f32_16x16x32_bf16 v[132:135], a[184:187], a[64:67], v[132:135]
buffer_load_dwordx4 v12, s[12:15], s29 offen offset:3072 nt lds
v_mfma_f32_16x16x32_bf16 v[132:135], a[188:191], a[68:71], v[132:135]
v_mfma_f32_16x16x32_bf16 v[140:143], a[184:187], a[72:75], v[140:143]
v_mfma_f32_16x16x32_bf16 v[140:143], a[188:191], a[76:79], v[140:143]
buffer_load_dword a247, v1, s[44:47], s34 offen
v_mfma_f32_16x16x32_bf16 v[148:151], a[184:187], a[80:83], v[148:151]
v_mfma_f32_16x16x32_bf16 v[148:151], a[188:191], a[84:87], v[148:151]
v_mfma_f32_16x16x32_bf16 v[156:159], a[184:187], a[88:91], v[156:159]
v_mfma_f32_16x16x32_bf16 v[156:159], a[188:191], a[92:95], v[156:159]
s_waitcnt vmcnt(10) lgkmcnt(0)
s_barrier
v_mfma_f32_16x16x32_bf16 v[160:163], a[192:195], a[32:35], v[160:163]
v_mfma_f32_16x16x32_bf16 v[160:163], a[196:199], a[36:39], v[160:163]
ds_read_b128 a[160:163], v17 offset:32768
v_mfma_f32_16x16x32_bf16 v[168:171], a[192:195], a[40:43], v[168:171]
ds_read_b128 a[164:167], v18 offset:32768
v_mfma_f32_16x16x32_bf16 v[168:171], a[196:199], a[44:47], v[168:171]
s_add_u32 m0, s25, 102400
s_xor_b32 s29, s27, 3145728
buffer_load_dwordx4 v13, s[12:15], s29 offen offset:0 nt lds
v_mfma_f32_16x16x32_bf16 v[176:179], a[192:195], a[48:51], v[176:179]
ds_read_b128 a[168:171], v17 offset:34816
v_mfma_f32_16x16x32_bf16 v[176:179], a[196:199], a[52:55], v[176:179]
v_mfma_f32_16x16x32_bf16 v[184:187], a[192:195], a[56:59], v[184:187]
ds_read_b128 a[172:175], v18 offset:34816
v_mfma_f32_16x16x32_bf16 v[184:187], a[196:199], a[60:63], v[184:187]
ds_read_b128 a[176:179], v17 offset:36864
v_mfma_f32_16x16x32_bf16 v[192:195], a[192:195], a[64:67], v[192:195]
ds_read_b128 a[180:183], v18 offset:36864
v_mfma_f32_16x16x32_bf16 v[192:195], a[196:199], a[68:71], v[192:195]
ds_read_b128 a[184:187], v17 offset:38912
v_mfma_f32_16x16x32_bf16 v[200:203], a[192:195], a[72:75], v[200:203]
v_mfma_f32_16x16x32_bf16 v[200:203], a[196:199], a[76:79], v[200:203]
buffer_load_dwordx4 v14, s[12:15], s29 offen offset:1024 nt lds
v_mfma_f32_16x16x32_bf16 v[208:211], a[192:195], a[80:83], v[208:211]
ds_read_b128 a[188:191], v18 offset:38912
v_mfma_f32_16x16x32_bf16 v[208:211], a[196:199], a[84:87], v[208:211]
ds_read_b64_tr_b16 a[96:97], v21 offset:0
v_mfma_f32_16x16x32_bf16 v[216:219], a[192:195], a[88:91], v[216:219]
ds_read_b64_tr_b16 a[98:99], v21 offset:2048
v_mfma_f32_16x16x32_bf16 v[216:219], a[196:199], a[92:95], v[216:219]
ds_read_b64_tr_b16 a[100:101], v21 offset:16384
v_mfma_f32_16x16x32_bf16 v[164:167], a[200:203], a[32:35], v[164:167]
v_mfma_f32_16x16x32_bf16 v[164:167], a[204:207], a[36:39], v[164:167]
buffer_load_dwordx4 v15, s[12:15], s29 offen offset:2048 nt lds
v_mfma_f32_16x16x32_bf16 v[172:175], a[200:203], a[40:43], v[172:175]
ds_read_b64_tr_b16 a[102:103], v21 offset:18432
v_mfma_f32_16x16x32_bf16 v[172:175], a[204:207], a[44:47], v[172:175]
ds_read_b64_tr_b16 a[104:105], v22 offset:0
v_mfma_f32_16x16x32_bf16 v[180:183], a[200:203], a[48:51], v[180:183]
ds_read_b64_tr_b16 a[106:107], v22 offset:2048
v_mfma_f32_16x16x32_bf16 v[180:183], a[204:207], a[52:55], v[180:183]
v_mfma_f32_16x16x32_bf16 v[188:191], a[200:203], a[56:59], v[188:191]
ds_read_b64_tr_b16 a[108:109], v22 offset:16384
v_mfma_f32_16x16x32_bf16 v[188:191], a[204:207], a[60:63], v[188:191]
ds_read_b64_tr_b16 a[110:111], v22 offset:18432
v_mfma_f32_16x16x32_bf16 v[196:199], a[200:203], a[64:67], v[196:199]
buffer_load_dwordx4 v16, s[12:15], s29 offen offset:3072 nt lds
v_mfma_f32_16x16x32_bf16 v[196:199], a[204:207], a[68:71], v[196:199]
ds_read_b64_tr_b16 a[112:113], v23 offset:0
v_mfma_f32_16x16x32_bf16 v[204:207], a[200:203], a[72:75], v[204:207]
ds_read_b64_tr_b16 a[114:115], v23 offset:2048
v_mfma_f32_16x16x32_bf16 v[204:207], a[204:207], a[76:79], v[204:207]
v_mfma_f32_16x16x32_bf16 v[212:215], a[200:203], a[80:83], v[212:215]
ds_read_b64_tr_b16 a[116:117], v23 offset:16384
v_mfma_f32_16x16x32_bf16 v[212:215], a[204:207], a[84:87], v[212:215]
ds_read_b64_tr_b16 a[118:119], v23 offset:18432
v_mfma_f32_16x16x32_bf16 v[220:223], a[200:203], a[88:91], v[220:223]
s_add_u32 m0, s28, 0
s_xor_b32 s29, s26, 768
buffer_load_dwordx4 v5, s[8:11], s29 offen offset:0 lds
v_mfma_f32_16x16x32_bf16 v[220:223], a[204:207], a[92:95], v[220:223]
ds_read_b64_tr_b16 a[120:121], v24 offset:0
v_mfma_f32_16x16x32_bf16 v[224:227], a[208:211], a[32:35], v[224:227]
v_mfma_f32_16x16x32_bf16 v[224:227], a[212:215], a[36:39], v[224:227]
ds_read_b64_tr_b16 a[122:123], v24 offset:2048
v_mfma_f32_16x16x32_bf16 v[232:235], a[208:211], a[40:43], v[232:235]
ds_read_b64_tr_b16 a[124:125], v24 offset:16384
v_mfma_f32_16x16x32_bf16 v[232:235], a[212:215], a[44:47], v[232:235]
ds_read_b64_tr_b16 a[126:127], v24 offset:18432
v_mfma_f32_16x16x32_bf16 v[240:243], a[208:211], a[48:51], v[240:243]
buffer_load_dwordx4 v6, s[8:11], s29 offen offset:1024 lds
v_mfma_f32_16x16x32_bf16 v[240:243], a[212:215], a[52:55], v[240:243]
ds_read_b64_tr_b16 a[128:129], v25 offset:0
v_mfma_f32_16x16x32_bf16 v[248:251], a[208:211], a[56:59], v[248:251]
v_mfma_f32_16x16x32_bf16 v[248:251], a[212:215], a[60:63], v[248:251]
ds_read_b64_tr_b16 a[130:131], v25 offset:2048
v_mfma_f32_16x16x32_bf16 a[0:3], a[208:211], a[64:67], a[0:3]
ds_read_b64_tr_b16 a[132:133], v25 offset:16384
v_mfma_f32_16x16x32_bf16 a[0:3], a[212:215], a[68:71], a[0:3]
ds_read_b64_tr_b16 a[134:135], v25 offset:18432
v_mfma_f32_16x16x32_bf16 a[8:11], a[208:211], a[72:75], a[8:11]
ds_read_b64_tr_b16 a[136:137], v26 offset:0
v_mfma_f32_16x16x32_bf16 a[8:11], a[212:215], a[76:79], a[8:11]
v_mfma_f32_16x16x32_bf16 a[16:19], a[208:211], a[80:83], a[16:19]
buffer_load_dwordx4 v7, s[8:11], s29 offen offset:2048 lds
v_mfma_f32_16x16x32_bf16 a[16:19], a[212:215], a[84:87], a[16:19]
ds_read_b64_tr_b16 a[138:139], v26 offset:2048
v_mfma_f32_16x16x32_bf16 a[24:27], a[208:211], a[88:91], a[24:27]
ds_read_b64_tr_b16 a[140:141], v26 offset:16384
v_mfma_f32_16x16x32_bf16 a[24:27], a[212:215], a[92:95], a[24:27]
ds_read_b64_tr_b16 a[142:143], v26 offset:18432
v_mfma_f32_16x16x32_bf16 v[228:231], a[216:219], a[32:35], v[228:231]
ds_read_b64_tr_b16 a[144:145], v27 offset:0
v_mfma_f32_16x16x32_bf16 v[228:231], a[220:223], a[36:39], v[228:231]
v_mfma_f32_16x16x32_bf16 v[236:239], a[216:219], a[40:43], v[236:239]
buffer_load_dwordx4 v8, s[8:11], s29 offen offset:3072 lds
v_mfma_f32_16x16x32_bf16 v[236:239], a[220:223], a[44:47], v[236:239]
ds_read_b64_tr_b16 a[146:147], v27 offset:2048
v_mfma_f32_16x16x32_bf16 v[244:247], a[216:219], a[48:51], v[244:247]
ds_read_b64_tr_b16 a[148:149], v27 offset:16384
v_mfma_f32_16x16x32_bf16 v[244:247], a[220:223], a[52:55], v[244:247]
ds_read_b64_tr_b16 a[150:151], v27 offset:18432
v_mfma_f32_16x16x32_bf16 v[252:255], a[216:219], a[56:59], v[252:255]
v_mfma_f32_16x16x32_bf16 v[252:255], a[220:223], a[60:63], v[252:255]
ds_read_b64_tr_b16 a[152:153], v28 offset:0
v_mfma_f32_16x16x32_bf16 a[4:7], a[216:219], a[64:67], a[4:7]
ds_read_b64_tr_b16 a[154:155], v28 offset:2048
v_mfma_f32_16x16x32_bf16 a[4:7], a[220:223], a[68:71], a[4:7]
global_load_dword v31, v4, s[98:99]
v_mfma_f32_16x16x32_bf16 a[12:15], a[216:219], a[72:75], a[12:15]
ds_read_b64_tr_b16 a[156:157], v28 offset:16384
v_mfma_f32_16x16x32_bf16 a[12:15], a[220:223], a[76:79], a[12:15]
ds_read_b64_tr_b16 a[158:159], v28 offset:18432
v_mfma_f32_16x16x32_bf16 a[20:23], a[216:219], a[80:83], a[20:23]
v_mfma_f32_16x16x32_bf16 a[20:23], a[220:223], a[84:87], a[20:23]
v_mfma_f32_16x16x32_bf16 a[28:31], a[216:219], a[88:91], a[28:31]
v_mfma_f32_16x16x32_bf16 a[28:31], a[220:223], a[92:95], a[28:31]
s_waitcnt vmcnt(14) lgkmcnt(0)
s_barrier
v_mfma_f32_16x16x32_bf16 v[32:35], a[160:163], a[96:99], v[32:35]
v_mfma_f32_16x16x32_bf16 v[32:35], a[164:167], a[100:103], v[32:35]
v_mfma_f32_16x16x32_bf16 v[40:43], a[160:163], a[104:107], v[40:43]
s_add_u32 m0, s25, 65536
s_xor_b32 s29, s27, 3670016
buffer_load_dwordx4 v9, s[12:15], s29 offen offset:0 nt lds
v_mfma_f32_16x16x32_bf16 v[40:43], a[164:167], a[108:111], v[40:43]
v_mfma_f32_16x16x32_bf16 v[48:51], a[160:163], a[112:115], v[48:51]
ds_read_b128 a[192:195], v17 offset:49152
v_mfma_f32_16x16x32_bf16 v[48:51], a[164:167], a[116:119], v[48:51]
v_mfma_f32_16x16x32_bf16 v[56:59], a[160:163], a[120:123], v[56:59]
v_mfma_f32_16x16x32_bf16 v[56:59], a[164:167], a[124:127], v[56:59]
buffer_load_dwordx4 v10, s[12:15], s29 offen offset:1024 nt lds
v_mfma_f32_16x16x32_bf16 v[64:67], a[160:163], a[128:131], v[64:67]
v_mfma_f32_16x16x32_bf16 v[64:67], a[164:167], a[132:135], v[64:67]
ds_read_b128 a[196:199], v18 offset:49152
v_mfma_f32_16x16x32_bf16 v[72:75], a[160:163], a[136:139], v[72:75]
v_mfma_f32_16x16x32_bf16 v[72:75], a[164:167], a[140:143], v[72:75]
v_mfma_f32_16x16x32_bf16 v[80:83], a[160:163], a[144:147], v[80:83]
buffer_load_dwordx4 v11, s[12:15], s29 offen offset:2048 nt lds
v_mfma_f32_16x16x32_bf16 v[80:83], a[164:167], a[148:151], v[80:83]
v_mfma_f32_16x16x32_bf16 v[88:91], a[160:163], a[152:155], v[88:91]
ds_read_b128 a[200:203], v17 offset:51200
v_mfma_f32_16x16x32_bf16 v[88:91], a[164:167], a[156:159], v[88:91]
v_mfma_f32_16x16x32_bf16 v[36:39], a[168:171], a[96:99], v[36:39]
v_mfma_f32_16x16x32_bf16 v[36:39], a[172:175], a[100:103], v[36:39]
buffer_load_dwordx4 v12, s[12:15], s29 offen offset:3072 nt lds
v_mfma_f32_16x16x32_bf16 v[44:47], a[168:171], a[104:107], v[44:47]
v_mfma_f32_16x16x32_bf16 v[44:47], a[172:175], a[108:111], v[44:47]
ds_read_b128 a[204:207], v18 offset:51200
v_mfma_f32_16x16x32_bf16 v[52:55], a[168:171], a[112:115], v[52:55]
v_mfma_f32_16x16x32_bf16 v[52:55], a[172:175], a[116:119], v[52:55]
v_mfma_f32_16x16x32_bf16 v[60:63], a[168:171], a[120:123], v[60:63]
s_add_u32 m0, s25, 69632
s_xor_b32 s29, s27, 3670016
buffer_load_dwordx4 v13, s[12:15], s29 offen offset:0 nt lds
v_mfma_f32_16x16x32_bf16 v[60:63], a[172:175], a[124:127], v[60:63]
v_mfma_f32_16x16x32_bf16 v[68:71], a[168:171], a[128:131], v[68:71]
ds_read_b128 a[208:211], v17 offset:53248
v_mfma_f32_16x16x32_bf16 v[68:71], a[172:175], a[132:135], v[68:71]
v_mfma_f32_16x16x32_bf16 v[76:79], a[168:171], a[136:139], v[76:79]
v_mfma_f32_16x16x32_bf16 v[76:79], a[172:175], a[140:143], v[76:79]
buffer_load_dwordx4 v14, s[12:15], s29 offen offset:1024 nt lds
v_mfma_f32_16x16x32_bf16 v[84:87], a[168:171], a[144:147], v[84:87]
v_mfma_f32_16x16x32_bf16 v[84:87], a[172:175], a[148:151], v[84:87]
ds_read_b128 a[212:215], v18 offset:53248
v_mfma_f32_16x16x32_bf16 v[92:95], a[168:171], a[152:155], v[92:95]
v_mfma_f32_16x16x32_bf16 v[92:95], a[172:175], a[156:159], v[92:95]
v_mfma_f32_16x16x32_bf16 v[96:99], a[176:179], a[96:99], v[96:99]
buffer_load_dwordx4 v15, s[12:15], s29 offen offset:2048 nt lds
v_mfma_f32_16x16x32_bf16 v[96:99], a[180:183], a[100:103], v[96:99]
v_mfma_f32_16x16x32_bf16 v[104:107], a[176:179], a[104:107], v[104:107]
ds_read_b128 a[216:219], v17 offset:55296
v_mfma_f32_16x16x32_bf16 v[104:107], a[180:183], a[108:111], v[104:107]
v_mfma_f32_16x16x32_bf16 v[112:115], a[176:179], a[112:115], v[112:115]
v_mfma_f32_16x16x32_bf16 v[112:115], a[180:183], a[116:119], v[112:115]
buffer_load_dwordx4 v16, s[12:15], s29 offen offset:3072 nt lds
v_mfma_f32_16x16x32_bf16 v[120:123], a[176:179], a[120:123], v[120:123]
v_mfma_f32_16x16x32_bf16 v[120:123], a[180:183], a[124:127], v[120:123]
ds_read_b128 a[220:223], v18 offset:55296
v_mfma_f32_16x16x32_bf16 v[128:131], a[176:179], a[128:131], v[128:131]
v_mfma_f32_16x16x32_bf16 v[128:131], a[180:183], a[132:135], v[128:131]
v_mfma_f32_16x16x32_bf16 v[136:139], a[176:179], a[136:139], v[136:139]
s_add_u32 m0, s28, 16384
s_xor_b32 s29, s26, 896
buffer_load_dwordx4 v5, s[8:11], s29 offen offset:0 lds
v_mfma_f32_16x16x32_bf16 v[136:139], a[180:183], a[140:143], v[136:139]
v_mfma_f32_16x16x32_bf16 v[144:147], a[176:179], a[144:147], v[144:147]
v_mfma_f32_16x16x32_bf16 v[144:147], a[180:183], a[148:151], v[144:147]
v_mfma_f32_16x16x32_bf16 v[152:155], a[176:179], a[152:155], v[152:155]
v_mfma_f32_16x16x32_bf16 v[152:155], a[180:183], a[156:159], v[152:155]
buffer_load_dwordx4 v6, s[8:11], s29 offen offset:1024 lds
v_mfma_f32_16x16x32_bf16 v[100:103], a[184:187], a[96:99], v[100:103]
v_mfma_f32_16x16x32_bf16 v[100:103], a[188:191], a[100:103], v[100:103]
v_mfma_f32_16x16x32_bf16 v[108:111], a[184:187], a[104:107], v[108:111]
v_mfma_f32_16x16x32_bf16 v[108:111], a[188:191], a[108:111], v[108:111]
v_mfma_f32_16x16x32_bf16 v[116:119], a[184:187], a[112:115], v[116:119]
buffer_load_dwordx4 v7, s[8:11], s29 offen offset:2048 lds
v_mfma_f32_16x16x32_bf16 v[116:119], a[188:191], a[116:119], v[116:119]
v_mfma_f32_16x16x32_bf16 v[124:127], a[184:187], a[120:123], v[124:127]
v_mfma_f32_16x16x32_bf16 v[124:127], a[188:191], a[124:127], v[124:127]
v_mfma_f32_16x16x32_bf16 v[132:135], a[184:187], a[128:131], v[132:135]
v_mfma_f32_16x16x32_bf16 v[132:135], a[188:191], a[132:135], v[132:135]
buffer_load_dwordx4 v8, s[8:11], s29 offen offset:3072 lds
v_mfma_f32_16x16x32_bf16 v[140:143], a[184:187], a[136:139], v[140:143]
v_mfma_f32_16x16x32_bf16 v[140:143], a[188:191], a[140:143], v[140:143]
v_mfma_f32_16x16x32_bf16 v[148:151], a[184:187], a[144:147], v[148:151]
v_mfma_f32_16x16x32_bf16 v[148:151], a[188:191], a[148:151], v[148:151]
v_mfma_f32_16x16x32_bf16 v[156:159], a[184:187], a[152:155], v[156:159]
v_mfma_f32_16x16x32_bf16 v[156:159], a[188:191], a[156:159], v[156:159]
s_waitcnt vmcnt(13) lgkmcnt(0)
s_barrier
v_mfma_f32_16x16x32_bf16 v[160:163], a[192:195], a[96:99], v[160:163]
s_lshl_b32 s27, s20, 17
v_mfma_f32_16x16x32_bf16 v[160:163], a[196:199], a[100:103], v[160:163]
ds_read_b128 a[160:163], v17 offset:0
v_bfe_u32 v1, v0, 4, 2
v_mfma_f32_16x16x32_bf16 v[168:171], a[192:195], a[104:107], v[168:171]
ds_read_b128 a[164:167], v18 offset:0
v_mfma_f32_16x16x32_bf16 v[168:171], a[196:199], a[108:111], v[168:171]
s_add_u32 m0, s28, 32768
s_xor_b32 s29, s26, 1049344
buffer_load_dwordx4 v5, s[8:11], s29 offen offset:0 lds
v_lshlrev_b32 v2, 1, v1
v_mfma_f32_16x16x32_bf16 v[176:179], a[192:195], a[112:115], v[176:179]
ds_read_b128 a[168:171], v17 offset:2048
v_mfma_f32_16x16x32_bf16 v[176:179], a[196:199], a[116:119], v[176:179]
v_and_b32 v3, 15, v0
ds_read_b128 a[172:175], v18 offset:2048
v_mfma_f32_16x16x32_bf16 v[184:187], a[192:195], a[120:123], v[184:187]
v_xor_b32 v3, v3, v2
ds_read_b128 a[176:179], v17 offset:4096
v_mfma_f32_16x16x32_bf16 v[184:187], a[196:199], a[124:127], v[184:187]
buffer_load_dwordx4 v6, s[8:11], s29 offen offset:1024 lds
v_mfma_f32_16x16x32_bf16 v[192:195], a[192:195], a[128:131], v[192:195]
v_lshlrev_b32 v3, 4, v3
ds_read_b128 a[180:183], v18 offset:4096
v_mfma_f32_16x16x32_bf16 v[192:195], a[196:199], a[132:135], v[192:195]
v_lshl_add_u32 v9, v1, 13, v3
v_mfma_f32_16x16x32_bf16 v[200:203], a[192:195], a[136:139], v[200:203]
ds_read_b128 a[184:187], v17 offset:6144
v_xor_b32 v3, 128, v9
v_mfma_f32_16x16x32_bf16 v[200:203], a[196:199], a[140:143], v[200:203]
ds_read_b128 a[188:191], v18 offset:6144
v_add_u32 v10, 31744, v9
v_mfma_f32_16x16x32_bf16 v[208:211], a[192:195], a[144:147], v[208:211]
buffer_load_dwordx4 v7, s[8:11], s29 offen offset:2048 lds
v_mfma_f32_16x16x32_bf16 v[208:211], a[196:199], a[148:151], v[208:211]
ds_read_b64_tr_b16 a[32:33], v21 offset:32768
v_add_u32 v11, 63488, v3
v_mfma_f32_16x16x32_bf16 v[216:219], a[192:195], a[152:155], v[216:219]
ds_read_b64_tr_b16 a[34:35], v21 offset:34816
v_mfma_f32_16x16x32_bf16 v[216:219], a[196:199], a[156:159], v[216:219]
v_add_u32 v12, 95232, v3
s_branch kf_kernel_pl7
kf_kernel_pd7:
s_branch kf_kernel_pd9
kf_kernel_pl7:
ds_read_b64_tr_b16 a[36:37], v21 offset:49152
v_mfma_f32_16x16x32_bf16 v[164:167], a[200:203], a[96:99], v[164:167]
v_and_b32 v2, 2, v2
v_mfma_f32_16x16x32_bf16 v[164:167], a[204:207], a[100:103], v[164:167]
ds_read_b64_tr_b16 a[38:39], v21 offset:51200
v_and_b32 v3, 7, v0
v_mfma_f32_16x16x32_bf16 v[172:175], a[200:203], a[104:107], v[172:175]
buffer_load_dwordx4 v8, s[8:11], s29 offen offset:3072 lds
ds_read_b64_tr_b16 a[40:41], v22 offset:32768
v_mfma_f32_16x16x32_bf16 v[172:175], a[204:207], a[108:111], v[172:175]
v_xor_b32 v3, v3, v2
v_mfma_f32_16x16x32_bf16 v[180:183], a[200:203], a[112:115], v[180:183]
v_bfe_u32 v1, v0, 3, 3
ds_read_b64_tr_b16 a[42:43], v22 offset:34816
v_mfma_f32_16x16x32_bf16 v[180:183], a[204:207], a[116:119], v[180:183]
v_mul_u32_u24 v1, 3456, v1
v_mfma_f32_16x16x32_bf16 v[188:191], a[200:203], a[120:123], v[188:191]
ds_read_b64_tr_b16 a[44:45], v22 offset:49152
s_add_u32 m0, s28, 49152
s_xor_b32 s29, s26, 1049472
buffer_load_dwordx4 v5, s[8:11], s29 offen offset:0 lds
v_mfma_f32_16x16x32_bf16 v[188:191], a[204:207], a[124:127], v[188:191]
v_lshl_add_u32 v13, v3, 4, v1
ds_read_b64_tr_b16 a[46:47], v22 offset:51200
v_mfma_f32_16x16x32_bf16 v[196:199], a[200:203], a[128:131], v[196:199]
v_xor_b32 v14, 64, v13
v_mfma_f32_16x16x32_bf16 v[196:199], a[204:207], a[132:135], v[196:199]
ds_read_b64_tr_b16 a[48:49], v23 offset:32768
v_add_u32 v14, 26624, v14
v_mfma_f32_16x16x32_bf16 v[204:207], a[200:203], a[136:139], v[204:207]
ds_read_b64_tr_b16 a[50:51], v23 offset:34816
v_mfma_f32_16x16x32_bf16 v[204:207], a[204:207], a[140:143], v[204:207]
buffer_load_dwordx4 v6, s[8:11], s29 offen offset:1024 lds
v_mfma_f32_16x16x32_bf16 v[212:215], a[200:203], a[144:147], v[212:215]
ds_read_b64_tr_b16 a[52:53], v23 offset:49152
v_mfma_f32_16x16x32_bf16 v[212:215], a[204:207], a[148:151], v[212:215]
ds_read_b64_tr_b16 a[54:55], v23 offset:51200
v_mfma_f32_16x16x32_bf16 v[220:223], a[200:203], a[152:155], v[220:223]
ds_read_b64_tr_b16 a[56:57], v24 offset:32768
v_mfma_f32_16x16x32_bf16 v[220:223], a[204:207], a[156:159], v[220:223]
v_mfma_f32_16x16x32_bf16 v[224:227], a[208:211], a[96:99], v[224:227]
ds_read_b64_tr_b16 a[58:59], v24 offset:34816
buffer_load_dwordx4 v7, s[8:11], s29 offen offset:2048 lds
v_mfma_f32_16x16x32_bf16 v[224:227], a[212:215], a[100:103], v[224:227]
v_mfma_f32_16x16x32_bf16 v[232:235], a[208:211], a[104:107], v[232:235]
ds_read_b64_tr_b16 a[60:61], v24 offset:49152
v_mfma_f32_16x16x32_bf16 v[232:235], a[212:215], a[108:111], v[232:235]
ds_read_b64_tr_b16 a[62:63], v24 offset:51200
v_mfma_f32_16x16x32_bf16 v[240:243], a[208:211], a[112:115], v[240:243]
ds_read_b64_tr_b16 a[64:65], v25 offset:32768
v_mfma_f32_16x16x32_bf16 v[240:243], a[212:215], a[116:119], v[240:243]
buffer_load_dwordx4 v8, s[8:11], s29 offen offset:3072 lds
v_mfma_f32_16x16x32_bf16 v[248:251], a[208:211], a[120:123], v[248:251]
ds_read_b64_tr_b16 a[66:67], v25 offset:34816
v_mfma_f32_16x16x32_bf16 v[248:251], a[212:215], a[124:127], v[248:251]
ds_read_b64_tr_b16 a[68:69], v25 offset:49152
v_mfma_f32_16x16x32_bf16 a[0:3], a[208:211], a[128:131], a[0:3]
v_mfma_f32_16x16x32_bf16 a[0:3], a[212:215], a[132:135], a[0:3]
ds_read_b64_tr_b16 a[70:71], v25 offset:51200
v_mfma_f32_16x16x32_bf16 a[8:11], a[208:211], a[136:139], a[8:11]
s_add_u32 m0, s35, 131072
s_add_u32 s29, s54, 0
buffer_load_dwordx4 v13, s[40:43], s29 offen offset:0 lds
v_mfma_f32_16x16x32_bf16 a[8:11], a[212:215], a[140:143], a[8:11]
ds_read_b64_tr_b16 a[72:73], v26 offset:32768
v_mfma_f32_16x16x32_bf16 a[16:19], a[208:211], a[144:147], a[16:19]
ds_read_b64_tr_b16 a[74:75], v26 offset:34816
v_mfma_f32_16x16x32_bf16 a[16:19], a[212:215], a[148:151], a[16:19]
v_mfma_f32_16x16x32_bf16 a[24:27], a[208:211], a[152:155], a[24:27]
ds_read_b64_tr_b16 a[76:77], v26 offset:49152
v_mfma_f32_16x16x32_bf16 a[24:27], a[212:215], a[156:159], a[24:27]
ds_read_b64_tr_b16 a[78:79], v26 offset:51200
buffer_load_dwordx4 v14, s[40:43], s29 offen offset:1024 lds
v_mfma_f32_16x16x32_bf16 v[228:231], a[216:219], a[96:99], v[228:231]
v_mfma_f32_16x16x32_bf16 v[228:231], a[220:223], a[100:103], v[228:231]
ds_read_b64_tr_b16 a[80:81], v27 offset:32768
v_mfma_f32_16x16x32_bf16 v[236:239], a[216:219], a[104:107], v[236:239]
ds_read_b64_tr_b16 a[82:83], v27 offset:34816
v_mfma_f32_16x16x32_bf16 v[236:239], a[220:223], a[108:111], v[236:239]
ds_read_b64_tr_b16 a[84:85], v27 offset:49152
v_mfma_f32_16x16x32_bf16 v[244:247], a[216:219], a[112:115], v[244:247]
v_mfma_f32_16x16x32_bf16 v[244:247], a[220:223], a[116:119], v[244:247]
s_add_u32 m0, s35, 139264
s_add_u32 s29, s54, 221184
buffer_load_dwordx4 v13, s[40:43], s29 offen offset:0 lds
ds_read_b64_tr_b16 a[86:87], v27 offset:51200
v_mfma_f32_16x16x32_bf16 v[252:255], a[216:219], a[120:123], v[252:255]
ds_read_b64_tr_b16 a[88:89], v28 offset:32768
v_mfma_f32_16x16x32_bf16 v[252:255], a[220:223], a[124:127], v[252:255]
v_mfma_f32_16x16x32_bf16 a[4:7], a[216:219], a[128:131], a[4:7]
ds_read_b64_tr_b16 a[90:91], v28 offset:34816
v_mfma_f32_16x16x32_bf16 a[4:7], a[220:223], a[132:135], a[4:7]
buffer_load_dwordx4 v14, s[40:43], s29 offen offset:1024 lds
v_mfma_f32_16x16x32_bf16 a[12:15], a[216:219], a[136:139], a[12:15]
ds_read_b64_tr_b16 a[92:93], v28 offset:49152
v_mfma_f32_16x16x32_bf16 a[12:15], a[220:223], a[140:143], a[12:15]
ds_read_b64_tr_b16 a[94:95], v28 offset:51200
v_mfma_f32_16x16x32_bf16 a[20:23], a[216:219], a[144:147], a[20:23]
v_mfma_f32_16x16x32_bf16 a[20:23], a[220:223], a[148:151], a[20:23]
v_mfma_f32_16x16x32_bf16 a[28:31], a[216:219], a[152:155], a[28:31]
v_mfma_f32_16x16x32_bf16 a[28:31], a[220:223], a[156:159], a[28:31]
s_waitcnt vmcnt(12) lgkmcnt(0)
s_barrier
v_mfma_f32_16x16x32_bf16 v[32:35], a[160:163], a[32:35], v[32:35]
v_mfma_f32_16x16x32_bf16 v[32:35], a[164:167], a[36:39], v[32:35]
ds_read_b128 a[192:195], v17 offset:16384
v_mfma_f32_16x16x32_bf16 v[40:43], a[160:163], a[40:43], v[40:43]
ds_read_b128 a[196:199], v18 offset:16384
v_mfma_f32_16x16x32_bf16 v[40:43], a[164:167], a[44:47], v[40:43]
s_add_u32 m0, s28, 98304
s_add_u32 s29, s27, 0
buffer_load_dwordx4 v9, s[44:47], s29 offen offset:0 lds
v_mfma_f32_16x16x32_bf16 v[48:51], a[160:163], a[48:51], v[48:51]
ds_read_b128 a[200:203], v17 offset:18432
v_mfma_f32_16x16x32_bf16 v[48:51], a[164:167], a[52:55], v[48:51]
v_mfma_f32_16x16x32_bf16 v[56:59], a[160:163], a[56:59], v[56:59]
ds_read_b128 a[204:207], v18 offset:18432
v_mfma_f32_16x16x32_bf16 v[56:59], a[164:167], a[60:63], v[56:59]
ds_read_b128 a[208:211], v17 offset:20480
v_mfma_f32_16x16x32_bf16 v[64:67], a[160:163], a[64:67], v[64:67]
ds_read_b128 a[212:215], v18 offset:20480
v_mfma_f32_16x16x32_bf16 v[64:67], a[164:167], a[68:71], v[64:67]
ds_read_b128 a[216:219], v17 offset:22528
v_mfma_f32_16x16x32_bf16 v[72:75], a[160:163], a[72:75], v[72:75]
v_mfma_f32_16x16x32_bf16 v[72:75], a[164:167], a[76:79], v[72:75]
buffer_load_dwordx4 v10, s[44:47], s29 offen offset:1024 lds
v_mfma_f32_16x16x32_bf16 v[80:83], a[160:163], a[80:83], v[80:83]
ds_read_b128 a[220:223], v18 offset:22528
v_mfma_f32_16x16x32_bf16 v[80:83], a[164:167], a[84:87], v[80:83]
ds_read_b64_tr_b16 a[96:97], v21 offset:0
v_mfma_f32_16x16x32_bf16 v[88:91], a[160:163], a[88:91], v[88:91]
ds_read_b64_tr_b16 a[98:99], v21 offset:2048
v_mfma_f32_16x16x32_bf16 v[88:91], a[164:167], a[92:95], v[88:91]
v_mfma_f32_16x16x32_bf16 v[36:39], a[168:171], a[32:35], v[36:39]
ds_read_b64_tr_b16 a[100:101], v21 offset:16384
v_mfma_f32_16x16x32_bf16 v[36:39], a[172:175], a[36:39], v[36:39]
ds_read_b64_tr_b16 a[102:103], v21 offset:18432
v_mfma_f32_16x16x32_bf16 v[44:47], a[168:171], a[40:43], v[44:47]
buffer_load_dwordx4 v11, s[44:47], s29 offen offset:2048 lds
v_mfma_f32_16x16x32_bf16 v[44:47], a[172:175], a[44:47], v[44:47]
ds_read_b64_tr_b16 a[104:105], v22 offset:0
v_mfma_f32_16x16x32_bf16 v[52:55], a[168:171], a[48:51], v[52:55]
v_mfma_f32_16x16x32_bf16 v[52:55], a[172:175], a[52:55], v[52:55]
ds_read_b64_tr_b16 a[106:107], v22 offset:2048
v_mfma_f32_16x16x32_bf16 v[60:63], a[168:171], a[56:59], v[60:63]
ds_read_b64_tr_b16 a[108:109], v22 offset:16384
v_mfma_f32_16x16x32_bf16 v[60:63], a[172:175], a[60:63], v[60:63]
ds_read_b64_tr_b16 a[110:111], v22 offset:18432
v_mfma_f32_16x16x32_bf16 v[68:71], a[168:171], a[64:67], v[68:71]
ds_read_b64_tr_b16 a[112:113], v23 offset:0
v_mfma_f32_16x16x32_bf16 v[68:71], a[172:175], a[68:71], v[68:71]
v_mfma_f32_16x16x32_bf16 v[76:79], a[168:171], a[72:75], v[76:79]
buffer_load_dwordx4 v12, s[44:47], s29 offen offset:3072 lds
v_mfma_f32_16x16x32_bf16 v[76:79], a[172:175], a[76:79], v[76:79]
ds_read_b64_tr_b16 a[114:115], v23 offset:2048
v_mfma_f32_16x16x32_bf16 v[84:87], a[168:171], a[80:83], v[84:87]
ds_read_b64_tr_b16 a[116:117], v23 offset:16384
v_mfma_f32_16x16x32_bf16 v[84:87], a[172:175], a[84:87], v[84:87]
ds_read_b64_tr_b16 a[118:119], v23 offset:18432
v_mfma_f32_16x16x32_bf16 v[92:95], a[168:171], a[88:91], v[92:95]
v_mfma_f32_16x16x32_bf16 v[92:95], a[172:175], a[92:95], v[92:95]
ds_read_b64_tr_b16 a[120:121], v24 offset:0
v_mfma_f32_16x16x32_bf16 v[96:99], a[176:179], a[32:35], v[96:99]
ds_read_b64_tr_b16 a[122:123], v24 offset:2048
v_mfma_f32_16x16x32_bf16 v[96:99], a[180:183], a[36:39], v[96:99]
s_add_u32 m0, s28, 114688
s_add_u32 s29, s27, 524288
buffer_load_dwordx4 v9, s[44:47], s29 offen offset:0 lds
v_mfma_f32_16x16x32_bf16 v[104:107], a[176:179], a[40:43], v[104:107]
ds_read_b64_tr_b16 a[124:125], v24 offset:16384
v_mfma_f32_16x16x32_bf16 v[104:107], a[180:183], a[44:47], v[104:107]
v_mfma_f32_16x16x32_bf16 v[112:115], a[176:179], a[48:51], v[112:115]
ds_read_b64_tr_b16 a[126:127], v24 offset:18432
v_mfma_f32_16x16x32_bf16 v[112:115], a[180:183], a[52:55], v[112:115]
ds_read_b64_tr_b16 a[128:129], v25 offset:0
v_mfma_f32_16x16x32_bf16 v[120:123], a[176:179], a[56:59], v[120:123]
ds_read_b64_tr_b16 a[130:131], v25 offset:2048
v_mfma_f32_16x16x32_bf16 v[120:123], a[180:183], a[60:63], v[120:123]
ds_read_b64_tr_b16 a[132:133], v25 offset:16384
v_mfma_f32_16x16x32_bf16 v[128:131], a[176:179], a[64:67], v[128:131]
v_mfma_f32_16x16x32_bf16 v[128:131], a[180:183], a[68:71], v[128:131]
buffer_load_dwordx4 v10, s[44:47], s29 offen offset:1024 lds
v_mfma_f32_16x16x32_bf16 v[136:139], a[176:179], a[72:75], v[136:139]
ds_read_b64_tr_b16 a[134:135], v25 offset:18432
v_mfma_f32_16x16x32_bf16 v[136:139], a[180:183], a[76:79], v[136:139]
ds_read_b64_tr_b16 a[136:137], v26 offset:0
v_mfma_f32_16x16x32_bf16 v[144:147], a[176:179], a[80:83], v[144:147]
ds_read_b64_tr_b16 a[138:139], v26 offset:2048
v_mfma_f32_16x16x32_bf16 v[144:147], a[180:183], a[84:87], v[144:147]
v_mfma_f32_16x16x32_bf16 v[152:155], a[176:179], a[88:91], v[152:155]
ds_read_b64_tr_b16 a[140:141], v26 offset:16384
v_mfma_f32_16x16x32_bf16 v[152:155], a[180:183], a[92:95], v[152:155]
ds_read_b64_tr_b16 a[142:143], v26 offset:18432
v_mfma_f32_16x16x32_bf16 v[100:103], a[184:187], a[32:35], v[100:103]
buffer_load_dwordx4 v11, s[44:47], s29 offen offset:2048 lds
v_mfma_f32_16x16x32_bf16 v[100:103], a[188:191], a[36:39], v[100:103]
ds_read_b64_tr_b16 a[144:145], v27 offset:0
v_mfma_f32_16x16x32_bf16 v[108:111], a[184:187], a[40:43], v[108:111]
v_mfma_f32_16x16x32_bf16 v[108:111], a[188:191], a[44:47], v[108:111]
ds_read_b64_tr_b16 a[146:147], v27 offset:2048
v_mfma_f32_16x16x32_bf16 v[116:119], a[184:187], a[48:51], v[116:119]
ds_read_b64_tr_b16 a[148:149], v27 offset:16384
v_mfma_f32_16x16x32_bf16 v[116:119], a[188:191], a[52:55], v[116:119]
ds_read_b64_tr_b16 a[150:151], v27 offset:18432
v_mfma_f32_16x16x32_bf16 v[124:127], a[184:187], a[56:59], v[124:127]
ds_read_b64_tr_b16 a[152:153], v28 offset:0
v_mfma_f32_16x16x32_bf16 v[124:127], a[188:191], a[60:63], v[124:127]
v_mfma_f32_16x16x32_bf16 v[132:135], a[184:187], a[64:67], v[132:135]
buffer_load_dwordx4 v12, s[44:47], s29 offen offset:3072 lds
v_mfma_f32_16x16x32_bf16 v[132:135], a[188:191], a[68:71], v[132:135]
ds_read_b64_tr_b16 a[154:155], v28 offset:2048
v_mfma_f32_16x16x32_bf16 v[140:143], a[184:187], a[72:75], v[140:143]
ds_read_b64_tr_b16 a[156:157], v28 offset:16384
v_mfma_f32_16x16x32_bf16 v[140:143], a[188:191], a[76:79], v[140:143]
ds_read_b64_tr_b16 a[158:159], v28 offset:18432
v_mfma_f32_16x16x32_bf16 v[148:151], a[184:187], a[80:83], v[148:151]
v_mfma_f32_16x16x32_bf16 v[148:151], a[188:191], a[84:87], v[148:151]
v_mfma_f32_16x16x32_bf16 v[156:159], a[184:187], a[88:91], v[156:159]
v_mfma_f32_16x16x32_bf16 v[156:159], a[188:191], a[92:95], v[156:159]
s_waitcnt vmcnt(16) lgkmcnt(0)
s_barrier
v_mfma_f32_16x16x32_bf16 v[32:35], a[192:195], a[96:99], v[32:35]
v_mfma_f32_16x16x32_bf16 v[32:35], a[196:199], a[100:103], v[32:35]
v_mfma_f32_16x16x32_bf16 v[40:43], a[192:195], a[104:107], v[40:43]
v_and_b32 v20, 7, v0
v_lshlrev_b32 v20, 8, v20
s_mov_b32 s55, 3174400
buffer_load_dword v30, v20, s[48:51], s55 offen sc1
v_mfma_f32_16x16x32_bf16 v[40:43], a[196:199], a[108:111], v[40:43]
ds_read_b128 a[160:163], v17 offset:32768
v_mfma_f32_16x16x32_bf16 v[48:51], a[192:195], a[112:115], v[48:51]
v_mfma_f32_16x16x32_bf16 v[48:51], a[196:199], a[116:119], v[48:51]
v_bfe_u32 v1, v0, 2, 2
v_mfma_f32_16x16x32_bf16 v[56:59], a[192:195], a[120:123], v[56:59]
s_add_u32 m0, s28, 65536
s_add_u32 s29, s27, 1048576
buffer_load_dwordx4 v9, s[44:47], s29 offen offset:0 lds
v_mfma_f32_16x16x32_bf16 v[56:59], a[196:199], a[124:127], v[56:59]
ds_read_b128 a[164:167], v18 offset:32768
v_mfma_f32_16x16x32_bf16 v[64:67], a[192:195], a[128:131], v[64:67]
v_bfe_u32 v2, v0, 4, 2
v_mfma_f32_16x16x32_bf16 v[64:67], a[196:199], a[132:135], v[64:67]
v_lshl_add_u32 v3, v2, 3, v1
v_mfma_f32_16x16x32_bf16 v[72:75], a[192:195], a[136:139], v[72:75]
v_lshlrev_b32 v3, 8, v3
v_mfma_f32_16x16x32_bf16 v[72:75], a[196:199], a[140:143], v[72:75]
buffer_load_dwordx4 v10, s[44:47], s29 offen offset:1024 lds
v_bfe_u32 v1, v0, 2, 3
v_mfma_f32_16x16x32_bf16 v[80:83], a[192:195], a[144:147], v[80:83]
ds_read_b128 a[168:171], v17 offset:34816
v_mfma_f32_16x16x32_bf16 v[80:83], a[196:199], a[148:151], v[80:83]
v_lshl_add_u32 v3, v1, 5, v3
v_mfma_f32_16x16x32_bf16 v[88:91], a[192:195], a[152:155], v[88:91]
v_and_b32 v1, 3, v0
v_mfma_f32_16x16x32_bf16 v[88:91], a[196:199], a[156:159], v[88:91]
buffer_load_dwordx4 v11, s[44:47], s29 offen offset:2048 lds
v_mfma_f32_16x16x32_bf16 v[36:39], a[200:203], a[96:99], v[36:39]
v_lshl_add_u32 v3, v1, 3, v3
v_mfma_f32_16x16x32_bf16 v[36:39], a[204:207], a[100:103], v[36:39]
v_add_u32 v21, 65536, v3
ds_read_b128 a[172:175], v18 offset:34816
v_mfma_f32_16x16x32_bf16 v[44:47], a[200:203], a[104:107], v[44:47]
v_xor_b32 v22, 32, v21
v_mfma_f32_16x16x32_bf16 v[44:47], a[204:207], a[108:111], v[44:47]
buffer_load_dwordx4 v12, s[44:47], s29 offen offset:3072 lds
v_mfma_f32_16x16x32_bf16 v[52:55], a[200:203], a[112:115], v[52:55]
v_xor_b32 v23, 64, v21
v_mfma_f32_16x16x32_bf16 v[52:55], a[204:207], a[116:119], v[52:55]
v_xor_b32 v24, 96, v21
v_mfma_f32_16x16x32_bf16 v[60:63], a[200:203], a[120:123], v[60:63]
ds_read_b128 a[176:179], v17 offset:36864
v_mfma_f32_16x16x32_bf16 v[60:63], a[204:207], a[124:127], v[60:63]
v_xor_b32 v25, 128, v21
s_add_u32 m0, s28, 81920
s_add_u32 s29, s27, 1572864
buffer_load_dwordx4 v9, s[44:47], s29 offen offset:0 lds
v_mfma_f32_16x16x32_bf16 v[68:71], a[200:203], a[128:131], v[68:71]
v_xor_b32 v26, 160, v21
v_mfma_f32_16x16x32_bf16 v[68:71], a[204:207], a[132:135], v[68:71]
v_xor_b32 v27, 192, v21
v_mfma_f32_16x16x32_bf16 v[76:79], a[200:203], a[136:139], v[76:79]
v_xor_b32 v28, 224, v21
v_mfma_f32_16x16x32_bf16 v[76:79], a[204:207], a[140:143], v[76:79]
ds_read_b128 a[180:183], v18 offset:36864
v_mfma_f32_16x16x32_bf16 v[84:87], a[200:203], a[144:147], v[84:87]
buffer_load_dwordx4 v10, s[44:47], s29 offen offset:1024 lds
v_mfma_f32_16x16x32_bf16 v[84:87], a[204:207], a[148:151], v[84:87]
v_bfe_u32 v1, v0, 2, 2
v_bfe_u32 v2, v0, 4, 2
v_mfma_f32_16x16x32_bf16 v[92:95], a[200:203], a[152:155], v[92:95]
v_lshl_add_u32 v3, v2, 3, v1
v_mfma_f32_16x16x32_bf16 v[92:95], a[204:207], a[156:159], v[92:95]
v_lshlrev_b32 v3, 7, v3
v_mfma_f32_16x16x32_bf16 v[96:99], a[208:211], a[96:99], v[96:99]
buffer_load_dwordx4 v11, s[44:47], s29 offen offset:2048 lds
v_mfma_f32_16x16x32_bf16 v[96:99], a[212:215], a[100:103], v[96:99]
ds_read_b128 a[184:187], v17 offset:38912
v_mfma_f32_16x16x32_bf16 v[104:107], a[208:211], a[104:107], v[104:107]
v_bfe_u32 v1, v0, 3, 2
v_mfma_f32_16x16x32_bf16 v[104:107], a[212:215], a[108:111], v[104:107]
v_lshl_add_u32 v3, v1, 5, v3
v_and_b32 v1, 3, v0
v_mfma_f32_16x16x32_bf16 v[112:115], a[208:211], a[112:115], v[112:115]
buffer_load_dwordx4 v12, s[44:47], s29 offen offset:3072 lds
v_mfma_f32_16x16x32_bf16 v[112:115], a[212:215], a[116:119], v[112:115]
ds_read_b128 a[188:191], v18 offset:38912
v_mfma_f32_16x16x32_bf16 v[120:123], a[208:211], a[120:123], v[120:123]
v_lshl_add_u32 v3, v1, 3, v3
v_mfma_f32_16x16x32_bf16 v[120:123], a[212:215], a[124:127], v[120:123]
v_add_u32 v5, 131072, v3
v_mfma_f32_16x16x32_bf16 v[128:131], a[208:211], a[128:131], v[128:131]
v_xor_b32 v6, 32, v5
v_mfma_f32_16x16x32_bf16 v[128:131], a[212:215], a[132:135], v[128:131]
s_add_u32 m0, s35, 147456
s_add_u32 s29, s54, 442368
buffer_load_dwordx4 v13, s[40:43], s29 offen offset:0 lds
v_xor_b32 v7, 64, v5
v_mfma_f32_16x16x32_bf16 v[136:139], a[208:211], a[136:139], v[136:139]
v_mfma_f32_16x16x32_bf16 v[136:139], a[212:215], a[140:143], v[136:139]
v_xor_b32 v8, 96, v5
v_mfma_f32_16x16x32_bf16 v[144:147], a[208:211], a[144:147], v[144:147]
s_mul_i32 s39, s21, 1064960
v_mfma_f32_16x16x32_bf16 v[144:147], a[212:215], a[148:151], v[144:147]
buffer_load_dwordx4 v14, s[40:43], s29 offen offset:1024 lds
v_mfma_f32_16x16x32_bf16 v[152:155], a[208:211], a[152:155], v[152:155]
s_add_u32 s39, s39, 4194304
v_mfma_f32_16x16x32_bf16 v[152:155], a[212:215], a[156:159], v[152:155]
s_add_u32 s8, s6, s39
s_addc_u32 s9, s7, 0
v_mfma_f32_16x16x32_bf16 v[100:103], a[216:219], a[96:99], v[100:103]
s_mov_b32 s10, 1064960
v_mfma_f32_16x16x32_bf16 v[100:103], a[220:223], a[100:103], v[100:103]
s_add_u32 m0, s35, 155648
s_add_u32 s29, s54, 663552
buffer_load_dwordx4 v13, s[40:43], s29 offen offset:0 lds
v_mfma_f32_16x16x32_bf16 v[108:111], a[216:219], a[104:107], v[108:111]
s_mov_b32 s11, 0x20000
v_mfma_f32_16x16x32_bf16 v[108:111], a[220:223], a[108:111], v[108:111]
s_cmp_eq_u32 s20, 3
s_cselect_b32 s10, 1044480, s10
v_mfma_f32_16x16x32_bf16 v[116:119], a[216:219], a[112:115], v[116:119]
v_mfma_f32_16x16x32_bf16 v[116:119], a[220:223], a[116:119], v[116:119]
s_sub_u32 s12, s56, 12288
buffer_load_dwordx4 v14, s[40:43], s29 offen offset:1024 lds
v_mfma_f32_16x16x32_bf16 v[124:127], a[216:219], a[120:123], v[124:127]
s_sub_u32 s13, s56, 20480
v_mfma_f32_16x16x32_bf16 v[124:127], a[220:223], a[124:127], v[124:127]
s_and_b32 s14, s24, 7
v_mfma_f32_16x16x32_bf16 v[132:135], a[216:219], a[128:131], v[132:135]
s_lshl2_add_u32 s14, s14, s20
v_mfma_f32_16x16x32_bf16 v[132:135], a[220:223], a[132:135], v[132:135]
v_mfma_f32_16x16x32_bf16 v[140:143], a[216:219], a[136:139], v[140:143]
global_load_dword v31, v4, s[98:99]
v_mfma_f32_16x16x32_bf16 v[140:143], a[220:223], a[140:143], v[140:143]
s_cmp_lt_u32 s14, 2
s_cselect_b32 s14, 4096, 0
s_add_u32 s14, s14, s12
v_mfma_f32_16x16x32_bf16 v[148:151], a[216:219], a[144:147], v[148:151]
v_mfma_f32_16x16x32_bf16 v[148:151], a[220:223], a[148:151], v[148:151]
v_mfma_f32_16x16x32_bf16 v[156:159], a[216:219], a[152:155], v[156:159]
v_mfma_f32_16x16x32_bf16 v[156:159], a[220:223], a[156:159], v[156:159]
s_waitcnt vmcnt(13) lgkmcnt(0)
s_barrier
v_and_b32 v1, 63, v30
v_cmp_gt_u32 vcc, 32, v1
s_cmp_lg_u64 vcc, 0
s_cbranch_scc1 kf_kernel_spin_xnv
kf_kernel_ret_xnv:
v_mfma_f32_16x16x32_bf16 v[160:163], a[160:163], a[32:35], v[160:163]
v_readlane_b32 s4, v30, s23
v_mfma_f32_16x16x32_bf16 v[160:163], a[164:167], a[36:39], v[160:163]
s_lshl_b32 s57, s57, 5
v_mfma_f32_16x16x32_bf16 v[168:171], a[160:163], a[40:43], v[168:171]
ds_read_b128 a[192:195], v17 offset:49152
v_mfma_f32_16x16x32_bf16 v[168:171], a[164:167], a[44:47], v[168:171]
v_cvt_pk_bf16_f32 v32, v32, v33
v_mfma_f32_16x16x32_bf16 v[176:179], a[160:163], a[48:51], v[176:179]
s_add_u32 s34, s32, 0
buffer_load_dwordx4 a[224:227], v4, s[48:51], s34 offen sc1
v_mfma_f32_16x16x32_bf16 v[176:179], a[164:167], a[52:55], v[176:179]
v_cvt_pk_bf16_f32 v33, v34, v35
v_mfma_f32_16x16x32_bf16 v[184:187], a[160:163], a[56:59], v[184:187]
v_cvt_pk_bf16_f32 v34, v36, v37
v_mfma_f32_16x16x32_bf16 v[184:187], a[164:167], a[60:63], v[184:187]
ds_read_b128 a[196:199], v18 offset:49152
v_mfma_f32_16x16x32_bf16 v[192:195], a[160:163], a[64:67], v[192:195]
v_cvt_pk_bf16_f32 v35, v38, v39
v_mfma_f32_16x16x32_bf16 v[192:195], a[164:167], a[68:71], v[192:195]
s_add_u32 s53, s14, 0
buffer_store_dwordx4 v[32:35], v4, s[16:19], s53 offen offset:0
v_mfma_f32_16x16x32_bf16 v[200:203], a[160:163], a[72:75], v[200:203]
v_cvt_pk_bf16_f32 v40, v40, v41
v_mfma_f32_16x16x32_bf16 v[200:203], a[164:167], a[76:79], v[200:203]
buffer_load_dwordx4 a[228:231], v4, s[48:51], s34 offen offset:1024 sc1
v_mfma_f32_16x16x32_bf16 v[208:211], a[160:163], a[80:83], v[208:211]
v_cvt_pk_bf16_f32 v41, v42, v43
v_mfma_f32_16x16x32_bf16 v[208:211], a[164:167], a[84:87], v[208:211]
ds_read_b128 a[200:203], v17 offset:51200
v_mfma_f32_16x16x32_bf16 v[216:219], a[160:163], a[88:91], v[216:219]
v_cvt_pk_bf16_f32 v42, v44, v45
v_mfma_f32_16x16x32_bf16 v[216:219], a[164:167], a[92:95], v[216:219]
v_cvt_pk_bf16_f32 v43, v46, v47
v_mfma_f32_16x16x32_bf16 v[164:167], a[168:171], a[32:35], v[164:167]
buffer_store_dwordx4 v[40:43], v4, s[16:19], s53 offen offset:1024
v_mfma_f32_16x16x32_bf16 v[164:167], a[172:175], a[36:39], v[164:167]
ds_read_b128 a[204:207], v18 offset:51200
v_mfma_f32_16x16x32_bf16 v[172:175], a[168:171], a[40:43], v[172:175]
v_cvt_pk_bf16_f32 v48, v48, v49
v_mfma_f32_16x16x32_bf16 v[172:175], a[172:175], a[44:47], v[172:175]
s_add_u32 s34, s32, 20480
buffer_load_dwordx4 a[232:235], v4, s[48:51], s34 offen sc1
v_mfma_f32_16x16x32_bf16 v[180:183], a[168:171], a[48:51], v[180:183]
v_cvt_pk_bf16_f32 v49, v50, v51
v_mfma_f32_16x16x32_bf16 v[180:183], a[172:175], a[52:55], v[180:183]
v_cvt_pk_bf16_f32 v50, v52, v53
v_mfma_f32_16x16x32_bf16 v[188:191], a[168:171], a[56:59], v[188:191]
v_cvt_pk_bf16_f32 v51, v54, v55
v_mfma_f32_16x16x32_bf16 v[188:191], a[172:175], a[60:63], v[188:191]
ds_read_b128 a[208:211], v17 offset:53248
v_mfma_f32_16x16x32_bf16 v[196:199], a[168:171], a[64:67], v[196:199]
buffer_store_dwordx4 v[48:51], v4, s[16:19], s53 offen offset:2048
v_mfma_f32_16x16x32_bf16 v[196:199], a[172:175], a[68:71], v[196:199]
v_cvt_pk_bf16_f32 v56, v56, v57
v_mfma_f32_16x16x32_bf16 v[204:207], a[168:171], a[72:75], v[204:207]
buffer_load_dwordx4 a[236:239], v4, s[48:51], s34 offen offset:1024 sc1
v_mfma_f32_16x16x32_bf16 v[204:207], a[172:175], a[76:79], v[204:207]
v_cvt_pk_bf16_f32 v57, v58, v59
v_mfma_f32_16x16x32_bf16 v[212:215], a[168:171], a[80:83], v[212:215]
ds_read_b128 a[212:215], v18 offset:53248
v_mfma_f32_16x16x32_bf16 v[212:215], a[172:175], a[84:87], v[212:215]
v_cvt_pk_bf16_f32 v58, v60, v61
v_cvt_pk_bf16_f32 v59, v62, v63
v_mfma_f32_16x16x32_bf16 v[220:223], a[168:171], a[88:91], v[220:223]
buffer_store_dwordx4 v[56:59], v4, s[16:19], s53 offen offset:3072
v_mfma_f32_16x16x32_bf16 v[220:223], a[172:175], a[92:95], v[220:223]
v_cvt_pk_bf16_f32 v64, v64, v65
v_mfma_f32_16x16x32_bf16 v[224:227], a[176:179], a[32:35], v[224:227]
ds_read_b128 a[216:219], v17 offset:55296
v_mfma_f32_16x16x32_bf16 v[224:227], a[180:183], a[36:39], v[224:227]
v_cvt_pk_bf16_f32 v65, v66, v67
v_mfma_f32_16x16x32_bf16 v[232:235], a[176:179], a[40:43], v[232:235]
s_add_u32 s34, s33, 0
buffer_load_dwordx4 a[240:243], v4, s[48:51], s34 offen sc1
v_mfma_f32_16x16x32_bf16 v[232:235], a[180:183], a[44:47], v[232:235]
v_cvt_pk_bf16_f32 v66, v68, v69
v_mfma_f32_16x16x32_bf16 v[240:243], a[176:179], a[48:51], v[240:243]
v_cvt_pk_bf16_f32 v67, v70, v71
v_mfma_f32_16x16x32_bf16 v[240:243], a[180:183], a[52:55], v[240:243]
ds_read_b128 a[220:223], v18 offset:55296
v_mfma_f32_16x16x32_bf16 v[248:251], a[176:179], a[56:59], v[248:251]
s_add_u32 s53, s56, 4096
buffer_store_dwordx4 v[64:67], v4, s[16:19], s53 offen offset:0
v_mfma_f32_16x16x32_bf16 v[248:251], a[180:183], a[60:63], v[248:251]
v_cvt_pk_bf16_f32 v72, v72, v73
v_mfma_f32_16x16x32_bf16 a[0:3], a[176:179], a[64:67], a[0:3]
v_cvt_pk_bf16_f32 v73, v74, v75
v_mfma_f32_16x16x32_bf16 a[0:3], a[180:183], a[68:71], a[0:3]
buffer_load_dwordx4 a[244:247], v4, s[48:51], s34 offen offset:1024 sc1
v_mfma_f32_16x16x32_bf16 a[8:11], a[176:179], a[72:75], a[8:11]
v_cvt_pk_bf16_f32 v74, v76, v77
v_mfma_f32_16x16x32_bf16 a[8:11], a[180:183], a[76:79], a[8:11]
v_mfma_f32_16x16x32_bf16 a[16:19], a[176:179], a[80:83], a[16:19]
v_cvt_pk_bf16_f32 v75, v78, v79
v_mfma_f32_16x16x32_bf16 a[16:19], a[180:183], a[84:87], a[16:19]
buffer_store_dwordx4 v[72:75], v4, s[16:19], s53 offen offset:1024
v_mfma_f32_16x16x32_bf16 a[24:27], a[176:179], a[88:91], a[24:27]
v_cvt_pk_bf16_f32 v80, v80, v81
v_mfma_f32_16x16x32_bf16 a[24:27], a[180:183], a[92:95], a[24:27]
v_mfma_f32_16x16x32_bf16 v[228:231], a[184:187], a[32:35], v[228:231]
v_cvt_pk_bf16_f32 v81, v82, v83
v_mfma_f32_16x16x32_bf16 v[228:231], a[188:191], a[36:39], v[228:231]
s_add_u32 s34, s33, 20480
buffer_load_dwordx4 a[248:251], v4, s[48:51], s34 offen sc1
v_mfma_f32_16x16x32_bf16 v[236:239], a[184:187], a[40:43], v[236:239]
v_cvt_pk_bf16_f32 v82, v84, v85
v_mfma_f32_16x16x32_bf16 v[236:239], a[188:191], a[44:47], v[236:239]
v_cvt_pk_bf16_f32 v83, v86, v87
v_mfma_f32_16x16x32_bf16 v[244:247], a[184:187], a[48:51], v[244:247]
buffer_store_dwordx4 v[80:83], v4, s[16:19], s53 offen offset:2048
v_mfma_f32_16x16x32_bf16 v[244:247], a[188:191], a[52:55], v[244:247]
v_mfma_f32_16x16x32_bf16 v[252:255], a[184:187], a[56:59], v[252:255]
v_cvt_pk_bf16_f32 v88, v88, v89
v_mfma_f32_16x16x32_bf16 v[252:255], a[188:191], a[60:63], v[252:255]
v_cvt_pk_bf16_f32 v89, v90, v91
v_mfma_f32_16x16x32_bf16 a[4:7], a[184:187], a[64:67], a[4:7]
buffer_load_dwordx4 a[252:255], v4, s[48:51], s34 offen offset:1024 sc1
v_mfma_f32_16x16x32_bf16 a[4:7], a[188:191], a[68:71], a[4:7]
v_cvt_pk_bf16_f32 v90, v92, v93
v_mfma_f32_16x16x32_bf16 a[12:15], a[184:187], a[72:75], a[12:15]
v_mfma_f32_16x16x32_bf16 a[12:15], a[188:191], a[76:79], a[12:15]
v_cvt_pk_bf16_f32 v91, v94, v95
buffer_store_dwordx4 v[88:91], v4, s[16:19], s53 offen offset:3072
v_mfma_f32_16x16x32_bf16 a[20:23], a[184:187], a[80:83], a[20:23]
v_mfma_f32_16x16x32_bf16 a[20:23], a[188:191], a[84:87], a[20:23]
v_mfma_f32_16x16x32_bf16 a[28:31], a[184:187], a[88:91], a[28:31]
v_mfma_f32_16x16x32_bf16 a[28:31], a[188:191], a[92:95], a[28:31]
s_waitcnt vmcnt(34) lgkmcnt(0)
s_barrier
v_mfma_f32_16x16x32_bf16 v[160:163], a[192:195], a[96:99], v[160:163]
v_cvt_pk_bf16_f32 v96, v96, v97
v_mfma_f32_16x16x32_bf16 v[160:163], a[196:199], a[100:103], v[160:163]
ds_read_b64_tr_b16 a[64:65], v21 offset:32768
v_mfma_f32_16x16x32_bf16 v[168:171], a[192:195], a[104:107], v[168:171]
v_cvt_pk_bf16_f32 v97, v98, v99
v_mfma_f32_16x16x32_bf16 v[168:171], a[196:199], a[108:111], v[168:171]
s_add_u32 s34, s32, 2048
buffer_load_dwordx4 a[160:163], v4, s[48:51], s34 offen sc1
v_mfma_f32_16x16x32_bf16 v[176:179], a[192:195], a[112:115], v[176:179]
v_cvt_pk_bf16_f32 v98, v100, v101
v_mfma_f32_16x16x32_bf16 v[176:179], a[196:199], a[116:119], v[176:179]
ds_read_b64_tr_b16 a[66:67], v21 offset:33792
v_mfma_f32_16x16x32_bf16 v[184:187], a[192:195], a[120:123], v[184:187]
v_cvt_pk_bf16_f32 v99, v102, v103
v_mfma_f32_16x16x32_bf16 v[184:187], a[196:199], a[124:127], v[184:187]
s_add_u32 s53, s56, 16384
buffer_store_dwordx4 v[96:99], v4, s[16:19], s53 offen offset:0
ds_read_b64_tr_b16 a[68:69], v21 offset:40960
v_mfma_f32_16x16x32_bf16 v[192:195], a[192:195], a[128:131], v[192:195]
v_cvt_pk_bf16_f32 v104, v104, v105
v_mfma_f32_16x16x32_bf16 v[192:195], a[196:199], a[132:135], v[192:195]
v_cvt_pk_bf16_f32 v105, v106, v107
v_mfma_f32_16x16x32_bf16 v[200:203], a[192:195], a[136:139], v[200:203]
ds_read_b64_tr_b16 a[70:71], v21 offset:41984
v_mfma_f32_16x16x32_bf16 v[200:203], a[196:199], a[140:143], v[200:203]
buffer_load_dwordx4 a[164:167], v4, s[48:51], s34 offen offset:1024 sc1
v_mfma_f32_16x16x32_bf16 v[208:211], a[192:195], a[144:147], v[208:211]
v_cvt_pk_bf16_f32 v106, v108, v109
v_mfma_f32_16x16x32_bf16 v[208:211], a[196:199], a[148:151], v[208:211]
v_cvt_pk_bf16_f32 v107, v110, v111
v_mfma_f32_16x16x32_bf16 v[216:219], a[192:195], a[152:155], v[216:219]
ds_read_b64_tr_b16 a[72:73], v22 offset:32768
buffer_store_dwordx4 v[104:107], v4, s[16:19], s53 offen offset:1024
v_mfma_f32_16x16x32_bf16 v[216:219], a[196:199], a[156:159], v[216:219]
s_branch kf_kernel_pl8
kf_kernel_pd8:
s_branch kf_kernel_pd12
kf_kernel_pl8:
v_cvt_pk_bf16_f32 v112, v112, v113
v_mfma_f32_16x16x32_bf16 v[164:167], a[200:203], a[96:99], v[164:167]
ds_read_b64_tr_b16 a[74:75], v22 offset:33792
v_mfma_f32_16x16x32_bf16 v[164:167], a[204:207], a[100:103], v[164:167]
v_cvt_pk_bf16_f32 v113, v114, v115
v_mfma_f32_16x16x32_bf16 v[172:175], a[200:203], a[104:107], v[172:175]
s_add_u32 s34, s32, 22528
buffer_load_dwordx4 a[168:171], v4, s[48:51], s34 offen sc1
v_mfma_f32_16x16x32_bf16 v[172:175], a[204:207], a[108:111], v[172:175]
v_cvt_pk_bf16_f32 v114, v116, v117
v_mfma_f32_16x16x32_bf16 v[180:183], a[200:203], a[112:115], v[180:183]
ds_read_b64_tr_b16 a[76:77], v22 offset:40960
v_mfma_f32_16x16x32_bf16 v[180:183], a[204:207], a[116:119], v[180:183]
v_cvt_pk_bf16_f32 v115, v118, v119
v_mfma_f32_16x16x32_bf16 v[188:191], a[200:203], a[120:123], v[188:191]
buffer_store_dwordx4 v[112:115], v4, s[16:19], s53 offen offset:2048
ds_read_b64_tr_b16 a[78:79], v22 offset:41984
v_mfma_f32_16x16x32_bf16 v[188:191], a[204:207], a[124:127], v[188:191]
v_cvt_pk_bf16_f32 v120, v120, v121
v_mfma_f32_16x16x32_bf16 v[196:199], a[200:203], a[128:131], v[196:199]
v_cvt_pk_bf16_f32 v121, v122, v123
v_mfma_f32_16x16x32_bf16 v[196:199], a[204:207], a[132:135], v[196:199]
ds_read_b64_tr_b16 a[80:81], v23 offset:32768
v_mfma_f32_16x16x32_bf16 v[204:207], a[200:203], a[136:139], v[204:207]
buffer_load_dwordx4 a[172:175], v4, s[48:51], s34 offen offset:1024 sc1
v_mfma_f32_16x16x32_bf16 v[204:207], a[204:207], a[140:143], v[204:207]
v_cvt_pk_bf16_f32 v122, v124, v125
v_mfma_f32_16x16x32_bf16 v[212:215], a[200:203], a[144:147], v[212:215]
v_cvt_pk_bf16_f32 v123, v126, v127
v_mfma_f32_16x16x32_bf16 v[212:215], a[204:207], a[148:151], v[212:215]
ds_read_b64_tr_b16 a[82:83], v23 offset:33792
buffer_store_dwordx4 v[120:123], v4, s[16:19], s53 offen offset:3072
v_mfma_f32_16x16x32_bf16 v[220:223], a[200:203], a[152:155], v[220:223]
v_cvt_pk_bf16_f32 v128, v128, v129
v_mfma_f32_16x16x32_bf16 v[220:223], a[204:207], a[156:159], v[220:223]
ds_read_b64_tr_b16 a[84:85], v23 offset:40960
v_mfma_f32_16x16x32_bf16 v[224:227], a[208:211], a[96:99], v[224:227]
v_cvt_pk_bf16_f32 v129, v130, v131
v_mfma_f32_16x16x32_bf16 v[224:227], a[212:215], a[100:103], v[224:227]
s_add_u32 s34, s33, 2048
buffer_load_dwordx4 a[176:179], v4, s[48:51], s34 offen sc1
v_mfma_f32_16x16x32_bf16 v[232:235], a[208:211], a[104:107], v[232:235]
v_cvt_pk_bf16_f32 v130, v132, v133
v_mfma_f32_16x16x32_bf16 v[232:235], a[212:215], a[108:111], v[232:235]
ds_read_b64_tr_b16 a[86:87], v23 offset:41984
v_mfma_f32_16x16x32_bf16 v[240:243], a[208:211], a[112:115], v[240:243]
v_cvt_pk_bf16_f32 v131, v134, v135
v_mfma_f32_16x16x32_bf16 v[240:243], a[212:215], a[116:119], v[240:243]
s_add_u32 s53, s13, 20480
buffer_store_dwordx4 v[128:131], v4, s[16:19], s53 offen offset:0
ds_read_b64_tr_b16 a[88:89], v24 offset:32768
v_mfma_f32_16x16x32_bf16 v[248:251], a[208:211], a[120:123], v[248:251]
v_cvt_pk_bf16_f32 v136, v136, v137
v_mfma_f32_16x16x32_bf16 v[248:251], a[212:215], a[124:127], v[248:251]
v_cvt_pk_bf16_f32 v137, v138, v139
v_mfma_f32_16x16x32_bf16 a[0:3], a[208:211], a[128:131], a[0:3]
ds_read_b64_tr_b16 a[90:91], v24 offset:33792
v_mfma_f32_16x16x32_bf16 a[0:3], a[212:215], a[132:135], a[0:3]
buffer_load_dwordx4 a[180:183], v4, s[48:51], s34 offen offset:1024 sc1
v_mfma_f32_16x16x32_bf16 a[8:11], a[208:211], a[136:139], a[8:11]
v_cvt_pk_bf16_f32 v138, v140, v141
v_mfma_f32_16x16x32_bf16 a[8:11], a[212:215], a[140:143], a[8:11]
v_cvt_pk_bf16_f32 v139, v142, v143
v_mfma_f32_16x16x32_bf16 a[16:19], a[208:211], a[144:147], a[16:19]
ds_read_b64_tr_b16 a[92:93], v24 offset:40960
buffer_store_dwordx4 v[136:139], v4, s[16:19], s53 offen offset:1024
v_mfma_f32_16x16x32_bf16 a[16:19], a[212:215], a[148:151], a[16:19]
v_cvt_pk_bf16_f32 v144, v144, v145
v_mfma_f32_16x16x32_bf16 a[24:27], a[208:211], a[152:155], a[24:27]
ds_read_b64_tr_b16 a[94:95], v24 offset:41984
v_mfma_f32_16x16x32_bf16 a[24:27], a[212:215], a[156:159], a[24:27]
v_cvt_pk_bf16_f32 v145, v146, v147
v_mfma_f32_16x16x32_bf16 v[228:231], a[216:219], a[96:99], v[228:231]
s_add_u32 s34, s33, 22528
buffer_load_dwordx4 a[184:187], v4, s[48:51], s34 offen sc1
v_mfma_f32_16x16x32_bf16 v[228:231], a[220:223], a[100:103], v[228:231]
v_cvt_pk_bf16_f32 v146, v148, v149
v_mfma_f32_16x16x32_bf16 v[236:239], a[216:219], a[104:107], v[236:239]
v_mfma_f32_16x16x32_bf16 v[236:239], a[220:223], a[108:111], v[236:239]
v_cvt_pk_bf16_f32 v147, v150, v151
v_mfma_f32_16x16x32_bf16 v[244:247], a[216:219], a[112:115], v[244:247]
buffer_store_dwordx4 v[144:147], v4, s[16:19], s53 offen offset:2048
v_mfma_f32_16x16x32_bf16 v[244:247], a[220:223], a[116:119], v[244:247]
v_cvt_pk_bf16_f32 v152, v152, v153
v_mfma_f32_16x16x32_bf16 v[252:255], a[216:219], a[120:123], v[252:255]
v_cvt_pk_bf16_f32 v153, v154, v155
v_mfma_f32_16x16x32_bf16 v[252:255], a[220:223], a[124:127], v[252:255]
v_mfma_f32_16x16x32_bf16 a[4:7], a[216:219], a[128:131], a[4:7]
buffer_load_dwordx4 a[188:191], v4, s[48:51], s34 offen offset:1024 sc1
v_mfma_f32_16x16x32_bf16 a[4:7], a[220:223], a[132:135], a[4:7]
v_cvt_pk_bf16_f32 v154, v156, v157
v_mfma_f32_16x16x32_bf16 a[12:15], a[216:219], a[136:139], a[12:15]
v_cvt_pk_bf16_f32 v155, v158, v159
v_mfma_f32_16x16x32_bf16 a[12:15], a[220:223], a[140:143], a[12:15]
buffer_store_dwordx4 v[152:155], v4, s[16:19], s53 offen offset:3072
v_mfma_f32_16x16x32_bf16 a[20:23], a[216:219], a[144:147], a[20:23]
v_mfma_f32_16x16x32_bf16 a[20:23], a[220:223], a[148:151], a[20:23]
v_mfma_f32_16x16x32_bf16 a[28:31], a[216:219], a[152:155], a[28:31]
v_mfma_f32_16x16x32_bf16 a[28:31], a[220:223], a[156:159], a[28:31]
s_branch kf_kernel_pl9
kf_kernel_pd9:
s_branch kf_kernel_pd13
kf_kernel_pl9:
kf_kernel_z:
s_add_u32 s34, s32, 4096
s_waitcnt vmcnt(17) lgkmcnt(12)
ds_read_b64_tr_b16 a[96:97], v25 offset:32768
v_mfma_f32_16x16x32_bf16 v[32:35], a[64:67], a[224:227], 0
ds_read_b64_tr_b16 a[98:99], v25 offset:33792
ds_read_b64_tr_b16 a[100:101], v25 offset:40960
v_mfma_f32_16x16x32_bf16 v[32:35], a[68:71], a[228:231], v[32:35]
s_waitcnt lgkmcnt(11)
ds_read_b64_tr_b16 a[102:103], v25 offset:41984
ds_read_b64_tr_b16 a[104:105], v26 offset:32768
v_mfma_f32_16x16x32_bf16 v[64:67], a[64:67], a[232:235], 0
s_waitcnt lgkmcnt(9)
v_cvt_pk_bf16_f32 v248, v248, v249
v_cvt_pk_bf16_f32 v232, v232, v233
v_mfma_f32_16x16x32_bf16 v[64:67], a[68:71], a[236:239], v[64:67]
ds_read_b64_tr_b16 a[106:107], v26 offset:33792
v_cvt_pk_bf16_f32 v249, v250, v251
v_mfma_f32_16x16x32_bf16 v[96:99], a[64:67], a[240:243], 0
v_cvt_pk_bf16_f32 v233, v234, v235
v_mfma_f32_16x16x32_bf16 v[96:99], a[68:71], a[244:247], v[96:99]
ds_read_b64_tr_b16 a[108:109], v26 offset:40960
ds_read_b64_tr_b16 a[110:111], v26 offset:41984
v_mfma_f32_16x16x32_bf16 v[128:131], a[64:67], a[248:251], 0
buffer_load_dwordx4 a[192:195], v4, s[48:51], s34 offen sc1
v_mfma_f32_16x16x32_bf16 v[128:131], a[68:71], a[252:255], v[128:131]
v_cvt_pk_bf16_f32 v250, v252, v253
v_cvt_pk_bf16_f32 v240, v240, v241
v_mfma_f32_16x16x32_bf16 v[36:39], a[72:75], a[224:227], 0
v_cvt_pk_bf16_f32 v241, v242, v243
v_cvt_pk_bf16_f32 v224, v224, v225
v_mfma_f32_16x16x32_bf16 v[36:39], a[76:79], a[228:231], v[36:39]
v_cvt_pk_bf16_f32 v234, v236, v237
v_cvt_pk_bf16_f32 v235, v238, v239
v_mfma_f32_16x16x32_bf16 v[68:71], a[72:75], a[232:235], 0
s_waitcnt lgkmcnt(8)
buffer_load_dwordx4 a[196:199], v4, s[48:51], s34 offen offset:1024 sc1
v_mfma_f32_16x16x32_bf16 v[68:71], a[76:79], a[236:239], v[68:71]
ds_read_b64_tr_b16 a[112:113], v27 offset:32768
s_waitcnt lgkmcnt(5)
v_mfma_f32_16x16x32_bf16 v[100:103], a[72:75], a[240:243], 0
v_cvt_pk_bf16_f32 v225, v226, v227
v_cvt_pk_bf16_f32 v226, v228, v229
v_mfma_f32_16x16x32_bf16 v[100:103], a[76:79], a[244:247], v[100:103]
ds_read_b64_tr_b16 a[114:115], v27 offset:33792
ds_read_b64_tr_b16 a[116:117], v27 offset:40960
v_mfma_f32_16x16x32_bf16 v[132:135], a[72:75], a[248:251], 0
v_cvt_pk_bf16_f32 v229, v194, v195
v_cvt_pk_bf16_f32 v251, v254, v255
v_mfma_f32_16x16x32_bf16 v[132:135], a[76:79], a[252:255], v[132:135]
ds_read_b64_tr_b16 a[118:119], v27 offset:41984
ds_read_b64_tr_b16 a[120:121], v28 offset:32768
v_mfma_f32_16x16x32_bf16 v[40:43], a[80:83], a[224:227], 0
ds_read_b64_tr_b16 a[122:123], v28 offset:33792
v_mfma_f32_16x16x32_bf16 v[40:43], a[84:87], a[228:231], v[40:43]
s_add_u32 s34, s32, 24576
ds_read_b64_tr_b16 a[124:125], v28 offset:40960
v_cvt_pk_bf16_f32 v160, v160, v161
v_mfma_f32_16x16x32_bf16 v[72:75], a[80:83], a[232:235], 0
ds_read_b64_tr_b16 a[126:127], v28 offset:41984
v_cvt_pk_bf16_f32 v243, v246, v247
v_mfma_f32_16x16x32_bf16 v[72:75], a[84:87], a[236:239], v[72:75]
s_waitcnt lgkmcnt(8)
v_cvt_pk_bf16_f32 v242, v244, v245
v_mfma_f32_16x16x32_bf16 v[104:107], a[80:83], a[240:243], 0
v_mfma_f32_16x16x32_bf16 v[104:107], a[84:87], a[244:247], v[104:107]
v_cvt_pk_bf16_f32 v254, v220, v221
v_mfma_f32_16x16x32_bf16 v[136:139], a[80:83], a[248:251], 0
buffer_load_dwordx4 a[200:203], v4, s[48:51], s34 offen sc1
v_mfma_f32_16x16x32_bf16 v[136:139], a[84:87], a[252:255], v[136:139]
v_cvt_pk_bf16_f32 v161, v162, v163
v_mfma_f32_16x16x32_bf16 v[44:47], a[88:91], a[224:227], 0
v_cvt_pk_bf16_f32 v228, v192, v193
v_cvt_pk_bf16_f32 v253, v218, v219
v_mfma_f32_16x16x32_bf16 v[44:47], a[92:95], a[228:231], v[44:47]
v_cvt_pk_bf16_f32 v236, v200, v201
v_cvt_pk_bf16_f32 v239, v206, v207
v_mfma_f32_16x16x32_bf16 v[76:79], a[88:91], a[232:235], 0
ds_read_b64_tr_b16 a[64:65], v5 offset:0
v_cvt_pk_bf16_f32 v227, v230, v231
v_mfma_f32_16x16x32_bf16 v[76:79], a[92:95], a[236:239], v[76:79]
v_cvt_pk_bf16_f32 v255, v222, v223
v_cvt_pk_bf16_f32 v162, v164, v165
v_mfma_f32_16x16x32_bf16 v[108:111], a[88:91], a[240:243], 0
ds_read_b64_tr_b16 a[66:67], v5 offset:512
v_mfma_f32_16x16x32_bf16 v[108:111], a[92:95], a[244:247], v[108:111]
buffer_load_dwordx4 a[204:207], v4, s[48:51], s34 offen offset:1024 sc1
v_mfma_f32_16x16x32_bf16 v[140:143], a[88:91], a[248:251], 0
v_cvt_pk_bf16_f32 v168, v168, v169
v_cvt_pk_bf16_f32 v244, v208, v209
v_mfma_f32_16x16x32_bf16 v[140:143], a[92:95], a[252:255], v[140:143]
v_cvt_pk_bf16_f32 v245, v210, v211
v_mfma_f32_16x16x32_bf16 v[48:51], a[96:99], a[224:227], 0
ds_read_b64_tr_b16 a[68:69], v5 offset:4096
v_cvt_pk_bf16_f32 v169, v170, v171
v_mfma_f32_16x16x32_bf16 v[48:51], a[100:103], a[228:231], v[48:51]
v_cvt_pk_bf16_f32 v238, v204, v205
v_cvt_pk_bf16_f32 v163, v166, v167
v_mfma_f32_16x16x32_bf16 v[80:83], a[96:99], a[232:235], 0
v_cvt_pk_bf16_f32 v247, v214, v215
v_mfma_f32_16x16x32_bf16 v[80:83], a[100:103], a[236:239], v[80:83]
s_add_u32 s34, s33, 4096
v_cvt_pk_bf16_f32 v252, v216, v217
v_cvt_pk_bf16_f32 v237, v202, v203
v_mfma_f32_16x16x32_bf16 v[112:115], a[96:99], a[240:243], 0
s_waitcnt lgkmcnt(7)
v_cvt_pk_bf16_f32 v170, v172, v173
s_add_u32 s53, s12, 524288
v_mfma_f32_16x16x32_bf16 v[112:115], a[100:103], a[244:247], v[112:115]
s_waitcnt lgkmcnt(3)
ds_read_b64_tr_b16 a[70:71], v5 offset:4608
ds_read_b64_tr_b16 a[72:73], v6 offset:0
v_mfma_f32_16x16x32_bf16 v[144:147], a[96:99], a[248:251], 0
buffer_load_dwordx4 a[208:211], v4, s[48:51], s34 offen sc1
v_mfma_f32_16x16x32_bf16 v[144:147], a[100:103], a[252:255], v[144:147]
ds_read_b64_tr_b16 a[74:75], v6 offset:512
v_mfma_f32_16x16x32_bf16 v[52:55], a[104:107], a[224:227], 0
ds_read_b64_tr_b16 a[76:77], v6 offset:4096
ds_read_b64_tr_b16 a[78:79], v6 offset:4608
v_mfma_f32_16x16x32_bf16 v[52:55], a[108:111], a[228:231], v[52:55]
ds_read_b64_tr_b16 a[80:81], v7 offset:0
v_cvt_pk_bf16_f32 v230, v196, v197
v_mfma_f32_16x16x32_bf16 v[84:87], a[104:107], a[232:235], 0
buffer_store_dwordx4 v[160:163], v4, s[16:19], s53 offen offset:0
v_mfma_f32_16x16x32_bf16 v[84:87], a[108:111], a[236:239], v[84:87]
v_cvt_pk_bf16_f32 v171, v174, v175
v_mfma_f32_16x16x32_bf16 v[116:119], a[104:107], a[240:243], 0
v_cvt_pk_bf16_f32 v176, v176, v177
v_cvt_pk_bf16_f32 v231, v198, v199
v_mfma_f32_16x16x32_bf16 v[116:119], a[108:111], a[244:247], v[116:119]
buffer_load_dwordx4 a[212:215], v4, s[48:51], s34 offen offset:1024 sc1
v_mfma_f32_16x16x32_bf16 v[148:151], a[104:107], a[248:251], 0
s_add_u32 s29, s27, 2097152
ds_read_b64_tr_b16 a[82:83], v7 offset:512
ds_read_b64_tr_b16 a[84:85], v7 offset:4096
v_mfma_f32_16x16x32_bf16 v[148:151], a[108:111], a[252:255], v[148:151]
buffer_store_dwordx4 v[168:171], v4, s[16:19], s53 offen offset:1024
v_mfma_f32_16x16x32_bf16 v[56:59], a[112:115], a[224:227], 0
ds_read_b64_tr_b16 a[86:87], v7 offset:4608
ds_read_b64_tr_b16 a[88:89], v8 offset:0
v_mfma_f32_16x16x32_bf16 v[56:59], a[116:119], a[228:231], v[56:59]
v_mfma_f32_16x16x32_bf16 v[88:91], a[112:115], a[232:235], 0
ds_read_b64_tr_b16 a[90:91], v8 offset:512
ds_read_b64_tr_b16 a[92:93], v8 offset:4096
v_mfma_f32_16x16x32_bf16 v[88:91], a[116:119], a[236:239], v[88:91]
s_add_u32 s34, s33, 24576
v_cvt_pk_bf16_f32 v177, v178, v179
v_mfma_f32_16x16x32_bf16 v[120:123], a[112:115], a[240:243], 0
v_cvt_pk_bf16_f32 v246, v212, v213
v_cvt_pk_bf16_f32 v179, v182, v183
v_mfma_f32_16x16x32_bf16 v[120:123], a[116:119], a[244:247], v[120:123]
v_cvt_pk_bf16_f32 v178, v180, v181
v_cvt_pk_bf16_f32 v184, v184, v185
v_mfma_f32_16x16x32_bf16 v[152:155], a[112:115], a[248:251], 0
buffer_load_dwordx4 a[216:219], v4, s[48:51], s34 offen sc1
v_mfma_f32_16x16x32_bf16 v[152:155], a[116:119], a[252:255], v[152:155]
buffer_store_dwordx4 v[176:179], v4, s[16:19], s53 offen offset:2048
v_mfma_f32_16x16x32_bf16 v[60:63], a[120:123], a[224:227], 0
ds_read_b64_tr_b16 a[94:95], v8 offset:4608
v_mfma_f32_16x16x32_bf16 v[60:63], a[124:127], a[228:231], v[60:63]
v_mfma_f32_16x16x32_bf16 v[92:95], a[120:123], a[232:235], 0
s_add_u32 m0, s28, 98304
v_cvt_pk_bf16_f32 v185, v186, v187
v_cvt_pk_bf16_f32 v187, v190, v191
v_mfma_f32_16x16x32_bf16 v[92:95], a[124:127], a[236:239], v[92:95]
v_cvt_pk_bf16_f32 v186, v188, v189
v_mfma_f32_16x16x32_bf16 v[124:127], a[120:123], a[240:243], 0
buffer_store_dwordx4 v[184:187], v4, s[16:19], s53 offen offset:3072
v_mfma_f32_16x16x32_bf16 v[124:127], a[124:127], a[244:247], v[124:127]
buffer_load_dwordx4 a[220:223], v4, s[48:51], s34 offen offset:1024 sc1
v_mfma_f32_16x16x32_bf16 v[156:159], a[120:123], a[248:251], 0
v_mfma_f32_16x16x32_bf16 v[156:159], a[124:127], a[252:255], v[156:159]
s_waitcnt vmcnt(58) lgkmcnt(12)
s_barrier
v_mfma_f32_16x16x32_bf16 v[160:163], a[64:67], a[224:227], 0
ds_read_b64_tr_b16 a[96:97], v21 offset:49152
ds_read_b64_tr_b16 a[98:99], v21 offset:50176
v_mfma_f32_16x16x32_bf16 v[160:163], a[68:71], a[228:231], v[160:163]
ds_read_b64_tr_b16 a[100:101], v21 offset:57344
ds_read_b64_tr_b16 a[102:103], v21 offset:58368
v_mfma_f32_16x16x32_bf16 v[176:179], a[64:67], a[232:235], 0
ds_read_b64_tr_b16 a[104:105], v22 offset:49152
ds_read_b64_tr_b16 a[106:107], v22 offset:50176
v_mfma_f32_16x16x32_bf16 v[176:179], a[68:71], a[236:239], v[176:179]
ds_read_b64_tr_b16 a[108:109], v22 offset:57344
ds_read_b64_tr_b16 a[110:111], v22 offset:58368
v_mfma_f32_16x16x32_bf16 v[192:195], a[64:67], a[240:243], 0
ds_read_b64_tr_b16 a[112:113], v23 offset:49152
v_mfma_f32_16x16x32_bf16 v[192:195], a[68:71], a[244:247], v[192:195]
buffer_load_dwordx4 v9, s[44:47], s29 offen offset:0 lds
v_mfma_f32_16x16x32_bf16 v[208:211], a[64:67], a[248:251], 0
ds_read_b64_tr_b16 a[114:115], v23 offset:50176
ds_read_b64_tr_b16 a[116:117], v23 offset:57344
v_mfma_f32_16x16x32_bf16 v[208:211], a[68:71], a[252:255], v[208:211]
s_waitcnt lgkmcnt(15)
v_mfma_f32_16x16x32_bf16 v[164:167], a[72:75], a[224:227], 0
v_mfma_f32_16x16x32_bf16 v[164:167], a[76:79], a[228:231], v[164:167]
ds_read_b64_tr_b16 a[118:119], v23 offset:58368
s_add_u32 s34, s32, 6144
v_mfma_f32_16x16x32_bf16 v[180:183], a[72:75], a[232:235], 0
s_waitcnt lgkmcnt(15)
v_mfma_f32_16x16x32_bf16 v[180:183], a[76:79], a[236:239], v[180:183]
s_waitcnt lgkmcnt(12)
buffer_load_dwordx4 v10, s[44:47], s29 offen offset:1024 lds
v_mfma_f32_16x16x32_bf16 v[196:199], a[72:75], a[240:243], 0
ds_read_b64_tr_b16 a[120:121], v24 offset:49152
ds_read_b64_tr_b16 a[122:123], v24 offset:50176
v_mfma_f32_16x16x32_bf16 v[196:199], a[76:79], a[244:247], v[196:199]
ds_read_b64_tr_b16 a[124:125], v24 offset:57344
ds_read_b64_tr_b16 a[126:127], v24 offset:58368
v_mfma_f32_16x16x32_bf16 v[212:215], a[72:75], a[248:251], 0
v_mfma_f32_16x16x32_bf16 v[212:215], a[76:79], a[252:255], v[212:215]
buffer_load_dwordx4 v11, s[44:47], s29 offen offset:2048 lds
v_mfma_f32_16x16x32_bf16 v[168:171], a[80:83], a[224:227], 0
v_mfma_f32_16x16x32_bf16 v[168:171], a[84:87], a[228:231], v[168:171]
v_mfma_f32_16x16x32_bf16 v[184:187], a[80:83], a[232:235], 0
v_mfma_f32_16x16x32_bf16 v[184:187], a[84:87], a[236:239], v[184:187]
v_mfma_f32_16x16x32_bf16 v[200:203], a[80:83], a[240:243], 0
buffer_load_dwordx4 v12, s[44:47], s29 offen offset:3072 lds
v_mfma_f32_16x16x32_bf16 v[200:203], a[84:87], a[244:247], v[200:203]
global_load_dword v31, v4, s[98:99]
v_mfma_f32_16x16x32_bf16 v[216:219], a[80:83], a[248:251], 0
v_mfma_f32_16x16x32_bf16 v[216:219], a[84:87], a[252:255], v[216:219]
v_mfma_f32_16x16x32_bf16 v[172:175], a[88:91], a[224:227], 0
v_mfma_f32_16x16x32_bf16 v[172:175], a[92:95], a[228:231], v[172:175]
v_mfma_f32_16x16x32_bf16 v[188:191], a[88:91], a[232:235], 0
v_mfma_f32_16x16x32_bf16 v[188:191], a[92:95], a[236:239], v[188:191]
v_mfma_f32_16x16x32_bf16 v[204:207], a[88:91], a[240:243], 0
v_mfma_f32_16x16x32_bf16 v[204:207], a[92:95], a[244:247], v[204:207]
buffer_load_dwordx4 a[128:131], v4, s[48:51], s34 offen sc1
v_mfma_f32_16x16x32_bf16 v[220:223], a[88:91], a[248:251], 0
s_waitcnt vmcnt(19) lgkmcnt(12)
ds_read_b64_tr_b16 a[64:65], v25 offset:49152
ds_read_b64_tr_b16 a[66:67], v25 offset:50176
v_mfma_f32_16x16x32_bf16 v[220:223], a[92:95], a[252:255], v[220:223]
ds_read_b64_tr_b16 a[68:69], v25 offset:57344
ds_read_b64_tr_b16 a[70:71], v25 offset:58368
v_mfma_f32_16x16x32_bf16 v[32:35], a[96:99], a[160:163], v[32:35]
s_waitcnt lgkmcnt(12)
ds_read_b64_tr_b16 a[72:73], v26 offset:49152
ds_read_b64_tr_b16 a[74:75], v26 offset:50176
v_mfma_f32_16x16x32_bf16 v[32:35], a[100:103], a[164:167], v[32:35]
s_waitcnt lgkmcnt(10)
ds_read_b64_tr_b16 a[76:77], v26 offset:57344
ds_read_b64_tr_b16 a[78:79], v26 offset:58368
v_mfma_f32_16x16x32_bf16 v[64:67], a[96:99], a[168:171], v[64:67]
ds_read_b64_tr_b16 a[80:81], v27 offset:49152
ds_read_b64_tr_b16 a[82:83], v27 offset:50176
v_mfma_f32_16x16x32_bf16 v[64:67], a[100:103], a[172:175], v[64:67]
s_add_u32 s53, s56, 528384
ds_read_b64_tr_b16 a[84:85], v27 offset:57344
ds_read_b64_tr_b16 a[86:87], v27 offset:58368
v_mfma_f32_16x16x32_bf16 v[96:99], a[96:99], a[176:179], v[96:99]
buffer_load_dwordx4 a[132:135], v4, s[48:51], s34 offen offset:1024 sc1
v_mfma_f32_16x16x32_bf16 v[96:99], a[100:103], a[180:183], v[96:99]
ds_read_b64_tr_b16 a[88:89], v28 offset:49152
ds_read_b64_tr_b16 a[90:91], v28 offset:50176
v_mfma_f32_16x16x32_bf16 v[128:131], a[96:99], a[184:187], v[128:131]
ds_read_b64_tr_b16 a[92:93], v28 offset:57344
v_mfma_f32_16x16x32_bf16 v[128:131], a[100:103], a[188:191], v[128:131]
v_mfma_f32_16x16x32_bf16 v[36:39], a[104:107], a[160:163], v[36:39]
ds_read_b64_tr_b16 a[94:95], v28 offset:58368
ds_read_b64_tr_b16 a[96:97], v5 offset:8192
v_mfma_f32_16x16x32_bf16 v[36:39], a[108:111], a[164:167], v[36:39]
buffer_store_dwordx4 v[228:231], v4, s[16:19], s53 offen offset:0
v_mfma_f32_16x16x32_bf16 v[68:71], a[104:107], a[168:171], v[68:71]
s_add_u32 s34, s32, 26624
ds_read_b64_tr_b16 a[98:99], v5 offset:8704
s_waitcnt lgkmcnt(15)
v_mfma_f32_16x16x32_bf16 v[68:71], a[108:111], a[172:175], v[68:71]
v_mfma_f32_16x16x32_bf16 v[100:103], a[104:107], a[176:179], v[100:103]
buffer_load_dwordx4 a[136:139], v4, s[48:51], s34 offen sc1
v_mfma_f32_16x16x32_bf16 v[100:103], a[108:111], a[180:183], v[100:103]
ds_read_b64_tr_b16 a[100:101], v5 offset:12288
v_mfma_f32_16x16x32_bf16 v[132:135], a[104:107], a[184:187], v[132:135]
ds_read_b64_tr_b16 a[102:103], v5 offset:12800
ds_read_b64_tr_b16 a[104:105], v6 offset:8192
v_mfma_f32_16x16x32_bf16 v[132:135], a[108:111], a[188:191], v[132:135]
ds_read_b64_tr_b16 a[106:107], v6 offset:8704
ds_read_b64_tr_b16 a[108:109], v6 offset:12288
v_mfma_f32_16x16x32_bf16 v[40:43], a[112:115], a[160:163], v[40:43]
v_mfma_f32_16x16x32_bf16 v[40:43], a[116:119], a[164:167], v[40:43]
v_mfma_f32_16x16x32_bf16 v[72:75], a[112:115], a[168:171], v[72:75]
ds_read_b64_tr_b16 a[110:111], v6 offset:12800
v_mfma_f32_16x16x32_bf16 v[72:75], a[116:119], a[172:175], v[72:75]
v_mfma_f32_16x16x32_bf16 v[104:107], a[112:115], a[176:179], v[104:107]
v_mfma_f32_16x16x32_bf16 v[104:107], a[116:119], a[180:183], v[104:107]
buffer_load_dwordx4 a[140:143], v4, s[48:51], s34 offen offset:1024 sc1
v_mfma_f32_16x16x32_bf16 v[136:139], a[112:115], a[184:187], v[136:139]
ds_read_b64_tr_b16 a[112:113], v7 offset:8192
s_waitcnt lgkmcnt(15)
v_mfma_f32_16x16x32_bf16 v[136:139], a[116:119], a[188:191], v[136:139]
ds_read_b64_tr_b16 a[114:115], v7 offset:8704
ds_read_b64_tr_b16 a[116:117], v7 offset:12288
v_mfma_f32_16x16x32_bf16 v[44:47], a[120:123], a[160:163], v[44:47]
buffer_store_dwordx4 v[236:239], v4, s[16:19], s53 offen offset:1024
v_mfma_f32_16x16x32_bf16 v[44:47], a[124:127], a[164:167], v[44:47]
ds_read_b64_tr_b16 a[118:119], v7 offset:12800
v_mfma_f32_16x16x32_bf16 v[76:79], a[120:123], a[168:171], v[76:79]
v_mfma_f32_16x16x32_bf16 v[76:79], a[124:127], a[172:175], v[76:79]
s_add_u32 s34, s33, 6144
v_mfma_f32_16x16x32_bf16 v[108:111], a[120:123], a[176:179], v[108:111]
buffer_load_dwordx4 a[144:147], v4, s[48:51], s34 offen sc1
v_mfma_f32_16x16x32_bf16 v[108:111], a[124:127], a[180:183], v[108:111]
s_waitcnt lgkmcnt(15)
v_mfma_f32_16x16x32_bf16 v[140:143], a[120:123], a[184:187], v[140:143]
ds_read_b64_tr_b16 a[120:121], v8 offset:8192
v_mfma_f32_16x16x32_bf16 v[140:143], a[124:127], a[188:191], v[140:143]
ds_read_b64_tr_b16 a[122:123], v8 offset:8704
ds_read_b64_tr_b16 a[124:125], v8 offset:12288
v_mfma_f32_16x16x32_bf16 v[48:51], a[64:67], a[160:163], v[48:51]
ds_read_b64_tr_b16 a[126:127], v8 offset:12800
v_mfma_f32_16x16x32_bf16 v[48:51], a[68:71], a[164:167], v[48:51]
v_mfma_f32_16x16x32_bf16 v[80:83], a[64:67], a[168:171], v[80:83]
v_mfma_f32_16x16x32_bf16 v[80:83], a[68:71], a[172:175], v[80:83]
v_mfma_f32_16x16x32_bf16 v[112:115], a[64:67], a[176:179], v[112:115]
v_mfma_f32_16x16x32_bf16 v[112:115], a[68:71], a[180:183], v[112:115]
buffer_load_dwordx4 a[148:151], v4, s[48:51], s34 offen offset:1024 sc1
v_mfma_f32_16x16x32_bf16 v[144:147], a[64:67], a[184:187], v[144:147]
s_waitcnt lgkmcnt(15)
s_waitcnt lgkmcnt(15)
v_mfma_f32_16x16x32_bf16 v[144:147], a[68:71], a[188:191], v[144:147]
buffer_store_dwordx4 v[244:247], v4, s[16:19], s53 offen offset:2048
v_mfma_f32_16x16x32_bf16 v[52:55], a[72:75], a[160:163], v[52:55]
v_mfma_f32_16x16x32_bf16 v[52:55], a[76:79], a[164:167], v[52:55]
v_mfma_f32_16x16x32_bf16 v[84:87], a[72:75], a[168:171], v[84:87]
v_mfma_f32_16x16x32_bf16 v[84:87], a[76:79], a[172:175], v[84:87]
s_add_u32 s34, s33, 26624
v_mfma_f32_16x16x32_bf16 v[116:119], a[72:75], a[176:179], v[116:119]
buffer_load_dwordx4 a[152:155], v4, s[48:51], s34 offen sc1
v_mfma_f32_16x16x32_bf16 v[116:119], a[76:79], a[180:183], v[116:119]
v_mfma_f32_16x16x32_bf16 v[148:151], a[72:75], a[184:187], v[148:151]
v_mfma_f32_16x16x32_bf16 v[148:151], a[76:79], a[188:191], v[148:151]
v_mfma_f32_16x16x32_bf16 v[56:59], a[80:83], a[160:163], v[56:59]
v_mfma_f32_16x16x32_bf16 v[56:59], a[84:87], a[164:167], v[56:59]
v_mfma_f32_16x16x32_bf16 v[88:91], a[80:83], a[168:171], v[88:91]
v_mfma_f32_16x16x32_bf16 v[88:91], a[84:87], a[172:175], v[88:91]
v_mfma_f32_16x16x32_bf16 v[120:123], a[80:83], a[176:179], v[120:123]
v_mfma_f32_16x16x32_bf16 v[120:123], a[84:87], a[180:183], v[120:123]
buffer_load_dwordx4 a[156:159], v4, s[48:51], s34 offen offset:1024 sc1
v_mfma_f32_16x16x32_bf16 v[152:155], a[80:83], a[184:187], v[152:155]
s_add_u32 s34, s32, 8192
v_mfma_f32_16x16x32_bf16 v[152:155], a[84:87], a[188:191], v[152:155]
buffer_store_dwordx4 v[252:255], v4, s[16:19], s53 offen offset:3072
v_mfma_f32_16x16x32_bf16 v[60:63], a[88:91], a[160:163], v[60:63]
v_mfma_f32_16x16x32_bf16 v[60:63], a[92:95], a[164:167], v[60:63]
v_mfma_f32_16x16x32_bf16 v[92:95], a[88:91], a[168:171], v[92:95]
v_mfma_f32_16x16x32_bf16 v[92:95], a[92:95], a[172:175], v[92:95]
buffer_load_dwordx4 a[32:35], v4, s[48:51], s34 offen sc1
v_mfma_f32_16x16x32_bf16 v[124:127], a[88:91], a[176:179], v[124:127]
v_mfma_f32_16x16x32_bf16 v[124:127], a[92:95], a[180:183], v[124:127]
v_mfma_f32_16x16x32_bf16 v[156:159], a[88:91], a[184:187], v[156:159]
buffer_load_dwordx4 a[36:39], v4, s[48:51], s34 offen offset:1024 sc1
v_mfma_f32_16x16x32_bf16 v[156:159], a[92:95], a[188:191], v[156:159]
s_waitcnt vmcnt(63) lgkmcnt(12)
s_barrier
v_mfma_f32_16x16x32_bf16 v[160:163], a[96:99], a[160:163], v[160:163]
s_add_u32 s34, s32, 28672
ds_read_b64_tr_b16 a[64:65], v21 offset:0
ds_read_b64_tr_b16 a[66:67], v21 offset:1024
v_mfma_f32_16x16x32_bf16 v[160:163], a[100:103], a[164:167], v[160:163]
ds_read_b64_tr_b16 a[68:69], v21 offset:8192
ds_read_b64_tr_b16 a[70:71], v21 offset:9216
v_mfma_f32_16x16x32_bf16 v[176:179], a[96:99], a[168:171], v[176:179]
s_waitcnt lgkmcnt(12)
ds_read_b64_tr_b16 a[72:73], v22 offset:0
ds_read_b64_tr_b16 a[74:75], v22 offset:1024
v_mfma_f32_16x16x32_bf16 v[176:179], a[100:103], a[172:175], v[176:179]
buffer_load_dwordx4 a[40:43], v4, s[48:51], s34 offen sc1
v_mfma_f32_16x16x32_bf16 v[192:195], a[96:99], a[176:179], v[192:195]
ds_read_b64_tr_b16 a[76:77], v22 offset:8192
v_mfma_f32_16x16x32_bf16 v[192:195], a[100:103], a[180:183], v[192:195]
ds_read_b64_tr_b16 a[78:79], v22 offset:9216
ds_read_b64_tr_b16 a[80:81], v23 offset:0
v_mfma_f32_16x16x32_bf16 v[208:211], a[96:99], a[184:187], v[208:211]
ds_read_b64_tr_b16 a[82:83], v23 offset:1024
ds_read_b64_tr_b16 a[84:85], v23 offset:8192
v_mfma_f32_16x16x32_bf16 v[208:211], a[100:103], a[188:191], v[208:211]
ds_read_b64_tr_b16 a[86:87], v23 offset:9216
v_mfma_f32_16x16x32_bf16 v[164:167], a[104:107], a[160:163], v[164:167]
s_waitcnt lgkmcnt(15)
s_waitcnt lgkmcnt(12)
v_mfma_f32_16x16x32_bf16 v[164:167], a[108:111], a[164:167], v[164:167]
ds_read_b64_tr_b16 a[88:89], v24 offset:0
ds_read_b64_tr_b16 a[90:91], v24 offset:1024
v_mfma_f32_16x16x32_bf16 v[180:183], a[104:107], a[168:171], v[180:183]
ds_read_b64_tr_b16 a[92:93], v24 offset:8192
ds_read_b64_tr_b16 a[94:95], v24 offset:9216
v_mfma_f32_16x16x32_bf16 v[180:183], a[108:111], a[172:175], v[180:183]
v_mfma_f32_16x16x32_bf16 v[196:199], a[104:107], a[176:179], v[196:199]
v_mfma_f32_16x16x32_bf16 v[196:199], a[108:111], a[180:183], v[196:199]
buffer_load_dwordx4 a[44:47], v4, s[48:51], s34 offen offset:1024 sc1
v_mfma_f32_16x16x32_bf16 v[212:215], a[104:107], a[184:187], v[212:215]
v_mfma_f32_16x16x32_bf16 v[212:215], a[108:111], a[188:191], v[212:215]
v_mfma_f32_16x16x32_bf16 v[168:171], a[112:115], a[160:163], v[168:171]
v_mfma_f32_16x16x32_bf16 v[168:171], a[116:119], a[164:167], v[168:171]
v_mfma_f32_16x16x32_bf16 v[184:187], a[112:115], a[168:171], v[184:187]
s_add_u32 s34, s33, 8192
v_mfma_f32_16x16x32_bf16 v[184:187], a[116:119], a[172:175], v[184:187]
v_mfma_f32_16x16x32_bf16 v[200:203], a[112:115], a[176:179], v[200:203]
s_add_u32 m0, s35, 131072
v_mfma_f32_16x16x32_bf16 v[200:203], a[116:119], a[180:183], v[200:203]
buffer_load_dwordx4 a[48:51], v4, s[48:51], s34 offen sc1
v_mfma_f32_16x16x32_bf16 v[216:219], a[112:115], a[184:187], v[216:219]
v_mfma_f32_16x16x32_bf16 v[216:219], a[116:119], a[188:191], v[216:219]
v_mfma_f32_16x16x32_bf16 v[172:175], a[120:123], a[160:163], v[172:175]
v_mfma_f32_16x16x32_bf16 v[172:175], a[124:127], a[164:167], v[172:175]
v_mfma_f32_16x16x32_bf16 v[188:191], a[120:123], a[168:171], v[188:191]
v_mfma_f32_16x16x32_bf16 v[188:191], a[124:127], a[172:175], v[188:191]
v_mfma_f32_16x16x32_bf16 v[204:207], a[120:123], a[176:179], v[204:207]
v_mfma_f32_16x16x32_bf16 v[204:207], a[124:127], a[180:183], v[204:207]
buffer_load_dwordx4 a[52:55], v4, s[48:51], s34 offen offset:1024 sc1
v_mfma_f32_16x16x32_bf16 v[220:223], a[120:123], a[184:187], v[220:223]
v_mfma_f32_16x16x32_bf16 v[220:223], a[124:127], a[188:191], v[220:223]
s_waitcnt vmcnt(23) lgkmcnt(12)
ds_read_b64_tr_b16 a[96:97], v25 offset:0
ds_read_b64_tr_b16 a[98:99], v25 offset:1024
v_mfma_f32_16x16x32_bf16 v[32:35], a[64:67], a[192:195], v[32:35]
ds_read_b64_tr_b16 a[100:101], v25 offset:8192
ds_read_b64_tr_b16 a[102:103], v25 offset:9216
v_mfma_f32_16x16x32_bf16 v[32:35], a[68:71], a[196:199], v[32:35]
s_waitcnt lgkmcnt(12)
ds_read_b64_tr_b16 a[104:105], v26 offset:0
ds_read_b64_tr_b16 a[106:107], v26 offset:1024
v_mfma_f32_16x16x32_bf16 v[64:67], a[64:67], a[200:203], v[64:67]
s_add_u32 s34, s33, 28672
s_waitcnt lgkmcnt(10)
ds_read_b64_tr_b16 a[108:109], v26 offset:8192
v_mfma_f32_16x16x32_bf16 v[64:67], a[68:71], a[204:207], v[64:67]
s_branch kf_kernel_pl10
kf_kernel_pd10:
s_branch kf_kernel_pd14
kf_kernel_pl10:
ds_read_b64_tr_b16 a[110:111], v26 offset:9216
ds_read_b64_tr_b16 a[112:113], v27 offset:0
v_mfma_f32_16x16x32_bf16 v[96:99], a[64:67], a[208:211], v[96:99]
s_add_u32 s53, s56, 540672
ds_read_b64_tr_b16 a[114:115], v27 offset:1024
ds_read_b64_tr_b16 a[116:117], v27 offset:8192
v_mfma_f32_16x16x32_bf16 v[96:99], a[68:71], a[212:215], v[96:99]
buffer_load_dwordx4 a[56:59], v4, s[48:51], s34 offen sc1
v_mfma_f32_16x16x32_bf16 v[128:131], a[64:67], a[216:219], v[128:131]
s_waitcnt lgkmcnt(11)
ds_read_b64_tr_b16 a[118:119], v27 offset:9216
ds_read_b64_tr_b16 a[120:121], v28 offset:0
v_mfma_f32_16x16x32_bf16 v[128:131], a[68:71], a[220:223], v[128:131]
v_mfma_f32_16x16x32_bf16 v[36:39], a[72:75], a[192:195], v[36:39]
ds_read_b64_tr_b16 a[122:123], v28 offset:1024
ds_read_b64_tr_b16 a[124:125], v28 offset:8192
v_mfma_f32_16x16x32_bf16 v[36:39], a[76:79], a[196:199], v[36:39]
buffer_store_dwordx4 v[224:227], v4, s[16:19], s53 offen offset:0
v_mfma_f32_16x16x32_bf16 v[68:71], a[72:75], a[200:203], v[68:71]
ds_read_b64_tr_b16 a[126:127], v28 offset:9216
ds_read_b64_tr_b16 a[64:65], v5 offset:16384
v_mfma_f32_16x16x32_bf16 v[68:71], a[76:79], a[204:207], v[68:71]
s_add_u32 s29, s54, 884736
ds_read_b64_tr_b16 a[66:67], v5 offset:16896
v_mfma_f32_16x16x32_bf16 v[100:103], a[72:75], a[208:211], v[100:103]
ds_read_b64_tr_b16 a[68:69], v5 offset:20480
ds_read_b64_tr_b16 a[70:71], v5 offset:20992
v_mfma_f32_16x16x32_bf16 v[100:103], a[76:79], a[212:215], v[100:103]
buffer_load_dwordx4 a[60:63], v4, s[48:51], s34 offen offset:1024 sc1
v_mfma_f32_16x16x32_bf16 v[132:135], a[72:75], a[216:219], v[132:135]
ds_read_b64_tr_b16 a[72:73], v6 offset:16384
v_mfma_f32_16x16x32_bf16 v[132:135], a[76:79], a[220:223], v[132:135]
ds_read_b64_tr_b16 a[74:75], v6 offset:16896
ds_read_b64_tr_b16 a[76:77], v6 offset:20480
v_mfma_f32_16x16x32_bf16 v[40:43], a[80:83], a[192:195], v[40:43]
s_add_u32 s34, s32, 10240
v_mfma_f32_16x16x32_bf16 v[40:43], a[84:87], a[196:199], v[40:43]
v_mfma_f32_16x16x32_bf16 v[72:75], a[80:83], a[200:203], v[72:75]
v_mfma_f32_16x16x32_bf16 v[72:75], a[84:87], a[204:207], v[72:75]
ds_read_b64_tr_b16 a[78:79], v6 offset:20992
v_mfma_f32_16x16x32_bf16 v[104:107], a[80:83], a[208:211], v[104:107]
v_mfma_f32_16x16x32_bf16 v[104:107], a[84:87], a[212:215], v[104:107]
buffer_load_dwordx4 v13, s[40:43], s29 offen offset:0 lds
v_mfma_f32_16x16x32_bf16 v[136:139], a[80:83], a[216:219], v[136:139]
ds_read_b64_tr_b16 a[80:81], v7 offset:16384
ds_read_b64_tr_b16 a[82:83], v7 offset:16896
v_mfma_f32_16x16x32_bf16 v[136:139], a[84:87], a[220:223], v[136:139]
s_waitcnt lgkmcnt(15)
ds_read_b64_tr_b16 a[84:85], v7 offset:20480
ds_read_b64_tr_b16 a[86:87], v7 offset:20992
v_mfma_f32_16x16x32_bf16 v[44:47], a[88:91], a[192:195], v[44:47]
buffer_store_dwordx4 v[232:235], v4, s[16:19], s53 offen offset:1024
v_mfma_f32_16x16x32_bf16 v[44:47], a[92:95], a[196:199], v[44:47]
v_mfma_f32_16x16x32_bf16 v[76:79], a[88:91], a[200:203], v[76:79]
v_mfma_f32_16x16x32_bf16 v[76:79], a[92:95], a[204:207], v[76:79]
v_mfma_f32_16x16x32_bf16 v[108:111], a[88:91], a[208:211], v[108:111]
v_mfma_f32_16x16x32_bf16 v[108:111], a[92:95], a[212:215], v[108:111]
buffer_load_dwordx4 v14, s[40:43], s29 offen offset:1024 lds
v_mfma_f32_16x16x32_bf16 v[140:143], a[88:91], a[216:219], v[140:143]
ds_read_b64_tr_b16 a[88:89], v8 offset:16384
v_mfma_f32_16x16x32_bf16 v[140:143], a[92:95], a[220:223], v[140:143]
ds_read_b64_tr_b16 a[90:91], v8 offset:16896
ds_read_b64_tr_b16 a[92:93], v8 offset:20480
v_mfma_f32_16x16x32_bf16 v[48:51], a[96:99], a[192:195], v[48:51]
ds_read_b64_tr_b16 a[94:95], v8 offset:20992
v_mfma_f32_16x16x32_bf16 v[48:51], a[100:103], a[196:199], v[48:51]
v_mfma_f32_16x16x32_bf16 v[80:83], a[96:99], a[200:203], v[80:83]
s_add_u32 m0, s28, 114688
s_waitcnt lgkmcnt(15)
s_add_u32 s29, s27, 2621440
v_mfma_f32_16x16x32_bf16 v[80:83], a[100:103], a[204:207], v[80:83]
s_waitcnt lgkmcnt(15)
v_mfma_f32_16x16x32_bf16 v[112:115], a[96:99], a[208:211], v[112:115]
v_mfma_f32_16x16x32_bf16 v[112:115], a[100:103], a[212:215], v[112:115]
buffer_load_dwordx4 v9, s[44:47], s29 offen offset:0 lds
v_mfma_f32_16x16x32_bf16 v[144:147], a[96:99], a[216:219], v[144:147]
ds_read_b64_tr_b16 a[96:97], v21 offset:16384
s_waitcnt lgkmcnt(15)
v_mfma_f32_16x16x32_bf16 v[144:147], a[100:103], a[220:223], v[144:147]
buffer_store_dwordx4 v[240:243], v4, s[16:19], s53 offen offset:2048
v_mfma_f32_16x16x32_bf16 v[52:55], a[104:107], a[192:195], v[52:55]
v_mfma_f32_16x16x32_bf16 v[52:55], a[108:111], a[196:199], v[52:55]
ds_read_b64_tr_b16 a[98:99], v21 offset:17408
v_mfma_f32_16x16x32_bf16 v[84:87], a[104:107], a[200:203], v[84:87]
v_mfma_f32_16x16x32_bf16 v[84:87], a[108:111], a[204:207], v[84:87]
buffer_load_dwordx4 v10, s[44:47], s29 offen offset:1024 lds
v_mfma_f32_16x16x32_bf16 v[116:119], a[104:107], a[208:211], v[116:119]
ds_read_b64_tr_b16 a[100:101], v21 offset:24576
ds_read_b64_tr_b16 a[102:103], v21 offset:25600
v_mfma_f32_16x16x32_bf16 v[116:119], a[108:111], a[212:215], v[116:119]
v_mfma_f32_16x16x32_bf16 v[148:151], a[104:107], a[216:219], v[148:151]
ds_read_b64_tr_b16 a[104:105], v22 offset:16384
ds_read_b64_tr_b16 a[106:107], v22 offset:17408
v_mfma_f32_16x16x32_bf16 v[148:151], a[108:111], a[220:223], v[148:151]
buffer_load_dwordx4 v11, s[44:47], s29 offen offset:2048 lds
v_mfma_f32_16x16x32_bf16 v[56:59], a[112:115], a[192:195], v[56:59]
v_mfma_f32_16x16x32_bf16 v[56:59], a[116:119], a[196:199], v[56:59]
ds_read_b64_tr_b16 a[108:109], v22 offset:24576
ds_read_b64_tr_b16 a[110:111], v22 offset:25600
v_mfma_f32_16x16x32_bf16 v[88:91], a[112:115], a[200:203], v[88:91]
v_mfma_f32_16x16x32_bf16 v[88:91], a[116:119], a[204:207], v[88:91]
buffer_load_dwordx4 v12, s[44:47], s29 offen offset:3072 lds
v_mfma_f32_16x16x32_bf16 v[120:123], a[112:115], a[208:211], v[120:123]
v_mfma_f32_16x16x32_bf16 v[120:123], a[116:119], a[212:215], v[120:123]
global_load_dword v31, v4, s[98:99]
v_mfma_f32_16x16x32_bf16 v[152:155], a[112:115], a[216:219], v[152:155]
ds_read_b64_tr_b16 a[112:113], v23 offset:16384
s_waitcnt lgkmcnt(15)
v_mfma_f32_16x16x32_bf16 v[152:155], a[116:119], a[220:223], v[152:155]
buffer_store_dwordx4 v[248:251], v4, s[16:19], s53 offen offset:3072
v_mfma_f32_16x16x32_bf16 v[60:63], a[120:123], a[192:195], v[60:63]
ds_read_b64_tr_b16 a[114:115], v23 offset:17408
ds_read_b64_tr_b16 a[116:117], v23 offset:24576
v_mfma_f32_16x16x32_bf16 v[60:63], a[124:127], a[196:199], v[60:63]
ds_read_b64_tr_b16 a[118:119], v23 offset:25600
v_mfma_f32_16x16x32_bf16 v[92:95], a[120:123], a[200:203], v[92:95]
s_waitcnt lgkmcnt(15)
s_waitcnt lgkmcnt(15)
v_mfma_f32_16x16x32_bf16 v[92:95], a[124:127], a[204:207], v[92:95]
v_mfma_f32_16x16x32_bf16 v[124:127], a[120:123], a[208:211], v[124:127]
v_mfma_f32_16x16x32_bf16 v[124:127], a[124:127], a[212:215], v[124:127]
buffer_load_dwordx4 a[224:227], v4, s[48:51], s34 offen sc1
v_mfma_f32_16x16x32_bf16 v[156:159], a[120:123], a[216:219], v[156:159]
s_waitcnt lgkmcnt(12)
ds_read_b64_tr_b16 a[120:121], v24 offset:16384
ds_read_b64_tr_b16 a[122:123], v24 offset:17408
v_mfma_f32_16x16x32_bf16 v[156:159], a[124:127], a[220:223], v[156:159]
ds_read_b64_tr_b16 a[124:125], v24 offset:24576
ds_read_b64_tr_b16 a[126:127], v24 offset:25600
v_mfma_f32_16x16x32_bf16 v[160:163], a[64:67], a[192:195], v[160:163]
v_mfma_f32_16x16x32_bf16 v[160:163], a[68:71], a[196:199], v[160:163]
v_mfma_f32_16x16x32_bf16 v[176:179], a[64:67], a[200:203], v[176:179]
v_mfma_f32_16x16x32_bf16 v[176:179], a[68:71], a[204:207], v[176:179]
v_mfma_f32_16x16x32_bf16 v[192:195], a[64:67], a[208:211], v[192:195]
v_mfma_f32_16x16x32_bf16 v[192:195], a[68:71], a[212:215], v[192:195]
buffer_load_dwordx4 a[228:231], v4, s[48:51], s34 offen offset:1024 sc1
v_mfma_f32_16x16x32_bf16 v[208:211], a[64:67], a[216:219], v[208:211]
v_mfma_f32_16x16x32_bf16 v[208:211], a[68:71], a[220:223], v[208:211]
v_mfma_f32_16x16x32_bf16 v[164:167], a[72:75], a[192:195], v[164:167]
v_mfma_f32_16x16x32_bf16 v[164:167], a[76:79], a[196:199], v[164:167]
v_mfma_f32_16x16x32_bf16 v[180:183], a[72:75], a[200:203], v[180:183]
v_mfma_f32_16x16x32_bf16 v[180:183], a[76:79], a[204:207], v[180:183]
v_mfma_f32_16x16x32_bf16 v[196:199], a[72:75], a[208:211], v[196:199]
s_add_u32 s34, s32, 30720
v_mfma_f32_16x16x32_bf16 v[196:199], a[76:79], a[212:215], v[196:199]
buffer_load_dwordx4 a[232:235], v4, s[48:51], s34 offen sc1
v_mfma_f32_16x16x32_bf16 v[212:215], a[72:75], a[216:219], v[212:215]
v_mfma_f32_16x16x32_bf16 v[212:215], a[76:79], a[220:223], v[212:215]
s_add_u32 m0, s35, 139264
v_mfma_f32_16x16x32_bf16 v[168:171], a[80:83], a[192:195], v[168:171]
v_mfma_f32_16x16x32_bf16 v[168:171], a[84:87], a[196:199], v[168:171]
v_mfma_f32_16x16x32_bf16 v[184:187], a[80:83], a[200:203], v[184:187]
v_mfma_f32_16x16x32_bf16 v[184:187], a[84:87], a[204:207], v[184:187]
v_mfma_f32_16x16x32_bf16 v[200:203], a[80:83], a[208:211], v[200:203]
buffer_load_dwordx4 a[236:239], v4, s[48:51], s34 offen offset:1024 sc1
v_mfma_f32_16x16x32_bf16 v[200:203], a[84:87], a[212:215], v[200:203]
v_mfma_f32_16x16x32_bf16 v[216:219], a[80:83], a[216:219], v[216:219]
s_add_u32 s34, s33, 10240
v_mfma_f32_16x16x32_bf16 v[216:219], a[84:87], a[220:223], v[216:219]
v_mfma_f32_16x16x32_bf16 v[172:175], a[88:91], a[192:195], v[172:175]
v_mfma_f32_16x16x32_bf16 v[172:175], a[92:95], a[196:199], v[172:175]
v_mfma_f32_16x16x32_bf16 v[188:191], a[88:91], a[200:203], v[188:191]
v_mfma_f32_16x16x32_bf16 v[188:191], a[92:95], a[204:207], v[188:191]
v_mfma_f32_16x16x32_bf16 v[204:207], a[88:91], a[208:211], v[204:207]
v_mfma_f32_16x16x32_bf16 v[204:207], a[92:95], a[212:215], v[204:207]
buffer_load_dwordx4 a[240:243], v4, s[48:51], s34 offen sc1
v_mfma_f32_16x16x32_bf16 v[220:223], a[88:91], a[216:219], v[220:223]
s_waitcnt vmcnt(25) lgkmcnt(12)
s_barrier
v_mfma_f32_16x16x32_bf16 v[220:223], a[92:95], a[220:223], v[220:223]
ds_read_b64_tr_b16 a[64:65], v25 offset:16384
ds_read_b64_tr_b16 a[66:67], v25 offset:17408
v_mfma_f32_16x16x32_bf16 v[32:35], a[96:99], a[128:131], v[32:35]
s_waitcnt lgkmcnt(10)
v_accvgpr_read_b32 v224, a0
s_waitcnt lgkmcnt(6)
v_mfma_f32_16x16x32_bf16 v[32:35], a[100:103], a[132:135], v[32:35]
ds_read_b64_tr_b16 a[68:69], v25 offset:24576
ds_read_b64_tr_b16 a[70:71], v25 offset:25600
v_mfma_f32_16x16x32_bf16 v[64:67], a[96:99], a[136:139], v[64:67]
v_accvgpr_read_b32 v225, a1
v_accvgpr_read_b32 v228, a4
v_mfma_f32_16x16x32_bf16 v[64:67], a[100:103], a[140:143], v[64:67]
ds_read_b64_tr_b16 a[72:73], v26 offset:16384
ds_read_b64_tr_b16 a[74:75], v26 offset:17408
v_mfma_f32_16x16x32_bf16 v[96:99], a[96:99], a[144:147], v[96:99]
ds_read_b64_tr_b16 a[76:77], v26 offset:24576
v_cvt_pk_bf16_f32 v224, v224, v225
v_mfma_f32_16x16x32_bf16 v[96:99], a[100:103], a[148:151], v[96:99]
s_waitcnt lgkmcnt(7)
buffer_load_dwordx4 a[244:247], v4, s[48:51], s34 offen offset:1024 sc1
v_mfma_f32_16x16x32_bf16 v[128:131], a[96:99], a[152:155], v[128:131]
s_add_u32 s29, s54, 1105920
ds_read_b64_tr_b16 a[78:79], v26 offset:25600
ds_read_b64_tr_b16 a[80:81], v27 offset:16384
v_mfma_f32_16x16x32_bf16 v[128:131], a[100:103], a[156:159], v[128:131]
v_accvgpr_read_b32 v226, a2
v_mfma_f32_16x16x32_bf16 v[36:39], a[104:107], a[128:131], v[36:39]
ds_read_b64_tr_b16 a[82:83], v27 offset:17408
ds_read_b64_tr_b16 a[84:85], v27 offset:24576
v_mfma_f32_16x16x32_bf16 v[36:39], a[108:111], a[132:135], v[36:39]
ds_read_b64_tr_b16 a[86:87], v27 offset:25600
v_accvgpr_read_b32 v227, a3
v_mfma_f32_16x16x32_bf16 v[68:71], a[104:107], a[136:139], v[68:71]
v_accvgpr_read_b32 v233, a9
s_add_u32 s34, s33, 30720
v_mfma_f32_16x16x32_bf16 v[68:71], a[108:111], a[140:143], v[68:71]
v_mfma_f32_16x16x32_bf16 v[100:103], a[104:107], a[144:147], v[100:103]
s_waitcnt lgkmcnt(8)
v_accvgpr_read_b32 v239, a15
v_cvt_pk_bf16_f32 v225, v226, v227
v_mfma_f32_16x16x32_bf16 v[100:103], a[108:111], a[148:151], v[100:103]
buffer_load_dwordx4 a[248:251], v4, s[48:51], s34 offen sc1
v_mfma_f32_16x16x32_bf16 v[132:135], a[104:107], a[152:155], v[132:135]
s_add_u32 s53, s13, 544768
ds_read_b64_tr_b16 a[88:89], v28 offset:16384
v_accvgpr_read_b32 v229, a5
v_mfma_f32_16x16x32_bf16 v[132:135], a[108:111], a[156:159], v[132:135]
ds_read_b64_tr_b16 a[90:91], v28 offset:17408
ds_read_b64_tr_b16 a[92:93], v28 offset:24576
v_mfma_f32_16x16x32_bf16 v[40:43], a[112:115], a[128:131], v[40:43]
v_accvgpr_read_b32 v236, a12
v_accvgpr_read_b32 v230, a6
v_mfma_f32_16x16x32_bf16 v[40:43], a[116:119], a[132:135], v[40:43]
ds_read_b64_tr_b16 a[94:95], v28 offset:25600
ds_read_b64_tr_b16 a[96:97], v5 offset:24576
v_mfma_f32_16x16x32_bf16 v[72:75], a[112:115], a[136:139], v[72:75]
v_accvgpr_read_b32 v232, a8
s_waitcnt lgkmcnt(9)
v_mfma_f32_16x16x32_bf16 v[72:75], a[116:119], a[140:143], v[72:75]
v_mfma_f32_16x16x32_bf16 v[104:107], a[112:115], a[144:147], v[104:107]
v_accvgpr_read_b32 v231, a7
v_cvt_pk_bf16_f32 v227, v230, v231
v_mfma_f32_16x16x32_bf16 v[104:107], a[116:119], a[148:151], v[104:107]
buffer_load_dwordx4 a[252:255], v4, s[48:51], s34 offen offset:1024 sc1
v_mfma_f32_16x16x32_bf16 v[136:139], a[112:115], a[152:155], v[136:139]
ds_read_b64_tr_b16 a[98:99], v5 offset:25088
v_mfma_f32_16x16x32_bf16 v[136:139], a[116:119], a[156:159], v[136:139]
v_cvt_pk_bf16_f32 v226, v228, v229
v_mfma_f32_16x16x32_bf16 v[44:47], a[120:123], a[128:131], v[44:47]
ds_read_b64_tr_b16 a[100:101], v5 offset:28672
ds_read_b64_tr_b16 a[102:103], v5 offset:29184
v_mfma_f32_16x16x32_bf16 v[44:47], a[124:127], a[132:135], v[44:47]
buffer_store_dwordx4 v[224:227], v4, s[16:19], s53 offen offset:0
v_mfma_f32_16x16x32_bf16 v[76:79], a[120:123], a[136:139], v[76:79]
v_mfma_f32_16x16x32_bf16 v[76:79], a[124:127], a[140:143], v[76:79]
buffer_load_dwordx4 v13, s[40:43], s29 offen offset:0 lds
v_mfma_f32_16x16x32_bf16 v[108:111], a[120:123], a[144:147], v[108:111]
v_accvgpr_read_b32 v235, a11
v_mfma_f32_16x16x32_bf16 v[108:111], a[124:127], a[148:151], v[108:111]
v_accvgpr_read_b32 v234, a10
v_mfma_f32_16x16x32_bf16 v[140:143], a[120:123], a[152:155], v[140:143]
v_cvt_pk_bf16_f32 v232, v232, v233
v_cvt_pk_bf16_f32 v233, v234, v235
v_mfma_f32_16x16x32_bf16 v[140:143], a[124:127], a[156:159], v[140:143]
buffer_load_dwordx4 v14, s[40:43], s29 offen offset:1024 lds
v_mfma_f32_16x16x32_bf16 v[48:51], a[64:67], a[128:131], v[48:51]
ds_read_b64_tr_b16 a[104:105], v6 offset:24576
s_add_u32 m0, s35, 147456
v_mfma_f32_16x16x32_bf16 v[48:51], a[68:71], a[132:135], v[48:51]
ds_read_b64_tr_b16 a[106:107], v6 offset:25088
v_mfma_f32_16x16x32_bf16 v[80:83], a[64:67], a[136:139], v[80:83]
s_waitcnt lgkmcnt(10)
v_accvgpr_read_b32 v238, a14
v_accvgpr_read_b32 v237, a13
v_mfma_f32_16x16x32_bf16 v[80:83], a[68:71], a[140:143], v[80:83]
s_waitcnt lgkmcnt(6)
v_cvt_pk_bf16_f32 v234, v236, v237
v_mfma_f32_16x16x32_bf16 v[112:115], a[64:67], a[144:147], v[112:115]
ds_read_b64_tr_b16 a[108:109], v6 offset:28672
ds_read_b64_tr_b16 a[110:111], v6 offset:29184
v_mfma_f32_16x16x32_bf16 v[112:115], a[68:71], a[148:151], v[112:115]
s_add_u32 s29, s54, 1327104
v_accvgpr_read_b32 v247, a23
v_cvt_pk_bf16_f32 v235, v238, v239
v_mfma_f32_16x16x32_bf16 v[144:147], a[64:67], a[152:155], v[144:147]
buffer_load_dwordx4 v13, s[40:43], s29 offen offset:0 lds
v_mfma_f32_16x16x32_bf16 v[144:147], a[68:71], a[156:159], v[144:147]
ds_read_b64_tr_b16 a[112:113], v7 offset:24576
v_mfma_f32_16x16x32_bf16 v[52:55], a[72:75], a[128:131], v[52:55]
ds_read_b64_tr_b16 a[114:115], v7 offset:25088
v_accvgpr_read_b32 v245, a21
v_mfma_f32_16x16x32_bf16 v[52:55], a[76:79], a[132:135], v[52:55]
ds_read_b64_tr_b16 a[116:117], v7 offset:28672
v_accvgpr_read_b32 v243, a19
v_mfma_f32_16x16x32_bf16 v[84:87], a[72:75], a[136:139], v[84:87]
ds_read_b64_tr_b16 a[118:119], v7 offset:29184
v_mfma_f32_16x16x32_bf16 v[84:87], a[76:79], a[140:143], v[84:87]
ds_read_b64_tr_b16 a[120:121], v8 offset:24576
ds_read_b64_tr_b16 a[122:123], v8 offset:25088
v_mfma_f32_16x16x32_bf16 v[116:119], a[72:75], a[144:147], v[116:119]
ds_read_b64_tr_b16 a[124:125], v8 offset:28672
v_mfma_f32_16x16x32_bf16 v[116:119], a[76:79], a[148:151], v[116:119]
buffer_load_dwordx4 v14, s[40:43], s29 offen offset:1024 lds
v_mfma_f32_16x16x32_bf16 v[148:151], a[72:75], a[152:155], v[148:151]
ds_read_b64_tr_b16 a[126:127], v8 offset:29184
v_mfma_f32_16x16x32_bf16 v[148:151], a[76:79], a[156:159], v[148:151]
s_add_u32 s29, s27, 3145728
v_accvgpr_read_b32 v240, a16
s_add_u32 m0, s28, 65536
v_mfma_f32_16x16x32_bf16 v[56:59], a[80:83], a[128:131], v[56:59]
buffer_store_dwordx4 v[232:235], v4, s[16:19], s53 offen offset:1024
v_mfma_f32_16x16x32_bf16 v[56:59], a[84:87], a[132:135], v[56:59]
ds_read_b64_tr_b16 a[64:65], v21 offset:32768
ds_read_b64_tr_b16 a[66:67], v21 offset:33792
v_mfma_f32_16x16x32_bf16 v[88:91], a[80:83], a[136:139], v[88:91]
ds_read_b64_tr_b16 a[68:69], v21 offset:40960
ds_read_b64_tr_b16 a[70:71], v21 offset:41984
v_mfma_f32_16x16x32_bf16 v[88:91], a[84:87], a[140:143], v[88:91]
ds_read_b64_tr_b16 a[72:73], v22 offset:32768
ds_read_b64_tr_b16 a[74:75], v22 offset:33792
v_mfma_f32_16x16x32_bf16 v[120:123], a[80:83], a[144:147], v[120:123]
ds_read_b64_tr_b16 a[76:77], v22 offset:40960
ds_read_b64_tr_b16 a[78:79], v22 offset:41984
v_mfma_f32_16x16x32_bf16 v[120:123], a[84:87], a[148:151], v[120:123]
buffer_load_dwordx4 v9, s[44:47], s29 offen offset:0 lds
v_mfma_f32_16x16x32_bf16 v[152:155], a[80:83], a[152:155], v[152:155]
s_waitcnt lgkmcnt(15)
s_waitcnt lgkmcnt(15)
v_accvgpr_read_b32 v249, a25
v_mfma_f32_16x16x32_bf16 v[152:155], a[84:87], a[156:159], v[152:155]
v_accvgpr_read_b32 v241, a17
v_mfma_f32_16x16x32_bf16 v[60:63], a[88:91], a[128:131], v[60:63]
v_mfma_f32_16x16x32_bf16 v[60:63], a[92:95], a[132:135], v[60:63]
v_cvt_pk_bf16_f32 v240, v240, v241
s_waitcnt lgkmcnt(12)
v_mfma_f32_16x16x32_bf16 v[92:95], a[88:91], a[136:139], v[92:95]
s_waitcnt lgkmcnt(8)
v_accvgpr_read_b32 v242, a18
v_cvt_pk_bf16_f32 v241, v242, v243
v_mfma_f32_16x16x32_bf16 v[92:95], a[92:95], a[140:143], v[92:95]
v_mfma_f32_16x16x32_bf16 v[124:127], a[88:91], a[144:147], v[124:127]
v_accvgpr_read_b32 v244, a20
v_accvgpr_read_b32 v246, a22
v_mfma_f32_16x16x32_bf16 v[124:127], a[92:95], a[148:151], v[124:127]
buffer_load_dwordx4 v10, s[44:47], s29 offen offset:1024 lds
v_mfma_f32_16x16x32_bf16 v[156:159], a[88:91], a[152:155], v[156:159]
ds_read_b64_tr_b16 a[80:81], v23 offset:32768
ds_read_b64_tr_b16 a[82:83], v23 offset:33792
v_mfma_f32_16x16x32_bf16 v[156:159], a[92:95], a[156:159], v[156:159]
ds_read_b64_tr_b16 a[84:85], v23 offset:40960
v_mfma_f32_16x16x32_bf16 v[160:163], a[96:99], a[128:131], v[160:163]
v_mfma_f32_16x16x32_bf16 v[160:163], a[100:103], a[132:135], v[160:163]
v_mfma_f32_16x16x32_bf16 v[176:179], a[96:99], a[136:139], v[176:179]
v_accvgpr_read_b32 v252, a28
v_mfma_f32_16x16x32_bf16 v[176:179], a[100:103], a[140:143], v[176:179]
v_accvgpr_read_b32 v248, a24
v_mfma_f32_16x16x32_bf16 v[192:195], a[96:99], a[144:147], v[192:195]
buffer_load_dwordx4 v11, s[44:47], s29 offen offset:2048 lds
v_mfma_f32_16x16x32_bf16 v[192:195], a[100:103], a[148:151], v[192:195]
v_cvt_pk_bf16_f32 v242, v244, v245
v_cvt_pk_bf16_f32 v243, v246, v247
v_mfma_f32_16x16x32_bf16 v[208:211], a[96:99], a[152:155], v[208:211]
ds_read_b64_tr_b16 a[86:87], v23 offset:41984
ds_read_b64_tr_b16 a[88:89], v24 offset:32768
v_mfma_f32_16x16x32_bf16 v[208:211], a[100:103], a[156:159], v[208:211]
buffer_store_dwordx4 v[240:243], v4, s[16:19], s53 offen offset:2048
v_mfma_f32_16x16x32_bf16 v[164:167], a[104:107], a[128:131], v[164:167]
ds_read_b64_tr_b16 a[90:91], v24 offset:33792
ds_read_b64_tr_b16 a[92:93], v24 offset:40960
v_mfma_f32_16x16x32_bf16 v[164:167], a[108:111], a[132:135], v[164:167]
v_accvgpr_read_b32 v251, a27
v_mfma_f32_16x16x32_bf16 v[180:183], a[104:107], a[136:139], v[180:183]
v_accvgpr_read_b32 v253, a29
v_mfma_f32_16x16x32_bf16 v[180:183], a[108:111], a[140:143], v[180:183]
v_mfma_f32_16x16x32_bf16 v[196:199], a[104:107], a[144:147], v[196:199]
ds_read_b64_tr_b16 a[94:95], v24 offset:41984
v_accvgpr_read_b32 v250, a26
v_mfma_f32_16x16x32_bf16 v[196:199], a[108:111], a[148:151], v[196:199]
buffer_load_dwordx4 v12, s[44:47], s29 offen offset:3072 lds
v_mfma_f32_16x16x32_bf16 v[212:215], a[104:107], a[152:155], v[212:215]
v_mfma_f32_16x16x32_bf16 v[212:215], a[108:111], a[156:159], v[212:215]
v_accvgpr_read_b32 v254, a30
v_mfma_f32_16x16x32_bf16 v[168:171], a[112:115], a[128:131], v[168:171]
s_add_u32 s34, s32, 14336
v_cvt_pk_bf16_f32 v248, v248, v249
v_accvgpr_read_b32 v255, a31
v_mfma_f32_16x16x32_bf16 v[168:171], a[116:119], a[132:135], v[168:171]
v_mfma_f32_16x16x32_bf16 v[184:187], a[112:115], a[136:139], v[184:187]
v_mfma_f32_16x16x32_bf16 v[184:187], a[116:119], a[140:143], v[184:187]
v_mfma_f32_16x16x32_bf16 v[200:203], a[112:115], a[144:147], v[200:203]
v_mfma_f32_16x16x32_bf16 v[200:203], a[116:119], a[148:151], v[200:203]
buffer_load_dwordx4 a[160:163], v4, s[48:51], s34 offen sc1
v_mfma_f32_16x16x32_bf16 v[216:219], a[112:115], a[152:155], v[216:219]
v_mfma_f32_16x16x32_bf16 v[216:219], a[116:119], a[156:159], v[216:219]
v_mfma_f32_16x16x32_bf16 v[172:175], a[120:123], a[128:131], v[172:175]
v_mfma_f32_16x16x32_bf16 v[172:175], a[124:127], a[132:135], v[172:175]
v_mfma_f32_16x16x32_bf16 v[188:191], a[120:123], a[136:139], v[188:191]
v_cvt_pk_bf16_f32 v249, v250, v251
v_cvt_pk_bf16_f32 v251, v254, v255
v_mfma_f32_16x16x32_bf16 v[188:191], a[124:127], a[140:143], v[188:191]
v_cvt_pk_bf16_f32 v250, v252, v253
v_mfma_f32_16x16x32_bf16 v[204:207], a[120:123], a[144:147], v[204:207]
v_mfma_f32_16x16x32_bf16 v[204:207], a[124:127], a[148:151], v[204:207]
buffer_load_dwordx4 a[164:167], v4, s[48:51], s34 offen offset:1024 sc1
v_mfma_f32_16x16x32_bf16 v[220:223], a[120:123], a[152:155], v[220:223]
buffer_store_dwordx4 v[248:251], v4, s[16:19], s53 offen offset:3072
v_mfma_f32_16x16x32_bf16 v[220:223], a[124:127], a[156:159], v[220:223]
s_waitcnt vmcnt(29) lgkmcnt(12)
s_barrier
v_mfma_f32_16x16x32_bf16 v[32:35], a[64:67], a[32:35], v[32:35]
ds_read_b64_tr_b16 a[96:97], v25 offset:32768
v_mfma_f32_16x16x32_bf16 v[32:35], a[68:71], a[36:39], v[32:35]
s_waitcnt lgkmcnt(9)
ds_read_b64_tr_b16 a[98:99], v25 offset:33792
ds_read_b64_tr_b16 a[100:101], v25 offset:40960
v_mfma_f32_16x16x32_bf16 v[64:67], a[64:67], a[40:43], v[64:67]
s_add_u32 s34, s32, 34816
ds_read_b64_tr_b16 a[102:103], v25 offset:41984
ds_read_b64_tr_b16 a[104:105], v26 offset:32768
v_mfma_f32_16x16x32_bf16 v[64:67], a[68:71], a[44:47], v[64:67]
buffer_load_dwordx4 a[168:171], v4, s[48:51], s34 offen sc1
v_mfma_f32_16x16x32_bf16 v[96:99], a[64:67], a[48:51], v[96:99]
ds_read_b64_tr_b16 a[106:107], v26 offset:33792
v_mfma_f32_16x16x32_bf16 v[96:99], a[68:71], a[52:55], v[96:99]
ds_read_b64_tr_b16 a[108:109], v26 offset:40960
ds_read_b64_tr_b16 a[110:111], v26 offset:41984
v_mfma_f32_16x16x32_bf16 v[128:131], a[64:67], a[56:59], v[128:131]
s_waitcnt lgkmcnt(12)
ds_read_b64_tr_b16 a[112:113], v27 offset:32768
ds_read_b64_tr_b16 a[114:115], v27 offset:33792
v_mfma_f32_16x16x32_bf16 v[128:131], a[68:71], a[60:63], v[128:131]
buffer_load_dwordx4 a[172:175], v4, s[48:51], s34 offen offset:1024 sc1
v_mfma_f32_16x16x32_bf16 v[36:39], a[72:75], a[32:35], v[36:39]
ds_read_b64_tr_b16 a[116:117], v27 offset:40960
ds_read_b64_tr_b16 a[118:119], v27 offset:41984
v_mfma_f32_16x16x32_bf16 v[36:39], a[76:79], a[36:39], v[36:39]
ds_read_b64_tr_b16 a[120:121], v28 offset:32768
ds_read_b64_tr_b16 a[122:123], v28 offset:33792
v_mfma_f32_16x16x32_bf16 v[68:71], a[72:75], a[40:43], v[68:71]
v_mfma_f32_16x16x32_bf16 v[68:71], a[76:79], a[44:47], v[68:71]
s_waitcnt lgkmcnt(14)
s_add_u32 s34, s33, 14336
ds_read_b64_tr_b16 a[124:125], v28 offset:40960
v_mfma_f32_16x16x32_bf16 v[100:103], a[72:75], a[48:51], v[100:103]
ds_read_b64_tr_b16 a[126:127], v28 offset:41984
v_mfma_f32_16x16x32_bf16 v[100:103], a[76:79], a[52:55], v[100:103]
buffer_load_dwordx4 a[176:179], v4, s[48:51], s34 offen sc1
v_mfma_f32_16x16x32_bf16 v[132:135], a[72:75], a[56:59], v[132:135]
v_mfma_f32_16x16x32_bf16 v[132:135], a[76:79], a[60:63], v[132:135]
ds_read_b64_tr_b16 a[64:65], v5 offset:0
ds_read_b64_tr_b16 a[66:67], v5 offset:512
v_mfma_f32_16x16x32_bf16 v[40:43], a[80:83], a[32:35], v[40:43]
s_add_u32 m0, s35, 155648
v_mfma_f32_16x16x32_bf16 v[40:43], a[84:87], a[36:39], v[40:43]
ds_read_b64_tr_b16 a[68:69], v5 offset:4096
ds_read_b64_tr_b16 a[70:71], v5 offset:4608
v_mfma_f32_16x16x32_bf16 v[72:75], a[80:83], a[40:43], v[72:75]
ds_read_b64_tr_b16 a[72:73], v6 offset:0
ds_read_b64_tr_b16 a[74:75], v6 offset:512
v_mfma_f32_16x16x32_bf16 v[72:75], a[84:87], a[44:47], v[72:75]
v_mfma_f32_16x16x32_bf16 v[104:107], a[80:83], a[48:51], v[104:107]
buffer_load_dwordx4 a[180:183], v4, s[48:51], s34 offen offset:1024 sc1
v_mfma_f32_16x16x32_bf16 v[104:107], a[84:87], a[52:55], v[104:107]
global_load_dword v31, v4, s[98:99]
v_mfma_f32_16x16x32_bf16 v[136:139], a[80:83], a[56:59], v[136:139]
ds_read_b64_tr_b16 a[76:77], v6 offset:4096
v_mfma_f32_16x16x32_bf16 v[136:139], a[84:87], a[60:63], v[136:139]
s_add_u32 s34, s33, 34816
s_waitcnt lgkmcnt(15)
v_mfma_f32_16x16x32_bf16 v[44:47], a[88:91], a[32:35], v[44:47]
v_mfma_f32_16x16x32_bf16 v[44:47], a[92:95], a[36:39], v[44:47]
ds_read_b64_tr_b16 a[78:79], v6 offset:4608
v_mfma_f32_16x16x32_bf16 v[76:79], a[88:91], a[40:43], v[76:79]
v_mfma_f32_16x16x32_bf16 v[76:79], a[92:95], a[44:47], v[76:79]
s_waitcnt lgkmcnt(15)
buffer_load_dwordx4 a[184:187], v4, s[48:51], s34 offen sc1
v_mfma_f32_16x16x32_bf16 v[108:111], a[88:91], a[48:51], v[108:111]
ds_read_b64_tr_b16 a[80:81], v7 offset:0
ds_read_b64_tr_b16 a[82:83], v7 offset:512
v_mfma_f32_16x16x32_bf16 v[108:111], a[92:95], a[52:55], v[108:111]
ds_read_b64_tr_b16 a[84:85], v7 offset:4096
ds_read_b64_tr_b16 a[86:87], v7 offset:4608
v_mfma_f32_16x16x32_bf16 v[140:143], a[88:91], a[56:59], v[140:143]
buffer_load_dwordx4 a[188:191], v4, s[48:51], s34 offen offset:1024 sc1
v_mfma_f32_16x16x32_bf16 v[140:143], a[92:95], a[60:63], v[140:143]
v_mfma_f32_16x16x32_bf16 v[48:51], a[96:99], a[32:35], v[48:51]
ds_read_b64_tr_b16 a[88:89], v8 offset:0
v_mfma_f32_16x16x32_bf16 v[48:51], a[100:103], a[36:39], v[48:51]
s_add_u32 s29, s54, 1548288
v_mfma_f32_16x16x32_bf16 v[80:83], a[96:99], a[40:43], v[80:83]
v_mfma_f32_16x16x32_bf16 v[80:83], a[100:103], a[44:47], v[80:83]
ds_read_b64_tr_b16 a[90:91], v8 offset:512
ds_read_b64_tr_b16 a[92:93], v8 offset:4096
v_mfma_f32_16x16x32_bf16 v[112:115], a[96:99], a[48:51], v[112:115]
s_add_u32 s34, s32, 12288
v_mfma_f32_16x16x32_bf16 v[112:115], a[100:103], a[52:55], v[112:115]
buffer_load_dwordx4 v13, s[40:43], s29 offen offset:0 lds
v_mfma_f32_16x16x32_bf16 v[144:147], a[96:99], a[56:59], v[144:147]
s_waitcnt lgkmcnt(15)
v_mfma_f32_16x16x32_bf16 v[144:147], a[100:103], a[60:63], v[144:147]
ds_read_b64_tr_b16 a[94:95], v8 offset:4608
s_waitcnt lgkmcnt(15)
v_mfma_f32_16x16x32_bf16 v[52:55], a[104:107], a[32:35], v[52:55]
v_mfma_f32_16x16x32_bf16 v[52:55], a[108:111], a[36:39], v[52:55]
v_mfma_f32_16x16x32_bf16 v[84:87], a[104:107], a[40:43], v[84:87]
v_mfma_f32_16x16x32_bf16 v[84:87], a[108:111], a[44:47], v[84:87]
v_mfma_f32_16x16x32_bf16 v[116:119], a[104:107], a[48:51], v[116:119]
v_mfma_f32_16x16x32_bf16 v[116:119], a[108:111], a[52:55], v[116:119]
buffer_load_dwordx4 v14, s[40:43], s29 offen offset:1024 lds
v_mfma_f32_16x16x32_bf16 v[148:151], a[104:107], a[56:59], v[148:151]
v_mfma_f32_16x16x32_bf16 v[148:151], a[108:111], a[60:63], v[148:151]
v_mfma_f32_16x16x32_bf16 v[56:59], a[112:115], a[32:35], v[56:59]
v_mfma_f32_16x16x32_bf16 v[56:59], a[116:119], a[36:39], v[56:59]
v_mfma_f32_16x16x32_bf16 v[88:91], a[112:115], a[40:43], v[88:91]
v_mfma_f32_16x16x32_bf16 v[88:91], a[116:119], a[44:47], v[88:91]
v_mfma_f32_16x16x32_bf16 v[120:123], a[112:115], a[48:51], v[120:123]
v_mfma_f32_16x16x32_bf16 v[120:123], a[116:119], a[52:55], v[120:123]
buffer_load_dwordx4 a[0:3], v4, s[48:51], s34 offen sc1
v_mfma_f32_16x16x32_bf16 v[152:155], a[112:115], a[56:59], v[152:155]
v_mfma_f32_16x16x32_bf16 v[152:155], a[116:119], a[60:63], v[152:155]
v_mfma_f32_16x16x32_bf16 v[60:63], a[120:123], a[32:35], v[60:63]
v_mfma_f32_16x16x32_bf16 v[60:63], a[124:127], a[36:39], v[60:63]
v_mfma_f32_16x16x32_bf16 v[92:95], a[120:123], a[40:43], v[92:95]
buffer_load_dwordx4 a[4:7], v4, s[48:51], s34 offen offset:1024 sc1
v_mfma_f32_16x16x32_bf16 v[92:95], a[124:127], a[44:47], v[92:95]
s_add_u32 s34, s32, 32768
v_mfma_f32_16x16x32_bf16 v[124:127], a[120:123], a[48:51], v[124:127]
buffer_load_dwordx4 a[8:11], v4, s[48:51], s34 offen sc1
v_mfma_f32_16x16x32_bf16 v[124:127], a[124:127], a[52:55], v[124:127]
s_waitcnt vmcnt(12) lgkmcnt(12)
v_mfma_f32_16x16x32_bf16 v[156:159], a[120:123], a[56:59], v[156:159]
s_cmp_eq_u32 s4, s57
s_barrier
v_mfma_f32_16x16x32_bf16 v[156:159], a[124:127], a[60:63], v[156:159]
s_cbranch_scc1 kf_kernel_rel1
kf_kernel_wb1:
buffer_wbl2 sc1
s_waitcnt vmcnt(0)
kf_kernel_rel1:
v_mfma_f32_16x16x32_bf16 v[160:163], a[64:67], a[32:35], v[160:163]
s_branch kf_kernel_pl11
kf_kernel_pd11:
s_branch kf_kernel_pd15
kf_kernel_pl11:
ds_read_b64_tr_b16 a[96:97], v5 offset:8192
ds_read_b64_tr_b16 a[98:99], v5 offset:8704
v_mfma_f32_16x16x32_bf16 v[160:163], a[68:71], a[36:39], v[160:163]
ds_read_b64_tr_b16 a[100:101], v5 offset:12288
v_mov_b32 v1, 1
v_mfma_f32_16x16x32_bf16 v[176:179], a[64:67], a[40:43], v[176:179]
buffer_atomic_add v1, v29, s[48:51], s3 offen sc1
v_mfma_f32_16x16x32_bf16 v[176:179], a[68:71], a[44:47], v[176:179]
ds_read_b64_tr_b16 a[102:103], v5 offset:12800
ds_read_b64_tr_b16 a[104:105], v6 offset:8192
v_mfma_f32_16x16x32_bf16 v[192:195], a[64:67], a[48:51], v[192:195]
ds_read_b64_tr_b16 a[106:107], v6 offset:8704
s_waitcnt lgkmcnt(14)
v_mfma_f32_16x16x32_bf16 v[192:195], a[68:71], a[52:55], v[192:195]
s_waitcnt lgkmcnt(10)
buffer_load_dwordx4 a[12:15], v4, s[48:51], s34 offen offset:1024 sc1
v_mfma_f32_16x16x32_bf16 v[208:211], a[64:67], a[56:59], v[208:211]
v_mfma_f32_16x16x32_bf16 v[208:211], a[68:71], a[60:63], v[208:211]
ds_read_b64_tr_b16 a[108:109], v6 offset:12288
ds_read_b64_tr_b16 a[110:111], v6 offset:12800
v_mfma_f32_16x16x32_bf16 v[164:167], a[72:75], a[32:35], v[164:167]
s_waitcnt lgkmcnt(8)
ds_read_b64_tr_b16 a[112:113], v7 offset:8192
v_mfma_f32_16x16x32_bf16 v[164:167], a[76:79], a[36:39], v[164:167]
ds_read_b64_tr_b16 a[114:115], v7 offset:8704
ds_read_b64_tr_b16 a[116:117], v7 offset:12288
v_mfma_f32_16x16x32_bf16 v[180:183], a[72:75], a[40:43], v[180:183]
s_add_u32 s34, s33, 12288
ds_read_b64_tr_b16 a[118:119], v7 offset:12800
ds_read_b64_tr_b16 a[120:121], v8 offset:8192
v_mfma_f32_16x16x32_bf16 v[180:183], a[76:79], a[44:47], v[180:183]
ds_read_b64_tr_b16 a[122:123], v8 offset:8704
ds_read_b64_tr_b16 a[124:125], v8 offset:12288
v_mfma_f32_16x16x32_bf16 v[196:199], a[72:75], a[48:51], v[196:199]
v_mfma_f32_16x16x32_bf16 v[196:199], a[76:79], a[52:55], v[196:199]
buffer_load_dwordx4 a[16:19], v4, s[48:51], s34 offen sc1
v_mfma_f32_16x16x32_bf16 v[212:215], a[72:75], a[56:59], v[212:215]
ds_read_b64_tr_b16 a[126:127], v8 offset:12800
v_mfma_f32_16x16x32_bf16 v[212:215], a[76:79], a[60:63], v[212:215]
v_mfma_f32_16x16x32_bf16 v[168:171], a[80:83], a[32:35], v[168:171]
v_mfma_f32_16x16x32_bf16 v[168:171], a[84:87], a[36:39], v[168:171]
v_mfma_f32_16x16x32_bf16 v[184:187], a[80:83], a[40:43], v[184:187]
v_mfma_f32_16x16x32_bf16 v[184:187], a[84:87], a[44:47], v[184:187]
buffer_load_dwordx4 a[20:23], v4, s[48:51], s34 offen offset:1024 sc1
v_mfma_f32_16x16x32_bf16 v[200:203], a[80:83], a[48:51], v[200:203]
v_mfma_f32_16x16x32_bf16 v[200:203], a[84:87], a[52:55], v[200:203]
s_add_u32 s34, s33, 32768
v_mfma_f32_16x16x32_bf16 v[216:219], a[80:83], a[56:59], v[216:219]
v_mfma_f32_16x16x32_bf16 v[216:219], a[84:87], a[60:63], v[216:219]
buffer_load_dwordx4 a[24:27], v4, s[48:51], s34 offen sc1
v_mfma_f32_16x16x32_bf16 v[172:175], a[88:91], a[32:35], v[172:175]
v_mfma_f32_16x16x32_bf16 v[172:175], a[92:95], a[36:39], v[172:175]
v_mfma_f32_16x16x32_bf16 v[188:191], a[88:91], a[40:43], v[188:191]
v_mfma_f32_16x16x32_bf16 v[188:191], a[92:95], a[44:47], v[188:191]
v_mfma_f32_16x16x32_bf16 v[204:207], a[88:91], a[48:51], v[204:207]
v_mfma_f32_16x16x32_bf16 v[204:207], a[92:95], a[52:55], v[204:207]
buffer_load_dwordx4 a[28:31], v4, s[48:51], s34 offen offset:1024 sc1
v_mfma_f32_16x16x32_bf16 v[220:223], a[88:91], a[56:59], v[220:223]
v_mfma_f32_16x16x32_bf16 v[220:223], a[92:95], a[60:63], v[220:223]
s_waitcnt vmcnt(32) lgkmcnt(12)
ds_read_b64_tr_b16 a[64:65], v21 offset:49152
ds_read_b64_tr_b16 a[66:67], v21 offset:50176
v_mfma_f32_16x16x32_bf16 v[160:163], a[96:99], a[224:227], v[160:163]
s_add_u32 s34, s32, 16384
ds_read_b64_tr_b16 a[68:69], v21 offset:57344
ds_read_b64_tr_b16 a[70:71], v21 offset:58368
v_mfma_f32_16x16x32_bf16 v[160:163], a[100:103], a[228:231], v[160:163]
s_waitcnt lgkmcnt(12)
ds_read_b64_tr_b16 a[72:73], v22 offset:49152
ds_read_b64_tr_b16 a[74:75], v22 offset:50176
v_mfma_f32_16x16x32_bf16 v[176:179], a[96:99], a[232:235], v[176:179]
s_waitcnt lgkmcnt(10)
ds_read_b64_tr_b16 a[76:77], v22 offset:57344
s_waitcnt lgkmcnt(7)
v_mfma_f32_16x16x32_bf16 v[176:179], a[100:103], a[236:239], v[176:179]
ds_read_b64_tr_b16 a[78:79], v22 offset:58368
ds_read_b64_tr_b16 a[80:81], v23 offset:49152
v_mfma_f32_16x16x32_bf16 v[192:195], a[96:99], a[240:243], v[192:195]
ds_read_b64_tr_b16 a[82:83], v23 offset:50176
ds_read_b64_tr_b16 a[84:85], v23 offset:57344
v_mfma_f32_16x16x32_bf16 v[192:195], a[100:103], a[244:247], v[192:195]
buffer_load_dwordx4 a[192:195], v4, s[48:51], s34 offen sc1
v_mfma_f32_16x16x32_bf16 v[208:211], a[96:99], a[248:251], v[208:211]
ds_read_b64_tr_b16 a[86:87], v23 offset:58368
ds_read_b64_tr_b16 a[88:89], v24 offset:49152
v_mfma_f32_16x16x32_bf16 v[208:211], a[100:103], a[252:255], v[208:211]
ds_read_b64_tr_b16 a[90:91], v24 offset:50176
v_mfma_f32_16x16x32_bf16 v[164:167], a[104:107], a[224:227], v[164:167]
v_mfma_f32_16x16x32_bf16 v[164:167], a[108:111], a[228:231], v[164:167]
ds_read_b64_tr_b16 a[92:93], v24 offset:57344
ds_read_b64_tr_b16 a[94:95], v24 offset:58368
v_mfma_f32_16x16x32_bf16 v[180:183], a[104:107], a[232:235], v[180:183]
v_mfma_f32_16x16x32_bf16 v[180:183], a[108:111], a[236:239], v[180:183]
buffer_load_dwordx4 a[196:199], v4, s[48:51], s34 offen offset:1024 sc1
v_mfma_f32_16x16x32_bf16 v[196:199], a[104:107], a[240:243], v[196:199]
s_add_u32 s34, s32, 36864
v_mfma_f32_16x16x32_bf16 v[196:199], a[108:111], a[244:247], v[196:199]
v_mfma_f32_16x16x32_bf16 v[212:215], a[104:107], a[248:251], v[212:215]
v_mfma_f32_16x16x32_bf16 v[212:215], a[108:111], a[252:255], v[212:215]
buffer_load_dwordx4 a[200:203], v4, s[48:51], s34 offen sc1
v_mfma_f32_16x16x32_bf16 v[168:171], a[112:115], a[224:227], v[168:171]
v_mfma_f32_16x16x32_bf16 v[168:171], a[116:119], a[228:231], v[168:171]
v_mfma_f32_16x16x32_bf16 v[184:187], a[112:115], a[232:235], v[184:187]
v_mfma_f32_16x16x32_bf16 v[184:187], a[116:119], a[236:239], v[184:187]
v_mfma_f32_16x16x32_bf16 v[200:203], a[112:115], a[240:243], v[200:203]
v_mfma_f32_16x16x32_bf16 v[200:203], a[116:119], a[244:247], v[200:203]
buffer_load_dwordx4 a[204:207], v4, s[48:51], s34 offen offset:1024 sc1
v_mfma_f32_16x16x32_bf16 v[216:219], a[112:115], a[248:251], v[216:219]
v_mfma_f32_16x16x32_bf16 v[216:219], a[116:119], a[252:255], v[216:219]
v_mfma_f32_16x16x32_bf16 v[172:175], a[120:123], a[224:227], v[172:175]
s_add_u32 s34, s33, 16384
v_mfma_f32_16x16x32_bf16 v[172:175], a[124:127], a[228:231], v[172:175]
v_mfma_f32_16x16x32_bf16 v[188:191], a[120:123], a[232:235], v[188:191]
v_mfma_f32_16x16x32_bf16 v[188:191], a[124:127], a[236:239], v[188:191]
v_mfma_f32_16x16x32_bf16 v[204:207], a[120:123], a[240:243], v[204:207]
buffer_load_dwordx4 a[208:211], v4, s[48:51], s34 offen sc1
v_mfma_f32_16x16x32_bf16 v[204:207], a[124:127], a[244:247], v[204:207]
v_mfma_f32_16x16x32_bf16 v[220:223], a[120:123], a[248:251], v[220:223]
v_mfma_f32_16x16x32_bf16 v[220:223], a[124:127], a[252:255], v[220:223]
s_waitcnt vmcnt(32) lgkmcnt(12)
s_barrier
v_mfma_f32_16x16x32_bf16 v[32:35], a[64:67], a[224:227], v[32:35]
s_waitcnt lgkmcnt(8)
ds_read_b64_tr_b16 a[96:97], v25 offset:49152
ds_read_b64_tr_b16 a[98:99], v25 offset:50176
v_mfma_f32_16x16x32_bf16 v[32:35], a[68:71], a[228:231], v[32:35]
s_waitcnt lgkmcnt(6)
ds_read_b64_tr_b16 a[100:101], v25 offset:57344
ds_read_b64_tr_b16 a[102:103], v25 offset:58368
v_mfma_f32_16x16x32_bf16 v[64:67], a[64:67], a[232:235], v[64:67]
s_add_u32 m0, s35, 131072
ds_read_b64_tr_b16 a[104:105], v26 offset:49152
ds_read_b64_tr_b16 a[106:107], v26 offset:50176
v_mfma_f32_16x16x32_bf16 v[64:67], a[68:71], a[236:239], v[64:67]
ds_read_b64_tr_b16 a[108:109], v26 offset:57344
ds_read_b64_tr_b16 a[110:111], v26 offset:58368
v_mfma_f32_16x16x32_bf16 v[96:99], a[64:67], a[240:243], v[96:99]
buffer_load_dwordx4 a[212:215], v4, s[48:51], s34 offen offset:1024 sc1
v_mfma_f32_16x16x32_bf16 v[96:99], a[68:71], a[244:247], v[96:99]
ds_read_b64_tr_b16 a[112:113], v27 offset:49152
v_mfma_f32_16x16x32_bf16 v[128:131], a[64:67], a[248:251], v[128:131]
s_add_u32 s29, s54, 1769472
ds_read_b64_tr_b16 a[114:115], v27 offset:50176
ds_read_b64_tr_b16 a[116:117], v27 offset:57344
v_mfma_f32_16x16x32_bf16 v[128:131], a[68:71], a[252:255], v[128:131]
ds_read_b64_tr_b16 a[118:119], v27 offset:58368
v_mfma_f32_16x16x32_bf16 v[36:39], a[72:75], a[224:227], v[36:39]
ds_read_b64_tr_b16 a[120:121], v28 offset:49152
ds_read_b64_tr_b16 a[122:123], v28 offset:50176
v_mfma_f32_16x16x32_bf16 v[36:39], a[76:79], a[228:231], v[36:39]
s_add_u32 s34, s33, 36864
ds_read_b64_tr_b16 a[124:125], v28 offset:57344
ds_read_b64_tr_b16 a[126:127], v28 offset:58368
v_mfma_f32_16x16x32_bf16 v[68:71], a[72:75], a[232:235], v[68:71]
buffer_load_dwordx4 a[216:219], v4, s[48:51], s34 offen sc1
v_mfma_f32_16x16x32_bf16 v[68:71], a[76:79], a[236:239], v[68:71]
ds_read_b64_tr_b16 a[64:65], v5 offset:16384
ds_read_b64_tr_b16 a[66:67], v5 offset:16896
v_mfma_f32_16x16x32_bf16 v[100:103], a[72:75], a[240:243], v[100:103]
v_mfma_f32_16x16x32_bf16 v[100:103], a[76:79], a[244:247], v[100:103]
ds_read_b64_tr_b16 a[68:69], v5 offset:20480
ds_read_b64_tr_b16 a[70:71], v5 offset:20992
v_mfma_f32_16x16x32_bf16 v[132:135], a[72:75], a[248:251], v[132:135]
ds_read_b64_tr_b16 a[72:73], v6 offset:16384
v_mfma_f32_16x16x32_bf16 v[132:135], a[76:79], a[252:255], v[132:135]
buffer_load_dwordx4 a[220:223], v4, s[48:51], s34 offen offset:1024 sc1
v_mfma_f32_16x16x32_bf16 v[40:43], a[80:83], a[224:227], v[40:43]
ds_read_b64_tr_b16 a[74:75], v6 offset:16896
ds_read_b64_tr_b16 a[76:77], v6 offset:20480
v_mfma_f32_16x16x32_bf16 v[40:43], a[84:87], a[228:231], v[40:43]
ds_read_b64_tr_b16 a[78:79], v6 offset:20992
v_mfma_f32_16x16x32_bf16 v[72:75], a[80:83], a[232:235], v[72:75]
v_mfma_f32_16x16x32_bf16 v[72:75], a[84:87], a[236:239], v[72:75]
v_mfma_f32_16x16x32_bf16 v[104:107], a[80:83], a[240:243], v[104:107]
v_mfma_f32_16x16x32_bf16 v[104:107], a[84:87], a[244:247], v[104:107]
buffer_load_dwordx4 v13, s[40:43], s29 offen offset:0 lds
v_mfma_f32_16x16x32_bf16 v[136:139], a[80:83], a[248:251], v[136:139]
ds_read_b64_tr_b16 a[80:81], v7 offset:16384
s_waitcnt lgkmcnt(15)
v_mfma_f32_16x16x32_bf16 v[136:139], a[84:87], a[252:255], v[136:139]
ds_read_b64_tr_b16 a[82:83], v7 offset:16896
ds_read_b64_tr_b16 a[84:85], v7 offset:20480
v_mfma_f32_16x16x32_bf16 v[44:47], a[88:91], a[224:227], v[44:47]
ds_read_b64_tr_b16 a[86:87], v7 offset:20992
v_mfma_f32_16x16x32_bf16 v[44:47], a[92:95], a[228:231], v[44:47]
v_mfma_f32_16x16x32_bf16 v[76:79], a[88:91], a[232:235], v[76:79]
s_waitcnt lgkmcnt(15)
v_mfma_f32_16x16x32_bf16 v[76:79], a[92:95], a[236:239], v[76:79]
v_mfma_f32_16x16x32_bf16 v[108:111], a[88:91], a[240:243], v[108:111]
s_waitcnt lgkmcnt(15)
v_mfma_f32_16x16x32_bf16 v[108:111], a[92:95], a[244:247], v[108:111]
buffer_load_dwordx4 v14, s[40:43], s29 offen offset:1024 lds
v_mfma_f32_16x16x32_bf16 v[140:143], a[88:91], a[248:251], v[140:143]
ds_read_b64_tr_b16 a[88:89], v8 offset:16384
ds_read_b64_tr_b16 a[90:91], v8 offset:16896
v_mfma_f32_16x16x32_bf16 v[140:143], a[92:95], a[252:255], v[140:143]
ds_read_b64_tr_b16 a[92:93], v8 offset:20480
v_mfma_f32_16x16x32_bf16 v[48:51], a[96:99], a[224:227], v[48:51]
v_mfma_f32_16x16x32_bf16 v[48:51], a[100:103], a[228:231], v[48:51]
s_add_u32 m0, s35, 139264
ds_read_b64_tr_b16 a[94:95], v8 offset:20992
v_mfma_f32_16x16x32_bf16 v[80:83], a[96:99], a[232:235], v[80:83]
s_add_u32 s29, s54, 1990656
v_mfma_f32_16x16x32_bf16 v[80:83], a[100:103], a[236:239], v[80:83]
buffer_load_dwordx4 v13, s[40:43], s29 offen offset:0 lds
v_mfma_f32_16x16x32_bf16 v[112:115], a[96:99], a[240:243], v[112:115]
v_mfma_f32_16x16x32_bf16 v[112:115], a[100:103], a[244:247], v[112:115]
v_mfma_f32_16x16x32_bf16 v[144:147], a[96:99], a[248:251], v[144:147]
v_mfma_f32_16x16x32_bf16 v[144:147], a[100:103], a[252:255], v[144:147]
buffer_load_dwordx4 v14, s[40:43], s29 offen offset:1024 lds
v_mfma_f32_16x16x32_bf16 v[52:55], a[104:107], a[224:227], v[52:55]
s_waitcnt lgkmcnt(15)
v_mfma_f32_16x16x32_bf16 v[52:55], a[108:111], a[228:231], v[52:55]
s_add_u32 m0, s28, 81920
v_mfma_f32_16x16x32_bf16 v[84:87], a[104:107], a[232:235], v[84:87]
v_mfma_f32_16x16x32_bf16 v[84:87], a[108:111], a[236:239], v[84:87]
s_waitcnt lgkmcnt(15)
s_add_u32 s29, s27, 3670016
v_mfma_f32_16x16x32_bf16 v[116:119], a[104:107], a[240:243], v[116:119]
v_mfma_f32_16x16x32_bf16 v[116:119], a[108:111], a[244:247], v[116:119]
buffer_load_dwordx4 v9, s[44:47], s29 offen offset:0 lds
v_mfma_f32_16x16x32_bf16 v[148:151], a[104:107], a[248:251], v[148:151]
v_mfma_f32_16x16x32_bf16 v[148:151], a[108:111], a[252:255], v[148:151]
v_mfma_f32_16x16x32_bf16 v[56:59], a[112:115], a[224:227], v[56:59]
v_mfma_f32_16x16x32_bf16 v[56:59], a[116:119], a[228:231], v[56:59]
v_mfma_f32_16x16x32_bf16 v[88:91], a[112:115], a[232:235], v[88:91]
v_mfma_f32_16x16x32_bf16 v[88:91], a[116:119], a[236:239], v[88:91]
v_mfma_f32_16x16x32_bf16 v[120:123], a[112:115], a[240:243], v[120:123]
v_mfma_f32_16x16x32_bf16 v[120:123], a[116:119], a[244:247], v[120:123]
buffer_load_dwordx4 v10, s[44:47], s29 offen offset:1024 lds
v_mfma_f32_16x16x32_bf16 v[152:155], a[112:115], a[248:251], v[152:155]
global_load_dword v31, v4, s[98:99]
v_mfma_f32_16x16x32_bf16 v[152:155], a[116:119], a[252:255], v[152:155]
v_mfma_f32_16x16x32_bf16 v[60:63], a[120:123], a[224:227], v[60:63]
v_mfma_f32_16x16x32_bf16 v[60:63], a[124:127], a[228:231], v[60:63]
v_mfma_f32_16x16x32_bf16 v[92:95], a[120:123], a[232:235], v[92:95]
v_mfma_f32_16x16x32_bf16 v[92:95], a[124:127], a[236:239], v[92:95]
buffer_load_dwordx4 v11, s[44:47], s29 offen offset:2048 lds
v_mfma_f32_16x16x32_bf16 v[124:127], a[120:123], a[240:243], v[124:127]
v_mfma_f32_16x16x32_bf16 v[124:127], a[124:127], a[244:247], v[124:127]
v_mfma_f32_16x16x32_bf16 v[156:159], a[120:123], a[248:251], v[156:159]
buffer_load_dwordx4 v12, s[44:47], s29 offen offset:3072 lds
v_mfma_f32_16x16x32_bf16 v[156:159], a[124:127], a[252:255], v[156:159]
s_waitcnt vmcnt(17) lgkmcnt(12)
s_barrier
v_mfma_f32_16x16x32_bf16 v[160:163], a[64:67], a[0:3], v[160:163]
ds_read_b64_tr_b16 a[96:97], v21 offset:0
ds_read_b64_tr_b16 a[98:99], v21 offset:1024
v_mfma_f32_16x16x32_bf16 v[160:163], a[68:71], a[4:7], v[160:163]
v_mfma_f32_16x16x32_bf16 v[176:179], a[64:67], a[8:11], v[176:179]
s_add_u32 m0, s28, 98304
ds_read_b64_tr_b16 a[100:101], v21 offset:8192
ds_read_b64_tr_b16 a[102:103], v21 offset:9216
v_mfma_f32_16x16x32_bf16 v[176:179], a[68:71], a[12:15], v[176:179]
s_add_u32 s29, s27, 4194304
ds_read_b64_tr_b16 a[104:105], v22 offset:0
ds_read_b64_tr_b16 a[106:107], v22 offset:1024
v_mfma_f32_16x16x32_bf16 v[192:195], a[64:67], a[16:19], v[192:195]
s_waitcnt lgkmcnt(14)
ds_read_b64_tr_b16 a[108:109], v22 offset:8192
ds_read_b64_tr_b16 a[110:111], v22 offset:9216
v_mfma_f32_16x16x32_bf16 v[192:195], a[68:71], a[20:23], v[192:195]
buffer_load_dwordx4 v9, s[44:47], s29 offen offset:0 lds
v_mfma_f32_16x16x32_bf16 v[208:211], a[64:67], a[24:27], v[208:211]
s_waitcnt lgkmcnt(12)
s_waitcnt lgkmcnt(8)
ds_read_b64_tr_b16 a[112:113], v23 offset:0
v_mfma_f32_16x16x32_bf16 v[208:211], a[68:71], a[28:31], v[208:211]
ds_read_b64_tr_b16 a[114:115], v23 offset:1024
ds_read_b64_tr_b16 a[116:117], v23 offset:8192
v_mfma_f32_16x16x32_bf16 v[164:167], a[72:75], a[0:3], v[164:167]
ds_read_b64_tr_b16 a[118:119], v23 offset:9216
v_mfma_f32_16x16x32_bf16 v[164:167], a[76:79], a[4:7], v[164:167]
ds_read_b64_tr_b16 a[120:121], v24 offset:0
ds_read_b64_tr_b16 a[122:123], v24 offset:1024
v_mfma_f32_16x16x32_bf16 v[180:183], a[72:75], a[8:11], v[180:183]
ds_read_b64_tr_b16 a[124:125], v24 offset:8192
v_mfma_f32_16x16x32_bf16 v[180:183], a[76:79], a[12:15], v[180:183]
s_waitcnt lgkmcnt(11)
ds_read_b64_tr_b16 a[126:127], v24 offset:9216
ds_read_b64_tr_b16 a[64:65], v25 offset:0
v_mfma_f32_16x16x32_bf16 v[196:199], a[72:75], a[16:19], v[196:199]
ds_read_b64_tr_b16 a[66:67], v25 offset:1024
v_mfma_f32_16x16x32_bf16 v[196:199], a[76:79], a[20:23], v[196:199]
buffer_load_dwordx4 v10, s[44:47], s29 offen offset:1024 lds
v_mfma_f32_16x16x32_bf16 v[212:215], a[72:75], a[24:27], v[212:215]
ds_read_b64_tr_b16 a[68:69], v25 offset:8192
ds_read_b64_tr_b16 a[70:71], v25 offset:9216
v_mfma_f32_16x16x32_bf16 v[212:215], a[76:79], a[28:31], v[212:215]
v_mfma_f32_16x16x32_bf16 v[168:171], a[80:83], a[0:3], v[168:171]
s_waitcnt lgkmcnt(12)
ds_read_b64_tr_b16 a[72:73], v26 offset:0
ds_read_b64_tr_b16 a[74:75], v26 offset:1024
v_mfma_f32_16x16x32_bf16 v[168:171], a[84:87], a[4:7], v[168:171]
ds_read_b64_tr_b16 a[76:77], v26 offset:8192
ds_read_b64_tr_b16 a[78:79], v26 offset:9216
v_mfma_f32_16x16x32_bf16 v[184:187], a[80:83], a[8:11], v[184:187]
s_add_u32 s34, s32, 18432
v_mfma_f32_16x16x32_bf16 v[184:187], a[84:87], a[12:15], v[184:187]
s_waitcnt lgkmcnt(12)
buffer_load_dwordx4 v11, s[44:47], s29 offen offset:2048 lds
v_mfma_f32_16x16x32_bf16 v[200:203], a[80:83], a[16:19], v[200:203]
v_mfma_f32_16x16x32_bf16 v[200:203], a[84:87], a[20:23], v[200:203]
v_mfma_f32_16x16x32_bf16 v[216:219], a[80:83], a[24:27], v[216:219]
ds_read_b64_tr_b16 a[80:81], v27 offset:0
ds_read_b64_tr_b16 a[82:83], v27 offset:1024
v_mfma_f32_16x16x32_bf16 v[216:219], a[84:87], a[28:31], v[216:219]
ds_read_b64_tr_b16 a[84:85], v27 offset:8192
ds_read_b64_tr_b16 a[86:87], v27 offset:9216
v_mfma_f32_16x16x32_bf16 v[172:175], a[88:91], a[0:3], v[172:175]
v_mfma_f32_16x16x32_bf16 v[172:175], a[92:95], a[4:7], v[172:175]
v_mfma_f32_16x16x32_bf16 v[188:191], a[88:91], a[8:11], v[188:191]
v_mfma_f32_16x16x32_bf16 v[188:191], a[92:95], a[12:15], v[188:191]
buffer_load_dwordx4 v12, s[44:47], s29 offen offset:3072 lds
v_mfma_f32_16x16x32_bf16 v[204:207], a[88:91], a[16:19], v[204:207]
v_mfma_f32_16x16x32_bf16 v[204:207], a[92:95], a[20:23], v[204:207]
s_add_u32 m0, s28, 114688
s_add_u32 s29, s27, 4718592
v_mfma_f32_16x16x32_bf16 v[220:223], a[88:91], a[24:27], v[220:223]
buffer_load_dwordx4 v9, s[44:47], s29 offen offset:0 lds
v_mfma_f32_16x16x32_bf16 v[220:223], a[92:95], a[28:31], v[220:223]
ds_read_b64_tr_b16 a[88:89], v28 offset:0
ds_read_b64_tr_b16 a[90:91], v28 offset:1024
v_mfma_f32_16x16x32_bf16 v[32:35], a[96:99], a[0:3], v[32:35]
ds_read_b64_tr_b16 a[92:93], v28 offset:8192
ds_read_b64_tr_b16 a[94:95], v28 offset:9216
v_mfma_f32_16x16x32_bf16 v[32:35], a[100:103], a[4:7], v[32:35]
v_mfma_f32_16x16x32_bf16 v[64:67], a[96:99], a[8:11], v[64:67]
v_mfma_f32_16x16x32_bf16 v[64:67], a[100:103], a[12:15], v[64:67]
v_mfma_f32_16x16x32_bf16 v[96:99], a[96:99], a[16:19], v[96:99]
v_mfma_f32_16x16x32_bf16 v[96:99], a[100:103], a[20:23], v[96:99]
buffer_load_dwordx4 v10, s[44:47], s29 offen offset:1024 lds
v_mfma_f32_16x16x32_bf16 v[128:131], a[96:99], a[24:27], v[128:131]
ds_read_b64_tr_b16 a[96:97], v5 offset:24576
ds_read_b64_tr_b16 a[98:99], v5 offset:25088
v_mfma_f32_16x16x32_bf16 v[128:131], a[100:103], a[28:31], v[128:131]
ds_read_b64_tr_b16 a[100:101], v5 offset:28672
ds_read_b64_tr_b16 a[102:103], v5 offset:29184
v_mfma_f32_16x16x32_bf16 v[36:39], a[104:107], a[0:3], v[36:39]
v_mfma_f32_16x16x32_bf16 v[36:39], a[108:111], a[4:7], v[36:39]
s_waitcnt lgkmcnt(15)
v_mfma_f32_16x16x32_bf16 v[68:71], a[104:107], a[8:11], v[68:71]
v_mfma_f32_16x16x32_bf16 v[68:71], a[108:111], a[12:15], v[68:71]
v_mfma_f32_16x16x32_bf16 v[100:103], a[104:107], a[16:19], v[100:103]
v_mfma_f32_16x16x32_bf16 v[100:103], a[108:111], a[20:23], v[100:103]
buffer_load_dwordx4 v11, s[44:47], s29 offen offset:2048 lds
v_mfma_f32_16x16x32_bf16 v[132:135], a[104:107], a[24:27], v[132:135]
ds_read_b64_tr_b16 a[104:105], v6 offset:24576
ds_read_b64_tr_b16 a[106:107], v6 offset:25088
v_mfma_f32_16x16x32_bf16 v[132:135], a[108:111], a[28:31], v[132:135]
ds_read_b64_tr_b16 a[108:109], v6 offset:28672
v_mfma_f32_16x16x32_bf16 v[40:43], a[112:115], a[0:3], v[40:43]
v_mfma_f32_16x16x32_bf16 v[40:43], a[116:119], a[4:7], v[40:43]
ds_read_b64_tr_b16 a[110:111], v6 offset:29184
v_mfma_f32_16x16x32_bf16 v[72:75], a[112:115], a[8:11], v[72:75]
v_mfma_f32_16x16x32_bf16 v[72:75], a[116:119], a[12:15], v[72:75]
s_waitcnt lgkmcnt(15)
buffer_load_dwordx4 v12, s[44:47], s29 offen offset:3072 lds
v_mfma_f32_16x16x32_bf16 v[104:107], a[112:115], a[16:19], v[104:107]
v_mfma_f32_16x16x32_bf16 v[104:107], a[116:119], a[20:23], v[104:107]
v_mfma_f32_16x16x32_bf16 v[136:139], a[112:115], a[24:27], v[136:139]
ds_read_b64_tr_b16 a[112:113], v7 offset:24576
ds_read_b64_tr_b16 a[114:115], v7 offset:25088
v_mfma_f32_16x16x32_bf16 v[136:139], a[116:119], a[28:31], v[136:139]
buffer_load_dwordx4 a[128:131], v4, s[48:51], s34 offen sc1
v_mfma_f32_16x16x32_bf16 v[44:47], a[120:123], a[0:3], v[44:47]
ds_read_b64_tr_b16 a[116:117], v7 offset:28672
ds_read_b64_tr_b16 a[118:119], v7 offset:29184
v_mfma_f32_16x16x32_bf16 v[44:47], a[124:127], a[4:7], v[44:47]
s_waitcnt lgkmcnt(15)
s_waitcnt lgkmcnt(15)
v_mfma_f32_16x16x32_bf16 v[76:79], a[120:123], a[8:11], v[76:79]
v_mfma_f32_16x16x32_bf16 v[76:79], a[124:127], a[12:15], v[76:79]
v_mfma_f32_16x16x32_bf16 v[108:111], a[120:123], a[16:19], v[108:111]
s_waitcnt lgkmcnt(12)
v_mfma_f32_16x16x32_bf16 v[108:111], a[124:127], a[20:23], v[108:111]
buffer_load_dwordx4 a[132:135], v4, s[48:51], s34 offen offset:1024 sc1
v_mfma_f32_16x16x32_bf16 v[140:143], a[120:123], a[24:27], v[140:143]
s_add_u32 s34, s32, 38912
ds_read_b64_tr_b16 a[120:121], v8 offset:24576
ds_read_b64_tr_b16 a[122:123], v8 offset:25088
v_mfma_f32_16x16x32_bf16 v[140:143], a[124:127], a[28:31], v[140:143]
ds_read_b64_tr_b16 a[124:125], v8 offset:28672
v_mfma_f32_16x16x32_bf16 v[48:51], a[64:67], a[0:3], v[48:51]
v_mfma_f32_16x16x32_bf16 v[48:51], a[68:71], a[4:7], v[48:51]
buffer_load_dword v30, off, s[48:51], s52 sc1
v_mfma_f32_16x16x32_bf16 v[80:83], a[64:67], a[8:11], v[80:83]
ds_read_b64_tr_b16 a[126:127], v8 offset:29184
v_mfma_f32_16x16x32_bf16 v[80:83], a[68:71], a[12:15], v[80:83]
v_mfma_f32_16x16x32_bf16 v[112:115], a[64:67], a[16:19], v[112:115]
v_mfma_f32_16x16x32_bf16 v[112:115], a[68:71], a[20:23], v[112:115]
buffer_load_dwordx4 a[136:139], v4, s[48:51], s34 offen sc1
v_mfma_f32_16x16x32_bf16 v[144:147], a[64:67], a[24:27], v[144:147]
v_mfma_f32_16x16x32_bf16 v[144:147], a[68:71], a[28:31], v[144:147]
v_mfma_f32_16x16x32_bf16 v[52:55], a[72:75], a[0:3], v[52:55]
v_mfma_f32_16x16x32_bf16 v[52:55], a[76:79], a[4:7], v[52:55]
v_mfma_f32_16x16x32_bf16 v[84:87], a[72:75], a[8:11], v[84:87]
buffer_load_dwordx4 a[140:143], v4, s[48:51], s34 offen offset:1024 sc1
v_mfma_f32_16x16x32_bf16 v[84:87], a[76:79], a[12:15], v[84:87]
v_mfma_f32_16x16x32_bf16 v[116:119], a[72:75], a[16:19], v[116:119]
s_add_u32 s34, s33, 18432
s_add_u32 s98, s98, kf_kernel_last-65536-kf_kernel_z
v_mfma_f32_16x16x32_bf16 v[116:119], a[76:79], a[20:23], v[116:119]
v_mfma_f32_16x16x32_bf16 v[148:151], a[72:75], a[24:27], v[148:151]
v_mfma_f32_16x16x32_bf16 v[148:151], a[76:79], a[28:31], v[148:151]
buffer_load_dwordx4 a[144:147], v4, s[48:51], s34 offen sc1
v_mfma_f32_16x16x32_bf16 v[56:59], a[80:83], a[0:3], v[56:59]
v_mfma_f32_16x16x32_bf16 v[56:59], a[84:87], a[4:7], v[56:59]
v_mfma_f32_16x16x32_bf16 v[88:91], a[80:83], a[8:11], v[88:91]
s_addc_u32 s99, s99, 0
v_mfma_f32_16x16x32_bf16 v[88:91], a[84:87], a[12:15], v[88:91]
v_mfma_f32_16x16x32_bf16 v[120:123], a[80:83], a[16:19], v[120:123]
buffer_load_dwordx4 a[148:151], v4, s[48:51], s34 offen offset:1024 sc1
v_mfma_f32_16x16x32_bf16 v[120:123], a[84:87], a[20:23], v[120:123]
global_load_dword v31, v4, s[98:99]
v_mfma_f32_16x16x32_bf16 v[152:155], a[80:83], a[24:27], v[152:155]
v_mfma_f32_16x16x32_bf16 v[152:155], a[84:87], a[28:31], v[152:155]
v_mfma_f32_16x16x32_bf16 v[60:63], a[88:91], a[0:3], v[60:63]
v_mfma_f32_16x16x32_bf16 v[60:63], a[92:95], a[4:7], v[60:63]
s_add_u32 s34, s33, 38912
v_mfma_f32_16x16x32_bf16 v[92:95], a[88:91], a[8:11], v[92:95]
v_mfma_f32_16x16x32_bf16 v[92:95], a[92:95], a[12:15], v[92:95]
v_mfma_f32_16x16x32_bf16 v[124:127], a[88:91], a[16:19], v[124:127]
v_mfma_f32_16x16x32_bf16 v[124:127], a[92:95], a[20:23], v[124:127]
buffer_load_dwordx4 a[152:155], v4, s[48:51], s34 offen sc1
v_mfma_f32_16x16x32_bf16 v[156:159], a[88:91], a[24:27], v[156:159]
v_mfma_f32_16x16x32_bf16 v[156:159], a[92:95], a[28:31], v[156:159]
s_waitcnt vmcnt(22) lgkmcnt(12)
s_barrier
v_mfma_f32_16x16x32_bf16 v[160:163], a[96:99], a[160:163], v[160:163]
ds_read_b64_tr_b16 a[64:65], v5 offset:0
ds_read_b64_tr_b16 a[66:67], v5 offset:512
v_mfma_f32_16x16x32_bf16 v[160:163], a[100:103], a[164:167], v[160:163]
ds_read_b64_tr_b16 a[68:69], v5 offset:4096
ds_read_b64_tr_b16 a[70:71], v5 offset:4608
v_mfma_f32_16x16x32_bf16 v[176:179], a[96:99], a[168:171], v[176:179]
ds_read_b64_tr_b16 a[72:73], v6 offset:0
ds_read_b64_tr_b16 a[74:75], v6 offset:512
v_mfma_f32_16x16x32_bf16 v[176:179], a[100:103], a[172:175], v[176:179]
s_waitcnt lgkmcnt(14)
v_mfma_f32_16x16x32_bf16 v[192:195], a[96:99], a[176:179], v[192:195]
ds_read_b64_tr_b16 a[76:77], v6 offset:4096
ds_read_b64_tr_b16 a[78:79], v6 offset:4608
v_mfma_f32_16x16x32_bf16 v[192:195], a[100:103], a[180:183], v[192:195]
buffer_load_dwordx4 a[156:159], v4, s[48:51], s34 offen offset:1024 sc1
v_mfma_f32_16x16x32_bf16 v[208:211], a[96:99], a[184:187], v[208:211]
v_mfma_f32_16x16x32_bf16 v[208:211], a[100:103], a[188:191], v[208:211]
v_mfma_f32_16x16x32_bf16 v[164:167], a[104:107], a[160:163], v[164:167]
v_mfma_f32_16x16x32_bf16 v[164:167], a[108:111], a[164:167], v[164:167]
v_mfma_f32_16x16x32_bf16 v[180:183], a[104:107], a[168:171], v[180:183]
v_mfma_f32_16x16x32_bf16 v[180:183], a[108:111], a[172:175], v[180:183]
v_mfma_f32_16x16x32_bf16 v[196:199], a[104:107], a[176:179], v[196:199]
v_mfma_f32_16x16x32_bf16 v[196:199], a[108:111], a[180:183], v[196:199]
v_mfma_f32_16x16x32_bf16 v[212:215], a[104:107], a[184:187], v[212:215]
s_waitcnt vmcnt(7) lgkmcnt(12)
v_cmp_gt_u32 vcc, 16, v30
s_cmp_lg_u64 vcc, 0
v_mfma_f32_16x16x32_bf16 v[212:215], a[108:111], a[188:191], v[212:215]
s_cbranch_scc1 kf_kernel_spin_kv
kf_kernel_ret_kv:
v_mfma_f32_16x16x32_bf16 v[168:171], a[112:115], a[160:163], v[168:171]
ds_read_b64_tr_b16 a[80:81], v7 offset:0
ds_read_b64_tr_b16 a[82:83], v7 offset:512
v_mfma_f32_16x16x32_bf16 v[168:171], a[116:119], a[164:167], v[168:171]
s_waitcnt lgkmcnt(10)
ds_read_b64_tr_b16 a[84:85], v7 offset:4096
ds_read_b64_tr_b16 a[86:87], v7 offset:4608
v_mfma_f32_16x16x32_bf16 v[184:187], a[112:115], a[168:171], v[184:187]
ds_read_b64_tr_b16 a[88:89], v8 offset:0
ds_read_b64_tr_b16 a[90:91], v8 offset:512
v_mfma_f32_16x16x32_bf16 v[184:187], a[116:119], a[172:175], v[184:187]
s_add_u32 m0, s28, 0
s_lshl_b32 s60, s100, 7
v_mfma_f32_16x16x32_bf16 v[200:203], a[112:115], a[176:179], v[200:203]
ds_read_b64_tr_b16 a[92:93], v8 offset:4096
ds_read_b64_tr_b16 a[94:95], v8 offset:4608
v_mfma_f32_16x16x32_bf16 v[200:203], a[116:119], a[180:183], v[200:203]
buffer_load_dwordx4 v4, s[8:11], s36 offen offset:0 sc1 lds
v_mfma_f32_16x16x32_bf16 v[216:219], a[112:115], a[184:187], v[216:219]
v_mfma_f32_16x16x32_bf16 v[216:219], a[116:119], a[188:191], v[216:219]
v_and_b32 v1, 15, v0
v_mfma_f32_16x16x32_bf16 v[172:175], a[120:123], a[160:163], v[172:175]
s_add_u32 s60, s60, 46135616
v_mfma_f32_16x16x32_bf16 v[172:175], a[124:127], a[164:167], v[172:175]
v_bfe_u32 v2, v0, 4, 1
s_mov_b32 s43, 0x20000
v_mfma_f32_16x16x32_bf16 v[188:191], a[120:123], a[168:171], v[188:191]
v_mfma_f32_16x16x32_bf16 v[188:191], a[124:127], a[172:175], v[188:191]
v_mfma_f32_16x16x32_bf16 v[204:207], a[120:123], a[176:179], v[204:207]
v_mfma_f32_16x16x32_bf16 v[204:207], a[124:127], a[180:183], v[204:207]
buffer_load_dwordx4 v4, s[8:11], s36 offen offset:1024 sc1 lds
v_mfma_f32_16x16x32_bf16 v[220:223], a[120:123], a[184:187], v[220:223]
v_mfma_f32_16x16x32_bf16 v[220:223], a[124:127], a[188:191], v[220:223]
s_waitcnt vmcnt(29) lgkmcnt(12)
ds_read_b64_tr_b16 a[96:97], v5 offset:8192
s_load_dwordx2 s[16:17], s[0:1], 40
v_mfma_f32_16x16x32_bf16 v[160:163], a[64:67], a[192:195], v[160:163]
s_load_dwordx4 s[44:47], s[0:1], 64
s_load_dwordx2 s[12:13], s[0:1], 80
ds_read_b64_tr_b16 a[98:99], v5 offset:8704
v_mfma_f32_16x16x32_bf16 v[160:163], a[68:71], a[196:199], v[160:163]
ds_read_b64_tr_b16 a[100:101], v5 offset:12288
v_mul_u32_u24 v1, 1728, v1
v_mfma_f32_16x16x32_bf16 v[176:179], a[64:67], a[200:203], v[176:179]
s_waitcnt lgkmcnt(11)
ds_read_b64_tr_b16 a[102:103], v5 offset:12800
ds_read_b64_tr_b16 a[104:105], v6 offset:8192
v_mfma_f32_16x16x32_bf16 v[176:179], a[68:71], a[204:207], v[176:179]
buffer_load_dwordx4 v4, s[8:11], s36 offen offset:2048 sc1 lds
v_mfma_f32_16x16x32_bf16 v[192:195], a[64:67], a[208:211], v[192:195]
ds_read_b64_tr_b16 a[106:107], v6 offset:8704
ds_read_b64_tr_b16 a[108:109], v6 offset:12288
v_mfma_f32_16x16x32_bf16 v[192:195], a[68:71], a[212:215], v[192:195]
v_lshl_add_u32 v1, v2, 5, v1
v_mfma_f32_16x16x32_bf16 v[208:211], a[64:67], a[216:219], v[208:211]
buffer_load_dwordx4 v4, s[8:11], s36 offen offset:3072 sc1 lds
v_mfma_f32_16x16x32_bf16 v[208:211], a[68:71], a[220:223], v[208:211]
s_sub_u32 s36, s36, 16384
v_mov_b32 v15, 0xbdd2d3e8
v_mfma_f32_16x16x32_bf16 v[164:167], a[72:75], a[192:195], v[164:167]
ds_read_b64_tr_b16 a[110:111], v6 offset:12800
s_lshl_b32 s59, s100, 11
v_mfma_f32_16x16x32_bf16 v[164:167], a[76:79], a[196:199], v[164:167]
s_add_u32 s59, s59, 41943040
s_cmp_ge_u32 s100, 27
v_mfma_f32_16x16x32_bf16 v[180:183], a[72:75], a[200:203], v[180:183]
v_mov_b32 v14, 0xc0135761
v_bfe_u32 v2, v0, 5, 1
v_mfma_f32_16x16x32_bf16 v[180:183], a[76:79], a[204:207], v[180:183]
s_cselect_b32 s60, 1073741824, s60
s_cmp_ge_u32 s100, 14
s_cselect_b64 vcc, -1, 0
v_mfma_f32_16x16x32_bf16 v[196:199], a[72:75], a[208:211], v[196:199]
s_waitcnt lgkmcnt(12)
s_cselect_b32 s14, s60, s59
s_waitcnt lgkmcnt(8)
v_mfma_f32_16x16x32_bf16 v[196:199], a[76:79], a[212:215], v[196:199]
ds_read_b64_tr_b16 a[112:113], v7 offset:8192
s_add_u32 s59, s59, 1024
v_mfma_f32_16x16x32_bf16 v[212:215], a[72:75], a[216:219], v[212:215]
s_branch kf_kernel_pl12
kf_kernel_pd12:
s_branch kf_kernel_pd16
kf_kernel_pl12:
ds_read_b64_tr_b16 a[114:115], v7 offset:8704
v_mfma_f32_16x16x32_bf16 v[212:215], a[76:79], a[220:223], v[212:215]
ds_read_b64_tr_b16 a[116:117], v7 offset:12288
s_mov_b32 s27, 0
v_mfma_f32_16x16x32_bf16 v[168:171], a[80:83], a[192:195], v[168:171]
s_add_u32 s60, s60, 64
s_cmp_ge_u32 s100, 13
ds_read_b64_tr_b16 a[118:119], v7 offset:12800
v_mfma_f32_16x16x32_bf16 v[168:171], a[84:87], a[196:199], v[168:171]
v_mfma_f32_16x16x32_bf16 v[184:187], a[80:83], a[200:203], v[184:187]
s_mov_b32 s40, s6
v_mov_b32 v16, 0x3e0293ee
v_lshl_add_u32 v9, v2, 4, v1
v_mfma_f32_16x16x32_bf16 v[184:187], a[84:87], a[204:207], v[184:187]
ds_read_b64_tr_b16 a[120:121], v8 offset:8192
ds_read_b64_tr_b16 a[122:123], v8 offset:8704
v_mfma_f32_16x16x32_bf16 v[200:203], a[80:83], a[208:211], v[200:203]
v_cndmask_b32 v11, v4, v9, vcc
s_cselect_b64 vcc, -1, 0
v_mfma_f32_16x16x32_bf16 v[200:203], a[84:87], a[212:215], v[200:203]
s_cselect_b32 s15, s60, s59
ds_read_b64_tr_b16 a[124:125], v8 offset:12288
s_lshl_b32 s3, s22, 2
v_mfma_f32_16x16x32_bf16 v[216:219], a[80:83], a[216:219], v[216:219]
s_add_u32 s3, s3, s20
s_lshl_b32 s3, s3, 8
s_add_u32 s3, s3, 3194880
v_mfma_f32_16x16x32_bf16 v[216:219], a[84:87], a[220:223], v[216:219]
v_mfma_f32_16x16x32_bf16 v[172:175], a[88:91], a[192:195], v[172:175]
s_cmp_ge_u32 s100, 27
v_mov_b32 v2, 1073741824
v_mfma_f32_16x16x32_bf16 v[172:175], a[92:95], a[196:199], v[172:175]
ds_read_b64_tr_b16 a[126:127], v8 offset:12800
v_mfma_f32_16x16x32_bf16 v[188:191], a[88:91], a[200:203], v[188:191]
v_cndmask_b32 v12, v4, v9, vcc
v_cmp_eq_u32 vcc, 0, v4
v_mfma_f32_16x16x32_bf16 v[188:191], a[92:95], a[204:207], v[188:191]
s_cselect_b32 s3, 1073741824, s3
s_lshl_b32 s32, s22, 3
v_mfma_f32_16x16x32_bf16 v[204:207], a[88:91], a[208:211], v[204:207]
s_add_u32 s32, s32, s20
s_sub_u32 s32, 63, s32
v_mfma_f32_16x16x32_bf16 v[204:207], a[92:95], a[212:215], v[204:207]
s_mul_i32 s60, s31, 27648
v_cndmask_b32 v10, v2, 0, vcc
s_lshr_b32 s32, s32, 1
v_mfma_f32_16x16x32_bf16 v[220:223], a[88:91], a[216:219], v[220:223]
s_lshl_b32 s32, s32, 15
s_mov_b32 s42, 134217728
s_mul_i32 s59, s30, 27648
v_mfma_f32_16x16x32_bf16 v[220:223], a[92:95], a[220:223], v[220:223]
s_waitcnt vmcnt(4) lgkmcnt(12)
s_barrier
v_mfma_f32_16x16x32_bf16 v[160:163], a[96:99], a[128:131], v[160:163]
s_mov_b32 s41, s7
s_add_u32 s32, s32, s28
v_mfma_f32_16x16x32_bf16 v[160:163], a[100:103], a[132:135], v[160:163]
ds_read_b64_tr_b16 a[64:65], v21 offset:16384
ds_read_b64_tr_b16 a[66:67], v21 offset:17408
v_mfma_f32_16x16x32_bf16 v[176:179], a[96:99], a[136:139], v[176:179]
s_cmp_eq_u32 s22, 7
ds_read_b64_tr_b16 a[68:69], v21 offset:24576
ds_read_b64_tr_b16 a[70:71], v21 offset:25600
v_mfma_f32_16x16x32_bf16 v[176:179], a[100:103], a[140:143], v[176:179]
s_waitcnt lgkmcnt(12)
s_waitcnt lgkmcnt(8)
s_cselect_b32 s26, 10, 8
v_mfma_f32_16x16x32_bf16 v[192:195], a[96:99], a[144:147], v[192:195]
s_lshl_b32 s26, s26, 14
s_add_u32 s26, s26, s28
s_cmp_eq_u32 s4, s57
v_mfma_f32_16x16x32_bf16 v[192:195], a[100:103], a[148:151], v[192:195]
s_cselect_b32 s63, 1, 0
s_mov_b32 s56, 0x4f800000
ds_read_b64_tr_b16 a[72:73], v21 offset:32768
v_mfma_f32_16x16x32_bf16 v[208:211], a[96:99], a[152:155], v[208:211]
s_and_b32 s34, s24, 3
s_lshl_b32 s38, s34, 3
v_mfma_f32_16x16x32_bf16 v[208:211], a[100:103], a[156:159], v[208:211]
s_sub_u32 s62, s22, 1
v_mov_b32 v20, 0x1c000
s_cmp_le_u32 s22, 4
v_mfma_f32_16x16x32_bf16 v[164:167], a[104:107], a[128:131], v[164:167]
s_cselect_b32 s62, s34, s62
s_cselect_b32 s38, 0, s38
s_mul_i32 s34, s22, 6
v_mfma_f32_16x16x32_bf16 v[164:167], a[108:111], a[132:135], v[164:167]
s_mov_b32 s39, s28
s_add_u32 s34, s34, 8
s_cmp_lt_u32 s22, 4
v_mfma_f32_16x16x32_bf16 v[180:183], a[104:107], a[136:139], v[180:183]
s_cselect_b32 s38, s34, s38
s_waitcnt lgkmcnt(5)
ds_read_b64_tr_b16 a[74:75], v21 offset:33792
v_mfma_f32_16x16x32_bf16 v[180:183], a[108:111], a[140:143], v[180:183]
s_lshr_b32 s34, s23, 1
s_lshl_b32 s34, s34, 5
s_waitcnt lgkmcnt(2)
v_mfma_f32_16x16x32_bf16 v[196:199], a[104:107], a[144:147], v[196:199]
ds_read_b64_tr_b16 a[76:77], v21 offset:40960
ds_read_b64_tr_b16 a[78:79], v21 offset:41984
v_mfma_f32_16x16x32_bf16 v[196:199], a[108:111], a[148:151], v[196:199]
ds_read_b64_tr_b16 a[80:81], v21 offset:49152
ds_read_b64_tr_b16 a[82:83], v21 offset:50176
v_mfma_f32_16x16x32_bf16 v[212:215], a[104:107], a[152:155], v[212:215]
s_add_u32 s38, s38, s34
s_and_b32 s34, s23, 1
v_mfma_f32_16x16x32_bf16 v[212:215], a[108:111], a[156:159], v[212:215]
s_lshl2_add_u32 s62, s62, s20
ds_read_b64_tr_b16 a[84:85], v21 offset:57344
ds_read_b64_tr_b16 a[86:87], v21 offset:58368
v_mfma_f32_16x16x32_bf16 v[168:171], a[112:115], a[128:131], v[168:171]
ds_read_b64_tr_b16 a[88:89], v22 offset:16384
v_mfma_f32_16x16x32_bf16 v[168:171], a[116:119], a[132:135], v[168:171]
s_lshl1_add_u32 s33, s62, s34
ds_read_b64_tr_b16 a[90:91], v22 offset:17408
ds_read_b64_tr_b16 a[92:93], v22 offset:24576
v_mfma_f32_16x16x32_bf16 v[184:187], a[112:115], a[136:139], v[184:187]
s_lshl_b32 s33, s33, 16
s_add_u32 s33, s33, 50393088
ds_read_b64_tr_b16 a[94:95], v22 offset:25600
v_mfma_f32_16x16x32_bf16 v[184:187], a[116:119], a[140:143], v[184:187]
s_cmp_ge_u32 s62, 27
s_cselect_b32 s33, 1073741824, s33
s_lshl1_add_u32 s34, s20, s38
v_mfma_f32_16x16x32_bf16 v[200:203], a[112:115], a[144:147], v[200:203]
v_mfma_f32_16x16x32_bf16 v[200:203], a[116:119], a[148:151], v[200:203]
s_lshl_b32 s34, s34, 16
s_add_u32 s35, s34, 1920
v_mfma_f32_16x16x32_bf16 v[216:219], a[112:115], a[152:155], v[216:219]
s_lshr_b32 s34, s22, 2
s_sub_u32 s34, s20, s34
s_mov_b32 s57, 0xff800000
v_mfma_f32_16x16x32_bf16 v[216:219], a[116:119], a[156:159], v[216:219]
s_cmp_eq_u32 s34, 3
s_cselect_b32 s35, 1073741824, s35
s_lshl_b32 s37, s23, 5
v_mfma_f32_16x16x32_bf16 v[172:175], a[120:123], a[128:131], v[172:175]
v_mfma_f32_16x16x32_bf16 v[172:175], a[124:127], a[132:135], v[172:175]
v_mfma_f32_16x16x32_bf16 v[188:191], a[120:123], a[136:139], v[188:191]
s_add_u32 s37, s37, s24
s_add_u32 m0, s28, 16384
s_mov_b32 s61, 16384
v_mfma_f32_16x16x32_bf16 v[188:191], a[124:127], a[140:143], v[188:191]
buffer_load_dwordx4 v4, s[8:11], s36 offen offset:0 sc1 lds
v_mfma_f32_16x16x32_bf16 v[204:207], a[120:123], a[144:147], v[204:207]
v_pk_mul_f32 v[230:231], v[166:167], v[166:167]
v_pk_mul_f32 v[228:229], v[164:165], v[164:165]
v_pk_fma_f32 v[228:229], v[14:15], v[228:229], v[14:15] op_sel:[1,0,0] op_sel_hi:[1,1,0]
v_pk_mul_f32 v[226:227], v[162:163], v[162:163]
v_pk_mul_f32 v[224:225], v[160:161], v[160:161]
v_pk_fma_f32 v[224:225], v[14:15], v[224:225], v[14:15] op_sel:[1,0,0] op_sel_hi:[1,1,0]
v_pk_fma_f32 v[230:231], v[14:15], v[230:231], v[14:15] op_sel:[1,0,0] op_sel_hi:[1,1,0]
v_pk_mul_f32 v[228:229], v[228:229], v[164:165]
v_pk_mul_f32 v[230:231], v[230:231], v[166:167]
v_pk_mul_f32 v[224:225], v[224:225], v[160:161]
v_pk_fma_f32 v[226:227], v[14:15], v[226:227], v[14:15] op_sel:[1,0,0] op_sel_hi:[1,1,0]
v_pk_mul_f32 v[226:227], v[226:227], v[162:163]
v_exp_f32 v227, v227
v_mfma_f32_16x16x32_bf16 v[204:207], a[124:127], a[148:151], v[204:207]
v_exp_f32 v225, v225
v_mfma_f32_16x16x32_bf16 v[220:223], a[120:123], a[152:155], v[220:223]
v_exp_f32 v226, v226
v_mfma_f32_16x16x32_bf16 v[220:223], a[124:127], a[156:159], v[220:223]
s_waitcnt lgkmcnt(8)
buffer_load_dwordx4 v4, s[8:11], s36 offen offset:1024 sc1 lds
v_mfma_f32_16x16x32_bf16 v[32:35], a[64:67], a[160:163], v[32:35]
ds_read_b64_tr_b16 a[96:97], v22 offset:32768
ds_read_b64_tr_b16 a[98:99], v22 offset:33792
v_mfma_f32_16x16x32_bf16 v[32:35], a[68:71], a[164:167], v[32:35]
v_exp_f32 v230, v230
v_mfma_f32_16x16x32_bf16 v[64:67], a[64:67], a[168:171], v[64:67]
ds_read_b64_tr_b16 a[100:101], v22 offset:40960
v_exp_f32 v224, v224
v_exp_f32 v228, v228
v_pk_mul_f32 v[238:239], v[182:183], v[182:183]
v_pk_add_f32 v[224:225], v[224:225], 1.0 op_sel_hi:[1,0]
v_pk_fma_f32 v[238:239], v[14:15], v[238:239], v[14:15] op_sel:[1,0,0] op_sel_hi:[1,1,0]
v_rcp_f32 v224, v224
v_pk_mul_f32 v[234:235], v[178:179], v[178:179]
v_pk_mul_f32 v[238:239], v[238:239], v[182:183]
v_pk_fma_f32 v[234:235], v[14:15], v[234:235], v[14:15] op_sel:[1,0,0] op_sel_hi:[1,1,0]
v_pk_mul_f32 v[234:235], v[234:235], v[178:179]
v_pk_add_f32 v[226:227], v[226:227], 1.0 op_sel_hi:[1,0]
v_exp_f32 v231, v231
v_rcp_f32 v226, v226
v_pk_mul_f32 v[236:237], v[180:181], v[180:181]
v_pk_fma_f32 v[236:237], v[14:15], v[236:237], v[14:15] op_sel:[1,0,0] op_sel_hi:[1,1,0]
v_pk_add_f32 v[230:231], v[230:231], 1.0 op_sel_hi:[1,0]
v_mfma_f32_16x16x32_bf16 v[64:67], a[68:71], a[172:175], v[64:67]
ds_read_b64_tr_b16 a[102:103], v22 offset:41984
ds_read_b64_tr_b16 a[104:105], v22 offset:49152
v_mfma_f32_16x16x32_bf16 v[96:99], a[64:67], a[176:179], v[96:99]
buffer_load_dwordx4 v4, s[8:11], s36 offen offset:2048 sc1 lds
v_mfma_f32_16x16x32_bf16 v[96:99], a[68:71], a[180:183], v[96:99]
s_sub_u32 s58, 3, s20
ds_read_b64_tr_b16 a[106:107], v22 offset:50176
v_exp_f32 v229, v229
v_exp_f32 v235, v235
v_pk_mul_f32 v[236:237], v[236:237], v[180:181]
v_pk_mul_f32 v[232:233], v[176:177], v[176:177]
v_pk_fma_f32 v[232:233], v[14:15], v[232:233], v[14:15] op_sel:[1,0,0] op_sel_hi:[1,1,0]
v_pk_mul_f32 v[232:233], v[232:233], v[176:177]
v_pk_add_f32 v[228:229], v[228:229], 1.0 op_sel_hi:[1,0]
v_exp_f32 v238, v238
v_mfma_f32_16x16x32_bf16 v[128:131], a[64:67], a[184:187], v[128:131]
s_waitcnt lgkmcnt(10)
v_rcp_f32 v230, v230
v_mfma_f32_16x16x32_bf16 v[128:131], a[68:71], a[188:191], v[128:131]
v_exp_f32 v239, v239
v_mfma_f32_16x16x32_bf16 v[32:35], a[72:75], a[192:195], v[32:35]
v_exp_f32 v234, v234
v_mfma_f32_16x16x32_bf16 v[32:35], a[76:79], a[196:199], v[32:35]
ds_read_b64_tr_b16 a[108:109], v22 offset:57344
ds_read_b64_tr_b16 a[110:111], v22 offset:58368
v_mfma_f32_16x16x32_bf16 v[64:67], a[72:75], a[200:203], v[64:67]
v_rcp_f32 v229, v229
v_mfma_f32_16x16x32_bf16 v[64:67], a[76:79], a[204:207], v[64:67]
v_exp_f32 v236, v236
v_mfma_f32_16x16x32_bf16 v[96:99], a[72:75], a[208:211], v[96:99]
v_rcp_f32 v225, v225
v_exp_f32 v237, v237
v_rcp_f32 v231, v231
v_pk_mul_f32 v[242:243], v[194:195], v[194:195]
v_pk_add_f32 v[238:239], v[238:239], 1.0 op_sel_hi:[1,0]
v_exp_f32 v233, v233
v_pk_mul_f32 v[244:245], v[196:197], v[196:197]
v_pk_mul_f32 v[166:167], v[166:167], v[230:231]
v_pk_fma_f32 v[244:245], v[14:15], v[244:245], v[14:15] op_sel:[1,0,0] op_sel_hi:[1,1,0]
v_pk_mul_f32 v[244:245], v[244:245], v[196:197]
v_mfma_f32_16x16x32_bf16 v[96:99], a[76:79], a[212:215], v[96:99]
buffer_load_dwordx4 v4, s[8:11], s36 offen offset:3072 sc1 lds
v_rcp_f32 v227, v227
v_rcp_f32 v228, v228
v_pk_mul_f32 v[162:163], v[162:163], v[226:227]
v_pk_mul_f32 v[160:161], v[160:161], v[224:225]
v_cvt_pk_bf16_f32 v160, v160, v161
v_cvt_pk_bf16_f32 v161, v162, v163
v_pk_mul_f32 v[246:247], v[198:199], v[198:199]
v_pk_fma_f32 v[246:247], v[14:15], v[246:247], v[14:15] op_sel:[1,0,0] op_sel_hi:[1,1,0]
v_pk_fma_f32 v[242:243], v[14:15], v[242:243], v[14:15] op_sel:[1,0,0] op_sel_hi:[1,1,0]
v_cvt_pk_bf16_f32 v163, v166, v167
v_pk_mul_f32 v[242:243], v[242:243], v[194:195]
v_exp_f32 v232, v232
v_pk_add_f32 v[236:237], v[236:237], 1.0 op_sel_hi:[1,0]
v_pk_add_f32 v[234:235], v[234:235], 1.0 op_sel_hi:[1,0]
v_pk_mul_f32 v[164:165], v[164:165], v[228:229]
v_mfma_f32_16x16x32_bf16 v[128:131], a[72:75], a[216:219], v[128:131]
v_rcp_f32 v236, v236
v_mfma_f32_16x16x32_bf16 v[128:131], a[76:79], a[220:223], v[128:131]
ds_read_b64_tr_b16 a[112:113], v23 offset:16384
ds_read_b64_tr_b16 a[114:115], v23 offset:17408
v_mfma_f32_16x16x32_bf16 v[32:35], a[80:83], a[128:131], v[32:35]
s_waitcnt lgkmcnt(10)
v_rcp_f32 v239, v239
v_cvt_pk_bf16_f32 v162, v164, v165
v_rcp_f32 v235, v235
v_pk_mul_f32 v[240:241], v[192:193], v[192:193]
v_pk_fma_f32 v[240:241], v[14:15], v[240:241], v[14:15] op_sel:[1,0,0] op_sel_hi:[1,1,0]
v_pk_mul_f32 v[240:241], v[240:241], v[192:193]
v_pk_add_f32 v[232:233], v[232:233], 1.0 op_sel_hi:[1,0]
v_permlane16_swap_b32 v160, v162
v_pk_mul_f32 v[246:247], v[246:247], v[198:199]
v_mfma_f32_16x16x32_bf16 v[32:35], a[84:87], a[132:135], v[32:35]
s_add_u32 s34, s59, s14
v_exp_f32 v242, v242
v_permlane16_swap_b32 v161, v163
v_mfma_f32_16x16x32_bf16 v[64:67], a[80:83], a[136:139], v[64:67]
ds_read_b64_tr_b16 a[116:117], v23 offset:24576
ds_read_b64_tr_b16 a[118:119], v23 offset:25600
v_mfma_f32_16x16x32_bf16 v[64:67], a[84:87], a[140:143], v[64:67]
buffer_store_dwordx4 v[160:163], v11, s[40:43], s34 offen sc1
v_exp_f32 v243, v243
v_mfma_f32_16x16x32_bf16 v[96:99], a[80:83], a[144:147], v[96:99]
ds_read_b64_tr_b16 a[120:121], v23 offset:32768
v_exp_f32 v246, v246
v_mfma_f32_16x16x32_bf16 v[96:99], a[84:87], a[148:151], v[96:99]
s_sub_u32 s36, s36, 16384
v_rcp_f32 v234, v234
v_mfma_f32_16x16x32_bf16 v[128:131], a[80:83], a[152:155], v[128:131]
v_rcp_f32 v233, v233
v_mfma_f32_16x16x32_bf16 v[128:131], a[84:87], a[156:159], v[128:131]
v_exp_f32 v245, v245
v_mfma_f32_16x16x32_bf16 v[36:39], a[88:91], a[160:163], v[36:39]
v_exp_f32 v244, v244
v_mfma_f32_16x16x32_bf16 v[36:39], a[92:95], a[164:167], v[36:39]
ds_read_b64_tr_b16 a[122:123], v23 offset:33792
ds_read_b64_tr_b16 a[124:125], v23 offset:40960
v_mfma_f32_16x16x32_bf16 v[68:71], a[88:91], a[168:171], v[68:71]
v_rcp_f32 v237, v237
v_mfma_f32_16x16x32_bf16 v[68:71], a[92:95], a[172:175], v[68:71]
v_rcp_f32 v232, v232
v_mfma_f32_16x16x32_bf16 v[100:103], a[88:91], a[176:179], v[100:103]
v_exp_f32 v240, v240
v_mfma_f32_16x16x32_bf16 v[100:103], a[92:95], a[180:183], v[100:103]
v_exp_f32 v241, v241
v_rcp_f32 v238, v238
v_exp_f32 v247, v247
v_pk_mul_f32 v[224:225], v[208:209], v[208:209]
v_pk_add_f32 v[246:247], v[246:247], 1.0 op_sel_hi:[1,0]
v_pk_mul_f32 v[228:229], v[212:213], v[212:213]
v_pk_mul_f32 v[180:181], v[180:181], v[236:237]
v_pk_mul_f32 v[176:177], v[176:177], v[232:233]
v_pk_add_f32 v[240:241], v[240:241], 1.0 op_sel_hi:[1,0]
v_pk_mul_f32 v[230:231], v[214:215], v[214:215]
v_pk_fma_f32 v[230:231], v[14:15], v[230:231], v[14:15] op_sel:[1,0,0] op_sel_hi:[1,1,0]
v_pk_mul_f32 v[230:231], v[230:231], v[214:215]
v_pk_mul_f32 v[178:179], v[178:179], v[234:235]
v_pk_fma_f32 v[224:225], v[14:15], v[224:225], v[14:15] op_sel:[1,0,0] op_sel_hi:[1,1,0]
v_pk_mul_f32 v[224:225], v[224:225], v[208:209]
v_pk_add_f32 v[242:243], v[242:243], 1.0 op_sel_hi:[1,0]
v_pk_mul_f32 v[226:227], v[210:211], v[210:211]
v_mfma_f32_16x16x32_bf16 v[132:135], a[88:91], a[184:187], v[132:135]
ds_read_b64_tr_b16 a[126:127], v23 offset:41984
ds_read_b64_tr_b16 a[64:65], v23 offset:49152
v_mfma_f32_16x16x32_bf16 v[132:135], a[92:95], a[188:191], v[132:135]
s_waitcnt lgkmcnt(13)
ds_read_b64_tr_b16 a[66:67], v23 offset:50176
v_rcp_f32 v241, v241
v_cvt_pk_bf16_f32 v176, v176, v177
v_cvt_pk_bf16_f32 v177, v178, v179
v_exp_f32 v225, v225
v_pk_mul_f32 v[182:183], v[182:183], v[238:239]
v_pk_fma_f32 v[226:227], v[14:15], v[226:227], v[14:15] op_sel:[1,0,0] op_sel_hi:[1,1,0]
v_pk_fma_f32 v[228:229], v[14:15], v[228:229], v[14:15] op_sel:[1,0,0] op_sel_hi:[1,1,0]
v_pk_mul_f32 v[228:229], v[228:229], v[212:213]
v_pk_mul_f32 v[226:227], v[226:227], v[210:211]
v_pk_add_f32 v[244:245], v[244:245], 1.0 op_sel_hi:[1,0]
v_mfma_f32_16x16x32_bf16 v[36:39], a[96:99], a[192:195], v[36:39]
v_cvt_pk_bf16_f32 v178, v180, v181
v_cvt_pk_bf16_f32 v179, v182, v183
v_mfma_f32_16x16x32_bf16 v[36:39], a[100:103], a[196:199], v[36:39]
s_waitcnt lgkmcnt(10)
ds_read_b64_tr_b16 a[68:69], v23 offset:57344
ds_read_b64_tr_b16 a[70:71], v23 offset:58368
ds_read_b64_tr_b16 a[72:73], v24 offset:16384
v_mfma_f32_16x16x32_bf16 v[68:71], a[96:99], a[200:203], v[68:71]
v_permlane16_swap_b32 v176, v178
v_mfma_f32_16x16x32_bf16 v[68:71], a[100:103], a[204:207], v[68:71]
s_add_u32 s34, s34, 27648
v_permlane16_swap_b32 v177, v179
v_mfma_f32_16x16x32_bf16 v[100:103], a[96:99], a[208:211], v[100:103]
buffer_store_dwordx4 v[176:179], v11, s[40:43], s34 offen sc1
v_mfma_f32_16x16x32_bf16 v[100:103], a[100:103], a[212:215], v[100:103]
v_rcp_f32 v247, v247
v_mfma_f32_16x16x32_bf16 v[132:135], a[96:99], a[216:219], v[132:135]
v_rcp_f32 v245, v245
v_mfma_f32_16x16x32_bf16 v[132:135], a[100:103], a[220:223], v[132:135]
v_rcp_f32 v242, v242
v_mfma_f32_16x16x32_bf16 v[36:39], a[104:107], a[128:131], v[36:39]
v_rcp_f32 v243, v243
v_mfma_f32_16x16x32_bf16 v[36:39], a[108:111], a[132:135], v[36:39]
v_exp_f32 v227, v227
v_rcp_f32 v244, v244
v_exp_f32 v230, v230
v_exp_f32 v224, v224
v_pk_mul_f32 v[236:237], v[172:173], v[172:173]
v_pk_fma_f32 v[236:237], v[14:15], v[236:237], v[14:15] op_sel:[1,0,0] op_sel_hi:[1,1,0]
v_pk_mul_f32 v[234:235], v[170:171], v[170:171]
v_pk_mul_f32 v[232:233], v[168:169], v[168:169]
v_pk_fma_f32 v[234:235], v[14:15], v[234:235], v[14:15] op_sel:[1,0,0] op_sel_hi:[1,1,0]
v_pk_add_f32 v[224:225], v[224:225], 1.0 op_sel_hi:[1,0]
v_mfma_f32_16x16x32_bf16 v[68:71], a[104:107], a[136:139], v[68:71]
s_add_u32 m0, s28, 32768
ds_read_b64_tr_b16 a[74:75], v24 offset:17408
ds_read_b64_tr_b16 a[76:77], v24 offset:24576
ds_read_b64_tr_b16 a[78:79], v24 offset:25600
v_mfma_f32_16x16x32_bf16 v[68:71], a[108:111], a[140:143], v[68:71]
buffer_load_dwordx4 v4, s[8:11], s36 offen offset:0 sc1 lds
v_mfma_f32_16x16x32_bf16 v[100:103], a[104:107], a[144:147], v[100:103]
v_exp_f32 v226, v226
v_mfma_f32_16x16x32_bf16 v[100:103], a[108:111], a[148:151], v[100:103]
v_exp_f32 v231, v231
v_rcp_f32 v240, v240
v_rcp_f32 v246, v246
v_pk_mul_f32 v[196:197], v[196:197], v[244:245]
v_pk_fma_f32 v[232:233], v[14:15], v[232:233], v[14:15] op_sel:[1,0,0] op_sel_hi:[1,1,0]
v_pk_mul_f32 v[192:193], v[192:193], v[240:241]
v_pk_mul_f32 v[194:195], v[194:195], v[242:243]
v_mfma_f32_16x16x32_bf16 v[132:135], a[104:107], a[152:155], v[132:135]
s_waitcnt lgkmcnt(12)
ds_read_b64_tr_b16 a[80:81], v24 offset:32768
ds_read_b64_tr_b16 a[82:83], v24 offset:33792
v_mfma_f32_16x16x32_bf16 v[132:135], a[108:111], a[156:159], v[132:135]
v_cvt_pk_bf16_f32 v192, v192, v193
v_exp_f32 v228, v228
v_cvt_pk_bf16_f32 v193, v194, v195
v_exp_f32 v229, v229
v_pk_mul_f32 v[238:239], v[174:175], v[174:175]
v_pk_mul_f32 v[234:235], v[234:235], v[170:171]
v_pk_add_f32 v[230:231], v[230:231], 1.0 op_sel_hi:[1,0]
v_pk_fma_f32 v[238:239], v[14:15], v[238:239], v[14:15] op_sel:[1,0,0] op_sel_hi:[1,1,0]
v_pk_mul_f32 v[238:239], v[238:239], v[174:175]
v_pk_add_f32 v[226:227], v[226:227], 1.0 op_sel_hi:[1,0]
v_pk_mul_f32 v[236:237], v[236:237], v[172:173]
v_cvt_pk_bf16_f32 v194, v196, v197
v_pk_mul_f32 v[232:233], v[232:233], v[168:169]
v_pk_mul_f32 v[198:199], v[198:199], v[246:247]
v_mfma_f32_16x16x32_bf16 v[40:43], a[112:115], a[160:163], v[40:43]
buffer_load_dwordx4 v4, s[8:11], s36 offen offset:1024 sc1 lds
v_cvt_pk_bf16_f32 v195, v198, v199
v_rcp_f32 v227, v227
v_pk_add_f32 v[228:229], v[228:229], 1.0 op_sel_hi:[1,0]
v_mfma_f32_16x16x32_bf16 v[40:43], a[116:119], a[164:167], v[40:43]
ds_read_b64_tr_b16 a[84:85], v24 offset:40960
ds_read_b64_tr_b16 a[86:87], v24 offset:41984
v_mfma_f32_16x16x32_bf16 v[72:75], a[112:115], a[168:171], v[72:75]
s_add_u32 s34, s60, s14
v_permlane16_swap_b32 v192, v194
v_mfma_f32_16x16x32_bf16 v[72:75], a[116:119], a[172:175], v[72:75]
v_permlane16_swap_b32 v193, v195
v_mfma_f32_16x16x32_bf16 v[104:107], a[112:115], a[176:179], v[104:107]
buffer_store_dwordx4 v[192:195], v11, s[40:43], s34 offen sc1
v_mfma_f32_16x16x32_bf16 v[104:107], a[116:119], a[180:183], v[104:107]
buffer_load_dwordx4 v4, s[8:11], s36 offen offset:2048 sc1 lds
v_mfma_f32_16x16x32_bf16 v[136:139], a[112:115], a[184:187], v[136:139]
v_accvgpr_write_b32 a241, 0
v_rcp_f32 v224, v224
v_rcp_f32 v225, v225
v_pk_mul_f32 v[38:39], v[38:39], v[16:17] op_sel_hi:[1,0]
v_pk_mul_f32 v[34:35], v[34:35], v[16:17] op_sel_hi:[1,0]
v_pk_mul_f32 v[132:133], v[132:133], v[16:17] op_sel_hi:[1,0]
v_pk_mul_f32 v[128:129], v[128:129], v[16:17] op_sel_hi:[1,0]
v_pk_mul_f32 v[68:69], v[68:69], v[16:17] op_sel_hi:[1,0]
v_pk_mul_f32 v[130:131], v[130:131], v[16:17] op_sel_hi:[1,0]
v_pk_mul_f32 v[102:103], v[102:103], v[16:17] op_sel_hi:[1,0]
v_pk_mul_f32 v[96:97], v[96:97], v[16:17] op_sel_hi:[1,0]
v_pk_mul_f32 v[64:65], v[64:65], v[16:17] op_sel_hi:[1,0]
v_pk_mul_f32 v[36:37], v[36:37], v[16:17] op_sel_hi:[1,0]
v_pk_mul_f32 v[134:135], v[134:135], v[16:17] op_sel_hi:[1,0]
v_pk_mul_f32 v[66:67], v[66:67], v[16:17] op_sel_hi:[1,0]
v_pk_mul_f32 v[32:33], v[32:33], v[16:17] op_sel_hi:[1,0]
v_cvt_pk_bf16_f32 v32, v32, v33
v_pk_mul_f32 v[98:99], v[98:99], v[16:17] op_sel_hi:[1,0]
v_pk_mul_f32 v[70:71], v[70:71], v[16:17] op_sel_hi:[1,0]
v_cvt_pk_bf16_f32 v96, v96, v97
v_mfma_f32_16x16x32_bf16 v[136:139], a[116:119], a[188:191], v[136:139]
s_waitcnt lgkmcnt(12)
ds_read_b64_tr_b16 a[88:89], v24 offset:49152
ds_read_b64_tr_b16 a[90:91], v24 offset:50176
v_mfma_f32_16x16x32_bf16 v[40:43], a[120:123], a[192:195], v[40:43]
ds_read_b64_tr_b16 a[92:93], v24 offset:57344
ds_read_b64_tr_b16 a[94:95], v24 offset:58368
v_cvt_pk_bf16_f32 v128, v128, v129
v_mfma_f32_16x16x32_bf16 v[40:43], a[124:127], a[196:199], v[40:43]
s_waitcnt lgkmcnt(12)
v_rcp_f32 v228, v228
v_cvt_pk_bf16_f32 v129, v130, v131
v_rcp_f32 v226, v226
v_cvt_pk_bf16_f32 v33, v34, v35
v_cvt_pk_bf16_f32 v64, v64, v65
v_pk_mul_f32 v[100:101], v[100:101], v[16:17] op_sel_hi:[1,0]
v_mfma_f32_16x16x32_bf16 v[72:75], a[120:123], a[200:203], v[72:75]
v_cvt_pk_bf16_f32 v65, v66, v67
v_accvgpr_write_b32 a48, v128
v_cvt_pk_bf16_f32 v130, v132, v133
v_mfma_f32_16x16x32_bf16 v[72:75], a[124:127], a[204:207], v[72:75]
ds_read_b64_tr_b16 a[96:97], v25 offset:16384
buffer_load_dwordx4 v4, s[8:11], s36 offen offset:3072 sc1 lds
v_mfma_f32_16x16x32_bf16 v[104:107], a[120:123], a[208:211], v[104:107]
ds_read_b64_tr_b16 a[98:99], v25 offset:17408
v_accvgpr_write_b32 a1, v33
v_mfma_f32_16x16x32_bf16 v[104:107], a[124:127], a[212:215], v[104:107]
v_cvt_pk_bf16_f32 v97, v98, v99
v_cvt_pk_bf16_f32 v99, v102, v103
v_accvgpr_write_b32 a33, v97
v_mfma_f32_16x16x32_bf16 v[136:139], a[120:123], a[216:219], v[136:139]
s_waitcnt lgkmcnt(10)
ds_read_b64_tr_b16 a[100:101], v25 offset:24576
ds_read_b64_tr_b16 a[102:103], v25 offset:25600
v_cvt_pk_bf16_f32 v131, v134, v135
v_accvgpr_write_b32 a0, v32
v_mfma_f32_16x16x32_bf16 v[136:139], a[124:127], a[220:223], v[136:139]
ds_read_b64_tr_b16 a[104:105], v25 offset:32768
ds_read_b64_tr_b16 a[106:107], v25 offset:33792
v_mfma_f32_16x16x32_bf16 v[40:43], a[64:67], a[128:131], v[40:43]
v_cvt_pk_bf16_f32 v66, v68, v69
v_accvgpr_write_b32 a16, v64
v_mfma_f32_16x16x32_bf16 v[40:43], a[68:71], a[132:135], v[40:43]
v_accvgpr_write_b32 a50, v130
v_exp_f32 v236, v236
v_mfma_f32_16x16x32_bf16 v[72:75], a[64:67], a[136:139], v[72:75]
v_cvt_pk_bf16_f32 v34, v36, v37
v_cvt_pk_bf16_f32 v98, v100, v101
v_mfma_f32_16x16x32_bf16 v[72:75], a[68:71], a[140:143], v[72:75]
v_rcp_f32 v229, v229
v_mfma_f32_16x16x32_bf16 v[104:107], a[64:67], a[144:147], v[104:107]
v_accvgpr_write_b32 a245, 0
v_accvgpr_write_b32 a2, v34
v_mfma_f32_16x16x32_bf16 v[104:107], a[68:71], a[148:151], v[104:107]
s_sub_u32 s36, s36, 16384
v_accvgpr_write_b32 a18, v66
v_accvgpr_write_b32 a17, v65
v_mfma_f32_16x16x32_bf16 v[136:139], a[64:67], a[152:155], v[136:139]
v_cvt_pk_bf16_f32 v35, v38, v39
v_accvgpr_write_b32 a3, v35
v_accvgpr_write_b32 a249, 0
v_mfma_f32_16x16x32_bf16 v[136:139], a[68:71], a[156:159], v[136:139]
v_rcp_f32 v230, v230
v_accvgpr_write_b32 a32, v96
v_mfma_f32_16x16x32_bf16 v[44:47], a[72:75], a[160:163], v[44:47]
v_cvt_pk_bf16_f32 v67, v70, v71
v_accvgpr_write_b32 a34, v98
v_mfma_f32_16x16x32_bf16 v[44:47], a[76:79], a[164:167], v[44:47]
v_exp_f32 v232, v232
v_accvgpr_write_b32 a240, 0
v_accvgpr_write_b32 a19, v67
v_accvgpr_write_b32 a252, 0
v_pk_mul_f32 v[246:247], v[190:191], v[190:191]
v_pk_mul_f32 v[240:241], v[184:185], v[184:185]
v_mfma_f32_16x16x32_bf16 v[76:79], a[72:75], a[168:171], v[76:79]
v_accvgpr_write_b32 a49, v129
v_accvgpr_write_b32 a51, v131
v_exp_f32 v237, v237
v_accvgpr_write_b32 a248, 0
v_pk_mul_f32 v[244:245], v[188:189], v[188:189]
v_mfma_f32_16x16x32_bf16 v[76:79], a[76:79], a[172:175], v[76:79]
s_waitcnt lgkmcnt(10)
v_exp_f32 v239, v239
v_mfma_f32_16x16x32_bf16 v[108:111], a[72:75], a[176:179], v[108:111]
v_exp_f32 v238, v238
v_mfma_f32_16x16x32_bf16 v[108:111], a[76:79], a[180:183], v[108:111]
v_exp_f32 v233, v233
v_rcp_f32 v231, v231
v_exp_f32 v234, v234
v_pk_add_f32 v[232:233], v[232:233], 1.0 op_sel_hi:[1,0]
v_exp_f32 v235, v235
v_pk_mul_f32 v[210:211], v[210:211], v[226:227]
v_pk_fma_f32 v[240:241], v[14:15], v[240:241], v[14:15] op_sel:[1,0,0] op_sel_hi:[1,1,0]
v_pk_mul_f32 v[240:241], v[240:241], v[184:185]
v_pk_mul_f32 v[242:243], v[186:187], v[186:187]
v_pk_mul_f32 v[208:209], v[208:209], v[224:225]
v_pk_fma_f32 v[244:245], v[14:15], v[244:245], v[14:15] op_sel:[1,0,0] op_sel_hi:[1,1,0]
v_pk_fma_f32 v[242:243], v[14:15], v[242:243], v[14:15] op_sel:[1,0,0] op_sel_hi:[1,1,0]
v_pk_mul_f32 v[214:215], v[214:215], v[230:231]
v_pk_mul_f32 v[212:213], v[212:213], v[228:229]
v_pk_add_f32 v[238:239], v[238:239], 1.0 op_sel_hi:[1,0]
v_pk_add_f32 v[234:235], v[234:235], 1.0 op_sel_hi:[1,0]
v_pk_add_f32 v[236:237], v[236:237], 1.0 op_sel_hi:[1,0]
v_pk_fma_f32 v[246:247], v[14:15], v[246:247], v[14:15] op_sel:[1,0,0] op_sel_hi:[1,1,0]
v_pk_mul_f32 v[244:245], v[244:245], v[188:189]
v_pk_mul_f32 v[246:247], v[246:247], v[190:191]
v_cvt_pk_bf16_f32 v208, v208, v209
v_accvgpr_write_b32 a35, v99
v_exp_f32 v241, v241
v_mfma_f32_16x16x32_bf16 v[140:143], a[72:75], a[184:187], v[140:143]
s_waitcnt lgkmcnt(6)
ds_read_b64_tr_b16 a[108:109], v25 offset:40960
ds_read_b64_tr_b16 a[110:111], v25 offset:41984
v_mfma_f32_16x16x32_bf16 v[140:143], a[76:79], a[188:191], v[140:143]
v_cvt_pk_bf16_f32 v209, v210, v211
v_cvt_pk_bf16_f32 v210, v212, v213
v_mfma_f32_16x16x32_bf16 v[44:47], a[80:83], a[192:195], v[44:47]
v_rcp_f32 v235, v235
v_permlane16_swap_b32 v208, v210
v_cvt_pk_bf16_f32 v211, v214, v215
v_mfma_f32_16x16x32_bf16 v[44:47], a[84:87], a[196:199], v[44:47]
v_rcp_f32 v233, v233
v_permlane16_swap_b32 v209, v211
v_accvgpr_write_b32 a244, 0
v_pk_mul_f32 v[242:243], v[242:243], v[186:187]
v_mfma_f32_16x16x32_bf16 v[76:79], a[80:83], a[200:203], v[76:79]
s_add_u32 s34, s34, 27648
ds_read_b64_tr_b16 a[112:113], v25 offset:49152
ds_read_b64_tr_b16 a[114:115], v25 offset:50176
ds_read_b64_tr_b16 a[116:117], v25 offset:57344
ds_read_b64_tr_b16 a[118:119], v25 offset:58368
v_exp_f32 v240, v240
v_mfma_f32_16x16x32_bf16 v[76:79], a[84:87], a[204:207], v[76:79]
v_accvgpr_write_b32 a253, 0
v_rcp_f32 v236, v236
v_mfma_f32_16x16x32_bf16 v[108:111], a[80:83], a[208:211], v[108:111]
buffer_store_dwordx4 v[208:211], v11, s[40:43], s34 offen sc1
v_mfma_f32_16x16x32_bf16 v[108:111], a[84:87], a[212:215], v[108:111]
v_rcp_f32 v232, v232
v_mfma_f32_16x16x32_bf16 v[140:143], a[80:83], a[216:219], v[140:143]
s_add_u32 m0, s28, 49152
v_rcp_f32 v234, v234
v_mfma_f32_16x16x32_bf16 v[140:143], a[84:87], a[220:223], v[140:143]
ds_read_b64_tr_b16 a[120:121], v26 offset:16384
ds_read_b64_tr_b16 a[122:123], v26 offset:17408
v_mfma_f32_16x16x32_bf16 v[44:47], a[88:91], a[128:131], v[44:47]
v_rcp_f32 v238, v238
v_mfma_f32_16x16x32_bf16 v[44:47], a[92:95], a[132:135], v[44:47]
v_exp_f32 v245, v245
v_mfma_f32_16x16x32_bf16 v[76:79], a[88:91], a[136:139], v[76:79]
ds_read_b64_tr_b16 a[124:125], v26 offset:24576
s_branch kf_kernel_pl13
kf_kernel_pd13:
s_branch kf_kernel_pd17
kf_kernel_pl13:
v_rcp_f32 v239, v239
v_exp_f32 v244, v244
v_pk_mul_f32 v[174:175], v[174:175], v[238:239]
v_pk_mul_f32 v[230:231], v[206:207], v[206:207]
v_rcp_f32 v237, v237
v_pk_mul_f32 v[72:73], v[72:73], v[16:17] op_sel_hi:[1,0]
v_pk_mul_f32 v[172:173], v[172:173], v[236:237]
v_pk_mul_f32 v[170:171], v[170:171], v[234:235]
v_exp_f32 v242, v242
v_pk_mul_f32 v[168:169], v[168:169], v[232:233]
v_cvt_pk_bf16_f32 v168, v168, v169
v_exp_f32 v247, v247
v_pk_mul_f32 v[224:225], v[200:201], v[200:201]
v_mfma_f32_16x16x32_bf16 v[76:79], a[92:95], a[140:143], v[76:79]
s_add_u32 s34, s59, s15
v_exp_f32 v243, v243
v_cvt_pk_bf16_f32 v169, v170, v171
v_exp_f32 v246, v246
v_pk_add_f32 v[240:241], v[240:241], 1.0 op_sel_hi:[1,0]
v_cvt_pk_bf16_f32 v171, v174, v175
v_pk_add_f32 v[242:243], v[242:243], 1.0 op_sel_hi:[1,0]
v_pk_mul_f32 v[226:227], v[202:203], v[202:203]
v_pk_fma_f32 v[226:227], v[14:15], v[226:227], v[14:15] op_sel:[1,0,0] op_sel_hi:[1,1,0]
v_pk_mul_f32 v[228:229], v[204:205], v[204:205]
v_pk_fma_f32 v[228:229], v[14:15], v[228:229], v[14:15] op_sel:[1,0,0] op_sel_hi:[1,1,0]
v_pk_fma_f32 v[224:225], v[14:15], v[224:225], v[14:15] op_sel:[1,0,0] op_sel_hi:[1,1,0]
v_cvt_pk_bf16_f32 v170, v172, v173
v_pk_add_f32 v[246:247], v[246:247], 1.0 op_sel_hi:[1,0]
v_pk_mul_f32 v[226:227], v[226:227], v[202:203]
v_pk_fma_f32 v[230:231], v[14:15], v[230:231], v[14:15] op_sel:[1,0,0] op_sel_hi:[1,1,0]
v_pk_mul_f32 v[228:229], v[228:229], v[204:205]
v_pk_mul_f32 v[230:231], v[230:231], v[206:207]
v_pk_add_f32 v[244:245], v[244:245], 1.0 op_sel_hi:[1,0]
v_cvt_pk_bf16_f32 v72, v72, v73
v_permlane16_swap_b32 v168, v170
v_pk_mul_f32 v[224:225], v[224:225], v[200:201]
v_mfma_f32_16x16x32_bf16 v[108:111], a[88:91], a[144:147], v[108:111]
s_waitcnt lgkmcnt(11)
ds_read_b64_tr_b16 a[126:127], v26 offset:25600
ds_read_b64_tr_b16 a[64:65], v26 offset:32768
ds_read_b64_tr_b16 a[66:67], v26 offset:33792
v_mfma_f32_16x16x32_bf16 v[108:111], a[92:95], a[148:151], v[108:111]
buffer_load_dwordx4 v4, s[8:11], s36 offen offset:0 sc1 lds
v_mfma_f32_16x16x32_bf16 v[140:143], a[88:91], a[152:155], v[140:143]
ds_read_b64_tr_b16 a[68:69], v26 offset:40960
ds_read_b64_tr_b16 a[70:71], v26 offset:41984
v_mfma_f32_16x16x32_bf16 v[140:143], a[92:95], a[156:159], v[140:143]
v_permlane16_swap_b32 v169, v171
v_mfma_f32_16x16x32_bf16 v[48:51], a[96:99], a[160:163], v[48:51]
buffer_store_dwordx4 v[168:171], v12, s[40:43], s34 offen sc1
v_mfma_f32_16x16x32_bf16 v[48:51], a[100:103], a[164:167], v[48:51]
v_rcp_f32 v246, v246
v_mfma_f32_16x16x32_bf16 v[80:83], a[96:99], a[168:171], v[80:83]
v_rcp_f32 v243, v243
v_mfma_f32_16x16x32_bf16 v[80:83], a[100:103], a[172:175], v[80:83]
buffer_load_dwordx4 v4, s[8:11], s36 offen offset:1024 sc1 lds
v_rcp_f32 v242, v242
v_rcp_f32 v241, v241
v_pk_mul_f32 v[44:45], v[44:45], v[16:17] op_sel_hi:[1,0]
v_pk_mul_f32 v[42:43], v[42:43], v[16:17] op_sel_hi:[1,0]
v_pk_mul_f32 v[74:75], v[74:75], v[16:17] op_sel_hi:[1,0]
v_pk_mul_f32 v[46:47], v[46:47], v[16:17] op_sel_hi:[1,0]
v_pk_mul_f32 v[104:105], v[104:105], v[16:17] op_sel_hi:[1,0]
v_pk_mul_f32 v[78:79], v[78:79], v[16:17] op_sel_hi:[1,0]
v_pk_mul_f32 v[40:41], v[40:41], v[16:17] op_sel_hi:[1,0]
v_pk_mul_f32 v[76:77], v[76:77], v[16:17] op_sel_hi:[1,0]
v_pk_mul_f32 v[138:139], v[138:139], v[16:17] op_sel_hi:[1,0]
v_pk_mul_f32 v[110:111], v[110:111], v[16:17] op_sel_hi:[1,0]
v_mfma_f32_16x16x32_bf16 v[112:115], a[96:99], a[176:179], v[112:115]
v_rcp_f32 v245, v245
v_cvt_pk_bf16_f32 v73, v74, v75
v_mfma_f32_16x16x32_bf16 v[112:115], a[100:103], a[180:183], v[112:115]
s_waitcnt lgkmcnt(12)
v_accvgpr_write_b32 a21, v73
v_cvt_pk_bf16_f32 v40, v40, v41
v_mfma_f32_16x16x32_bf16 v[144:147], a[96:99], a[184:187], v[144:147]
ds_read_b64_tr_b16 a[72:73], v26 offset:49152
ds_read_b64_tr_b16 a[74:75], v26 offset:50176
ds_read_b64_tr_b16 a[76:77], v26 offset:57344
v_rcp_f32 v240, v240
v_pk_mul_f32 v[108:109], v[108:109], v[16:17] op_sel_hi:[1,0]
v_pk_mul_f32 v[140:141], v[140:141], v[16:17] op_sel_hi:[1,0]
v_pk_mul_f32 v[106:107], v[106:107], v[16:17] op_sel_hi:[1,0]
v_pk_mul_f32 v[142:143], v[142:143], v[16:17] op_sel_hi:[1,0]
v_pk_mul_f32 v[136:137], v[136:137], v[16:17] op_sel_hi:[1,0]
v_and_b32 v19, 1, v0
v_mfma_f32_16x16x32_bf16 v[144:147], a[100:103], a[188:191], v[144:147]
buffer_load_dwordx4 v4, s[8:11], s36 offen offset:2048 sc1 lds
v_cvt_pk_bf16_f32 v41, v42, v43
v_mfma_f32_16x16x32_bf16 v[48:51], a[104:107], a[192:195], v[48:51]
v_cvt_pk_bf16_f32 v43, v46, v47
v_accvgpr_write_b32 a4, v40
v_mfma_f32_16x16x32_bf16 v[48:51], a[108:111], a[196:199], v[48:51]
v_cvt_pk_bf16_f32 v104, v104, v105
v_rcp_f32 v244, v244
v_mfma_f32_16x16x32_bf16 v[80:83], a[104:107], a[200:203], v[80:83]
ds_read_b64_tr_b16 a[78:79], v26 offset:58368
v_mul_u32_u24 v19, 0xaaaa, v19
v_mfma_f32_16x16x32_bf16 v[80:83], a[108:111], a[204:207], v[80:83]
buffer_load_dwordx4 v4, s[8:11], s36 offen offset:3072 sc1 lds
v_mfma_f32_16x16x32_bf16 v[112:115], a[104:107], a[208:211], v[112:115]
s_waitcnt lgkmcnt(12)
ds_read_b64_tr_b16 a[80:81], v27 offset:16384
ds_read_b64_tr_b16 a[82:83], v27 offset:17408
v_cvt_pk_bf16_f32 v136, v136, v137
v_cvt_pk_bf16_f32 v42, v44, v45
v_mfma_f32_16x16x32_bf16 v[112:115], a[108:111], a[212:215], v[112:115]
ds_read_b64_tr_b16 a[84:85], v27 offset:24576
ds_read_b64_tr_b16 a[86:87], v27 offset:25600
v_mfma_f32_16x16x32_bf16 v[144:147], a[104:107], a[216:219], v[144:147]
v_cvt_pk_bf16_f32 v105, v106, v107
v_accvgpr_write_b32 a5, v41
v_mfma_f32_16x16x32_bf16 v[144:147], a[108:111], a[220:223], v[144:147]
s_waitcnt lgkmcnt(12)
v_exp_f32 v228, v228
v_mfma_f32_16x16x32_bf16 v[48:51], a[112:115], a[128:131], v[48:51]
v_cvt_pk_bf16_f32 v137, v138, v139
v_cvt_pk_bf16_f32 v74, v76, v77
v_accvgpr_write_b32 a22, v74
v_mfma_f32_16x16x32_bf16 v[48:51], a[116:119], a[132:135], v[48:51]
v_cvt_pk_bf16_f32 v107, v110, v111
v_accvgpr_write_b32 a53, v137
v_mfma_f32_16x16x32_bf16 v[80:83], a[112:115], a[136:139], v[80:83]
v_exp_f32 v226, v226
v_mfma_f32_16x16x32_bf16 v[80:83], a[116:119], a[140:143], v[80:83]
v_exp_f32 v227, v227
v_mfma_f32_16x16x32_bf16 v[112:115], a[112:115], a[144:147], v[112:115]
ds_read_b64_tr_b16 a[88:89], v27 offset:32768
ds_read_b64_tr_b16 a[90:91], v27 offset:33792
v_mfma_f32_16x16x32_bf16 v[112:115], a[116:119], a[148:151], v[112:115]
s_sub_u32 s36, s36, 16384
v_cvt_pk_bf16_f32 v139, v142, v143
v_accvgpr_write_b32 a36, v104
v_rcp_f32 v247, v247
v_accvgpr_write_b32 a39, v107
v_mfma_f32_16x16x32_bf16 v[144:147], a[112:115], a[152:155], v[144:147]
s_add_u32 s34, s34, 27648
v_cvt_pk_bf16_f32 v106, v108, v109
v_exp_f32 v230, v230
v_mfma_f32_16x16x32_bf16 v[144:147], a[116:119], a[156:159], v[144:147]
v_accvgpr_write_b32 a55, v139
v_accvgpr_write_b32 a52, v136
v_mfma_f32_16x16x32_bf16 v[52:55], a[120:123], a[160:163], v[52:55]
v_cvt_pk_bf16_f32 v75, v78, v79
v_accvgpr_write_b32 a7, v43
v_exp_f32 v224, v224
v_cvt_pk_bf16_f32 v138, v140, v141
v_accvgpr_write_b32 a20, v72
v_mfma_f32_16x16x32_bf16 v[52:55], a[124:127], a[164:167], v[52:55]
v_exp_f32 v225, v225
v_mfma_f32_16x16x32_bf16 v[84:87], a[120:123], a[168:171], v[84:87]
v_exp_f32 v229, v229
v_exp_f32 v231, v231
v_accvgpr_write_b32 a6, v42
v_pk_mul_f32 v[186:187], v[186:187], v[242:243]
v_pk_add_f32 v[230:231], v[230:231], 1.0 op_sel_hi:[1,0]
v_accvgpr_write_b32 a38, v106
v_pk_mul_f32 v[238:239], v[222:223], v[222:223]
v_pk_add_f32 v[224:225], v[224:225], 1.0 op_sel_hi:[1,0]
v_pk_mul_f32 v[188:189], v[188:189], v[244:245]
v_pk_mul_f32 v[190:191], v[190:191], v[246:247]
v_pk_fma_f32 v[238:239], v[14:15], v[238:239], v[14:15] op_sel:[1,0,0] op_sel_hi:[1,1,0]
v_pk_mul_f32 v[232:233], v[216:217], v[216:217]
v_pk_mul_f32 v[184:185], v[184:185], v[240:241]
v_pk_fma_f32 v[232:233], v[14:15], v[232:233], v[14:15] op_sel:[1,0,0] op_sel_hi:[1,1,0]
v_pk_mul_f32 v[232:233], v[232:233], v[216:217]
v_pk_add_f32 v[228:229], v[228:229], 1.0 op_sel_hi:[1,0]
v_cvt_pk_bf16_f32 v184, v184, v185
v_pk_add_f32 v[226:227], v[226:227], 1.0 op_sel_hi:[1,0]
v_cvt_pk_bf16_f32 v185, v186, v187
v_cvt_pk_bf16_f32 v187, v190, v191
v_cvt_pk_bf16_f32 v186, v188, v189
v_accvgpr_write_b32 a23, v75
v_pk_mul_f32 v[236:237], v[220:221], v[220:221]
v_pk_mul_f32 v[238:239], v[238:239], v[222:223]
v_mfma_f32_16x16x32_bf16 v[84:87], a[124:127], a[172:175], v[84:87]
s_waitcnt lgkmcnt(10)
ds_read_b64_tr_b16 a[92:93], v27 offset:40960
ds_read_b64_tr_b16 a[94:95], v27 offset:41984
ds_read_b64_tr_b16 a[96:97], v27 offset:49152
v_exp_f32 v233, v233
v_permlane16_swap_b32 v185, v187
v_mfma_f32_16x16x32_bf16 v[116:119], a[120:123], a[176:179], v[116:119]
ds_read_b64_tr_b16 a[98:99], v27 offset:50176
v_accvgpr_write_b32 a54, v138
v_permlane16_swap_b32 v184, v186
v_accvgpr_write_b32 a37, v105
v_pk_mul_f32 v[234:235], v[218:219], v[218:219]
v_pk_fma_f32 v[234:235], v[14:15], v[234:235], v[14:15] op_sel:[1,0,0] op_sel_hi:[1,1,0]
v_pk_mul_f32 v[234:235], v[234:235], v[218:219]
v_mfma_f32_16x16x32_bf16 v[116:119], a[124:127], a[180:183], v[116:119]
v_rcp_f32 v229, v229
v_mfma_f32_16x16x32_bf16 v[148:151], a[120:123], a[184:187], v[148:151]
buffer_store_dwordx4 v[184:187], v12, s[40:43], s34 offen sc1
v_mfma_f32_16x16x32_bf16 v[148:151], a[124:127], a[188:191], v[148:151]
s_add_u32 m0, s28, 65536
v_add_u32 v19, 0x4444, v19
v_rcp_f32 v225, v225
v_exp_f32 v235, v235
v_pk_fma_f32 v[236:237], v[14:15], v[236:237], v[14:15] op_sel:[1,0,0] op_sel_hi:[1,1,0]
v_pk_mul_f32 v[236:237], v[236:237], v[220:221]
v_mfma_f32_16x16x32_bf16 v[52:55], a[64:67], a[192:195], v[52:55]
ds_read_b64_tr_b16 a[100:101], v27 offset:57344
ds_read_b64_tr_b16 a[102:103], v27 offset:58368
v_mfma_f32_16x16x32_bf16 v[52:55], a[68:71], a[196:199], v[52:55]
v_rcp_f32 v227, v227
v_mfma_f32_16x16x32_bf16 v[84:87], a[64:67], a[200:203], v[84:87]
v_rcp_f32 v231, v231
v_mfma_f32_16x16x32_bf16 v[84:87], a[68:71], a[204:207], v[84:87]
v_exp_f32 v236, v236
v_mfma_f32_16x16x32_bf16 v[116:119], a[64:67], a[208:211], v[116:119]
buffer_load_dwordx4 v4, s[8:11], s36 offen offset:0 sc1 lds
v_mfma_f32_16x16x32_bf16 v[116:119], a[68:71], a[212:215], v[116:119]
s_waitcnt lgkmcnt(12)
v_exp_f32 v237, v237
v_mfma_f32_16x16x32_bf16 v[148:151], a[64:67], a[216:219], v[148:151]
v_rcp_f32 v226, v226
v_mfma_f32_16x16x32_bf16 v[148:151], a[68:71], a[220:223], v[148:151]
v_rcp_f32 v230, v230
v_mfma_f32_16x16x32_bf16 v[52:55], a[72:75], a[128:131], v[52:55]
v_rcp_f32 v228, v228
v_exp_f32 v238, v238
v_mfma_f32_16x16x32_bf16 v[52:55], a[76:79], a[132:135], v[52:55]
v_rcp_f32 v224, v224
v_exp_f32 v234, v234
v_exp_f32 v239, v239
v_pk_mul_f32 v[200:201], v[200:201], v[224:225]
v_pk_add_f32 v[238:239], v[238:239], 1.0 op_sel_hi:[1,0]
v_pk_mul_f32 v[202:203], v[202:203], v[226:227]
v_pk_mul_f32 v[206:207], v[206:207], v[230:231]
v_exp_f32 v232, v232
v_pk_add_f32 v[236:237], v[236:237], 1.0 op_sel_hi:[1,0]
v_cvt_pk_bf16_f32 v200, v200, v201
v_cvt_pk_bf16_f32 v201, v202, v203
v_cvt_pk_bf16_f32 v203, v206, v207
v_pk_add_f32 v[234:235], v[234:235], 1.0 op_sel_hi:[1,0]
v_pk_add_f32 v[232:233], v[232:233], 1.0 op_sel_hi:[1,0]
v_pk_mul_f32 v[204:205], v[204:205], v[228:229]
v_cvt_pk_bf16_f32 v202, v204, v205
v_mfma_f32_16x16x32_bf16 v[84:87], a[72:75], a[136:139], v[84:87]
s_waitcnt lgkmcnt(8)
ds_read_b64_tr_b16 a[104:105], v28 offset:16384
ds_read_b64_tr_b16 a[106:107], v28 offset:17408
v_mfma_f32_16x16x32_bf16 v[84:87], a[76:79], a[140:143], v[84:87]
s_add_u32 s34, s60, s15
v_permlane16_swap_b32 v201, v203
v_permlane16_swap_b32 v200, v202
v_mfma_f32_16x16x32_bf16 v[116:119], a[72:75], a[144:147], v[116:119]
buffer_store_dwordx4 v[200:203], v12, s[40:43], s34 offen sc1
v_mfma_f32_16x16x32_bf16 v[116:119], a[76:79], a[148:151], v[116:119]
buffer_load_dwordx4 v4, s[8:11], s36 offen offset:1024 sc1 lds
v_mfma_f32_16x16x32_bf16 v[148:151], a[72:75], a[152:155], v[148:151]
v_rcp_f32 v233, v233
v_mfma_f32_16x16x32_bf16 v[148:151], a[76:79], a[156:159], v[148:151]
v_rcp_f32 v235, v235
v_mfma_f32_16x16x32_bf16 v[56:59], a[80:83], a[160:163], v[56:59]
ds_read_b64_tr_b16 a[108:109], v28 offset:24576
ds_read_b64_tr_b16 a[110:111], v28 offset:25600
v_mfma_f32_16x16x32_bf16 v[56:59], a[84:87], a[164:167], v[56:59]
ds_read_b64_tr_b16 a[112:113], v28 offset:32768
ds_read_b64_tr_b16 a[114:115], v28 offset:33792
v_mfma_f32_16x16x32_bf16 v[88:91], a[80:83], a[168:171], v[88:91]
v_rcp_f32 v236, v236
v_mfma_f32_16x16x32_bf16 v[88:91], a[84:87], a[172:175], v[88:91]
v_rcp_f32 v238, v238
v_rcp_f32 v237, v237
v_rcp_f32 v234, v234
v_pk_mul_f32 v[80:81], v[80:81], v[16:17] op_sel_hi:[1,0]
v_pk_mul_f32 v[82:83], v[82:83], v[16:17] op_sel_hi:[1,0]
v_cvt_pk_bf16_f32 v80, v80, v81
v_pk_mul_f32 v[86:87], v[86:87], v[16:17] op_sel_hi:[1,0]
v_pk_mul_f32 v[52:53], v[52:53], v[16:17] op_sel_hi:[1,0]
v_pk_mul_f32 v[48:49], v[48:49], v[16:17] op_sel_hi:[1,0]
v_mfma_f32_16x16x32_bf16 v[120:123], a[80:83], a[176:179], v[120:123]
s_waitcnt lgkmcnt(10)
ds_read_b64_tr_b16 a[116:117], v28 offset:40960
v_cvt_pk_bf16_f32 v48, v48, v49
v_mfma_f32_16x16x32_bf16 v[120:123], a[84:87], a[180:183], v[120:123]
buffer_load_dwordx4 v4, s[8:11], s36 offen offset:2048 sc1 lds
v_mfma_f32_16x16x32_bf16 v[152:155], a[80:83], a[184:187], v[152:155]
ds_read_b64_tr_b16 a[118:119], v28 offset:41984
v_rcp_f32 v232, v232
v_rcp_f32 v239, v239
v_pk_mul_f32 v[148:149], v[148:149], v[16:17] op_sel_hi:[1,0]
v_pk_mul_f32 v[116:117], v[116:117], v[16:17] op_sel_hi:[1,0]
v_pk_mul_f32 v[118:119], v[118:119], v[16:17] op_sel_hi:[1,0]
v_pk_mul_f32 v[146:147], v[146:147], v[16:17] op_sel_hi:[1,0]
v_pk_mul_f32 v[218:219], v[218:219], v[234:235]
v_pk_mul_f32 v[144:145], v[144:145], v[16:17] op_sel_hi:[1,0]
v_pk_mul_f32 v[216:217], v[216:217], v[232:233]
v_pk_mul_f32 v[222:223], v[222:223], v[238:239]
v_cvt_pk_bf16_f32 v81, v82, v83
v_pk_mul_f32 v[54:55], v[54:55], v[16:17] op_sel_hi:[1,0]
v_pk_mul_f32 v[220:221], v[220:221], v[236:237]
v_pk_mul_f32 v[112:113], v[112:113], v[16:17] op_sel_hi:[1,0]
v_pk_mul_f32 v[50:51], v[50:51], v[16:17] op_sel_hi:[1,0]
v_mfma_f32_16x16x32_bf16 v[152:155], a[84:87], a[188:191], v[152:155]
s_waitcnt lgkmcnt(8)
v_cvt_pk_bf16_f32 v112, v112, v113
v_cvt_pk_bf16_f32 v144, v144, v145
v_cvt_pk_bf16_f32 v49, v50, v51
v_mfma_f32_16x16x32_bf16 v[56:59], a[88:91], a[192:195], v[56:59]
ds_read_b64_tr_b16 a[120:121], v28 offset:49152
v_cvt_pk_bf16_f32 v83, v86, v87
v_mfma_f32_16x16x32_bf16 v[56:59], a[92:95], a[196:199], v[56:59]
v_cvt_pk_bf16_f32 v216, v216, v217
v_accvgpr_write_b32 a40, v112
v_cvt_pk_bf16_f32 v145, v146, v147
v_cvt_pk_bf16_f32 v217, v218, v219
v_accvgpr_write_b32 a25, v81
v_mfma_f32_16x16x32_bf16 v[88:91], a[88:91], a[200:203], v[88:91]
buffer_load_dwordx4 v4, s[8:11], s36 offen offset:3072 sc1 lds
v_cvt_pk_bf16_f32 v218, v220, v221
v_cvt_pk_bf16_f32 v51, v54, v55
v_cvt_pk_bf16_f32 v50, v52, v53
v_pk_mul_f32 v[150:151], v[150:151], v[16:17] op_sel_hi:[1,0]
v_pk_mul_f32 v[114:115], v[114:115], v[16:17] op_sel_hi:[1,0]
v_pk_mul_f32 v[84:85], v[84:85], v[16:17] op_sel_hi:[1,0]
v_mfma_f32_16x16x32_bf16 v[88:91], a[92:95], a[204:207], v[88:91]
v_cvt_pk_bf16_f32 v219, v222, v223
v_cvt_pk_bf16_f32 v113, v114, v115
v_mfma_f32_16x16x32_bf16 v[120:123], a[88:91], a[208:211], v[120:123]
s_add_u32 m0, s28, 81920
ds_read_b64_tr_b16 a[122:123], v28 offset:50176
ds_read_b64_tr_b16 a[124:125], v28 offset:57344
v_mfma_f32_16x16x32_bf16 v[120:123], a[92:95], a[212:215], v[120:123]
v_accvgpr_write_b32 a24, v80
v_accvgpr_write_b32 a9, v49
v_mfma_f32_16x16x32_bf16 v[152:155], a[88:91], a[216:219], v[152:155]
v_permlane16_swap_b32 v217, v219
v_mfma_f32_16x16x32_bf16 v[152:155], a[92:95], a[220:223], v[152:155]
v_mov_b64 v[166:167], 0
v_cvt_pk_bf16_f32 v114, v116, v117
v_mfma_f32_16x16x32_bf16 v[56:59], a[96:99], a[128:131], v[56:59]
s_sub_u32 s36, s36, 16384
v_accvgpr_write_b32 a11, v51
v_cvt_pk_bf16_f32 v115, v118, v119
v_mfma_f32_16x16x32_bf16 v[56:59], a[100:103], a[132:135], v[56:59]
v_and_b32 v1, 15, v0
v_accvgpr_write_b32 a57, v145
v_mfma_f32_16x16x32_bf16 v[88:91], a[96:99], a[136:139], v[88:91]
s_add_u32 s34, s34, 27648
ds_read_b64_tr_b16 a[126:127], v28 offset:58368
v_mov_b64 v[186:187], 0
v_mfma_f32_16x16x32_bf16 v[88:91], a[100:103], a[140:143], v[88:91]
v_mov_b64 v[178:179], 0
v_cvt_pk_bf16_f32 v146, v148, v149
v_cvt_pk_bf16_f32 v82, v84, v85
v_cvt_pk_bf16_f32 v147, v150, v151
v_mfma_f32_16x16x32_bf16 v[120:123], a[96:99], a[144:147], v[120:123]
s_waitcnt lgkmcnt(8)
v_accvgpr_write_b32 a43, v115
v_and_b32 v112, 2, v0
v_accvgpr_write_b32 a27, v83
v_permlane16_swap_b32 v216, v218
v_mfma_f32_16x16x32_bf16 v[120:123], a[100:103], a[148:151], v[120:123]
buffer_store_dwordx4 v[216:219], v12, s[40:43], s34 offen sc1
v_mfma_f32_16x16x32_bf16 v[152:155], a[96:99], a[152:155], v[152:155]
v_add_u32 v112, -1, v112
v_ashrrev_i32 v112, 31, v112
v_accvgpr_write_b32 a8, v48
v_accvgpr_write_b32 a41, v113
v_mfma_f32_16x16x32_bf16 v[152:155], a[100:103], a[156:159], v[152:155]
s_barrier
v_mfma_f32_16x16x32_bf16 v[60:63], a[104:107], a[160:163], v[60:63]
v_accvgpr_write_b32 a10, v50
v_and_b32 v112, 0x3f803f80, v112
v_mfma_f32_16x16x32_bf16 v[60:63], a[108:111], a[164:167], v[60:63]
buffer_load_dwordx4 v4, s[8:11], s36 offen offset:0 sc1 lds
v_mfma_f32_16x16x32_bf16 v[92:95], a[104:107], a[168:171], v[92:95]
s_waitcnt lgkmcnt(4)
v_accvgpr_write_b32 a26, v82
v_mov_b64 v[242:243], 0
v_mov_b32 v113, v112
v_mfma_f32_16x16x32_bf16 v[92:95], a[108:111], a[172:175], v[92:95]
v_mov_b64 v[184:185], 0
v_accvgpr_write_b32 a58, v146
v_bfe_u32 v2, v0, 4, 2
v_mfma_f32_16x16x32_bf16 v[124:127], a[104:107], a[176:179], v[124:127]
buffer_load_dwordx4 v4, s[8:11], s36 offen offset:1024 sc1 lds
v_mfma_f32_16x16x32_bf16 v[124:127], a[108:111], a[180:183], v[124:127]
v_lshlrev_b32 v2, 2, v2
v_mov_b64 v[190:191], 0
v_mfma_f32_16x16x32_bf16 v[156:159], a[104:107], a[184:187], v[156:159]
buffer_load_dwordx4 v4, s[8:11], s36 offen offset:2048 sc1 lds
v_mfma_f32_16x16x32_bf16 v[156:159], a[108:111], a[188:191], v[156:159]
v_mov_b64 v[230:231], 0
v_accvgpr_write_b32 a42, v114
v_sub_u32 v1, v1, v2
v_mfma_f32_16x16x32_bf16 v[60:63], a[112:115], a[192:195], v[60:63]
s_waitcnt lgkmcnt(0)
v_cmp_le_i32 s[50:51], 1, v1
v_mov_b64 v[168:169], 0
v_mfma_f32_16x16x32_bf16 v[60:63], a[116:119], a[196:199], v[60:63]
v_mov_b32 v114, v112
v_accvgpr_write_b32 a56, v144
v_mfma_f32_16x16x32_bf16 v[92:95], a[112:115], a[200:203], v[92:95]
v_mov_b64 v[226:227], 0
v_accvgpr_write_b32 a59, v147
v_mfma_f32_16x16x32_bf16 v[92:95], a[116:119], a[204:207], v[92:95]
v_mov_b64 v[238:239], 0
v_mov_b64 v[244:245], 0
v_mfma_f32_16x16x32_bf16 v[124:127], a[112:115], a[208:211], v[124:127]
v_cmp_le_i32 s[54:55], 3, v1
v_mov_b64 v[176:177], 0
v_cmp_le_i32 s[48:49], 0, v1
v_mfma_f32_16x16x32_bf16 v[124:127], a[116:119], a[212:215], v[124:127]
v_mov_b64 v[172:173], 0
v_mov_b32 v7, v4
v_mfma_f32_16x16x32_bf16 v[156:159], a[112:115], a[216:219], v[156:159]
s_waitcnt lgkmcnt(0)
buffer_load_dwordx4 v4, s[8:11], s36 offen offset:3072 sc1 lds
v_mfma_f32_16x16x32_bf16 v[156:159], a[116:119], a[220:223], v[156:159]
v_mov_b32 v115, v112
v_mov_b64 v[174:175], 0
v_mfma_f32_16x16x32_bf16 v[60:63], a[120:123], a[128:131], v[60:63]
v_mov_b64 v[224:225], 0
v_mov_b64 v[240:241], 0
v_mfma_f32_16x16x32_bf16 v[60:63], a[124:127], a[132:135], v[60:63]
s_mov_b64 s[4:5], s[46:47]
v_mov_b32 v5, v4
v_mov_b64 v[164:165], 0
v_mfma_f32_16x16x32_bf16 v[92:95], a[120:123], a[136:139], v[92:95]
v_mov_b64 v[254:255], 0
v_cmp_le_i32 s[52:53], 2, v1
v_mfma_f32_16x16x32_bf16 v[92:95], a[124:127], a[140:143], v[92:95]
s_sub_u32 s36, s36, 16384
v_mov_b64 v[248:249], 0
v_mov_b64 v[180:181], 0
v_mfma_f32_16x16x32_bf16 v[124:127], a[120:123], a[144:147], v[124:127]
v_mov_b64 v[250:251], 0
v_mov_b64 v[232:233], 0
v_mfma_f32_16x16x32_bf16 v[124:127], a[124:127], a[148:151], v[124:127]
s_mov_b32 s46, 8388608
v_mov_b32 v31, v4
v_mov_b64 v[182:183], 0
v_mfma_f32_16x16x32_bf16 v[156:159], a[120:123], a[152:155], v[156:159]
s_add_u32 m0, s28, 98304
v_mov_b64 v[162:163], 0
v_mov_b64 v[236:237], 0
v_mfma_f32_16x16x32_bf16 v[156:159], a[124:127], a[156:159], v[156:159]
s_mov_b32 s47, 0x20000
v_mov_b64 v[170:171], 0
v_mov_b32 v28, v4
v_mov_b64 v[252:253], 0
v_mov_b32 v6, v4
v_mov_b64 v[160:161], 0
v_pk_mul_f32 v[120:121], v[120:121], v[16:17] op_sel_hi:[1,0]
v_pk_mul_f32 v[62:63], v[62:63], v[16:17] op_sel_hi:[1,0]
v_pk_mul_f32 v[152:153], v[152:153], v[16:17] op_sel_hi:[1,0]
v_pk_mul_f32 v[154:155], v[154:155], v[16:17] op_sel_hi:[1,0]
v_pk_mul_f32 v[122:123], v[122:123], v[16:17] op_sel_hi:[1,0]
v_pk_mul_f32 v[156:157], v[156:157], v[16:17] op_sel_hi:[1,0]
v_pk_mul_f32 v[158:159], v[158:159], v[16:17] op_sel_hi:[1,0]
v_mov_b64 v[246:247], 0
v_cvt_pk_bf16_f32 v120, v120, v121
v_accvgpr_write_b32 a44, v120
v_cvt_pk_bf16_f32 v152, v152, v153
v_pk_mul_f32 v[60:61], v[60:61], v[16:17] op_sel_hi:[1,0]
v_mov_b64 v[228:229], 0
v_pk_mul_f32 v[88:89], v[88:89], v[16:17] op_sel_hi:[1,0]
v_mov_b64 v[234:235], 0
v_pk_mul_f32 v[90:91], v[90:91], v[16:17] op_sel_hi:[1,0]
v_cvt_pk_bf16_f32 v153, v154, v155
v_cvt_pk_bf16_f32 v154, v156, v157
v_cvt_pk_bf16_f32 v88, v88, v89
v_pk_mul_f32 v[126:127], v[126:127], v[16:17] op_sel_hi:[1,0]
v_cvt_pk_bf16_f32 v155, v158, v159
v_cvt_pk_bf16_f32 v121, v122, v123
v_pk_mul_f32 v[94:95], v[94:95], v[16:17] op_sel_hi:[1,0]
v_pk_mul_f32 v[124:125], v[124:125], v[16:17] op_sel_hi:[1,0]
v_pk_mul_f32 v[56:57], v[56:57], v[16:17] op_sel_hi:[1,0]
v_pk_mul_f32 v[92:93], v[92:93], v[16:17] op_sel_hi:[1,0]
v_cvt_pk_bf16_f32 v89, v90, v91
v_cvt_pk_bf16_f32 v122, v124, v125
v_accvgpr_write_b32 a60, v152
v_accvgpr_write_b32 a46, v122
v_cvt_pk_bf16_f32 v90, v92, v93
v_cvt_pk_bf16_f32 v123, v126, v127
v_accvgpr_write_b32 a47, v123
v_accvgpr_write_b32 a61, v153
v_cvt_pk_bf16_f32 v56, v56, v57
v_pk_mul_f32 v[58:59], v[58:59], v[16:17] op_sel_hi:[1,0]
v_cvt_pk_bf16_f32 v57, v58, v59
v_accvgpr_write_b32 a12, v56
v_mov_b64 v[188:189], 0
v_cvt_pk_bf16_f32 v58, v60, v61
v_cvt_pk_bf16_f32 v59, v62, v63
v_accvgpr_write_b32 a15, v59
v_accvgpr_write_b32 a30, v90
v_accvgpr_write_b32 a14, v58
v_accvgpr_write_b32 a29, v89
v_cvt_pk_bf16_f32 v91, v94, v95
v_accvgpr_write_b32 a31, v91
v_accvgpr_write_b32 a45, v121
v_accvgpr_write_b32 a62, v154
v_accvgpr_write_b32 a13, v57
v_accvgpr_write_b32 a28, v88
v_accvgpr_write_b32 a63, v155
kf_kernel_q:
kf_kernel_idle:
s_cmp_eq_u32 s58, 0
s_cbranch_scc1 kf_kernel_preB
kf_kernel_idle_b:
s_bitcmp1_b32 s39, 14
s_cbranch_scc1 kf_kernel_nb1
kf_kernel_b1:
s_waitcnt vmcnt(16) lgkmcnt(0)
s_barrier
kf_kernel_nb1:
buffer_load_dwordx4 v6, s[8:11], s36 offen offset:0 sc1 lds
buffer_load_dwordx4 v7, s[8:11], s36 offen offset:1024 sc1 lds
buffer_load_dwordx4 v28, s[8:11], s36 offen offset:2048 sc1 lds
buffer_load_dwordx4 v31, s[8:11], s36 offen offset:3072 sc1 lds
s_sub_u32 s36, s36, s61
s_sub_u32 s29, s39, 16384
s_and_b32 m0, s29, 0x1ffff
s_add_u32 s39, s39, 16384
v_and_or_b32 v5, s39, v20, v4
s_sub_u32 s58, s58, 1
s_lshl2_add_u32 s29, s20, s58
s_cmp_eq_u32 s29, 2
s_cbranch_scc1 kf_kernel_pd18
s_cmp_eq_u32 s29, 5
s_cbranch_scc1 kf_kernel_pd19
s_cmp_eq_u32 s29, 8
s_cbranch_scc1 kf_kernel_pd21
s_cmp_eq_u32 s29, 1
s_cbranch_scc1 kf_kernel_pd22
s_cmp_eq_u32 s29, 4
s_cbranch_scc1 kf_kernel_pd23
s_branch kf_kernel_pd24
kf_kernel_preB:
s_bitcmp1_b32 s20, 0
s_cbranch_scc1 kf_kernel_preB1
kf_kernel_preB0:
ds_read_b128 a[64:67], v5 offset:0
v_mov_b64 v[48:49], 0
ds_read_b128 a[68:71], v5 offset:1024
ds_read_b128 a[72:75], v5 offset:2048
buffer_load_dwordx4 v6, s[8:11], s36 offen offset:0 sc1 lds
v_mov_b64 v[142:143], 0
v_mov_b64 v[134:135], 0
ds_read_b128 a[76:79], v5 offset:3072
ds_read_b128 a[80:83], v5 offset:4096
ds_read_b128 a[84:87], v5 offset:5120
ds_read_b128 a[88:91], v5 offset:6144
v_mov_b64 v[140:141], 0
v_mov_b64 v[138:139], 0
v_mov_b64 v[130:131], 0
ds_read_b128 a[92:95], v5 offset:7168
buffer_load_dwordx4 v7, s[8:11], s36 offen offset:1024 sc1 lds
buffer_load_dwordx4 v28, s[8:11], s36 offen offset:2048 sc1 lds
v_mov_b64 v[56:57], 0
v_mov_b64 v[54:55], 0
v_mov_b64 v[136:137], 0
v_mov_b32 v1, 1
buffer_load_dwordx4 v31, s[8:11], s36 offen offset:3072 sc1 lds
s_sub_u32 s36, s36, s61
v_mov_b64 v[128:129], 0
s_sub_u32 s29, s39, 16384
v_mov_b64 v[58:59], 0
s_add_u32 s39, s39, 16384
v_and_or_b32 v5, s39, v20, v4
s_waitcnt lgkmcnt(0)
v_mfma_f32_16x16x32_bf16 v[80:83], a[64:67], a[0:3], 0
v_mfma_f32_16x16x32_bf16 v[80:83], a[68:71], a[4:7], v[80:83]
v_mfma_f32_16x16x32_bf16 v[80:83], a[72:75], a[8:11], v[80:83]
s_waitcnt vmcnt(8)
buffer_atomic_add v1, v10, s[40:43], s3 offen sc1
v_mfma_f32_16x16x32_bf16 v[80:83], a[76:79], a[12:15], v[80:83]
s_waitcnt vmcnt(16) lgkmcnt(0)
s_barrier
v_mov_b32 v18, s57
v_mov_b64 v[50:51], 0
v_mov_b64 v[132:133], 0
v_mfma_f32_16x16x32_bf16 v[88:91], a[64:67], a[16:19], 0
s_and_b32 m0, s29, 0x1ffff
ds_read_b128 a[64:67], v5 offset:0
v_cndmask_b32 v81, v18, v81, s[50:51]
v_cndmask_b32 v83, v18, v83, s[54:55]
v_cndmask_b32 v82, v18, v82, s[52:53]
v_cndmask_b32 v80, v18, v80, s[48:49]
v_max3_f32 v18, v80, v81, v82
v_max_f32 v18, v18, v83
v_mov_b32 v1, v18
v_mfma_f32_16x16x32_bf16 v[88:91], a[68:71], a[20:23], v[88:91]
ds_read_b128 a[68:71], v5 offset:1024
v_permlane16_swap_b32 v1, v18
v_max_f32 v18, v18, v1
v_mov_b32 v1, v18
v_mfma_f32_16x16x32_bf16 v[88:91], a[72:75], a[24:27], v[88:91]
ds_read_b128 a[72:75], v5 offset:2048
v_permlane32_swap_b32 v1, v18
v_max_f32 v18, v18, v1
v_add_f32 v18, 0x42000000, v18
v_sub_f32 v82, v82, v18
v_sub_f32 v83, v83, v18
v_sub_f32 v35, 0, v18
v_mfma_f32_16x16x32_bf16 v[88:91], a[76:79], a[28:31], v[88:91]
ds_read_b128 a[76:79], v5 offset:3072
v_sub_f32 v33, 0, v18
v_mfma_f32_16x16x32_bf16 v[92:95], a[80:83], a[16:19], 0
ds_read_b128 a[80:83], v5 offset:4096
ds_read_b128 a[96:99], v5 offset:8192
v_sub_f32 v34, 0, v18
v_sub_f32 v80, v80, v18
v_exp_f32 v83, v83
v_mfma_f32_16x16x32_bf16 v[92:95], a[84:87], a[20:23], v[92:95]
s_branch kf_kernel_pl14
kf_kernel_pd14:
s_branch kf_kernel_r0
kf_kernel_pl14:
ds_read_b128 a[84:87], v5 offset:5120
ds_read_b128 a[100:103], v5 offset:9216
v_sub_f32 v32, 0, v18
v_mfma_f32_16x16x32_bf16 v[92:95], a[88:91], a[24:27], v[92:95]
ds_read_b128 a[88:91], v5 offset:6144
ds_read_b128 a[104:107], v5 offset:10240
buffer_load_dwordx4 v6, s[8:11], s36 offen offset:0 sc1 lds
v_mfma_f32_16x16x32_bf16 v[92:95], a[92:95], a[28:31], v[92:95]
s_waitcnt lgkmcnt(6)
ds_read_b128 a[92:95], v5 offset:7168
ds_read_b128 a[108:111], v5 offset:11264
ds_read_b128 a[112:115], v5 offset:12288
ds_read_b128 a[116:119], v5 offset:13312
ds_read_b128 a[120:123], v5 offset:14336
v_exp_f32 v82, v82
v_sub_f32 v81, v81, v18
v_mov_b32 v18, s57
v_cndmask_b32 v95, v18, v95, s[54:55]
v_cndmask_b32 v93, v18, v93, s[50:51]
v_exp_f32 v80, v80
v_cndmask_b32 v92, v18, v92, s[48:49]
v_exp_f32 v81, v81
v_cndmask_b32 v94, v18, v94, s[52:53]
v_max3_f32 v18, v88, v89, v90
v_max3_f32 v18, v18, v91, v92
v_max3_f32 v18, v18, v93, v94
v_max_f32 v18, v18, v95
v_mov_b32 v1, v18
v_cvt_pk_bf16_f32 v52, v80, v81
v_cvt_pk_bf16_f32 v53, v82, v83
v_mfma_f32_16x16x32_bf16 v[80:83], a[64:67], a[0:3], v[32:35]
s_sub_u32 s29, s39, 16384
ds_read_b128 a[124:127], v5 offset:15360
v_permlane16_swap_b32 v1, v18
v_mfma_f32_16x16x32_bf16 v[80:83], a[68:71], a[4:7], v[80:83]
s_add_u32 s39, s39, 16384
v_max_f32 v18, v18, v1
v_mov_b32 v1, v18
v_mfma_f32_16x16x32_bf16 v[80:83], a[72:75], a[8:11], v[80:83]
s_waitcnt lgkmcnt(5)
buffer_load_dwordx4 v7, s[8:11], s36 offen offset:1024 sc1 lds
v_permlane32_swap_b32 v1, v18
v_max_f32 v18, v18, v1
v_add_f32 v18, 0x42000000, v18
v_and_or_b32 v5, s39, v20, v4
v_sub_f32 v89, v89, v18
v_mfma_f32_16x16x32_bf16 v[80:83], a[76:79], a[12:15], v[80:83]
s_bitset0_b32 s39, 14
v_sub_f32 v94, v94, v18
v_sub_f32 v91, v91, v18
v_mfma_f32_16x16x32_bf16 v[84:87], a[80:83], a[0:3], v[32:35]
s_waitcnt lgkmcnt(0)
v_exp_f32 v94, v94
v_exp_f32 v91, v91
v_and_or_b32 v5, s39, v20, v4
v_sub_f32 v92, v92, v18
v_sub_f32 v38, 0, v18
v_sub_f32 v90, v90, v18
v_exp_f32 v89, v89
v_mfma_f32_16x16x32_bf16 v[84:87], a[84:87], a[4:7], v[84:87]
buffer_load_dwordx4 v28, s[8:11], s36 offen offset:2048 sc1 lds
buffer_load_dwordx4 v31, s[8:11], s36 offen offset:3072 sc1 lds
v_sub_f32 v93, v93, v18
v_sub_f32 v95, v95, v18
v_mfma_f32_16x16x32_bf16 v[84:87], a[88:91], a[8:11], v[84:87]
s_and_b32 m0, s29, 0x1ffff
v_exp_f32 v95, v95
v_sub_f32 v36, 0, v18
v_mfma_f32_16x16x32_bf16 v[84:87], a[92:95], a[12:15], v[84:87]
s_min_u32 s59, s26, s32
v_sub_f32 v88, v88, v18
v_exp_f32 v88, v88
v_smfmac_f32_16x16x64_bf16 a[240:243], v[112:115], v[48:55], v19
s_sub_u32 s59, s59, s39
v_exp_f32 v90, v90
v_mfma_f32_16x16x32_bf16 v[144:147], a[112:115], v[52:55], 0
s_sub_u32 s36, s36, s61
v_exp_f32 v93, v93
v_cvt_pk_bf16_f32 v63, v94, v95
v_sub_f32 v37, 0, v18
v_cvt_pk_bf16_f32 v61, v90, v91
v_mfma_f32_16x16x32_bf16 v[148:151], a[116:119], v[52:55], 0
s_max_i32 s59, s59, 0x8000
v_sub_f32 v39, 0, v18
v_exp_f32 v92, v92
v_mfma_f32_16x16x32_bf16 v[152:155], a[120:123], v[52:55], 0
s_lshl_b32 s59, s59, 9
s_sub_u32 s39, s39, s59
v_cvt_pk_bf16_f32 v60, v88, v89
v_cvt_pk_bf16_f32 v62, v92, v93
v_mfma_f32_16x16x32_bf16 v[156:159], a[124:127], v[52:55], 0
s_branch kf_kernel_loopB1
kf_kernel_pd15:
s_branch kf_kernel_r0
kf_kernel_preB1:
s_waitcnt vmcnt(16) lgkmcnt(0)
s_barrier
ds_read_b128 a[64:67], v5 offset:0
s_sub_u32 s29, s39, 16384
ds_read_b128 a[68:71], v5 offset:1024
v_mov_b64 v[62:63], 0
ds_read_b128 a[72:75], v5 offset:2048
v_mov_b64 v[148:149], 0
v_mov_b64 v[158:159], 0
ds_read_b128 a[76:79], v5 offset:3072
ds_read_b128 a[80:83], v5 offset:4096
ds_read_b128 a[84:87], v5 offset:5120
ds_read_b128 a[88:91], v5 offset:6144
buffer_load_dwordx4 v6, s[8:11], s36 offen offset:0 sc1 lds
buffer_load_dwordx4 v7, s[8:11], s36 offen offset:1024 sc1 lds
v_mov_b64 v[144:145], 0
ds_read_b128 a[92:95], v5 offset:7168
v_mov_b64 v[146:147], 0
v_mov_b64 v[152:153], 0
s_add_u32 s39, s39, 16384
v_and_or_b32 v5, s39, v20, v4
v_mov_b64 v[154:155], 0
buffer_load_dwordx4 v28, s[8:11], s36 offen offset:2048 sc1 lds
v_mov_b64 v[60:61], 0
v_mov_b64 v[156:157], 0
s_waitcnt lgkmcnt(0)
v_mfma_f32_16x16x32_bf16 v[80:83], a[64:67], a[0:3], 0
v_mov_b64 v[150:151], 0
v_mov_b32 v1, 1
v_mfma_f32_16x16x32_bf16 v[80:83], a[68:71], a[4:7], v[80:83]
buffer_load_dwordx4 v31, s[8:11], s36 offen offset:3072 sc1 lds
v_mfma_f32_16x16x32_bf16 v[80:83], a[72:75], a[8:11], v[80:83]
v_mov_b64 v[50:51], 0
v_mfma_f32_16x16x32_bf16 v[80:83], a[76:79], a[12:15], v[80:83]
s_waitcnt vmcnt(8)
buffer_atomic_add v1, v10, s[40:43], s3 offen sc1
v_mfma_f32_16x16x32_bf16 v[88:91], a[64:67], a[16:19], 0
s_sub_u32 s36, s36, s61
ds_read_b128 a[64:67], v5 offset:0
v_mov_b32 v18, s57
v_mfma_f32_16x16x32_bf16 v[88:91], a[68:71], a[20:23], v[88:91]
ds_read_b128 a[68:71], v5 offset:1024
v_cndmask_b32 v83, v18, v83, s[54:55]
v_cndmask_b32 v81, v18, v81, s[50:51]
v_cndmask_b32 v80, v18, v80, s[48:49]
v_cndmask_b32 v82, v18, v82, s[52:53]
v_max3_f32 v18, v80, v81, v82
v_max_f32 v18, v18, v83
v_mov_b32 v1, v18
s_nop 1
v_permlane16_swap_b32 v1, v18
v_max_f32 v18, v18, v1
v_mov_b32 v1, v18
v_mfma_f32_16x16x32_bf16 v[88:91], a[72:75], a[24:27], v[88:91]
s_and_b32 m0, s29, 0x1ffff
v_permlane32_swap_b32 v1, v18
v_max_f32 v18, v18, v1
v_add_f32 v18, 0x42000000, v18
v_sub_f32 v81, v81, v18
v_mfma_f32_16x16x32_bf16 v[88:91], a[76:79], a[28:31], v[88:91]
ds_read_b128 a[72:75], v5 offset:2048
ds_read_b128 a[76:79], v5 offset:3072
v_mfma_f32_16x16x32_bf16 v[92:95], a[80:83], a[16:19], 0
ds_read_b128 a[80:83], v5 offset:4096
ds_read_b128 a[96:99], v5 offset:8192
v_sub_f32 v32, 0, v18
v_sub_f32 v83, v83, v18
v_mfma_f32_16x16x32_bf16 v[92:95], a[84:87], a[20:23], v[92:95]
ds_read_b128 a[84:87], v5 offset:5120
ds_read_b128 a[100:103], v5 offset:9216
v_sub_f32 v34, 0, v18
v_mfma_f32_16x16x32_bf16 v[92:95], a[88:91], a[24:27], v[92:95]
v_sub_f32 v82, v82, v18
v_exp_f32 v83, v83
v_exp_f32 v81, v81
v_sub_f32 v80, v80, v18
v_exp_f32 v80, v80
v_exp_f32 v82, v82
v_mfma_f32_16x16x32_bf16 v[92:95], a[92:95], a[28:31], v[92:95]
s_waitcnt lgkmcnt(4)
ds_read_b128 a[88:91], v5 offset:6144
ds_read_b128 a[104:107], v5 offset:10240
ds_read_b128 a[92:95], v5 offset:7168
ds_read_b128 a[108:111], v5 offset:11264
ds_read_b128 a[112:115], v5 offset:12288
ds_read_b128 a[116:119], v5 offset:13312
v_sub_f32 v33, 0, v18
v_sub_f32 v35, 0, v18
v_mov_b32 v18, s57
v_cndmask_b32 v92, v18, v92, s[48:49]
v_cndmask_b32 v94, v18, v94, s[52:53]
v_cndmask_b32 v95, v18, v95, s[54:55]
v_cndmask_b32 v93, v18, v93, s[50:51]
v_cvt_pk_bf16_f32 v49, v82, v83
v_cvt_pk_bf16_f32 v48, v80, v81
v_mfma_f32_16x16x32_bf16 v[80:83], a[64:67], a[0:3], v[32:35]
s_sub_u32 s29, s39, 16384
ds_read_b128 a[120:123], v5 offset:14336
ds_read_b128 a[124:127], v5 offset:15360
buffer_load_dwordx4 v6, s[8:11], s36 offen offset:0 sc1 lds
v_mfma_f32_16x16x32_bf16 v[80:83], a[68:71], a[4:7], v[80:83]
v_max3_f32 v18, v88, v89, v90
v_max3_f32 v18, v18, v91, v92
v_max3_f32 v18, v18, v93, v94
v_max_f32 v18, v18, v95
v_mov_b32 v1, v18
v_mfma_f32_16x16x32_bf16 v[80:83], a[72:75], a[8:11], v[80:83]
s_waitcnt lgkmcnt(5)
buffer_load_dwordx4 v7, s[8:11], s36 offen offset:1024 sc1 lds
buffer_load_dwordx4 v28, s[8:11], s36 offen offset:2048 sc1 lds
v_permlane16_swap_b32 v1, v18
v_max_f32 v18, v18, v1
v_mov_b32 v1, v18
v_mfma_f32_16x16x32_bf16 v[80:83], a[76:79], a[12:15], v[80:83]
s_add_u32 s39, s39, 16384
v_and_or_b32 v5, s39, v20, v4
v_permlane32_swap_b32 v1, v18
v_max_f32 v18, v18, v1
v_add_f32 v18, 0x42000000, v18
v_sub_f32 v92, v92, v18
v_sub_f32 v39, 0, v18
v_sub_f32 v90, v90, v18
v_mfma_f32_16x16x32_bf16 v[84:87], a[80:83], a[0:3], v[32:35]
s_bitset0_b32 s39, 14
v_sub_f32 v95, v95, v18
v_sub_f32 v89, v89, v18
v_exp_f32 v89, v89
v_mfma_f32_16x16x32_bf16 v[84:87], a[84:87], a[4:7], v[84:87]
s_waitcnt lgkmcnt(0)
buffer_load_dwordx4 v31, s[8:11], s36 offen offset:3072 sc1 lds
v_exp_f32 v95, v95
v_sub_f32 v93, v93, v18
v_exp_f32 v93, v93
v_sub_f32 v91, v91, v18
v_mfma_f32_16x16x32_bf16 v[84:87], a[88:91], a[8:11], v[84:87]
s_min_u32 s59, s26, s32
v_sub_f32 v38, 0, v18
v_exp_f32 v90, v90
v_sub_f32 v37, 0, v18
v_mfma_f32_16x16x32_bf16 v[84:87], a[92:95], a[12:15], v[84:87]
s_sub_u32 s36, s36, s61
s_sub_u32 s59, s59, s39
v_exp_f32 v91, v91
v_mfma_f32_16x16x32_bf16 v[128:131], a[96:99], v[48:51], 0
s_max_i32 s59, s59, 0x8000
v_and_or_b32 v5, s39, v20, v4
v_sub_f32 v94, v94, v18
v_mfma_f32_16x16x32_bf16 v[132:135], a[100:103], v[48:51], 0
s_lshl_b32 s59, s59, 9
v_sub_f32 v36, 0, v18
v_exp_f32 v94, v94
v_mfma_f32_16x16x32_bf16 v[136:139], a[104:107], v[48:51], 0
s_and_b32 m0, s29, 0x1ffff
v_sub_f32 v88, v88, v18
v_cvt_pk_bf16_f32 v57, v90, v91
v_exp_f32 v88, v88
v_exp_f32 v92, v92
v_cvt_pk_bf16_f32 v56, v88, v89
v_mfma_f32_16x16x32_bf16 v[140:143], a[108:111], v[48:51], 0
s_sub_u32 s39, s39, s59
v_cvt_pk_bf16_f32 v58, v92, v93
v_cvt_pk_bf16_f32 v59, v94, v95
kf_kernel_loopB:
v_mfma_f32_16x16x32_bf16 v[88:91], a[64:67], a[16:19], v[36:39]
s_waitcnt vmcnt(16) lgkmcnt(0)
s_barrier
v_mfma_f32_16x16x32_bf16 v[88:91], a[68:71], a[20:23], v[88:91]
ds_read_b128 a[64:67], v5 offset:0
ds_read_b128 a[68:71], v5 offset:1024
v_mfma_f32_16x16x32_bf16 v[88:91], a[72:75], a[24:27], v[88:91]
v_exp_f32 v81, v81
v_mfma_f32_16x16x32_bf16 v[88:91], a[76:79], a[28:31], v[88:91]
ds_read_b128 a[72:75], v5 offset:2048
ds_read_b128 a[76:79], v5 offset:3072
v_mfma_f32_16x16x32_bf16 v[92:95], a[80:83], a[16:19], v[36:39]
ds_read_b128 a[80:83], v5 offset:4096
v_exp_f32 v83, v83
v_mfma_f32_16x16x32_bf16 v[92:95], a[84:87], a[20:23], v[92:95]
v_exp_f32 v80, v80
v_mfma_f32_16x16x32_bf16 v[92:95], a[88:91], a[24:27], v[92:95]
ds_read_b128 a[84:87], v5 offset:5120
ds_read_b128 a[88:91], v5 offset:6144
v_mfma_f32_16x16x32_bf16 v[92:95], a[92:95], a[28:31], v[92:95]
ds_read_b128 a[92:95], v5 offset:7168
v_exp_f32 v88, v88
v_mfma_f32_16x16x32_bf16 v[160:163], a[112:115], v[60:63], v[160:163]
v_exp_f32 v86, v86
v_mfma_f32_16x16x32_bf16 v[160:163], a[96:99], v[56:59], v[160:163]
ds_read_b128 a[112:115], v5 offset:12288
ds_read_b128 a[96:99], v5 offset:8192
v_mfma_f32_16x16x32_bf16 v[164:167], a[116:119], v[60:63], v[164:167]
v_exp_f32 v82, v82
v_mfma_f32_16x16x32_bf16 v[164:167], a[100:103], v[56:59], v[164:167]
ds_read_b128 a[116:119], v5 offset:13312
ds_read_b128 a[100:103], v5 offset:9216
v_mfma_f32_16x16x32_bf16 v[168:171], a[120:123], v[60:63], v[168:171]
v_exp_f32 v87, v87
v_mfma_f32_16x16x32_bf16 v[168:171], a[104:107], v[56:59], v[168:171]
ds_read_b128 a[120:123], v5 offset:14336
ds_read_b128 a[104:107], v5 offset:10240
v_mfma_f32_16x16x32_bf16 v[172:175], a[124:127], v[60:63], v[172:175]
ds_read_b128 a[124:127], v5 offset:15360
v_cvt_pk_bf16_f32 v52, v80, v81
v_mfma_f32_16x16x32_bf16 v[172:175], a[108:111], v[56:59], v[172:175]
s_waitcnt lgkmcnt(11)
ds_read_b128 a[108:111], v5 offset:11264
v_cvt_pk_bf16_f32 v53, v82, v83
v_mfma_f32_16x16x32_bf16 v[80:83], a[64:67], a[0:3], v[32:35]
buffer_load_dwordx4 v6, s[8:11], s36 offen offset:0 sc1 lds
v_mfma_f32_16x16x32_bf16 v[80:83], a[68:71], a[4:7], v[80:83]
v_exp_f32 v84, v84
v_mfma_f32_16x16x32_bf16 v[80:83], a[72:75], a[8:11], v[80:83]
s_waitcnt lgkmcnt(8)
v_exp_f32 v85, v85
v_mfma_f32_16x16x32_bf16 v[80:83], a[76:79], a[12:15], v[80:83]
v_cvt_pk_bf16_f32 v55, v86, v87
v_cvt_pk_bf16_f32 v54, v84, v85
v_mfma_f32_16x16x32_bf16 v[84:87], a[80:83], a[0:3], v[32:35]
s_waitcnt lgkmcnt(4)
buffer_load_dwordx4 v7, s[8:11], s36 offen offset:1024 sc1 lds
v_mfma_f32_16x16x32_bf16 v[84:87], a[84:87], a[4:7], v[84:87]
buffer_load_dwordx4 v28, s[8:11], s36 offen offset:2048 sc1 lds
v_mfma_f32_16x16x32_bf16 v[84:87], a[88:91], a[8:11], v[84:87]
v_exp_f32 v92, v92
v_mfma_f32_16x16x32_bf16 v[84:87], a[92:95], a[12:15], v[84:87]
v_exp_f32 v93, v93
v_smfmac_f32_16x16x64_bf16 a[240:243], v[112:115], v[48:55], v19
v_exp_f32 v91, v91
v_mfma_f32_16x16x32_bf16 v[144:147], a[96:99], v[48:51], v[144:147]
v_exp_f32 v89, v89
v_mfma_f32_16x16x32_bf16 v[144:147], a[112:115], v[52:55], v[144:147]
v_exp_f32 v94, v94
v_mfma_f32_16x16x32_bf16 v[148:151], a[100:103], v[48:51], v[148:151]
s_waitcnt lgkmcnt(0)
buffer_load_dwordx4 v31, s[8:11], s36 offen offset:3072 sc1 lds
v_mfma_f32_16x16x32_bf16 v[148:151], a[116:119], v[52:55], v[148:151]
v_exp_f32 v90, v90
v_mfma_f32_16x16x32_bf16 v[152:155], a[104:107], v[48:51], v[152:155]
s_sub_u32 s36, s36, s61
v_exp_f32 v95, v95
v_mfma_f32_16x16x32_bf16 v[152:155], a[120:123], v[52:55], v[152:155]
v_cvt_pk_bf16_f32 v60, v88, v89
v_cvt_pk_bf16_f32 v63, v94, v95
v_mfma_f32_16x16x32_bf16 v[156:159], a[108:111], v[48:51], v[156:159]
s_bitset1_b32 m0, 14
v_cvt_pk_bf16_f32 v62, v92, v93
v_cvt_pk_bf16_f32 v61, v90, v91
v_mfma_f32_16x16x32_bf16 v[156:159], a[124:127], v[52:55], v[156:159]
s_cbranch_scc1 kf_kernel_sw_loopB1
kf_kernel_loopB1:
v_mfma_f32_16x16x32_bf16 v[88:91], a[64:67], a[16:19], v[36:39]
v_exp_f32 v85, v85
v_mfma_f32_16x16x32_bf16 v[88:91], a[68:71], a[20:23], v[88:91]
v_exp_f32 v82, v82
v_mfma_f32_16x16x32_bf16 v[88:91], a[72:75], a[24:27], v[88:91]
ds_read_b128 a[64:67], v5 offset:16384
ds_read_b128 a[68:71], v5 offset:17408
v_mfma_f32_16x16x32_bf16 v[88:91], a[76:79], a[28:31], v[88:91]
ds_read_b128 a[72:75], v5 offset:18432
ds_read_b128 a[76:79], v5 offset:19456
v_mfma_f32_16x16x32_bf16 v[92:95], a[80:83], a[16:19], v[36:39]
v_exp_f32 v81, v81
v_mfma_f32_16x16x32_bf16 v[92:95], a[84:87], a[20:23], v[92:95]
ds_read_b128 a[80:83], v5 offset:20480
ds_read_b128 a[84:87], v5 offset:21504
v_mfma_f32_16x16x32_bf16 v[92:95], a[88:91], a[24:27], v[92:95]
v_exp_f32 v80, v80
v_mfma_f32_16x16x32_bf16 v[92:95], a[92:95], a[28:31], v[92:95]
v_exp_f32 v84, v84
v_smfmac_f32_16x16x64_bf16 a[244:247], v[112:115], v[56:63], v19
ds_read_b128 a[88:91], v5 offset:22528
ds_read_b128 a[92:95], v5 offset:23552
v_mfma_f32_16x16x32_bf16 v[176:179], a[96:99], v[56:59], v[176:179]
v_exp_f32 v83, v83
v_mfma_f32_16x16x32_bf16 v[176:179], a[112:115], v[60:63], v[176:179]
ds_read_b128 a[96:99], v5 offset:24576
ds_read_b128 a[112:115], v5 offset:28672
v_mfma_f32_16x16x32_bf16 v[180:183], a[100:103], v[56:59], v[180:183]
buffer_load_dwordx4 v6, s[8:11], s36 offen offset:0 sc1 lds
v_mfma_f32_16x16x32_bf16 v[180:183], a[116:119], v[60:63], v[180:183]
ds_read_b128 a[100:103], v5 offset:25600
ds_read_b128 a[116:119], v5 offset:29696
v_mfma_f32_16x16x32_bf16 v[184:187], a[104:107], v[56:59], v[184:187]
v_cvt_pk_bf16_f32 v50, v84, v85
v_cvt_pk_bf16_f32 v48, v80, v81
v_mfma_f32_16x16x32_bf16 v[184:187], a[120:123], v[60:63], v[184:187]
ds_read_b128 a[104:107], v5 offset:26624
v_cvt_pk_bf16_f32 v49, v82, v83
v_mfma_f32_16x16x32_bf16 v[188:191], a[108:111], v[56:59], v[188:191]
s_waitcnt lgkmcnt(9)
ds_read_b128 a[120:123], v5 offset:30720
ds_read_b128 a[108:111], v5 offset:27648
v_mfma_f32_16x16x32_bf16 v[188:191], a[124:127], v[60:63], v[188:191]
v_exp_f32 v86, v86
v_mfma_f32_16x16x32_bf16 v[80:83], a[64:67], a[0:3], v[32:35]
v_exp_f32 v87, v87
v_mfma_f32_16x16x32_bf16 v[80:83], a[68:71], a[4:7], v[80:83]
v_exp_f32 v91, v91
v_mfma_f32_16x16x32_bf16 v[80:83], a[72:75], a[8:11], v[80:83]
s_waitcnt lgkmcnt(7)
v_exp_f32 v93, v93
v_mfma_f32_16x16x32_bf16 v[80:83], a[76:79], a[12:15], v[80:83]
ds_read_b128 a[124:127], v5 offset:31744
v_cvt_pk_bf16_f32 v51, v86, v87
v_mfma_f32_16x16x32_bf16 v[84:87], a[80:83], a[0:3], v[32:35]
v_exp_f32 v92, v92
v_mfma_f32_16x16x32_bf16 v[84:87], a[84:87], a[4:7], v[84:87]
s_waitcnt lgkmcnt(4)
v_exp_f32 v88, v88
v_mfma_f32_16x16x32_bf16 v[84:87], a[88:91], a[8:11], v[84:87]
buffer_load_dwordx4 v7, s[8:11], s36 offen offset:1024 sc1 lds
v_mfma_f32_16x16x32_bf16 v[84:87], a[92:95], a[12:15], v[84:87]
buffer_load_dwordx4 v28, s[8:11], s36 offen offset:2048 sc1 lds
v_mfma_f32_16x16x32_bf16 v[128:131], a[112:115], v[52:55], v[128:131]
buffer_load_dwordx4 v31, s[8:11], s36 offen offset:3072 sc1 lds
v_mfma_f32_16x16x32_bf16 v[128:131], a[96:99], v[48:51], v[128:131]
s_waitcnt lgkmcnt(0)
v_cvt_pk_bf16_f32 v58, v92, v93
v_exp_f32 v94, v94
v_mfma_f32_16x16x32_bf16 v[132:135], a[116:119], v[52:55], v[132:135]
v_exp_f32 v90, v90
v_mfma_f32_16x16x32_bf16 v[132:135], a[100:103], v[48:51], v[132:135]
s_sub_u32 s36, s36, s61
v_exp_f32 v95, v95
v_mfma_f32_16x16x32_bf16 v[136:139], a[120:123], v[52:55], v[136:139]
s_and_b32 m0, s39, 0x1ffff
v_exp_f32 v89, v89
v_mfma_f32_16x16x32_bf16 v[136:139], a[104:107], v[48:51], v[136:139]
s_add_u32 s39, s39, 0x1008000
v_cvt_pk_bf16_f32 v57, v90, v91
v_cvt_pk_bf16_f32 v56, v88, v89
v_mfma_f32_16x16x32_bf16 v[140:143], a[124:127], v[52:55], v[140:143]
v_and_or_b32 v5, s39, v20, v4
v_cvt_pk_bf16_f32 v59, v94, v95
v_mfma_f32_16x16x32_bf16 v[140:143], a[108:111], v[48:51], v[140:143]
s_cbranch_scc0 kf_kernel_loopB
kf_kernel_loopBx:
s_cmp_lt_u32 s39, s32
s_cbranch_scc1 kf_kernel_hB
kf_kernel_exB:
s_cmp_eq_u32 s20, 0
s_cbranch_scc1 kf_kernel_pd20
s_cmp_eq_u32 s20, 1
s_cbranch_scc1 kf_kernel_pd29
s_cmp_eq_u32 s20, 2
s_cbranch_scc1 kf_kernel_pd30
kf_kernel_r3:
s_bitcmp1_b32 s20, 0
s_cbranch_scc1 kf_kernel_preA1
kf_kernel_xB:
v_mfma_f32_16x16x32_bf16 v[88:91], a[64:67], a[16:19], v[36:39]
s_waitcnt vmcnt(16) lgkmcnt(0)
s_barrier
v_mfma_f32_16x16x32_bf16 v[88:91], a[68:71], a[20:23], v[88:91]
ds_read_b128 a[64:67], v5 offset:0
ds_read_b128 a[68:71], v5 offset:1024
v_exp_f32 v85, v85
v_mfma_f32_16x16x32_bf16 v[88:91], a[72:75], a[24:27], v[88:91]
v_exp_f32 v87, v87
v_mfma_f32_16x16x32_bf16 v[88:91], a[76:79], a[28:31], v[88:91]
ds_read_b128 a[72:75], v5 offset:2048
ds_read_b128 a[76:79], v5 offset:3072
v_mfma_f32_16x16x32_bf16 v[92:95], a[80:83], a[16:19], v[36:39]
v_exp_f32 v83, v83
v_mfma_f32_16x16x32_bf16 v[92:95], a[84:87], a[20:23], v[92:95]
ds_read_b128 a[80:83], v5 offset:4096
ds_read_b128 a[84:87], v5 offset:5120
v_mfma_f32_16x16x32_bf16 v[92:95], a[88:91], a[24:27], v[92:95]
v_exp_f32 v81, v81
v_mfma_f32_16x16x32_bf16 v[92:95], a[92:95], a[28:31], v[92:95]
s_sub_u32 s29, s39, 16384
v_exp_f32 v84, v84
v_mfma_f32_16x16x32_bf16 v[160:163], a[112:115], v[60:63], v[160:163]
ds_read_b128 a[88:91], v5 offset:6144
ds_read_b128 a[92:95], v5 offset:7168
v_mfma_f32_16x16x32_bf16 v[160:163], a[96:99], v[56:59], v[160:163]
ds_read_b128 a[112:115], v5 offset:12288
ds_read_b128 a[96:99], v5 offset:8192
v_mfma_f32_16x16x32_bf16 v[164:167], a[116:119], v[60:63], v[164:167]
v_exp_f32 v80, v80
v_mfma_f32_16x16x32_bf16 v[164:167], a[100:103], v[56:59], v[164:167]
v_exp_f32 v91, v91
v_mfma_f32_16x16x32_bf16 v[168:171], a[120:123], v[60:63], v[168:171]
ds_read_b128 a[116:119], v5 offset:13312
ds_read_b128 a[100:103], v5 offset:9216
ds_read_b128 a[120:123], v5 offset:14336
v_mfma_f32_16x16x32_bf16 v[168:171], a[104:107], v[56:59], v[168:171]
v_exp_f32 v82, v82
v_mfma_f32_16x16x32_bf16 v[172:175], a[124:127], v[60:63], v[172:175]
s_waitcnt lgkmcnt(9)
v_exp_f32 v86, v86
v_mfma_f32_16x16x32_bf16 v[172:175], a[108:111], v[56:59], v[172:175]
v_cvt_pk_bf16_f32 v53, v82, v83
v_cvt_pk_bf16_f32 v52, v80, v81
v_mfma_f32_16x16x32_bf16 v[80:83], a[64:67], a[0:3], v[32:35]
buffer_load_dwordx4 v6, s[8:11], s36 offen offset:0 sc1 lds
v_mfma_f32_16x16x32_bf16 v[80:83], a[68:71], a[4:7], v[80:83]
s_waitcnt lgkmcnt(5)
ds_read_b128 a[104:107], v5 offset:10240
v_cvt_pk_bf16_f32 v54, v84, v85
v_mfma_f32_16x16x32_bf16 v[80:83], a[72:75], a[8:11], v[80:83]
ds_read_b128 a[124:127], v5 offset:15360
ds_read_b128 a[108:111], v5 offset:11264
v_mfma_f32_16x16x32_bf16 v[80:83], a[76:79], a[12:15], v[80:83]
s_add_u32 s39, s39, 16384
v_cvt_pk_bf16_f32 v55, v86, v87
v_and_or_b32 v5, s39, v20, v4
v_mfma_f32_16x16x32_bf16 v[84:87], a[80:83], a[0:3], v[32:35]
v_exp_f32 v95, v95
v_mfma_f32_16x16x32_bf16 v[84:87], a[84:87], a[4:7], v[84:87]
buffer_load_dwordx4 v7, s[8:11], s36 offen offset:1024 sc1 lds
v_mfma_f32_16x16x32_bf16 v[84:87], a[88:91], a[8:11], v[84:87]
s_waitcnt lgkmcnt(4)
v_exp_f32 v90, v90
v_mfma_f32_16x16x32_bf16 v[84:87], a[92:95], a[12:15], v[84:87]
buffer_load_dwordx4 v28, s[8:11], s36 offen offset:2048 sc1 lds
v_smfmac_f32_16x16x64_bf16 a[240:243], v[112:115], v[48:55], v19
v_exp_f32 v89, v89
v_mfma_f32_16x16x32_bf16 v[144:147], a[96:99], v[48:51], v[144:147]
buffer_load_dwordx4 v31, s[8:11], s36 offen offset:3072 sc1 lds
v_mfma_f32_16x16x32_bf16 v[144:147], a[112:115], v[52:55], v[144:147]
s_waitcnt lgkmcnt(0)
v_exp_f32 v94, v94
v_mfma_f32_16x16x32_bf16 v[148:151], a[100:103], v[48:51], v[148:151]
s_and_b32 m0, s29, 0x1ffff
v_exp_f32 v92, v92
v_mfma_f32_16x16x32_bf16 v[148:151], a[116:119], v[52:55], v[148:151]
s_sub_u32 s36, s36, s61
v_exp_f32 v93, v93
v_mfma_f32_16x16x32_bf16 v[152:155], a[104:107], v[48:51], v[152:155]
v_cvt_pk_bf16_f32 v61, v90, v91
v_cvt_pk_bf16_f32 v62, v92, v93
v_mfma_f32_16x16x32_bf16 v[152:155], a[120:123], v[52:55], v[152:155]
v_exp_f32 v88, v88
v_mfma_f32_16x16x32_bf16 v[156:159], a[108:111], v[48:51], v[156:159]
v_cvt_pk_bf16_f32 v60, v88, v89
v_cvt_pk_bf16_f32 v63, v94, v95
v_mfma_f32_16x16x32_bf16 v[156:159], a[124:127], v[52:55], v[156:159]
s_cbranch_scc1 kf_kernel_sw_preA0
kf_kernel_preA0:
v_mov_b64 v[70:71], 0
v_exp_f32 v80, v80
v_mfma_f32_16x16x32_bf16 v[88:91], a[64:67], a[16:19], v[36:39]
v_exp_f32 v87, v87
v_mfma_f32_16x16x32_bf16 v[88:91], a[68:71], a[20:23], v[88:91]
ds_read_b128 a[64:67], v5 offset:0
ds_read_b128 a[68:71], v5 offset:1024
v_mfma_f32_16x16x32_bf16 v[88:91], a[72:75], a[24:27], v[88:91]
v_exp_f32 v81, v81
v_exp_f32 v84, v84
v_mfma_f32_16x16x32_bf16 v[88:91], a[76:79], a[28:31], v[88:91]
ds_read_b128 a[72:75], v5 offset:2048
v_mov_b64 v[196:197], 0
v_mfma_f32_16x16x32_bf16 v[92:95], a[80:83], a[16:19], v[36:39]
ds_read_b128 a[76:79], v5 offset:3072
ds_read_b128 a[80:83], v5 offset:4096
v_mfma_f32_16x16x32_bf16 v[92:95], a[84:87], a[20:23], v[92:95]
ds_read_b128 a[84:87], v5 offset:5120
v_exp_f32 v86, v86
v_mfma_f32_16x16x32_bf16 v[92:95], a[88:91], a[24:27], v[92:95]
v_exp_f32 v85, v85
v_mfma_f32_16x16x32_bf16 v[92:95], a[92:95], a[28:31], v[92:95]
ds_read_b128 a[88:91], v5 offset:6144
ds_read_b128 a[92:95], v5 offset:7168
v_smfmac_f32_16x16x64_bf16 a[244:247], v[112:115], v[56:63], v19
v_cvt_pk_bf16_f32 v50, v84, v85
v_mov_b64 v[66:67], 0
v_mfma_f32_16x16x32_bf16 v[176:179], a[96:99], v[56:59], v[176:179]
ds_read_b128 a[96:99], v5 offset:8192
v_mov_b64 v[192:193], 0
v_mfma_f32_16x16x32_bf16 v[176:179], a[112:115], v[60:63], v[176:179]
v_cvt_pk_bf16_f32 v48, v80, v81
v_exp_f32 v83, v83
v_mfma_f32_16x16x32_bf16 v[180:183], a[100:103], v[56:59], v[180:183]
ds_read_b128 a[112:115], v5 offset:12288
ds_read_b128 a[100:103], v5 offset:9216
v_mfma_f32_16x16x32_bf16 v[180:183], a[116:119], v[60:63], v[180:183]
s_waitcnt lgkmcnt(7)
v_exp_f32 v90, v90
v_mov_b64 v[72:73], 0
v_mfma_f32_16x16x32_bf16 v[184:187], a[104:107], v[56:59], v[184:187]
ds_read_b128 a[116:119], v5 offset:13312
ds_read_b128 a[104:107], v5 offset:10240
v_mfma_f32_16x16x32_bf16 v[184:187], a[120:123], v[60:63], v[184:187]
v_exp_f32 v82, v82
v_mfma_f32_16x16x32_bf16 v[188:191], a[108:111], v[56:59], v[188:191]
s_waitcnt lgkmcnt(5)
ds_read_b128 a[120:123], v5 offset:14336
v_cvt_pk_bf16_f32 v51, v86, v87
v_mfma_f32_16x16x32_bf16 v[188:191], a[124:127], v[60:63], v[188:191]
v_mov_b64 v[200:201], 0
v_cvt_pk_bf16_f32 v49, v82, v83
v_mfma_f32_16x16x32_bf16 v[80:83], a[64:67], a[0:3], v[32:35]
v_exp_f32 v94, v94
v_mfma_f32_16x16x32_bf16 v[80:83], a[68:71], a[4:7], v[80:83]
buffer_load_dwordx4 v6, s[8:11], s36 offen offset:0 sc1 lds
v_mfma_f32_16x16x32_bf16 v[80:83], a[72:75], a[8:11], v[80:83]
s_sub_u32 s29, s39, 16384
ds_read_b128 a[108:111], v5 offset:11264
ds_read_b128 a[124:127], v5 offset:15360
v_mfma_f32_16x16x32_bf16 v[80:83], a[76:79], a[12:15], v[80:83]
v_exp_f32 v88, v88
v_mfma_f32_16x16x32_bf16 v[84:87], a[80:83], a[0:3], v[32:35]
buffer_load_dwordx4 v7, s[8:11], s36 offen offset:1024 sc1 lds
v_mfma_f32_16x16x32_bf16 v[84:87], a[84:87], a[4:7], v[84:87]
buffer_load_dwordx4 v28, s[8:11], s36 offen offset:2048 sc1 lds
v_mfma_f32_16x16x32_bf16 v[84:87], a[88:91], a[8:11], v[84:87]
v_exp_f32 v92, v92
v_mfma_f32_16x16x32_bf16 v[84:87], a[92:95], a[12:15], v[84:87]
s_waitcnt lgkmcnt(4)
buffer_load_dwordx4 v31, s[8:11], s36 offen offset:3072 sc1 lds
v_mfma_f32_16x16x32_bf16 v[96:99], a[64:67], a[32:35], 0
v_exp_f32 v91, v91
v_mfma_f32_16x16x32_bf16 v[96:99], a[68:71], a[36:39], v[96:99]
v_mov_b64 v[64:65], 0
v_mov_b64 v[204:205], 0
v_mfma_f32_16x16x32_bf16 v[96:99], a[72:75], a[40:43], v[96:99]
s_waitcnt lgkmcnt(0)
v_exp_f32 v95, v95
v_mfma_f32_16x16x32_bf16 v[96:99], a[76:79], a[44:47], v[96:99]
v_mov_b64 v[198:199], 0
v_mov_b64 v[194:195], 0
v_mfma_f32_16x16x32_bf16 v[128:131], a[112:115], v[52:55], v[128:131]
v_exp_f32 v89, v89
v_mfma_f32_16x16x32_bf16 v[128:131], a[96:99], v[48:51], v[128:131]
v_exp_f32 v93, v93
v_mfma_f32_16x16x32_bf16 v[132:135], a[116:119], v[52:55], v[132:135]
v_cvt_pk_bf16_f32 v59, v94, v95
v_cvt_pk_bf16_f32 v57, v90, v91
v_mfma_f32_16x16x32_bf16 v[132:135], a[100:103], v[48:51], v[132:135]
v_cvt_pk_bf16_f32 v56, v88, v89
v_mov_b64 v[74:75], 0
v_mfma_f32_16x16x32_bf16 v[136:139], a[120:123], v[52:55], v[136:139]
s_waitcnt vmcnt(16) lgkmcnt(0)
v_mov_b32 v18, s57
v_cndmask_b32 v98, v18, v98, s[52:53]
v_mfma_f32_16x16x32_bf16 v[136:139], a[104:107], v[48:51], v[136:139]
v_cndmask_b32 v96, v18, v96, s[48:49]
v_exp_f32 v86, v86
v_mfma_f32_16x16x32_bf16 v[140:143], a[124:127], v[52:55], v[140:143]
s_branch kf_kernel_pl16
kf_kernel_pd16:
s_branch kf_kernel_r0
kf_kernel_pl16:
v_cndmask_b32 v97, v18, v97, s[50:51]
v_cvt_pk_bf16_f32 v58, v92, v93
v_mfma_f32_16x16x32_bf16 v[140:143], a[108:111], v[48:51], v[140:143]
v_exp_f32 v81, v81
v_mfma_f32_16x16x32_bf16 v[88:91], a[64:67], a[16:19], v[36:39]
s_and_b32 m0, s29, 0x1ffff
s_barrier
v_mov_b64 v[206:207], 0
v_mfma_f32_16x16x32_bf16 v[88:91], a[68:71], a[20:23], v[88:91]
v_cndmask_b32 v99, v18, v99, s[54:55]
v_max3_f32 v18, v96, v97, v98
v_mov_b64 v[202:203], 0
v_mfma_f32_16x16x32_bf16 v[88:91], a[72:75], a[24:27], v[88:91]
s_add_u32 s39, s39, 16384
v_and_or_b32 v5, s39, v20, v4
v_exp_f32 v82, v82
v_mfma_f32_16x16x32_bf16 v[88:91], a[76:79], a[28:31], v[88:91]
v_max_f32 v18, v18, v99
v_mov_b32 v1, v18
v_mfma_f32_16x16x32_bf16 v[92:95], a[80:83], a[16:19], v[36:39]
v_exp_f32 v85, v85
v_mfma_f32_16x16x32_bf16 v[92:95], a[84:87], a[20:23], v[92:95]
s_sub_u32 s36, s36, s61
v_permlane16_swap_b32 v1, v18
v_max_f32 v18, v18, v1
v_mfma_f32_16x16x32_bf16 v[92:95], a[88:91], a[24:27], v[92:95]
v_mov_b32 v1, v18
v_exp_f32 v83, v83
v_mfma_f32_16x16x32_bf16 v[92:95], a[92:95], a[28:31], v[92:95]
v_exp_f32 v80, v80
v_mfma_f32_16x16x32_bf16 v[104:107], a[64:67], a[48:51], 0
ds_read_b128 a[64:67], v5 offset:0
v_cvt_pk_bf16_f32 v53, v82, v83
v_mfma_f32_16x16x32_bf16 v[104:107], a[68:71], a[52:55], v[104:107]
ds_read_b128 a[68:71], v5 offset:1024
v_permlane32_swap_b32 v1, v18
v_mfma_f32_16x16x32_bf16 v[104:107], a[72:75], a[56:59], v[104:107]
ds_read_b128 a[72:75], v5 offset:2048
v_max_f32 v18, v18, v1
v_mfma_f32_16x16x32_bf16 v[104:107], a[76:79], a[60:63], v[104:107]
ds_read_b128 a[76:79], v5 offset:3072
v_add_f32 v18, 0x42000000, v18
v_sub_f32 v98, v98, v18
v_sub_f32 v43, 0, v18
v_mfma_f32_16x16x32_bf16 v[108:111], a[80:83], a[48:51], 0
v_exp_f32 v84, v84
v_mfma_f32_16x16x32_bf16 v[108:111], a[84:87], a[52:55], v[108:111]
ds_read_b128 a[80:83], v5 offset:4096
ds_read_b128 a[84:87], v5 offset:5120
v_sub_f32 v42, 0, v18
v_cvt_pk_bf16_f32 v54, v84, v85
v_mfma_f32_16x16x32_bf16 v[108:111], a[88:91], a[56:59], v[108:111]
v_exp_f32 v88, v88
v_sub_f32 v96, v96, v18
v_mfma_f32_16x16x32_bf16 v[108:111], a[92:95], a[60:63], v[108:111]
ds_read_b128 a[88:91], v5 offset:6144
v_sub_f32 v40, 0, v18
v_mfma_f32_16x16x32_bf16 v[160:163], a[112:115], v[60:63], v[160:163]
ds_read_b128 a[92:95], v5 offset:7168
ds_read_b128 a[112:115], v5 offset:12288
v_exp_f32 v87, v87
v_exp_f32 v93, v93
v_mfma_f32_16x16x32_bf16 v[160:163], a[96:99], v[56:59], v[160:163]
v_sub_f32 v41, 0, v18
v_cvt_pk_bf16_f32 v52, v80, v81
v_mfma_f32_16x16x32_bf16 v[164:167], a[116:119], v[60:63], v[164:167]
ds_read_b128 a[96:99], v5 offset:8192
ds_read_b128 a[116:119], v5 offset:13312
v_exp_f32 v96, v96
v_mfma_f32_16x16x32_bf16 v[164:167], a[100:103], v[56:59], v[164:167]
ds_read_b128 a[100:103], v5 offset:9216
v_cvt_pk_bf16_f32 v55, v86, v87
v_mfma_f32_16x16x32_bf16 v[168:171], a[120:123], v[60:63], v[168:171]
ds_read_b128 a[120:123], v5 offset:14336
v_exp_f32 v95, v95
v_mfma_f32_16x16x32_bf16 v[168:171], a[104:107], v[56:59], v[168:171]
s_waitcnt lgkmcnt(9)
v_sub_f32 v99, v99, v18
v_sub_f32 v97, v97, v18
v_mfma_f32_16x16x32_bf16 v[172:175], a[124:127], v[60:63], v[172:175]
s_waitcnt lgkmcnt(5)
ds_read_b128 a[104:107], v5 offset:10240
ds_read_b128 a[124:127], v5 offset:15360
v_mfma_f32_16x16x32_bf16 v[172:175], a[108:111], v[56:59], v[172:175]
s_sub_u32 s29, s39, 16384
v_mov_b32 v18, s57
v_cndmask_b32 v110, v18, v110, s[52:53]
v_mfma_f32_16x16x32_bf16 v[80:83], a[64:67], a[0:3], v[32:35]
ds_read_b128 a[108:111], v5 offset:11264
v_cndmask_b32 v109, v18, v109, s[50:51]
v_exp_f32 v97, v97
v_mfma_f32_16x16x32_bf16 v[80:83], a[68:71], a[4:7], v[80:83]
s_waitcnt lgkmcnt(4)
buffer_load_dwordx4 v6, s[8:11], s36 offen offset:0 sc1 lds
v_mfma_f32_16x16x32_bf16 v[80:83], a[72:75], a[8:11], v[80:83]
v_exp_f32 v99, v99
v_mfma_f32_16x16x32_bf16 v[80:83], a[76:79], a[12:15], v[80:83]
s_add_u32 s39, s39, 16384
v_cndmask_b32 v108, v18, v108, s[48:49]
v_cndmask_b32 v111, v18, v111, s[54:55]
v_mfma_f32_16x16x32_bf16 v[84:87], a[80:83], a[0:3], v[32:35]
v_exp_f32 v98, v98
v_mfma_f32_16x16x32_bf16 v[84:87], a[84:87], a[4:7], v[84:87]
v_exp_f32 v92, v92
v_cvt_pk_bf16_f32 v69, v98, v99
v_mfma_f32_16x16x32_bf16 v[84:87], a[88:91], a[8:11], v[84:87]
v_max3_f32 v18, v104, v105, v106
v_max3_f32 v18, v18, v107, v108
v_max3_f32 v18, v18, v109, v110
v_max_f32 v18, v18, v111
v_mov_b32 v1, v18
v_mfma_f32_16x16x32_bf16 v[84:87], a[92:95], a[12:15], v[84:87]
s_waitcnt lgkmcnt(0)
v_cvt_pk_bf16_f32 v68, v96, v97
v_permlane16_swap_b32 v1, v18
v_max_f32 v18, v18, v1
v_mov_b32 v1, v18
v_mfma_f32_16x16x32_bf16 v[96:99], a[64:67], a[32:35], v[40:43]
v_exp_f32 v89, v89
v_permlane32_swap_b32 v1, v18
v_mfma_f32_16x16x32_bf16 v[96:99], a[68:71], a[36:39], v[96:99]
v_exp_f32 v94, v94
v_max_f32 v18, v18, v1
v_add_f32 v18, 0x42000000, v18
v_mfma_f32_16x16x32_bf16 v[96:99], a[72:75], a[40:43], v[96:99]
buffer_load_dwordx4 v7, s[8:11], s36 offen offset:1024 sc1 lds
v_mfma_f32_16x16x32_bf16 v[96:99], a[76:79], a[44:47], v[96:99]
v_exp_f32 v90, v90
v_mfma_f32_16x16x32_bf16 v[100:103], a[80:83], a[32:35], v[40:43]
v_cvt_pk_bf16_f32 v63, v94, v95
v_sub_f32 v47, 0, v18
v_sub_f32 v105, v105, v18
v_mfma_f32_16x16x32_bf16 v[100:103], a[84:87], a[36:39], v[100:103]
v_sub_f32 v104, v104, v18
v_sub_f32 v46, 0, v18
v_sub_f32 v45, 0, v18
v_mfma_f32_16x16x32_bf16 v[100:103], a[88:91], a[40:43], v[100:103]
buffer_load_dwordx4 v28, s[8:11], s36 offen offset:2048 sc1 lds
v_exp_f32 v105, v105
v_sub_f32 v109, v109, v18
v_mfma_f32_16x16x32_bf16 v[100:103], a[92:95], a[44:47], v[100:103]
v_cvt_pk_bf16_f32 v62, v92, v93
v_exp_f32 v104, v104
v_smfmac_f32_16x16x64_bf16 a[240:243], v[112:115], v[48:55], v19
v_exp_f32 v109, v109
v_mfma_f32_16x16x32_bf16 v[144:147], a[96:99], v[48:51], v[144:147]
v_exp_f32 v91, v91
v_mfma_f32_16x16x32_bf16 v[144:147], a[112:115], v[52:55], v[144:147]
v_sub_f32 v106, v106, v18
v_sub_f32 v107, v107, v18
v_cvt_pk_bf16_f32 v60, v88, v89
v_mfma_f32_16x16x32_bf16 v[148:151], a[100:103], v[48:51], v[148:151]
v_cvt_pk_bf16_f32 v76, v104, v105
v_sub_f32 v110, v110, v18
v_cvt_pk_bf16_f32 v61, v90, v91
v_mfma_f32_16x16x32_bf16 v[148:151], a[116:119], v[52:55], v[148:151]
v_exp_f32 v106, v106
v_mfma_f32_16x16x32_bf16 v[152:155], a[104:107], v[48:51], v[152:155]
v_sub_f32 v111, v111, v18
v_sub_f32 v108, v108, v18
v_mfma_f32_16x16x32_bf16 v[152:155], a[120:123], v[52:55], v[152:155]
buffer_load_dwordx4 v31, s[8:11], s36 offen offset:3072 sc1 lds
v_mfma_f32_16x16x32_bf16 v[156:159], a[108:111], v[48:51], v[156:159]
s_and_b32 m0, s29, 0x1ffff
v_exp_f32 v110, v110
v_mfma_f32_16x16x32_bf16 v[156:159], a[124:127], v[52:55], v[156:159]
v_exp_f32 v108, v108
v_sub_f32 v44, 0, v18
v_smfmac_f32_16x16x64_bf16 a[248:251], v[112:115], v[64:71], v19
v_exp_f32 v107, v107
v_mfma_f32_16x16x32_bf16 v[208:211], a[112:115], v[68:71], 0
s_sub_u32 s36, s36, s61
v_cvt_pk_bf16_f32 v78, v108, v109
v_and_or_b32 v5, s39, v20, v4
v_mfma_f32_16x16x32_bf16 v[212:215], a[116:119], v[68:71], 0
v_exp_f32 v111, v111
v_mfma_f32_16x16x32_bf16 v[216:219], a[120:123], v[68:71], 0
v_cvt_pk_bf16_f32 v77, v106, v107
v_cvt_pk_bf16_f32 v79, v110, v111
v_mfma_f32_16x16x32_bf16 v[220:223], a[124:127], v[68:71], 0
s_cbranch_scc1 kf_kernel_sw_enA0
kf_kernel_enA0:
s_bitset0_b32 s39, 14
v_and_or_b32 v5, s39, v20, v4
s_sub_u32 s59, s26, s39
s_max_i32 s59, s59, 0x8000
s_lshl_b32 s59, s59, 9
s_sub_u32 s39, s39, s59
s_branch kf_kernel_loopAB1
kf_kernel_pd17:
s_branch kf_kernel_r0
kf_kernel_preA1:
v_mfma_f32_16x16x32_bf16 v[88:91], a[64:67], a[16:19], v[36:39]
s_waitcnt vmcnt(16) lgkmcnt(0)
v_exp_f32 v80, v80
s_barrier
v_mfma_f32_16x16x32_bf16 v[88:91], a[68:71], a[20:23], v[88:91]
s_sub_u32 s29, s39, 16384
ds_read_b128 a[64:67], v5 offset:0
ds_read_b128 a[68:71], v5 offset:1024
v_mfma_f32_16x16x32_bf16 v[88:91], a[72:75], a[24:27], v[88:91]
v_exp_f32 v81, v81
v_mfma_f32_16x16x32_bf16 v[88:91], a[76:79], a[28:31], v[88:91]
ds_read_b128 a[72:75], v5 offset:2048
ds_read_b128 a[76:79], v5 offset:3072
v_mfma_f32_16x16x32_bf16 v[92:95], a[80:83], a[16:19], v[36:39]
ds_read_b128 a[80:83], v5 offset:4096
v_exp_f32 v82, v82
v_mfma_f32_16x16x32_bf16 v[92:95], a[84:87], a[20:23], v[92:95]
v_exp_f32 v86, v86
v_mfma_f32_16x16x32_bf16 v[92:95], a[88:91], a[24:27], v[92:95]
ds_read_b128 a[84:87], v5 offset:5120
ds_read_b128 a[88:91], v5 offset:6144
v_mfma_f32_16x16x32_bf16 v[92:95], a[92:95], a[28:31], v[92:95]
v_cvt_pk_bf16_f32 v52, v80, v81
v_exp_f32 v83, v83
v_mfma_f32_16x16x32_bf16 v[160:163], a[112:115], v[60:63], v[160:163]
ds_read_b128 a[92:95], v5 offset:7168
ds_read_b128 a[112:115], v5 offset:12288
v_mfma_f32_16x16x32_bf16 v[160:163], a[96:99], v[56:59], v[160:163]
ds_read_b128 a[96:99], v5 offset:8192
v_mov_b64 v[76:77], 0
v_mfma_f32_16x16x32_bf16 v[164:167], a[116:119], v[60:63], v[164:167]
ds_read_b128 a[116:119], v5 offset:13312
v_exp_f32 v84, v84
v_mov_b64 v[208:209], 0
v_mfma_f32_16x16x32_bf16 v[164:167], a[100:103], v[56:59], v[164:167]
s_add_u32 s39, s39, 16384
v_exp_f32 v85, v85
v_mfma_f32_16x16x32_bf16 v[168:171], a[120:123], v[60:63], v[168:171]
s_waitcnt lgkmcnt(7)
ds_read_b128 a[100:103], v5 offset:9216
ds_read_b128 a[120:123], v5 offset:14336
v_mfma_f32_16x16x32_bf16 v[168:171], a[104:107], v[56:59], v[168:171]
v_exp_f32 v87, v87
v_mfma_f32_16x16x32_bf16 v[172:175], a[124:127], v[60:63], v[172:175]
v_cvt_pk_bf16_f32 v53, v82, v83
v_mov_b64 v[222:223], 0
v_mfma_f32_16x16x32_bf16 v[172:175], a[108:111], v[56:59], v[172:175]
ds_read_b128 a[104:107], v5 offset:10240
v_mov_b64 v[210:211], 0
v_mfma_f32_16x16x32_bf16 v[80:83], a[64:67], a[0:3], v[32:35]
s_waitcnt lgkmcnt(6)
v_exp_f32 v95, v95
v_mfma_f32_16x16x32_bf16 v[80:83], a[68:71], a[4:7], v[80:83]
v_exp_f32 v93, v93
v_mfma_f32_16x16x32_bf16 v[80:83], a[72:75], a[8:11], v[80:83]
s_waitcnt lgkmcnt(2)
ds_read_b128 a[124:127], v5 offset:15360
ds_read_b128 a[108:111], v5 offset:11264
v_mfma_f32_16x16x32_bf16 v[80:83], a[76:79], a[12:15], v[80:83]
v_cvt_pk_bf16_f32 v55, v86, v87
v_cvt_pk_bf16_f32 v54, v84, v85
v_mfma_f32_16x16x32_bf16 v[84:87], a[80:83], a[0:3], v[32:35]
v_exp_f32 v88, v88
v_mfma_f32_16x16x32_bf16 v[84:87], a[84:87], a[4:7], v[84:87]
v_exp_f32 v89, v89
v_mfma_f32_16x16x32_bf16 v[84:87], a[88:91], a[8:11], v[84:87]
v_exp_f32 v94, v94
v_mfma_f32_16x16x32_bf16 v[84:87], a[92:95], a[12:15], v[84:87]
buffer_load_dwordx4 v6, s[8:11], s36 offen offset:0 sc1 lds
v_mfma_f32_16x16x32_bf16 v[96:99], a[64:67], a[32:35], 0
buffer_load_dwordx4 v7, s[8:11], s36 offen offset:1024 sc1 lds
v_mfma_f32_16x16x32_bf16 v[96:99], a[68:71], a[36:39], v[96:99]
s_waitcnt lgkmcnt(0)
v_mov_b64 v[66:67], 0
v_mov_b64 v[212:213], 0
v_mfma_f32_16x16x32_bf16 v[96:99], a[72:75], a[40:43], v[96:99]
buffer_load_dwordx4 v28, s[8:11], s36 offen offset:2048 sc1 lds
v_mfma_f32_16x16x32_bf16 v[96:99], a[76:79], a[44:47], v[96:99]
buffer_load_dwordx4 v31, s[8:11], s36 offen offset:3072 sc1 lds
v_smfmac_f32_16x16x64_bf16 a[240:243], v[112:115], v[48:55], v19
v_exp_f32 v91, v91
v_mfma_f32_16x16x32_bf16 v[144:147], a[96:99], v[48:51], v[144:147]
v_exp_f32 v90, v90
v_mfma_f32_16x16x32_bf16 v[144:147], a[112:115], v[52:55], v[144:147]
v_mov_b64 v[216:217], 0
v_cvt_pk_bf16_f32 v60, v88, v89
v_mfma_f32_16x16x32_bf16 v[148:151], a[100:103], v[48:51], v[148:151]
v_exp_f32 v92, v92
v_mfma_f32_16x16x32_bf16 v[148:151], a[116:119], v[52:55], v[148:151]
s_and_b32 m0, s29, 0x1ffff
v_mov_b64 v[78:79], 0
v_cvt_pk_bf16_f32 v61, v90, v91
v_mfma_f32_16x16x32_bf16 v[152:155], a[104:107], v[48:51], v[152:155]
s_sub_u32 s36, s36, s61
v_cvt_pk_bf16_f32 v63, v94, v95
v_cvt_pk_bf16_f32 v62, v92, v93
v_mfma_f32_16x16x32_bf16 v[152:155], a[120:123], v[52:55], v[152:155]
v_mov_b64 v[218:219], 0
v_mov_b64 v[214:215], 0
v_mfma_f32_16x16x32_bf16 v[156:159], a[108:111], v[48:51], v[156:159]
v_and_or_b32 v5, s39, v20, v4
v_mov_b64 v[220:221], 0
v_mfma_f32_16x16x32_bf16 v[156:159], a[124:127], v[52:55], v[156:159]
s_cbranch_scc1 kf_kernel_sw_diagA1
kf_kernel_diagA1:
v_mov_b32 v18, s57
v_mfma_f32_16x16x32_bf16 v[88:91], a[64:67], a[16:19], v[36:39]
v_exp_f32 v83, v83
v_cndmask_b32 v96, v18, v96, s[48:49]
v_mfma_f32_16x16x32_bf16 v[88:91], a[68:71], a[20:23], v[88:91]
v_exp_f32 v80, v80
v_mfma_f32_16x16x32_bf16 v[88:91], a[72:75], a[24:27], v[88:91]
v_exp_f32 v82, v82
v_mfma_f32_16x16x32_bf16 v[88:91], a[76:79], a[28:31], v[88:91]
v_exp_f32 v81, v81
v_cndmask_b32 v99, v18, v99, s[54:55]
v_mfma_f32_16x16x32_bf16 v[92:95], a[80:83], a[16:19], v[36:39]
v_exp_f32 v86, v86
v_mfma_f32_16x16x32_bf16 v[92:95], a[84:87], a[20:23], v[92:95]
v_cndmask_b32 v97, v18, v97, s[50:51]
v_cndmask_b32 v98, v18, v98, s[52:53]
v_max3_f32 v18, v96, v97, v98
v_max_f32 v18, v18, v99
v_mov_b32 v1, v18
v_mfma_f32_16x16x32_bf16 v[92:95], a[88:91], a[24:27], v[92:95]
v_exp_f32 v87, v87
v_mfma_f32_16x16x32_bf16 v[92:95], a[92:95], a[28:31], v[92:95]
v_permlane16_swap_b32 v1, v18
v_max_f32 v18, v18, v1
v_mfma_f32_16x16x32_bf16 v[104:107], a[64:67], a[48:51], 0
ds_read_b128 a[64:67], v5 offset:0
v_mov_b32 v1, v18
v_mfma_f32_16x16x32_bf16 v[104:107], a[68:71], a[52:55], v[104:107]
ds_read_b128 a[68:71], v5 offset:1024
v_exp_f32 v84, v84
v_mfma_f32_16x16x32_bf16 v[104:107], a[72:75], a[56:59], v[104:107]
v_permlane32_swap_b32 v1, v18
v_max_f32 v18, v18, v1
v_add_f32 v18, 0x42000000, v18
v_sub_f32 v42, 0, v18
v_mfma_f32_16x16x32_bf16 v[104:107], a[76:79], a[60:63], v[104:107]
ds_read_b128 a[72:75], v5 offset:2048
ds_read_b128 a[76:79], v5 offset:3072
v_sub_f32 v96, v96, v18
v_sub_f32 v98, v98, v18
v_cvt_pk_bf16_f32 v49, v82, v83
v_mfma_f32_16x16x32_bf16 v[108:111], a[80:83], a[48:51], 0
ds_read_b128 a[80:83], v5 offset:4096
v_sub_f32 v97, v97, v18
v_mfma_f32_16x16x32_bf16 v[108:111], a[84:87], a[52:55], v[108:111]
v_cvt_pk_bf16_f32 v48, v80, v81
v_exp_f32 v95, v95
v_mfma_f32_16x16x32_bf16 v[108:111], a[88:91], a[56:59], v[108:111]
ds_read_b128 a[84:87], v5 offset:5120
ds_read_b128 a[88:91], v5 offset:6144
v_mfma_f32_16x16x32_bf16 v[108:111], a[92:95], a[60:63], v[108:111]
ds_read_b128 a[92:95], v5 offset:7168
v_exp_f32 v96, v96
v_smfmac_f32_16x16x64_bf16 a[244:247], v[112:115], v[56:63], v19
v_exp_f32 v85, v85
v_mfma_f32_16x16x32_bf16 v[176:179], a[96:99], v[56:59], v[176:179]
ds_read_b128 a[96:99], v5 offset:8192
v_exp_f32 v97, v97
v_mfma_f32_16x16x32_bf16 v[176:179], a[112:115], v[60:63], v[176:179]
v_exp_f32 v91, v91
v_mfma_f32_16x16x32_bf16 v[180:183], a[100:103], v[56:59], v[180:183]
ds_read_b128 a[112:115], v5 offset:12288
ds_read_b128 a[100:103], v5 offset:9216
v_sub_f32 v40, 0, v18
v_sub_f32 v99, v99, v18
v_exp_f32 v98, v98
v_mfma_f32_16x16x32_bf16 v[180:183], a[116:119], v[60:63], v[180:183]
s_waitcnt lgkmcnt(7)
v_exp_f32 v93, v93
v_mfma_f32_16x16x32_bf16 v[184:187], a[104:107], v[56:59], v[184:187]
ds_read_b128 a[116:119], v5 offset:13312
ds_read_b128 a[104:107], v5 offset:10240
v_mfma_f32_16x16x32_bf16 v[184:187], a[120:123], v[60:63], v[184:187]
ds_read_b128 a[120:123], v5 offset:14336
v_cvt_pk_bf16_f32 v51, v86, v87
v_mfma_f32_16x16x32_bf16 v[188:191], a[108:111], v[56:59], v[188:191]
ds_read_b128 a[108:111], v5 offset:11264
v_cvt_pk_bf16_f32 v50, v84, v85
v_sub_f32 v41, 0, v18
v_sub_f32 v43, 0, v18
v_mov_b32 v18, s57
v_mfma_f32_16x16x32_bf16 v[188:191], a[124:127], v[60:63], v[188:191]
s_waitcnt lgkmcnt(7)
ds_read_b128 a[124:127], v5 offset:15360
v_cndmask_b32 v109, v18, v109, s[50:51]
v_cndmask_b32 v110, v18, v110, s[52:53]
v_mfma_f32_16x16x32_bf16 v[80:83], a[64:67], a[0:3], v[32:35]
buffer_load_dwordx4 v6, s[8:11], s36 offen offset:0 sc1 lds
v_exp_f32 v90, v90
v_mfma_f32_16x16x32_bf16 v[80:83], a[68:71], a[4:7], v[80:83]
v_exp_f32 v88, v88
v_mfma_f32_16x16x32_bf16 v[80:83], a[72:75], a[8:11], v[80:83]
v_exp_f32 v89, v89
v_mfma_f32_16x16x32_bf16 v[80:83], a[76:79], a[12:15], v[80:83]
v_exp_f32 v99, v99
v_mfma_f32_16x16x32_bf16 v[84:87], a[80:83], a[0:3], v[32:35]
v_cvt_pk_bf16_f32 v65, v98, v99
v_cndmask_b32 v111, v18, v111, s[54:55]
v_mfma_f32_16x16x32_bf16 v[84:87], a[84:87], a[4:7], v[84:87]
v_cndmask_b32 v108, v18, v108, s[48:49]
v_max3_f32 v18, v104, v105, v106
v_max3_f32 v18, v18, v107, v108
v_mfma_f32_16x16x32_bf16 v[84:87], a[88:91], a[8:11], v[84:87]
v_max3_f32 v18, v18, v109, v110
v_max_f32 v18, v18, v111
v_mov_b32 v1, v18
v_mfma_f32_16x16x32_bf16 v[84:87], a[92:95], a[12:15], v[84:87]
s_waitcnt lgkmcnt(4)
buffer_load_dwordx4 v7, s[8:11], s36 offen offset:1024 sc1 lds
v_cvt_pk_bf16_f32 v64, v96, v97
v_mfma_f32_16x16x32_bf16 v[96:99], a[64:67], a[32:35], v[40:43]
v_permlane16_swap_b32 v1, v18
v_mfma_f32_16x16x32_bf16 v[96:99], a[68:71], a[36:39], v[96:99]
s_waitcnt lgkmcnt(0)
v_exp_f32 v92, v92
v_mfma_f32_16x16x32_bf16 v[96:99], a[72:75], a[40:43], v[96:99]
v_max_f32 v18, v18, v1
v_mov_b32 v1, v18
v_mfma_f32_16x16x32_bf16 v[96:99], a[76:79], a[44:47], v[96:99]
s_sub_u32 s29, s39, 16384
v_permlane32_swap_b32 v1, v18
v_max_f32 v18, v18, v1
v_mfma_f32_16x16x32_bf16 v[100:103], a[80:83], a[32:35], v[40:43]
v_add_f32 v18, 0x42000000, v18
v_cvt_pk_bf16_f32 v56, v88, v89
v_mfma_f32_16x16x32_bf16 v[100:103], a[84:87], a[36:39], v[100:103]
v_sub_f32 v106, v106, v18
v_sub_f32 v110, v110, v18
v_mfma_f32_16x16x32_bf16 v[100:103], a[88:91], a[40:43], v[100:103]
buffer_load_dwordx4 v28, s[8:11], s36 offen offset:2048 sc1 lds
v_mfma_f32_16x16x32_bf16 v[100:103], a[92:95], a[44:47], v[100:103]
s_add_u32 s39, s39, 16384
v_sub_f32 v44, 0, v18
v_sub_f32 v111, v111, v18
v_and_or_b32 v5, s39, v20, v4
v_mfma_f32_16x16x32_bf16 v[128:131], a[112:115], v[52:55], v[128:131]
s_bitset0_b32 s39, 14
v_exp_f32 v94, v94
v_sub_f32 v104, v104, v18
v_sub_f32 v105, v105, v18
v_mfma_f32_16x16x32_bf16 v[128:131], a[96:99], v[48:51], v[128:131]
buffer_load_dwordx4 v31, s[8:11], s36 offen offset:3072 sc1 lds
v_mfma_f32_16x16x32_bf16 v[132:135], a[116:119], v[52:55], v[132:135]
v_sub_f32 v108, v108, v18
v_sub_f32 v109, v109, v18
v_cvt_pk_bf16_f32 v57, v90, v91
v_mfma_f32_16x16x32_bf16 v[132:135], a[100:103], v[48:51], v[132:135]
s_sub_u32 s59, s26, s39
v_exp_f32 v108, v108
v_sub_f32 v107, v107, v18
v_mfma_f32_16x16x32_bf16 v[136:139], a[120:123], v[52:55], v[136:139]
v_exp_f32 v105, v105
v_and_or_b32 v5, s39, v20, v4
v_mfma_f32_16x16x32_bf16 v[136:139], a[104:107], v[48:51], v[136:139]
s_max_i32 s59, s59, 0x8000
v_cvt_pk_bf16_f32 v58, v92, v93
v_exp_f32 v111, v111
v_mfma_f32_16x16x32_bf16 v[140:143], a[124:127], v[52:55], v[140:143]
s_and_b32 m0, s29, 0x1ffff
v_exp_f32 v107, v107
v_mfma_f32_16x16x32_bf16 v[140:143], a[108:111], v[48:51], v[140:143]
s_sub_u32 s36, s36, s61
v_cvt_pk_bf16_f32 v59, v94, v95
v_exp_f32 v104, v104
v_sub_f32 v45, 0, v18
v_sub_f32 v46, 0, v18
v_mfma_f32_16x16x32_bf16 v[192:195], a[96:99], v[64:67], 0
v_cvt_pk_bf16_f32 v72, v104, v105
v_exp_f32 v109, v109
v_sub_f32 v47, 0, v18
v_mfma_f32_16x16x32_bf16 v[196:199], a[100:103], v[64:67], 0
v_exp_f32 v110, v110
v_mfma_f32_16x16x32_bf16 v[200:203], a[104:107], v[64:67], 0
s_lshl_b32 s59, s59, 9
v_exp_f32 v106, v106
v_mfma_f32_16x16x32_bf16 v[204:207], a[108:111], v[64:67], 0
s_sub_u32 s39, s39, s59
v_cvt_pk_bf16_f32 v75, v110, v111
v_cvt_pk_bf16_f32 v73, v106, v107
v_cvt_pk_bf16_f32 v74, v108, v109
kf_kernel_loopAB:
v_mfma_f32_16x16x32_bf16 v[88:91], a[64:67], a[16:19], v[36:39]
s_waitcnt vmcnt(16) lgkmcnt(0)
s_barrier
v_mfma_f32_16x16x32_bf16 v[88:91], a[68:71], a[20:23], v[88:91]
v_mfma_f32_16x16x32_bf16 v[88:91], a[72:75], a[24:27], v[88:91]
v_exp_f32 v85, v85
v_mfma_f32_16x16x32_bf16 v[88:91], a[76:79], a[28:31], v[88:91]
v_exp_f32 v100, v100
v_mfma_f32_16x16x32_bf16 v[92:95], a[80:83], a[16:19], v[36:39]
v_exp_f32 v101, v101
v_mfma_f32_16x16x32_bf16 v[92:95], a[84:87], a[20:23], v[92:95]
v_exp_f32 v80, v80
v_mfma_f32_16x16x32_bf16 v[92:95], a[88:91], a[24:27], v[92:95]
v_exp_f32 v86, v86
v_mfma_f32_16x16x32_bf16 v[92:95], a[92:95], a[28:31], v[92:95]
v_exp_f32 v102, v102
v_mfma_f32_16x16x32_bf16 v[104:107], a[64:67], a[48:51], v[44:47]
v_exp_f32 v87, v87
v_mfma_f32_16x16x32_bf16 v[104:107], a[68:71], a[52:55], v[104:107]
ds_read_b128 a[64:67], v5 offset:0
ds_read_b128 a[68:71], v5 offset:1024
v_mfma_f32_16x16x32_bf16 v[104:107], a[72:75], a[56:59], v[104:107]
v_exp_f32 v98, v98
v_mfma_f32_16x16x32_bf16 v[104:107], a[76:79], a[60:63], v[104:107]
ds_read_b128 a[72:75], v5 offset:2048
ds_read_b128 a[76:79], v5 offset:3072
v_mfma_f32_16x16x32_bf16 v[108:111], a[80:83], a[48:51], v[44:47]
v_mfma_f32_16x16x32_bf16 v[108:111], a[84:87], a[52:55], v[108:111]
ds_read_b128 a[80:83], v5 offset:4096
ds_read_b128 a[84:87], v5 offset:5120
v_mfma_f32_16x16x32_bf16 v[108:111], a[88:91], a[56:59], v[108:111]
ds_read_b128 a[88:91], v5 offset:6144
v_cvt_pk_bf16_f32 v70, v100, v101
v_mfma_f32_16x16x32_bf16 v[108:111], a[92:95], a[60:63], v[108:111]
v_exp_f32 v103, v103
v_mfma_f32_16x16x32_bf16 v[160:163], a[112:115], v[60:63], v[160:163]
ds_read_b128 a[92:95], v5 offset:7168
v_mfma_f32_16x16x32_bf16 v[160:163], a[96:99], v[56:59], v[160:163]
v_exp_f32 v97, v97
v_mfma_f32_16x16x32_bf16 v[164:167], a[116:119], v[60:63], v[164:167]
v_exp_f32 v81, v81
v_mfma_f32_16x16x32_bf16 v[164:167], a[100:103], v[56:59], v[164:167]
v_cvt_pk_bf16_f32 v71, v102, v103
v_mfma_f32_16x16x32_bf16 v[168:171], a[120:123], v[60:63], v[168:171]
v_exp_f32 v84, v84
v_mfma_f32_16x16x32_bf16 v[168:171], a[104:107], v[56:59], v[168:171]
v_exp_f32 v96, v96
v_mfma_f32_16x16x32_bf16 v[172:175], a[124:127], v[60:63], v[172:175]
v_exp_f32 v82, v82
v_mfma_f32_16x16x32_bf16 v[172:175], a[108:111], v[56:59], v[172:175]
v_exp_f32 v83, v83
v_mfma_f32_16x16x32_bf16 v[224:227], a[112:115], v[76:79], v[224:227]
v_cvt_pk_bf16_f32 v55, v86, v87
v_mfma_f32_16x16x32_bf16 v[224:227], a[96:99], v[72:75], v[224:227]
ds_read_b128 a[112:115], v5 offset:12288
ds_read_b128 a[96:99], v5 offset:8192
v_mfma_f32_16x16x32_bf16 v[228:231], a[116:119], v[76:79], v[228:231]
ds_read_b128 a[116:119], v5 offset:13312
v_cvt_pk_bf16_f32 v52, v80, v81
v_mfma_f32_16x16x32_bf16 v[228:231], a[100:103], v[72:75], v[228:231]
buffer_load_dwordx4 v6, s[8:11], s36 offen offset:0 sc1 lds
v_mfma_f32_16x16x32_bf16 v[232:235], a[120:123], v[76:79], v[232:235]
s_waitcnt lgkmcnt(7)
ds_read_b128 a[100:103], v5 offset:9216
ds_read_b128 a[120:123], v5 offset:14336
v_mfma_f32_16x16x32_bf16 v[232:235], a[104:107], v[72:75], v[232:235]
v_cvt_pk_bf16_f32 v68, v96, v97
v_cvt_pk_bf16_f32 v54, v84, v85
v_mfma_f32_16x16x32_bf16 v[236:239], a[124:127], v[76:79], v[236:239]
ds_read_b128 a[104:107], v5 offset:10240
ds_read_b128 a[124:127], v5 offset:15360
v_mfma_f32_16x16x32_bf16 v[236:239], a[108:111], v[72:75], v[236:239]
ds_read_b128 a[108:111], v5 offset:11264
v_cvt_pk_bf16_f32 v53, v82, v83
v_mfma_f32_16x16x32_bf16 v[80:83], a[64:67], a[0:3], v[32:35]
v_exp_f32 v91, v91
v_mfma_f32_16x16x32_bf16 v[80:83], a[68:71], a[4:7], v[80:83]
v_exp_f32 v95, v95
v_mfma_f32_16x16x32_bf16 v[80:83], a[72:75], a[8:11], v[80:83]
s_waitcnt lgkmcnt(8)
v_exp_f32 v109, v109
v_mfma_f32_16x16x32_bf16 v[80:83], a[76:79], a[12:15], v[80:83]
buffer_load_dwordx4 v7, s[8:11], s36 offen offset:1024 sc1 lds
v_mfma_f32_16x16x32_bf16 v[84:87], a[80:83], a[0:3], v[32:35]
v_exp_f32 v99, v99
v_mfma_f32_16x16x32_bf16 v[84:87], a[84:87], a[4:7], v[84:87]
v_exp_f32 v106, v106
v_mfma_f32_16x16x32_bf16 v[84:87], a[88:91], a[8:11], v[84:87]
v_exp_f32 v88, v88
v_mfma_f32_16x16x32_bf16 v[84:87], a[92:95], a[12:15], v[84:87]
v_cvt_pk_bf16_f32 v69, v98, v99
v_mfma_f32_16x16x32_bf16 v[96:99], a[64:67], a[32:35], v[40:43]
v_exp_f32 v110, v110
v_mfma_f32_16x16x32_bf16 v[96:99], a[68:71], a[36:39], v[96:99]
v_exp_f32 v93, v93
v_mfma_f32_16x16x32_bf16 v[96:99], a[72:75], a[40:43], v[96:99]
s_waitcnt lgkmcnt(4)
v_exp_f32 v94, v94
v_mfma_f32_16x16x32_bf16 v[96:99], a[76:79], a[44:47], v[96:99]
v_exp_f32 v90, v90
v_mfma_f32_16x16x32_bf16 v[100:103], a[80:83], a[32:35], v[40:43]
v_cvt_pk_bf16_f32 v61, v90, v91
v_mfma_f32_16x16x32_bf16 v[100:103], a[84:87], a[36:39], v[100:103]
v_exp_f32 v108, v108
v_mfma_f32_16x16x32_bf16 v[100:103], a[88:91], a[40:43], v[100:103]
v_exp_f32 v111, v111
v_mfma_f32_16x16x32_bf16 v[100:103], a[92:95], a[44:47], v[100:103]
v_exp_f32 v89, v89
v_smfmac_f32_16x16x64_bf16 a[240:243], v[112:115], v[48:55], v19
buffer_load_dwordx4 v28, s[8:11], s36 offen offset:2048 sc1 lds
v_mfma_f32_16x16x32_bf16 v[144:147], a[96:99], v[48:51], v[144:147]
v_exp_f32 v107, v107
v_mfma_f32_16x16x32_bf16 v[144:147], a[112:115], v[52:55], v[144:147]
s_waitcnt lgkmcnt(0)
v_mfma_f32_16x16x32_bf16 v[148:151], a[100:103], v[48:51], v[148:151]
v_cvt_pk_bf16_f32 v79, v110, v111
v_mfma_f32_16x16x32_bf16 v[148:151], a[116:119], v[52:55], v[148:151]
v_mfma_f32_16x16x32_bf16 v[152:155], a[104:107], v[48:51], v[152:155]
v_exp_f32 v92, v92
v_mfma_f32_16x16x32_bf16 v[152:155], a[120:123], v[52:55], v[152:155]
v_cvt_pk_bf16_f32 v63, v94, v95
v_mfma_f32_16x16x32_bf16 v[156:159], a[108:111], v[48:51], v[156:159]
v_mfma_f32_16x16x32_bf16 v[156:159], a[124:127], v[52:55], v[156:159]
v_smfmac_f32_16x16x64_bf16 a[248:251], v[112:115], v[64:71], v19
buffer_load_dwordx4 v31, s[8:11], s36 offen offset:3072 sc1 lds
v_mfma_f32_16x16x32_bf16 v[208:211], a[96:99], v[64:67], v[208:211]
s_bitset1_b32 m0, 14
v_cvt_pk_bf16_f32 v78, v108, v109
v_mfma_f32_16x16x32_bf16 v[208:211], a[112:115], v[68:71], v[208:211]
v_exp_f32 v104, v104
v_mfma_f32_16x16x32_bf16 v[212:215], a[100:103], v[64:67], v[212:215]
v_mfma_f32_16x16x32_bf16 v[212:215], a[116:119], v[68:71], v[212:215]
v_exp_f32 v105, v105
v_mfma_f32_16x16x32_bf16 v[216:219], a[104:107], v[64:67], v[216:219]
v_cvt_pk_bf16_f32 v60, v88, v89
v_mfma_f32_16x16x32_bf16 v[216:219], a[120:123], v[68:71], v[216:219]
v_cvt_pk_bf16_f32 v62, v92, v93
v_mfma_f32_16x16x32_bf16 v[220:223], a[108:111], v[64:67], v[220:223]
s_sub_u32 s36, s36, s61
v_cvt_pk_bf16_f32 v77, v106, v107
v_cvt_pk_bf16_f32 v76, v104, v105
v_mfma_f32_16x16x32_bf16 v[220:223], a[124:127], v[68:71], v[220:223]
s_cbranch_scc1 kf_kernel_sw_loopAB1
kf_kernel_loopAB1:
v_mfma_f32_16x16x32_bf16 v[88:91], a[64:67], a[16:19], v[36:39]
v_exp_f32 v101, v101
v_mfma_f32_16x16x32_bf16 v[88:91], a[68:71], a[20:23], v[88:91]
v_exp_f32 v99, v99
v_mfma_f32_16x16x32_bf16 v[88:91], a[72:75], a[24:27], v[88:91]
v_exp_f32 v81, v81
v_mfma_f32_16x16x32_bf16 v[88:91], a[76:79], a[28:31], v[88:91]
v_exp_f32 v87, v87
v_mfma_f32_16x16x32_bf16 v[92:95], a[80:83], a[16:19], v[36:39]
v_exp_f32 v84, v84
v_mfma_f32_16x16x32_bf16 v[92:95], a[84:87], a[20:23], v[92:95]
v_exp_f32 v103, v103
v_mfma_f32_16x16x32_bf16 v[92:95], a[88:91], a[24:27], v[92:95]
v_exp_f32 v96, v96
v_mfma_f32_16x16x32_bf16 v[92:95], a[92:95], a[28:31], v[92:95]
v_exp_f32 v91, v91
v_mfma_f32_16x16x32_bf16 v[104:107], a[64:67], a[48:51], v[44:47]
v_exp_f32 v98, v98
v_mfma_f32_16x16x32_bf16 v[104:107], a[68:71], a[52:55], v[104:107]
ds_read_b128 a[64:67], v5 offset:16384
ds_read_b128 a[68:71], v5 offset:17408
v_mfma_f32_16x16x32_bf16 v[104:107], a[72:75], a[56:59], v[104:107]
ds_read_b128 a[72:75], v5 offset:18432
v_mfma_f32_16x16x32_bf16 v[104:107], a[76:79], a[60:63], v[104:107]
ds_read_b128 a[76:79], v5 offset:19456
v_mfma_f32_16x16x32_bf16 v[108:111], a[80:83], a[48:51], v[44:47]
v_exp_f32 v82, v82
v_mfma_f32_16x16x32_bf16 v[108:111], a[84:87], a[52:55], v[108:111]
ds_read_b128 a[80:83], v5 offset:20480
v_mfma_f32_16x16x32_bf16 v[108:111], a[88:91], a[56:59], v[108:111]
ds_read_b128 a[84:87], v5 offset:21504
ds_read_b128 a[88:91], v5 offset:22528
v_mfma_f32_16x16x32_bf16 v[108:111], a[92:95], a[60:63], v[108:111]
v_exp_f32 v85, v85
v_smfmac_f32_16x16x64_bf16 a[244:247], v[112:115], v[56:63], v19
ds_read_b128 a[92:95], v5 offset:23552
v_mfma_f32_16x16x32_bf16 v[176:179], a[96:99], v[56:59], v[176:179]
v_exp_f32 v97, v97
v_mfma_f32_16x16x32_bf16 v[176:179], a[112:115], v[60:63], v[176:179]
v_exp_f32 v80, v80
v_mfma_f32_16x16x32_bf16 v[180:183], a[100:103], v[56:59], v[180:183]
v_mfma_f32_16x16x32_bf16 v[180:183], a[116:119], v[60:63], v[180:183]
v_exp_f32 v83, v83
v_mfma_f32_16x16x32_bf16 v[184:187], a[104:107], v[56:59], v[184:187]
s_waitcnt lgkmcnt(4)
v_exp_f32 v90, v90
v_mfma_f32_16x16x32_bf16 v[184:187], a[120:123], v[60:63], v[184:187]
v_exp_f32 v93, v93
v_mfma_f32_16x16x32_bf16 v[188:191], a[108:111], v[56:59], v[188:191]
v_cvt_pk_bf16_f32 v48, v80, v81
v_mfma_f32_16x16x32_bf16 v[188:191], a[124:127], v[60:63], v[188:191]
v_exp_f32 v102, v102
v_smfmac_f32_16x16x64_bf16 a[252:255], v[112:115], v[72:79], v19
v_exp_f32 v86, v86
v_mfma_f32_16x16x32_bf16 v[240:243], a[96:99], v[72:75], v[240:243]
ds_read_b128 a[96:99], v5 offset:24576
v_mfma_f32_16x16x32_bf16 v[240:243], a[112:115], v[76:79], v[240:243]
v_cvt_pk_bf16_f32 v51, v86, v87
v_cvt_pk_bf16_f32 v50, v84, v85
v_mfma_f32_16x16x32_bf16 v[244:247], a[100:103], v[72:75], v[244:247]
ds_read_b128 a[112:115], v5 offset:28672
ds_read_b128 a[100:103], v5 offset:25600
v_mfma_f32_16x16x32_bf16 v[244:247], a[116:119], v[76:79], v[244:247]
ds_read_b128 a[116:119], v5 offset:29696
v_mfma_f32_16x16x32_bf16 v[248:251], a[104:107], v[72:75], v[248:251]
ds_read_b128 a[104:107], v5 offset:26624
v_cvt_pk_bf16_f32 v49, v82, v83
v_mfma_f32_16x16x32_bf16 v[248:251], a[120:123], v[76:79], v[248:251]
ds_read_b128 a[120:123], v5 offset:30720
v_mfma_f32_16x16x32_bf16 v[252:255], a[108:111], v[72:75], v[252:255]
ds_read_b128 a[108:111], v5 offset:27648
v_mfma_f32_16x16x32_bf16 v[252:255], a[124:127], v[76:79], v[252:255]
s_waitcnt lgkmcnt(7)
ds_read_b128 a[124:127], v5 offset:31744
v_mfma_f32_16x16x32_bf16 v[80:83], a[64:67], a[0:3], v[32:35]
v_exp_f32 v100, v100
v_mfma_f32_16x16x32_bf16 v[80:83], a[68:71], a[4:7], v[80:83]
buffer_load_dwordx4 v6, s[8:11], s36 offen offset:0 sc1 lds
v_mfma_f32_16x16x32_bf16 v[80:83], a[72:75], a[8:11], v[80:83]
v_exp_f32 v105, v105
v_mfma_f32_16x16x32_bf16 v[80:83], a[76:79], a[12:15], v[80:83]
v_mfma_f32_16x16x32_bf16 v[84:87], a[80:83], a[0:3], v[32:35]
v_cvt_pk_bf16_f32 v65, v98, v99
v_cvt_pk_bf16_f32 v64, v96, v97
v_mfma_f32_16x16x32_bf16 v[84:87], a[84:87], a[4:7], v[84:87]
s_waitcnt lgkmcnt(4)
v_mfma_f32_16x16x32_bf16 v[84:87], a[88:91], a[8:11], v[84:87]
v_exp_f32 v111, v111
v_mfma_f32_16x16x32_bf16 v[84:87], a[92:95], a[12:15], v[84:87]
buffer_load_dwordx4 v7, s[8:11], s36 offen offset:1024 sc1 lds
v_mfma_f32_16x16x32_bf16 v[96:99], a[64:67], a[32:35], v[40:43]
v_exp_f32 v88, v88
v_mfma_f32_16x16x32_bf16 v[96:99], a[68:71], a[36:39], v[96:99]
v_exp_f32 v94, v94
v_mfma_f32_16x16x32_bf16 v[96:99], a[72:75], a[40:43], v[96:99]
v_mfma_f32_16x16x32_bf16 v[96:99], a[76:79], a[44:47], v[96:99]
v_cvt_pk_bf16_f32 v67, v102, v103
v_cvt_pk_bf16_f32 v66, v100, v101
v_mfma_f32_16x16x32_bf16 v[100:103], a[80:83], a[32:35], v[40:43]
v_exp_f32 v110, v110
v_mfma_f32_16x16x32_bf16 v[100:103], a[84:87], a[36:39], v[100:103]
v_exp_f32 v106, v106
v_mfma_f32_16x16x32_bf16 v[100:103], a[88:91], a[40:43], v[100:103]
v_exp_f32 v104, v104
v_mfma_f32_16x16x32_bf16 v[100:103], a[92:95], a[44:47], v[100:103]
buffer_load_dwordx4 v28, s[8:11], s36 offen offset:2048 sc1 lds
v_mfma_f32_16x16x32_bf16 v[128:131], a[112:115], v[52:55], v[128:131]
v_exp_f32 v89, v89
v_mfma_f32_16x16x32_bf16 v[128:131], a[96:99], v[48:51], v[128:131]
v_exp_f32 v95, v95
v_mfma_f32_16x16x32_bf16 v[132:135], a[116:119], v[52:55], v[132:135]
s_waitcnt lgkmcnt(0)
v_exp_f32 v107, v107
v_mfma_f32_16x16x32_bf16 v[132:135], a[100:103], v[48:51], v[132:135]
v_exp_f32 v108, v108
v_mfma_f32_16x16x32_bf16 v[136:139], a[120:123], v[52:55], v[136:139]
v_cvt_pk_bf16_f32 v59, v94, v95
v_mfma_f32_16x16x32_bf16 v[136:139], a[104:107], v[48:51], v[136:139]
v_cvt_pk_bf16_f32 v75, v110, v111
v_mfma_f32_16x16x32_bf16 v[140:143], a[124:127], v[52:55], v[140:143]
v_cvt_pk_bf16_f32 v73, v106, v107
v_mfma_f32_16x16x32_bf16 v[140:143], a[108:111], v[48:51], v[140:143]
buffer_load_dwordx4 v31, s[8:11], s36 offen offset:3072 sc1 lds
v_mfma_f32_16x16x32_bf16 v[192:195], a[112:115], v[68:71], v[192:195]
s_and_b32 m0, s39, 0x1ffff
v_exp_f32 v109, v109
v_mfma_f32_16x16x32_bf16 v[192:195], a[96:99], v[64:67], v[192:195]
s_sub_u32 s36, s36, s61
s_add_u32 s39, s39, 0x1008000
v_cvt_pk_bf16_f32 v57, v90, v91
v_mfma_f32_16x16x32_bf16 v[196:199], a[116:119], v[68:71], v[196:199]
v_and_or_b32 v5, s39, v20, v4
v_mfma_f32_16x16x32_bf16 v[196:199], a[100:103], v[64:67], v[196:199]
v_cvt_pk_bf16_f32 v74, v108, v109
v_cvt_pk_bf16_f32 v72, v104, v105
v_mfma_f32_16x16x32_bf16 v[200:203], a[120:123], v[68:71], v[200:203]
v_mfma_f32_16x16x32_bf16 v[200:203], a[104:107], v[64:67], v[200:203]
v_exp_f32 v92, v92
v_mfma_f32_16x16x32_bf16 v[204:207], a[124:127], v[68:71], v[204:207]
v_cvt_pk_bf16_f32 v58, v92, v93
v_cvt_pk_bf16_f32 v56, v88, v89
v_mfma_f32_16x16x32_bf16 v[204:207], a[108:111], v[64:67], v[204:207]
s_cbranch_scc0 kf_kernel_loopAB
kf_kernel_loopABx:
s_branch kf_kernel_hA
kf_kernel_drain:
s_waitcnt vmcnt(16)
v_mfma_f32_16x16x32_bf16 v[128:131], a[64:67], v[52:55], v[128:131]
s_and_b32 s29, s22, 1
s_lshl_b32 s29, s29, 16
v_mfma_f32_16x16x32_bf16 v[132:135], a[68:71], v[52:55], v[132:135]
s_barrier
v_mfma_f32_16x16x32_bf16 v[136:139], a[72:75], v[52:55], v[136:139]
v_accvgpr_read_b32 v33, a241
v_mfma_f32_16x16x32_bf16 v[140:143], a[76:79], v[52:55], v[140:143]
s_add_u32 s12, s29, s28
s_xor_b32 s13, s12, 0x10000
v_accvgpr_read_b32 v40, a248
v_mfma_f32_16x16x32_bf16 v[192:195], a[64:67], v[68:71], v[192:195]
s_add_u32 s29, s35, 0xfffffc00
s_add_u32 m0, s13, 49152
v_mfma_f32_16x16x32_bf16 v[196:199], a[68:71], v[68:71], v[196:199]
buffer_load_dwordx4 v21, s[44:47], s29 offen offset:0 lds
v_mfma_f32_16x16x32_bf16 v[200:203], a[72:75], v[68:71], v[200:203]
v_lshlrev_b32 v117, 16, v117
v_mfma_f32_16x16x32_bf16 v[204:207], a[76:79], v[68:71], v[204:207]
buffer_load_dwordx4 v22, s[44:47], s29 offen offset:1024 lds
v_smfmac_f32_16x16x64_bf16 a[244:247], v[112:115], v[56:63], v19
v_accvgpr_read_b32 v32, a240
v_smfmac_f32_16x16x64_bf16 a[252:255], v[112:115], v[72:79], v19
buffer_load_dwordx4 v23, s[44:47], s29 offen offset:2048 lds
v_mfma_f32_16x16x32_bf16 v[160:163], a[64:67], v[60:63], v[160:163]
v_lshlrev_b32 v116, 16, v116
v_mfma_f32_16x16x32_bf16 v[164:167], a[68:71], v[60:63], v[164:167]
v_mfma_f32_16x16x32_bf16 v[168:171], a[72:75], v[60:63], v[168:171]
v_accvgpr_read_b32 v41, a249
v_add_f32 v40, v40, v41
v_mfma_f32_16x16x32_bf16 v[172:175], a[76:79], v[60:63], v[172:175]
v_mfma_f32_16x16x32_bf16 v[176:179], a[96:99], v[56:59], v[176:179]
v_mfma_f32_16x16x32_bf16 v[176:179], a[112:115], v[60:63], v[176:179]
buffer_load_dwordx4 v24, s[44:47], s29 offen offset:3072 lds
v_mfma_f32_16x16x32_bf16 v[180:183], a[100:103], v[56:59], v[180:183]
s_add_u32 m0, s12, 0
v_lshlrev_b32 v119, 16, v119
v_accvgpr_read_b32 v44, a252
v_mfma_f32_16x16x32_bf16 v[180:183], a[116:119], v[60:63], v[180:183]
v_add_f32 v32, v32, v33
v_accvgpr_read_b32 v36, a244
v_mfma_f32_16x16x32_bf16 v[184:187], a[104:107], v[56:59], v[184:187]
s_add_u32 s29, s35, 0xfffffb80
v_max_f32 v18, v32, v40
v_cmp_u_f32 s[16:17], v32, v40
v_mfma_f32_16x16x32_bf16 v[184:187], a[120:123], v[60:63], v[184:187]
buffer_load_dwordx4 v21, s[44:47], s29 offen offset:0 lds
v_mfma_f32_16x16x32_bf16 v[188:191], a[108:111], v[56:59], v[188:191]
v_accvgpr_read_b32 v45, a253
v_mfma_f32_16x16x32_bf16 v[188:191], a[124:127], v[60:63], v[188:191]
v_accvgpr_read_b32 v37, a245
v_add_f32 v36, v36, v37
v_mfma_f32_16x16x32_bf16 v[224:227], a[64:67], v[76:79], v[224:227]
v_mfma_f32_16x16x32_bf16 v[228:231], a[68:71], v[76:79], v[228:231]
v_mfma_f32_16x16x32_bf16 v[232:235], a[72:75], v[76:79], v[232:235]
buffer_load_dwordx4 v22, s[44:47], s29 offen offset:1024 lds
v_mfma_f32_16x16x32_bf16 v[236:239], a[76:79], v[76:79], v[236:239]
v_add_f32 v44, v44, v45
v_mfma_f32_16x16x32_bf16 v[240:243], a[96:99], v[72:75], v[240:243]
v_max3_f32 v18, v18, v36, v44
v_cmp_lt_f32 vcc, s56, v18
v_mfma_f32_16x16x32_bf16 v[240:243], a[112:115], v[76:79], v[240:243]
buffer_load_dwordx4 v23, s[44:47], s29 offen offset:2048 lds
v_mfma_f32_16x16x32_bf16 v[244:247], a[100:103], v[72:75], v[244:247]
v_cmp_u_f32 s[58:59], v36, v44
v_lshlrev_b32 v118, 16, v118
v_mfma_f32_16x16x32_bf16 v[244:247], a[116:119], v[76:79], v[244:247]
v_mfma_f32_16x16x32_bf16 v[248:251], a[104:107], v[72:75], v[248:251]
s_or_b64 s[16:17], s[16:17], s[58:59]
v_mfma_f32_16x16x32_bf16 v[248:251], a[120:123], v[76:79], v[248:251]
buffer_load_dwordx4 v24, s[44:47], s29 offen offset:3072 lds
v_mfma_f32_16x16x32_bf16 v[252:255], a[108:111], v[72:75], v[252:255]
s_add_u32 s14, s28, 0x20000
s_or_b64 vcc, vcc, s[16:17]
v_mfma_f32_16x16x32_bf16 v[252:255], a[124:127], v[76:79], v[252:255]
s_cbranch_vccnz kf_kernel_slow
kf_kernel_fin:
s_bfe_u32 s3, s23, 0x10002
s_and_b32 s60, s23, 1
s_lshl1_add_u32 s3, s3, s60
s_load_dwordx2 s[56:57], s[0:1], 88
v_rcp_f32 v32, v32
v_rcp_f32 v40, v40
v_rcp_f32 v36, v36
v_rcp_f32 v44, v44
s_cmp_eq_u32 s3, 1
s_cbranch_scc1 kf_kernel_f1
s_cmp_eq_u32 s3, 2
s_cbranch_scc1 kf_kernel_f2
s_cmp_eq_u32 s3, 3
s_cbranch_scc1 kf_kernel_f3
kf_kernel_f0:
v_pk_mul_f32 v[156:157], v[156:157], v[32:33] op_sel_hi:[1,0]
v_pk_mul_f32 v[172:173], v[172:173], v[36:37] op_sel_hi:[1,0]
v_pk_mul_f32 v[154:155], v[154:155], v[32:33] op_sel_hi:[1,0]
v_pk_mul_f32 v[136:137], v[136:137], v[32:33] op_sel_hi:[1,0]
v_pk_mul_f32 v[164:165], v[164:165], v[36:37] op_sel_hi:[1,0]
s_sub_u32 s34, s33, 28672
v_pk_mul_f32 v[132:133], v[132:133], v[32:33] op_sel_hi:[1,0]
v_pk_mul_f32 v[130:131], v[130:131], v[32:33] op_sel_hi:[1,0]
v_pk_mul_f32 v[162:163], v[162:163], v[36:37] op_sel_hi:[1,0]
v_pk_mul_f32 v[142:143], v[142:143], v[32:33] op_sel_hi:[1,0]
s_add_u32 s16, s4, 416
buffer_load_dwordx4 a[240:243], v4, s[40:43], s34 offen offset:0 sc1
buffer_load_dwordx4 a[244:247], v4, s[40:43], s34 offen offset:1024 sc1
buffer_load_dwordx4 a[248:251], v4, s[40:43], s34 offen offset:2048 sc1
buffer_load_dwordx4 a[252:255], v4, s[40:43], s34 offen offset:3072 sc1
v_pk_mul_f32 v[152:153], v[152:153], v[32:33] op_sel_hi:[1,0]
v_pk_mul_f32 v[184:185], v[184:185], v[36:37] op_sel_hi:[1,0]
v_pk_mul_f32 v[144:145], v[144:145], v[32:33] op_sel_hi:[1,0]
v_pk_mul_f32 v[160:161], v[160:161], v[36:37] op_sel_hi:[1,0]
v_pk_mul_f32 v[128:129], v[128:129], v[32:33] op_sel_hi:[1,0]
v_pk_mul_f32 v[168:169], v[168:169], v[36:37] op_sel_hi:[1,0]
v_pk_mul_f32 v[166:167], v[166:167], v[36:37] op_sel_hi:[1,0]
v_cvt_pk_bf16_f32 v128, v128, v129
v_cvt_pk_bf16_f32 v129, v130, v131
v_pk_mul_f32 v[176:177], v[176:177], v[36:37] op_sel_hi:[1,0]
v_pk_mul_f32 v[134:135], v[134:135], v[32:33] op_sel_hi:[1,0]
s_sub_u32 s34, s33, 32768
v_pk_mul_f32 v[186:187], v[186:187], v[36:37] op_sel_hi:[1,0]
v_pk_mul_f32 v[170:171], v[170:171], v[36:37] op_sel_hi:[1,0]
v_pk_mul_f32 v[150:151], v[150:151], v[32:33] op_sel_hi:[1,0]
s_lshl_b32 s16, s16, 5
v_cvt_pk_bf16_f32 v131, v134, v135
v_cvt_pk_bf16_f32 v135, v142, v143
v_cvt_pk_bf16_f32 v142, v156, v157
v_pk_mul_f32 v[140:141], v[140:141], v[32:33] op_sel_hi:[1,0]
v_cvt_pk_bf16_f32 v130, v132, v133
s_add_u32 s16, s16, s21
s_add_u32 s60, s30, 416
s_lshl_b32 s60, s60, 5
buffer_load_dwordx4 a[80:83], v4, s[40:43], s34 offen offset:0 sc1
buffer_load_dwordx4 a[84:87], v4, s[40:43], s34 offen offset:1024 sc1
buffer_load_dwordx4 a[88:91], v4, s[40:43], s34 offen offset:2048 sc1
v_cvt_pk_bf16_f32 v157, v186, v187
v_pk_mul_f32 v[158:159], v[158:159], v[32:33] op_sel_hi:[1,0]
v_pk_mul_f32 v[182:183], v[182:183], v[36:37] op_sel_hi:[1,0]
v_cvt_pk_bf16_f32 v132, v136, v137
v_pk_mul_f32 v[138:139], v[138:139], v[32:33] op_sel_hi:[1,0]
v_cvt_pk_bf16_f32 v134, v140, v141
v_pk_mul_f32 v[178:179], v[178:179], v[36:37] op_sel_hi:[1,0]
v_cvt_pk_bf16_f32 v140, v152, v153
v_cvt_pk_bf16_f32 v133, v138, v139
v_pk_mul_f32 v[148:149], v[148:149], v[32:33] op_sel_hi:[1,0]
s_add_u32 s60, s60, s21
v_cvt_pk_bf16_f32 v138, v148, v149
v_cvt_pk_bf16_f32 v148, v168, v169
v_cvt_pk_bf16_f32 v152, v176, v177
v_pk_mul_f32 v[168:169], v[216:217], v[40:41] op_sel_hi:[1,0]
v_cvt_pk_bf16_f32 v136, v144, v145
v_cvt_pk_bf16_f32 v144, v160, v161
v_pk_mul_f32 v[174:175], v[174:175], v[36:37] op_sel_hi:[1,0]
v_pk_mul_f32 v[146:147], v[146:147], v[32:33] op_sel_hi:[1,0]
v_cvt_pk_bf16_f32 v141, v154, v155
v_cvt_pk_bf16_f32 v149, v170, v171
v_cvt_pk_bf16_f32 v143, v158, v159
s_lshl_b32 s60, s60, 12
v_cvt_pk_bf16_f32 v156, v184, v185
v_cvt_pk_bf16_f32 v137, v146, v147
v_cvt_pk_bf16_f32 v145, v162, v163
v_pk_mul_f32 v[204:205], v[204:205], v[40:41] op_sel_hi:[1,0]
v_pk_mul_f32 v[190:191], v[190:191], v[36:37] op_sel_hi:[1,0]
v_pk_mul_f32 v[170:171], v[218:219], v[40:41] op_sel_hi:[1,0]
v_cvt_pk_bf16_f32 v146, v164, v165
v_pk_mul_f32 v[180:181], v[180:181], v[36:37] op_sel_hi:[1,0]
v_pk_mul_f32 v[184:185], v[232:233], v[44:45] op_sel_hi:[1,0]
v_cvt_pk_bf16_f32 v139, v150, v151
v_cvt_pk_bf16_f32 v150, v172, v173
v_cvt_pk_bf16_f32 v153, v178, v179
v_pk_mul_f32 v[172:173], v[220:221], v[40:41] op_sel_hi:[1,0]
v_cvt_pk_bf16_f32 v151, v174, v175
v_cvt_pk_bf16_f32 v147, v166, v167
v_cvt_pk_bf16_f32 v159, v190, v191
v_pk_mul_f32 v[176:177], v[224:225], v[44:45] op_sel_hi:[1,0]
v_pk_mul_f32 v[174:175], v[222:223], v[40:41] op_sel_hi:[1,0]
v_cvt_pk_bf16_f32 v220, v168, v169
v_cvt_pk_bf16_f32 v154, v180, v181
v_pk_mul_f32 v[188:189], v[188:189], v[36:37] op_sel_hi:[1,0]
v_pk_mul_f32 v[194:195], v[194:195], v[40:41] op_sel_hi:[1,0]
v_pk_mul_f32 v[242:243], v[242:243], v[44:45] op_sel_hi:[1,0]
v_pk_mul_f32 v[178:179], v[226:227], v[44:45] op_sel_hi:[1,0]
v_pk_mul_f32 v[196:197], v[196:197], v[40:41] op_sel_hi:[1,0]
v_pk_mul_f32 v[180:181], v[228:229], v[44:45] op_sel_hi:[1,0]
v_pk_mul_f32 v[244:245], v[244:245], v[44:45] op_sel_hi:[1,0]
v_pk_mul_f32 v[246:247], v[246:247], v[44:45] op_sel_hi:[1,0]
v_cvt_pk_bf16_f32 v158, v188, v189
v_cvt_pk_bf16_f32 v228, v184, v185
v_pk_mul_f32 v[186:187], v[234:235], v[44:45] op_sel_hi:[1,0]
v_pk_mul_f32 v[162:163], v[210:211], v[40:41] op_sel_hi:[1,0]
s_lshl_b32 s16, s16, 12
s_xor_b32 s17, s16, 0x20000
ds_read_b128 a[0:3], v8 offset:16384
buffer_load_dwordx4 a[92:95], v4, s[40:43], s34 offen offset:3072 sc1
buffer_store_dwordx4 v[128:131], v4, s[40:43], s60 offen offset:0 sc1
buffer_store_dwordx4 v[132:135], v4, s[40:43], s60 offen offset:1024 sc1
ds_read_b128 a[4:7], v9 offset:16384
ds_read_b128 a[8:11], v8 offset:18432
ds_read_b128 a[12:15], v9 offset:18432
ds_read_b128 a[16:19], v8 offset:20480
ds_read_b128 a[20:23], v9 offset:20480
v_cvt_pk_bf16_f32 v234, v244, v245
v_cvt_pk_bf16_f32 v229, v186, v187
v_pk_mul_f32 v[198:199], v[198:199], v[40:41] op_sel_hi:[1,0]
v_pk_mul_f32 v[166:167], v[214:215], v[40:41] op_sel_hi:[1,0]
v_cvt_pk_bf16_f32 v155, v182, v183
v_pk_mul_f32 v[164:165], v[212:213], v[40:41] op_sel_hi:[1,0]
v_pk_mov_b32 v[100:101], v[118:119], v[118:119] op_sel:[1,1]
v_pk_mul_f32 v[240:241], v[240:241], v[44:45] op_sel_hi:[1,0]
v_pk_mul_f32 v[254:255], v[254:255], v[44:45] op_sel_hi:[1,0]
v_pk_mul_f32 v[188:189], v[236:237], v[44:45] op_sel_hi:[1,0]
v_cvt_pk_bf16_f32 v221, v170, v171
v_cvt_pk_bf16_f32 v233, v242, v243
v_pk_mul_f32 v[200:201], v[200:201], v[40:41] op_sel_hi:[1,0]
v_pk_mul_f32 v[160:161], v[208:209], v[40:41] op_sel_hi:[1,0]
v_pk_mul_f32 v[248:249], v[248:249], v[44:45] op_sel_hi:[1,0]
v_cvt_pk_bf16_f32 v232, v240, v241
v_pk_mul_f32 v[182:183], v[230:231], v[44:45] op_sel_hi:[1,0]
v_cvt_pk_bf16_f32 v225, v178, v179
v_pk_mov_b32 v[54:55], v[116:117], v[116:117] op_sel:[0,0]
v_pk_mul_f32 v[202:203], v[202:203], v[40:41] op_sel_hi:[1,0]
v_cvt_pk_bf16_f32 v213, v202, v203
v_cvt_pk_bf16_f32 v212, v200, v201
v_cvt_pk_bf16_f32 v211, v198, v199
v_cvt_pk_bf16_f32 v223, v174, v175
v_cvt_pk_bf16_f32 v216, v160, v161
v_pk_mul_f32 v[190:191], v[238:239], v[44:45] op_sel_hi:[1,0]
v_pk_mov_b32 v[84:85], v[118:119], v[118:119] op_sel:[0,0]
v_pk_mul_f32 v[250:251], v[250:251], v[44:45] op_sel_hi:[1,0]
v_pk_mul_f32 v[192:193], v[192:193], v[40:41] op_sel_hi:[1,0]
v_cvt_pk_bf16_f32 v208, v192, v193
v_cvt_pk_bf16_f32 v222, v172, v173
v_cvt_pk_bf16_f32 v209, v194, v195
v_cvt_pk_bf16_f32 v219, v166, v167
v_cvt_pk_bf16_f32 v210, v196, v197
v_pk_mov_b32 v[68:69], v[116:117], v[116:117] op_sel:[1,1]
v_cvt_pk_bf16_f32 v217, v162, v163
v_pk_mov_b32 v[70:71], v[116:117], v[116:117] op_sel:[1,1]
v_cvt_pk_bf16_f32 v227, v182, v183
v_cvt_pk_bf16_f32 v239, v254, v255
v_cvt_pk_bf16_f32 v230, v188, v189
buffer_store_dwordx4 v[136:139], v4, s[40:43], s60 offen offset:2048 sc1
ds_read_b128 a[24:27], v8 offset:22528
buffer_store_dwordx4 v[140:143], v4, s[40:43], s60 offen offset:3072 sc1
s_add_u32 s60, s60, 131072
ds_read_b128 a[28:31], v9 offset:22528
buffer_store_dwordx4 v[144:147], v4, s[40:43], s60 offen offset:0 sc1
buffer_store_dwordx4 v[148:151], v4, s[40:43], s60 offen offset:1024 sc1
buffer_store_dwordx4 v[152:155], v4, s[40:43], s60 offen offset:2048 sc1
buffer_store_dwordx4 v[156:159], v4, s[40:43], s60 offen offset:3072 sc1
v_pk_mov_b32 v[52:53], v[116:117], v[116:117] op_sel:[0,0]
v_cvt_pk_bf16_f32 v226, v180, v181
v_pk_mov_b32 v[86:87], v[118:119], v[118:119] op_sel:[0,0]
v_cvt_pk_bf16_f32 v214, v204, v205
v_pk_mul_f32 v[206:207], v[206:207], v[40:41] op_sel_hi:[1,0]
v_cvt_pk_bf16_f32 v224, v176, v177
v_pk_mov_b32 v[102:103], v[118:119], v[118:119] op_sel:[1,1]
v_cvt_pk_bf16_f32 v235, v246, v247
v_cvt_pk_bf16_f32 v231, v190, v191
v_cvt_pk_bf16_f32 v236, v248, v249
v_cvt_pk_bf16_f32 v215, v206, v207
v_pk_mul_f32 v[252:253], v[252:253], v[44:45] op_sel_hi:[1,0]
v_cvt_pk_bf16_f32 v238, v252, v253
v_cvt_pk_bf16_f32 v237, v250, v251
v_cvt_pk_bf16_f32 v218, v164, v165
s_branch kf_kernel_fx
kf_kernel_f1:
v_pk_mul_f32 v[204:205], v[204:205], v[40:41] op_sel_hi:[1,0]
v_pk_mul_f32 v[200:201], v[200:201], v[40:41] op_sel_hi:[1,0]
v_pk_mul_f32 v[232:233], v[232:233], v[44:45] op_sel_hi:[1,0]
v_pk_mul_f32 v[220:221], v[220:221], v[40:41] op_sel_hi:[1,0]
v_pk_mul_f32 v[194:195], v[194:195], v[40:41] op_sel_hi:[1,0]
v_pk_mul_f32 v[96:97], v[144:145], v[32:33] op_sel_hi:[1,0]
v_pk_mul_f32 v[80:81], v[128:129], v[32:33] op_sel_hi:[1,0]
v_pk_mul_f32 v[212:213], v[212:213], v[40:41] op_sel_hi:[1,0]
v_pk_mul_f32 v[82:83], v[130:131], v[32:33] op_sel_hi:[1,0]
v_pk_mul_f32 v[84:85], v[132:133], v[32:33] op_sel_hi:[1,0]
v_pk_mul_f32 v[100:101], v[148:149], v[32:33] op_sel_hi:[1,0]
s_sub_u32 s34, s33, 28672
buffer_load_dwordx4 a[240:243], v4, s[40:43], s34 offen offset:0 sc1
buffer_load_dwordx4 a[244:247], v4, s[40:43], s34 offen offset:1024 sc1
buffer_load_dwordx4 a[248:251], v4, s[40:43], s34 offen offset:2048 sc1
buffer_load_dwordx4 a[252:255], v4, s[40:43], s34 offen offset:3072 sc1
s_add_u32 s16, s4, 416
v_pk_mul_f32 v[236:237], v[236:237], v[44:45] op_sel_hi:[1,0]
v_pk_mul_f32 v[192:193], v[192:193], v[40:41] op_sel_hi:[1,0]
v_pk_mul_f32 v[218:219], v[218:219], v[40:41] op_sel_hi:[1,0]
v_pk_mul_f32 v[244:245], v[244:245], v[44:45] op_sel_hi:[1,0]
v_pk_mul_f32 v[234:235], v[234:235], v[44:45] op_sel_hi:[1,0]
v_pk_mul_f32 v[90:91], v[138:139], v[32:33] op_sel_hi:[1,0]
s_sub_u32 s34, s33, 32768
buffer_load_dwordx4 a[80:83], v4, s[40:43], s34 offen offset:0 sc1
buffer_load_dwordx4 a[84:87], v4, s[40:43], s34 offen offset:1024 sc1
buffer_load_dwordx4 a[88:91], v4, s[40:43], s34 offen offset:2048 sc1
buffer_load_dwordx4 a[92:95], v4, s[40:43], s34 offen offset:3072 sc1
s_add_u32 s60, s31, 416
v_pk_mul_f32 v[246:247], v[246:247], v[44:45] op_sel_hi:[1,0]
v_pk_mul_f32 v[248:249], v[248:249], v[44:45] op_sel_hi:[1,0]
s_lshl_b32 s16, s16, 5
s_lshl_b32 s60, s60, 5
v_pk_mul_f32 v[106:107], v[154:155], v[32:33] op_sel_hi:[1,0]
v_pk_mul_f32 v[228:229], v[228:229], v[44:45] op_sel_hi:[1,0]
v_pk_mul_f32 v[86:87], v[134:135], v[32:33] op_sel_hi:[1,0]
v_pk_mul_f32 v[202:203], v[202:203], v[40:41] op_sel_hi:[1,0]
v_cvt_pk_bf16_f32 v148, v232, v233
v_pk_mul_f32 v[88:89], v[136:137], v[32:33] op_sel_hi:[1,0]
s_add_u32 s60, s60, s21
v_pk_mul_f32 v[98:99], v[146:147], v[32:33] op_sel_hi:[1,0]
v_pk_mul_f32 v[196:197], v[196:197], v[40:41] op_sel_hi:[1,0]
v_cvt_pk_bf16_f32 v133, v202, v203
v_pk_mul_f32 v[92:93], v[140:141], v[32:33] op_sel_hi:[1,0]
v_pk_mul_f32 v[108:109], v[156:157], v[32:33] op_sel_hi:[1,0]
v_pk_mul_f32 v[104:105], v[152:153], v[32:33] op_sel_hi:[1,0]
s_add_u32 s16, s16, s21
v_cvt_pk_bf16_f32 v154, v244, v245
v_pk_mul_f32 v[102:103], v[150:151], v[32:33] op_sel_hi:[1,0]
v_pk_mul_f32 v[94:95], v[142:143], v[32:33] op_sel_hi:[1,0]
v_pk_mul_f32 v[254:255], v[254:255], v[44:45] op_sel_hi:[1,0]
v_cvt_pk_bf16_f32 v138, v212, v213
v_cvt_pk_bf16_f32 v149, v234, v235
v_pk_mul_f32 v[224:225], v[224:225], v[44:45] op_sel_hi:[1,0]
v_pk_mul_f32 v[198:199], v[198:199], v[40:41] op_sel_hi:[1,0]
v_cvt_pk_bf16_f32 v134, v204, v205
v_pk_mul_f32 v[110:111], v[158:159], v[32:33] op_sel_hi:[1,0]
v_cvt_pk_bf16_f32 v159, v254, v255
v_pk_mul_f32 v[210:211], v[210:211], v[40:41] op_sel_hi:[1,0]
v_pk_mul_f32 v[208:209], v[208:209], v[40:41] op_sel_hi:[1,0]
v_pk_mul_f32 v[222:223], v[222:223], v[40:41] op_sel_hi:[1,0]
v_pk_mul_f32 v[250:251], v[250:251], v[44:45] op_sel_hi:[1,0]
v_pk_mul_f32 v[230:231], v[230:231], v[44:45] op_sel_hi:[1,0]
v_cvt_pk_bf16_f32 v136, v208, v209
v_pk_mul_f32 v[240:241], v[240:241], v[44:45] op_sel_hi:[1,0]
v_cvt_pk_bf16_f32 v130, v196, v197
v_pk_mul_f32 v[242:243], v[242:243], v[44:45] op_sel_hi:[1,0]
v_cvt_pk_bf16_f32 v131, v198, v199
s_lshl_b32 s60, s60, 12
v_cvt_pk_bf16_f32 v155, v246, v247
v_cvt_pk_bf16_f32 v153, v242, v243
v_cvt_pk_bf16_f32 v141, v218, v219
v_cvt_pk_bf16_f32 v219, v102, v103
v_cvt_pk_bf16_f32 v142, v220, v221
v_pk_mul_f32 v[172:173], v[172:173], v[36:37] op_sel_hi:[1,0]
v_cvt_pk_bf16_f32 v128, v192, v193
v_pk_mul_f32 v[214:215], v[214:215], v[40:41] op_sel_hi:[1,0]
v_pk_mul_f32 v[162:163], v[162:163], v[36:37] op_sel_hi:[1,0]
v_cvt_pk_bf16_f32 v132, v200, v201
v_cvt_pk_bf16_f32 v137, v210, v211
v_cvt_pk_bf16_f32 v129, v194, v195
v_pk_mul_f32 v[206:207], v[206:207], v[40:41] op_sel_hi:[1,0]
v_pk_mul_f32 v[176:177], v[176:177], v[36:37] op_sel_hi:[1,0]
v_pk_mul_f32 v[174:175], v[174:175], v[36:37] op_sel_hi:[1,0]
v_pk_mul_f32 v[168:169], v[168:169], v[36:37] op_sel_hi:[1,0]
v_cvt_pk_bf16_f32 v211, v86, v87
v_pk_mul_f32 v[226:227], v[226:227], v[44:45] op_sel_hi:[1,0]
v_cvt_pk_bf16_f32 v152, v240, v241
v_pk_mul_f32 v[166:167], v[166:167], v[36:37] op_sel_hi:[1,0]
v_cvt_pk_bf16_f32 v213, v90, v91
v_cvt_pk_bf16_f32 v150, v236, v237
s_lshl_b32 s16, s16, 12
s_xor_b32 s17, s16, 0x20000
ds_read_b128 a[0:3], v8 offset:16384
ds_read_b128 a[4:7], v9 offset:16384
ds_read_b128 a[8:11], v8 offset:18432
v_cvt_pk_bf16_f32 v143, v222, v223
v_cvt_pk_bf16_f32 v135, v206, v207
v_pk_mul_f32 v[238:239], v[238:239], v[44:45] op_sel_hi:[1,0]
v_pk_mul_f32 v[178:179], v[178:179], v[36:37] op_sel_hi:[1,0]
v_pk_mul_f32 v[216:217], v[216:217], v[40:41] op_sel_hi:[1,0]
v_cvt_pk_bf16_f32 v223, v110, v111
v_pk_mul_f32 v[182:183], v[182:183], v[36:37] op_sel_hi:[1,0]
v_cvt_pk_bf16_f32 v210, v84, v85
v_pk_mul_f32 v[180:181], v[180:181], v[36:37] op_sel_hi:[1,0]
v_pk_mul_f32 v[188:189], v[188:189], v[36:37] op_sel_hi:[1,0]
v_pk_mul_f32 v[160:161], v[160:161], v[36:37] op_sel_hi:[1,0]
v_cvt_pk_bf16_f32 v140, v216, v217
v_cvt_pk_bf16_f32 v146, v228, v229
v_cvt_pk_bf16_f32 v139, v214, v215
v_pk_mov_b32 v[70:71], v[116:117], v[116:117] op_sel:[1,1]
v_pk_mov_b32 v[52:53], v[116:117], v[116:117] op_sel:[0,0]
v_pk_mov_b32 v[86:87], v[118:119], v[118:119] op_sel:[0,0]
v_cvt_pk_bf16_f32 v208, v80, v81
v_cvt_pk_bf16_f32 v145, v226, v227
ds_read_b128 a[12:15], v9 offset:18432
buffer_store_dwordx4 v[128:131], v4, s[40:43], s60 offen offset:0 sc1
buffer_store_dwordx4 v[132:135], v4, s[40:43], s60 offen offset:1024 sc1
ds_read_b128 a[16:19], v8 offset:20480
buffer_store_dwordx4 v[136:139], v4, s[40:43], s60 offen offset:2048 sc1
buffer_store_dwordx4 v[140:143], v4, s[40:43], s60 offen offset:3072 sc1
ds_read_b128 a[20:23], v9 offset:20480
ds_read_b128 a[24:27], v8 offset:22528
ds_read_b128 a[28:31], v9 offset:22528
v_pk_mul_f32 v[164:165], v[164:165], v[36:37] op_sel_hi:[1,0]
v_cvt_pk_bf16_f32 v217, v98, v99
v_cvt_pk_bf16_f32 v212, v88, v89
v_cvt_pk_bf16_f32 v144, v224, v225
v_pk_mul_f32 v[184:185], v[184:185], v[36:37] op_sel_hi:[1,0]
v_pk_mul_f32 v[252:253], v[252:253], v[44:45] op_sel_hi:[1,0]
v_pk_mov_b32 v[54:55], v[116:117], v[116:117] op_sel:[0,0]
v_cvt_pk_bf16_f32 v222, v108, v109
v_cvt_pk_bf16_f32 v218, v100, v101
v_pk_mov_b32 v[100:101], v[118:119], v[118:119] op_sel:[1,1]
v_pk_mov_b32 v[102:103], v[118:119], v[118:119] op_sel:[1,1]
v_cvt_pk_bf16_f32 v216, v96, v97
v_cvt_pk_bf16_f32 v209, v82, v83
v_cvt_pk_bf16_f32 v224, v160, v161
v_pk_mul_f32 v[170:171], v[170:171], v[36:37] op_sel_hi:[1,0]
v_cvt_pk_bf16_f32 v235, v182, v183
v_cvt_pk_bf16_f32 v151, v238, v239
v_cvt_pk_bf16_f32 v157, v250, v251
v_cvt_pk_bf16_f32 v234, v180, v181
v_cvt_pk_bf16_f32 v220, v104, v105
v_pk_mul_f32 v[190:191], v[190:191], v[36:37] op_sel_hi:[1,0]
v_cvt_pk_bf16_f32 v147, v230, v231
v_cvt_pk_bf16_f32 v158, v252, v253
v_cvt_pk_bf16_f32 v228, v168, v169
v_cvt_pk_bf16_f32 v230, v172, v173
v_cvt_pk_bf16_f32 v231, v174, v175
v_cvt_pk_bf16_f32 v233, v178, v179
v_cvt_pk_bf16_f32 v239, v190, v191
v_pk_mov_b32 v[68:69], v[116:117], v[116:117] op_sel:[1,1]
v_cvt_pk_bf16_f32 v236, v184, v185
v_cvt_pk_bf16_f32 v227, v166, v167
v_cvt_pk_bf16_f32 v226, v164, v165
v_cvt_pk_bf16_f32 v229, v170, v171
v_cvt_pk_bf16_f32 v225, v162, v163
v_cvt_pk_bf16_f32 v156, v248, v249
v_pk_mul_f32 v[186:187], v[186:187], v[36:37] op_sel_hi:[1,0]
v_pk_mov_b32 v[84:85], v[118:119], v[118:119] op_sel:[0,0]
v_cvt_pk_bf16_f32 v221, v106, v107
v_cvt_pk_bf16_f32 v232, v176, v177
v_cvt_pk_bf16_f32 v238, v188, v189
s_add_u32 s60, s60, 131072
buffer_store_dwordx4 v[144:147], v4, s[40:43], s60 offen offset:0 sc1
buffer_store_dwordx4 v[148:151], v4, s[40:43], s60 offen offset:1024 sc1
buffer_store_dwordx4 v[152:155], v4, s[40:43], s60 offen offset:2048 sc1
buffer_store_dwordx4 v[156:159], v4, s[40:43], s60 offen offset:3072 sc1
v_cvt_pk_bf16_f32 v237, v186, v187
v_cvt_pk_bf16_f32 v214, v92, v93
v_cvt_pk_bf16_f32 v215, v94, v95
s_branch kf_kernel_fx
kf_kernel_f2:
v_pk_mul_f32 v[130:131], v[130:131], v[32:33] op_sel_hi:[1,0]
v_pk_mul_f32 v[158:159], v[158:159], v[32:33] op_sel_hi:[1,0]
v_pk_mul_f32 v[138:139], v[138:139], v[32:33] op_sel_hi:[1,0]
v_pk_mul_f32 v[144:145], v[144:145], v[32:33] op_sel_hi:[1,0]
v_pk_mul_f32 v[184:185], v[184:185], v[36:37] op_sel_hi:[1,0]
v_pk_mul_f32 v[132:133], v[132:133], v[32:33] op_sel_hi:[1,0]
v_pk_mul_f32 v[136:137], v[136:137], v[32:33] op_sel_hi:[1,0]
v_pk_mul_f32 v[178:179], v[178:179], v[36:37] op_sel_hi:[1,0]
v_pk_mul_f32 v[174:175], v[174:175], v[36:37] op_sel_hi:[1,0]
v_pk_mul_f32 v[128:129], v[128:129], v[32:33] op_sel_hi:[1,0]
s_add_u32 s60, s30, 416
v_pk_mul_f32 v[154:155], v[154:155], v[32:33] op_sel_hi:[1,0]
v_pk_mul_f32 v[152:153], v[152:153], v[32:33] op_sel_hi:[1,0]
s_add_u32 s16, s4, 416
v_cvt_pk_bf16_f32 v128, v128, v129
v_cvt_pk_bf16_f32 v129, v130, v131
v_pk_mul_f32 v[160:161], v[160:161], v[36:37] op_sel_hi:[1,0]
v_pk_mul_f32 v[134:135], v[134:135], v[32:33] op_sel_hi:[1,0]
v_pk_mul_f32 v[148:149], v[148:149], v[32:33] op_sel_hi:[1,0]
v_pk_mul_f32 v[170:171], v[170:171], v[36:37] op_sel_hi:[1,0]
v_pk_mul_f32 v[156:157], v[156:157], v[32:33] op_sel_hi:[1,0]
v_pk_mul_f32 v[186:187], v[186:187], v[36:37] op_sel_hi:[1,0]
s_lshl_b32 s60, s60, 5
v_pk_mul_f32 v[140:141], v[140:141], v[32:33] op_sel_hi:[1,0]
v_pk_mul_f32 v[162:163], v[162:163], v[36:37] op_sel_hi:[1,0]
v_pk_mul_f32 v[176:177], v[176:177], v[36:37] op_sel_hi:[1,0]
v_pk_mul_f32 v[180:181], v[180:181], v[36:37] op_sel_hi:[1,0]
v_cvt_pk_bf16_f32 v131, v134, v135
v_cvt_pk_bf16_f32 v134, v140, v141
s_lshl_b32 s16, s16, 5
v_pk_mul_f32 v[166:167], v[166:167], v[36:37] op_sel_hi:[1,0]
v_cvt_pk_bf16_f32 v130, v132, v133
v_cvt_pk_bf16_f32 v140, v152, v153
v_cvt_pk_bf16_f32 v132, v136, v137
v_cvt_pk_bf16_f32 v133, v138, v139
v_pk_mul_f32 v[168:169], v[168:169], v[36:37] op_sel_hi:[1,0]
v_pk_mul_f32 v[142:143], v[142:143], v[32:33] op_sel_hi:[1,0]
v_pk_mul_f32 v[146:147], v[146:147], v[32:33] op_sel_hi:[1,0]
s_add_u32 s60, s60, s21
s_sub_u32 s34, s33, 28672
buffer_load_dwordx4 a[240:243], v4, s[40:43], s34 offen offset:0 sc1
buffer_load_dwordx4 a[244:247], v4, s[40:43], s34 offen offset:1024 sc1
buffer_load_dwordx4 a[248:251], v4, s[40:43], s34 offen offset:2048 sc1
buffer_load_dwordx4 a[252:255], v4, s[40:43], s34 offen offset:3072 sc1
v_cvt_pk_bf16_f32 v138, v148, v149
v_cvt_pk_bf16_f32 v141, v154, v155
v_pk_mul_f32 v[150:151], v[150:151], v[32:33] op_sel_hi:[1,0]
s_lshl_b32 s60, s60, 12
v_cvt_pk_bf16_f32 v153, v178, v179
v_pk_mul_f32 v[172:173], v[172:173], v[36:37] op_sel_hi:[1,0]
v_pk_mul_f32 v[164:165], v[164:165], v[36:37] op_sel_hi:[1,0]
v_cvt_pk_bf16_f32 v135, v142, v143
s_sub_u32 s34, s33, 32768
buffer_load_dwordx4 a[80:83], v4, s[40:43], s34 offen offset:0 sc1
buffer_load_dwordx4 a[84:87], v4, s[40:43], s34 offen offset:1024 sc1
buffer_load_dwordx4 a[88:91], v4, s[40:43], s34 offen offset:2048 sc1
buffer_load_dwordx4 a[92:95], v4, s[40:43], s34 offen offset:3072 sc1
v_pk_mul_f32 v[182:183], v[182:183], v[36:37] op_sel_hi:[1,0]
s_add_u32 s16, s16, s21
v_cvt_pk_bf16_f32 v149, v170, v171
v_pk_mul_f32 v[170:171], v[218:219], v[40:41] op_sel_hi:[1,0]
v_pk_mul_f32 v[196:197], v[196:197], v[40:41] op_sel_hi:[1,0]
v_cvt_pk_bf16_f32 v137, v146, v147
v_cvt_pk_bf16_f32 v139, v150, v151
v_cvt_pk_bf16_f32 v150, v172, v173
v_cvt_pk_bf16_f32 v142, v156, v157
v_cvt_pk_bf16_f32 v146, v164, v165
v_cvt_pk_bf16_f32 v143, v158, v159
v_cvt_pk_bf16_f32 v136, v144, v145
v_cvt_pk_bf16_f32 v144, v160, v161
s_lshl_b32 s16, s16, 12
v_pk_mul_f32 v[190:191], v[190:191], v[36:37] op_sel_hi:[1,0]
v_pk_mul_f32 v[188:189], v[188:189], v[36:37] op_sel_hi:[1,0]
v_pk_mul_f32 v[164:165], v[212:213], v[40:41] op_sel_hi:[1,0]
v_pk_mul_f32 v[198:199], v[198:199], v[40:41] op_sel_hi:[1,0]
v_cvt_pk_bf16_f32 v156, v184, v185
v_pk_mul_f32 v[184:185], v[232:233], v[44:45] op_sel_hi:[1,0]
v_cvt_pk_bf16_f32 v148, v168, v169
v_cvt_pk_bf16_f32 v151, v174, v175
v_cvt_pk_bf16_f32 v147, v166, v167
v_pk_mul_f32 v[174:175], v[222:223], v[40:41] op_sel_hi:[1,0]
v_pk_mul_f32 v[204:205], v[204:205], v[40:41] op_sel_hi:[1,0]
v_pk_mul_f32 v[242:243], v[242:243], v[44:45] op_sel_hi:[1,0]
v_pk_mul_f32 v[160:161], v[208:209], v[40:41] op_sel_hi:[1,0]
v_cvt_pk_bf16_f32 v212, v184, v185
v_cvt_pk_bf16_f32 v159, v190, v191
v_cvt_pk_bf16_f32 v157, v186, v187
v_cvt_pk_bf16_f32 v158, v188, v189
v_pk_mul_f32 v[188:189], v[236:237], v[44:45] op_sel_hi:[1,0]
v_pk_mul_f32 v[178:179], v[226:227], v[44:45] op_sel_hi:[1,0]
v_pk_mul_f32 v[192:193], v[192:193], v[40:41] op_sel_hi:[1,0]
v_cvt_pk_bf16_f32 v145, v162, v163
s_xor_b32 s17, s16, 0x20000
v_pk_mul_f32 v[248:249], v[248:249], v[44:45] op_sel_hi:[1,0]
v_cvt_pk_bf16_f32 v209, v178, v179
v_pk_mul_f32 v[190:191], v[238:239], v[44:45] op_sel_hi:[1,0]
v_pk_mul_f32 v[166:167], v[214:215], v[40:41] op_sel_hi:[1,0]
v_cvt_pk_bf16_f32 v227, v198, v199
v_pk_mul_f32 v[250:251], v[250:251], v[44:45] op_sel_hi:[1,0]
v_pk_mul_f32 v[206:207], v[206:207], v[40:41] op_sel_hi:[1,0]
v_pk_mul_f32 v[202:203], v[202:203], v[40:41] op_sel_hi:[1,0]
v_cvt_pk_bf16_f32 v155, v182, v183
v_pk_mul_f32 v[182:183], v[230:231], v[44:45] op_sel_hi:[1,0]
v_cvt_pk_bf16_f32 v154, v180, v181
v_cvt_pk_bf16_f32 v239, v174, v175
v_pk_mul_f32 v[168:169], v[216:217], v[40:41] op_sel_hi:[1,0]
v_pk_mul_f32 v[172:173], v[220:221], v[40:41] op_sel_hi:[1,0]
v_cvt_pk_bf16_f32 v236, v168, v169
v_cvt_pk_bf16_f32 v237, v170, v171
v_pk_mov_b32 v[100:101], v[118:119], v[118:119] op_sel:[1,1]
v_pk_mul_f32 v[240:241], v[240:241], v[44:45] op_sel_hi:[1,0]
v_cvt_pk_bf16_f32 v216, v240, v241
v_cvt_pk_bf16_f32 v152, v176, v177
v_pk_mul_f32 v[176:177], v[224:225], v[44:45] op_sel_hi:[1,0]
v_pk_mul_f32 v[162:163], v[210:211], v[40:41] op_sel_hi:[1,0]
v_pk_mov_b32 v[54:55], v[116:117], v[116:117] op_sel:[0,0]
v_pk_mul_f32 v[186:187], v[234:235], v[44:45] op_sel_hi:[1,0]
v_cvt_pk_bf16_f32 v235, v166, v167
v_cvt_pk_bf16_f32 v217, v242, v243
buffer_store_dwordx4 v[128:131], v4, s[40:43], s60 offen offset:0 sc1
buffer_store_dwordx4 v[132:135], v4, s[40:43], s60 offen offset:1024 sc1
ds_read_b128 a[0:3], v8 offset:16384
ds_read_b128 a[4:7], v9 offset:16384
ds_read_b128 a[8:11], v8 offset:18432
ds_read_b128 a[12:15], v9 offset:18432
ds_read_b128 a[16:19], v8 offset:20480
buffer_store_dwordx4 v[136:139], v4, s[40:43], s60 offen offset:2048 sc1
buffer_store_dwordx4 v[140:143], v4, s[40:43], s60 offen offset:3072 sc1
ds_read_b128 a[20:23], v9 offset:20480
ds_read_b128 a[24:27], v8 offset:22528
v_cvt_pk_bf16_f32 v211, v182, v183
v_pk_mov_b32 v[52:53], v[116:117], v[116:117] op_sel:[0,0]
v_pk_mul_f32 v[180:181], v[228:229], v[44:45] op_sel_hi:[1,0]
v_pk_mov_b32 v[70:71], v[116:117], v[116:117] op_sel:[1,1]
v_pk_mov_b32 v[84:85], v[118:119], v[118:119] op_sel:[0,0]
v_pk_mov_b32 v[86:87], v[118:119], v[118:119] op_sel:[0,0]
v_cvt_pk_bf16_f32 v230, v204, v205
v_pk_mul_f32 v[246:247], v[246:247], v[44:45] op_sel_hi:[1,0]
v_pk_mul_f32 v[200:201], v[200:201], v[40:41] op_sel_hi:[1,0]
v_pk_mov_b32 v[102:103], v[118:119], v[118:119] op_sel:[1,1]
v_cvt_pk_bf16_f32 v219, v246, v247
v_cvt_pk_bf16_f32 v224, v192, v193
v_pk_mul_f32 v[244:245], v[244:245], v[44:45] op_sel_hi:[1,0]
v_pk_mov_b32 v[68:69], v[116:117], v[116:117] op_sel:[1,1]
v_cvt_pk_bf16_f32 v208, v176, v177
v_cvt_pk_bf16_f32 v214, v188, v189
v_cvt_pk_bf16_f32 v231, v206, v207
v_cvt_pk_bf16_f32 v221, v250, v251
v_cvt_pk_bf16_f32 v220, v248, v249
v_pk_mul_f32 v[252:253], v[252:253], v[44:45] op_sel_hi:[1,0]
v_cvt_pk_bf16_f32 v222, v252, v253
v_cvt_pk_bf16_f32 v234, v164, v165
v_cvt_pk_bf16_f32 v215, v190, v191
v_pk_mul_f32 v[254:255], v[254:255], v[44:45] op_sel_hi:[1,0]
v_cvt_pk_bf16_f32 v210, v180, v181
v_cvt_pk_bf16_f32 v229, v202, v203
s_add_u32 s60, s60, 131072
ds_read_b128 a[28:31], v9 offset:22528
buffer_store_dwordx4 v[144:147], v4, s[40:43], s60 offen offset:0 sc1
buffer_store_dwordx4 v[148:151], v4, s[40:43], s60 offen offset:1024 sc1
buffer_store_dwordx4 v[152:155], v4, s[40:43], s60 offen offset:2048 sc1
buffer_store_dwordx4 v[156:159], v4, s[40:43], s60 offen offset:3072 sc1
v_cvt_pk_bf16_f32 v213, v186, v187
v_cvt_pk_bf16_f32 v228, v200, v201
v_cvt_pk_bf16_f32 v233, v162, v163
v_cvt_pk_bf16_f32 v218, v244, v245
v_pk_mul_f32 v[194:195], v[194:195], v[40:41] op_sel_hi:[1,0]
v_cvt_pk_bf16_f32 v225, v194, v195
v_cvt_pk_bf16_f32 v238, v172, v173
v_cvt_pk_bf16_f32 v226, v196, v197
v_cvt_pk_bf16_f32 v223, v254, v255
v_cvt_pk_bf16_f32 v232, v160, v161
s_branch kf_kernel_fx
kf_kernel_f3:
v_pk_mul_f32 v[212:213], v[212:213], v[40:41] op_sel_hi:[1,0]
v_pk_mul_f32 v[202:203], v[202:203], v[40:41] op_sel_hi:[1,0]
v_pk_mul_f32 v[88:89], v[136:137], v[32:33] op_sel_hi:[1,0]
v_pk_mul_f32 v[84:85], v[132:133], v[32:33] op_sel_hi:[1,0]
s_add_u32 s60, s31, 416
v_pk_mul_f32 v[96:97], v[144:145], v[32:33] op_sel_hi:[1,0]
v_pk_mul_f32 v[200:201], v[200:201], v[40:41] op_sel_hi:[1,0]
s_lshl_b32 s60, s60, 5
v_pk_mul_f32 v[98:99], v[146:147], v[32:33] op_sel_hi:[1,0]
v_pk_mul_f32 v[236:237], v[236:237], v[44:45] op_sel_hi:[1,0]
v_pk_mul_f32 v[104:105], v[152:153], v[32:33] op_sel_hi:[1,0]
v_pk_mul_f32 v[234:235], v[234:235], v[44:45] op_sel_hi:[1,0]
v_pk_mul_f32 v[92:93], v[140:141], v[32:33] op_sel_hi:[1,0]
v_pk_mul_f32 v[100:101], v[148:149], v[32:33] op_sel_hi:[1,0]
s_add_u32 s16, s4, 416
v_pk_mul_f32 v[214:215], v[214:215], v[40:41] op_sel_hi:[1,0]
v_pk_mul_f32 v[80:81], v[128:129], v[32:33] op_sel_hi:[1,0]
s_lshl_b32 s16, s16, 5
s_sub_u32 s34, s33, 28672
buffer_load_dwordx4 a[240:243], v4, s[40:43], s34 offen offset:0 sc1
buffer_load_dwordx4 a[244:247], v4, s[40:43], s34 offen offset:1024 sc1
buffer_load_dwordx4 a[248:251], v4, s[40:43], s34 offen offset:2048 sc1
buffer_load_dwordx4 a[252:255], v4, s[40:43], s34 offen offset:3072 sc1
s_add_u32 s60, s60, s21
v_pk_mul_f32 v[210:211], v[210:211], v[40:41] op_sel_hi:[1,0]
v_cvt_pk_bf16_f32 v149, v234, v235
v_pk_mul_f32 v[250:251], v[250:251], v[44:45] op_sel_hi:[1,0]
v_pk_mul_f32 v[230:231], v[230:231], v[44:45] op_sel_hi:[1,0]
v_pk_mul_f32 v[246:247], v[246:247], v[44:45] op_sel_hi:[1,0]
v_pk_mul_f32 v[110:111], v[158:159], v[32:33] op_sel_hi:[1,0]
v_pk_mul_f32 v[248:249], v[248:249], v[44:45] op_sel_hi:[1,0]
v_pk_mul_f32 v[218:219], v[218:219], v[40:41] op_sel_hi:[1,0]
v_pk_mul_f32 v[86:87], v[134:135], v[32:33] op_sel_hi:[1,0]
s_add_u32 s16, s16, s21
v_pk_mul_f32 v[232:233], v[232:233], v[44:45] op_sel_hi:[1,0]
v_pk_mul_f32 v[90:91], v[138:139], v[32:33] op_sel_hi:[1,0]
v_pk_mul_f32 v[224:225], v[224:225], v[44:45] op_sel_hi:[1,0]
s_lshl_b32 s60, s60, 12
v_pk_mul_f32 v[244:245], v[244:245], v[44:45] op_sel_hi:[1,0]
v_pk_mul_f32 v[198:199], v[198:199], v[40:41] op_sel_hi:[1,0]
v_pk_mul_f32 v[206:207], v[206:207], v[40:41] op_sel_hi:[1,0]
v_pk_mul_f32 v[196:197], v[196:197], v[40:41] op_sel_hi:[1,0]
v_pk_mul_f32 v[94:95], v[142:143], v[32:33] op_sel_hi:[1,0]
v_cvt_pk_bf16_f32 v144, v224, v225
v_cvt_pk_bf16_f32 v139, v214, v215
v_pk_mul_f32 v[204:205], v[204:205], v[40:41] op_sel_hi:[1,0]
v_pk_mul_f32 v[240:241], v[240:241], v[44:45] op_sel_hi:[1,0]
v_cvt_pk_bf16_f32 v138, v212, v213
v_pk_mul_f32 v[208:209], v[208:209], v[40:41] op_sel_hi:[1,0]
v_cvt_pk_bf16_f32 v147, v230, v231
v_pk_mul_f32 v[102:103], v[150:151], v[32:33] op_sel_hi:[1,0]
v_pk_mul_f32 v[82:83], v[130:131], v[32:33] op_sel_hi:[1,0]
v_pk_mul_f32 v[106:107], v[154:155], v[32:33] op_sel_hi:[1,0]
v_cvt_pk_bf16_f32 v136, v208, v209
v_pk_mul_f32 v[226:227], v[226:227], v[44:45] op_sel_hi:[1,0]
v_cvt_pk_bf16_f32 v133, v202, v203
v_pk_mul_f32 v[228:229], v[228:229], v[44:45] op_sel_hi:[1,0]
v_cvt_pk_bf16_f32 v145, v226, v227
v_pk_mul_f32 v[194:195], v[194:195], v[40:41] op_sel_hi:[1,0]
v_cvt_pk_bf16_f32 v129, v194, v195
v_pk_mul_f32 v[222:223], v[222:223], v[40:41] op_sel_hi:[1,0]
v_cvt_pk_bf16_f32 v146, v228, v229
v_pk_mul_f32 v[108:109], v[156:157], v[32:33] op_sel_hi:[1,0]
v_cvt_pk_bf16_f32 v228, v88, v89
v_pk_mul_f32 v[254:255], v[254:255], v[44:45] op_sel_hi:[1,0]
v_pk_mul_f32 v[192:193], v[192:193], v[40:41] op_sel_hi:[1,0]
v_pk_mul_f32 v[164:165], v[164:165], v[36:37] op_sel_hi:[1,0]
v_cvt_pk_bf16_f32 v150, v236, v237
v_cvt_pk_bf16_f32 v141, v218, v219
s_sub_u32 s34, s33, 32768
buffer_load_dwordx4 a[80:83], v4, s[40:43], s34 offen offset:0 sc1
buffer_load_dwordx4 a[84:87], v4, s[40:43], s34 offen offset:1024 sc1
buffer_load_dwordx4 a[88:91], v4, s[40:43], s34 offen offset:2048 sc1
buffer_load_dwordx4 a[92:95], v4, s[40:43], s34 offen offset:3072 sc1
v_cvt_pk_bf16_f32 v231, v94, v95
v_pk_mul_f32 v[216:217], v[216:217], v[40:41] op_sel_hi:[1,0]
v_cvt_pk_bf16_f32 v229, v90, v91
v_cvt_pk_bf16_f32 v148, v232, v233
v_cvt_pk_bf16_f32 v233, v98, v99
v_cvt_pk_bf16_f32 v159, v254, v255
v_pk_mul_f32 v[220:221], v[220:221], v[40:41] op_sel_hi:[1,0]
v_cvt_pk_bf16_f32 v130, v196, v197
v_cvt_pk_bf16_f32 v226, v84, v85
v_pk_mul_f32 v[166:167], v[166:167], v[36:37] op_sel_hi:[1,0]
v_cvt_pk_bf16_f32 v132, v200, v201
v_cvt_pk_bf16_f32 v131, v198, v199
v_cvt_pk_bf16_f32 v230, v92, v93
v_cvt_pk_bf16_f32 v134, v204, v205
v_pk_mul_f32 v[242:243], v[242:243], v[44:45] op_sel_hi:[1,0]
v_cvt_pk_bf16_f32 v155, v246, v247
v_cvt_pk_bf16_f32 v152, v240, v241
v_cvt_pk_bf16_f32 v128, v192, v193
v_cvt_pk_bf16_f32 v135, v206, v207
v_cvt_pk_bf16_f32 v137, v210, v211
v_cvt_pk_bf16_f32 v140, v216, v217
v_cvt_pk_bf16_f32 v154, v244, v245
v_pk_mul_f32 v[174:175], v[174:175], v[36:37] op_sel_hi:[1,0]
v_cvt_pk_bf16_f32 v143, v222, v223
v_pk_mul_f32 v[168:169], v[168:169], v[36:37] op_sel_hi:[1,0]
v_pk_mul_f32 v[176:177], v[176:177], v[36:37] op_sel_hi:[1,0]
v_cvt_pk_bf16_f32 v156, v248, v249
s_lshl_b32 s16, s16, 12
s_xor_b32 s17, s16, 0x20000
ds_read_b128 a[0:3], v8 offset:16384
ds_read_b128 a[4:7], v9 offset:16384
ds_read_b128 a[8:11], v8 offset:18432
ds_read_b128 a[12:15], v9 offset:18432
buffer_store_dwordx4 v[128:131], v4, s[40:43], s60 offen offset:0 sc1
ds_read_b128 a[16:19], v8 offset:20480
ds_read_b128 a[20:23], v9 offset:20480
v_pk_mul_f32 v[252:253], v[252:253], v[44:45] op_sel_hi:[1,0]
v_cvt_pk_bf16_f32 v142, v220, v221
v_pk_mul_f32 v[162:163], v[162:163], v[36:37] op_sel_hi:[1,0]
v_cvt_pk_bf16_f32 v210, v164, v165
v_cvt_pk_bf16_f32 v158, v252, v253
v_cvt_pk_bf16_f32 v236, v104, v105
v_pk_mul_f32 v[178:179], v[178:179], v[36:37] op_sel_hi:[1,0]
v_cvt_pk_bf16_f32 v216, v176, v177
v_cvt_pk_bf16_f32 v237, v106, v107
v_cvt_pk_bf16_f32 v212, v168, v169
v_pk_mul_f32 v[238:239], v[238:239], v[44:45] op_sel_hi:[1,0]
v_pk_mul_f32 v[170:171], v[170:171], v[36:37] op_sel_hi:[1,0]
v_pk_mul_f32 v[184:185], v[184:185], v[36:37] op_sel_hi:[1,0]
v_cvt_pk_bf16_f32 v213, v170, v171
v_pk_mul_f32 v[180:181], v[180:181], v[36:37] op_sel_hi:[1,0]
v_pk_mul_f32 v[182:183], v[182:183], v[36:37] op_sel_hi:[1,0]
v_cvt_pk_bf16_f32 v151, v238, v239
v_pk_mul_f32 v[190:191], v[190:191], v[36:37] op_sel_hi:[1,0]
v_pk_mul_f32 v[172:173], v[172:173], v[36:37] op_sel_hi:[1,0]
v_cvt_pk_bf16_f32 v153, v242, v243
v_cvt_pk_bf16_f32 v232, v96, v97
v_cvt_pk_bf16_f32 v157, v250, v251
v_pk_mul_f32 v[160:161], v[160:161], v[36:37] op_sel_hi:[1,0]
v_cvt_pk_bf16_f32 v209, v162, v163
v_pk_mul_f32 v[188:189], v[188:189], v[36:37] op_sel_hi:[1,0]
v_pk_mul_f32 v[186:187], v[186:187], v[36:37] op_sel_hi:[1,0]
v_cvt_pk_bf16_f32 v208, v160, v161
v_pk_mov_b32 v[54:55], v[116:117], v[116:117] op_sel:[0,0]
ds_read_b128 a[24:27], v8 offset:22528
ds_read_b128 a[28:31], v9 offset:22528
buffer_store_dwordx4 v[132:135], v4, s[40:43], s60 offen offset:1024 sc1
buffer_store_dwordx4 v[136:139], v4, s[40:43], s60 offen offset:2048 sc1
buffer_store_dwordx4 v[140:143], v4, s[40:43], s60 offen offset:3072 sc1
v_cvt_pk_bf16_f32 v235, v102, v103
v_cvt_pk_bf16_f32 v220, v184, v185
v_cvt_pk_bf16_f32 v218, v180, v181
v_cvt_pk_bf16_f32 v219, v182, v183
v_cvt_pk_bf16_f32 v238, v108, v109
v_cvt_pk_bf16_f32 v234, v100, v101
v_pk_mov_b32 v[84:85], v[118:119], v[118:119] op_sel:[0,0]
v_pk_mov_b32 v[52:53], v[116:117], v[116:117] op_sel:[0,0]
v_cvt_pk_bf16_f32 v222, v188, v189
v_cvt_pk_bf16_f32 v239, v110, v111
v_cvt_pk_bf16_f32 v214, v172, v173
v_cvt_pk_bf16_f32 v227, v86, v87
v_pk_mov_b32 v[70:71], v[116:117], v[116:117] op_sel:[1,1]
v_pk_mov_b32 v[102:103], v[118:119], v[118:119] op_sel:[1,1]
v_cvt_pk_bf16_f32 v223, v190, v191
v_cvt_pk_bf16_f32 v211, v166, v167
s_add_u32 s60, s60, 131072
buffer_store_dwordx4 v[144:147], v4, s[40:43], s60 offen offset:0 sc1
buffer_store_dwordx4 v[148:151], v4, s[40:43], s60 offen offset:1024 sc1
buffer_store_dwordx4 v[152:155], v4, s[40:43], s60 offen offset:2048 sc1
buffer_store_dwordx4 v[156:159], v4, s[40:43], s60 offen offset:3072 sc1
v_pk_mov_b32 v[86:87], v[118:119], v[118:119] op_sel:[0,0]
v_cvt_pk_bf16_f32 v224, v80, v81
v_cvt_pk_bf16_f32 v225, v82, v83
v_pk_mov_b32 v[100:101], v[118:119], v[118:119] op_sel:[1,1]
v_pk_mov_b32 v[68:69], v[116:117], v[116:117] op_sel:[1,1]
v_cvt_pk_bf16_f32 v217, v178, v179
v_cvt_pk_bf16_f32 v215, v174, v175
v_cvt_pk_bf16_f32 v221, v186, v187
kf_kernel_fx:
s_cmp_lt_u32 s22, 4
s_cbranch_scc1 kf_kernel_g6
kf_kernel_g8:
s_waitcnt vmcnt(40) lgkmcnt(0)
v_mfma_f32_16x16x32_bf16 v[48:51], a[128:131], a[0:3], v[52:55]
s_and_b32 s3, s23, 1
ds_read_b128 a[40:43], v8 offset:24576
ds_read_b128 a[44:47], v9 offset:24576
v_mfma_f32_16x16x32_bf16 v[48:51], a[136:139], a[4:7], v[48:51]
s_lshr_b32 s55, s23, 1
ds_read_b128 a[48:51], v8 offset:26624
s_add_u32 s3, s3, s38
v_mfma_f32_16x16x32_bf16 v[52:55], a[132:135], a[0:3], v[52:55]
s_sub_u32 s34, s33, 36864
ds_read_b128 a[52:55], v9 offset:26624
v_mfma_f32_16x16x32_bf16 v[52:55], a[140:143], a[4:7], v[52:55]
s_lshl2_add_u32 s39, s22, s55
ds_read_b128 a[56:59], v8 offset:28672
ds_read_b128 a[60:63], v9 offset:28672
v_mfma_f32_16x16x32_bf16 v[56:59], a[128:131], a[8:11], 0
buffer_load_dwordx4 a[96:99], v4, s[40:43], s34 offen offset:0 sc1
v_mfma_f32_16x16x32_bf16 v[56:59], a[136:139], a[12:15], v[56:59]
s_lshl_b32 s39, s39, 8
ds_read_b128 a[64:67], v8 offset:30720
v_mov_b32 v45, 1
v_mfma_f32_16x16x32_bf16 v[60:63], a[132:135], a[8:11], 0
buffer_load_dwordx4 a[100:103], v4, s[40:43], s34 offen offset:1024 sc1
v_mfma_f32_16x16x32_bf16 v[60:63], a[140:143], a[12:15], v[60:63]
ds_read_b128 a[68:71], v9 offset:30720
s_mul_i32 s38, s3, 27
v_mfma_f32_16x16x32_bf16 v[64:67], a[128:131], a[16:19], v[68:71]
s_add_u32 s38, s38, s62
v_mov_b32 v44, 0
s_add_u32 s39, s39, 3162112
v_mfma_f32_16x16x32_bf16 v[64:67], a[136:139], a[20:23], v[64:67]
s_lshl_b32 s38, s38, 10
v_mfma_f32_16x16x32_bf16 v[68:71], a[132:135], a[16:19], v[68:71]
v_mfma_f32_16x16x32_bf16 v[68:71], a[140:143], a[20:23], v[68:71]
buffer_load_dwordx4 a[104:107], v4, s[40:43], s34 offen offset:2048 sc1
v_mfma_f32_16x16x32_bf16 v[72:75], a[128:131], a[24:27], 0
v_mfma_f32_16x16x32_bf16 v[72:75], a[136:139], a[28:31], v[72:75]
v_mfma_f32_16x16x32_bf16 v[76:79], a[132:135], a[24:27], 0
s_cmp_ge_u32 s62, 27
s_cselect_b32 s38, 536870912, s38
s_cmp_lt_u32 s22, 4
v_mfma_f32_16x16x32_bf16 v[76:79], a[140:143], a[28:31], v[76:79]
s_waitcnt vmcnt(43) lgkmcnt(0)
s_barrier
v_mfma_f32_16x16x32_bf16 v[80:83], a[128:131], a[40:43], v[84:87]
ds_read_b128 a[0:3], v8 offset:32768
ds_read_b128 a[4:7], v9 offset:32768
v_mfma_f32_16x16x32_bf16 v[80:83], a[136:139], a[44:47], v[80:83]
buffer_store_dwordx4 v[208:211], v4, s[40:43], s16 offen offset:0
v_mfma_f32_16x16x32_bf16 v[84:87], a[132:135], a[40:43], v[84:87]
s_cselect_b32 s52, 536870912, 0
ds_read_b128 a[8:11], v8 offset:34816
ds_read_b128 a[12:15], v9 offset:34816
v_mfma_f32_16x16x32_bf16 v[84:87], a[140:143], a[44:47], v[84:87]
s_lshl_b32 s3, s20, 10
ds_read_b128 a[16:19], v8 offset:36864
ds_read_b128 a[20:23], v9 offset:36864
v_mfma_f32_16x16x32_bf16 v[88:91], a[128:131], a[48:51], 0
ds_read_b128 a[24:27], v8 offset:38912
ds_read_b128 a[28:31], v9 offset:38912
v_mfma_f32_16x16x32_bf16 v[88:91], a[136:139], a[52:55], v[88:91]
buffer_load_dwordx4 a[108:111], v4, s[40:43], s34 offen offset:3072 sc1
v_mfma_f32_16x16x32_bf16 v[92:95], a[132:135], a[48:51], 0
s_sub_u32 s34, s33, 40960
v_mfma_f32_16x16x32_bf16 v[92:95], a[140:143], a[52:55], v[92:95]
v_mfma_f32_16x16x32_bf16 v[96:99], a[128:131], a[56:59], v[100:103]
buffer_load_dwordx4 a[112:115], v4, s[40:43], s34 offen offset:0 sc1
v_mfma_f32_16x16x32_bf16 v[96:99], a[136:139], a[60:63], v[96:99]
v_mfma_f32_16x16x32_bf16 v[100:103], a[132:135], a[56:59], v[100:103]
v_mfma_f32_16x16x32_bf16 v[100:103], a[140:143], a[60:63], v[100:103]
buffer_load_dwordx4 a[116:119], v4, s[40:43], s34 offen offset:1024 sc1
v_mfma_f32_16x16x32_bf16 v[104:107], a[128:131], a[64:67], 0
s_add_u32 s32, s12, s3
v_mfma_f32_16x16x32_bf16 v[104:107], a[136:139], a[68:71], v[104:107]
s_add_u32 s27, s14, s3
s_add_u32 s26, s13, s3
s_and_b32 s3, s20, 1
v_mfma_f32_16x16x32_bf16 v[108:111], a[132:135], a[64:67], 0
s_bfe_u32 s54, s23, 0x10001
s_lshl_b32 s3, s3, 2
v_mfma_f32_16x16x32_bf16 v[108:111], a[140:143], a[68:71], v[108:111]
s_waitcnt vmcnt(47) lgkmcnt(0)
ds_read_b128 a[40:43], v8 offset:40960
ds_read_b128 a[44:47], v9 offset:40960
v_mfma_f32_16x16x32_bf16 v[48:51], a[144:147], a[0:3], v[48:51]
ds_read_b128 a[48:51], v8 offset:43008
ds_read_b128 a[52:55], v9 offset:43008
v_mfma_f32_16x16x32_bf16 v[48:51], a[152:155], a[4:7], v[48:51]
buffer_store_dwordx4 v[212:215], v4, s[40:43], s16 offen offset:1024
v_mfma_f32_16x16x32_bf16 v[52:55], a[148:151], a[0:3], v[52:55]
s_and_b32 s53, s24, 3
ds_read_b128 a[56:59], v8 offset:45056
v_mfma_f32_16x16x32_bf16 v[52:55], a[156:159], a[4:7], v[52:55]
v_mfma_f32_16x16x32_bf16 v[56:59], a[144:147], a[8:11], v[56:59]
s_lshl2_add_u32 s53, s54, s53
s_xor_b32 s3, s3, s53
s_mul_i32 s18, s3, 5120
v_mfma_f32_16x16x32_bf16 v[56:59], a[152:155], a[12:15], v[56:59]
s_lshr_b32 s54, s20, 1
ds_read_b128 a[60:63], v9 offset:45056
ds_read_b128 a[64:67], v8 offset:47104
v_mfma_f32_16x16x32_bf16 v[60:63], a[148:151], a[8:11], v[60:63]
buffer_load_dwordx4 a[120:123], v4, s[40:43], s34 offen offset:2048 sc1
v_mfma_f32_16x16x32_bf16 v[60:63], a[156:159], a[12:15], v[60:63]
ds_read_b128 a[68:71], v9 offset:47104
v_mfma_f32_16x16x32_bf16 v[64:67], a[144:147], a[16:19], v[64:67]
s_lshl_b32 s3, s54, 16
s_add_u32 s18, s18, s3
v_mfma_f32_16x16x32_bf16 v[64:67], a[152:155], a[20:23], v[64:67]
s_lshl_b32 s3, s21, 18
s_add_u32 s18, s18, s3
v_mfma_f32_16x16x32_bf16 v[68:71], a[148:151], a[16:19], v[68:71]
s_add_u32 s18, s18, 104857600
v_mfma_f32_16x16x32_bf16 v[68:71], a[156:159], a[20:23], v[68:71]
buffer_load_dwordx4 a[124:127], v4, s[40:43], s34 offen offset:3072 sc1
v_mfma_f32_16x16x32_bf16 v[72:75], a[144:147], a[24:27], v[72:75]
s_cmp_eq_u32 s55, 3
v_mfma_f32_16x16x32_bf16 v[72:75], a[152:155], a[28:31], v[72:75]
s_cselect_b32 s49, 1073741824, 0
v_mfma_f32_16x16x32_bf16 v[76:79], a[148:151], a[24:27], v[76:79]
s_and_b32 s3, s12, 0x10000
v_add_u32 v32, s3, v4
v_xor_b32 v33, 0x10000, v32
v_mfma_f32_16x16x32_bf16 v[76:79], a[156:159], a[28:31], v[76:79]
s_waitcnt vmcnt(46) lgkmcnt(0)
s_barrier
v_mfma_f32_16x16x32_bf16 v[80:83], a[144:147], a[40:43], v[80:83]
ds_read_b128 a[0:3], v8 offset:49152
ds_read_b128 a[4:7], v9 offset:49152
v_mfma_f32_16x16x32_bf16 v[80:83], a[152:155], a[44:47], v[80:83]
buffer_store_dwordx4 v[216:219], v4, s[40:43], s16 offen offset:2048
v_mfma_f32_16x16x32_bf16 v[84:87], a[148:151], a[40:43], v[84:87]
s_sub_u32 s34, s33, 45056
ds_read_b128 a[8:11], v8 offset:51200
ds_read_b128 a[12:15], v9 offset:51200
v_mfma_f32_16x16x32_bf16 v[84:87], a[156:159], a[44:47], v[84:87]
buffer_load_dwordx4 a[128:131], v4, s[40:43], s34 offen offset:0 sc1
v_mfma_f32_16x16x32_bf16 v[88:91], a[144:147], a[48:51], v[88:91]
ds_read_b128 a[16:19], v8 offset:53248
ds_read_b128 a[20:23], v9 offset:53248
v_mfma_f32_16x16x32_bf16 v[88:91], a[152:155], a[52:55], v[88:91]
ds_read_b128 a[24:27], v8 offset:55296
ds_read_b128 a[28:31], v9 offset:55296
v_mfma_f32_16x16x32_bf16 v[92:95], a[148:151], a[48:51], v[92:95]
v_lshrrev_b32 v2, 2, v0
s_mul_i32 s37, s4, 27648
v_mfma_f32_16x16x32_bf16 v[92:95], a[156:159], a[52:55], v[92:95]
s_xor_b32 s48, s4, 1
v_mfma_f32_16x16x32_bf16 v[96:99], a[144:147], a[56:59], v[96:99]
buffer_load_dwordx4 a[132:135], v4, s[40:43], s34 offen offset:1024 sc1
v_mfma_f32_16x16x32_bf16 v[96:99], a[152:155], a[60:63], v[96:99]
v_lshlrev_b32 v2, 8, v2
v_and_b32 v1, 3, v0
v_mfma_f32_16x16x32_bf16 v[100:103], a[148:151], a[56:59], v[100:103]
v_mfma_f32_16x16x32_bf16 v[100:103], a[156:159], a[60:63], v[100:103]
buffer_load_dwordx4 a[136:139], v4, s[40:43], s34 offen offset:2048 sc1
v_mfma_f32_16x16x32_bf16 v[104:107], a[144:147], a[64:67], v[104:107]
s_mul_i32 s3, s55, 7168
s_add_u32 s37, s37, s3
v_lshlrev_b32 v46, 8, v1
v_mfma_f32_16x16x32_bf16 v[104:107], a[152:155], a[68:71], v[104:107]
v_mfma_f32_16x16x32_bf16 v[108:111], a[148:151], a[64:67], v[108:111]
s_mul_i32 s48, s48, 27648
s_add_u32 s48, s48, s3
v_mfma_f32_16x16x32_bf16 v[108:111], a[156:159], a[68:71], v[108:111]
s_waitcnt vmcnt(48) lgkmcnt(0)
ds_read_b128 a[40:43], v8 offset:57344
ds_read_b128 a[44:47], v9 offset:57344
v_mfma_f32_16x16x32_bf16 v[48:51], a[160:163], a[0:3], v[48:51]
ds_read_b128 a[48:51], v8 offset:59392
ds_read_b128 a[52:55], v9 offset:59392
v_mfma_f32_16x16x32_bf16 v[48:51], a[168:171], a[4:7], v[48:51]
ds_read_b128 a[56:59], v8 offset:61440
ds_read_b128 a[60:63], v9 offset:61440
v_mfma_f32_16x16x32_bf16 v[52:55], a[164:167], a[0:3], v[52:55]
buffer_store_dwordx4 v[220:223], v4, s[40:43], s16 offen offset:3072
v_mfma_f32_16x16x32_bf16 v[52:55], a[172:175], a[4:7], v[52:55]
ds_read_b128 a[64:67], v8 offset:63488
v_mfma_f32_16x16x32_bf16 v[56:59], a[160:163], a[8:11], v[56:59]
ds_read_b128 a[68:71], v9 offset:63488
v_mfma_f32_16x16x32_bf16 v[56:59], a[168:171], a[12:15], v[56:59]
v_mfma_f32_16x16x32_bf16 v[60:63], a[164:167], a[8:11], v[60:63]
s_mov_b32 s3, 3145728
v_add_u32 v34, 0x20000, v4
v_mfma_f32_16x16x32_bf16 v[60:63], a[172:175], a[12:15], v[60:63]
buffer_load_dword v30, v2, s[40:43], s3 offen sc1
v_mfma_f32_16x16x32_bf16 v[64:67], a[160:163], a[16:19], v[64:67]
v_mfma_f32_16x16x32_bf16 v[64:67], a[168:171], a[20:23], v[64:67]
v_mfma_f32_16x16x32_bf16 v[68:71], a[164:167], a[16:19], v[68:71]
v_mfma_f32_16x16x32_bf16 v[68:71], a[172:175], a[20:23], v[68:71]
buffer_load_dwordx4 a[140:143], v4, s[40:43], s34 offen offset:3072 sc1
v_mfma_f32_16x16x32_bf16 v[72:75], a[160:163], a[24:27], v[72:75]
v_mfma_f32_16x16x32_bf16 v[72:75], a[168:171], a[28:31], v[72:75]
s_sub_u32 s34, s33, 49152
v_mfma_f32_16x16x32_bf16 v[76:79], a[164:167], a[24:27], v[76:79]
v_mfma_f32_16x16x32_bf16 v[76:79], a[172:175], a[28:31], v[76:79]
s_waitcnt vmcnt(48) lgkmcnt(0)
s_barrier
v_mfma_f32_16x16x32_bf16 v[80:83], a[160:163], a[40:43], v[80:83]
ds_read_b128 a[0:3], v10 offset:0
ds_read_b128 a[4:7], v11 offset:0
v_mfma_f32_16x16x32_bf16 v[80:83], a[168:171], a[44:47], v[80:83]
ds_read_b128 a[8:11], v10 offset:2048
ds_read_b128 a[12:15], v11 offset:2048
v_mfma_f32_16x16x32_bf16 v[84:87], a[164:167], a[40:43], v[84:87]
buffer_store_dwordx4 v[224:227], v4, s[40:43], s17 offen offset:0
v_mfma_f32_16x16x32_bf16 v[84:87], a[172:175], a[44:47], v[84:87]
ds_read_b128 a[16:19], v10 offset:4096
ds_read_b128 a[20:23], v11 offset:4096
v_mfma_f32_16x16x32_bf16 v[88:91], a[160:163], a[48:51], v[88:91]
buffer_load_dwordx4 a[144:147], v4, s[40:43], s34 offen offset:0 sc1
v_mfma_f32_16x16x32_bf16 v[88:91], a[168:171], a[52:55], v[88:91]
ds_read_b128 a[24:27], v10 offset:6144
ds_read_b128 a[28:31], v11 offset:6144
v_mfma_f32_16x16x32_bf16 v[92:95], a[164:167], a[48:51], v[92:95]
v_mfma_f32_16x16x32_bf16 v[92:95], a[172:175], a[52:55], v[92:95]
v_mfma_f32_16x16x32_bf16 v[96:99], a[160:163], a[56:59], v[96:99]
buffer_load_dwordx4 a[148:151], v4, s[40:43], s34 offen offset:1024 sc1
v_mfma_f32_16x16x32_bf16 v[96:99], a[168:171], a[60:63], v[96:99]
v_mfma_f32_16x16x32_bf16 v[100:103], a[164:167], a[56:59], v[100:103]
v_mfma_f32_16x16x32_bf16 v[100:103], a[172:175], a[60:63], v[100:103]
buffer_load_dwordx4 a[152:155], v4, s[40:43], s34 offen offset:2048 sc1
v_mfma_f32_16x16x32_bf16 v[104:107], a[160:163], a[64:67], v[104:107]
v_mfma_f32_16x16x32_bf16 v[104:107], a[168:171], a[68:71], v[104:107]
v_mfma_f32_16x16x32_bf16 v[108:111], a[164:167], a[64:67], v[108:111]
v_mfma_f32_16x16x32_bf16 v[108:111], a[172:175], a[68:71], v[108:111]
s_waitcnt vmcnt(48) lgkmcnt(0)
ds_read_b128 a[40:43], v10 offset:8192
ds_read_b128 a[44:47], v11 offset:8192
v_mfma_f32_16x16x32_bf16 v[48:51], a[176:179], a[0:3], v[48:51]
ds_read_b128 a[48:51], v10 offset:10240
ds_read_b128 a[52:55], v11 offset:10240
v_mfma_f32_16x16x32_bf16 v[48:51], a[184:187], a[4:7], v[48:51]
ds_read_b128 a[56:59], v10 offset:12288
ds_read_b128 a[60:63], v11 offset:12288
v_mfma_f32_16x16x32_bf16 v[52:55], a[180:183], a[0:3], v[52:55]
buffer_store_dwordx4 v[228:231], v4, s[40:43], s17 offen offset:1024
v_mfma_f32_16x16x32_bf16 v[52:55], a[188:191], a[4:7], v[52:55]
v_mfma_f32_16x16x32_bf16 v[56:59], a[176:179], a[8:11], v[56:59]
v_mfma_f32_16x16x32_bf16 v[56:59], a[184:187], a[12:15], v[56:59]
ds_read_b128 a[64:67], v10 offset:14336
ds_read_b128 a[68:71], v11 offset:14336
v_mfma_f32_16x16x32_bf16 v[60:63], a[180:183], a[8:11], v[60:63]
v_mfma_f32_16x16x32_bf16 v[60:63], a[188:191], a[12:15], v[60:63]
buffer_load_dwordx4 a[156:159], v4, s[40:43], s34 offen offset:3072 sc1
v_mfma_f32_16x16x32_bf16 v[64:67], a[176:179], a[16:19], v[64:67]
v_mfma_f32_16x16x32_bf16 v[64:67], a[184:187], a[20:23], v[64:67]
v_mfma_f32_16x16x32_bf16 v[68:71], a[180:183], a[16:19], v[68:71]
s_sub_u32 s34, s33, 53248
v_mfma_f32_16x16x32_bf16 v[68:71], a[188:191], a[20:23], v[68:71]
buffer_load_dwordx4 a[160:163], v4, s[40:43], s34 offen offset:0 sc1
v_mfma_f32_16x16x32_bf16 v[72:75], a[176:179], a[24:27], v[72:75]
v_lshrrev_b32 v47, 1, v4
s_add_u32 s29, s35, 0xfffffb00
v_mfma_f32_16x16x32_bf16 v[72:75], a[184:187], a[28:31], v[72:75]
v_mfma_f32_16x16x32_bf16 v[76:79], a[180:183], a[24:27], v[76:79]
v_mfma_f32_16x16x32_bf16 v[76:79], a[188:191], a[28:31], v[76:79]
s_waitcnt vmcnt(48) lgkmcnt(0)
s_barrier
v_mfma_f32_16x16x32_bf16 v[80:83], a[176:179], a[40:43], v[80:83]
ds_read_b128 a[0:3], v10 offset:16384
ds_read_b128 a[4:7], v11 offset:16384
v_mfma_f32_16x16x32_bf16 v[80:83], a[184:187], a[44:47], v[80:83]
ds_read_b128 a[8:11], v10 offset:18432
ds_read_b128 a[12:15], v11 offset:18432
v_mfma_f32_16x16x32_bf16 v[84:87], a[180:183], a[40:43], v[84:87]
buffer_store_dwordx4 v[232:235], v4, s[40:43], s17 offen offset:2048
v_mfma_f32_16x16x32_bf16 v[84:87], a[188:191], a[44:47], v[84:87]
ds_read_b128 a[16:19], v10 offset:20480
ds_read_b128 a[20:23], v11 offset:20480
v_mfma_f32_16x16x32_bf16 v[88:91], a[176:179], a[48:51], v[88:91]
buffer_load_dwordx4 a[164:167], v4, s[40:43], s34 offen offset:1024 sc1
v_mfma_f32_16x16x32_bf16 v[88:91], a[184:187], a[52:55], v[88:91]
v_mfma_f32_16x16x32_bf16 v[92:95], a[180:183], a[48:51], v[92:95]
ds_read_b128 a[24:27], v10 offset:22528
ds_read_b128 a[28:31], v11 offset:22528
v_mfma_f32_16x16x32_bf16 v[92:95], a[188:191], a[52:55], v[92:95]
v_mfma_f32_16x16x32_bf16 v[96:99], a[176:179], a[56:59], v[96:99]
buffer_load_dwordx4 a[168:171], v4, s[40:43], s34 offen offset:2048 sc1
v_mfma_f32_16x16x32_bf16 v[96:99], a[184:187], a[60:63], v[96:99]
v_mfma_f32_16x16x32_bf16 v[100:103], a[180:183], a[56:59], v[100:103]
v_mfma_f32_16x16x32_bf16 v[100:103], a[188:191], a[60:63], v[100:103]
buffer_load_dwordx4 a[172:175], v4, s[40:43], s34 offen offset:3072 sc1
v_mfma_f32_16x16x32_bf16 v[104:107], a[176:179], a[64:67], v[104:107]
v_mfma_f32_16x16x32_bf16 v[104:107], a[184:187], a[68:71], v[104:107]
v_mfma_f32_16x16x32_bf16 v[108:111], a[180:183], a[64:67], v[108:111]
v_mfma_f32_16x16x32_bf16 v[108:111], a[188:191], a[68:71], v[108:111]
s_waitcnt vmcnt(48) lgkmcnt(0)
ds_read_b128 a[40:43], v10 offset:24576
ds_read_b128 a[44:47], v11 offset:24576
v_mfma_f32_16x16x32_bf16 v[48:51], a[192:195], a[0:3], v[48:51]
buffer_store_dwordx4 v[236:239], v4, s[40:43], s17 offen offset:3072
v_mfma_f32_16x16x32_bf16 v[48:51], a[200:203], a[4:7], v[48:51]
ds_read_b128 a[48:51], v10 offset:26624
ds_read_b128 a[52:55], v11 offset:26624
v_mfma_f32_16x16x32_bf16 v[52:55], a[196:199], a[0:3], v[52:55]
ds_read_b128 a[56:59], v10 offset:28672
ds_read_b128 a[60:63], v11 offset:28672
v_mfma_f32_16x16x32_bf16 v[52:55], a[204:207], a[4:7], v[52:55]
ds_read_b128 a[64:67], v10 offset:30720
v_mfma_f32_16x16x32_bf16 v[56:59], a[192:195], a[8:11], v[56:59]
v_mfma_f32_16x16x32_bf16 v[56:59], a[200:203], a[12:15], v[56:59]
s_add_u32 m0, s13, 0
ds_read_b128 a[68:71], v11 offset:30720
v_mfma_f32_16x16x32_bf16 v[60:63], a[196:199], a[8:11], v[60:63]
v_mfma_f32_16x16x32_bf16 v[60:63], a[204:207], a[12:15], v[60:63]
buffer_load_dwordx4 v21, s[44:47], s29 offen offset:0 lds
v_mfma_f32_16x16x32_bf16 v[64:67], a[192:195], a[16:19], v[64:67]
v_mfma_f32_16x16x32_bf16 v[64:67], a[200:203], a[20:23], v[64:67]
v_mfma_f32_16x16x32_bf16 v[68:71], a[196:199], a[16:19], v[68:71]
v_mfma_f32_16x16x32_bf16 v[68:71], a[204:207], a[20:23], v[68:71]
buffer_load_dwordx4 v22, s[44:47], s29 offen offset:1024 lds
v_mfma_f32_16x16x32_bf16 v[72:75], a[192:195], a[24:27], v[72:75]
v_mfma_f32_16x16x32_bf16 v[72:75], a[200:203], a[28:31], v[72:75]
v_mfma_f32_16x16x32_bf16 v[76:79], a[196:199], a[24:27], v[76:79]
v_mfma_f32_16x16x32_bf16 v[76:79], a[204:207], a[28:31], v[76:79]
s_waitcnt vmcnt(48) lgkmcnt(0)
s_barrier
ds_read_b128 a[0:3], v10 offset:32768
ds_read_b128 a[4:7], v11 offset:32768
ds_read_b128 a[8:11], v10 offset:34816
ds_read_b128 a[12:15], v11 offset:34816
v_mfma_f32_16x16x32_bf16 v[80:83], a[192:195], a[40:43], v[80:83]
ds_read_b128 a[16:19], v10 offset:36864
ds_read_b128 a[20:23], v11 offset:36864
v_mfma_f32_16x16x32_bf16 v[80:83], a[200:203], a[44:47], v[80:83]
ds_read_b128 a[24:27], v10 offset:38912
ds_read_b128 a[28:31], v11 offset:38912
v_mfma_f32_16x16x32_bf16 v[84:87], a[196:199], a[40:43], v[84:87]
buffer_load_dwordx4 v23, s[44:47], s29 offen offset:2048 lds
v_mfma_f32_16x16x32_bf16 v[84:87], a[204:207], a[44:47], v[84:87]
v_mfma_f32_16x16x32_bf16 v[88:91], a[192:195], a[48:51], v[88:91]
buffer_load_dwordx4 v24, s[44:47], s29 offen offset:3072 lds
v_mfma_f32_16x16x32_bf16 v[88:91], a[200:203], a[52:55], v[88:91]
s_add_u32 s29, s35, 0xfffffa80
s_add_u32 m0, s13, 16384
v_mfma_f32_16x16x32_bf16 v[92:95], a[196:199], a[48:51], v[92:95]
v_mfma_f32_16x16x32_bf16 v[92:95], a[204:207], a[52:55], v[92:95]
v_mfma_f32_16x16x32_bf16 v[96:99], a[192:195], a[56:59], v[96:99]
buffer_load_dwordx4 v21, s[44:47], s29 offen offset:0 lds
v_mfma_f32_16x16x32_bf16 v[96:99], a[200:203], a[60:63], v[96:99]
v_mfma_f32_16x16x32_bf16 v[100:103], a[196:199], a[56:59], v[100:103]
v_mfma_f32_16x16x32_bf16 v[100:103], a[204:207], a[60:63], v[100:103]
buffer_load_dwordx4 v22, s[44:47], s29 offen offset:1024 lds
v_mfma_f32_16x16x32_bf16 v[104:107], a[192:195], a[64:67], v[104:107]
v_mfma_f32_16x16x32_bf16 v[104:107], a[200:203], a[68:71], v[104:107]
v_mfma_f32_16x16x32_bf16 v[108:111], a[196:199], a[64:67], v[108:111]
s_waitcnt vmcnt(19) lgkmcnt(0)
v_cmp_gt_u32 vcc, 16, v30
s_cmp_lg_u64 vcc, 0
v_mfma_f32_16x16x32_bf16 v[108:111], a[204:207], a[68:71], v[108:111]
s_cbranch_scc1 kf_kernel_spin_wf8
kf_kernel_ret_wf8:
v_mfma_f32_16x16x32_bf16 v[48:51], a[208:211], a[0:3], v[48:51]
ds_read_b128 a[40:43], v10 offset:40960
ds_read_b128 a[44:47], v11 offset:40960
v_mfma_f32_16x16x32_bf16 v[48:51], a[216:219], a[4:7], v[48:51]
buffer_load_dwordx4 v23, s[44:47], s29 offen offset:2048 lds
v_mfma_f32_16x16x32_bf16 v[52:55], a[212:215], a[0:3], v[52:55]
ds_read_b128 a[48:51], v10 offset:43008
ds_read_b128 a[52:55], v11 offset:43008
v_mfma_f32_16x16x32_bf16 v[52:55], a[220:223], a[4:7], v[52:55]
ds_read_b128 a[56:59], v10 offset:45056
ds_read_b128 a[60:63], v11 offset:45056
v_mfma_f32_16x16x32_bf16 v[56:59], a[208:211], a[8:11], v[56:59]
ds_read_b128 a[64:67], v10 offset:47104
ds_read_b128 a[68:71], v11 offset:47104
v_mfma_f32_16x16x32_bf16 v[56:59], a[216:219], a[12:15], v[56:59]
v_mfma_f32_16x16x32_bf16 v[60:63], a[212:215], a[8:11], v[60:63]
s_add_u32 s34, s38, 41943040
v_mfma_f32_16x16x32_bf16 v[60:63], a[220:223], a[12:15], v[60:63]
buffer_load_dwordx4 v24, s[44:47], s29 offen offset:3072 lds
v_mfma_f32_16x16x32_bf16 v[64:67], a[208:211], a[16:19], v[64:67]
v_mfma_f32_16x16x32_bf16 v[64:67], a[216:219], a[20:23], v[64:67]
v_mfma_f32_16x16x32_bf16 v[68:71], a[212:215], a[16:19], v[68:71]
s_add_u32 s29, s35, 0xfffffa00
v_mfma_f32_16x16x32_bf16 v[68:71], a[220:223], a[20:23], v[68:71]
buffer_load_dwordx4 v[240:243], v4, s[40:43], s34 offen sc1
v_mfma_f32_16x16x32_bf16 v[72:75], a[208:211], a[24:27], v[72:75]
v_mfma_f32_16x16x32_bf16 v[72:75], a[216:219], a[28:31], v[72:75]
v_mfma_f32_16x16x32_bf16 v[76:79], a[212:215], a[24:27], v[76:79]
v_mfma_f32_16x16x32_bf16 v[76:79], a[220:223], a[28:31], v[76:79]
s_waitcnt vmcnt(48) lgkmcnt(0)
s_barrier
v_mfma_f32_16x16x32_bf16 v[80:83], a[208:211], a[40:43], v[80:83]
s_add_u32 m0, s13, 32768
ds_read_b128 a[0:3], v12 offset:0
ds_read_b128 a[4:7], v13 offset:0
v_mfma_f32_16x16x32_bf16 v[80:83], a[216:219], a[44:47], v[80:83]
ds_read_b128 a[8:11], v12 offset:2048
ds_read_b128 a[12:15], v13 offset:2048
v_mfma_f32_16x16x32_bf16 v[84:87], a[212:215], a[40:43], v[84:87]
buffer_load_dwordx4 v21, s[44:47], s29 offen offset:0 lds
v_mfma_f32_16x16x32_bf16 v[84:87], a[220:223], a[44:47], v[84:87]
ds_read_b128 a[16:19], v12 offset:4096
ds_read_b128 a[20:23], v13 offset:4096
v_mfma_f32_16x16x32_bf16 v[88:91], a[208:211], a[48:51], v[88:91]
ds_read_b128 a[24:27], v12 offset:6144
ds_read_b128 a[28:31], v13 offset:6144
v_mfma_f32_16x16x32_bf16 v[88:91], a[216:219], a[52:55], v[88:91]
buffer_load_dwordx4 v22, s[44:47], s29 offen offset:1024 lds
v_mfma_f32_16x16x32_bf16 v[92:95], a[212:215], a[48:51], v[92:95]
v_mfma_f32_16x16x32_bf16 v[92:95], a[220:223], a[52:55], v[92:95]
v_mfma_f32_16x16x32_bf16 v[96:99], a[208:211], a[56:59], v[96:99]
buffer_load_dwordx4 v23, s[44:47], s29 offen offset:2048 lds
v_mfma_f32_16x16x32_bf16 v[96:99], a[216:219], a[60:63], v[96:99]
v_mfma_f32_16x16x32_bf16 v[100:103], a[212:215], a[56:59], v[100:103]
buffer_load_dwordx4 v24, s[44:47], s29 offen offset:3072 lds
v_mfma_f32_16x16x32_bf16 v[100:103], a[220:223], a[60:63], v[100:103]
v_mfma_f32_16x16x32_bf16 v[104:107], a[208:211], a[64:67], v[104:107]
s_add_u32 s34, s38, 41998336
v_mfma_f32_16x16x32_bf16 v[104:107], a[216:219], a[68:71], v[104:107]
v_mfma_f32_16x16x32_bf16 v[108:111], a[212:215], a[64:67], v[108:111]
v_mfma_f32_16x16x32_bf16 v[108:111], a[220:223], a[68:71], v[108:111]
s_waitcnt vmcnt(48) lgkmcnt(0)
ds_read_b128 a[40:43], v12 offset:8192
ds_read_b128 a[44:47], v13 offset:8192
v_mfma_f32_16x16x32_bf16 v[48:51], a[224:227], a[0:3], v[48:51]
ds_read_b128 a[48:51], v12 offset:10240
ds_read_b128 a[52:55], v13 offset:10240
v_mfma_f32_16x16x32_bf16 v[48:51], a[232:235], a[4:7], v[48:51]
ds_read_b128 a[56:59], v12 offset:12288
ds_read_b128 a[60:63], v13 offset:12288
v_mfma_f32_16x16x32_bf16 v[52:55], a[228:231], a[0:3], v[52:55]
buffer_load_dwordx4 v[244:247], v4, s[40:43], s34 offen sc1
v_mfma_f32_16x16x32_bf16 v[52:55], a[236:239], a[4:7], v[52:55]
v_mfma_f32_16x16x32_bf16 v[56:59], a[224:227], a[8:11], v[56:59]
s_sub_u32 s34, s33, 57344
s_cmp_eq_u32 s63, 0
v_mfma_f32_16x16x32_bf16 v[56:59], a[232:235], a[12:15], v[56:59]
ds_read_b128 a[64:67], v12 offset:14336
ds_read_b128 a[68:71], v13 offset:14336
v_mfma_f32_16x16x32_bf16 v[60:63], a[228:231], a[8:11], v[60:63]
v_mfma_f32_16x16x32_bf16 v[60:63], a[236:239], a[12:15], v[60:63]
buffer_load_dwordx4 a[176:179], v4, s[40:43], s34 offen offset:0 sc1
v_mfma_f32_16x16x32_bf16 v[64:67], a[224:227], a[16:19], v[64:67]
v_mfma_f32_16x16x32_bf16 v[64:67], a[232:235], a[20:23], v[64:67]
v_mfma_f32_16x16x32_bf16 v[68:71], a[228:231], a[16:19], v[68:71]
v_mfma_f32_16x16x32_bf16 v[68:71], a[236:239], a[20:23], v[68:71]
buffer_load_dwordx4 a[180:183], v4, s[40:43], s34 offen offset:1024 sc1
v_mfma_f32_16x16x32_bf16 v[72:75], a[224:227], a[24:27], v[72:75]
v_mfma_f32_16x16x32_bf16 v[72:75], a[232:235], a[28:31], v[72:75]
v_mfma_f32_16x16x32_bf16 v[76:79], a[228:231], a[24:27], v[76:79]
s_waitcnt vmcnt(16) lgkmcnt(0)
s_barrier
v_mfma_f32_16x16x32_bf16 v[76:79], a[236:239], a[28:31], v[76:79]
s_cbranch_scc1 kf_kernel_cwb8
kf_kernel_cwr8:
buffer_atomic_add v45, v29, s[40:43], s39 offen sc1
v_mfma_f32_16x16x32_bf16 v[80:83], a[224:227], a[40:43], v[80:83]
ds_read_b128 a[0:3], v12 offset:16384
ds_read_b128 a[4:7], v13 offset:16384
v_mfma_f32_16x16x32_bf16 v[80:83], a[232:235], a[44:47], v[80:83]
ds_read_b128 a[8:11], v12 offset:18432
ds_read_b128 a[12:15], v13 offset:18432
v_mfma_f32_16x16x32_bf16 v[84:87], a[228:231], a[40:43], v[84:87]
buffer_load_dwordx4 a[184:187], v4, s[40:43], s34 offen offset:2048 sc1
v_mfma_f32_16x16x32_bf16 v[84:87], a[236:239], a[44:47], v[84:87]
s_add_u32 m0, s14, 0
ds_read_b128 a[16:19], v12 offset:20480
ds_read_b128 a[20:23], v13 offset:20480
v_mfma_f32_16x16x32_bf16 v[88:91], a[224:227], a[48:51], v[88:91]
buffer_load_dwordx4 a[188:191], v4, s[40:43], s34 offen offset:3072 sc1
v_mfma_f32_16x16x32_bf16 v[88:91], a[232:235], a[52:55], v[88:91]
ds_read_b128 a[24:27], v12 offset:22528
ds_read_b128 a[28:31], v13 offset:22528
v_mfma_f32_16x16x32_bf16 v[92:95], a[228:231], a[48:51], v[92:95]
s_add_u32 s29, s35, 0xfffff980
v_mfma_f32_16x16x32_bf16 v[92:95], a[236:239], a[52:55], v[92:95]
v_mfma_f32_16x16x32_bf16 v[96:99], a[224:227], a[56:59], v[96:99]
buffer_load_dwordx4 v21, s[44:47], s29 offen offset:0 lds
v_mfma_f32_16x16x32_bf16 v[96:99], a[232:235], a[60:63], v[96:99]
v_mfma_f32_16x16x32_bf16 v[100:103], a[228:231], a[56:59], v[100:103]
v_mfma_f32_16x16x32_bf16 v[100:103], a[236:239], a[60:63], v[100:103]
buffer_load_dwordx4 v22, s[44:47], s29 offen offset:1024 lds
v_mfma_f32_16x16x32_bf16 v[104:107], a[224:227], a[64:67], v[104:107]
v_mfma_f32_16x16x32_bf16 v[104:107], a[232:235], a[68:71], v[104:107]
v_mfma_f32_16x16x32_bf16 v[108:111], a[228:231], a[64:67], v[108:111]
v_mfma_f32_16x16x32_bf16 v[108:111], a[236:239], a[68:71], v[108:111]
s_waitcnt vmcnt(48) lgkmcnt(0)
ds_read_b128 a[40:43], v12 offset:24576
ds_read_b128 a[44:47], v13 offset:24576
v_mfma_f32_16x16x32_bf16 v[48:51], a[240:243], a[0:3], v[48:51]
ds_read_b128 a[48:51], v12 offset:26624
ds_read_b128 a[52:55], v13 offset:26624
v_mfma_f32_16x16x32_bf16 v[48:51], a[248:251], a[4:7], v[48:51]
ds_read_b128 a[56:59], v12 offset:28672
ds_read_b128 a[60:63], v13 offset:28672
v_mfma_f32_16x16x32_bf16 v[52:55], a[244:247], a[0:3], v[52:55]
buffer_load_dwordx4 v23, s[44:47], s29 offen offset:2048 lds
v_mfma_f32_16x16x32_bf16 v[52:55], a[252:255], a[4:7], v[52:55]
v_mfma_f32_16x16x32_bf16 v[56:59], a[240:243], a[8:11], v[56:59]
v_mfma_f32_16x16x32_bf16 v[56:59], a[248:251], a[12:15], v[56:59]
ds_read_b128 a[64:67], v12 offset:30720
ds_read_b128 a[68:71], v13 offset:30720
v_mfma_f32_16x16x32_bf16 v[60:63], a[244:247], a[8:11], v[60:63]
v_mfma_f32_16x16x32_bf16 v[60:63], a[252:255], a[12:15], v[60:63]
buffer_load_dwordx4 v24, s[44:47], s29 offen offset:3072 lds
v_mfma_f32_16x16x32_bf16 v[64:67], a[240:243], a[16:19], v[64:67]
s_add_u32 s34, s38, 42053632
v_mfma_f32_16x16x32_bf16 v[64:67], a[248:251], a[20:23], v[64:67]
v_mfma_f32_16x16x32_bf16 v[68:71], a[244:247], a[16:19], v[68:71]
v_mfma_f32_16x16x32_bf16 v[68:71], a[252:255], a[20:23], v[68:71]
buffer_load_dwordx4 v[248:251], v4, s[40:43], s34 offen sc1
v_mfma_f32_16x16x32_bf16 v[72:75], a[240:243], a[24:27], v[72:75]
v_mfma_f32_16x16x32_bf16 v[72:75], a[248:251], a[28:31], v[72:75]
s_add_u32 m0, s14, 16384
v_mfma_f32_16x16x32_bf16 v[76:79], a[244:247], a[24:27], v[76:79]
s_add_u32 s29, s35, 0xfffff900
v_mfma_f32_16x16x32_bf16 v[76:79], a[252:255], a[28:31], v[76:79]
s_waitcnt vmcnt(48) lgkmcnt(0)
s_barrier
v_mfma_f32_16x16x32_bf16 v[80:83], a[240:243], a[40:43], v[80:83]
ds_read_b128 a[0:3], v10 offset:49152
ds_read_b128 a[4:7], v11 offset:49152
v_mfma_f32_16x16x32_bf16 v[80:83], a[248:251], a[44:47], v[80:83]
ds_read_b128 a[8:11], v10 offset:51200
ds_read_b128 a[12:15], v11 offset:51200
v_mfma_f32_16x16x32_bf16 v[84:87], a[244:247], a[40:43], v[84:87]
buffer_load_dwordx4 v21, s[44:47], s29 offen offset:0 lds
v_mfma_f32_16x16x32_bf16 v[84:87], a[252:255], a[44:47], v[84:87]
s_add_u32 s34, s38, 42108928
ds_read_b128 a[16:19], v10 offset:53248
ds_read_b128 a[20:23], v11 offset:53248
v_mfma_f32_16x16x32_bf16 v[88:91], a[240:243], a[48:51], v[88:91]
ds_read_b128 a[24:27], v10 offset:55296
ds_read_b128 a[28:31], v11 offset:55296
v_mfma_f32_16x16x32_bf16 v[88:91], a[248:251], a[52:55], v[88:91]
buffer_load_dwordx4 v22, s[44:47], s29 offen offset:1024 lds
v_mfma_f32_16x16x32_bf16 v[92:95], a[244:247], a[48:51], v[92:95]
v_mfma_f32_16x16x32_bf16 v[92:95], a[252:255], a[52:55], v[92:95]
v_mfma_f32_16x16x32_bf16 v[96:99], a[240:243], a[56:59], v[96:99]
buffer_load_dwordx4 v23, s[44:47], s29 offen offset:2048 lds
v_mfma_f32_16x16x32_bf16 v[96:99], a[248:251], a[60:63], v[96:99]
v_mfma_f32_16x16x32_bf16 v[100:103], a[244:247], a[56:59], v[100:103]
v_mfma_f32_16x16x32_bf16 v[100:103], a[252:255], a[60:63], v[100:103]
buffer_load_dwordx4 v24, s[44:47], s29 offen offset:3072 lds
v_mfma_f32_16x16x32_bf16 v[104:107], a[240:243], a[64:67], v[104:107]
v_mfma_f32_16x16x32_bf16 v[104:107], a[248:251], a[68:71], v[104:107]
v_mfma_f32_16x16x32_bf16 v[108:111], a[244:247], a[64:67], v[108:111]
v_mfma_f32_16x16x32_bf16 v[108:111], a[252:255], a[68:71], v[108:111]
s_waitcnt vmcnt(48) lgkmcnt(0)
ds_read_b128 a[40:43], v10 offset:57344
ds_read_b128 a[44:47], v11 offset:57344
v_mfma_f32_16x16x32_bf16 v[48:51], a[80:83], a[0:3], v[48:51]
s_add_u32 s34, s34, s52
ds_read_b128 a[48:51], v10 offset:59392
ds_read_b128 a[52:55], v11 offset:59392
v_mfma_f32_16x16x32_bf16 v[48:51], a[88:91], a[4:7], v[48:51]
ds_read_b128 a[56:59], v10 offset:61440
ds_read_b128 a[60:63], v11 offset:61440
v_mfma_f32_16x16x32_bf16 v[52:55], a[84:87], a[0:3], v[52:55]
buffer_load_dwordx4 v[252:255], v4, s[40:43], s34 offen sc1
v_mfma_f32_16x16x32_bf16 v[52:55], a[92:95], a[4:7], v[52:55]
ds_read_b128 a[64:67], v10 offset:63488
ds_read_b128 a[68:71], v11 offset:63488
v_mfma_f32_16x16x32_bf16 v[56:59], a[80:83], a[8:11], v[56:59]
s_sub_u32 s34, s33, 61440
v_mfma_f32_16x16x32_bf16 v[56:59], a[88:91], a[12:15], v[56:59]
v_mfma_f32_16x16x32_bf16 v[60:63], a[84:87], a[8:11], v[60:63]
v_mfma_f32_16x16x32_bf16 v[60:63], a[92:95], a[12:15], v[60:63]
buffer_load_dwordx4 a[192:195], v4, s[40:43], s34 offen offset:0 sc1
v_mfma_f32_16x16x32_bf16 v[64:67], a[80:83], a[16:19], v[64:67]
v_mfma_f32_16x16x32_bf16 v[64:67], a[88:91], a[20:23], v[64:67]
s_add_u32 s29, s35, 0xfffff880
v_mfma_f32_16x16x32_bf16 v[68:71], a[84:87], a[16:19], v[68:71]
v_mfma_f32_16x16x32_bf16 v[68:71], a[92:95], a[20:23], v[68:71]
buffer_load_dwordx4 a[196:199], v4, s[40:43], s34 offen offset:1024 sc1
v_mfma_f32_16x16x32_bf16 v[72:75], a[80:83], a[24:27], v[72:75]
v_mfma_f32_16x16x32_bf16 v[72:75], a[88:91], a[28:31], v[72:75]
v_mfma_f32_16x16x32_bf16 v[76:79], a[84:87], a[24:27], v[76:79]
v_mfma_f32_16x16x32_bf16 v[76:79], a[92:95], a[28:31], v[76:79]
s_waitcnt vmcnt(48) lgkmcnt(0)
s_barrier
v_mfma_f32_16x16x32_bf16 v[80:83], a[80:83], a[40:43], v[80:83]
ds_read_b128 a[0:3], v8 offset:0
ds_read_b128 a[4:7], v9 offset:0
v_mfma_f32_16x16x32_bf16 v[80:83], a[88:91], a[44:47], v[80:83]
buffer_load_dwordx4 a[200:203], v4, s[40:43], s34 offen offset:2048 sc1
v_mfma_f32_16x16x32_bf16 v[84:87], a[84:87], a[40:43], v[84:87]
ds_read_b128 a[8:11], v8 offset:2048
ds_read_b128 a[12:15], v9 offset:2048
v_mfma_f32_16x16x32_bf16 v[84:87], a[92:95], a[44:47], v[84:87]
ds_read_b128 a[16:19], v8 offset:4096
ds_read_b128 a[20:23], v9 offset:4096
v_mfma_f32_16x16x32_bf16 v[88:91], a[80:83], a[48:51], v[88:91]
buffer_load_dwordx4 a[204:207], v4, s[40:43], s34 offen offset:3072 sc1
v_mfma_f32_16x16x32_bf16 v[88:91], a[88:91], a[52:55], v[88:91]
v_mfma_f32_16x16x32_bf16 v[92:95], a[84:87], a[48:51], v[92:95]
s_add_u32 m0, s13, 49152
ds_read_b128 a[24:27], v8 offset:6144
ds_read_b128 a[28:31], v9 offset:6144
v_mfma_f32_16x16x32_bf16 v[92:95], a[92:95], a[52:55], v[92:95]
buffer_load_dwordx4 v21, s[44:47], s29 offen offset:0 lds
v_mfma_f32_16x16x32_bf16 v[96:99], a[80:83], a[56:59], v[96:99]
v_mfma_f32_16x16x32_bf16 v[96:99], a[88:91], a[60:63], v[96:99]
v_mfma_f32_16x16x32_bf16 v[100:103], a[84:87], a[56:59], v[100:103]
v_mfma_f32_16x16x32_bf16 v[100:103], a[92:95], a[60:63], v[100:103]
buffer_load_dwordx4 v22, s[44:47], s29 offen offset:1024 lds
v_mfma_f32_16x16x32_bf16 v[104:107], a[80:83], a[64:67], v[104:107]
v_mfma_f32_16x16x32_bf16 v[104:107], a[88:91], a[68:71], v[104:107]
v_mfma_f32_16x16x32_bf16 v[108:111], a[84:87], a[64:67], v[108:111]
v_mfma_f32_16x16x32_bf16 v[108:111], a[92:95], a[68:71], v[108:111]
s_waitcnt vmcnt(48) lgkmcnt(0)
ds_read_b128 a[40:43], v8 offset:8192
ds_read_b128 a[44:47], v9 offset:8192
v_mfma_f32_16x16x32_bf16 v[48:51], a[96:99], a[0:3], v[48:51]
ds_read_b128 a[48:51], v8 offset:10240
ds_read_b128 a[52:55], v9 offset:10240
v_mfma_f32_16x16x32_bf16 v[48:51], a[104:107], a[4:7], v[48:51]
ds_read_b128 a[56:59], v8 offset:12288
v_mfma_f32_16x16x32_bf16 v[52:55], a[100:103], a[0:3], v[52:55]
buffer_load_dwordx4 v23, s[44:47], s29 offen offset:2048 lds
v_mfma_f32_16x16x32_bf16 v[52:55], a[108:111], a[4:7], v[52:55]
ds_read_b128 a[60:63], v9 offset:12288
ds_read_b128 a[64:67], v8 offset:14336
v_mfma_f32_16x16x32_bf16 v[56:59], a[96:99], a[8:11], v[56:59]
v_mfma_f32_16x16x32_bf16 v[56:59], a[104:107], a[12:15], v[56:59]
ds_read_b128 a[68:71], v9 offset:14336
v_mfma_f32_16x16x32_bf16 v[60:63], a[100:103], a[8:11], v[60:63]
v_mfma_f32_16x16x32_bf16 v[60:63], a[108:111], a[12:15], v[60:63]
buffer_load_dwordx4 v24, s[44:47], s29 offen offset:3072 lds
v_mfma_f32_16x16x32_bf16 v[64:67], a[96:99], a[16:19], v[64:67]
v_mfma_f32_16x16x32_bf16 v[64:67], a[104:107], a[20:23], v[64:67]
v_mfma_f32_16x16x32_bf16 v[68:71], a[100:103], a[16:19], v[68:71]
s_add_u32 m0, s32, 20480
s_xor_b32 s29, s18, 0
v_mfma_f32_16x16x32_bf16 v[68:71], a[108:111], a[20:23], v[68:71]
buffer_load_dwordx4 v4, s[40:43], s29 offen offset:0 sc1 lds
v_mfma_f32_16x16x32_bf16 v[72:75], a[96:99], a[24:27], v[72:75]
v_mfma_f32_16x16x32_bf16 v[72:75], a[104:107], a[28:31], v[72:75]
v_mfma_f32_16x16x32_bf16 v[76:79], a[100:103], a[24:27], v[76:79]
v_mfma_f32_16x16x32_bf16 v[76:79], a[108:111], a[28:31], v[76:79]
s_waitcnt vmcnt(34) lgkmcnt(0)
s_barrier
ds_read_b128 a[0:3], v10 offset:0
v_mfma_f32_16x16x32_bf16 v[80:83], a[96:99], a[40:43], v[80:83]
ds_read_b128 a[4:7], v11 offset:0
ds_read_b128 a[8:11], v10 offset:2048
v_mfma_f32_16x16x32_bf16 v[80:83], a[104:107], a[44:47], v[80:83]
buffer_load_dwordx4 v4, s[40:43], s29 offen offset:1024 sc1 lds
v_mfma_f32_16x16x32_bf16 v[84:87], a[100:103], a[40:43], v[84:87]
ds_read_b128 a[12:15], v11 offset:2048
ds_read_b128 a[16:19], v10 offset:4096
v_mfma_f32_16x16x32_bf16 v[84:87], a[108:111], a[44:47], v[84:87]
ds_read_b128 a[20:23], v11 offset:4096
ds_read_b128 a[24:27], v10 offset:6144
v_mfma_f32_16x16x32_bf16 v[88:91], a[96:99], a[48:51], v[88:91]
ds_read_b128 a[28:31], v11 offset:6144
v_mfma_f32_16x16x32_bf16 v[88:91], a[104:107], a[52:55], v[88:91]
buffer_load_dwordx4 v4, s[40:43], s29 offen offset:2048 sc1 lds
v_mfma_f32_16x16x32_bf16 v[92:95], a[100:103], a[48:51], v[92:95]
v_mfma_f32_16x16x32_bf16 v[92:95], a[108:111], a[52:55], v[92:95]
v_mfma_f32_16x16x32_bf16 v[96:99], a[96:99], a[56:59], v[96:99]
buffer_load_dwordx4 v4, s[40:43], s29 offen offset:3072 sc1 lds
v_mfma_f32_16x16x32_bf16 v[96:99], a[104:107], a[60:63], v[96:99]
v_mfma_f32_16x16x32_bf16 v[100:103], a[100:103], a[56:59], v[100:103]
s_add_u32 m0, s32, 21504
s_add_u32 s29, s29, 1024
v_mfma_f32_16x16x32_bf16 v[100:103], a[108:111], a[60:63], v[100:103]
buffer_load_dwordx4 v4, s[40:43], s29 offen offset:3072 sc1 lds
v_mfma_f32_16x16x32_bf16 v[104:107], a[96:99], a[64:67], v[104:107]
v_mfma_f32_16x16x32_bf16 v[104:107], a[104:107], a[68:71], v[104:107]
s_add_u32 m0, s32, 40960
v_mfma_f32_16x16x32_bf16 v[108:111], a[100:103], a[64:67], v[108:111]
v_mfma_f32_16x16x32_bf16 v[108:111], a[108:111], a[68:71], v[108:111]
s_waitcnt vmcnt(48) lgkmcnt(0)
ds_read_b128 a[40:43], v10 offset:8192
ds_read_b128 a[44:47], v11 offset:8192
v_mfma_f32_16x16x32_bf16 v[48:51], a[112:115], a[0:3], v[48:51]
s_xor_b32 s29, s18, 131072
ds_read_b128 a[48:51], v10 offset:10240
ds_read_b128 a[52:55], v11 offset:10240
v_mfma_f32_16x16x32_bf16 v[48:51], a[120:123], a[4:7], v[48:51]
ds_read_b128 a[56:59], v10 offset:12288
ds_read_b128 a[60:63], v11 offset:12288
v_mfma_f32_16x16x32_bf16 v[52:55], a[116:119], a[0:3], v[52:55]
buffer_load_dword v30, v44, s[40:43], s39 offen sc1
v_mfma_f32_16x16x32_bf16 v[52:55], a[124:127], a[4:7], v[52:55]
ds_read_b128 a[64:67], v10 offset:14336
ds_read_b128 a[68:71], v11 offset:14336
v_mfma_f32_16x16x32_bf16 v[56:59], a[112:115], a[8:11], v[56:59]
v_mfma_f32_16x16x32_bf16 v[56:59], a[120:123], a[12:15], v[56:59]
v_mfma_f32_16x16x32_bf16 v[60:63], a[116:119], a[8:11], v[60:63]
v_mfma_f32_16x16x32_bf16 v[60:63], a[124:127], a[12:15], v[60:63]
buffer_load_dwordx4 v4, s[40:43], s29 offen offset:0 sc1 lds
v_mfma_f32_16x16x32_bf16 v[64:67], a[112:115], a[16:19], v[64:67]
v_mfma_f32_16x16x32_bf16 v[64:67], a[120:123], a[20:23], v[64:67]
v_mfma_f32_16x16x32_bf16 v[68:71], a[116:119], a[16:19], v[68:71]
v_mfma_f32_16x16x32_bf16 v[68:71], a[124:127], a[20:23], v[68:71]
buffer_load_dwordx4 v4, s[40:43], s29 offen offset:1024 sc1 lds
v_mfma_f32_16x16x32_bf16 v[72:75], a[112:115], a[24:27], v[72:75]
v_mfma_f32_16x16x32_bf16 v[72:75], a[120:123], a[28:31], v[72:75]
v_mfma_f32_16x16x32_bf16 v[76:79], a[116:119], a[24:27], v[76:79]
v_mfma_f32_16x16x32_bf16 v[76:79], a[124:127], a[28:31], v[76:79]
s_waitcnt vmcnt(37) lgkmcnt(0)
s_barrier
ds_read_b128 a[0:3], v10 offset:16384
v_mfma_f32_16x16x32_bf16 v[80:83], a[112:115], a[40:43], v[80:83]
s_xor_b32 s3, s53, 4
ds_read_b128 a[4:7], v11 offset:16384
ds_read_b128 a[8:11], v10 offset:18432
v_mfma_f32_16x16x32_bf16 v[80:83], a[120:123], a[44:47], v[80:83]
s_mul_i32 s13, s3, 5120
ds_read_b128 a[12:15], v11 offset:18432
ds_read_b128 a[16:19], v10 offset:20480
v_mfma_f32_16x16x32_bf16 v[84:87], a[116:119], a[40:43], v[84:87]
s_mul_i32 s3, s55, 7
ds_read_b128 a[20:23], v11 offset:20480
v_mfma_f32_16x16x32_bf16 v[84:87], a[124:127], a[44:47], v[84:87]
buffer_load_dwordx4 v4, s[40:43], s29 offen offset:2048 sc1 lds
v_mfma_f32_16x16x32_bf16 v[88:91], a[112:115], a[48:51], v[88:91]
s_add_u32 s3, s3, s20
ds_read_b128 a[24:27], v10 offset:22528
ds_read_b128 a[28:31], v11 offset:22528
v_mfma_f32_16x16x32_bf16 v[88:91], a[120:123], a[52:55], v[88:91]
buffer_load_dwordx4 v4, s[40:43], s29 offen offset:3072 sc1 lds
v_mfma_f32_16x16x32_bf16 v[92:95], a[116:119], a[48:51], v[92:95]
s_mul_i32 s12, s53, 5120
s_sub_u32 s13, s13, s12
s_cmp_ge_u32 s3, 23
v_mfma_f32_16x16x32_bf16 v[92:95], a[124:127], a[52:55], v[92:95]
s_cselect_b32 s50, 1073741824, 0
s_add_u32 m0, s32, 41984
s_add_u32 s29, s29, 1024
v_mfma_f32_16x16x32_bf16 v[96:99], a[112:115], a[56:59], v[96:99]
buffer_load_dwordx4 v4, s[40:43], s29 offen offset:3072 sc1 lds
v_mfma_f32_16x16x32_bf16 v[96:99], a[120:123], a[60:63], v[96:99]
s_add_u32 m0, s32, 0
v_mfma_f32_16x16x32_bf16 v[100:103], a[116:119], a[56:59], v[100:103]
s_xor_b32 s29, s18, 262144
v_mfma_f32_16x16x32_bf16 v[100:103], a[124:127], a[60:63], v[100:103]
buffer_load_dwordx4 v4, s[40:43], s29 offen offset:0 sc1 lds
v_mfma_f32_16x16x32_bf16 v[104:107], a[112:115], a[64:67], v[104:107]
v_mfma_f32_16x16x32_bf16 v[104:107], a[120:123], a[68:71], v[104:107]
s_lshl_b32 s3, s3, 16
s_add_u32 s19, s12, s3
s_lshl2_add_u32 s3, s21, s20
v_mfma_f32_16x16x32_bf16 v[108:111], a[116:119], a[64:67], v[108:111]
s_lshl_b32 s3, s3, 16
s_add_u32 s12, s12, s3
s_add_u32 s12, s12, 104857600
v_mfma_f32_16x16x32_bf16 v[108:111], a[124:127], a[68:71], v[108:111]
s_waitcnt vmcnt(48) lgkmcnt(0)
ds_read_b128 a[40:43], v10 offset:24576
ds_read_b128 a[44:47], v11 offset:24576
v_mfma_f32_16x16x32_bf16 v[48:51], a[128:131], a[0:3], v[48:51]
ds_read_b128 a[48:51], v10 offset:26624
ds_read_b128 a[52:55], v11 offset:26624
v_mfma_f32_16x16x32_bf16 v[48:51], a[136:139], a[4:7], v[48:51]
ds_read_b128 a[56:59], v10 offset:28672
ds_read_b128 a[60:63], v11 offset:28672
v_mfma_f32_16x16x32_bf16 v[52:55], a[132:135], a[0:3], v[52:55]
buffer_load_dwordx4 v4, s[40:43], s29 offen offset:1024 sc1 lds
v_mfma_f32_16x16x32_bf16 v[52:55], a[140:143], a[4:7], v[52:55]
ds_read_b128 a[64:67], v10 offset:30720
ds_read_b128 a[68:71], v11 offset:30720
v_mfma_f32_16x16x32_bf16 v[56:59], a[128:131], a[8:11], v[56:59]
v_mfma_f32_16x16x32_bf16 v[56:59], a[136:139], a[12:15], v[56:59]
v_mfma_f32_16x16x32_bf16 v[60:63], a[132:135], a[8:11], v[60:63]
buffer_load_dwordx4 v4, s[40:43], s29 offen offset:2048 sc1 lds
v_mfma_f32_16x16x32_bf16 v[60:63], a[140:143], a[12:15], v[60:63]
v_mfma_f32_16x16x32_bf16 v[64:67], a[128:131], a[16:19], v[64:67]
v_mfma_f32_16x16x32_bf16 v[64:67], a[136:139], a[20:23], v[64:67]
v_mfma_f32_16x16x32_bf16 v[68:71], a[132:135], a[16:19], v[68:71]
s_cmp_eq_u32 s20, 3
v_mfma_f32_16x16x32_bf16 v[68:71], a[140:143], a[20:23], v[68:71]
buffer_load_dwordx4 v4, s[40:43], s29 offen offset:3072 sc1 lds
v_mfma_f32_16x16x32_bf16 v[72:75], a[128:131], a[24:27], v[72:75]
s_cselect_b32 s50, 1073741824, s50
s_add_u32 m0, s32, 1024
v_mfma_f32_16x16x32_bf16 v[72:75], a[136:139], a[28:31], v[72:75]
s_add_u32 s29, s29, 1024
v_mfma_f32_16x16x32_bf16 v[76:79], a[132:135], a[24:27], v[76:79]
s_waitcnt vmcnt(39) lgkmcnt(0)
s_barrier
v_mfma_f32_16x16x32_bf16 v[76:79], a[140:143], a[28:31], v[76:79]
ds_read_b128 a[0:3], v10 offset:32768
ds_read_b128 a[4:7], v11 offset:32768
v_mfma_f32_16x16x32_bf16 v[80:83], a[128:131], a[40:43], v[80:83]
buffer_load_dwordx4 v4, s[40:43], s29 offen offset:3072 sc1 lds
v_mfma_f32_16x16x32_bf16 v[80:83], a[136:139], a[44:47], v[80:83]
ds_read_b128 a[8:11], v10 offset:34816
ds_read_b128 a[12:15], v11 offset:34816
v_mfma_f32_16x16x32_bf16 v[84:87], a[132:135], a[40:43], v[84:87]
s_xor_b32 s29, s18, 393216
ds_read_b128 a[16:19], v10 offset:36864
ds_read_b128 a[20:23], v11 offset:36864
v_mfma_f32_16x16x32_bf16 v[84:87], a[140:143], a[44:47], v[84:87]
ds_read_b128 a[24:27], v10 offset:38912
v_mfma_f32_16x16x32_bf16 v[88:91], a[128:131], a[48:51], v[88:91]
s_add_u32 m0, s26, 0
ds_read_b128 a[28:31], v11 offset:38912
v_mfma_f32_16x16x32_bf16 v[88:91], a[136:139], a[52:55], v[88:91]
buffer_load_dwordx4 v4, s[40:43], s29 offen offset:0 sc1 lds
v_mfma_f32_16x16x32_bf16 v[92:95], a[132:135], a[48:51], v[92:95]
v_mfma_f32_16x16x32_bf16 v[92:95], a[140:143], a[52:55], v[92:95]
v_mfma_f32_16x16x32_bf16 v[96:99], a[128:131], a[56:59], v[96:99]
buffer_load_dwordx4 v4, s[40:43], s29 offen offset:1024 sc1 lds
v_mfma_f32_16x16x32_bf16 v[96:99], a[136:139], a[60:63], v[96:99]
v_mfma_f32_16x16x32_bf16 v[100:103], a[132:135], a[56:59], v[100:103]
v_mfma_f32_16x16x32_bf16 v[100:103], a[140:143], a[60:63], v[100:103]
buffer_load_dwordx4 v4, s[40:43], s29 offen offset:2048 sc1 lds
v_mfma_f32_16x16x32_bf16 v[104:107], a[128:131], a[64:67], v[104:107]
v_mfma_f32_16x16x32_bf16 v[104:107], a[136:139], a[68:71], v[104:107]
v_mfma_f32_16x16x32_bf16 v[108:111], a[132:135], a[64:67], v[108:111]
s_waitcnt vmcnt(13) lgkmcnt(0)
v_cmp_gt_u32 vcc, 8, v30
s_cmp_lg_u64 vcc, 0
v_mfma_f32_16x16x32_bf16 v[108:111], a[140:143], a[68:71], v[108:111]
s_cbranch_scc1 kf_kernel_spin_ctx8
kf_kernel_ret_ctx8:
v_mfma_f32_16x16x32_bf16 v[48:51], a[144:147], a[0:3], v[48:51]
ds_read_b128 a[40:43], v10 offset:40960
ds_read_b128 a[44:47], v11 offset:40960
v_mfma_f32_16x16x32_bf16 v[48:51], a[152:155], a[4:7], v[48:51]
ds_read_b128 a[48:51], v10 offset:43008
ds_read_b128 a[52:55], v11 offset:43008
v_mfma_f32_16x16x32_bf16 v[52:55], a[148:151], a[0:3], v[52:55]
buffer_load_dwordx4 v4, s[40:43], s29 offen offset:3072 sc1 lds
v_mfma_f32_16x16x32_bf16 v[52:55], a[156:159], a[4:7], v[52:55]
ds_read_b128 a[56:59], v10 offset:45056
ds_read_b128 a[60:63], v11 offset:45056
v_mfma_f32_16x16x32_bf16 v[56:59], a[144:147], a[8:11], v[56:59]
s_add_u32 s29, s29, 1024
ds_read_b128 a[64:67], v10 offset:47104
v_mfma_f32_16x16x32_bf16 v[56:59], a[152:155], a[12:15], v[56:59]
ds_read_b128 a[68:71], v11 offset:47104
s_add_u32 m0, s26, 1024
v_mfma_f32_16x16x32_bf16 v[60:63], a[148:151], a[8:11], v[60:63]
v_mfma_f32_16x16x32_bf16 v[60:63], a[156:159], a[12:15], v[60:63]
buffer_load_dwordx4 v4, s[40:43], s29 offen offset:3072 sc1 lds
v_mfma_f32_16x16x32_bf16 v[64:67], a[144:147], a[16:19], v[64:67]
s_xor_b32 s34, s16, 4096
v_mfma_f32_16x16x32_bf16 v[64:67], a[152:155], a[20:23], v[64:67]
s_add_u32 m0, s26, 20480
v_mfma_f32_16x16x32_bf16 v[68:71], a[148:151], a[16:19], v[68:71]
v_mfma_f32_16x16x32_bf16 v[68:71], a[156:159], a[20:23], v[68:71]
buffer_load_dwordx4 a[240:243], v4, s[40:43], s34 offen sc1
v_mfma_f32_16x16x32_bf16 v[72:75], a[144:147], a[24:27], v[72:75]
v_mfma_f32_16x16x32_bf16 v[72:75], a[152:155], a[28:31], v[72:75]
v_mfma_f32_16x16x32_bf16 v[76:79], a[148:151], a[24:27], v[76:79]
v_mfma_f32_16x16x32_bf16 v[76:79], a[156:159], a[28:31], v[76:79]
s_waitcnt vmcnt(36) lgkmcnt(0)
s_barrier
v_mfma_f32_16x16x32_bf16 v[80:83], a[144:147], a[40:43], v[80:83]
ds_read_b128 a[0:3], v12 offset:0
ds_read_b128 a[4:7], v13 offset:0
v_mfma_f32_16x16x32_bf16 v[80:83], a[152:155], a[44:47], v[80:83]
ds_read_b128 a[8:11], v12 offset:2048
ds_read_b128 a[12:15], v13 offset:2048
v_mfma_f32_16x16x32_bf16 v[84:87], a[148:151], a[40:43], v[84:87]
buffer_load_dwordx4 a[248:251], v4, s[40:43], s34 offen offset:1024 sc1
v_mfma_f32_16x16x32_bf16 v[84:87], a[156:159], a[44:47], v[84:87]
s_xor_b32 s34, s17, 4096
ds_read_b128 a[16:19], v12 offset:4096
ds_read_b128 a[20:23], v13 offset:4096
v_mfma_f32_16x16x32_bf16 v[88:91], a[144:147], a[48:51], v[88:91]
v_mfma_f32_16x16x32_bf16 v[88:91], a[152:155], a[52:55], v[88:91]
buffer_load_dwordx4 a[244:247], v4, s[40:43], s34 offen sc1
v_mfma_f32_16x16x32_bf16 v[92:95], a[148:151], a[48:51], v[92:95]
s_xor_b32 s29, s18, 524288
ds_read_b128 a[24:27], v12 offset:6144
ds_read_b128 a[28:31], v13 offset:6144
v_mfma_f32_16x16x32_bf16 v[92:95], a[156:159], a[52:55], v[92:95]
v_mfma_f32_16x16x32_bf16 v[96:99], a[144:147], a[56:59], v[96:99]
buffer_load_dwordx4 a[252:255], v4, s[40:43], s34 offen offset:1024 sc1
v_mfma_f32_16x16x32_bf16 v[96:99], a[152:155], a[60:63], v[96:99]
v_mfma_f32_16x16x32_bf16 v[100:103], a[148:151], a[56:59], v[100:103]
s_xor_b32 s34, s16, 6144
v_mfma_f32_16x16x32_bf16 v[100:103], a[156:159], a[60:63], v[100:103]
buffer_load_dwordx4 a[80:83], v4, s[40:43], s34 offen sc1
v_mfma_f32_16x16x32_bf16 v[104:107], a[144:147], a[64:67], v[104:107]
v_mfma_f32_16x16x32_bf16 v[104:107], a[152:155], a[68:71], v[104:107]
v_mfma_f32_16x16x32_bf16 v[108:111], a[148:151], a[64:67], v[108:111]
v_mfma_f32_16x16x32_bf16 v[108:111], a[156:159], a[68:71], v[108:111]
s_waitcnt vmcnt(48) lgkmcnt(0)
buffer_load_dwordx4 a[88:91], v4, s[40:43], s34 offen offset:1024 sc1
v_mfma_f32_16x16x32_bf16 v[48:51], a[160:163], a[0:3], v[48:51]
ds_read_b128 a[40:43], v12 offset:8192
ds_read_b128 a[44:47], v13 offset:8192
v_mfma_f32_16x16x32_bf16 v[48:51], a[168:171], a[4:7], v[48:51]
ds_read_b128 a[48:51], v12 offset:10240
ds_read_b128 a[52:55], v13 offset:10240
v_mfma_f32_16x16x32_bf16 v[52:55], a[164:167], a[0:3], v[52:55]
s_xor_b32 s34, s17, 6144
ds_read_b128 a[56:59], v12 offset:12288
v_mfma_f32_16x16x32_bf16 v[52:55], a[172:175], a[4:7], v[52:55]
v_mfma_f32_16x16x32_bf16 v[56:59], a[160:163], a[8:11], v[56:59]
ds_read_b128 a[60:63], v13 offset:12288
v_mfma_f32_16x16x32_bf16 v[56:59], a[168:171], a[12:15], v[56:59]
ds_read_b128 a[64:67], v12 offset:14336
ds_read_b128 a[68:71], v13 offset:14336
v_mfma_f32_16x16x32_bf16 v[60:63], a[164:167], a[8:11], v[60:63]
v_mfma_f32_16x16x32_bf16 v[60:63], a[172:175], a[12:15], v[60:63]
buffer_load_dwordx4 a[84:87], v4, s[40:43], s34 offen sc1
v_mfma_f32_16x16x32_bf16 v[64:67], a[160:163], a[16:19], v[64:67]
v_mfma_f32_16x16x32_bf16 v[64:67], a[168:171], a[20:23], v[64:67]
v_mfma_f32_16x16x32_bf16 v[68:71], a[164:167], a[16:19], v[68:71]
v_mfma_f32_16x16x32_bf16 v[68:71], a[172:175], a[20:23], v[68:71]
buffer_load_dwordx4 a[92:95], v4, s[40:43], s34 offen offset:1024 sc1
v_mfma_f32_16x16x32_bf16 v[72:75], a[160:163], a[24:27], v[72:75]
v_mfma_f32_16x16x32_bf16 v[72:75], a[168:171], a[28:31], v[72:75]
v_mfma_f32_16x16x32_bf16 v[76:79], a[164:167], a[24:27], v[76:79]
v_mfma_f32_16x16x32_bf16 v[76:79], a[172:175], a[28:31], v[76:79]
s_waitcnt vmcnt(38) lgkmcnt(0)
s_barrier
v_mfma_f32_16x16x32_bf16 v[80:83], a[160:163], a[40:43], v[80:83]
ds_read_b128 a[0:3], v12 offset:16384
ds_read_b128 a[4:7], v13 offset:16384
v_mfma_f32_16x16x32_bf16 v[80:83], a[168:171], a[44:47], v[80:83]
ds_read_b128 a[8:11], v12 offset:18432
ds_read_b128 a[12:15], v13 offset:18432
v_mfma_f32_16x16x32_bf16 v[84:87], a[164:167], a[40:43], v[84:87]
buffer_load_dwordx4 v4, s[40:43], s29 offen offset:0 sc1 lds
v_mfma_f32_16x16x32_bf16 v[84:87], a[172:175], a[44:47], v[84:87]
ds_read_b128 a[16:19], v12 offset:20480
ds_read_b128 a[20:23], v13 offset:20480
v_mfma_f32_16x16x32_bf16 v[88:91], a[160:163], a[48:51], v[88:91]
ds_read_b128 a[24:27], v12 offset:22528
ds_read_b128 a[28:31], v13 offset:22528
v_mfma_f32_16x16x32_bf16 v[88:91], a[168:171], a[52:55], v[88:91]
buffer_load_dwordx4 v4, s[40:43], s29 offen offset:1024 sc1 lds
v_mfma_f32_16x16x32_bf16 v[92:95], a[164:167], a[48:51], v[92:95]
v_mfma_f32_16x16x32_bf16 v[92:95], a[172:175], a[52:55], v[92:95]
v_mfma_f32_16x16x32_bf16 v[96:99], a[160:163], a[56:59], v[96:99]
buffer_load_dwordx4 v4, s[40:43], s29 offen offset:2048 sc1 lds
v_mfma_f32_16x16x32_bf16 v[96:99], a[168:171], a[60:63], v[96:99]
v_mfma_f32_16x16x32_bf16 v[100:103], a[164:167], a[56:59], v[100:103]
v_mfma_f32_16x16x32_bf16 v[100:103], a[172:175], a[60:63], v[100:103]
buffer_load_dwordx4 v4, s[40:43], s29 offen offset:3072 sc1 lds
v_mfma_f32_16x16x32_bf16 v[104:107], a[160:163], a[64:67], v[104:107]
s_add_u32 m0, s26, 21504
s_add_u32 s29, s29, 1024
v_mfma_f32_16x16x32_bf16 v[104:107], a[168:171], a[68:71], v[104:107]
v_mfma_f32_16x16x32_bf16 v[108:111], a[164:167], a[64:67], v[108:111]
v_mfma_f32_16x16x32_bf16 v[108:111], a[172:175], a[68:71], v[108:111]
s_waitcnt vmcnt(48) lgkmcnt(0)
ds_read_b128 a[40:43], v12 offset:24576
ds_read_b128 a[44:47], v13 offset:24576
v_mfma_f32_16x16x32_bf16 v[48:51], a[176:179], a[0:3], v[48:51]
s_xor_b32 s34, s16, 8192
ds_read_b128 a[48:51], v12 offset:26624
v_mfma_f32_16x16x32_bf16 v[48:51], a[184:187], a[4:7], v[48:51]
ds_read_b128 a[52:55], v13 offset:26624
ds_read_b128 a[56:59], v12 offset:28672
v_mfma_f32_16x16x32_bf16 v[52:55], a[180:183], a[0:3], v[52:55]
buffer_load_dwordx4 v4, s[40:43], s29 offen offset:3072 sc1 lds
v_mfma_f32_16x16x32_bf16 v[52:55], a[188:191], a[4:7], v[52:55]
s_xor_b32 s29, s18, 655360
ds_read_b128 a[60:63], v13 offset:28672
v_mfma_f32_16x16x32_bf16 v[56:59], a[176:179], a[8:11], v[56:59]
ds_read_b128 a[64:67], v12 offset:30720
ds_read_b128 a[68:71], v13 offset:30720
v_mfma_f32_16x16x32_bf16 v[56:59], a[184:187], a[12:15], v[56:59]
v_mfma_f32_16x16x32_bf16 v[60:63], a[180:183], a[8:11], v[60:63]
v_mfma_f32_16x16x32_bf16 v[60:63], a[188:191], a[12:15], v[60:63]
buffer_load_dwordx4 a[96:99], v4, s[40:43], s34 offen sc1
v_mfma_f32_16x16x32_bf16 v[64:67], a[176:179], a[16:19], v[64:67]
v_mfma_f32_16x16x32_bf16 v[64:67], a[184:187], a[20:23], v[64:67]
v_mfma_f32_16x16x32_bf16 v[68:71], a[180:183], a[16:19], v[68:71]
s_add_u32 m0, s27, 0
v_mfma_f32_16x16x32_bf16 v[68:71], a[188:191], a[20:23], v[68:71]
buffer_load_dwordx4 a[104:107], v4, s[40:43], s34 offen offset:1024 sc1
v_mfma_f32_16x16x32_bf16 v[72:75], a[176:179], a[24:27], v[72:75]
v_mfma_f32_16x16x32_bf16 v[72:75], a[184:187], a[28:31], v[72:75]
v_mfma_f32_16x16x32_bf16 v[76:79], a[180:183], a[24:27], v[76:79]
s_waitcnt vmcnt(36) lgkmcnt(0)
s_barrier
v_mfma_f32_16x16x32_bf16 v[76:79], a[188:191], a[28:31], v[76:79]
s_xor_b32 s34, s17, 8192
ds_read_b128 a[0:3], v10 offset:49152
ds_read_b128 a[4:7], v11 offset:49152
v_mfma_f32_16x16x32_bf16 v[80:83], a[176:179], a[40:43], v[80:83]
ds_read_b128 a[8:11], v10 offset:51200
ds_read_b128 a[12:15], v11 offset:51200
v_mfma_f32_16x16x32_bf16 v[80:83], a[184:187], a[44:47], v[80:83]
ds_read_b128 a[16:19], v10 offset:53248
ds_read_b128 a[20:23], v11 offset:53248
v_mfma_f32_16x16x32_bf16 v[84:87], a[180:183], a[40:43], v[84:87]
buffer_load_dwordx4 a[100:103], v4, s[40:43], s34 offen sc1
v_mfma_f32_16x16x32_bf16 v[84:87], a[188:191], a[44:47], v[84:87]
ds_read_b128 a[24:27], v10 offset:55296
ds_read_b128 a[28:31], v11 offset:55296
v_mfma_f32_16x16x32_bf16 v[88:91], a[176:179], a[48:51], v[88:91]
v_mfma_f32_16x16x32_bf16 v[88:91], a[184:187], a[52:55], v[88:91]
buffer_load_dwordx4 a[108:111], v4, s[40:43], s34 offen offset:1024 sc1
v_mfma_f32_16x16x32_bf16 v[92:95], a[180:183], a[48:51], v[92:95]
v_mfma_f32_16x16x32_bf16 v[92:95], a[188:191], a[52:55], v[92:95]
v_mfma_f32_16x16x32_bf16 v[96:99], a[176:179], a[56:59], v[96:99]
buffer_load_dwordx4 v4, s[40:43], s29 offen offset:0 sc1 lds
v_mfma_f32_16x16x32_bf16 v[96:99], a[184:187], a[60:63], v[96:99]
v_mfma_f32_16x16x32_bf16 v[100:103], a[180:183], a[56:59], v[100:103]
v_mfma_f32_16x16x32_bf16 v[100:103], a[188:191], a[60:63], v[100:103]
buffer_load_dwordx4 v4, s[40:43], s29 offen offset:1024 sc1 lds
v_mfma_f32_16x16x32_bf16 v[104:107], a[176:179], a[64:67], v[104:107]
v_mfma_f32_16x16x32_bf16 v[104:107], a[184:187], a[68:71], v[104:107]
v_mfma_f32_16x16x32_bf16 v[108:111], a[180:183], a[64:67], v[108:111]
v_mfma_f32_16x16x32_bf16 v[108:111], a[188:191], a[68:71], v[108:111]
s_waitcnt vmcnt(44) lgkmcnt(0)
ds_read_b128 a[40:43], v10 offset:57344
ds_read_b128 a[44:47], v11 offset:57344
v_mfma_f32_16x16x32_bf16 v[48:51], a[192:195], a[0:3], v[48:51]
ds_read_b128 a[48:51], v10 offset:59392
ds_read_b128 a[52:55], v11 offset:59392
v_mfma_f32_16x16x32_bf16 v[48:51], a[200:203], a[4:7], v[48:51]
ds_read_b128 a[56:59], v10 offset:61440
ds_read_b128 a[60:63], v11 offset:61440
v_mfma_f32_16x16x32_bf16 v[52:55], a[196:199], a[0:3], v[52:55]
buffer_load_dwordx4 v4, s[40:43], s29 offen offset:2048 sc1 lds
v_mfma_f32_16x16x32_bf16 v[52:55], a[204:207], a[4:7], v[52:55]
ds_read_b128 a[64:67], v10 offset:63488
ds_read_b128 a[68:71], v11 offset:63488
v_mfma_f32_16x16x32_bf16 v[56:59], a[192:195], a[8:11], v[56:59]
v_mfma_f32_16x16x32_bf16 v[56:59], a[200:203], a[12:15], v[56:59]
v_mfma_f32_16x16x32_bf16 v[60:63], a[196:199], a[8:11], v[60:63]
v_mfma_f32_16x16x32_bf16 v[60:63], a[204:207], a[12:15], v[60:63]
buffer_load_dwordx4 v4, s[40:43], s29 offen offset:3072 sc1 lds
v_mfma_f32_16x16x32_bf16 v[64:67], a[192:195], a[16:19], v[64:67]
s_add_u32 m0, s27, 1024
v_mfma_f32_16x16x32_bf16 v[64:67], a[200:203], a[20:23], v[64:67]
s_add_u32 s29, s29, 1024
v_mfma_f32_16x16x32_bf16 v[68:71], a[196:199], a[16:19], v[68:71]
v_mfma_f32_16x16x32_bf16 v[68:71], a[204:207], a[20:23], v[68:71]
buffer_load_dwordx4 v4, s[40:43], s29 offen offset:3072 sc1 lds
v_mfma_f32_16x16x32_bf16 v[72:75], a[192:195], a[24:27], v[72:75]
v_mfma_f32_16x16x32_bf16 v[72:75], a[200:203], a[28:31], v[72:75]
v_mfma_f32_16x16x32_bf16 v[76:79], a[196:199], a[24:27], v[76:79]
s_waitcnt vmcnt(38) lgkmcnt(0)
s_barrier
v_mfma_f32_16x16x32_bf16 v[76:79], a[204:207], a[28:31], v[76:79]
ds_read_b128 a[0:3], v32 offset:25600
ds_read_b128 a[4:7], v32 offset:35840
v_mfma_f32_16x16x32_bf16 v[80:83], a[192:195], a[40:43], v[80:83]
s_xor_b32 s34, s16, 10240
ds_read_b128 a[8:11], v32 offset:26624
ds_read_b128 a[12:15], v32 offset:36864
v_mfma_f32_16x16x32_bf16 v[80:83], a[200:203], a[44:47], v[80:83]
buffer_load_dwordx4 a[112:115], v4, s[40:43], s34 offen sc1
v_mfma_f32_16x16x32_bf16 v[84:87], a[196:199], a[40:43], v[84:87]
ds_read_b128 a[16:19], v32 offset:27648
ds_read_b128 a[20:23], v32 offset:37888
v_mfma_f32_16x16x32_bf16 v[84:87], a[204:207], a[44:47], v[84:87]
ds_read_b128 a[24:27], v32 offset:28672
ds_read_b128 a[28:31], v32 offset:38912
v_mfma_f32_16x16x32_bf16 v[88:91], a[192:195], a[48:51], v[88:91]
buffer_load_dwordx4 a[120:123], v4, s[40:43], s34 offen offset:1024 sc1
v_mfma_f32_16x16x32_bf16 v[88:91], a[200:203], a[52:55], v[88:91]
s_xor_b32 s34, s17, 10240
ds_read_b128 a[32:35], v32 offset:29696
v_mfma_f32_16x16x32_bf16 v[92:95], a[196:199], a[48:51], v[92:95]
v_mfma_f32_16x16x32_bf16 v[92:95], a[204:207], a[52:55], v[92:95]
ds_read_b128 a[36:39], v32 offset:39936
v_mfma_f32_16x16x32_bf16 v[96:99], a[192:195], a[56:59], v[96:99]
buffer_load_dwordx4 a[116:119], v4, s[40:43], s34 offen sc1
v_mfma_f32_16x16x32_bf16 v[96:99], a[200:203], a[60:63], v[96:99]
v_mfma_f32_16x16x32_bf16 v[100:103], a[196:199], a[56:59], v[100:103]
v_mfma_f32_16x16x32_bf16 v[100:103], a[204:207], a[60:63], v[100:103]
v_mfma_f32_16x16x32_bf16 v[104:107], a[192:195], a[64:67], v[104:107]
buffer_load_dwordx4 a[124:127], v4, s[40:43], s34 offen offset:1024 sc1
v_mfma_f32_16x16x32_bf16 v[104:107], a[200:203], a[68:71], v[104:107]
v_mfma_f32_16x16x32_bf16 v[108:111], a[196:199], a[64:67], v[108:111]
v_mfma_f32_16x16x32_bf16 v[108:111], a[204:207], a[68:71], v[108:111]
s_branch kf_kernel_o
kf_kernel_g6:
s_waitcnt vmcnt(40) lgkmcnt(0)
ds_read_b128 a[40:43], v8 offset:22528
ds_read_b128 a[44:47], v9 offset:22528
ds_read_b128 a[48:51], v8 offset:24576
ds_read_b128 a[52:55], v9 offset:24576
ds_read_b128 a[56:59], v8 offset:26624
v_mfma_f32_16x16x32_bf16 v[48:51], a[128:131], a[0:3], v[52:55]
s_sub_u32 s34, s33, 36864
v_mov_b32 v45, 1
s_lshr_b32 s55, s23, 1
v_mfma_f32_16x16x32_bf16 v[48:51], a[136:139], a[4:7], v[48:51]
buffer_load_dwordx4 a[96:99], v4, s[40:43], s34 offen offset:0 sc1
s_and_b32 s3, s23, 1
v_mfma_f32_16x16x32_bf16 v[52:55], a[132:135], a[0:3], v[52:55]
v_mfma_f32_16x16x32_bf16 v[52:55], a[140:143], a[4:7], v[52:55]
ds_read_b128 a[60:63], v9 offset:26624
v_mfma_f32_16x16x32_bf16 v[56:59], a[128:131], a[8:11], 0
buffer_load_dwordx4 a[100:103], v4, s[40:43], s34 offen offset:1024 sc1
v_mfma_f32_16x16x32_bf16 v[56:59], a[136:139], a[12:15], v[56:59]
s_add_u32 s3, s3, s38
s_mul_i32 s38, s3, 27
s_add_u32 s38, s38, s62
v_mfma_f32_16x16x32_bf16 v[60:63], a[132:135], a[8:11], 0
buffer_load_dwordx4 a[104:107], v4, s[40:43], s34 offen offset:2048 sc1
v_mfma_f32_16x16x32_bf16 v[60:63], a[140:143], a[12:15], v[60:63]
v_mfma_f32_16x16x32_bf16 v[64:67], a[128:131], a[16:19], v[68:71]
s_lshl2_add_u32 s39, s22, s55
s_lshl_b32 s38, s38, 10
s_lshl_b32 s39, s39, 8
v_mfma_f32_16x16x32_bf16 v[64:67], a[136:139], a[20:23], v[64:67]
v_mfma_f32_16x16x32_bf16 v[68:71], a[132:135], a[16:19], v[68:71]
v_mfma_f32_16x16x32_bf16 v[68:71], a[140:143], a[20:23], v[68:71]
s_waitcnt vmcnt(43) lgkmcnt(0)
s_barrier
ds_read_b128 a[0:3], v8 offset:32768
ds_read_b128 a[4:7], v9 offset:32768
v_mfma_f32_16x16x32_bf16 v[72:75], a[128:131], a[40:43], 0
s_add_u32 s39, s39, 3162112
s_cmp_ge_u32 s62, 27
ds_read_b128 a[8:11], v8 offset:34816
ds_read_b128 a[12:15], v9 offset:34816
s_cselect_b32 s38, 536870912, s38
ds_read_b128 a[16:19], v8 offset:36864
buffer_store_dwordx4 v[208:211], v4, s[40:43], s16 offen offset:0
v_mfma_f32_16x16x32_bf16 v[72:75], a[136:139], a[44:47], v[72:75]
ds_read_b128 a[20:23], v9 offset:36864
v_mfma_f32_16x16x32_bf16 v[76:79], a[132:135], a[40:43], 0
s_cmp_lt_u32 s22, 4
s_cselect_b32 s52, 536870912, 0
s_lshl_b32 s3, s20, 10
s_bfe_u32 s54, s23, 0x10001
v_mfma_f32_16x16x32_bf16 v[76:79], a[140:143], a[44:47], v[76:79]
s_and_b32 s53, s24, 3
buffer_load_dwordx4 a[108:111], v4, s[40:43], s34 offen offset:3072 sc1
v_mfma_f32_16x16x32_bf16 v[80:83], a[128:131], a[48:51], v[84:87]
s_sub_u32 s34, s33, 40960
buffer_load_dwordx4 a[112:115], v4, s[40:43], s34 offen offset:0 sc1
v_mfma_f32_16x16x32_bf16 v[80:83], a[136:139], a[52:55], v[80:83]
v_mov_b32 v44, 0
v_mfma_f32_16x16x32_bf16 v[84:87], a[132:135], a[48:51], v[84:87]
s_add_u32 s26, s13, s3
v_mfma_f32_16x16x32_bf16 v[84:87], a[140:143], a[52:55], v[84:87]
v_mfma_f32_16x16x32_bf16 v[88:91], a[128:131], a[56:59], 0
buffer_load_dwordx4 a[116:119], v4, s[40:43], s34 offen offset:1024 sc1
v_mfma_f32_16x16x32_bf16 v[88:91], a[136:139], a[60:63], v[88:91]
v_mfma_f32_16x16x32_bf16 v[92:95], a[132:135], a[56:59], 0
s_waitcnt vmcnt(47) lgkmcnt(0)
ds_read_b128 a[40:43], v8 offset:38912
ds_read_b128 a[44:47], v9 offset:38912
v_mfma_f32_16x16x32_bf16 v[92:95], a[140:143], a[60:63], v[92:95]
s_add_u32 s32, s12, s3
ds_read_b128 a[48:51], v8 offset:40960
ds_read_b128 a[52:55], v9 offset:40960
v_mfma_f32_16x16x32_bf16 v[48:51], a[144:147], a[0:3], v[48:51]
ds_read_b128 a[56:59], v8 offset:43008
ds_read_b128 a[60:63], v9 offset:43008
v_mfma_f32_16x16x32_bf16 v[48:51], a[152:155], a[4:7], v[48:51]
buffer_store_dwordx4 v[212:215], v4, s[40:43], s16 offen offset:1024
v_mfma_f32_16x16x32_bf16 v[52:55], a[148:151], a[0:3], v[52:55]
s_lshl2_add_u32 s53, s54, s53
s_lshr_b32 s54, s20, 1
v_mfma_f32_16x16x32_bf16 v[52:55], a[156:159], a[4:7], v[52:55]
s_add_u32 s27, s14, s3
s_and_b32 s3, s20, 1
s_lshl_b32 s3, s3, 2
v_mfma_f32_16x16x32_bf16 v[56:59], a[144:147], a[8:11], v[56:59]
buffer_load_dwordx4 a[120:123], v4, s[40:43], s34 offen offset:2048 sc1
v_mfma_f32_16x16x32_bf16 v[56:59], a[152:155], a[12:15], v[56:59]
v_mfma_f32_16x16x32_bf16 v[60:63], a[148:151], a[8:11], v[60:63]
v_mfma_f32_16x16x32_bf16 v[60:63], a[156:159], a[12:15], v[60:63]
buffer_load_dwordx4 a[124:127], v4, s[40:43], s34 offen offset:3072 sc1
v_mfma_f32_16x16x32_bf16 v[64:67], a[144:147], a[16:19], v[64:67]
s_xor_b32 s3, s3, s53
s_mul_i32 s18, s3, 5120
v_mfma_f32_16x16x32_bf16 v[64:67], a[152:155], a[20:23], v[64:67]
s_lshl_b32 s3, s54, 16
s_add_u32 s18, s18, s3
s_lshl_b32 s3, s21, 18
v_mfma_f32_16x16x32_bf16 v[68:71], a[148:151], a[16:19], v[68:71]
s_add_u32 s18, s18, s3
s_add_u32 s18, s18, 104857600
s_cmp_eq_u32 s55, 3
v_mfma_f32_16x16x32_bf16 v[68:71], a[156:159], a[20:23], v[68:71]
s_waitcnt vmcnt(46) lgkmcnt(0)
s_barrier
ds_read_b128 a[0:3], v8 offset:49152
ds_read_b128 a[4:7], v9 offset:49152
s_cselect_b32 s49, 1073741824, 0
ds_read_b128 a[8:11], v8 offset:51200
ds_read_b128 a[12:15], v9 offset:51200
ds_read_b128 a[16:19], v8 offset:53248
v_mfma_f32_16x16x32_bf16 v[72:75], a[144:147], a[40:43], v[72:75]
v_mfma_f32_16x16x32_bf16 v[72:75], a[152:155], a[44:47], v[72:75]
buffer_store_dwordx4 v[216:219], v4, s[40:43], s16 offen offset:2048
v_mfma_f32_16x16x32_bf16 v[76:79], a[148:151], a[40:43], v[76:79]
ds_read_b128 a[20:23], v9 offset:53248
v_lshrrev_b32 v2, 2, v0
v_mfma_f32_16x16x32_bf16 v[76:79], a[156:159], a[44:47], v[76:79]
s_sub_u32 s34, s33, 45056
s_xor_b32 s48, s4, 1
buffer_load_dwordx4 a[128:131], v4, s[40:43], s34 offen offset:0 sc1
v_mfma_f32_16x16x32_bf16 v[80:83], a[144:147], a[48:51], v[80:83]
s_and_b32 s3, s12, 0x10000
buffer_load_dwordx4 a[132:135], v4, s[40:43], s34 offen offset:1024 sc1
v_mfma_f32_16x16x32_bf16 v[80:83], a[152:155], a[52:55], v[80:83]
v_mfma_f32_16x16x32_bf16 v[84:87], a[148:151], a[48:51], v[84:87]
s_mul_i32 s37, s4, 27648
v_add_u32 v32, s3, v4
v_mfma_f32_16x16x32_bf16 v[84:87], a[156:159], a[52:55], v[84:87]
v_mfma_f32_16x16x32_bf16 v[88:91], a[144:147], a[56:59], v[88:91]
buffer_load_dwordx4 a[136:139], v4, s[40:43], s34 offen offset:2048 sc1
v_mfma_f32_16x16x32_bf16 v[88:91], a[152:155], a[60:63], v[88:91]
s_waitcnt vmcnt(48) lgkmcnt(0)
ds_read_b128 a[40:43], v8 offset:55296
ds_read_b128 a[44:47], v9 offset:55296
ds_read_b128 a[48:51], v8 offset:57344
ds_read_b128 a[52:55], v9 offset:57344
v_mfma_f32_16x16x32_bf16 v[92:95], a[148:151], a[56:59], v[92:95]
ds_read_b128 a[56:59], v8 offset:59392
s_mul_i32 s48, s48, 27648
v_mfma_f32_16x16x32_bf16 v[92:95], a[156:159], a[60:63], v[92:95]
s_mul_i32 s3, s55, 7168
ds_read_b128 a[60:63], v9 offset:59392
v_mfma_f32_16x16x32_bf16 v[48:51], a[160:163], a[0:3], v[48:51]
v_mfma_f32_16x16x32_bf16 v[48:51], a[168:171], a[4:7], v[48:51]
buffer_store_dwordx4 v[220:223], v4, s[40:43], s16 offen offset:3072
s_add_u32 s48, s48, s3
v_mfma_f32_16x16x32_bf16 v[52:55], a[164:167], a[0:3], v[52:55]
s_add_u32 s37, s37, s3
v_xor_b32 v33, 0x10000, v32
v_mfma_f32_16x16x32_bf16 v[52:55], a[172:175], a[4:7], v[52:55]
v_mfma_f32_16x16x32_bf16 v[56:59], a[160:163], a[8:11], v[56:59]
v_mfma_f32_16x16x32_bf16 v[56:59], a[168:171], a[12:15], v[56:59]
s_mov_b32 s3, 3145728
v_add_u32 v34, 0x20000, v4
v_lshrrev_b32 v47, 1, v4
v_lshlrev_b32 v2, 8, v2
v_mfma_f32_16x16x32_bf16 v[60:63], a[164:167], a[8:11], v[60:63]
buffer_load_dword v30, v2, s[40:43], s3 offen sc1
v_mfma_f32_16x16x32_bf16 v[60:63], a[172:175], a[12:15], v[60:63]
buffer_load_dwordx4 a[140:143], v4, s[40:43], s34 offen offset:3072 sc1
v_mfma_f32_16x16x32_bf16 v[64:67], a[160:163], a[16:19], v[64:67]
v_mfma_f32_16x16x32_bf16 v[64:67], a[168:171], a[20:23], v[64:67]
s_waitcnt vmcnt(48) lgkmcnt(0)
s_barrier
ds_read_b128 a[0:3], v10 offset:0
v_mfma_f32_16x16x32_bf16 v[68:71], a[164:167], a[16:19], v[68:71]
s_sub_u32 s34, s33, 49152
ds_read_b128 a[4:7], v11 offset:0
ds_read_b128 a[8:11], v10 offset:2048
v_mfma_f32_16x16x32_bf16 v[68:71], a[172:175], a[20:23], v[68:71]
v_and_b32 v1, 3, v0
v_mfma_f32_16x16x32_bf16 v[72:75], a[160:163], a[40:43], v[72:75]
ds_read_b128 a[12:15], v11 offset:2048
ds_read_b128 a[16:19], v10 offset:4096
v_mfma_f32_16x16x32_bf16 v[72:75], a[168:171], a[44:47], v[72:75]
ds_read_b128 a[20:23], v11 offset:4096
buffer_store_dwordx4 v[224:227], v4, s[40:43], s17 offen offset:0
v_mfma_f32_16x16x32_bf16 v[76:79], a[164:167], a[40:43], v[76:79]
v_mfma_f32_16x16x32_bf16 v[76:79], a[172:175], a[44:47], v[76:79]
buffer_load_dwordx4 a[144:147], v4, s[40:43], s34 offen offset:0 sc1
v_mfma_f32_16x16x32_bf16 v[80:83], a[160:163], a[48:51], v[80:83]
v_mfma_f32_16x16x32_bf16 v[80:83], a[168:171], a[52:55], v[80:83]
v_mfma_f32_16x16x32_bf16 v[84:87], a[164:167], a[48:51], v[84:87]
buffer_load_dwordx4 a[148:151], v4, s[40:43], s34 offen offset:1024 sc1
v_mfma_f32_16x16x32_bf16 v[84:87], a[172:175], a[52:55], v[84:87]
v_lshlrev_b32 v46, 8, v1
v_mfma_f32_16x16x32_bf16 v[88:91], a[160:163], a[56:59], v[88:91]
buffer_load_dwordx4 a[152:155], v4, s[40:43], s34 offen offset:2048 sc1
v_mfma_f32_16x16x32_bf16 v[88:91], a[168:171], a[60:63], v[88:91]
v_mfma_f32_16x16x32_bf16 v[92:95], a[164:167], a[56:59], v[92:95]
s_waitcnt vmcnt(48) lgkmcnt(0)
ds_read_b128 a[40:43], v10 offset:6144
ds_read_b128 a[44:47], v11 offset:6144
ds_read_b128 a[48:51], v10 offset:8192
ds_read_b128 a[52:55], v11 offset:8192
v_mfma_f32_16x16x32_bf16 v[92:95], a[172:175], a[60:63], v[92:95]
ds_read_b128 a[56:59], v10 offset:10240
ds_read_b128 a[60:63], v11 offset:10240
v_mfma_f32_16x16x32_bf16 v[48:51], a[176:179], a[0:3], v[48:51]
v_mfma_f32_16x16x32_bf16 v[48:51], a[184:187], a[4:7], v[48:51]
buffer_store_dwordx4 v[228:231], v4, s[40:43], s17 offen offset:1024
v_mfma_f32_16x16x32_bf16 v[52:55], a[180:183], a[0:3], v[52:55]
v_mfma_f32_16x16x32_bf16 v[52:55], a[188:191], a[4:7], v[52:55]
buffer_load_dwordx4 a[156:159], v4, s[40:43], s34 offen offset:3072 sc1
v_mfma_f32_16x16x32_bf16 v[56:59], a[176:179], a[8:11], v[56:59]
v_mfma_f32_16x16x32_bf16 v[56:59], a[184:187], a[12:15], v[56:59]
v_mfma_f32_16x16x32_bf16 v[60:63], a[180:183], a[8:11], v[60:63]
v_mfma_f32_16x16x32_bf16 v[60:63], a[188:191], a[12:15], v[60:63]
s_sub_u32 s34, s33, 53248
buffer_load_dwordx4 a[160:163], v4, s[40:43], s34 offen offset:0 sc1
v_mfma_f32_16x16x32_bf16 v[64:67], a[176:179], a[16:19], v[64:67]
v_mfma_f32_16x16x32_bf16 v[64:67], a[184:187], a[20:23], v[64:67]
v_mfma_f32_16x16x32_bf16 v[68:71], a[180:183], a[16:19], v[68:71]
s_waitcnt vmcnt(48) lgkmcnt(0)
s_barrier
ds_read_b128 a[0:3], v10 offset:16384
ds_read_b128 a[4:7], v11 offset:16384
v_mfma_f32_16x16x32_bf16 v[68:71], a[188:191], a[20:23], v[68:71]
ds_read_b128 a[8:11], v10 offset:18432
ds_read_b128 a[12:15], v11 offset:18432
v_mfma_f32_16x16x32_bf16 v[72:75], a[176:179], a[40:43], v[72:75]
buffer_store_dwordx4 v[232:235], v4, s[40:43], s17 offen offset:2048
v_mfma_f32_16x16x32_bf16 v[72:75], a[184:187], a[44:47], v[72:75]
ds_read_b128 a[16:19], v10 offset:20480
ds_read_b128 a[20:23], v11 offset:20480
v_mfma_f32_16x16x32_bf16 v[76:79], a[180:183], a[40:43], v[76:79]
v_mfma_f32_16x16x32_bf16 v[76:79], a[188:191], a[44:47], v[76:79]
buffer_load_dwordx4 a[164:167], v4, s[40:43], s34 offen offset:1024 sc1
v_mfma_f32_16x16x32_bf16 v[80:83], a[176:179], a[48:51], v[80:83]
v_mfma_f32_16x16x32_bf16 v[80:83], a[184:187], a[52:55], v[80:83]
v_mfma_f32_16x16x32_bf16 v[84:87], a[180:183], a[48:51], v[84:87]
buffer_load_dwordx4 a[168:171], v4, s[40:43], s34 offen offset:2048 sc1
v_mfma_f32_16x16x32_bf16 v[84:87], a[188:191], a[52:55], v[84:87]
v_mfma_f32_16x16x32_bf16 v[88:91], a[176:179], a[56:59], v[88:91]
buffer_load_dwordx4 a[172:175], v4, s[40:43], s34 offen offset:3072 sc1
v_mfma_f32_16x16x32_bf16 v[88:91], a[184:187], a[60:63], v[88:91]
v_mfma_f32_16x16x32_bf16 v[92:95], a[180:183], a[56:59], v[92:95]
v_mfma_f32_16x16x32_bf16 v[92:95], a[188:191], a[60:63], v[92:95]
s_waitcnt vmcnt(48) lgkmcnt(0)
ds_read_b128 a[40:43], v10 offset:22528
ds_read_b128 a[44:47], v11 offset:22528
ds_read_b128 a[48:51], v10 offset:24576
ds_read_b128 a[52:55], v11 offset:24576
ds_read_b128 a[56:59], v10 offset:26624
ds_read_b128 a[60:63], v11 offset:26624
s_add_u32 s29, s35, 0xfffffb00
v_mfma_f32_16x16x32_bf16 v[48:51], a[192:195], a[0:3], v[48:51]
buffer_store_dwordx4 v[236:239], v4, s[40:43], s17 offen offset:3072
s_add_u32 m0, s13, 0
v_mfma_f32_16x16x32_bf16 v[48:51], a[200:203], a[4:7], v[48:51]
v_mfma_f32_16x16x32_bf16 v[52:55], a[196:199], a[0:3], v[52:55]
v_mfma_f32_16x16x32_bf16 v[52:55], a[204:207], a[4:7], v[52:55]
v_mfma_f32_16x16x32_bf16 v[56:59], a[192:195], a[8:11], v[56:59]
buffer_load_dwordx4 v21, s[44:47], s29 offen offset:0 lds
v_mfma_f32_16x16x32_bf16 v[56:59], a[200:203], a[12:15], v[56:59]
v_mfma_f32_16x16x32_bf16 v[60:63], a[196:199], a[8:11], v[60:63]
v_mfma_f32_16x16x32_bf16 v[60:63], a[204:207], a[12:15], v[60:63]
buffer_load_dwordx4 v22, s[44:47], s29 offen offset:1024 lds
v_mfma_f32_16x16x32_bf16 v[64:67], a[192:195], a[16:19], v[64:67]
v_mfma_f32_16x16x32_bf16 v[64:67], a[200:203], a[20:23], v[64:67]
v_mfma_f32_16x16x32_bf16 v[68:71], a[196:199], a[16:19], v[68:71]
s_waitcnt vmcnt(48) lgkmcnt(0)
s_barrier
ds_read_b128 a[0:3], v10 offset:32768
ds_read_b128 a[4:7], v11 offset:32768
ds_read_b128 a[8:11], v10 offset:34816
v_mfma_f32_16x16x32_bf16 v[68:71], a[204:207], a[20:23], v[68:71]
ds_read_b128 a[12:15], v11 offset:34816
ds_read_b128 a[16:19], v10 offset:36864
v_mfma_f32_16x16x32_bf16 v[72:75], a[192:195], a[40:43], v[72:75]
ds_read_b128 a[20:23], v11 offset:36864
v_mfma_f32_16x16x32_bf16 v[72:75], a[200:203], a[44:47], v[72:75]
buffer_load_dwordx4 v23, s[44:47], s29 offen offset:2048 lds
v_mfma_f32_16x16x32_bf16 v[76:79], a[196:199], a[40:43], v[76:79]
v_mfma_f32_16x16x32_bf16 v[76:79], a[204:207], a[44:47], v[76:79]
buffer_load_dwordx4 v24, s[44:47], s29 offen offset:3072 lds
s_add_u32 m0, s13, 16384
v_mfma_f32_16x16x32_bf16 v[80:83], a[192:195], a[48:51], v[80:83]
v_mfma_f32_16x16x32_bf16 v[80:83], a[200:203], a[52:55], v[80:83]
v_mfma_f32_16x16x32_bf16 v[84:87], a[196:199], a[48:51], v[84:87]
s_add_u32 s29, s35, 0xfffffa80
buffer_load_dwordx4 v21, s[44:47], s29 offen offset:0 lds
v_mfma_f32_16x16x32_bf16 v[84:87], a[204:207], a[52:55], v[84:87]
v_mfma_f32_16x16x32_bf16 v[88:91], a[192:195], a[56:59], v[88:91]
buffer_load_dwordx4 v22, s[44:47], s29 offen offset:1024 lds
v_mfma_f32_16x16x32_bf16 v[88:91], a[200:203], a[60:63], v[88:91]
v_mfma_f32_16x16x32_bf16 v[92:95], a[196:199], a[56:59], v[92:95]
s_waitcnt vmcnt(19) lgkmcnt(0)
v_cmp_gt_u32 vcc, 16, v30
s_cmp_lg_u64 vcc, 0
v_mfma_f32_16x16x32_bf16 v[92:95], a[204:207], a[60:63], v[92:95]
s_cbranch_scc1 kf_kernel_spin_wf6
kf_kernel_ret_wf6:
ds_read_b128 a[40:43], v10 offset:38912
ds_read_b128 a[44:47], v11 offset:38912
ds_read_b128 a[48:51], v10 offset:40960
ds_read_b128 a[52:55], v11 offset:40960
ds_read_b128 a[56:59], v10 offset:43008
v_mfma_f32_16x16x32_bf16 v[48:51], a[208:211], a[0:3], v[48:51]
ds_read_b128 a[60:63], v11 offset:43008
v_mfma_f32_16x16x32_bf16 v[48:51], a[216:219], a[4:7], v[48:51]
buffer_load_dwordx4 v23, s[44:47], s29 offen offset:2048 lds
v_mfma_f32_16x16x32_bf16 v[52:55], a[212:215], a[0:3], v[52:55]
v_mfma_f32_16x16x32_bf16 v[52:55], a[220:223], a[4:7], v[52:55]
v_mfma_f32_16x16x32_bf16 v[56:59], a[208:211], a[8:11], v[56:59]
buffer_load_dwordx4 v24, s[44:47], s29 offen offset:3072 lds
v_mfma_f32_16x16x32_bf16 v[56:59], a[216:219], a[12:15], v[56:59]
s_add_u32 s34, s38, 41943040
v_mfma_f32_16x16x32_bf16 v[60:63], a[212:215], a[8:11], v[60:63]
v_mfma_f32_16x16x32_bf16 v[60:63], a[220:223], a[12:15], v[60:63]
buffer_load_dwordx4 v[240:243], v4, s[40:43], s34 offen sc1
v_mfma_f32_16x16x32_bf16 v[64:67], a[208:211], a[16:19], v[64:67]
s_add_u32 s34, s38, 41998336
v_mfma_f32_16x16x32_bf16 v[64:67], a[216:219], a[20:23], v[64:67]
s_add_u32 s29, s35, 0xfffffa00
v_mfma_f32_16x16x32_bf16 v[68:71], a[212:215], a[16:19], v[68:71]
s_waitcnt vmcnt(48) lgkmcnt(0)
s_barrier
ds_read_b128 a[0:3], v12 offset:0
v_mfma_f32_16x16x32_bf16 v[68:71], a[220:223], a[20:23], v[68:71]
ds_read_b128 a[4:7], v13 offset:0
ds_read_b128 a[8:11], v12 offset:2048
ds_read_b128 a[12:15], v13 offset:2048
v_mfma_f32_16x16x32_bf16 v[72:75], a[208:211], a[40:43], v[72:75]
s_add_u32 m0, s13, 32768
ds_read_b128 a[16:19], v12 offset:4096
ds_read_b128 a[20:23], v13 offset:4096
v_mfma_f32_16x16x32_bf16 v[72:75], a[216:219], a[44:47], v[72:75]
buffer_load_dwordx4 v21, s[44:47], s29 offen offset:0 lds
v_mfma_f32_16x16x32_bf16 v[76:79], a[212:215], a[40:43], v[76:79]
v_mfma_f32_16x16x32_bf16 v[76:79], a[220:223], a[44:47], v[76:79]
buffer_load_dwordx4 v22, s[44:47], s29 offen offset:1024 lds
v_mfma_f32_16x16x32_bf16 v[80:83], a[208:211], a[48:51], v[80:83]
v_mfma_f32_16x16x32_bf16 v[80:83], a[216:219], a[52:55], v[80:83]
v_mfma_f32_16x16x32_bf16 v[84:87], a[212:215], a[48:51], v[84:87]
buffer_load_dwordx4 v23, s[44:47], s29 offen offset:2048 lds
v_mfma_f32_16x16x32_bf16 v[84:87], a[220:223], a[52:55], v[84:87]
v_mfma_f32_16x16x32_bf16 v[88:91], a[208:211], a[56:59], v[88:91]
buffer_load_dwordx4 v24, s[44:47], s29 offen offset:3072 lds
v_mfma_f32_16x16x32_bf16 v[88:91], a[216:219], a[60:63], v[88:91]
v_mfma_f32_16x16x32_bf16 v[92:95], a[212:215], a[56:59], v[92:95]
v_mfma_f32_16x16x32_bf16 v[92:95], a[220:223], a[60:63], v[92:95]
s_waitcnt vmcnt(48) lgkmcnt(0)
ds_read_b128 a[40:43], v12 offset:6144
ds_read_b128 a[44:47], v13 offset:6144
ds_read_b128 a[48:51], v12 offset:8192
ds_read_b128 a[52:55], v13 offset:8192
ds_read_b128 a[56:59], v12 offset:10240
ds_read_b128 a[60:63], v13 offset:10240
v_mfma_f32_16x16x32_bf16 v[48:51], a[224:227], a[0:3], v[48:51]
v_mfma_f32_16x16x32_bf16 v[48:51], a[232:235], a[4:7], v[48:51]
buffer_load_dwordx4 v[244:247], v4, s[40:43], s34 offen sc1
v_mfma_f32_16x16x32_bf16 v[52:55], a[228:231], a[0:3], v[52:55]
v_mfma_f32_16x16x32_bf16 v[52:55], a[236:239], a[4:7], v[52:55]
s_sub_u32 s34, s33, 57344
v_mfma_f32_16x16x32_bf16 v[56:59], a[224:227], a[8:11], v[56:59]
buffer_load_dwordx4 a[176:179], v4, s[40:43], s34 offen offset:0 sc1
v_mfma_f32_16x16x32_bf16 v[56:59], a[232:235], a[12:15], v[56:59]
s_cmp_eq_u32 s63, 0
v_mfma_f32_16x16x32_bf16 v[60:63], a[228:231], a[8:11], v[60:63]
v_mfma_f32_16x16x32_bf16 v[60:63], a[236:239], a[12:15], v[60:63]
buffer_load_dwordx4 a[180:183], v4, s[40:43], s34 offen offset:1024 sc1
v_mfma_f32_16x16x32_bf16 v[64:67], a[224:227], a[16:19], v[64:67]
v_mfma_f32_16x16x32_bf16 v[64:67], a[232:235], a[20:23], v[64:67]
v_mfma_f32_16x16x32_bf16 v[68:71], a[228:231], a[16:19], v[68:71]
v_mfma_f32_16x16x32_bf16 v[68:71], a[236:239], a[20:23], v[68:71]
s_waitcnt vmcnt(16) lgkmcnt(0)
s_barrier
s_cbranch_scc1 kf_kernel_cwb6
kf_kernel_cwr6:
ds_read_b128 a[0:3], v12 offset:16384
ds_read_b128 a[4:7], v13 offset:16384
buffer_atomic_add v45, v29, s[40:43], s39 offen sc1
v_mfma_f32_16x16x32_bf16 v[72:75], a[224:227], a[40:43], v[72:75]
s_add_u32 m0, s14, 0
ds_read_b128 a[8:11], v12 offset:18432
ds_read_b128 a[12:15], v13 offset:18432
ds_read_b128 a[16:19], v12 offset:20480
ds_read_b128 a[20:23], v13 offset:20480
v_mfma_f32_16x16x32_bf16 v[72:75], a[232:235], a[44:47], v[72:75]
buffer_load_dwordx4 a[184:187], v4, s[40:43], s34 offen offset:2048 sc1
v_mfma_f32_16x16x32_bf16 v[76:79], a[228:231], a[40:43], v[76:79]
buffer_load_dwordx4 a[188:191], v4, s[40:43], s34 offen offset:3072 sc1
v_mfma_f32_16x16x32_bf16 v[76:79], a[236:239], a[44:47], v[76:79]
v_mfma_f32_16x16x32_bf16 v[80:83], a[224:227], a[48:51], v[80:83]
s_add_u32 s29, s35, 0xfffff980
v_mfma_f32_16x16x32_bf16 v[80:83], a[232:235], a[52:55], v[80:83]
v_mfma_f32_16x16x32_bf16 v[84:87], a[228:231], a[48:51], v[84:87]
buffer_load_dwordx4 v21, s[44:47], s29 offen offset:0 lds
v_mfma_f32_16x16x32_bf16 v[84:87], a[236:239], a[52:55], v[84:87]
v_mfma_f32_16x16x32_bf16 v[88:91], a[224:227], a[56:59], v[88:91]
buffer_load_dwordx4 v22, s[44:47], s29 offen offset:1024 lds
v_mfma_f32_16x16x32_bf16 v[88:91], a[232:235], a[60:63], v[88:91]
v_mfma_f32_16x16x32_bf16 v[92:95], a[228:231], a[56:59], v[92:95]
v_mfma_f32_16x16x32_bf16 v[92:95], a[236:239], a[60:63], v[92:95]
s_waitcnt vmcnt(48) lgkmcnt(0)
ds_read_b128 a[40:43], v12 offset:22528
ds_read_b128 a[44:47], v13 offset:22528
ds_read_b128 a[48:51], v12 offset:24576
ds_read_b128 a[52:55], v13 offset:24576
v_mfma_f32_16x16x32_bf16 v[48:51], a[240:243], a[0:3], v[48:51]
v_mfma_f32_16x16x32_bf16 v[48:51], a[248:251], a[4:7], v[48:51]
buffer_load_dwordx4 v23, s[44:47], s29 offen offset:2048 lds
v_mfma_f32_16x16x32_bf16 v[52:55], a[244:247], a[0:3], v[52:55]
ds_read_b128 a[56:59], v12 offset:26624
ds_read_b128 a[60:63], v13 offset:26624
s_add_u32 s34, s38, 42053632
v_mfma_f32_16x16x32_bf16 v[52:55], a[252:255], a[4:7], v[52:55]
v_mfma_f32_16x16x32_bf16 v[56:59], a[240:243], a[8:11], v[56:59]
buffer_load_dwordx4 v24, s[44:47], s29 offen offset:3072 lds
s_add_u32 m0, s14, 16384
v_mfma_f32_16x16x32_bf16 v[56:59], a[248:251], a[12:15], v[56:59]
s_add_u32 s29, s35, 0xfffff900
v_mfma_f32_16x16x32_bf16 v[60:63], a[244:247], a[8:11], v[60:63]
v_mfma_f32_16x16x32_bf16 v[60:63], a[252:255], a[12:15], v[60:63]
buffer_load_dwordx4 v[248:251], v4, s[40:43], s34 offen sc1
v_mfma_f32_16x16x32_bf16 v[64:67], a[240:243], a[16:19], v[64:67]
v_mfma_f32_16x16x32_bf16 v[64:67], a[248:251], a[20:23], v[64:67]
v_mfma_f32_16x16x32_bf16 v[68:71], a[244:247], a[16:19], v[68:71]
v_mfma_f32_16x16x32_bf16 v[68:71], a[252:255], a[20:23], v[68:71]
s_waitcnt vmcnt(48) lgkmcnt(0)
s_barrier
ds_read_b128 a[0:3], v10 offset:49152
ds_read_b128 a[4:7], v11 offset:49152
ds_read_b128 a[8:11], v10 offset:51200
ds_read_b128 a[12:15], v11 offset:51200
ds_read_b128 a[16:19], v10 offset:53248
ds_read_b128 a[20:23], v11 offset:53248
v_mfma_f32_16x16x32_bf16 v[72:75], a[240:243], a[40:43], v[72:75]
buffer_load_dwordx4 v21, s[44:47], s29 offen offset:0 lds
v_mfma_f32_16x16x32_bf16 v[72:75], a[248:251], a[44:47], v[72:75]
v_mfma_f32_16x16x32_bf16 v[76:79], a[244:247], a[40:43], v[76:79]
buffer_load_dwordx4 v22, s[44:47], s29 offen offset:1024 lds
v_mfma_f32_16x16x32_bf16 v[76:79], a[252:255], a[44:47], v[76:79]
v_mfma_f32_16x16x32_bf16 v[80:83], a[240:243], a[48:51], v[80:83]
v_mfma_f32_16x16x32_bf16 v[80:83], a[248:251], a[52:55], v[80:83]
v_mfma_f32_16x16x32_bf16 v[84:87], a[244:247], a[48:51], v[84:87]
buffer_load_dwordx4 v23, s[44:47], s29 offen offset:2048 lds
v_mfma_f32_16x16x32_bf16 v[84:87], a[252:255], a[52:55], v[84:87]
v_mfma_f32_16x16x32_bf16 v[88:91], a[240:243], a[56:59], v[88:91]
buffer_load_dwordx4 v24, s[44:47], s29 offen offset:3072 lds
v_mfma_f32_16x16x32_bf16 v[88:91], a[248:251], a[60:63], v[88:91]
s_add_u32 s34, s38, 42108928
v_mfma_f32_16x16x32_bf16 v[92:95], a[244:247], a[56:59], v[92:95]
v_mfma_f32_16x16x32_bf16 v[92:95], a[252:255], a[60:63], v[92:95]
s_waitcnt vmcnt(48) lgkmcnt(0)
ds_read_b128 a[40:43], v10 offset:55296
ds_read_b128 a[44:47], v11 offset:55296
s_add_u32 s34, s34, s52
buffer_load_dwordx4 v[252:255], v4, s[40:43], s34 offen sc1
ds_read_b128 a[48:51], v10 offset:57344
v_mfma_f32_16x16x32_bf16 v[48:51], a[80:83], a[0:3], v[48:51]
ds_read_b128 a[52:55], v11 offset:57344
ds_read_b128 a[56:59], v10 offset:59392
s_sub_u32 s34, s33, 61440
v_mfma_f32_16x16x32_bf16 v[48:51], a[88:91], a[4:7], v[48:51]
s_add_u32 s29, s35, 0xfffff880
v_mfma_f32_16x16x32_bf16 v[52:55], a[84:87], a[0:3], v[52:55]
ds_read_b128 a[60:63], v11 offset:59392
v_mfma_f32_16x16x32_bf16 v[52:55], a[92:95], a[4:7], v[52:55]
v_mfma_f32_16x16x32_bf16 v[56:59], a[80:83], a[8:11], v[56:59]
buffer_load_dwordx4 a[192:195], v4, s[40:43], s34 offen offset:0 sc1
v_mfma_f32_16x16x32_bf16 v[56:59], a[88:91], a[12:15], v[56:59]
v_mfma_f32_16x16x32_bf16 v[60:63], a[84:87], a[8:11], v[60:63]
v_mfma_f32_16x16x32_bf16 v[60:63], a[92:95], a[12:15], v[60:63]
buffer_load_dwordx4 a[196:199], v4, s[40:43], s34 offen offset:1024 sc1
v_mfma_f32_16x16x32_bf16 v[64:67], a[80:83], a[16:19], v[64:67]
v_mfma_f32_16x16x32_bf16 v[64:67], a[88:91], a[20:23], v[64:67]
v_mfma_f32_16x16x32_bf16 v[68:71], a[84:87], a[16:19], v[68:71]
s_waitcnt vmcnt(48) lgkmcnt(0)
s_barrier
v_mfma_f32_16x16x32_bf16 v[68:71], a[92:95], a[20:23], v[68:71]
ds_read_b128 a[0:3], v8 offset:0
ds_read_b128 a[4:7], v9 offset:0
v_mfma_f32_16x16x32_bf16 v[72:75], a[80:83], a[40:43], v[72:75]
ds_read_b128 a[8:11], v8 offset:2048
ds_read_b128 a[12:15], v9 offset:2048
v_mfma_f32_16x16x32_bf16 v[72:75], a[88:91], a[44:47], v[72:75]
ds_read_b128 a[16:19], v8 offset:4096
ds_read_b128 a[20:23], v9 offset:4096
buffer_load_dwordx4 a[200:203], v4, s[40:43], s34 offen offset:2048 sc1
v_mfma_f32_16x16x32_bf16 v[76:79], a[84:87], a[40:43], v[76:79]
s_add_u32 m0, s13, 49152
buffer_load_dwordx4 a[204:207], v4, s[40:43], s34 offen offset:3072 sc1
v_mfma_f32_16x16x32_bf16 v[76:79], a[92:95], a[44:47], v[76:79]
v_mfma_f32_16x16x32_bf16 v[80:83], a[80:83], a[48:51], v[80:83]
v_mfma_f32_16x16x32_bf16 v[80:83], a[88:91], a[52:55], v[80:83]
v_mfma_f32_16x16x32_bf16 v[84:87], a[84:87], a[48:51], v[84:87]
buffer_load_dwordx4 v21, s[44:47], s29 offen offset:0 lds
v_mfma_f32_16x16x32_bf16 v[84:87], a[92:95], a[52:55], v[84:87]
v_mfma_f32_16x16x32_bf16 v[88:91], a[80:83], a[56:59], v[88:91]
buffer_load_dwordx4 v22, s[44:47], s29 offen offset:1024 lds
v_mfma_f32_16x16x32_bf16 v[88:91], a[88:91], a[60:63], v[88:91]
v_mfma_f32_16x16x32_bf16 v[92:95], a[84:87], a[56:59], v[92:95]
v_mfma_f32_16x16x32_bf16 v[92:95], a[92:95], a[60:63], v[92:95]
s_waitcnt vmcnt(48) lgkmcnt(0)
ds_read_b128 a[40:43], v8 offset:6144
ds_read_b128 a[44:47], v9 offset:6144
ds_read_b128 a[48:51], v8 offset:8192
v_mfma_f32_16x16x32_bf16 v[48:51], a[96:99], a[0:3], v[48:51]
v_mfma_f32_16x16x32_bf16 v[48:51], a[104:107], a[4:7], v[48:51]
ds_read_b128 a[52:55], v9 offset:8192
ds_read_b128 a[56:59], v8 offset:10240
buffer_load_dwordx4 v23, s[44:47], s29 offen offset:2048 lds
v_mfma_f32_16x16x32_bf16 v[52:55], a[100:103], a[0:3], v[52:55]
ds_read_b128 a[60:63], v9 offset:10240
v_mfma_f32_16x16x32_bf16 v[52:55], a[108:111], a[4:7], v[52:55]
v_mfma_f32_16x16x32_bf16 v[56:59], a[96:99], a[8:11], v[56:59]
buffer_load_dwordx4 v24, s[44:47], s29 offen offset:3072 lds
v_mfma_f32_16x16x32_bf16 v[56:59], a[104:107], a[12:15], v[56:59]
v_mfma_f32_16x16x32_bf16 v[60:63], a[100:103], a[8:11], v[60:63]
s_add_u32 m0, s32, 20480
s_xor_b32 s29, s18, 0
v_mfma_f32_16x16x32_bf16 v[60:63], a[108:111], a[12:15], v[60:63]
buffer_load_dwordx4 v4, s[40:43], s29 offen offset:0 sc1 lds
v_mfma_f32_16x16x32_bf16 v[64:67], a[96:99], a[16:19], v[64:67]
v_mfma_f32_16x16x32_bf16 v[64:67], a[104:107], a[20:23], v[64:67]
v_mfma_f32_16x16x32_bf16 v[68:71], a[100:103], a[16:19], v[68:71]
v_mfma_f32_16x16x32_bf16 v[68:71], a[108:111], a[20:23], v[68:71]
s_waitcnt vmcnt(34) lgkmcnt(0)
s_barrier
ds_read_b128 a[0:3], v10 offset:0
ds_read_b128 a[4:7], v11 offset:0
ds_read_b128 a[8:11], v10 offset:2048
v_mfma_f32_16x16x32_bf16 v[72:75], a[96:99], a[40:43], v[72:75]
ds_read_b128 a[12:15], v11 offset:2048
ds_read_b128 a[16:19], v10 offset:4096
ds_read_b128 a[20:23], v11 offset:4096
v_mfma_f32_16x16x32_bf16 v[72:75], a[104:107], a[44:47], v[72:75]
buffer_load_dwordx4 v4, s[40:43], s29 offen offset:1024 sc1 lds
v_mfma_f32_16x16x32_bf16 v[76:79], a[100:103], a[40:43], v[76:79]
v_mfma_f32_16x16x32_bf16 v[76:79], a[108:111], a[44:47], v[76:79]
buffer_load_dwordx4 v4, s[40:43], s29 offen offset:2048 sc1 lds
v_mfma_f32_16x16x32_bf16 v[80:83], a[96:99], a[48:51], v[80:83]
v_mfma_f32_16x16x32_bf16 v[80:83], a[104:107], a[52:55], v[80:83]
v_mfma_f32_16x16x32_bf16 v[84:87], a[100:103], a[48:51], v[84:87]
buffer_load_dwordx4 v4, s[40:43], s29 offen offset:3072 sc1 lds
s_add_u32 s29, s29, 1024
s_add_u32 m0, s32, 21504
v_mfma_f32_16x16x32_bf16 v[84:87], a[108:111], a[52:55], v[84:87]
v_mfma_f32_16x16x32_bf16 v[88:91], a[96:99], a[56:59], v[88:91]
buffer_load_dwordx4 v4, s[40:43], s29 offen offset:3072 sc1 lds
v_mfma_f32_16x16x32_bf16 v[88:91], a[104:107], a[60:63], v[88:91]
v_mfma_f32_16x16x32_bf16 v[92:95], a[100:103], a[56:59], v[92:95]
s_add_u32 m0, s32, 40960
v_mfma_f32_16x16x32_bf16 v[92:95], a[108:111], a[60:63], v[92:95]
s_waitcnt vmcnt(48) lgkmcnt(0)
ds_read_b128 a[40:43], v10 offset:6144
ds_read_b128 a[44:47], v11 offset:6144
ds_read_b128 a[48:51], v10 offset:8192
ds_read_b128 a[52:55], v11 offset:8192
ds_read_b128 a[56:59], v10 offset:10240
v_mfma_f32_16x16x32_bf16 v[48:51], a[112:115], a[0:3], v[48:51]
ds_read_b128 a[60:63], v11 offset:10240
s_xor_b32 s29, s18, 131072
v_mfma_f32_16x16x32_bf16 v[48:51], a[120:123], a[4:7], v[48:51]
buffer_load_dword v30, v44, s[40:43], s39 offen sc1
v_mfma_f32_16x16x32_bf16 v[52:55], a[116:119], a[0:3], v[52:55]
v_mfma_f32_16x16x32_bf16 v[52:55], a[124:127], a[4:7], v[52:55]
v_mfma_f32_16x16x32_bf16 v[56:59], a[112:115], a[8:11], v[56:59]
buffer_load_dwordx4 v4, s[40:43], s29 offen offset:0 sc1 lds
v_mfma_f32_16x16x32_bf16 v[56:59], a[120:123], a[12:15], v[56:59]
v_mfma_f32_16x16x32_bf16 v[60:63], a[116:119], a[8:11], v[60:63]
v_mfma_f32_16x16x32_bf16 v[60:63], a[124:127], a[12:15], v[60:63]
buffer_load_dwordx4 v4, s[40:43], s29 offen offset:1024 sc1 lds
v_mfma_f32_16x16x32_bf16 v[64:67], a[112:115], a[16:19], v[64:67]
v_mfma_f32_16x16x32_bf16 v[64:67], a[120:123], a[20:23], v[64:67]
v_mfma_f32_16x16x32_bf16 v[68:71], a[116:119], a[16:19], v[68:71]
v_mfma_f32_16x16x32_bf16 v[68:71], a[124:127], a[20:23], v[68:71]
s_waitcnt vmcnt(37) lgkmcnt(0)
s_barrier
ds_read_b128 a[0:3], v10 offset:16384
ds_read_b128 a[4:7], v11 offset:16384
ds_read_b128 a[8:11], v10 offset:18432
s_xor_b32 s3, s53, 4
ds_read_b128 a[12:15], v11 offset:18432
ds_read_b128 a[16:19], v10 offset:20480
v_mfma_f32_16x16x32_bf16 v[72:75], a[112:115], a[40:43], v[72:75]
s_mul_i32 s12, s53, 5120
s_mul_i32 s13, s3, 5120
s_sub_u32 s13, s13, s12
v_mfma_f32_16x16x32_bf16 v[72:75], a[120:123], a[44:47], v[72:75]
buffer_load_dwordx4 v4, s[40:43], s29 offen offset:2048 sc1 lds
ds_read_b128 a[20:23], v11 offset:20480
v_mfma_f32_16x16x32_bf16 v[76:79], a[116:119], a[40:43], v[76:79]
s_mul_i32 s3, s55, 7
s_add_u32 s3, s3, s20
s_cmp_ge_u32 s3, 23
s_cselect_b32 s50, 1073741824, 0
v_mfma_f32_16x16x32_bf16 v[76:79], a[124:127], a[44:47], v[76:79]
buffer_load_dwordx4 v4, s[40:43], s29 offen offset:3072 sc1 lds
v_mfma_f32_16x16x32_bf16 v[80:83], a[112:115], a[48:51], v[80:83]
s_add_u32 m0, s32, 41984
s_lshl_b32 s3, s3, 16
s_add_u32 s19, s12, s3
s_add_u32 s29, s29, 1024
v_mfma_f32_16x16x32_bf16 v[80:83], a[120:123], a[52:55], v[80:83]
buffer_load_dwordx4 v4, s[40:43], s29 offen offset:3072 sc1 lds
v_mfma_f32_16x16x32_bf16 v[84:87], a[116:119], a[48:51], v[84:87]
s_add_u32 m0, s32, 0
s_lshl2_add_u32 s3, s21, s20
s_xor_b32 s29, s18, 262144
v_mfma_f32_16x16x32_bf16 v[84:87], a[124:127], a[52:55], v[84:87]
buffer_load_dwordx4 v4, s[40:43], s29 offen offset:0 sc1 lds
v_mfma_f32_16x16x32_bf16 v[88:91], a[112:115], a[56:59], v[88:91]
v_mfma_f32_16x16x32_bf16 v[88:91], a[120:123], a[60:63], v[88:91]
v_mfma_f32_16x16x32_bf16 v[92:95], a[116:119], a[56:59], v[92:95]
s_waitcnt vmcnt(48) lgkmcnt(0)
ds_read_b128 a[40:43], v10 offset:22528
ds_read_b128 a[44:47], v11 offset:22528
ds_read_b128 a[48:51], v10 offset:24576
ds_read_b128 a[52:55], v11 offset:24576
v_mfma_f32_16x16x32_bf16 v[92:95], a[124:127], a[60:63], v[92:95]
ds_read_b128 a[56:59], v10 offset:26624
ds_read_b128 a[60:63], v11 offset:26624
v_mfma_f32_16x16x32_bf16 v[48:51], a[128:131], a[0:3], v[48:51]
s_lshl_b32 s3, s3, 16
v_mfma_f32_16x16x32_bf16 v[48:51], a[136:139], a[4:7], v[48:51]
buffer_load_dwordx4 v4, s[40:43], s29 offen offset:1024 sc1 lds
v_mfma_f32_16x16x32_bf16 v[52:55], a[132:135], a[0:3], v[52:55]
v_mfma_f32_16x16x32_bf16 v[52:55], a[140:143], a[4:7], v[52:55]
s_add_u32 s12, s12, s3
v_mfma_f32_16x16x32_bf16 v[56:59], a[128:131], a[8:11], v[56:59]
buffer_load_dwordx4 v4, s[40:43], s29 offen offset:2048 sc1 lds
v_mfma_f32_16x16x32_bf16 v[56:59], a[136:139], a[12:15], v[56:59]
v_mfma_f32_16x16x32_bf16 v[60:63], a[132:135], a[8:11], v[60:63]
s_add_u32 s12, s12, 104857600
s_cmp_eq_u32 s20, 3
v_mfma_f32_16x16x32_bf16 v[60:63], a[140:143], a[12:15], v[60:63]
buffer_load_dwordx4 v4, s[40:43], s29 offen offset:3072 sc1 lds
v_mfma_f32_16x16x32_bf16 v[64:67], a[128:131], a[16:19], v[64:67]
v_mfma_f32_16x16x32_bf16 v[64:67], a[136:139], a[20:23], v[64:67]
v_mfma_f32_16x16x32_bf16 v[68:71], a[132:135], a[16:19], v[68:71]
s_cselect_b32 s50, 1073741824, s50
s_add_u32 s29, s29, 1024
s_waitcnt vmcnt(39) lgkmcnt(0)
s_barrier
ds_read_b128 a[0:3], v10 offset:32768
ds_read_b128 a[4:7], v11 offset:32768
ds_read_b128 a[8:11], v10 offset:34816
ds_read_b128 a[12:15], v11 offset:34816
ds_read_b128 a[16:19], v10 offset:36864
v_mfma_f32_16x16x32_bf16 v[68:71], a[140:143], a[20:23], v[68:71]
ds_read_b128 a[20:23], v11 offset:36864
s_add_u32 m0, s32, 1024
v_mfma_f32_16x16x32_bf16 v[72:75], a[128:131], a[40:43], v[72:75]
buffer_load_dwordx4 v4, s[40:43], s29 offen offset:3072 sc1 lds
s_xor_b32 s29, s18, 393216
v_mfma_f32_16x16x32_bf16 v[72:75], a[136:139], a[44:47], v[72:75]
v_mfma_f32_16x16x32_bf16 v[76:79], a[132:135], a[40:43], v[76:79]
s_add_u32 m0, s26, 0
v_mfma_f32_16x16x32_bf16 v[76:79], a[140:143], a[44:47], v[76:79]
buffer_load_dwordx4 v4, s[40:43], s29 offen offset:0 sc1 lds
v_mfma_f32_16x16x32_bf16 v[80:83], a[128:131], a[48:51], v[80:83]
v_mfma_f32_16x16x32_bf16 v[80:83], a[136:139], a[52:55], v[80:83]
v_mfma_f32_16x16x32_bf16 v[84:87], a[132:135], a[48:51], v[84:87]
buffer_load_dwordx4 v4, s[40:43], s29 offen offset:1024 sc1 lds
v_mfma_f32_16x16x32_bf16 v[84:87], a[140:143], a[52:55], v[84:87]
v_mfma_f32_16x16x32_bf16 v[88:91], a[128:131], a[56:59], v[88:91]
buffer_load_dwordx4 v4, s[40:43], s29 offen offset:2048 sc1 lds
v_mfma_f32_16x16x32_bf16 v[88:91], a[136:139], a[60:63], v[88:91]
v_mfma_f32_16x16x32_bf16 v[92:95], a[132:135], a[56:59], v[92:95]
s_waitcnt vmcnt(13) lgkmcnt(0)
v_cmp_gt_u32 vcc, 8, v30
s_cmp_lg_u64 vcc, 0
v_mfma_f32_16x16x32_bf16 v[92:95], a[140:143], a[60:63], v[92:95]
s_cbranch_scc1 kf_kernel_spin_ctx6
kf_kernel_ret_ctx6:
ds_read_b128 a[40:43], v10 offset:38912
s_xor_b32 s34, s16, 4096
ds_read_b128 a[44:47], v11 offset:38912
ds_read_b128 a[48:51], v10 offset:40960
ds_read_b128 a[52:55], v11 offset:40960
ds_read_b128 a[56:59], v10 offset:43008
v_mfma_f32_16x16x32_bf16 v[48:51], a[144:147], a[0:3], v[48:51]
ds_read_b128 a[60:63], v11 offset:43008
v_mfma_f32_16x16x32_bf16 v[48:51], a[152:155], a[4:7], v[48:51]
buffer_load_dwordx4 v4, s[40:43], s29 offen offset:3072 sc1 lds
s_add_u32 s29, s29, 1024
v_mfma_f32_16x16x32_bf16 v[52:55], a[148:151], a[0:3], v[52:55]
v_mfma_f32_16x16x32_bf16 v[52:55], a[156:159], a[4:7], v[52:55]
v_mfma_f32_16x16x32_bf16 v[56:59], a[144:147], a[8:11], v[56:59]
s_add_u32 m0, s26, 1024
v_mfma_f32_16x16x32_bf16 v[56:59], a[152:155], a[12:15], v[56:59]
buffer_load_dwordx4 v4, s[40:43], s29 offen offset:3072 sc1 lds
v_mfma_f32_16x16x32_bf16 v[60:63], a[148:151], a[8:11], v[60:63]
buffer_load_dwordx4 a[240:243], v4, s[40:43], s34 offen sc1
v_mfma_f32_16x16x32_bf16 v[60:63], a[156:159], a[12:15], v[60:63]
v_mfma_f32_16x16x32_bf16 v[64:67], a[144:147], a[16:19], v[64:67]
v_mfma_f32_16x16x32_bf16 v[64:67], a[152:155], a[20:23], v[64:67]
v_mfma_f32_16x16x32_bf16 v[68:71], a[148:151], a[16:19], v[68:71]
v_mfma_f32_16x16x32_bf16 v[68:71], a[156:159], a[20:23], v[68:71]
s_waitcnt vmcnt(36) lgkmcnt(0)
s_barrier
ds_read_b128 a[0:3], v12 offset:0
ds_read_b128 a[4:7], v13 offset:0
ds_read_b128 a[8:11], v12 offset:2048
v_mfma_f32_16x16x32_bf16 v[72:75], a[144:147], a[40:43], v[72:75]
ds_read_b128 a[12:15], v13 offset:2048
ds_read_b128 a[16:19], v12 offset:4096
ds_read_b128 a[20:23], v13 offset:4096
v_mfma_f32_16x16x32_bf16 v[72:75], a[152:155], a[44:47], v[72:75]
buffer_load_dwordx4 a[248:251], v4, s[40:43], s34 offen offset:1024 sc1
v_mfma_f32_16x16x32_bf16 v[76:79], a[148:151], a[40:43], v[76:79]
v_mfma_f32_16x16x32_bf16 v[76:79], a[156:159], a[44:47], v[76:79]
s_xor_b32 s34, s17, 4096
buffer_load_dwordx4 a[244:247], v4, s[40:43], s34 offen sc1
v_mfma_f32_16x16x32_bf16 v[80:83], a[144:147], a[48:51], v[80:83]
v_mfma_f32_16x16x32_bf16 v[80:83], a[152:155], a[52:55], v[80:83]
s_add_u32 m0, s26, 20480
v_mfma_f32_16x16x32_bf16 v[84:87], a[148:151], a[48:51], v[84:87]
buffer_load_dwordx4 a[252:255], v4, s[40:43], s34 offen offset:1024 sc1
v_mfma_f32_16x16x32_bf16 v[84:87], a[156:159], a[52:55], v[84:87]
v_mfma_f32_16x16x32_bf16 v[88:91], a[144:147], a[56:59], v[88:91]
s_xor_b32 s34, s16, 6144
buffer_load_dwordx4 a[80:83], v4, s[40:43], s34 offen sc1
v_mfma_f32_16x16x32_bf16 v[88:91], a[152:155], a[60:63], v[88:91]
s_xor_b32 s29, s18, 524288
v_mfma_f32_16x16x32_bf16 v[92:95], a[148:151], a[56:59], v[92:95]
v_mfma_f32_16x16x32_bf16 v[92:95], a[156:159], a[60:63], v[92:95]
s_waitcnt vmcnt(48) lgkmcnt(0)
ds_read_b128 a[40:43], v12 offset:6144
ds_read_b128 a[44:47], v13 offset:6144
ds_read_b128 a[48:51], v12 offset:8192
v_mfma_f32_16x16x32_bf16 v[48:51], a[160:163], a[0:3], v[48:51]
ds_read_b128 a[52:55], v13 offset:8192
v_mfma_f32_16x16x32_bf16 v[48:51], a[168:171], a[4:7], v[48:51]
buffer_load_dwordx4 a[88:91], v4, s[40:43], s34 offen offset:1024 sc1
ds_read_b128 a[56:59], v12 offset:10240
ds_read_b128 a[60:63], v13 offset:10240
v_mfma_f32_16x16x32_bf16 v[52:55], a[164:167], a[0:3], v[52:55]
v_mfma_f32_16x16x32_bf16 v[52:55], a[172:175], a[4:7], v[52:55]
v_mfma_f32_16x16x32_bf16 v[56:59], a[160:163], a[8:11], v[56:59]
s_xor_b32 s34, s17, 6144
buffer_load_dwordx4 a[84:87], v4, s[40:43], s34 offen sc1
v_mfma_f32_16x16x32_bf16 v[56:59], a[168:171], a[12:15], v[56:59]
v_mfma_f32_16x16x32_bf16 v[60:63], a[164:167], a[8:11], v[60:63]
v_mfma_f32_16x16x32_bf16 v[60:63], a[172:175], a[12:15], v[60:63]
buffer_load_dwordx4 a[92:95], v4, s[40:43], s34 offen offset:1024 sc1
v_mfma_f32_16x16x32_bf16 v[64:67], a[160:163], a[16:19], v[64:67]
v_mfma_f32_16x16x32_bf16 v[64:67], a[168:171], a[20:23], v[64:67]
v_mfma_f32_16x16x32_bf16 v[68:71], a[164:167], a[16:19], v[68:71]
v_mfma_f32_16x16x32_bf16 v[68:71], a[172:175], a[20:23], v[68:71]
s_waitcnt vmcnt(38) lgkmcnt(0)
s_barrier
ds_read_b128 a[0:3], v12 offset:16384
ds_read_b128 a[4:7], v13 offset:16384
ds_read_b128 a[8:11], v12 offset:18432
ds_read_b128 a[12:15], v13 offset:18432
ds_read_b128 a[16:19], v12 offset:20480
ds_read_b128 a[20:23], v13 offset:20480
v_mfma_f32_16x16x32_bf16 v[72:75], a[160:163], a[40:43], v[72:75]
v_mfma_f32_16x16x32_bf16 v[72:75], a[168:171], a[44:47], v[72:75]
buffer_load_dwordx4 v4, s[40:43], s29 offen offset:0 sc1 lds
v_mfma_f32_16x16x32_bf16 v[76:79], a[164:167], a[40:43], v[76:79]
v_mfma_f32_16x16x32_bf16 v[76:79], a[172:175], a[44:47], v[76:79]
buffer_load_dwordx4 v4, s[40:43], s29 offen offset:1024 sc1 lds
v_mfma_f32_16x16x32_bf16 v[80:83], a[160:163], a[48:51], v[80:83]
v_mfma_f32_16x16x32_bf16 v[80:83], a[168:171], a[52:55], v[80:83]
buffer_load_dwordx4 v4, s[40:43], s29 offen offset:2048 sc1 lds
v_mfma_f32_16x16x32_bf16 v[84:87], a[164:167], a[48:51], v[84:87]
v_mfma_f32_16x16x32_bf16 v[84:87], a[172:175], a[52:55], v[84:87]
v_mfma_f32_16x16x32_bf16 v[88:91], a[160:163], a[56:59], v[88:91]
buffer_load_dwordx4 v4, s[40:43], s29 offen offset:3072 sc1 lds
v_mfma_f32_16x16x32_bf16 v[88:91], a[168:171], a[60:63], v[88:91]
s_add_u32 m0, s26, 21504
v_mfma_f32_16x16x32_bf16 v[92:95], a[164:167], a[56:59], v[92:95]
v_mfma_f32_16x16x32_bf16 v[92:95], a[172:175], a[60:63], v[92:95]
s_waitcnt vmcnt(48) lgkmcnt(0)
ds_read_b128 a[40:43], v12 offset:22528
ds_read_b128 a[44:47], v13 offset:22528
ds_read_b128 a[48:51], v12 offset:24576
ds_read_b128 a[52:55], v13 offset:24576
ds_read_b128 a[56:59], v12 offset:26624
ds_read_b128 a[60:63], v13 offset:26624
v_mfma_f32_16x16x32_bf16 v[48:51], a[176:179], a[0:3], v[48:51]
s_add_u32 s29, s29, 1024
s_xor_b32 s34, s16, 8192
v_mfma_f32_16x16x32_bf16 v[48:51], a[184:187], a[4:7], v[48:51]
buffer_load_dwordx4 v4, s[40:43], s29 offen offset:3072 sc1 lds
v_mfma_f32_16x16x32_bf16 v[52:55], a[180:183], a[0:3], v[52:55]
v_mfma_f32_16x16x32_bf16 v[52:55], a[188:191], a[4:7], v[52:55]
v_mfma_f32_16x16x32_bf16 v[56:59], a[176:179], a[8:11], v[56:59]
buffer_load_dwordx4 a[96:99], v4, s[40:43], s34 offen sc1
v_mfma_f32_16x16x32_bf16 v[56:59], a[184:187], a[12:15], v[56:59]
v_mfma_f32_16x16x32_bf16 v[60:63], a[180:183], a[8:11], v[60:63]
v_mfma_f32_16x16x32_bf16 v[60:63], a[188:191], a[12:15], v[60:63]
buffer_load_dwordx4 a[104:107], v4, s[40:43], s34 offen offset:1024 sc1
v_mfma_f32_16x16x32_bf16 v[64:67], a[176:179], a[16:19], v[64:67]
v_mfma_f32_16x16x32_bf16 v[64:67], a[184:187], a[20:23], v[64:67]
v_mfma_f32_16x16x32_bf16 v[68:71], a[180:183], a[16:19], v[68:71]
s_xor_b32 s29, s18, 655360
v_mfma_f32_16x16x32_bf16 v[68:71], a[188:191], a[20:23], v[68:71]
s_waitcnt vmcnt(36) lgkmcnt(0)
s_barrier
ds_read_b128 a[0:3], v10 offset:49152
ds_read_b128 a[4:7], v11 offset:49152
ds_read_b128 a[8:11], v10 offset:51200
ds_read_b128 a[12:15], v11 offset:51200
v_mfma_f32_16x16x32_bf16 v[72:75], a[176:179], a[40:43], v[72:75]
ds_read_b128 a[16:19], v10 offset:53248
ds_read_b128 a[20:23], v11 offset:53248
s_xor_b32 s34, s17, 8192
buffer_load_dwordx4 a[100:103], v4, s[40:43], s34 offen sc1
v_mfma_f32_16x16x32_bf16 v[72:75], a[184:187], a[44:47], v[72:75]
s_add_u32 m0, s27, 0
v_mfma_f32_16x16x32_bf16 v[76:79], a[180:183], a[40:43], v[76:79]
v_mfma_f32_16x16x32_bf16 v[76:79], a[188:191], a[44:47], v[76:79]
buffer_load_dwordx4 a[108:111], v4, s[40:43], s34 offen offset:1024 sc1
v_mfma_f32_16x16x32_bf16 v[80:83], a[176:179], a[48:51], v[80:83]
v_mfma_f32_16x16x32_bf16 v[80:83], a[184:187], a[52:55], v[80:83]
v_mfma_f32_16x16x32_bf16 v[84:87], a[180:183], a[48:51], v[84:87]
buffer_load_dwordx4 v4, s[40:43], s29 offen offset:0 sc1 lds
v_mfma_f32_16x16x32_bf16 v[84:87], a[188:191], a[52:55], v[84:87]
v_mfma_f32_16x16x32_bf16 v[88:91], a[176:179], a[56:59], v[88:91]
buffer_load_dwordx4 v4, s[40:43], s29 offen offset:1024 sc1 lds
v_mfma_f32_16x16x32_bf16 v[88:91], a[184:187], a[60:63], v[88:91]
v_mfma_f32_16x16x32_bf16 v[92:95], a[180:183], a[56:59], v[92:95]
s_waitcnt vmcnt(44) lgkmcnt(0)
ds_read_b128 a[40:43], v10 offset:55296
ds_read_b128 a[44:47], v11 offset:55296
ds_read_b128 a[48:51], v10 offset:57344
ds_read_b128 a[52:55], v11 offset:57344
v_mfma_f32_16x16x32_bf16 v[92:95], a[188:191], a[60:63], v[92:95]
v_mfma_f32_16x16x32_bf16 v[48:51], a[192:195], a[0:3], v[48:51]
ds_read_b128 a[56:59], v10 offset:59392
ds_read_b128 a[60:63], v11 offset:59392
v_mfma_f32_16x16x32_bf16 v[48:51], a[200:203], a[4:7], v[48:51]
buffer_load_dwordx4 v4, s[40:43], s29 offen offset:2048 sc1 lds
v_mfma_f32_16x16x32_bf16 v[52:55], a[196:199], a[0:3], v[52:55]
v_mfma_f32_16x16x32_bf16 v[52:55], a[204:207], a[4:7], v[52:55]
v_mfma_f32_16x16x32_bf16 v[56:59], a[192:195], a[8:11], v[56:59]
buffer_load_dwordx4 v4, s[40:43], s29 offen offset:3072 sc1 lds
s_add_u32 m0, s27, 1024
s_add_u32 s29, s29, 1024
v_mfma_f32_16x16x32_bf16 v[56:59], a[200:203], a[12:15], v[56:59]
v_mfma_f32_16x16x32_bf16 v[60:63], a[196:199], a[8:11], v[60:63]
v_mfma_f32_16x16x32_bf16 v[60:63], a[204:207], a[12:15], v[60:63]
buffer_load_dwordx4 v4, s[40:43], s29 offen offset:3072 sc1 lds
v_mfma_f32_16x16x32_bf16 v[64:67], a[192:195], a[16:19], v[64:67]
v_mfma_f32_16x16x32_bf16 v[64:67], a[200:203], a[20:23], v[64:67]
v_mfma_f32_16x16x32_bf16 v[68:71], a[196:199], a[16:19], v[68:71]
s_waitcnt vmcnt(38) lgkmcnt(0)
s_barrier
ds_read_b128 a[0:3], v32 offset:25600
ds_read_b128 a[4:7], v32 offset:35840
ds_read_b128 a[8:11], v32 offset:26624
ds_read_b128 a[12:15], v32 offset:36864
ds_read_b128 a[16:19], v32 offset:27648
v_mfma_f32_16x16x32_bf16 v[68:71], a[204:207], a[20:23], v[68:71]
s_xor_b32 s34, s16, 10240
ds_read_b128 a[20:23], v32 offset:37888
buffer_load_dwordx4 a[112:115], v4, s[40:43], s34 offen sc1
ds_read_b128 a[24:27], v32 offset:28672
ds_read_b128 a[28:31], v32 offset:38912
ds_read_b128 a[32:35], v32 offset:29696
ds_read_b128 a[36:39], v32 offset:39936
v_mfma_f32_16x16x32_bf16 v[72:75], a[192:195], a[40:43], v[72:75]
v_mfma_f32_16x16x32_bf16 v[72:75], a[200:203], a[44:47], v[72:75]
v_mfma_f32_16x16x32_bf16 v[76:79], a[196:199], a[40:43], v[76:79]
v_mfma_f32_16x16x32_bf16 v[76:79], a[204:207], a[44:47], v[76:79]
buffer_load_dwordx4 a[120:123], v4, s[40:43], s34 offen offset:1024 sc1
s_xor_b32 s34, s17, 10240
v_mfma_f32_16x16x32_bf16 v[80:83], a[192:195], a[48:51], v[80:83]
buffer_load_dwordx4 a[116:119], v4, s[40:43], s34 offen sc1
v_mfma_f32_16x16x32_bf16 v[80:83], a[200:203], a[52:55], v[80:83]
v_mfma_f32_16x16x32_bf16 v[84:87], a[196:199], a[48:51], v[84:87]
v_mfma_f32_16x16x32_bf16 v[84:87], a[204:207], a[52:55], v[84:87]
v_mfma_f32_16x16x32_bf16 v[88:91], a[192:195], a[56:59], v[88:91]
buffer_load_dwordx4 a[124:127], v4, s[40:43], s34 offen offset:1024 sc1
v_mfma_f32_16x16x32_bf16 v[88:91], a[200:203], a[60:63], v[88:91]
v_mfma_f32_16x16x32_bf16 v[92:95], a[196:199], a[56:59], v[92:95]
v_mfma_f32_16x16x32_bf16 v[92:95], a[204:207], a[60:63], v[92:95]
kf_kernel_o:
v_cvt_pk_bf16_f32 v56, v56, v57
s_xor_b32 s29, s18, 786432
s_lshl2_add_u32 s3, s2, s20
s_mul_i32 s3, s3, 13312
v_cvt_pk_bf16_f32 v57, v58, v59
s_waitcnt vmcnt(48) lgkmcnt(0)
v_mfma_f32_16x16x32_bf16 v[188:191], a[0:3], v[224:227], 0
s_add_u32 m0, s26, 40960
ds_read_b128 a[40:43], v32 offset:20480
ds_read_b128 a[44:47], v32 offset:30720
v_mfma_f32_16x16x32_bf16 v[188:191], a[4:7], v[228:231], v[188:191]
ds_read_b128 a[48:51], v32 offset:21504
ds_read_b128 a[52:55], v32 offset:31744
v_mfma_f32_16x16x32_bf16 v[148:151], a[0:3], v[208:211], 0
buffer_load_dwordx4 v4, s[40:43], s29 offen offset:0 sc1 lds
v_mfma_f32_16x16x32_bf16 v[148:151], a[4:7], v[212:215], v[148:151]
ds_read_b128 a[56:59], v32 offset:22528
ds_read_b128 a[60:63], v32 offset:32768
v_mfma_f32_16x16x32_bf16 v[192:195], a[8:11], v[224:227], 0
ds_read_b128 a[64:67], v32 offset:23552
ds_read_b128 a[68:71], v32 offset:33792
v_mfma_f32_16x16x32_bf16 v[192:195], a[12:15], v[228:231], v[192:195]
v_cvt_pk_bf16_f32 v72, v72, v73
v_cvt_pk_bf16_f32 v58, v60, v61
v_mfma_f32_16x16x32_bf16 v[152:155], a[8:11], v[208:211], 0
ds_read_b128 a[72:75], v32 offset:24576
ds_read_b128 a[76:79], v32 offset:34816
v_mfma_f32_16x16x32_bf16 v[152:155], a[12:15], v[212:215], v[152:155]
s_add_u32 s3, s3, 83894272
v_cvt_pk_bf16_f32 v59, v62, v63
v_mfma_f32_16x16x32_bf16 v[196:199], a[16:19], v[224:227], 0
buffer_store_dwordx4 v[56:59], v4, s[40:43], s3 offen offset:0 sc1
v_mfma_f32_16x16x32_bf16 v[196:199], a[20:23], v[228:231], v[196:199]
v_mfma_f32_16x16x32_bf16 v[156:159], a[16:19], v[208:211], 0
v_bfe_u32 v1, v0, 2, 2
v_mfma_f32_16x16x32_bf16 v[156:159], a[20:23], v[212:215], v[156:159]
v_mfma_f32_16x16x32_bf16 v[200:203], a[24:27], v[224:227], 0
buffer_load_dwordx4 v4, s[40:43], s29 offen offset:1024 sc1 lds
v_mfma_f32_16x16x32_bf16 v[200:203], a[28:31], v[228:231], v[200:203]
v_cvt_pk_bf16_f32 v73, v74, v75
v_cvt_pk_bf16_f32 v75, v78, v79
v_mfma_f32_16x16x32_bf16 v[160:163], a[24:27], v[208:211], 0
v_cvt_pk_bf16_f32 v74, v76, v77
v_mfma_f32_16x16x32_bf16 v[160:163], a[28:31], v[212:215], v[160:163]
v_mfma_f32_16x16x32_bf16 v[204:207], a[32:35], v[224:227], 0
buffer_store_dwordx4 v[72:75], v4, s[40:43], s3 offen offset:1024 sc1
v_mfma_f32_16x16x32_bf16 v[204:207], a[36:39], v[228:231], v[204:207]
v_mfma_f32_16x16x32_bf16 v[164:167], a[32:35], v[208:211], 0
s_waitcnt vmcnt(40) lgkmcnt(0)
s_barrier
v_mfma_f32_16x16x32_bf16 v[164:167], a[36:39], v[212:215], v[164:167]
ds_read_b128 a[0:3], v32 offset:46080
ds_read_b128 a[4:7], v32 offset:56320
v_mfma_f32_16x16x32_bf16 v[168:171], a[40:43], v[224:227], 0
v_cvt_pk_bf16_f32 v88, v88, v89
v_cvt_pk_bf16_f32 v104, v104, v105
v_mfma_f32_16x16x32_bf16 v[168:171], a[44:47], v[228:231], v[168:171]
v_cvt_pk_bf16_f32 v89, v90, v91
v_cvt_pk_bf16_f32 v90, v92, v93
v_mfma_f32_16x16x32_bf16 v[128:131], a[40:43], v[208:211], 0
ds_read_b128 a[8:11], v32 offset:47104
ds_read_b128 a[12:15], v32 offset:57344
v_mfma_f32_16x16x32_bf16 v[128:131], a[44:47], v[212:215], v[128:131]
buffer_load_dwordx4 v4, s[40:43], s29 offen offset:2048 sc1 lds
v_mfma_f32_16x16x32_bf16 v[172:175], a[48:51], v[224:227], 0
ds_read_b128 a[16:19], v32 offset:48128
ds_read_b128 a[20:23], v32 offset:58368
v_mfma_f32_16x16x32_bf16 v[172:175], a[52:55], v[228:231], v[172:175]
ds_read_b128 a[24:27], v32 offset:49152
ds_read_b128 a[28:31], v32 offset:59392
v_mfma_f32_16x16x32_bf16 v[132:135], a[48:51], v[208:211], 0
ds_read_b128 a[32:35], v32 offset:50176
v_mfma_f32_16x16x32_bf16 v[132:135], a[52:55], v[212:215], v[132:135]
v_cvt_pk_bf16_f32 v91, v94, v95
v_cvt_pk_bf16_f32 v105, v106, v107
v_mfma_f32_16x16x32_bf16 v[176:179], a[56:59], v[224:227], 0
buffer_store_dwordx4 v[88:91], v4, s[40:43], s3 offen offset:2048 sc1
v_mfma_f32_16x16x32_bf16 v[176:179], a[60:63], v[228:231], v[176:179]
buffer_load_dwordx4 v4, s[40:43], s29 offen offset:3072 sc1 lds
v_mfma_f32_16x16x32_bf16 v[136:139], a[56:59], v[208:211], 0
ds_read_b128 a[36:39], v32 offset:60416
v_mfma_f32_16x16x32_bf16 v[136:139], a[60:63], v[212:215], v[136:139]
v_bfe_u32 v2, v0, 4, 2
v_mfma_f32_16x16x32_bf16 v[180:183], a[64:67], v[224:227], 0
s_add_u32 s29, s29, 1024
v_cmp_eq_u32 vcc, v1, v2
v_mov_b64 v[12:13], 0
v_mfma_f32_16x16x32_bf16 v[180:183], a[68:71], v[228:231], v[180:183]
s_add_u32 m0, s26, 41984
v_cvt_pk_bf16_f32 v107, v110, v111
v_mov_b32 v1, 0x3f80
v_mfma_f32_16x16x32_bf16 v[140:143], a[64:67], v[208:211], 0
buffer_load_dwordx4 v4, s[40:43], s29 offen offset:3072 sc1 lds
v_mfma_f32_16x16x32_bf16 v[140:143], a[68:71], v[212:215], v[140:143]
s_add_u32 s3, s3, s52
v_cvt_pk_bf16_f32 v106, v108, v109
v_mov_b64 v[8:9], 0
v_mfma_f32_16x16x32_bf16 v[184:187], a[72:75], v[224:227], 0
buffer_store_dwordx4 v[104:107], v4, s[40:43], s3 offen offset:3072 sc1
v_mfma_f32_16x16x32_bf16 v[184:187], a[76:79], v[228:231], v[184:187]
v_mfma_f32_16x16x32_bf16 v[144:147], a[72:75], v[208:211], 0
v_mfma_f32_16x16x32_bf16 v[144:147], a[76:79], v[212:215], v[144:147]
s_waitcnt vmcnt(48) lgkmcnt(0)
ds_read_b128 a[40:43], v32 offset:40960
ds_read_b128 a[44:47], v32 offset:51200
v_mfma_f32_16x16x32_bf16 v[188:191], a[0:3], v[232:235], v[188:191]
s_xor_b32 s34, s16, 12288
ds_read_b128 a[48:51], v32 offset:41984
ds_read_b128 a[52:55], v32 offset:52224
v_mfma_f32_16x16x32_bf16 v[188:191], a[4:7], v[236:239], v[188:191]
buffer_load_dwordx4 a[128:131], v4, s[40:43], s34 offen sc1
v_mfma_f32_16x16x32_bf16 v[148:151], a[0:3], v[216:219], v[148:151]
ds_read_b128 a[56:59], v32 offset:43008
ds_read_b128 a[60:63], v32 offset:53248
v_mfma_f32_16x16x32_bf16 v[148:151], a[4:7], v[220:223], v[148:151]
ds_read_b128 a[64:67], v32 offset:44032
ds_read_b128 a[68:71], v32 offset:54272
v_mfma_f32_16x16x32_bf16 v[192:195], a[8:11], v[232:235], v[192:195]
ds_read_b128 a[72:75], v32 offset:45056
ds_read_b128 a[76:79], v32 offset:55296
v_mfma_f32_16x16x32_bf16 v[192:195], a[12:15], v[236:239], v[192:195]
buffer_load_dwordx4 a[136:139], v4, s[40:43], s34 offen offset:1024 sc1
v_mfma_f32_16x16x32_bf16 v[152:155], a[8:11], v[216:219], v[152:155]
v_permlane16_swap_b32 v240, v242
v_mfma_f32_16x16x32_bf16 v[152:155], a[12:15], v[220:223], v[152:155]
s_xor_b32 s34, s17, 12288
v_permlane16_swap_b32 v241, v243
v_mfma_f32_16x16x32_bf16 v[196:199], a[16:19], v[232:235], v[196:199]
buffer_load_dwordx4 a[132:135], v4, s[40:43], s34 offen sc1
v_mfma_f32_16x16x32_bf16 v[196:199], a[20:23], v[236:239], v[196:199]
v_mov_b32 v3, 0
v_mfma_f32_16x16x32_bf16 v[156:159], a[16:19], v[216:219], v[156:159]
s_xor_b32 s29, s18, 917504
v_lshlrev_b32 v210, 16, v241
v_cndmask_b32 v2, 0, v1, vcc
v_mfma_f32_16x16x32_bf16 v[156:159], a[20:23], v[220:223], v[156:159]
v_and_b32 v225, 0xffff0000, v242
v_and_b32 v227, 0xffff0000, v243
v_mfma_f32_16x16x32_bf16 v[200:203], a[24:27], v[232:235], v[200:203]
v_lshlrev_b32 v226, 16, v243
v_mfma_f32_16x16x32_bf16 v[200:203], a[28:31], v[236:239], v[200:203]
v_mfma_f32_16x16x32_bf16 v[160:163], a[24:27], v[216:219], v[160:163]
v_and_b32 v1, 48, v4
v_lshlrev_b32 v224, 16, v242
v_mfma_f32_16x16x32_bf16 v[160:163], a[28:31], v[220:223], v[160:163]
s_add_u32 m0, s32, 20480
v_and_b32 v211, 0xffff0000, v241
v_mfma_f32_16x16x32_bf16 v[204:207], a[32:35], v[232:235], v[204:207]
buffer_load_dwordx4 a[140:143], v4, s[40:43], s34 offen offset:1024 sc1
v_mfma_f32_16x16x32_bf16 v[204:207], a[36:39], v[236:239], v[204:207]
buffer_load_dwordx4 v4, s[40:43], s29 offen offset:0 sc1 lds
v_mfma_f32_16x16x32_bf16 v[164:167], a[32:35], v[216:219], v[164:167]
v_mov_b32 v24, 0
v_and_b32 v209, 0xffff0000, v240
v_mfma_f32_16x16x32_bf16 v[164:167], a[36:39], v[220:223], v[164:167]
s_waitcnt vmcnt(45) lgkmcnt(0)
s_barrier
v_mfma_f32_16x16x32_bf16 v[168:171], a[40:43], v[232:235], v[168:171]
v_permlane16_swap_b32 v244, v246
v_mfma_f32_16x16x32_bf16 v[168:171], a[44:47], v[236:239], v[168:171]
buffer_load_dwordx4 v4, s[40:43], s29 offen offset:1024 sc1 lds
v_mfma_f32_16x16x32_bf16 v[128:131], a[40:43], v[216:219], v[128:131]
ds_read_b128 a[0:3], v32 offset:5120
ds_read_b128 a[4:7], v32 offset:15360
v_mfma_f32_16x16x32_bf16 v[128:131], a[44:47], v[220:223], v[128:131]
ds_read_b128 a[8:11], v32 offset:6144
ds_read_b128 a[12:15], v32 offset:16384
v_mfma_f32_16x16x32_bf16 v[172:175], a[48:51], v[232:235], v[172:175]
buffer_load_dwordx4 v4, s[40:43], s29 offen offset:2048 sc1 lds
v_mfma_f32_16x16x32_bf16 v[172:175], a[52:55], v[236:239], v[172:175]
ds_read_b128 a[16:19], v32 offset:7168
ds_read_b128 a[20:23], v32 offset:17408
v_mfma_f32_16x16x32_bf16 v[132:135], a[48:51], v[216:219], v[132:135]
ds_read_b128 a[24:27], v32 offset:8192
ds_read_b128 a[28:31], v32 offset:18432
v_mfma_f32_16x16x32_bf16 v[132:135], a[52:55], v[220:223], v[132:135]
ds_read_b128 a[32:35], v32 offset:9216
ds_read_b128 a[36:39], v32 offset:19456
v_mfma_f32_16x16x32_bf16 v[176:179], a[56:59], v[232:235], v[176:179]
v_permlane16_swap_b32 v245, v247
v_mfma_f32_16x16x32_bf16 v[176:179], a[60:63], v[236:239], v[176:179]
v_lshlrev_b64 v[10:11], v1, v[2:3]
v_mfma_f32_16x16x32_bf16 v[136:139], a[56:59], v[216:219], v[136:139]
buffer_load_dwordx4 v4, s[40:43], s29 offen offset:3072 sc1 lds
v_mfma_f32_16x16x32_bf16 v[136:139], a[60:63], v[220:223], v[136:139]
v_and_b32 v215, 0xffff0000, v245
v_lshlrev_b32 v208, 16, v240
v_mfma_f32_16x16x32_bf16 v[180:183], a[64:67], v[232:235], v[180:183]
s_add_u32 s29, s29, 1024
v_lshlrev_b32 v212, 16, v244
v_lshlrev_b32 v214, 16, v245
v_mfma_f32_16x16x32_bf16 v[180:183], a[68:71], v[236:239], v[180:183]
s_add_u32 m0, s32, 21504
v_mfma_f32_16x16x32_bf16 v[140:143], a[64:67], v[216:219], v[140:143]
v_mfma_f32_16x16x32_bf16 v[140:143], a[68:71], v[220:223], v[140:143]
buffer_load_dwordx4 v4, s[40:43], s29 offen offset:3072 sc1 lds
v_mfma_f32_16x16x32_bf16 v[184:187], a[72:75], v[232:235], v[184:187]
v_and_b32 v213, 0xffff0000, v244
v_mfma_f32_16x16x32_bf16 v[184:187], a[76:79], v[236:239], v[184:187]
v_and_b32 v229, 0xffff0000, v246
v_mfma_f32_16x16x32_bf16 v[144:147], a[72:75], v[216:219], v[144:147]
v_and_b32 v231, 0xffff0000, v247
s_add_u32 m0, s32, 40960
v_mfma_f32_16x16x32_bf16 v[144:147], a[76:79], v[220:223], v[144:147]
s_waitcnt vmcnt(40) lgkmcnt(0)
v_permlane16_swap_b32 v249, v251
v_mfma_f32_16x16x32_bf16 v[188:191], a[0:3], a[244:247], v[188:191]
v_permlane16_swap_b32 v248, v250
v_mfma_f32_16x16x32_bf16 v[188:191], a[4:7], a[252:255], v[188:191]
s_xor_b32 s34, s16, 14336
ds_read_b128 a[40:43], v32 offset:0
ds_read_b128 a[44:47], v32 offset:10240
v_mfma_f32_16x16x32_bf16 v[148:151], a[0:3], a[240:243], v[148:151]
s_xor_b32 s29, s18, 1048576
ds_read_b128 a[48:51], v32 offset:1024
ds_read_b128 a[52:55], v32 offset:11264
v_mfma_f32_16x16x32_bf16 v[148:151], a[4:7], a[248:251], v[148:151]
buffer_load_dwordx4 a[144:147], v4, s[40:43], s34 offen sc1
v_mfma_f32_16x16x32_bf16 v[192:195], a[8:11], a[244:247], v[192:195]
buffer_load_dwordx4 a[152:155], v4, s[40:43], s34 offen offset:1024 sc1
v_mfma_f32_16x16x32_bf16 v[192:195], a[12:15], a[252:255], v[192:195]
s_xor_b32 s34, s17, 14336
ds_read_b128 a[56:59], v32 offset:2048
ds_read_b128 a[60:63], v32 offset:12288
v_mfma_f32_16x16x32_bf16 v[152:155], a[8:11], a[240:243], v[152:155]
ds_read_b128 a[64:67], v32 offset:3072
v_mfma_f32_16x16x32_bf16 v[152:155], a[12:15], a[248:251], v[152:155]
ds_read_b128 a[68:71], v32 offset:13312
ds_read_b128 a[72:75], v32 offset:4096
v_mfma_f32_16x16x32_bf16 v[196:199], a[16:19], a[244:247], v[196:199]
buffer_load_dwordx4 a[148:151], v4, s[40:43], s34 offen sc1
v_mfma_f32_16x16x32_bf16 v[196:199], a[20:23], a[252:255], v[196:199]
ds_read_b128 a[76:79], v32 offset:14336
v_mfma_f32_16x16x32_bf16 v[156:159], a[16:19], a[240:243], v[156:159]
v_lshlrev_b32 v230, 16, v247
v_mfma_f32_16x16x32_bf16 v[156:159], a[20:23], a[248:251], v[156:159]
v_lshlrev_b32 v234, 16, v251
v_and_b32 v217, 0xffff0000, v248
v_mfma_f32_16x16x32_bf16 v[200:203], a[24:27], a[244:247], v[200:203]
buffer_load_dwordx4 a[156:159], v4, s[40:43], s34 offen offset:1024 sc1
v_mfma_f32_16x16x32_bf16 v[200:203], a[28:31], a[252:255], v[200:203]
v_lshlrev_b32 v232, 16, v250
v_mfma_f32_16x16x32_bf16 v[160:163], a[24:27], a[240:243], v[160:163]
buffer_load_dwordx4 v4, s[40:43], s29 offen offset:0 sc1 lds
v_mfma_f32_16x16x32_bf16 v[160:163], a[28:31], a[248:251], v[160:163]
v_mfma_f32_16x16x32_bf16 v[204:207], a[32:35], a[244:247], v[204:207]
v_lshlrev_b32 v216, 16, v248
v_mfma_f32_16x16x32_bf16 v[204:207], a[36:39], a[252:255], v[204:207]
v_and_b32 v233, 0xffff0000, v250
v_lshlrev_b32 v228, 16, v246
v_mfma_f32_16x16x32_bf16 v[164:167], a[32:35], a[240:243], v[164:167]
v_and_b32 v235, 0xffff0000, v251
v_and_b32 v219, 0xffff0000, v249
v_mfma_f32_16x16x32_bf16 v[164:167], a[36:39], a[248:251], v[164:167]
s_waitcnt vmcnt(48) lgkmcnt(0)
s_barrier
ds_read_b128 a[0:3], v33 offset:5120
v_mfma_f32_16x16x32_bf16 v[168:171], a[40:43], a[244:247], v[168:171]
v_permlane16_swap_b32 v252, v254
v_mfma_f32_16x16x32_bf16 v[168:171], a[44:47], a[252:255], v[168:171]
s_xor_b32 s3, s2, 1
ds_read_b128 a[4:7], v33 offset:15360
ds_read_b128 a[8:11], v33 offset:6144
v_mfma_f32_16x16x32_bf16 v[128:131], a[40:43], a[240:243], v[128:131]
v_permlane16_swap_b32 v253, v255
v_mfma_f32_16x16x32_bf16 v[128:131], a[44:47], a[248:251], v[128:131]
ds_read_b128 a[12:15], v33 offset:16384
v_lshlrev_b32 v220, 16, v252
v_mfma_f32_16x16x32_bf16 v[172:175], a[48:51], a[244:247], v[172:175]
ds_read_b128 a[16:19], v33 offset:7168
ds_read_b128 a[20:23], v33 offset:17408
v_mfma_f32_16x16x32_bf16 v[172:175], a[52:55], a[252:255], v[172:175]
buffer_load_dwordx4 v4, s[40:43], s29 offen offset:1024 sc1 lds
v_mfma_f32_16x16x32_bf16 v[132:135], a[48:51], a[240:243], v[132:135]
ds_read_b128 a[24:27], v33 offset:8192
ds_read_b128 a[28:31], v33 offset:18432
v_mfma_f32_16x16x32_bf16 v[132:135], a[52:55], a[248:251], v[132:135]
s_xor_b32 s34, s16, 16384
ds_read_b128 a[32:35], v33 offset:9216
ds_read_b128 a[36:39], v33 offset:19456
v_mfma_f32_16x16x32_bf16 v[176:179], a[56:59], a[244:247], v[176:179]
buffer_load_dwordx4 v4, s[40:43], s29 offen offset:2048 sc1 lds
v_mfma_f32_16x16x32_bf16 v[176:179], a[60:63], a[252:255], v[176:179]
buffer_load_dwordx4 v4, s[40:43], s29 offen offset:3072 sc1 lds
v_mfma_f32_16x16x32_bf16 v[136:139], a[56:59], a[240:243], v[136:139]
s_lshl2_add_u32 s3, s3, s20
v_and_b32 v239, 0xffff0000, v255
v_mfma_f32_16x16x32_bf16 v[136:139], a[60:63], a[248:251], v[136:139]
s_add_u32 s29, s29, 1024
s_add_u32 m0, s32, 41984
s_mul_i32 s3, s3, 13312
v_mfma_f32_16x16x32_bf16 v[180:183], a[64:67], a[244:247], v[180:183]
buffer_load_dwordx4 v4, s[40:43], s29 offen offset:3072 sc1 lds
v_mfma_f32_16x16x32_bf16 v[180:183], a[68:71], a[252:255], v[180:183]
v_mfma_f32_16x16x32_bf16 v[140:143], a[64:67], a[240:243], v[140:143]
buffer_load_dwordx4 a[160:163], v4, s[40:43], s34 offen sc1
v_mfma_f32_16x16x32_bf16 v[140:143], a[68:71], a[248:251], v[140:143]
v_lshlrev_b32 v218, 16, v249
v_mfma_f32_16x16x32_bf16 v[184:187], a[72:75], a[244:247], v[184:187]
v_mfma_f32_16x16x32_bf16 v[184:187], a[76:79], a[252:255], v[184:187]
v_and_b32 v237, 0xffff0000, v254
s_add_u32 s3, s3, 83894272
v_mfma_f32_16x16x32_bf16 v[144:147], a[72:75], a[240:243], v[144:147]
v_lshlrev_b32 v236, 16, v254
v_mfma_f32_16x16x32_bf16 v[144:147], a[76:79], a[248:251], v[144:147]
s_waitcnt vmcnt(46) lgkmcnt(0)
ds_read_b128 a[40:43], v33 offset:0
ds_read_b128 a[44:47], v33 offset:10240
v_mfma_f32_16x16x32_bf16 v[188:191], a[0:3], a[84:87], v[188:191]
ds_read_b128 a[48:51], v33 offset:1024
ds_read_b128 a[52:55], v33 offset:11264
v_mfma_f32_16x16x32_bf16 v[188:191], a[4:7], a[92:95], v[188:191]
buffer_load_dwordx4 v[36:39], v4, s[40:43], s3 offen offset:0 sc1
v_mfma_f32_16x16x32_bf16 v[148:151], a[0:3], a[80:83], v[148:151]
v_and_b32 v221, 0xffff0000, v252
s_xor_b32 s29, s18, 1179648
v_mfma_f32_16x16x32_bf16 v[148:151], a[4:7], a[88:91], v[148:151]
ds_read_b128 a[56:59], v33 offset:2048
ds_read_b128 a[60:63], v33 offset:12288
v_mfma_f32_16x16x32_bf16 v[192:195], a[8:11], a[84:87], v[192:195]
ds_read_b128 a[64:67], v33 offset:3072
ds_read_b128 a[68:71], v33 offset:13312
v_mfma_f32_16x16x32_bf16 v[192:195], a[12:15], a[92:95], v[192:195]
v_mfma_f32_16x16x32_bf16 v[152:155], a[8:11], a[80:83], v[152:155]
ds_read_b128 a[72:75], v33 offset:4096
ds_read_b128 a[76:79], v33 offset:14336
v_mfma_f32_16x16x32_bf16 v[152:155], a[12:15], a[88:91], v[152:155]
buffer_load_dwordx4 v[40:43], v4, s[40:43], s3 offen offset:1024 sc1
v_mfma_f32_16x16x32_bf16 v[196:199], a[16:19], a[84:87], v[196:199]
v_mfma_f32_16x16x32_bf16 v[196:199], a[20:23], a[92:95], v[196:199]
v_mfma_f32_16x16x32_bf16 v[156:159], a[16:19], a[80:83], v[156:159]
buffer_load_dwordx4 v[112:115], v4, s[40:43], s3 offen offset:2048 sc1
v_mfma_f32_16x16x32_bf16 v[156:159], a[20:23], a[88:91], v[156:159]
v_mfma_f32_16x16x32_bf16 v[200:203], a[24:27], a[84:87], v[200:203]
v_mfma_f32_16x16x32_bf16 v[200:203], a[28:31], a[92:95], v[200:203]
s_add_u32 s3, s3, s52
v_mfma_f32_16x16x32_bf16 v[160:163], a[24:27], a[80:83], v[160:163]
s_add_u32 m0, s32, 0
v_lshlrev_b32 v238, 16, v255
v_mfma_f32_16x16x32_bf16 v[160:163], a[28:31], a[88:91], v[160:163]
buffer_load_dwordx4 v[116:119], v4, s[40:43], s3 offen offset:3072 sc1
v_mfma_f32_16x16x32_bf16 v[204:207], a[32:35], a[84:87], v[204:207]
v_mfma_f32_16x16x32_bf16 v[204:207], a[36:39], a[92:95], v[204:207]
v_lshlrev_b32 v222, 16, v253
v_mfma_f32_16x16x32_bf16 v[164:167], a[32:35], a[80:83], v[164:167]
v_mfma_f32_16x16x32_bf16 v[164:167], a[36:39], a[88:91], v[164:167]
s_waitcnt vmcnt(45) lgkmcnt(0)
s_barrier
v_mfma_f32_16x16x32_bf16 v[168:171], a[40:43], a[84:87], v[168:171]
buffer_load_dwordx4 a[168:171], v4, s[40:43], s34 offen offset:1024 sc1
v_mfma_f32_16x16x32_bf16 v[168:171], a[44:47], a[92:95], v[168:171]
ds_read_b128 a[0:3], v33 offset:25600
ds_read_b128 a[4:7], v33 offset:35840
v_mfma_f32_16x16x32_bf16 v[128:131], a[40:43], a[80:83], v[128:131]
ds_read_b128 a[8:11], v33 offset:26624
ds_read_b128 a[12:15], v33 offset:36864
v_mfma_f32_16x16x32_bf16 v[128:131], a[44:47], a[88:91], v[128:131]
s_xor_b32 s34, s17, 16384
ds_read_b128 a[16:19], v33 offset:27648
ds_read_b128 a[20:23], v33 offset:37888
v_mfma_f32_16x16x32_bf16 v[172:175], a[48:51], a[84:87], v[172:175]
ds_read_b128 a[24:27], v33 offset:28672
ds_read_b128 a[28:31], v33 offset:38912
v_mfma_f32_16x16x32_bf16 v[172:175], a[52:55], a[92:95], v[172:175]
buffer_load_dwordx4 a[164:167], v4, s[40:43], s34 offen sc1
v_mfma_f32_16x16x32_bf16 v[132:135], a[48:51], a[80:83], v[132:135]
v_and_b32 v223, 0xffff0000, v253
v_mfma_f32_16x16x32_bf16 v[132:135], a[52:55], a[88:91], v[132:135]
ds_read_b128 a[32:35], v33 offset:29696
ds_read_b128 a[36:39], v33 offset:39936
v_mfma_f32_16x16x32_bf16 v[176:179], a[56:59], a[84:87], v[176:179]
v_mfma_f32_16x16x32_bf16 v[176:179], a[60:63], a[92:95], v[176:179]
buffer_load_dwordx4 a[172:175], v4, s[40:43], s34 offen offset:1024 sc1
v_mfma_f32_16x16x32_bf16 v[136:139], a[56:59], a[80:83], v[136:139]
v_mfma_f32_16x16x32_bf16 v[136:139], a[60:63], a[88:91], v[136:139]
v_mfma_f32_16x16x32_bf16 v[180:183], a[64:67], a[84:87], v[180:183]
buffer_load_dwordx4 v4, s[40:43], s29 offen offset:0 sc1 lds
v_mfma_f32_16x16x32_bf16 v[180:183], a[68:71], a[92:95], v[180:183]
v_mfma_f32_16x16x32_bf16 v[140:143], a[64:67], a[80:83], v[140:143]
v_mfma_f32_16x16x32_bf16 v[140:143], a[68:71], a[88:91], v[140:143]
buffer_load_dwordx4 v4, s[40:43], s29 offen offset:1024 sc1 lds
v_mfma_f32_16x16x32_bf16 v[184:187], a[72:75], a[84:87], v[184:187]
v_mfma_f32_16x16x32_bf16 v[184:187], a[76:79], a[92:95], v[184:187]
v_mfma_f32_16x16x32_bf16 v[144:147], a[72:75], a[80:83], v[144:147]
v_mfma_f32_16x16x32_bf16 v[144:147], a[76:79], a[88:91], v[144:147]
s_waitcnt vmcnt(46) lgkmcnt(0)
ds_read_b128 a[40:43], v33 offset:20480
ds_read_b128 a[44:47], v33 offset:30720
v_mfma_f32_16x16x32_bf16 v[188:191], a[0:3], a[100:103], v[188:191]
ds_read_b128 a[48:51], v33 offset:21504
ds_read_b128 a[52:55], v33 offset:31744
v_mfma_f32_16x16x32_bf16 v[188:191], a[4:7], a[108:111], v[188:191]
ds_read_b128 a[56:59], v33 offset:22528
ds_read_b128 a[60:63], v33 offset:32768
v_mfma_f32_16x16x32_bf16 v[148:151], a[0:3], a[96:99], v[148:151]
buffer_load_dwordx4 v4, s[40:43], s29 offen offset:2048 sc1 lds
v_mfma_f32_16x16x32_bf16 v[148:151], a[4:7], a[104:107], v[148:151]
ds_read_b128 a[64:67], v33 offset:23552
ds_read_b128 a[68:71], v33 offset:33792
v_mfma_f32_16x16x32_bf16 v[192:195], a[8:11], a[100:103], v[192:195]
ds_read_b128 a[72:75], v33 offset:24576
ds_read_b128 a[76:79], v33 offset:34816
v_mfma_f32_16x16x32_bf16 v[192:195], a[12:15], a[108:111], v[192:195]
buffer_load_dwordx4 v4, s[40:43], s29 offen offset:3072 sc1 lds
v_mfma_f32_16x16x32_bf16 v[152:155], a[8:11], a[96:99], v[152:155]
v_mfma_f32_16x16x32_bf16 v[152:155], a[12:15], a[104:107], v[152:155]
s_xor_b32 s34, s16, 18432
s_add_u32 m0, s32, 1024
v_mfma_f32_16x16x32_bf16 v[196:199], a[16:19], a[100:103], v[196:199]
s_add_u32 s29, s29, 1024
v_mfma_f32_16x16x32_bf16 v[196:199], a[20:23], a[108:111], v[196:199]
buffer_load_dwordx4 v4, s[40:43], s29 offen offset:3072 sc1 lds
v_mfma_f32_16x16x32_bf16 v[156:159], a[16:19], a[96:99], v[156:159]
v_mfma_f32_16x16x32_bf16 v[156:159], a[20:23], a[104:107], v[156:159]
v_mfma_f32_16x16x32_bf16 v[200:203], a[24:27], a[100:103], v[200:203]
buffer_load_dwordx4 a[176:179], v4, s[40:43], s34 offen sc1
v_mfma_f32_16x16x32_bf16 v[200:203], a[28:31], a[108:111], v[200:203]
v_mfma_f32_16x16x32_bf16 v[160:163], a[24:27], a[96:99], v[160:163]
v_mfma_f32_16x16x32_bf16 v[160:163], a[28:31], a[104:107], v[160:163]
buffer_load_dwordx4 a[184:187], v4, s[40:43], s34 offen offset:1024 sc1
v_mfma_f32_16x16x32_bf16 v[204:207], a[32:35], a[100:103], v[204:207]
v_mfma_f32_16x16x32_bf16 v[204:207], a[36:39], a[108:111], v[204:207]
v_mfma_f32_16x16x32_bf16 v[164:167], a[32:35], a[96:99], v[164:167]
v_mfma_f32_16x16x32_bf16 v[164:167], a[36:39], a[104:107], v[164:167]
s_waitcnt vmcnt(10) lgkmcnt(0)
s_barrier
v_mfma_f32_16x16x32_bf16 v[56:59], v[10:13], v[36:39], v[48:51]
ds_read_b128 a[0:3], v34 offset:5120
ds_read_b128 a[4:7], v34 offset:15360
v_mfma_f32_16x16x32_bf16 v[60:63], v[8:11], v[36:39], v[52:55]
s_xor_b32 s34, s17, 18432
ds_read_b128 a[8:11], v34 offset:6144
ds_read_b128 a[12:15], v34 offset:16384
v_mfma_f32_16x16x32_bf16 v[72:75], v[10:13], v[40:43], v[64:67]
ds_read_b128 a[16:19], v34 offset:7168
ds_read_b128 a[20:23], v34 offset:17408
v_mfma_f32_16x16x32_bf16 v[76:79], v[8:11], v[40:43], v[68:71]
buffer_load_dwordx4 a[180:183], v4, s[40:43], s34 offen sc1
v_mfma_f32_16x16x32_bf16 v[88:91], v[10:13], v[112:115], v[80:83]
ds_read_b128 a[24:27], v34 offset:8192
ds_read_b128 a[28:31], v34 offset:18432
v_mfma_f32_16x16x32_bf16 v[92:95], v[8:11], v[112:115], v[84:87]
ds_read_b128 a[32:35], v34 offset:9216
ds_read_b128 a[36:39], v34 offset:19456
v_mfma_f32_16x16x32_bf16 v[104:107], v[10:13], v[116:119], v[96:99]
v_mfma_f32_16x16x32_bf16 v[108:111], v[8:11], v[116:119], v[100:103]
s_xor_b32 s29, s12, 1310720
v_mfma_f32_16x16x32_bf16 v[168:171], a[40:43], a[100:103], v[168:171]
buffer_load_dwordx4 a[188:191], v4, s[40:43], s34 offen offset:1024 sc1
v_mfma_f32_16x16x32_bf16 v[168:171], a[44:47], a[108:111], v[168:171]
s_add_u32 m0, s26, 0
v_mfma_f32_16x16x32_bf16 v[128:131], a[40:43], a[96:99], v[128:131]
s_add_u32 s29, s29, s13
v_mfma_f32_16x16x32_bf16 v[128:131], a[44:47], a[104:107], v[128:131]
v_mfma_f32_16x16x32_bf16 v[172:175], a[48:51], a[100:103], v[172:175]
v_mfma_f32_16x16x32_bf16 v[172:175], a[52:55], a[108:111], v[172:175]
buffer_load_dwordx4 v4, s[40:43], s29 offen offset:0 sc1 lds
v_mfma_f32_16x16x32_bf16 v[132:135], a[48:51], a[96:99], v[132:135]
v_mfma_f32_16x16x32_bf16 v[132:135], a[52:55], a[104:107], v[132:135]
v_mfma_f32_16x16x32_bf16 v[176:179], a[56:59], a[100:103], v[176:179]
v_cmp_u_f32 vcc, v60, v76
v_mfma_f32_16x16x32_bf16 v[176:179], a[60:63], a[108:111], v[176:179]
v_mfma_f32_16x16x32_bf16 v[136:139], a[56:59], a[96:99], v[136:139]
buffer_load_dwordx4 v4, s[40:43], s29 offen offset:1024 sc1 lds
v_mfma_f32_16x16x32_bf16 v[136:139], a[60:63], a[104:107], v[136:139]
v_cmp_u_f32 s[58:59], v92, v108
v_mfma_f32_16x16x32_bf16 v[180:183], a[64:67], a[100:103], v[180:183]
v_mfma_f32_16x16x32_bf16 v[180:183], a[68:71], a[108:111], v[180:183]
v_mfma_f32_16x16x32_bf16 v[140:143], a[64:67], a[96:99], v[140:143]
v_mfma_f32_16x16x32_bf16 v[140:143], a[68:71], a[104:107], v[140:143]
buffer_load_dwordx4 v4, s[40:43], s29 offen offset:2048 sc1 lds
v_mfma_f32_16x16x32_bf16 v[184:187], a[72:75], a[100:103], v[184:187]
s_or_b64 vcc, vcc, s[58:59]
v_mfma_f32_16x16x32_bf16 v[184:187], a[76:79], a[108:111], v[184:187]
v_mfma_f32_16x16x32_bf16 v[144:147], a[72:75], a[96:99], v[144:147]
v_mfma_f32_16x16x32_bf16 v[144:147], a[76:79], a[104:107], v[144:147]
s_cbranch_vccnz kf_kernel_ylate
kf_kernel_yret:
s_add_u32 s3, s38, 75497472
s_waitcnt vmcnt(47) lgkmcnt(0)
v_mfma_f32_16x16x32_bf16 v[188:191], a[0:3], a[116:119], v[188:191]
ds_read_b128 a[40:43], v34 offset:0
ds_read_b128 a[44:47], v34 offset:10240
v_mfma_f32_16x16x32_bf16 v[188:191], a[4:7], a[124:127], v[188:191]
buffer_load_dwordx4 v4, s[40:43], s29 offen offset:3072 sc1 lds
v_mfma_f32_16x16x32_bf16 v[148:151], a[0:3], a[112:115], v[148:151]
ds_read_b128 a[48:51], v34 offset:1024
ds_read_b128 a[52:55], v34 offset:11264
v_mfma_f32_16x16x32_bf16 v[148:151], a[4:7], a[120:123], v[148:151]
s_add_u32 m0, s26, 1024
v_mul_f32 v61, v61, v225
v_mul_f32 v59, v59, v211
v_mfma_f32_16x16x32_bf16 v[192:195], a[8:11], a[116:119], v[192:195]
ds_read_b128 a[56:59], v34 offset:2048
ds_read_b128 a[60:63], v34 offset:12288
v_mfma_f32_16x16x32_bf16 v[192:195], a[12:15], a[124:127], v[192:195]
ds_read_b128 a[64:67], v34 offset:3072
ds_read_b128 a[68:71], v34 offset:13312
v_mfma_f32_16x16x32_bf16 v[152:155], a[8:11], a[112:115], v[152:155]
ds_read_b128 a[72:75], v34 offset:4096
ds_read_b128 a[76:79], v34 offset:14336
v_mfma_f32_16x16x32_bf16 v[152:155], a[12:15], a[120:123], v[152:155]
v_mul_f32 v56, v56, v208
s_add_u32 s29, s29, 1024
v_mfma_f32_16x16x32_bf16 v[196:199], a[16:19], a[116:119], v[196:199]
v_mul_f32 v57, v57, v209
v_cvt_pk_bf16_f32 v56, v56, v57
v_mfma_f32_16x16x32_bf16 v[196:199], a[20:23], a[124:127], v[196:199]
buffer_load_dwordx4 v4, s[40:43], s29 offen offset:3072 sc1 lds
v_mfma_f32_16x16x32_bf16 v[156:159], a[16:19], a[112:115], v[156:159]
v_mul_f32 v62, v62, v226
v_mul_f32 v58, v58, v210
v_mfma_f32_16x16x32_bf16 v[156:159], a[20:23], a[120:123], v[156:159]
s_xor_b32 s34, s16, 20480
v_mul_f32 v60, v60, v224
v_mul_f32 v63, v63, v227
v_mfma_f32_16x16x32_bf16 v[200:203], a[24:27], a[116:119], v[200:203]
v_mul_f32 v73, v73, v213
v_cvt_pk_bf16_f32 v57, v58, v59
v_mfma_f32_16x16x32_bf16 v[200:203], a[28:31], a[124:127], v[200:203]
v_cvt_pk_bf16_f32 v58, v60, v61
v_cvt_pk_bf16_f32 v59, v62, v63
v_mfma_f32_16x16x32_bf16 v[160:163], a[24:27], a[112:115], v[160:163]
v_mul_f32 v74, v74, v214
v_mul_f32 v75, v75, v215
v_mfma_f32_16x16x32_bf16 v[160:163], a[28:31], a[120:123], v[160:163]
buffer_store_dwordx4 v[56:59], v4, s[40:43], s3 offen sc1
v_mfma_f32_16x16x32_bf16 v[204:207], a[32:35], a[116:119], v[204:207]
buffer_load_dwordx4 a[192:195], v4, s[40:43], s34 offen sc1
v_mfma_f32_16x16x32_bf16 v[204:207], a[36:39], a[124:127], v[204:207]
v_mul_f32 v72, v72, v212
s_add_u32 s3, s38, 75552768
v_mfma_f32_16x16x32_bf16 v[164:167], a[32:35], a[112:115], v[164:167]
s_waitcnt vmcnt(43) lgkmcnt(0)
v_mul_f32 v92, v92, v232
v_mul_f32 v78, v78, v230
v_mfma_f32_16x16x32_bf16 v[164:167], a[36:39], a[120:123], v[164:167]
s_barrier
ds_read_b128 a[0:3], v33 offset:46080
ds_read_b128 a[4:7], v33 offset:56320
v_mul_f32 v93, v93, v233
v_mfma_f32_16x16x32_bf16 v[168:171], a[40:43], a[116:119], v[168:171]
s_xor_b32 s29, s12, 1572864
v_cvt_pk_bf16_f32 v72, v72, v73
v_mul_f32 v76, v76, v228
v_mfma_f32_16x16x32_bf16 v[168:171], a[44:47], a[124:127], v[168:171]
ds_read_b128 a[8:11], v33 offset:47104
ds_read_b128 a[12:15], v33 offset:57344
ds_read_b128 a[16:19], v33 offset:48128
v_mfma_f32_16x16x32_bf16 v[128:131], a[40:43], a[112:115], v[128:131]
buffer_load_dwordx4 a[200:203], v4, s[40:43], s34 offen offset:1024 sc1
v_mfma_f32_16x16x32_bf16 v[128:131], a[44:47], a[120:123], v[128:131]
v_mul_f32 v79, v79, v231
v_mul_f32 v77, v77, v229
v_mfma_f32_16x16x32_bf16 v[172:175], a[48:51], a[116:119], v[172:175]
s_xor_b32 s34, s17, 20480
ds_read_b128 a[20:23], v33 offset:58368
ds_read_b128 a[24:27], v33 offset:49152
v_mfma_f32_16x16x32_bf16 v[172:175], a[52:55], a[124:127], v[172:175]
ds_read_b128 a[28:31], v33 offset:59392
v_cvt_pk_bf16_f32 v73, v74, v75
v_mfma_f32_16x16x32_bf16 v[132:135], a[48:51], a[112:115], v[132:135]
buffer_load_dwordx4 a[196:199], v4, s[40:43], s34 offen sc1
v_mfma_f32_16x16x32_bf16 v[132:135], a[52:55], a[120:123], v[132:135]
ds_read_b128 a[32:35], v33 offset:50176
ds_read_b128 a[36:39], v33 offset:60416
v_mfma_f32_16x16x32_bf16 v[176:179], a[56:59], a[116:119], v[176:179]
v_cvt_pk_bf16_f32 v75, v78, v79
v_cvt_pk_bf16_f32 v74, v76, v77
v_mfma_f32_16x16x32_bf16 v[176:179], a[60:63], a[124:127], v[176:179]
buffer_store_dwordx4 v[72:75], v4, s[40:43], s3 offen sc1
v_mfma_f32_16x16x32_bf16 v[136:139], a[56:59], a[112:115], v[136:139]
buffer_load_dwordx4 a[204:207], v4, s[40:43], s34 offen offset:1024 sc1
v_mfma_f32_16x16x32_bf16 v[136:139], a[60:63], a[120:123], v[136:139]
v_mfma_f32_16x16x32_bf16 v[180:183], a[64:67], a[116:119], v[180:183]
s_add_u32 s29, s29, s13
s_add_u32 s3, s38, 75608064
s_add_u32 m0, s26, 20480
v_mfma_f32_16x16x32_bf16 v[180:183], a[68:71], a[124:127], v[180:183]
v_mul_f32 v88, v88, v216
v_mul_f32 v95, v95, v235
v_mfma_f32_16x16x32_bf16 v[140:143], a[64:67], a[112:115], v[140:143]
buffer_load_dwordx4 v4, s[40:43], s29 offen offset:0 sc1 lds
v_mfma_f32_16x16x32_bf16 v[140:143], a[68:71], a[120:123], v[140:143]
v_mfma_f32_16x16x32_bf16 v[184:187], a[72:75], a[116:119], v[184:187]
v_mul_f32 v90, v90, v218
v_mul_f32 v91, v91, v219
v_mfma_f32_16x16x32_bf16 v[184:187], a[76:79], a[124:127], v[184:187]
v_mul_f32 v94, v94, v234
v_mul_f32 v89, v89, v217
v_mfma_f32_16x16x32_bf16 v[144:147], a[72:75], a[112:115], v[144:147]
s_waitcnt vmcnt(43) lgkmcnt(0)
ds_read_b128 a[40:43], v33 offset:40960
ds_read_b128 a[44:47], v33 offset:51200
v_mfma_f32_16x16x32_bf16 v[144:147], a[76:79], a[120:123], v[144:147]
v_cvt_pk_bf16_f32 v88, v88, v89
v_cvt_pk_bf16_f32 v89, v90, v91
v_mfma_f32_16x16x32_bf16 v[188:191], a[0:3], a[132:135], v[188:191]
buffer_load_dwordx4 v4, s[40:43], s29 offen offset:1024 sc1 lds
v_mfma_f32_16x16x32_bf16 v[188:191], a[4:7], a[140:143], v[188:191]
v_mul_f32 v105, v105, v221
v_cvt_pk_bf16_f32 v91, v94, v95
v_mfma_f32_16x16x32_bf16 v[148:151], a[0:3], a[128:131], v[148:151]
v_mul_f32 v110, v110, v238
v_cvt_pk_bf16_f32 v90, v92, v93
v_mfma_f32_16x16x32_bf16 v[148:151], a[4:7], a[136:139], v[148:151]
ds_read_b128 a[48:51], v33 offset:41984
ds_read_b128 a[52:55], v33 offset:52224
v_mfma_f32_16x16x32_bf16 v[192:195], a[8:11], a[132:135], v[192:195]
buffer_store_dwordx4 v[88:91], v4, s[40:43], s3 offen sc1
v_mfma_f32_16x16x32_bf16 v[192:195], a[12:15], a[140:143], v[192:195]
ds_read_b128 a[56:59], v33 offset:43008
ds_read_b128 a[60:63], v33 offset:53248
v_mfma_f32_16x16x32_bf16 v[152:155], a[8:11], a[128:131], v[152:155]
ds_read_b128 a[64:67], v33 offset:44032
ds_read_b128 a[68:71], v33 offset:54272
v_mfma_f32_16x16x32_bf16 v[152:155], a[12:15], a[136:139], v[152:155]
v_mul_f32 v109, v109, v237
v_mul_f32 v106, v106, v222
v_mfma_f32_16x16x32_bf16 v[196:199], a[16:19], a[132:135], v[196:199]
buffer_load_dwordx4 v4, s[40:43], s29 offen offset:2048 sc1 lds
v_mfma_f32_16x16x32_bf16 v[196:199], a[20:23], a[140:143], v[196:199]
s_add_u32 s3, s38, 75663360
v_mul_f32 v104, v104, v220
v_mfma_f32_16x16x32_bf16 v[156:159], a[16:19], a[128:131], v[156:159]
ds_read_b128 a[72:75], v33 offset:45056
ds_read_b128 a[76:79], v33 offset:55296
v_mfma_f32_16x16x32_bf16 v[156:159], a[20:23], a[136:139], v[156:159]
buffer_load_dwordx4 v4, s[40:43], s29 offen offset:3072 sc1 lds
v_mfma_f32_16x16x32_bf16 v[200:203], a[24:27], a[132:135], v[200:203]
s_add_u32 s3, s3, s52
v_mul_f32 v107, v107, v223
v_mul_f32 v108, v108, v236
v_mfma_f32_16x16x32_bf16 v[200:203], a[28:31], a[140:143], v[200:203]
v_mfma_f32_16x16x32_bf16 v[160:163], a[24:27], a[128:131], v[160:163]
s_add_u32 s29, s29, 1024
v_cvt_pk_bf16_f32 v104, v104, v105
v_mul_f32 v111, v111, v239
v_mfma_f32_16x16x32_bf16 v[160:163], a[28:31], a[136:139], v[160:163]
v_cvt_pk_bf16_f32 v105, v106, v107
v_cvt_pk_bf16_f32 v107, v110, v111
v_mfma_f32_16x16x32_bf16 v[204:207], a[32:35], a[132:135], v[204:207]
v_cvt_pk_bf16_f32 v106, v108, v109
v_mfma_f32_16x16x32_bf16 v[204:207], a[36:39], a[140:143], v[204:207]
buffer_store_dwordx4 v[104:107], v4, s[40:43], s3 offen sc1
v_mfma_f32_16x16x32_bf16 v[164:167], a[32:35], a[128:131], v[164:167]
s_add_u32 m0, s26, 21504
v_mfma_f32_16x16x32_bf16 v[164:167], a[36:39], a[136:139], v[164:167]
s_waitcnt vmcnt(43) lgkmcnt(0)
s_barrier
v_mfma_f32_16x16x32_bf16 v[168:171], a[40:43], a[132:135], v[168:171]
s_xor_b32 s34, s16, 22528
ds_read_b128 a[0:3], v32 offset:25600
ds_read_b128 a[4:7], v32 offset:35840
v_mfma_f32_16x16x32_bf16 v[168:171], a[44:47], a[140:143], v[168:171]
ds_read_b128 a[8:11], v32 offset:26624
ds_read_b128 a[12:15], v32 offset:36864
v_mfma_f32_16x16x32_bf16 v[128:131], a[40:43], a[128:131], v[128:131]
buffer_load_dwordx4 v4, s[40:43], s29 offen offset:3072 sc1 lds
v_mfma_f32_16x16x32_bf16 v[128:131], a[44:47], a[136:139], v[128:131]
ds_read_b128 a[16:19], v32 offset:27648
ds_read_b128 a[20:23], v32 offset:37888
v_mfma_f32_16x16x32_bf16 v[172:175], a[48:51], a[132:135], v[172:175]
ds_read_b128 a[24:27], v32 offset:28672
ds_read_b128 a[28:31], v32 offset:38912
v_mfma_f32_16x16x32_bf16 v[172:175], a[52:55], a[140:143], v[172:175]
ds_read_b128 a[32:35], v32 offset:29696
ds_read_b128 a[36:39], v32 offset:39936
v_mfma_f32_16x16x32_bf16 v[132:135], a[48:51], a[128:131], v[132:135]
v_mfma_f32_16x16x32_bf16 v[132:135], a[52:55], a[136:139], v[132:135]
buffer_load_dwordx4 a[208:211], v4, s[40:43], s34 offen sc1
v_mfma_f32_16x16x32_bf16 v[176:179], a[56:59], a[132:135], v[176:179]
v_mfma_f32_16x16x32_bf16 v[176:179], a[60:63], a[140:143], v[176:179]
v_mfma_f32_16x16x32_bf16 v[136:139], a[56:59], a[128:131], v[136:139]
buffer_load_dwordx4 a[216:219], v4, s[40:43], s34 offen offset:1024 sc1
v_mfma_f32_16x16x32_bf16 v[136:139], a[60:63], a[136:139], v[136:139]
v_mfma_f32_16x16x32_bf16 v[180:183], a[64:67], a[132:135], v[180:183]
v_mfma_f32_16x16x32_bf16 v[180:183], a[68:71], a[140:143], v[180:183]
s_xor_b32 s34, s17, 22528
v_mfma_f32_16x16x32_bf16 v[140:143], a[64:67], a[128:131], v[140:143]
v_mfma_f32_16x16x32_bf16 v[140:143], a[68:71], a[136:139], v[140:143]
buffer_load_dwordx4 a[212:215], v4, s[40:43], s34 offen sc1
v_mfma_f32_16x16x32_bf16 v[184:187], a[72:75], a[132:135], v[184:187]
v_mfma_f32_16x16x32_bf16 v[184:187], a[76:79], a[140:143], v[184:187]
v_mfma_f32_16x16x32_bf16 v[144:147], a[72:75], a[128:131], v[144:147]
v_mfma_f32_16x16x32_bf16 v[144:147], a[76:79], a[136:139], v[144:147]
s_waitcnt vmcnt(43) lgkmcnt(0)
buffer_load_dwordx4 a[220:223], v4, s[40:43], s34 offen offset:1024 sc1
v_mfma_f32_16x16x32_bf16 v[188:191], a[0:3], a[148:151], v[188:191]
ds_read_b128 a[40:43], v32 offset:20480
ds_read_b128 a[44:47], v32 offset:30720
v_mfma_f32_16x16x32_bf16 v[188:191], a[4:7], a[156:159], v[188:191]
s_xor_b32 s34, s16, 24576
ds_read_b128 a[48:51], v32 offset:21504
ds_read_b128 a[52:55], v32 offset:31744
v_mfma_f32_16x16x32_bf16 v[148:151], a[0:3], a[144:147], v[148:151]
ds_read_b128 a[56:59], v32 offset:22528
ds_read_b128 a[60:63], v32 offset:32768
v_mfma_f32_16x16x32_bf16 v[148:151], a[4:7], a[152:155], v[148:151]
ds_read_b128 a[64:67], v32 offset:23552
ds_read_b128 a[68:71], v32 offset:33792
v_mfma_f32_16x16x32_bf16 v[192:195], a[8:11], a[148:151], v[192:195]
buffer_load_dwordx4 a[224:227], v4, s[40:43], s34 offen sc1
v_mfma_f32_16x16x32_bf16 v[192:195], a[12:15], a[156:159], v[192:195]
v_mfma_f32_16x16x32_bf16 v[152:155], a[8:11], a[144:147], v[152:155]
ds_read_b128 a[72:75], v32 offset:24576
ds_read_b128 a[76:79], v32 offset:34816
v_mfma_f32_16x16x32_bf16 v[152:155], a[12:15], a[152:155], v[152:155]
v_mfma_f32_16x16x32_bf16 v[196:199], a[16:19], a[148:151], v[196:199]
v_mfma_f32_16x16x32_bf16 v[196:199], a[20:23], a[156:159], v[196:199]
buffer_load_dwordx4 a[232:235], v4, s[40:43], s34 offen offset:1024 sc1
v_mfma_f32_16x16x32_bf16 v[156:159], a[16:19], a[144:147], v[156:159]
s_xor_b32 s34, s17, 24576
v_mfma_f32_16x16x32_bf16 v[156:159], a[20:23], a[152:155], v[156:159]
v_mfma_f32_16x16x32_bf16 v[200:203], a[24:27], a[148:151], v[200:203]
buffer_load_dwordx4 a[228:231], v4, s[40:43], s34 offen sc1
v_mfma_f32_16x16x32_bf16 v[200:203], a[28:31], a[156:159], v[200:203]
v_mfma_f32_16x16x32_bf16 v[160:163], a[24:27], a[144:147], v[160:163]
v_mfma_f32_16x16x32_bf16 v[160:163], a[28:31], a[152:155], v[160:163]
buffer_load_dwordx4 a[236:239], v4, s[40:43], s34 offen offset:1024 sc1
v_mfma_f32_16x16x32_bf16 v[204:207], a[32:35], a[148:151], v[204:207]
v_mfma_f32_16x16x32_bf16 v[204:207], a[36:39], a[156:159], v[204:207]
v_mfma_f32_16x16x32_bf16 v[164:167], a[32:35], a[144:147], v[164:167]
v_mfma_f32_16x16x32_bf16 v[164:167], a[36:39], a[152:155], v[164:167]
s_waitcnt vmcnt(9) lgkmcnt(0)
s_barrier
v_mfma_f32_16x16x32_bf16 v[168:171], a[40:43], a[148:151], v[168:171]
s_and_b32 s53, s24, 3
s_lshl2_add_u32 s53, s55, s53
ds_read_b128 a[0:3], v32 offset:46080
v_mfma_f32_16x16x32_bf16 v[168:171], a[44:47], a[156:159], v[168:171]
s_xor_b32 s29, s12, 1835008
s_lshl_b32 s53, s53, 8
s_add_u32 s53, s53, 3170304
v_mfma_f32_16x16x32_bf16 v[128:131], a[40:43], a[144:147], v[128:131]
s_add_u32 s29, s29, s13
ds_read_b128 a[4:7], v32 offset:56320
ds_read_b128 a[8:11], v32 offset:47104
v_mfma_f32_16x16x32_bf16 v[128:131], a[44:47], a[152:155], v[128:131]
buffer_atomic_add v45, v29, s[40:43], s53 offen sc1
v_mfma_f32_16x16x32_bf16 v[172:175], a[48:51], a[148:151], v[172:175]
s_add_u32 m0, s27, 0
ds_read_b128 a[12:15], v32 offset:57344
ds_read_b128 a[16:19], v32 offset:48128
v_mfma_f32_16x16x32_bf16 v[172:175], a[52:55], a[156:159], v[172:175]
buffer_load_dwordx4 v4, s[40:43], s29 offen offset:0 sc1 lds
v_mfma_f32_16x16x32_bf16 v[132:135], a[48:51], a[144:147], v[132:135]
ds_read_b128 a[20:23], v32 offset:58368
ds_read_b128 a[24:27], v32 offset:49152
v_mfma_f32_16x16x32_bf16 v[132:135], a[52:55], a[152:155], v[132:135]
ds_read_b128 a[28:31], v32 offset:59392
ds_read_b128 a[32:35], v32 offset:50176
v_mfma_f32_16x16x32_bf16 v[176:179], a[56:59], a[148:151], v[176:179]
ds_read_b128 a[36:39], v32 offset:60416
v_mfma_f32_16x16x32_bf16 v[176:179], a[60:63], a[156:159], v[176:179]
buffer_load_dwordx4 v4, s[40:43], s29 offen offset:1024 sc1 lds
v_mfma_f32_16x16x32_bf16 v[136:139], a[56:59], a[144:147], v[136:139]
v_mfma_f32_16x16x32_bf16 v[136:139], a[60:63], a[152:155], v[136:139]
v_mfma_f32_16x16x32_bf16 v[180:183], a[64:67], a[148:151], v[180:183]
buffer_load_dwordx4 v4, s[40:43], s29 offen offset:2048 sc1 lds
v_mfma_f32_16x16x32_bf16 v[180:183], a[68:71], a[156:159], v[180:183]
v_mfma_f32_16x16x32_bf16 v[140:143], a[64:67], a[144:147], v[140:143]
v_mfma_f32_16x16x32_bf16 v[140:143], a[68:71], a[152:155], v[140:143]
buffer_load_dwordx4 v4, s[40:43], s29 offen offset:3072 sc1 lds
v_mfma_f32_16x16x32_bf16 v[184:187], a[72:75], a[148:151], v[184:187]
s_add_u32 s29, s29, 1024
v_mfma_f32_16x16x32_bf16 v[184:187], a[76:79], a[156:159], v[184:187]
s_add_u32 m0, s27, 1024
v_mfma_f32_16x16x32_bf16 v[144:147], a[72:75], a[144:147], v[144:147]
v_mfma_f32_16x16x32_bf16 v[144:147], a[76:79], a[152:155], v[144:147]
s_waitcnt vmcnt(40) lgkmcnt(0)
ds_read_b128 a[40:43], v32 offset:40960
ds_read_b128 v[100:103], v32 offset:51200
v_mfma_f32_16x16x32_bf16 v[188:191], a[0:3], a[164:167], v[188:191]
ds_read_b128 a[48:51], v32 offset:41984
ds_read_b128 v[104:107], v32 offset:52224
v_mfma_f32_16x16x32_bf16 v[188:191], a[4:7], a[172:175], v[188:191]
buffer_load_dwordx4 v4, s[40:43], s29 offen offset:3072 sc1 lds
v_mfma_f32_16x16x32_bf16 v[148:151], a[0:3], a[160:163], v[148:151]
ds_read_b128 a[56:59], v32 offset:43008
ds_read_b128 v[108:111], v32 offset:53248
v_mfma_f32_16x16x32_bf16 v[148:151], a[4:7], a[168:171], v[148:151]
v_mfma_f32_16x16x32_bf16 v[192:195], a[8:11], a[164:167], v[192:195]
s_xor_b32 s34, s16, 26624
ds_read_b128 a[64:67], v32 offset:44032
ds_read_b128 v[112:115], v32 offset:54272
v_mfma_f32_16x16x32_bf16 v[192:195], a[12:15], a[172:175], v[192:195]
ds_read_b128 a[72:75], v32 offset:45056
v_mfma_f32_16x16x32_bf16 v[152:155], a[8:11], a[160:163], v[152:155]
ds_read_b128 v[116:119], v32 offset:55296
v_mfma_f32_16x16x32_bf16 v[152:155], a[12:15], a[168:171], v[152:155]
buffer_load_dwordx4 a[240:243], v4, s[40:43], s34 offen sc1
v_mfma_f32_16x16x32_bf16 v[196:199], a[16:19], a[164:167], v[196:199]
v_mfma_f32_16x16x32_bf16 v[196:199], a[20:23], a[172:175], v[196:199]
v_mfma_f32_16x16x32_bf16 v[156:159], a[16:19], a[160:163], v[156:159]
buffer_load_dwordx4 a[248:251], v4, s[40:43], s34 offen offset:1024 sc1
v_mfma_f32_16x16x32_bf16 v[156:159], a[20:23], a[168:171], v[156:159]
v_mfma_f32_16x16x32_bf16 v[200:203], a[24:27], a[164:167], v[200:203]
v_mfma_f32_16x16x32_bf16 v[200:203], a[28:31], a[172:175], v[200:203]
s_xor_b32 s34, s17, 26624
v_mfma_f32_16x16x32_bf16 v[160:163], a[24:27], a[160:163], v[160:163]
s_add_u32 m0, s26, 40960
v_mfma_f32_16x16x32_bf16 v[160:163], a[28:31], a[168:171], v[160:163]
buffer_load_dwordx4 a[244:247], v4, s[40:43], s34 offen sc1
v_mfma_f32_16x16x32_bf16 v[204:207], a[32:35], a[164:167], v[204:207]
v_mfma_f32_16x16x32_bf16 v[204:207], a[36:39], a[172:175], v[204:207]
s_add_u32 s29, s19, 113246208
v_mfma_f32_16x16x32_bf16 v[164:167], a[32:35], a[160:163], v[164:167]
s_waitcnt vmcnt(39) lgkmcnt(0)
s_barrier
ds_read_b128 a[0:3], v32 offset:5120
ds_read_b128 a[4:7], v32 offset:15360
v_mfma_f32_16x16x32_bf16 v[164:167], a[36:39], a[168:171], v[164:167]
ds_read_b128 a[8:11], v32 offset:6144
ds_read_b128 a[12:15], v32 offset:16384
v_mfma_f32_16x16x32_bf16 v[168:171], a[40:43], a[164:167], v[168:171]
buffer_load_dwordx4 a[252:255], v4, s[40:43], s34 offen offset:1024 sc1
s_xor_b32 s34, s16, 28672
v_mfma_f32_16x16x32_bf16 v[168:171], v[100:103], a[172:175], v[168:171]
ds_read_b128 a[16:19], v32 offset:7168
ds_read_b128 a[20:23], v32 offset:17408
ds_read_b128 a[24:27], v32 offset:8192
ds_read_b128 a[28:31], v32 offset:18432
v_mfma_f32_16x16x32_bf16 v[128:131], a[40:43], a[160:163], v[128:131]
ds_read_b128 a[32:35], v32 offset:9216
ds_read_b128 a[36:39], v32 offset:19456
v_mfma_f32_16x16x32_bf16 v[172:175], a[48:51], a[164:167], v[172:175]
buffer_load_dwordx4 a[80:83], v4, s[40:43], s34 offen sc1
v_mfma_f32_16x16x32_bf16 v[172:175], v[104:107], a[172:175], v[172:175]
v_mfma_f32_16x16x32_bf16 v[132:135], a[48:51], a[160:163], v[132:135]
v_mfma_f32_16x16x32_bf16 v[176:179], a[56:59], a[164:167], v[176:179]
buffer_load_dwordx4 a[88:91], v4, s[40:43], s34 offen offset:1024 sc1
s_xor_b32 s34, s17, 28672
v_mfma_f32_16x16x32_bf16 v[176:179], v[108:111], a[172:175], v[176:179]
buffer_load_dwordx4 a[84:87], v4, s[40:43], s34 offen sc1
v_mfma_f32_16x16x32_bf16 v[136:139], a[56:59], a[160:163], v[136:139]
v_mfma_f32_16x16x32_bf16 v[180:183], a[64:67], a[164:167], v[180:183]
v_mfma_f32_16x16x32_bf16 v[180:183], v[112:115], a[172:175], v[180:183]
v_mfma_f32_16x16x32_bf16 v[140:143], a[64:67], a[160:163], v[140:143]
buffer_load_dwordx4 a[92:95], v4, s[40:43], s34 offen offset:1024 sc1
v_mfma_f32_16x16x32_bf16 v[184:187], a[72:75], a[164:167], v[184:187]
v_mfma_f32_16x16x32_bf16 v[184:187], v[116:119], a[172:175], v[184:187]
v_mfma_f32_16x16x32_bf16 v[144:147], a[72:75], a[160:163], v[144:147]
s_waitcnt vmcnt(40) lgkmcnt(0)
ds_read_b128 v[228:231], v32 offset:0
ds_read_b128 v[208:211], v32 offset:10240
v_mfma_f32_16x16x32_bf16 v[188:191], a[0:3], a[180:183], v[188:191]
s_add_u32 s29, s29, s13
ds_read_b128 v[232:235], v32 offset:1024
ds_read_b128 v[212:215], v32 offset:11264
ds_read_b128 v[236:239], v32 offset:2048
v_mfma_f32_16x16x32_bf16 v[188:191], a[4:7], a[188:191], v[188:191]
buffer_load_dwordx4 v4, s[40:43], s29 offen offset:0 sc1 lds
v_mfma_f32_16x16x32_bf16 v[148:151], a[0:3], a[176:179], v[148:151]
ds_read_b128 v[216:219], v32 offset:12288
ds_read_b128 v[240:243], v32 offset:3072
v_mfma_f32_16x16x32_bf16 v[148:151], a[4:7], a[184:187], v[148:151]
ds_read_b128 v[220:223], v32 offset:13312
ds_read_b128 v[244:247], v32 offset:4096
ds_read_b128 v[224:227], v32 offset:14336
v_mfma_f32_16x16x32_bf16 v[192:195], a[8:11], a[180:183], v[192:195]
v_mfma_f32_16x16x32_bf16 v[192:195], a[12:15], a[188:191], v[192:195]
buffer_load_dwordx4 v4, s[40:43], s29 offen offset:1024 sc1 lds
v_mfma_f32_16x16x32_bf16 v[152:155], a[8:11], a[176:179], v[152:155]
v_mfma_f32_16x16x32_bf16 v[152:155], a[12:15], a[184:187], v[152:155]
v_mfma_f32_16x16x32_bf16 v[196:199], a[16:19], a[180:183], v[196:199]
v_mfma_f32_16x16x32_bf16 v[196:199], a[20:23], a[188:191], v[196:199]
buffer_load_dwordx4 v4, s[40:43], s29 offen offset:2048 sc1 lds
v_mfma_f32_16x16x32_bf16 v[156:159], a[16:19], a[176:179], v[156:159]
v_mfma_f32_16x16x32_bf16 v[156:159], a[20:23], a[184:187], v[156:159]
v_mfma_f32_16x16x32_bf16 v[200:203], a[24:27], a[180:183], v[200:203]
buffer_load_dwordx4 v4, s[40:43], s29 offen offset:3072 sc1 lds
v_mfma_f32_16x16x32_bf16 v[200:203], a[28:31], a[188:191], v[200:203]
s_add_u32 m0, s26, 41984
s_add_u32 s29, s29, 1024
v_mfma_f32_16x16x32_bf16 v[160:163], a[24:27], a[176:179], v[160:163]
buffer_load_dwordx4 v4, s[40:43], s29 offen offset:3072 sc1 lds
v_mfma_f32_16x16x32_bf16 v[160:163], a[28:31], a[184:187], v[160:163]
s_add_u32 m0, s32, 20480
s_add_u32 s29, s19, 113508352
s_waitcnt vmcnt(40) lgkmcnt(0)
v_mfma_f32_16x16x32_bf16 v[204:207], a[32:35], a[180:183], v[204:207]
s_add_u32 s29, s29, s13
s_barrier
ds_read_b128 a[0:3], v33 offset:0
ds_read_b128 a[4:7], v33 offset:5120
ds_read_b128 a[8:11], v33 offset:1024
ds_read_b128 a[12:15], v33 offset:6144
ds_read_b128 a[16:19], v33 offset:2048
ds_read_b128 a[20:23], v33 offset:7168
v_mfma_f32_16x16x32_bf16 v[204:207], a[36:39], a[188:191], v[204:207]
ds_read_b128 a[24:27], v33 offset:3072
ds_read_b128 a[28:31], v33 offset:8192
v_mfma_f32_16x16x32_bf16 v[164:167], a[32:35], a[176:179], v[164:167]
ds_read_b128 a[32:35], v33 offset:4096
v_mfma_f32_16x16x32_bf16 v[164:167], a[36:39], a[184:187], v[164:167]
s_add_u32 s29, s29, s50
ds_read_b128 a[36:39], v33 offset:9216
v_mfma_f32_16x16x32_bf16 v[168:171], v[228:231], a[180:183], v[168:171]
buffer_load_dwordx4 v4, s[40:43], s29 offen offset:0 sc1 lds
v_mfma_f32_16x16x32_bf16 v[168:171], v[208:211], a[188:191], v[168:171]
v_mfma_f32_16x16x32_bf16 v[172:175], v[232:235], a[180:183], v[172:175]
buffer_load_dwordx4 v4, s[40:43], s29 offen offset:1024 sc1 lds
v_mfma_f32_16x16x32_bf16 v[172:175], v[212:215], a[188:191], v[172:175]
buffer_load_dwordx4 v4, s[40:43], s29 offen offset:2048 sc1 lds
buffer_load_dwordx4 v4, s[40:43], s29 offen offset:3072 sc1 lds
v_mfma_f32_16x16x32_bf16 v[176:179], v[236:239], a[180:183], v[176:179]
s_add_u32 s29, s29, 1024
v_mfma_f32_16x16x32_bf16 v[176:179], v[216:219], a[188:191], v[176:179]
s_add_u32 m0, s32, 21504
v_mfma_f32_16x16x32_bf16 v[180:183], v[240:243], a[180:183], v[180:183]
buffer_load_dwordx4 v4, s[40:43], s29 offen offset:3072 sc1 lds
v_mfma_f32_16x16x32_bf16 v[180:183], v[220:223], a[188:191], v[180:183]
v_mfma_f32_16x16x32_bf16 v[184:187], v[244:247], a[180:183], v[184:187]
v_mfma_f32_16x16x32_bf16 v[184:187], v[224:227], a[188:191], v[184:187]
s_waitcnt vmcnt(39) lgkmcnt(0)
ds_read_b128 a[40:43], v33 offset:10240
ds_read_b128 a[44:47], v33 offset:15360
v_mfma_f32_16x16x32_bf16 v[188:191], a[0:3], a[196:199], v[188:191]
ds_read_b128 a[48:51], v33 offset:11264
ds_read_b128 a[52:55], v33 offset:16384
v_mfma_f32_16x16x32_bf16 v[188:191], a[4:7], a[204:207], v[188:191]
ds_read_b128 a[56:59], v33 offset:12288
s_xor_b32 s34, s16, 30720
v_mfma_f32_16x16x32_bf16 v[148:151], a[0:3], a[192:195], v[148:151]
buffer_load_dwordx4 a[96:99], v4, s[40:43], s34 offen sc1
v_mfma_f32_16x16x32_bf16 v[148:151], a[4:7], a[200:203], v[148:151]
ds_read_b128 a[60:63], v33 offset:17408
ds_read_b128 a[64:67], v33 offset:13312
v_mfma_f32_16x16x32_bf16 v[192:195], a[8:11], a[196:199], v[192:195]
ds_read_b128 a[68:71], v33 offset:18432
ds_read_b128 a[72:75], v33 offset:14336
v_mfma_f32_16x16x32_bf16 v[192:195], a[12:15], a[204:207], v[192:195]
buffer_load_dwordx4 a[104:107], v4, s[40:43], s34 offen offset:1024 sc1
v_mfma_f32_16x16x32_bf16 v[152:155], a[8:11], a[192:195], v[152:155]
v_mfma_f32_16x16x32_bf16 v[152:155], a[12:15], a[200:203], v[152:155]
ds_read_b128 a[76:79], v33 offset:19456
v_mfma_f32_16x16x32_bf16 v[196:199], a[16:19], a[196:199], v[196:199]
s_xor_b32 s34, s17, 30720
v_mfma_f32_16x16x32_bf16 v[196:199], a[20:23], a[204:207], v[196:199]
s_add_u32 m0, s32, 40960
v_mfma_f32_16x16x32_bf16 v[156:159], a[16:19], a[192:195], v[156:159]
buffer_load_dwordx4 a[100:103], v4, s[40:43], s34 offen sc1
v_mfma_f32_16x16x32_bf16 v[156:159], a[20:23], a[200:203], v[156:159]
v_mfma_f32_16x16x32_bf16 v[200:203], a[24:27], a[196:199], v[200:203]
v_mfma_f32_16x16x32_bf16 v[200:203], a[28:31], a[204:207], v[200:203]
v_mfma_f32_16x16x32_bf16 v[160:163], a[24:27], a[192:195], v[160:163]
v_mfma_f32_16x16x32_bf16 v[160:163], a[28:31], a[200:203], v[160:163]
buffer_load_dwordx4 a[108:111], v4, s[40:43], s34 offen offset:1024 sc1
v_mfma_f32_16x16x32_bf16 v[204:207], a[32:35], a[196:199], v[204:207]
v_mfma_f32_16x16x32_bf16 v[204:207], a[36:39], a[204:207], v[204:207]
v_mfma_f32_16x16x32_bf16 v[164:167], a[32:35], a[192:195], v[164:167]
v_mfma_f32_16x16x32_bf16 v[164:167], a[36:39], a[200:203], v[164:167]
s_waitcnt vmcnt(32) lgkmcnt(0)
s_barrier
v_mfma_f32_16x16x32_bf16 v[188:191], a[40:43], a[212:215], v[188:191]
s_lshr_b32 s54, s5, 2
ds_read_b128 a[0:3], v33 offset:20480
ds_read_b128 a[4:7], v33 offset:25600
v_mfma_f32_16x16x32_bf16 v[188:191], a[44:47], a[220:223], v[188:191]
ds_read_b128 a[8:11], v33 offset:21504
ds_read_b128 a[12:15], v33 offset:26624
v_mfma_f32_16x16x32_bf16 v[148:151], a[40:43], a[208:211], v[148:151]
s_lshl_b32 s54, s54, 10
s_add_u32 s54, s54, 3170304
ds_read_b128 a[16:19], v33 offset:22528
v_mfma_f32_16x16x32_bf16 v[148:151], a[44:47], a[216:219], v[148:151]
buffer_load_dword v30, v46, s[40:43], s54 offen sc1
v_mfma_f32_16x16x32_bf16 v[192:195], a[48:51], a[212:215], v[192:195]
s_xor_b32 s29, s12, 1310720
ds_read_b128 a[20:23], v33 offset:27648
ds_read_b128 a[24:27], v33 offset:23552
v_mfma_f32_16x16x32_bf16 v[192:195], a[52:55], a[220:223], v[192:195]
buffer_load_dwordx4 v4, s[40:43], s29 offen offset:0 sc1 lds
v_mfma_f32_16x16x32_bf16 v[152:155], a[48:51], a[208:211], v[152:155]
v_mfma_f32_16x16x32_bf16 v[152:155], a[52:55], a[216:219], v[152:155]
ds_read_b128 a[28:31], v33 offset:28672
ds_read_b128 a[32:35], v33 offset:24576
v_mfma_f32_16x16x32_bf16 v[196:199], a[56:59], a[212:215], v[196:199]
ds_read_b128 a[36:39], v33 offset:29696
v_mfma_f32_16x16x32_bf16 v[196:199], a[60:63], a[220:223], v[196:199]
buffer_load_dwordx4 v4, s[40:43], s29 offen offset:1024 sc1 lds
v_mfma_f32_16x16x32_bf16 v[156:159], a[56:59], a[208:211], v[156:159]
v_mfma_f32_16x16x32_bf16 v[156:159], a[60:63], a[216:219], v[156:159]
v_mfma_f32_16x16x32_bf16 v[200:203], a[64:67], a[212:215], v[200:203]
buffer_load_dwordx4 v4, s[40:43], s29 offen offset:2048 sc1 lds
v_mfma_f32_16x16x32_bf16 v[200:203], a[68:71], a[220:223], v[200:203]
v_mfma_f32_16x16x32_bf16 v[160:163], a[64:67], a[208:211], v[160:163]
v_mfma_f32_16x16x32_bf16 v[160:163], a[68:71], a[216:219], v[160:163]
buffer_load_dwordx4 v4, s[40:43], s29 offen offset:3072 sc1 lds
v_mfma_f32_16x16x32_bf16 v[204:207], a[72:75], a[212:215], v[204:207]
s_add_u32 s29, s29, 1024
v_mfma_f32_16x16x32_bf16 v[204:207], a[76:79], a[220:223], v[204:207]
s_add_u32 m0, s32, 41984
v_mfma_f32_16x16x32_bf16 v[164:167], a[72:75], a[208:211], v[164:167]
v_mfma_f32_16x16x32_bf16 v[164:167], a[76:79], a[216:219], v[164:167]
s_waitcnt vmcnt(33) lgkmcnt(0)
ds_read_b128 a[40:43], v33 offset:30720
ds_read_b128 a[44:47], v33 offset:35840
v_mfma_f32_16x16x32_bf16 v[188:191], a[0:3], a[228:231], v[188:191]
buffer_load_dwordx4 v4, s[40:43], s29 offen offset:3072 sc1 lds
v_mfma_f32_16x16x32_bf16 v[188:191], a[4:7], a[236:239], v[188:191]
ds_read_b128 a[48:51], v33 offset:31744
ds_read_b128 a[52:55], v33 offset:36864
v_mfma_f32_16x16x32_bf16 v[148:151], a[0:3], a[224:227], v[148:151]
s_xor_b32 s29, s12, 1572864
s_add_u32 m0, s32, 0
ds_read_b128 a[56:59], v33 offset:32768
v_mfma_f32_16x16x32_bf16 v[148:151], a[4:7], a[232:235], v[148:151]
ds_read_b128 a[60:63], v33 offset:37888
ds_read_b128 a[64:67], v33 offset:33792
v_mfma_f32_16x16x32_bf16 v[192:195], a[8:11], a[228:231], v[192:195]
ds_read_b128 a[68:71], v33 offset:38912
ds_read_b128 a[72:75], v33 offset:34816
v_mfma_f32_16x16x32_bf16 v[192:195], a[12:15], a[236:239], v[192:195]
buffer_load_dwordx4 v4, s[40:43], s29 offen offset:0 sc1 lds
v_mfma_f32_16x16x32_bf16 v[152:155], a[8:11], a[224:227], v[152:155]
ds_read_b128 a[76:79], v33 offset:39936
v_mfma_f32_16x16x32_bf16 v[152:155], a[12:15], a[232:235], v[152:155]
v_mfma_f32_16x16x32_bf16 v[196:199], a[16:19], a[228:231], v[196:199]
v_mfma_f32_16x16x32_bf16 v[196:199], a[20:23], a[236:239], v[196:199]
buffer_load_dwordx4 v4, s[40:43], s29 offen offset:1024 sc1 lds
v_mfma_f32_16x16x32_bf16 v[156:159], a[16:19], a[224:227], v[156:159]
v_mfma_f32_16x16x32_bf16 v[156:159], a[20:23], a[232:235], v[156:159]
v_mfma_f32_16x16x32_bf16 v[200:203], a[24:27], a[228:231], v[200:203]
buffer_load_dwordx4 v4, s[40:43], s29 offen offset:2048 sc1 lds
v_mfma_f32_16x16x32_bf16 v[200:203], a[28:31], a[236:239], v[200:203]
v_mfma_f32_16x16x32_bf16 v[160:163], a[24:27], a[224:227], v[160:163]
v_mfma_f32_16x16x32_bf16 v[160:163], a[28:31], a[232:235], v[160:163]
buffer_load_dwordx4 v4, s[40:43], s29 offen offset:3072 sc1 lds
v_mfma_f32_16x16x32_bf16 v[204:207], a[32:35], a[228:231], v[204:207]
v_mfma_f32_16x16x32_bf16 v[204:207], a[36:39], a[236:239], v[204:207]
v_mfma_f32_16x16x32_bf16 v[164:167], a[32:35], a[224:227], v[164:167]
s_waitcnt vmcnt(9) lgkmcnt(0)
s_barrier
v_cmp_gt_u32 vcc, 16, v30
s_cmp_lg_u64 vcc, 0
v_mfma_f32_16x16x32_bf16 v[164:167], a[36:39], a[232:235], v[164:167]
s_cbranch_scc1 kf_kernel_spin_u
kf_kernel_ret_u:
v_mfma_f32_16x16x32_bf16 v[188:191], a[40:43], a[244:247], v[188:191]
s_add_u32 m0, s32, 1024
s_add_u32 s29, s29, 1024
ds_read_b128 a[0:3], v34 offset:0
v_mfma_f32_16x16x32_bf16 v[188:191], a[44:47], a[252:255], v[188:191]
buffer_load_dwordx4 v4, s[40:43], s29 offen offset:3072 sc1 lds
v_mfma_f32_16x16x32_bf16 v[148:151], a[40:43], a[240:243], v[148:151]
s_add_u32 s34, s48, 75497472
ds_read_b128 a[4:7], v34 offset:5120
ds_read_b128 a[8:11], v34 offset:1024
v_mfma_f32_16x16x32_bf16 v[148:151], a[44:47], a[248:251], v[148:151]
buffer_load_dwordx4 a[116:119], v4, s[40:43], s34 offen sc1
v_mfma_f32_16x16x32_bf16 v[192:195], a[48:51], a[244:247], v[192:195]
ds_read_b128 a[12:15], v34 offset:6144
ds_read_b128 a[16:19], v34 offset:2048
v_mfma_f32_16x16x32_bf16 v[192:195], a[52:55], a[252:255], v[192:195]
buffer_load_dwordx4 a[124:127], v4, s[40:43], s34 offen offset:1024 sc1
v_mfma_f32_16x16x32_bf16 v[152:155], a[48:51], a[240:243], v[152:155]
ds_read_b128 a[20:23], v34 offset:7168
ds_read_b128 a[24:27], v34 offset:3072
v_mfma_f32_16x16x32_bf16 v[152:155], a[52:55], a[248:251], v[152:155]
s_add_u32 s34, s37, 75497472
ds_read_b128 a[28:31], v34 offset:8192
ds_read_b128 a[32:35], v34 offset:4096
v_mfma_f32_16x16x32_bf16 v[196:199], a[56:59], a[244:247], v[196:199]
buffer_load_dwordx4 a[112:115], v4, s[40:43], s34 offen sc1
v_mfma_f32_16x16x32_bf16 v[196:199], a[60:63], a[252:255], v[196:199]
buffer_load_dwordx4 a[120:123], v4, s[40:43], s34 offen offset:1024 sc1
v_mfma_f32_16x16x32_bf16 v[156:159], a[56:59], a[240:243], v[156:159]
ds_read_b128 a[36:39], v34 offset:9216
v_mfma_f32_16x16x32_bf16 v[156:159], a[60:63], a[248:251], v[156:159]
s_add_u32 s34, s48, 75499520
v_mfma_f32_16x16x32_bf16 v[200:203], a[64:67], a[244:247], v[200:203]
s_add_u32 m0, s26, 0
v_mfma_f32_16x16x32_bf16 v[200:203], a[68:71], a[252:255], v[200:203]
buffer_load_dwordx4 a[132:135], v4, s[40:43], s34 offen sc1
v_mfma_f32_16x16x32_bf16 v[160:163], a[64:67], a[240:243], v[160:163]
v_mfma_f32_16x16x32_bf16 v[160:163], a[68:71], a[248:251], v[160:163]
buffer_load_dwordx4 a[140:143], v4, s[40:43], s34 offen offset:1024 sc1
v_mfma_f32_16x16x32_bf16 v[204:207], a[72:75], a[244:247], v[204:207]
v_mfma_f32_16x16x32_bf16 v[204:207], a[76:79], a[252:255], v[204:207]
v_mfma_f32_16x16x32_bf16 v[164:167], a[72:75], a[240:243], v[164:167]
s_add_u32 s34, s37, 75499520
v_mfma_f32_16x16x32_bf16 v[164:167], a[76:79], a[248:251], v[164:167]
s_waitcnt vmcnt(31) lgkmcnt(0)
ds_read_b128 a[40:43], v34 offset:10240
ds_read_b128 a[44:47], v34 offset:15360
v_mfma_f32_16x16x32_bf16 v[188:191], a[0:3], a[84:87], v[188:191]
ds_read_b128 a[48:51], v34 offset:11264
ds_read_b128 a[52:55], v34 offset:16384
v_mfma_f32_16x16x32_bf16 v[188:191], a[4:7], a[92:95], v[188:191]
buffer_load_dwordx4 a[128:131], v4, s[40:43], s34 offen sc1
v_mfma_f32_16x16x32_bf16 v[148:151], a[0:3], a[80:83], v[148:151]
ds_read_b128 a[56:59], v34 offset:12288
ds_read_b128 a[60:63], v34 offset:17408
v_mfma_f32_16x16x32_bf16 v[148:151], a[4:7], a[88:91], v[148:151]
buffer_load_dwordx4 a[136:139], v4, s[40:43], s34 offen offset:1024 sc1
v_mfma_f32_16x16x32_bf16 v[192:195], a[8:11], a[84:87], v[192:195]
s_add_u32 s34, s48, 75501568
v_mfma_f32_16x16x32_bf16 v[192:195], a[12:15], a[92:95], v[192:195]
ds_read_b128 a[64:67], v34 offset:13312
ds_read_b128 a[68:71], v34 offset:18432
v_mfma_f32_16x16x32_bf16 v[152:155], a[8:11], a[80:83], v[152:155]
buffer_load_dwordx4 a[148:151], v4, s[40:43], s34 offen sc1
v_mfma_f32_16x16x32_bf16 v[152:155], a[12:15], a[88:91], v[152:155]
ds_read_b128 a[72:75], v34 offset:14336
ds_read_b128 a[76:79], v34 offset:19456
v_mfma_f32_16x16x32_bf16 v[196:199], a[16:19], a[84:87], v[196:199]
buffer_load_dwordx4 a[156:159], v4, s[40:43], s34 offen offset:1024 sc1
v_mfma_f32_16x16x32_bf16 v[196:199], a[20:23], a[92:95], v[196:199]
s_add_u32 s34, s37, 75501568
v_mfma_f32_16x16x32_bf16 v[156:159], a[16:19], a[80:83], v[156:159]
buffer_load_dwordx4 a[144:147], v4, s[40:43], s34 offen sc1
v_mfma_f32_16x16x32_bf16 v[156:159], a[20:23], a[88:91], v[156:159]
v_mfma_f32_16x16x32_bf16 v[200:203], a[24:27], a[84:87], v[200:203]
v_mfma_f32_16x16x32_bf16 v[200:203], a[28:31], a[92:95], v[200:203]
buffer_load_dwordx4 a[152:155], v4, s[40:43], s34 offen offset:1024 sc1
v_mfma_f32_16x16x32_bf16 v[160:163], a[24:27], a[80:83], v[160:163]
s_add_u32 s34, s48, 75503616
s_add_u32 s34, s34, s49
v_mfma_f32_16x16x32_bf16 v[160:163], a[28:31], a[88:91], v[160:163]
buffer_load_dwordx4 a[164:167], v4, s[40:43], s34 offen sc1
v_mfma_f32_16x16x32_bf16 v[204:207], a[32:35], a[84:87], v[204:207]
s_add_u32 s34, s37, 75503616
s_lshl2_add_u32 s3, s2, s20
v_mfma_f32_16x16x32_bf16 v[204:207], a[36:39], a[92:95], v[204:207]
v_mfma_f32_16x16x32_bf16 v[164:167], a[32:35], a[80:83], v[164:167]
v_mfma_f32_16x16x32_bf16 v[164:167], a[36:39], a[88:91], v[164:167]
s_waitcnt vmcnt(13) lgkmcnt(0)
s_barrier
v_mfma_f32_16x16x32_bf16 v[188:191], a[40:43], a[100:103], v[188:191]
s_add_u32 s34, s34, s49
ds_read_b128 a[0:3], v33 offset:40960
ds_read_b128 a[4:7], v33 offset:46080
v_mfma_f32_16x16x32_bf16 v[188:191], a[44:47], a[108:111], v[188:191]
buffer_load_dwordx4 a[160:163], v4, s[40:43], s34 offen sc1
v_mfma_f32_16x16x32_bf16 v[148:151], a[40:43], a[96:99], v[148:151]
s_xor_b32 s29, s12, 1835008
ds_read_b128 a[8:11], v33 offset:51200
ds_read_b128 a[12:15], v33 offset:56320
v_mfma_f32_16x16x32_bf16 v[148:151], a[44:47], a[104:107], v[148:151]
buffer_load_dwordx4 v4, s[40:43], s29 offen offset:0 sc1 lds
v_mfma_f32_16x16x32_bf16 v[192:195], a[48:51], a[100:103], v[192:195]
ds_read_b128 a[16:19], v32 offset:20480
ds_read_b128 a[20:23], v32 offset:25600
v_mfma_f32_16x16x32_bf16 v[192:195], a[52:55], a[108:111], v[192:195]
ds_read_b128 a[24:27], v32 offset:30720
ds_read_b128 a[28:31], v33 offset:41984
v_mfma_f32_16x16x32_bf16 v[152:155], a[48:51], a[96:99], v[152:155]
buffer_load_dwordx4 v4, s[40:43], s29 offen offset:1024 sc1 lds
v_mfma_f32_16x16x32_bf16 v[152:155], a[52:55], a[104:107], v[152:155]
s_mul_i32 s3, s3, 13312
ds_read_b128 a[32:35], v33 offset:47104
ds_read_b128 a[36:39], v33 offset:52224
v_mfma_f32_16x16x32_bf16 v[196:199], a[56:59], a[100:103], v[196:199]
buffer_load_dwordx4 v4, s[40:43], s29 offen offset:2048 sc1 lds
v_mfma_f32_16x16x32_bf16 v[196:199], a[60:63], a[108:111], v[196:199]
v_mfma_f32_16x16x32_bf16 v[156:159], a[56:59], a[96:99], v[156:159]
buffer_load_dwordx4 v4, s[40:43], s29 offen offset:3072 sc1 lds
v_mfma_f32_16x16x32_bf16 v[156:159], a[60:63], a[104:107], v[156:159]
v_mfma_f32_16x16x32_bf16 v[200:203], a[64:67], a[100:103], v[200:203]
s_add_u32 s29, s29, 1024
s_add_u32 m0, s26, 1024
v_mfma_f32_16x16x32_bf16 v[200:203], a[68:71], a[108:111], v[200:203]
buffer_load_dwordx4 v4, s[40:43], s29 offen offset:3072 sc1 lds
v_mfma_f32_16x16x32_bf16 v[160:163], a[64:67], a[96:99], v[160:163]
s_add_u32 s29, s19, 113246208
s_add_u32 m0, s26, 20480
v_mfma_f32_16x16x32_bf16 v[160:163], a[68:71], a[104:107], v[160:163]
buffer_load_dwordx4 v4, s[40:43], s29 offen offset:0 sc1 lds
v_mfma_f32_16x16x32_bf16 v[204:207], a[72:75], a[100:103], v[204:207]
s_add_u32 s38, s3, 83886080
v_mfma_f32_16x16x32_bf16 v[204:207], a[76:79], a[108:111], v[204:207]
v_mfma_f32_16x16x32_bf16 v[164:167], a[72:75], a[96:99], v[164:167]
s_mov_b32 s18, 2621440
v_mfma_f32_16x16x32_bf16 v[164:167], a[76:79], a[104:107], v[164:167]
s_waitcnt vmcnt(13)
s_waitcnt lgkmcnt(7)
v_mfma_f32_16x16x32_bf16 v[188:191], a[0:3], a[116:119], v[188:191]
v_mfma_f32_16x16x32_bf16 v[188:191], a[4:7], a[124:127], v[188:191]
buffer_load_dwordx4 v4, s[40:43], s29 offen offset:1024 sc1 lds
v_mfma_f32_16x16x32_bf16 v[188:191], a[8:11], a[132:135], v[188:191]
buffer_load_dwordx4 v4, s[40:43], s29 offen offset:2048 sc1 lds
v_mfma_f32_16x16x32_bf16 v[148:151], a[0:3], a[112:115], v[148:151]
s_waitcnt vmcnt(10)
buffer_load_dwordx4 v4, s[40:43], s29 offen offset:3072 sc1 lds
v_mfma_f32_16x16x32_bf16 v[148:151], a[4:7], a[120:123], v[148:151]
s_add_u32 m0, s26, 21504
ds_read_b128 a[40:43], v33 offset:57344
ds_read_b128 a[44:47], v32 offset:21504
v_mfma_f32_16x16x32_bf16 v[148:151], a[8:11], a[128:131], v[148:151]
s_add_u32 s29, s29, 1024
ds_read_b128 a[48:51], v32 offset:26624
s_waitcnt lgkmcnt(7)
v_mfma_f32_16x16x32_bf16 v[188:191], a[12:15], a[140:143], v[188:191]
buffer_load_dwordx4 v4, s[40:43], s29 offen offset:3072 sc1 lds
v_mfma_f32_16x16x32_bf16 v[188:191], a[16:19], a[148:151], v[188:191]
s_add_u32 m0, s27, 0
v_mfma_f32_16x16x32_bf16 v[188:191], a[20:23], a[156:159], v[188:191]
s_waitcnt vmcnt(10)
ds_read_b128 a[52:55], v32 offset:31744
ds_read_b128 a[56:59], v33 offset:43008
v_mfma_f32_16x16x32_bf16 v[148:151], a[12:15], a[136:139], v[148:151]
s_waitcnt lgkmcnt(6)
ds_read_b128 a[60:63], v33 offset:48128
ds_read_b128 a[64:67], v33 offset:53248
v_mfma_f32_16x16x32_bf16 v[148:151], a[16:19], a[144:147], v[148:151]
s_add_u32 s29, s19, 113508352
s_add_u32 s29, s29, s50
ds_read_b128 a[68:71], v33 offset:58368
v_mfma_f32_16x16x32_bf16 v[148:151], a[20:23], a[152:155], v[148:151]
ds_read_b128 a[72:75], v32 offset:22528
v_mfma_f32_16x16x32_bf16 v[188:191], a[24:27], a[164:167], v[188:191]
ds_read_b128 a[76:79], v32 offset:27648
v_mfma_f32_16x16x32_bf16 v[148:151], a[24:27], a[160:163], v[148:151]
s_waitcnt lgkmcnt(8)
buffer_load_dwordx4 v4, s[40:43], s29 offen offset:0 sc1 lds
v_mfma_f32_16x16x32_bf16 v[192:195], a[28:31], a[116:119], v[192:195]
buffer_load_dwordx4 v4, s[40:43], s29 offen offset:1024 sc1 lds
v_mfma_f32_16x16x32_bf16 v[192:195], a[32:35], a[124:127], v[192:195]
s_xor_b32 s3, s2, 6
ds_read_b128 a[0:3], v32 offset:32768
ds_read_b128 a[4:7], v33 offset:44032
v_mfma_f32_16x16x32_bf16 v[192:195], a[36:39], a[132:135], v[192:195]
ds_read_b128 a[8:11], v33 offset:49152
ds_read_b128 a[12:15], v33 offset:54272
v_mfma_f32_16x16x32_bf16 v[152:155], a[28:31], a[112:115], v[152:155]
buffer_load_dwordx4 v4, s[40:43], s29 offen offset:2048 sc1 lds
v_mfma_f32_16x16x32_bf16 v[152:155], a[32:35], a[120:123], v[152:155]
ds_read_b128 a[16:19], v33 offset:59392
ds_read_b128 a[20:23], v32 offset:23552
v_mfma_f32_16x16x32_bf16 v[152:155], a[36:39], a[128:131], v[152:155]
buffer_load_dwordx4 v4, s[40:43], s29 offen offset:3072 sc1 lds
v_mfma_f32_16x16x32_bf16 v[192:195], a[40:43], a[140:143], v[192:195]
s_lshl2_add_u32 s3, s3, s20
s_add_u32 s29, s29, 1024
s_mul_i32 s3, s3, 13312
v_mfma_f32_16x16x32_bf16 v[192:195], a[44:47], a[148:151], v[192:195]
s_add_u32 m0, s27, 1024
ds_read_b128 a[24:27], v32 offset:28672
s_waitcnt lgkmcnt(12)
v_mfma_f32_16x16x32_bf16 v[192:195], a[48:51], a[156:159], v[192:195]
buffer_load_dwordx4 v4, s[40:43], s29 offen offset:3072 sc1 lds
v_mfma_f32_16x16x32_bf16 v[152:155], a[40:43], a[136:139], v[152:155]
v_mfma_f32_16x16x32_bf16 v[152:155], a[44:47], a[144:147], v[152:155]
s_waitcnt lgkmcnt(9)
v_cvt_pk_bf16_f32 v148, v148, v149
s_mov_b32 s19, 0x20000
v_mfma_f32_16x16x32_bf16 v[152:155], a[48:51], a[152:155], v[152:155]
s_add_u32 s39, s38, 4096
v_cvt_pk_bf16_f32 v149, v150, v151
v_mfma_f32_16x16x32_bf16 v[192:195], a[52:55], a[164:167], v[192:195]
ds_read_b128 a[28:31], v32 offset:33792
v_cvt_pk_bf16_f32 v188, v188, v189
v_mfma_f32_16x16x32_bf16 v[152:155], a[52:55], a[160:163], v[152:155]
s_mov_b32 s17, s57
ds_read_b128 a[32:35], v33 offset:45056
s_waitcnt lgkmcnt(8)
v_mfma_f32_16x16x32_bf16 v[196:199], a[56:59], a[116:119], v[196:199]
ds_read_b128 a[36:39], v33 offset:50176
s_add_u32 s48, s3, 83888128
v_mfma_f32_16x16x32_bf16 v[196:199], a[60:63], a[124:127], v[196:199]
v_mfma_f32_16x16x32_bf16 v[196:199], a[64:67], a[132:135], v[196:199]
v_mfma_f32_16x16x32_bf16 v[156:159], a[56:59], a[112:115], v[156:159]
v_cvt_pk_bf16_f32 v189, v190, v191
v_cvt_pk_bf16_f32 v190, v192, v193
v_mfma_f32_16x16x32_bf16 v[156:159], a[60:63], a[120:123], v[156:159]
v_mfma_f32_16x16x32_bf16 v[156:159], a[64:67], a[128:131], v[156:159]
v_cvt_pk_bf16_f32 v151, v154, v155
v_mfma_f32_16x16x32_bf16 v[196:199], a[68:71], a[140:143], v[196:199]
v_cvt_pk_bf16_f32 v150, v152, v153
v_cvt_pk_bf16_f32 v191, v194, v195
v_mfma_f32_16x16x32_bf16 v[196:199], a[72:75], a[148:151], v[196:199]
buffer_store_dwordx4 v[188:191], v4, s[40:43], s38 offen offset:2048 sc1
v_mfma_f32_16x16x32_bf16 v[196:199], a[76:79], a[156:159], v[196:199]
s_waitcnt lgkmcnt(6)
ds_read_b128 a[40:43], v33 offset:55296
ds_read_b128 a[44:47], v33 offset:60416
v_mfma_f32_16x16x32_bf16 v[156:159], a[68:71], a[136:139], v[156:159]
ds_read_b128 a[48:51], v32 offset:24576
ds_read_b128 a[52:55], v32 offset:29696
v_mfma_f32_16x16x32_bf16 v[156:159], a[72:75], a[144:147], v[156:159]
s_xor_b32 s3, s2, 2
ds_read_b128 a[56:59], v32 offset:34816
ds_read_b128 a[60:63], v32 offset:40960
v_mfma_f32_16x16x32_bf16 v[156:159], a[76:79], a[152:155], v[156:159]
v_mfma_f32_16x16x32_bf16 v[196:199], a[0:3], a[164:167], v[196:199]
s_lshl2_add_u32 s3, s3, s20
ds_read_b128 a[64:67], v32 offset:46080
ds_read_b128 a[68:71], v32 offset:51200
v_mfma_f32_16x16x32_bf16 v[156:159], a[0:3], a[160:163], v[156:159]
ds_read_b128 a[72:75], v32 offset:56320
v_mfma_f32_16x16x32_bf16 v[200:203], a[4:7], a[116:119], v[200:203]
buffer_store_dwordx4 v[148:151], v4, s[40:43], s38 offen offset:0 sc1
v_mfma_f32_16x16x32_bf16 v[200:203], a[8:11], a[124:127], v[200:203]
ds_read_b128 a[76:79], v32 offset:41984
v_mfma_f32_16x16x32_bf16 v[200:203], a[12:15], a[132:135], v[200:203]
ds_read_b128 a[0:3], v32 offset:47104
v_mfma_f32_16x16x32_bf16 v[160:163], a[4:7], a[112:115], v[160:163]
ds_read_b128 a[4:7], v32 offset:52224
v_mfma_f32_16x16x32_bf16 v[160:163], a[8:11], a[120:123], v[160:163]
s_mov_b32 s16, s56
v_mfma_f32_16x16x32_bf16 v[160:163], a[12:15], a[128:131], v[160:163]
s_waitcnt lgkmcnt(15)
ds_read_b128 a[8:11], v32 offset:57344
ds_read_b128 a[12:15], v32 offset:43008
v_mfma_f32_16x16x32_bf16 v[200:203], a[16:19], a[140:143], v[200:203]
v_mfma_f32_16x16x32_bf16 v[200:203], a[20:23], a[148:151], v[200:203]
v_cvt_pk_bf16_f32 v196, v196, v197
v_mfma_f32_16x16x32_bf16 v[200:203], a[24:27], a[156:159], v[200:203]
s_waitcnt lgkmcnt(14)
s_waitcnt lgkmcnt(11)
s_waitcnt lgkmcnt(8)
v_mfma_f32_16x16x32_bf16 v[160:163], a[16:19], a[136:139], v[160:163]
ds_read_b128 a[16:19], v32 offset:48128
v_cvt_pk_bf16_f32 v197, v198, v199
v_mfma_f32_16x16x32_bf16 v[160:163], a[20:23], a[144:147], v[160:163]
s_mul_i32 s3, s3, 13312
s_add_u32 s49, s3, 83888128
v_mfma_f32_16x16x32_bf16 v[160:163], a[24:27], a[152:155], v[160:163]
s_xor_b32 s3, s2, 4
s_lshl2_add_u32 s3, s3, s20
v_mfma_f32_16x16x32_bf16 v[200:203], a[28:31], a[164:167], v[200:203]
ds_read_b128 a[20:23], v32 offset:53248
v_cvt_pk_bf16_f32 v156, v156, v157
v_mfma_f32_16x16x32_bf16 v[160:163], a[28:31], a[160:163], v[160:163]
v_cvt_pk_bf16_f32 v157, v158, v159
v_mfma_f32_16x16x32_bf16 v[204:207], a[32:35], a[116:119], v[204:207]
ds_read_b128 a[24:27], v32 offset:58368
s_mul_i32 s3, s3, 13312
v_mfma_f32_16x16x32_bf16 v[204:207], a[36:39], a[124:127], v[204:207]
v_cvt_pk_bf16_f32 v199, v202, v203
v_mfma_f32_16x16x32_bf16 v[204:207], a[40:43], a[132:135], v[204:207]
ds_read_b128 a[28:31], v32 offset:44032
v_mfma_f32_16x16x32_bf16 v[164:167], a[32:35], a[112:115], v[164:167]
ds_read_b128 a[32:35], v32 offset:49152
v_mfma_f32_16x16x32_bf16 v[164:167], a[36:39], a[120:123], v[164:167]
s_waitcnt lgkmcnt(10)
v_cvt_pk_bf16_f32 v159, v162, v163
v_cvt_pk_bf16_f32 v198, v200, v201
v_mfma_f32_16x16x32_bf16 v[164:167], a[40:43], a[128:131], v[164:167]
ds_read_b128 a[36:39], v32 offset:54272
v_mfma_f32_16x16x32_bf16 v[204:207], a[44:47], a[140:143], v[204:207]
buffer_store_dwordx4 v[196:199], v4, s[40:43], s38 offen offset:3072 sc1
v_mfma_f32_16x16x32_bf16 v[204:207], a[48:51], a[148:151], v[204:207]
v_mfma_f32_16x16x32_bf16 v[204:207], a[52:55], a[156:159], v[204:207]
v_mfma_f32_16x16x32_bf16 v[164:167], a[44:47], a[136:139], v[164:167]
ds_read_b128 a[40:43], v32 offset:59392
ds_read_b128 a[44:47], v32 offset:45056
v_mfma_f32_16x16x32_bf16 v[164:167], a[48:51], a[144:147], v[164:167]
ds_read_b128 a[48:51], v32 offset:50176
v_mfma_f32_16x16x32_bf16 v[164:167], a[52:55], a[152:155], v[164:167]
ds_read_b128 a[52:55], v32 offset:55296
v_cvt_pk_bf16_f32 v158, v160, v161
v_mfma_f32_16x16x32_bf16 v[204:207], a[56:59], a[164:167], v[204:207]
s_waitcnt lgkmcnt(12)
v_mfma_f32_16x16x32_bf16 v[164:167], a[56:59], a[160:163], v[164:167]
buffer_store_dwordx4 v[156:159], v4, s[40:43], s38 offen offset:1024 sc1
v_mfma_f32_16x16x32_bf16 v[168:171], a[60:63], a[196:199], v[168:171]
ds_read_b128 a[56:59], v32 offset:60416
v_mfma_f32_16x16x32_bf16 v[168:171], a[64:67], a[204:207], v[168:171]
s_add_u32 s50, s3, 83891200
ds_read_b128 a[60:63], v32 offset:0
ds_read_b128 a[64:67], v32 offset:5120
v_mfma_f32_16x16x32_bf16 v[168:171], a[68:71], a[212:215], v[168:171]
ds_read_b128 a[68:71], v32 offset:10240
v_cvt_pk_bf16_f32 v164, v164, v165
v_mfma_f32_16x16x32_bf16 v[168:171], a[72:75], a[220:223], v[168:171]
ds_read_b128 a[72:75], v32 offset:15360
v_cvt_pk_bf16_f32 v165, v166, v167
v_mfma_f32_16x16x32_bf16 v[172:175], a[76:79], a[196:199], v[172:175]
ds_read_b128 a[76:79], v32 offset:1024
v_cvt_pk_bf16_f32 v167, v206, v207
v_mfma_f32_16x16x32_bf16 v[172:175], a[0:3], a[204:207], v[172:175]
v_mfma_f32_16x16x32_bf16 v[172:175], a[4:7], a[212:215], v[172:175]
s_waitcnt lgkmcnt(15)
ds_read_b128 a[0:3], v32 offset:6144
v_cvt_pk_bf16_f32 v166, v204, v205
v_mfma_f32_16x16x32_bf16 v[172:175], a[8:11], a[220:223], v[172:175]
s_waitcnt lgkmcnt(13)
ds_read_b128 a[4:7], v32 offset:11264
ds_read_b128 a[8:11], v32 offset:16384
v_mfma_f32_16x16x32_bf16 v[176:179], a[12:15], a[196:199], v[176:179]
buffer_store_dwordx4 v[164:167], v4, s[40:43], s39 offen offset:0 sc1
v_mfma_f32_16x16x32_bf16 v[176:179], a[16:19], a[204:207], v[176:179]
ds_read_b128 a[12:15], v32 offset:2048
ds_read_b128 a[16:19], v32 offset:7168
v_mfma_f32_16x16x32_bf16 v[176:179], a[20:23], a[212:215], v[176:179]
v_mfma_f32_16x16x32_bf16 v[176:179], a[24:27], a[220:223], v[176:179]
ds_read_b128 a[20:23], v32 offset:12288
ds_read_b128 a[24:27], v32 offset:17408
v_mfma_f32_16x16x32_bf16 v[180:183], a[28:31], a[196:199], v[180:183]
ds_read_b128 a[28:31], v32 offset:3072
s_waitcnt lgkmcnt(15)
v_mfma_f32_16x16x32_bf16 v[180:183], a[32:35], a[204:207], v[180:183]
ds_read_b128 a[32:35], v32 offset:8192
v_mfma_f32_16x16x32_bf16 v[180:183], a[36:39], a[212:215], v[180:183]
ds_read_b128 a[36:39], v32 offset:13312
v_mfma_f32_16x16x32_bf16 v[180:183], a[40:43], a[220:223], v[180:183]
s_waitcnt lgkmcnt(15)
s_waitcnt lgkmcnt(13)
ds_read_b128 a[40:43], v32 offset:18432
v_mfma_f32_16x16x32_bf16 v[184:187], a[44:47], a[196:199], v[184:187]
ds_read_b128 a[44:47], v32 offset:4096
v_mfma_f32_16x16x32_bf16 v[184:187], a[48:51], a[204:207], v[184:187]
ds_read_b128 a[48:51], v32 offset:9216
s_waitcnt lgkmcnt(13)
v_mfma_f32_16x16x32_bf16 v[184:187], a[52:55], a[212:215], v[184:187]
ds_read_b128 a[52:55], v32 offset:14336
v_mfma_f32_16x16x32_bf16 v[184:187], a[56:59], a[220:223], v[184:187]
ds_read_b128 a[56:59], v32 offset:19456
v_mfma_f32_16x16x32_bf16 v[168:171], a[60:63], a[228:231], v[168:171]
v_mfma_f32_16x16x32_bf16 v[168:171], a[64:67], a[236:239], v[168:171]
v_mfma_f32_16x16x32_bf16 v[168:171], a[68:71], a[244:247], v[168:171]
v_mfma_f32_16x16x32_bf16 v[168:171], a[72:75], a[252:255], v[168:171]
v_mfma_f32_16x16x32_bf16 v[172:175], a[76:79], a[228:231], v[172:175]
s_waitcnt lgkmcnt(12)
v_mfma_f32_16x16x32_bf16 v[172:175], a[0:3], a[236:239], v[172:175]
s_waitcnt vmcnt(5)
s_barrier
ds_read_b128 a[60:63], v33 offset:0
ds_read_b128 a[64:67], v33 offset:5120
v_mfma_f32_16x16x32_bf16 v[172:175], a[4:7], a[244:247], v[172:175]
ds_read_b128 a[68:71], v33 offset:10240
v_mfma_f32_16x16x32_bf16 v[172:175], a[8:11], a[252:255], v[172:175]
s_waitcnt lgkmcnt(12)
ds_read_b128 a[72:75], v33 offset:15360
ds_read_b128 a[76:79], v33 offset:20480
ds_read_b128 a[0:3], v33 offset:25600
v_mfma_f32_16x16x32_bf16 v[176:179], a[12:15], a[228:231], v[176:179]
ds_read_b128 a[4:7], v33 offset:30720
ds_read_b128 a[8:11], v33 offset:35840
ds_read_b128 a[12:15], v34 offset:0
v_mfma_f32_16x16x32_bf16 v[176:179], a[16:19], a[236:239], v[176:179]
ds_read_b128 a[16:19], v34 offset:5120
v_mfma_f32_16x16x32_bf16 v[176:179], a[20:23], a[244:247], v[176:179]
s_waitcnt lgkmcnt(15)
v_mfma_f32_16x16x32_bf16 v[176:179], a[24:27], a[252:255], v[176:179]
v_mfma_f32_16x16x32_bf16 v[180:183], a[28:31], a[228:231], v[180:183]
ds_read_b128 a[20:23], v34 offset:10240
s_waitcnt lgkmcnt(14)
ds_read_b128 a[24:27], v33 offset:1024
ds_read_b128 a[28:31], v33 offset:6144
v_mfma_f32_16x16x32_bf16 v[180:183], a[32:35], a[236:239], v[180:183]
ds_read_b128 a[32:35], v33 offset:11264
v_mfma_f32_16x16x32_bf16 v[180:183], a[36:39], a[244:247], v[180:183]
ds_read_b128 a[36:39], v33 offset:16384
v_mfma_f32_16x16x32_bf16 v[180:183], a[40:43], a[252:255], v[180:183]
v_mfma_f32_16x16x32_bf16 v[184:187], a[44:47], a[228:231], v[184:187]
ds_read_b128 a[40:43], v33 offset:21504
s_waitcnt lgkmcnt(15)
s_waitcnt lgkmcnt(13)
ds_read_b128 a[44:47], v33 offset:26624
v_mfma_f32_16x16x32_bf16 v[184:187], a[48:51], a[236:239], v[184:187]
s_waitcnt lgkmcnt(11)
ds_read_b128 a[48:51], v33 offset:31744
v_mfma_f32_16x16x32_bf16 v[184:187], a[52:55], a[244:247], v[184:187]
v_mfma_f32_16x16x32_bf16 v[184:187], a[56:59], a[252:255], v[184:187]
ds_read_b128 a[52:55], v33 offset:36864
s_waitcnt lgkmcnt(10)
v_mfma_f32_16x16x32_bf16 v[168:171], a[60:63], a[84:87], v[168:171]
ds_read_b128 a[56:59], v34 offset:1024
v_mfma_f32_16x16x32_bf16 v[168:171], a[64:67], a[92:95], v[168:171]
ds_read_b128 a[60:63], v34 offset:6144
s_waitcnt lgkmcnt(9)
v_mfma_f32_16x16x32_bf16 v[168:171], a[68:71], a[100:103], v[168:171]
ds_read_b128 a[64:67], v34 offset:11264
ds_read_b128 a[68:71], v33 offset:2048
v_mfma_f32_16x16x32_bf16 v[168:171], a[72:75], a[108:111], v[168:171]
s_waitcnt lgkmcnt(8)
v_mfma_f32_16x16x32_bf16 v[168:171], a[76:79], a[116:119], v[168:171]
ds_read_b128 a[72:75], v33 offset:7168
ds_read_b128 a[76:79], v33 offset:12288
v_mfma_f32_16x16x32_bf16 v[168:171], a[0:3], a[124:127], v[168:171]
ds_read_b128 a[0:3], v33 offset:17408
v_mfma_f32_16x16x32_bf16 v[168:171], a[4:7], a[132:135], v[168:171]
ds_read_b128 a[4:7], v33 offset:22528
v_mfma_f32_16x16x32_bf16 v[168:171], a[8:11], a[140:143], v[168:171]
v_mfma_f32_16x16x32_bf16 v[168:171], a[12:15], a[148:151], v[168:171]
ds_read_b128 a[8:11], v33 offset:27648
v_mfma_f32_16x16x32_bf16 v[168:171], a[16:19], a[156:159], v[168:171]
ds_read_b128 a[12:15], v33 offset:32768
ds_read_b128 a[16:19], v33 offset:37888
v_mfma_f32_16x16x32_bf16 v[168:171], a[20:23], a[164:167], v[168:171]
ds_read_b128 a[20:23], v34 offset:2048
v_mfma_f32_16x16x32_bf16 v[172:175], a[24:27], a[84:87], v[172:175]
ds_read_b128 a[24:27], v34 offset:7168
s_waitcnt lgkmcnt(14)
v_mfma_f32_16x16x32_bf16 v[172:175], a[28:31], a[92:95], v[172:175]
ds_read_b128 a[28:31], v34 offset:12288
v_mfma_f32_16x16x32_bf16 v[172:175], a[32:35], a[100:103], v[172:175]
s_waitcnt lgkmcnt(12)
s_waitcnt lgkmcnt(9)
v_mfma_f32_16x16x32_bf16 v[172:175], a[36:39], a[108:111], v[172:175]
ds_read_b128 a[32:35], v33 offset:3072
ds_read_b128 a[36:39], v33 offset:8192
v_mfma_f32_16x16x32_bf16 v[172:175], a[40:43], a[116:119], v[172:175]
ds_read_b128 a[40:43], v33 offset:13312
v_mfma_f32_16x16x32_bf16 v[172:175], a[44:47], a[124:127], v[172:175]
ds_read_b128 a[44:47], v33 offset:18432
v_mfma_f32_16x16x32_bf16 v[172:175], a[48:51], a[132:135], v[172:175]
ds_read_b128 a[48:51], v33 offset:23552
v_mfma_f32_16x16x32_bf16 v[172:175], a[52:55], a[140:143], v[172:175]
ds_read_b128 a[52:55], v33 offset:28672
v_mfma_f32_16x16x32_bf16 v[172:175], a[56:59], a[148:151], v[172:175]
ds_read_b128 a[56:59], v33 offset:33792
v_mfma_f32_16x16x32_bf16 v[172:175], a[60:63], a[156:159], v[172:175]
s_waitcnt lgkmcnt(13)
s_waitcnt lgkmcnt(10)
ds_read_b128 a[60:63], v33 offset:38912
v_mfma_f32_16x16x32_bf16 v[172:175], a[64:67], a[164:167], v[172:175]
v_cvt_pk_bf16_f32 v168, v168, v169
v_cvt_pk_bf16_f32 v169, v170, v171
v_mfma_f32_16x16x32_bf16 v[176:179], a[68:71], a[84:87], v[176:179]
ds_read_b128 a[64:67], v34 offset:3072
ds_read_b128 a[68:71], v34 offset:8192
v_mfma_f32_16x16x32_bf16 v[176:179], a[72:75], a[92:95], v[176:179]
ds_read_b128 a[72:75], v34 offset:13312
v_mfma_f32_16x16x32_bf16 v[176:179], a[76:79], a[100:103], v[176:179]
ds_read_b128 a[76:79], v33 offset:4096
v_cvt_pk_bf16_f32 v171, v174, v175
v_mfma_f32_16x16x32_bf16 v[176:179], a[0:3], a[108:111], v[176:179]
buffer_load_dwordx4 v[68:71], v4, s[40:43], s48 offen offset:0 sc1
v_mfma_f32_16x16x32_bf16 v[176:179], a[4:7], a[116:119], v[176:179]
ds_read_b128 a[0:3], v33 offset:9216
ds_read_b128 a[4:7], v33 offset:14336
v_cvt_pk_bf16_f32 v170, v172, v173
v_mfma_f32_16x16x32_bf16 v[176:179], a[8:11], a[124:127], v[176:179]
ds_read_b128 a[8:11], v33 offset:19456
s_waitcnt lgkmcnt(15)
v_mfma_f32_16x16x32_bf16 v[176:179], a[12:15], a[132:135], v[176:179]
s_waitcnt lgkmcnt(12)
buffer_store_dwordx4 v[168:171], v4, s[40:43], s39 offen offset:1024 sc1
v_mfma_f32_16x16x32_bf16 v[176:179], a[16:19], a[140:143], v[176:179]
ds_read_b128 a[12:15], v33 offset:24576
ds_read_b128 a[16:19], v33 offset:29696
v_mfma_f32_16x16x32_bf16 v[176:179], a[20:23], a[148:151], v[176:179]
s_waitcnt lgkmcnt(11)
v_mfma_f32_16x16x32_bf16 v[176:179], a[24:27], a[156:159], v[176:179]
ds_read_b128 a[20:23], v33 offset:34816
ds_read_b128 a[24:27], v33 offset:39936
v_mfma_f32_16x16x32_bf16 v[176:179], a[28:31], a[164:167], v[176:179]
ds_read_b128 a[28:31], v34 offset:4096
v_mfma_f32_16x16x32_bf16 v[180:183], a[32:35], a[84:87], v[180:183]
s_waitcnt lgkmcnt(11)
ds_read_b128 a[32:35], v34 offset:9216
v_mfma_f32_16x16x32_bf16 v[180:183], a[36:39], a[92:95], v[180:183]
ds_read_b128 a[36:39], v34 offset:14336
s_waitcnt lgkmcnt(10)
v_mfma_f32_16x16x32_bf16 v[180:183], a[40:43], a[100:103], v[180:183]
ds_read_b128 a[40:43], v32 offset:40960
v_mfma_f32_16x16x32_bf16 v[180:183], a[44:47], a[108:111], v[180:183]
s_sub_u32 s3, s49, 2048
s_waitcnt lgkmcnt(8)
ds_read_b128 a[44:47], v32 offset:46080
v_mfma_f32_16x16x32_bf16 v[180:183], a[48:51], a[116:119], v[180:183]
ds_read_b128 a[48:51], v32 offset:51200
v_mfma_f32_16x16x32_bf16 v[180:183], a[52:55], a[124:127], v[180:183]
buffer_load_dwordx4 v[72:75], v4, s[40:43], s3 offen offset:0 sc1
v_mfma_f32_16x16x32_bf16 v[180:183], a[56:59], a[132:135], v[180:183]
v_cvt_pk_bf16_f32 v176, v176, v177
v_cvt_pk_bf16_f32 v177, v178, v179
v_mfma_f32_16x16x32_bf16 v[180:183], a[60:63], a[140:143], v[180:183]
s_waitcnt lgkmcnt(7)
ds_read_b128 a[52:55], v32 offset:56320
v_mfma_f32_16x16x32_bf16 v[180:183], a[64:67], a[148:151], v[180:183]
ds_read_b128 a[56:59], v32 offset:0
ds_read_b128 a[60:63], v32 offset:5120
v_mfma_f32_16x16x32_bf16 v[180:183], a[68:71], a[156:159], v[180:183]
s_waitcnt lgkmcnt(7)
ds_read_b128 a[64:67], v32 offset:10240
v_mfma_f32_16x16x32_bf16 v[180:183], a[72:75], a[164:167], v[180:183]
ds_read_b128 a[68:71], v32 offset:15360
v_mfma_f32_16x16x32_bf16 v[184:187], a[76:79], a[84:87], v[184:187]
ds_read_b128 a[72:75], v33 offset:0
ds_read_b128 a[76:79], v33 offset:5120
v_mfma_f32_16x16x32_bf16 v[184:187], a[0:3], a[92:95], v[184:187]
ds_read_b128 a[0:3], v33 offset:10240
v_mfma_f32_16x16x32_bf16 v[184:187], a[4:7], a[100:103], v[184:187]
ds_read_b128 a[4:7], v33 offset:15360
v_cvt_pk_bf16_f32 v178, v180, v181
v_mfma_f32_16x16x32_bf16 v[184:187], a[8:11], a[108:111], v[184:187]
ds_read_b128 a[8:11], v33 offset:20480
v_cvt_pk_bf16_f32 v179, v182, v183
v_mfma_f32_16x16x32_bf16 v[184:187], a[12:15], a[116:119], v[184:187]
buffer_load_dwordx4 v[80:83], v4, s[40:43], s48 offen offset:1024 sc1
v_mfma_f32_16x16x32_bf16 v[184:187], a[16:19], a[124:127], v[184:187]
ds_read_b128 a[12:15], v33 offset:25600
s_waitcnt lgkmcnt(12)
v_mfma_f32_16x16x32_bf16 v[184:187], a[20:23], a[132:135], v[184:187]
s_waitcnt lgkmcnt(9)
ds_read_b128 a[16:19], v33 offset:30720
ds_read_b128 a[20:23], v33 offset:35840
v_mfma_f32_16x16x32_bf16 v[184:187], a[24:27], a[140:143], v[184:187]
buffer_store_dwordx4 v[176:179], v4, s[40:43], s39 offen offset:2048 sc1
v_mfma_f32_16x16x32_bf16 v[184:187], a[28:31], a[148:151], v[184:187]
ds_read_b128 a[24:27], v34 offset:0
ds_read_b128 a[28:31], v34 offset:5120
v_mfma_f32_16x16x32_bf16 v[184:187], a[32:35], a[156:159], v[184:187]
ds_read_b128 a[32:35], v34 offset:10240
v_mfma_f32_16x16x32_bf16 v[184:187], a[36:39], a[164:167], v[184:187]
s_waitcnt lgkmcnt(11)
ds_read_b128 a[36:39], v32 offset:41984
v_mfma_f32_16x16x32_bf16 v[128:131], v[100:103], a[168:171], v[128:131]
v_mfma_f32_16x16x32_bf16 v[128:131], v[228:231], a[176:179], v[128:131]
v_mfma_f32_16x16x32_bf16 v[128:131], v[208:211], a[184:187], v[128:131]
s_sub_u32 s3, s49, 2048
s_waitcnt lgkmcnt(9)
v_mfma_f32_16x16x32_bf16 v[128:131], v[10:13], v[14:17], v[128:131]
v_cvt_pk_bf16_f32 v184, v184, v185
v_cvt_pk_bf16_f32 v185, v186, v187
v_mfma_f32_16x16x32_bf16 v[128:131], a[40:43], a[192:195], v[128:131]
buffer_store_dwordx2 v[184:185], v47, s[40:43], s39 offen offset:3072 sc1
v_mfma_f32_16x16x32_bf16 v[128:131], a[44:47], a[200:203], v[128:131]
ds_read_b128 a[40:43], v32 offset:47104
v_mfma_f32_16x16x32_bf16 v[128:131], a[48:51], a[208:211], v[128:131]
ds_read_b128 a[44:47], v32 offset:52224
ds_read_b128 a[48:51], v32 offset:57344
v_mfma_f32_16x16x32_bf16 v[128:131], a[52:55], a[216:219], v[128:131]
ds_read_b128 a[52:55], v32 offset:1024
v_mfma_f32_16x16x32_bf16 v[128:131], a[56:59], a[224:227], v[128:131]
buffer_load_dwordx4 v[84:87], v4, s[40:43], s3 offen offset:1024 sc1
v_mfma_f32_16x16x32_bf16 v[128:131], a[60:63], a[232:235], v[128:131]
ds_read_b128 a[56:59], v32 offset:6144
v_mfma_f32_16x16x32_bf16 v[128:131], a[64:67], a[240:243], v[128:131]
s_waitcnt lgkmcnt(11)
ds_read_b128 a[60:63], v32 offset:11264
ds_read_b128 a[64:67], v32 offset:16384
v_mfma_f32_16x16x32_bf16 v[128:131], a[68:71], a[248:251], v[128:131]
ds_read_b128 a[68:71], v33 offset:1024
v_mfma_f32_16x16x32_bf16 v[128:131], a[72:75], a[80:83], v[128:131]
ds_read_b128 a[72:75], v33 offset:6144
v_mfma_f32_16x16x32_bf16 v[128:131], a[76:79], a[88:91], v[128:131]
ds_read_b128 a[76:79], v33 offset:11264
v_mfma_f32_16x16x32_bf16 v[128:131], a[0:3], a[96:99], v[128:131]
ds_read_b128 a[0:3], v33 offset:16384
v_mfma_f32_16x16x32_bf16 v[128:131], a[4:7], a[104:107], v[128:131]
ds_read_b128 a[4:7], v33 offset:21504
v_mfma_f32_16x16x32_bf16 v[128:131], a[8:11], a[112:115], v[128:131]
s_waitcnt lgkmcnt(15)
v_mfma_f32_16x16x32_bf16 v[128:131], a[12:15], a[120:123], v[128:131]
ds_read_b128 a[8:11], v33 offset:26624
ds_read_b128 a[12:15], v33 offset:31744
v_mfma_f32_16x16x32_bf16 v[128:131], a[16:19], a[128:131], v[128:131]
ds_read_b128 a[16:19], v33 offset:36864
v_mfma_f32_16x16x32_bf16 v[128:131], a[20:23], a[136:139], v[128:131]
v_mfma_f32_16x16x32_bf16 v[128:131], a[24:27], a[144:147], v[128:131]
s_waitcnt lgkmcnt(15)
buffer_load_dwordx2 v[92:93], v4, s[40:43], s48 offen offset:2056 sc1
v_mfma_f32_16x16x32_bf16 v[128:131], a[28:31], a[152:155], v[128:131]
ds_read_b128 a[20:23], v34 offset:1024
ds_read_b128 a[24:27], v34 offset:6144
v_mfma_f32_16x16x32_bf16 v[128:131], a[32:35], a[160:163], v[128:131]
ds_read_b128 a[28:31], v34 offset:11264
ds_read_b128 a[32:35], v32 offset:43008
v_mfma_f32_16x16x32_bf16 v[132:135], v[104:107], a[168:171], v[132:135]
v_mfma_f32_16x16x32_bf16 v[132:135], v[232:235], a[176:179], v[132:135]
v_mfma_f32_16x16x32_bf16 v[132:135], v[212:215], a[184:187], v[132:135]
v_mfma_f32_16x16x32_bf16 v[132:135], v[8:11], v[14:17], v[132:135]
v_mfma_f32_16x16x32_bf16 v[132:135], a[36:39], a[192:195], v[132:135]
ds_read_b128 a[36:39], v32 offset:48128
s_waitcnt lgkmcnt(15)
v_mfma_f32_16x16x32_bf16 v[132:135], a[40:43], a[200:203], v[132:135]
v_mfma_f32_16x16x32_bf16 v[132:135], a[44:47], a[208:211], v[132:135]
ds_read_b128 a[40:43], v32 offset:53248
ds_read_b128 a[44:47], v32 offset:58368
v_mfma_f32_16x16x32_bf16 v[132:135], a[48:51], a[216:219], v[132:135]
s_waitcnt lgkmcnt(15)
s_waitcnt lgkmcnt(13)
ds_read_b128 a[48:51], v32 offset:2048
v_mfma_f32_16x16x32_bf16 v[132:135], a[52:55], a[224:227], v[132:135]
ds_read_b128 a[52:55], v32 offset:7168
s_waitcnt lgkmcnt(12)
v_mfma_f32_16x16x32_bf16 v[132:135], a[56:59], a[232:235], v[132:135]
buffer_load_dwordx2 v[94:95], v4, s[40:43], s49 offen offset:2048 sc1
v_mfma_f32_16x16x32_bf16 v[132:135], a[60:63], a[240:243], v[132:135]
ds_read_b128 a[56:59], v32 offset:12288
ds_read_b128 a[60:63], v32 offset:17408
v_mfma_f32_16x16x32_bf16 v[132:135], a[64:67], a[248:251], v[132:135]
s_waitcnt lgkmcnt(11)
v_mfma_f32_16x16x32_bf16 v[132:135], a[68:71], a[80:83], v[132:135]
v_mfma_f32_16x16x32_bf16 v[132:135], a[72:75], a[88:91], v[132:135]
buffer_load_dwordx4 v[76:79], v4, s[40:43], s50 offen offset:0 sc1
v_mfma_f32_16x16x32_bf16 v[132:135], a[76:79], a[96:99], v[132:135]
ds_read_b128 a[64:67], v33 offset:2048
ds_read_b128 a[68:71], v33 offset:7168
v_mfma_f32_16x16x32_bf16 v[132:135], a[0:3], a[104:107], v[132:135]
ds_read_b128 a[72:75], v33 offset:12288
ds_read_b128 a[76:79], v33 offset:17408
v_mfma_f32_16x16x32_bf16 v[132:135], a[4:7], a[112:115], v[132:135]
ds_read_b128 a[0:3], v33 offset:22528
v_mfma_f32_16x16x32_bf16 v[132:135], a[8:11], a[120:123], v[132:135]
ds_read_b128 a[4:7], v33 offset:27648
ds_read_b128 a[8:11], v33 offset:32768
v_mfma_f32_16x16x32_bf16 v[132:135], a[12:15], a[128:131], v[132:135]
ds_read_b128 a[12:15], v33 offset:37888
v_mfma_f32_16x16x32_bf16 v[132:135], a[16:19], a[136:139], v[132:135]
ds_read_b128 a[16:19], v34 offset:2048
s_waitcnt lgkmcnt(15)
v_mfma_f32_16x16x32_bf16 v[132:135], a[20:23], a[144:147], v[132:135]
ds_read_b128 a[20:23], v34 offset:7168
v_mfma_f32_16x16x32_bf16 v[132:135], a[24:27], a[152:155], v[132:135]
v_mfma_f32_16x16x32_bf16 v[132:135], a[28:31], a[160:163], v[132:135]
ds_read_b128 a[24:27], v34 offset:12288
v_mfma_f32_16x16x32_bf16 v[136:139], v[108:111], a[168:171], v[136:139]
v_mfma_f32_16x16x32_bf16 v[136:139], v[236:239], a[176:179], v[136:139]
s_waitcnt lgkmcnt(15)
ds_read_b128 a[28:31], v32 offset:44032
v_mfma_f32_16x16x32_bf16 v[136:139], v[216:219], a[184:187], v[136:139]
v_mfma_f32_16x16x32_bf16 v[136:139], v[10:13], v[124:127], v[136:139]
v_mfma_f32_16x16x32_bf16 v[136:139], a[32:35], a[192:195], v[136:139]
ds_read_b128 a[32:35], v32 offset:49152
v_mfma_f32_16x16x32_bf16 v[136:139], a[36:39], a[200:203], v[136:139]
ds_read_b128 a[36:39], v32 offset:54272
v_mfma_f32_16x16x32_bf16 v[136:139], a[40:43], a[208:211], v[136:139]
ds_read_b128 a[40:43], v32 offset:59392
s_waitcnt lgkmcnt(15)
v_mfma_f32_16x16x32_bf16 v[136:139], a[44:47], a[216:219], v[136:139]
ds_read_b128 a[44:47], v32 offset:3072
v_mfma_f32_16x16x32_bf16 v[136:139], a[48:51], a[224:227], v[136:139]
ds_read_b128 a[48:51], v32 offset:8192
s_waitcnt lgkmcnt(15)
v_mfma_f32_16x16x32_bf16 v[136:139], a[52:55], a[232:235], v[136:139]
s_waitcnt lgkmcnt(13)
v_mfma_f32_16x16x32_bf16 v[136:139], a[56:59], a[240:243], v[136:139]
ds_read_b128 a[52:55], v32 offset:13312
ds_read_b128 a[56:59], v32 offset:18432
v_mfma_f32_16x16x32_bf16 v[136:139], a[60:63], a[248:251], v[136:139]
s_waitcnt lgkmcnt(12)
ds_read_b128 a[60:63], v33 offset:3072
v_mfma_f32_16x16x32_bf16 v[136:139], a[64:67], a[80:83], v[136:139]
s_waitcnt lgkmcnt(10)
s_waitcnt lgkmcnt(7)
ds_read_b128 a[64:67], v33 offset:8192
v_mfma_f32_16x16x32_bf16 v[136:139], a[68:71], a[88:91], v[136:139]
v_mfma_f32_16x16x32_bf16 v[136:139], a[72:75], a[96:99], v[136:139]
ds_read_b128 a[68:71], v33 offset:13312
ds_read_b128 a[72:75], v33 offset:18432
v_mfma_f32_16x16x32_bf16 v[136:139], a[76:79], a[104:107], v[136:139]
ds_read_b128 a[76:79], v33 offset:23552
v_mfma_f32_16x16x32_bf16 v[136:139], a[0:3], a[112:115], v[136:139]
buffer_load_dwordx4 v[88:91], v4, s[40:43], s50 offen offset:1024 sc1
v_mfma_f32_16x16x32_bf16 v[136:139], a[4:7], a[120:123], v[136:139]
ds_read_b128 a[0:3], v33 offset:28672
v_mfma_f32_16x16x32_bf16 v[136:139], a[8:11], a[128:131], v[136:139]
ds_read_b128 a[4:7], v33 offset:33792
ds_read_b128 a[8:11], v33 offset:38912
v_mfma_f32_16x16x32_bf16 v[136:139], a[12:15], a[136:139], v[136:139]
ds_read_b128 a[12:15], v34 offset:3072
s_waitcnt lgkmcnt(12)
v_mfma_f32_16x16x32_bf16 v[136:139], a[16:19], a[144:147], v[136:139]
v_mfma_f32_16x16x32_bf16 v[136:139], a[20:23], a[152:155], v[136:139]
s_waitcnt lgkmcnt(9)
ds_read_b128 a[16:19], v34 offset:8192
ds_read_b128 a[20:23], v34 offset:13312
v_mfma_f32_16x16x32_bf16 v[136:139], a[24:27], a[160:163], v[136:139]
s_waitcnt lgkmcnt(8)
ds_read_b128 a[24:27], v32 offset:45056
v_mfma_f32_16x16x32_bf16 v[140:143], v[112:115], a[168:171], v[140:143]
v_mfma_f32_16x16x32_bf16 v[140:143], v[240:243], a[176:179], v[140:143]
v_mfma_f32_16x16x32_bf16 v[140:143], v[220:223], a[184:187], v[140:143]
v_mfma_f32_16x16x32_bf16 v[140:143], v[8:11], v[124:127], v[140:143]
v_mfma_f32_16x16x32_bf16 v[140:143], a[28:31], a[192:195], v[140:143]
ds_read_b128 a[28:31], v32 offset:50176
v_mfma_f32_16x16x32_bf16 v[140:143], a[32:35], a[200:203], v[140:143]
ds_read_b128 a[32:35], v32 offset:55296
v_mfma_f32_16x16x32_bf16 v[140:143], a[36:39], a[208:211], v[140:143]
ds_read_b128 a[36:39], v32 offset:60416
v_mfma_f32_16x16x32_bf16 v[140:143], a[40:43], a[216:219], v[140:143]
ds_read_b128 a[40:43], v32 offset:4096
v_mfma_f32_16x16x32_bf16 v[140:143], a[44:47], a[224:227], v[140:143]
ds_read_b128 a[44:47], v32 offset:9216
v_mfma_f32_16x16x32_bf16 v[140:143], a[48:51], a[232:235], v[140:143]
ds_read_b128 a[48:51], v32 offset:14336
v_mfma_f32_16x16x32_bf16 v[140:143], a[52:55], a[240:243], v[140:143]
buffer_load_dwordx2 v[96:97], v47, s[40:43], s50 offen offset:2048 sc1
v_mfma_f32_16x16x32_bf16 v[140:143], a[56:59], a[248:251], v[140:143]
s_waitcnt lgkmcnt(12)
v_mfma_f32_16x16x32_bf16 v[140:143], a[60:63], a[80:83], v[140:143]
ds_read_b128 a[52:55], v32 offset:19456
v_mfma_f32_16x16x32_bf16 v[140:143], a[64:67], a[88:91], v[140:143]
v_mfma_f32_16x16x32_bf16 v[140:143], a[68:71], a[96:99], v[140:143]
v_mfma_f32_16x16x32_bf16 v[140:143], a[72:75], a[104:107], v[140:143]
v_mfma_f32_16x16x32_bf16 v[140:143], a[76:79], a[112:115], v[140:143]
v_mfma_f32_16x16x32_bf16 v[140:143], a[0:3], a[120:123], v[140:143]
s_waitcnt lgkmcnt(10)
v_mfma_f32_16x16x32_bf16 v[140:143], a[4:7], a[128:131], v[140:143]
v_mfma_f32_16x16x32_bf16 v[140:143], a[8:11], a[136:139], v[140:143]
v_mfma_f32_16x16x32_bf16 v[140:143], a[12:15], a[144:147], v[140:143]
s_waitcnt vmcnt(2)
ds_read_b128 a[56:59], v33 offset:4096
ds_read_b128 a[60:63], v33 offset:9216
v_mfma_f32_16x16x32_bf16 v[48:51], v[10:13], v[68:71], v[128:131]
ds_read_b128 a[64:67], v33 offset:14336
ds_read_b128 a[68:71], v33 offset:19456
v_mfma_f32_16x16x32_bf16 v[48:51], v[10:13], v[72:75], v[48:51]
ds_read_b128 a[72:75], v33 offset:24576
ds_read_b128 a[76:79], v33 offset:29696
v_mfma_f32_16x16x32_bf16 v[48:51], v[10:13], v[76:79], v[48:51]
ds_read_b128 a[0:3], v33 offset:34816
ds_read_b128 a[4:7], v33 offset:39936
v_mfma_f32_16x16x32_bf16 v[52:55], v[8:11], v[68:71], v[132:135]
s_waitcnt lgkmcnt(15)
ds_read_b128 a[8:11], v34 offset:4096
ds_read_b128 a[12:15], v34 offset:9216
v_mfma_f32_16x16x32_bf16 v[52:55], v[8:11], v[72:75], v[52:55]
v_mfma_f32_16x16x32_bf16 v[52:55], v[8:11], v[76:79], v[52:55]
v_cvt_pk_bf16_f32 v168, v48, v49
v_mfma_f32_16x16x32_bf16 v[140:143], a[16:19], a[152:155], v[140:143]
s_waitcnt lgkmcnt(14)
ds_read_b128 a[16:19], v34 offset:14336
v_mfma_f32_16x16x32_bf16 v[140:143], a[20:23], a[160:163], v[140:143]
s_waitcnt lgkmcnt(12)
v_mfma_f32_16x16x32_bf16 v[144:147], v[116:119], a[168:171], v[144:147]
v_mfma_f32_16x16x32_bf16 v[144:147], v[244:247], a[176:179], v[144:147]
v_cvt_pk_bf16_f32 v172, v52, v53
v_cvt_pk_bf16_f32 v169, v50, v51
v_mfma_f32_16x16x32_bf16 v[144:147], v[224:227], a[184:187], v[144:147]
v_cvt_pk_bf16_f32 v173, v54, v55
v_mfma_f32_16x16x32_bf16 v[144:147], v[8:11], v[24:27], v[144:147]
buffer_store_dwordx2 v[168:169], v25, s[16:19], s15 offen offset:0
v_mfma_f32_16x16x32_bf16 v[144:147], a[24:27], a[192:195], v[144:147]
buffer_store_dwordx2 v[172:173], v25, s[16:19], s15 offen offset:32
v_mfma_f32_16x16x32_bf16 v[144:147], a[28:31], a[200:203], v[144:147]
v_mfma_f32_16x16x32_bf16 v[144:147], a[32:35], a[208:211], v[144:147]
v_mfma_f32_16x16x32_bf16 v[144:147], a[36:39], a[216:219], v[144:147]
v_mfma_f32_16x16x32_bf16 v[144:147], a[40:43], a[224:227], v[144:147]
v_mfma_f32_16x16x32_bf16 v[144:147], a[44:47], a[232:235], v[144:147]
v_mfma_f32_16x16x32_bf16 v[144:147], a[48:51], a[240:243], v[144:147]
s_waitcnt vmcnt(3)
v_mfma_f32_16x16x32_bf16 v[56:59], v[10:13], v[80:83], v[136:139]
v_mfma_f32_16x16x32_bf16 v[56:59], v[10:13], v[84:87], v[56:59]
v_mfma_f32_16x16x32_bf16 v[56:59], v[10:13], v[88:91], v[56:59]
v_mfma_f32_16x16x32_bf16 v[60:63], v[8:11], v[80:83], v[140:143]
v_mfma_f32_16x16x32_bf16 v[60:63], v[8:11], v[84:87], v[60:63]
v_mfma_f32_16x16x32_bf16 v[60:63], v[8:11], v[88:91], v[60:63]
s_waitcnt lgkmcnt(9)
s_waitcnt lgkmcnt(6)
s_waitcnt lgkmcnt(3)
v_mfma_f32_16x16x32_bf16 v[144:147], a[52:55], a[248:251], v[144:147]
v_mfma_f32_16x16x32_bf16 v[144:147], a[56:59], a[80:83], v[144:147]
v_cvt_pk_bf16_f32 v176, v56, v57
v_cmp_u_f32 s[58:59], v48, v56
v_mfma_f32_16x16x32_bf16 v[144:147], a[60:63], a[88:91], v[144:147]
v_cvt_pk_bf16_f32 v181, v62, v63
v_mfma_f32_16x16x32_bf16 v[144:147], a[64:67], a[96:99], v[144:147]
v_cvt_pk_bf16_f32 v177, v58, v59
v_cvt_pk_bf16_f32 v180, v60, v61
v_mfma_f32_16x16x32_bf16 v[144:147], a[68:71], a[104:107], v[144:147]
s_waitcnt lgkmcnt(0)
buffer_store_dwordx2 v[176:177], v25, s[16:19], s15 offen offset:64
v_mfma_f32_16x16x32_bf16 v[144:147], a[72:75], a[112:115], v[144:147]
buffer_store_dwordx2 v[180:181], v25, s[16:19], s15 offen offset:96
v_mfma_f32_16x16x32_bf16 v[144:147], a[76:79], a[120:123], v[144:147]
v_mfma_f32_16x16x32_bf16 v[144:147], a[0:3], a[128:131], v[144:147]
v_mfma_f32_16x16x32_bf16 v[144:147], a[4:7], a[136:139], v[144:147]
v_mfma_f32_16x16x32_bf16 v[144:147], a[8:11], a[144:147], v[144:147]
v_mfma_f32_16x16x32_bf16 v[144:147], a[12:15], a[152:155], v[144:147]
v_mfma_f32_16x16x32_bf16 v[144:147], a[16:19], a[160:163], v[144:147]
s_waitcnt vmcnt(4)
v_mfma_f32_16x16x32_bf16 v[64:67], v[10:13], v[92:95], v[144:147]
v_mfma_f32_16x16x32_bf16 v[64:67], v[8:11], v[92:95], v[64:67]
v_mfma_f32_16x16x32_bf16 v[64:67], v[8:11], v[94:97], v[64:67]
s_nop 7
v_cvt_pk_bf16_f32 v184, v64, v65
v_cmp_u_f32 vcc, v64, v64
s_or_b64 vcc, vcc, s[58:59]
v_cvt_pk_bf16_f32 v185, v66, v67
s_cbranch_vccnz kf_kernel_late
kf_kernel_out:
buffer_store_dwordx2 v[184:185], v25, s[16:19], s15 offen offset:128
kf_kernel_end:
s_endpgm
kf_kernel_late:
s_mov_b32 s101, 0x40000
kf_kernel_late1:
buffer_load_dwordx4 v[68:71], v4, s[40:43], s48 offen offset:0 sc1
s_sub_u32 s3, s49, 2048
buffer_load_dwordx4 v[72:75], v4, s[40:43], s3 offen offset:0 sc1
buffer_load_dwordx4 v[76:79], v4, s[40:43], s50 offen offset:0 sc1
buffer_load_dwordx4 v[80:83], v4, s[40:43], s48 offen offset:1024 sc1
s_sub_u32 s3, s49, 2048
buffer_load_dwordx4 v[84:87], v4, s[40:43], s3 offen offset:1024 sc1
buffer_load_dwordx4 v[88:91], v4, s[40:43], s50 offen offset:1024 sc1
buffer_load_dwordx2 v[92:93], v4, s[40:43], s48 offen offset:2056 sc1
buffer_load_dwordx2 v[94:95], v4, s[40:43], s49 offen offset:2048 sc1
buffer_load_dwordx2 v[96:97], v47, s[40:43], s50 offen offset:2048 sc1
s_waitcnt vmcnt(0)
v_max_u32 v1, v68, v69
v_max3_u32 v1, v1, v70, v71
v_max3_u32 v1, v1, v72, v73
v_max3_u32 v1, v1, v74, v75
v_max3_u32 v1, v1, v76, v77
v_max3_u32 v1, v1, v78, v79
v_max3_u32 v1, v1, v80, v81
v_max3_u32 v1, v1, v82, v83
v_max3_u32 v1, v1, v84, v85
v_max3_u32 v1, v1, v86, v87
v_max3_u32 v1, v1, v88, v89
v_max3_u32 v1, v1, v90, v91
v_max3_u32 v1, v1, v92, v93
v_max3_u32 v1, v1, v94, v95
v_max3_u32 v1, v1, v96, v97
v_cmp_eq_u32 vcc, -1, v1
s_cbranch_vccz kf_kernel_late2
s_sub_u32 s101, s101, 1
s_cbranch_scc0 kf_kernel_late1
kf_kernel_late2:
v_mfma_f32_16x16x32_bf16 v[48:51], v[10:13], v[68:71], v[128:131]
v_mfma_f32_16x16x32_bf16 v[48:51], v[10:13], v[72:75], v[48:51]
v_mfma_f32_16x16x32_bf16 v[48:51], v[10:13], v[76:79], v[48:51]
v_mfma_f32_16x16x32_bf16 v[52:55], v[8:11], v[68:71], v[132:135]
v_mfma_f32_16x16x32_bf16 v[52:55], v[8:11], v[72:75], v[52:55]
v_mfma_f32_16x16x32_bf16 v[52:55], v[8:11], v[76:79], v[52:55]
v_mfma_f32_16x16x32_bf16 v[56:59], v[10:13], v[80:83], v[136:139]
v_mfma_f32_16x16x32_bf16 v[56:59], v[10:13], v[84:87], v[56:59]
v_mfma_f32_16x16x32_bf16 v[56:59], v[10:13], v[88:91], v[56:59]
v_mfma_f32_16x16x32_bf16 v[60:63], v[8:11], v[80:83], v[140:143]
v_mfma_f32_16x16x32_bf16 v[60:63], v[8:11], v[84:87], v[60:63]
v_mfma_f32_16x16x32_bf16 v[60:63], v[8:11], v[88:91], v[60:63]
v_mfma_f32_16x16x32_bf16 v[64:67], v[10:13], v[92:95], v[144:147]
v_mfma_f32_16x16x32_bf16 v[64:67], v[8:11], v[92:95], v[64:67]
v_mfma_f32_16x16x32_bf16 v[64:67], v[8:11], v[94:97], v[64:67]
v_cvt_pk_bf16_f32 v168, v48, v49
v_cvt_pk_bf16_f32 v169, v50, v51
v_cvt_pk_bf16_f32 v172, v52, v53
v_cvt_pk_bf16_f32 v173, v54, v55
v_cvt_pk_bf16_f32 v176, v56, v57
v_cvt_pk_bf16_f32 v177, v58, v59
v_cvt_pk_bf16_f32 v180, v60, v61
v_cvt_pk_bf16_f32 v181, v62, v63
v_cvt_pk_bf16_f32 v184, v64, v65
v_cvt_pk_bf16_f32 v185, v66, v67
buffer_store_dwordx2 v[168:169], v25, s[16:19], s15 offen offset:0
buffer_store_dwordx2 v[172:173], v25, s[16:19], s15 offen offset:32
buffer_store_dwordx2 v[176:177], v25, s[16:19], s15 offen offset:64
buffer_store_dwordx2 v[180:181], v25, s[16:19], s15 offen offset:96
s_branch kf_kernel_out
kf_kernel_ylate:
s_mov_b32 s101, 0x40000
kf_kernel_ylate1:
s_xor_b32 s3, s2, 1
s_lshl2_add_u32 s3, s3, s20
s_mul_i32 s3, s3, 13312
s_add_u32 s3, s3, 83894272
buffer_load_dwordx4 v[36:39], v4, s[40:43], s3 offen offset:0 sc1
buffer_load_dwordx4 v[40:43], v4, s[40:43], s3 offen offset:1024 sc1
buffer_load_dwordx4 v[112:115], v4, s[40:43], s3 offen offset:2048 sc1
s_add_u32 s3, s3, s52
buffer_load_dwordx4 v[116:119], v4, s[40:43], s3 offen offset:3072 sc1
s_waitcnt vmcnt(0)
v_max_u32 v1, v36, v37
v_max3_u32 v1, v1, v38, v39
v_max3_u32 v1, v1, v40, v41
v_max3_u32 v1, v1, v42, v43
v_max3_u32 v1, v1, v112, v113
v_max3_u32 v1, v1, v114, v115
v_max3_u32 v1, v1, v116, v117
v_max3_u32 v1, v1, v118, v119
v_cmp_eq_u32 vcc, -1, v1
s_cbranch_vccz kf_kernel_ylate2
s_sub_u32 s101, s101, 1
s_cbranch_scc0 kf_kernel_ylate1
kf_kernel_ylate2:
v_mfma_f32_16x16x32_bf16 v[56:59], v[10:13], v[36:39], v[48:51]
v_mfma_f32_16x16x32_bf16 v[60:63], v[8:11], v[36:39], v[52:55]
v_mfma_f32_16x16x32_bf16 v[72:75], v[10:13], v[40:43], v[64:67]
v_mfma_f32_16x16x32_bf16 v[76:79], v[8:11], v[40:43], v[68:71]
v_mfma_f32_16x16x32_bf16 v[88:91], v[10:13], v[112:115], v[80:83]
v_mfma_f32_16x16x32_bf16 v[92:95], v[8:11], v[112:115], v[84:87]
v_mfma_f32_16x16x32_bf16 v[104:107], v[10:13], v[116:119], v[96:99]
v_mfma_f32_16x16x32_bf16 v[108:111], v[8:11], v[116:119], v[100:103]
s_nop 7
s_branch kf_kernel_yret
kf_kernel_cwb8:
buffer_wbl2 sc1
s_waitcnt vmcnt(0)
s_branch kf_kernel_cwr8
kf_kernel_cwb6:
buffer_wbl2 sc1
s_waitcnt vmcnt(0)
s_branch kf_kernel_cwr6
kf_kernel_spin_bk:
s_mov_b32 s101, 0x40000
kf_kernel_spinl_bk:
buffer_load_dword v30, off, s[60:63], 0 sc1
s_waitcnt vmcnt(0)
v_cmp_gt_u32 vcc, 4, v30
s_cmp_lg_u64 vcc, 0
s_cbranch_scc0 kf_kernel_ret_bk
s_sub_u32 s101, s101, 1
s_cbranch_scc0 kf_kernel_spinl_bk
s_branch kf_kernel_ret_bk
kf_kernel_spin_xnk:
s_mov_b32 s101, 0x40000
kf_kernel_spinl_xnk:
v_and_b32 v20, 7, v0
v_lshlrev_b32 v20, 8, v20
s_mov_b32 s55, 3174400
buffer_load_dword v30, v20, s[48:51], s55 offen sc1
s_waitcnt vmcnt(0)
v_and_b32 v1, 63, v30
v_cmp_gt_u32 vcc, 32, v1
s_cmp_lg_u64 vcc, 0
s_cbranch_scc0 kf_kernel_ret_xnk
s_sub_u32 s101, s101, 1
s_cbranch_scc0 kf_kernel_spinl_xnk
s_branch kf_kernel_ret_xnk
kf_kernel_spin_bv:
s_mov_b32 s101, 0x40000
kf_kernel_spinl_bv:
buffer_load_dword v30, off, s[60:63], 0 sc1
s_waitcnt vmcnt(0)
v_cmp_gt_u32 vcc, 4, v30
s_cmp_lg_u64 vcc, 0
s_cbranch_scc0 kf_kernel_ret_bv
s_sub_u32 s101, s101, 1
s_cbranch_scc0 kf_kernel_spinl_bv
s_branch kf_kernel_ret_bv
kf_kernel_spin_xnv:
s_mov_b32 s101, 0x40000
kf_kernel_spinl_xnv:
v_and_b32 v20, 7, v0
v_lshlrev_b32 v20, 8, v20
s_mov_b32 s55, 3174400
buffer_load_dword v30, v20, s[48:51], s55 offen sc1
s_waitcnt vmcnt(0)
v_and_b32 v1, 63, v30
v_cmp_gt_u32 vcc, 32, v1
s_cmp_lg_u64 vcc, 0
s_cbranch_scc0 kf_kernel_ret_xnv
s_sub_u32 s101, s101, 1
s_cbranch_scc0 kf_kernel_spinl_xnv
s_branch kf_kernel_ret_xnv
kf_kernel_spin_kv:
s_mov_b32 s101, 0x40000
kf_kernel_spinl_kv:
buffer_load_dword v30, off, s[48:51], s52 sc1
s_waitcnt vmcnt(0)
v_cmp_gt_u32 vcc, 16, v30
s_cmp_lg_u64 vcc, 0
s_cbranch_scc0 kf_kernel_ret_kv
s_sub_u32 s101, s101, 1
s_cbranch_scc0 kf_kernel_spinl_kv
s_branch kf_kernel_ret_kv
kf_kernel_spin_wf8:
s_mov_b32 s101, 0x40000
kf_kernel_spinl_wf8:
v_lshrrev_b32 v2, 2, v0
v_lshlrev_b32 v2, 8, v2
s_mov_b32 s3, 3145728
buffer_load_dword v30, v2, s[40:43], s3 offen sc1
s_waitcnt vmcnt(0)
v_cmp_gt_u32 vcc, 16, v30
s_cmp_lg_u64 vcc, 0
s_cbranch_scc0 kf_kernel_ret_wf8
s_sub_u32 s101, s101, 1
s_cbranch_scc0 kf_kernel_spinl_wf8
s_branch kf_kernel_ret_wf8
kf_kernel_spin_ctx8:
s_mov_b32 s101, 0x40000
kf_kernel_spinl_ctx8:
buffer_load_dword v30, v44, s[40:43], s39 offen sc1
s_waitcnt vmcnt(0)
v_cmp_gt_u32 vcc, 8, v30
s_cmp_lg_u64 vcc, 0
s_cbranch_scc0 kf_kernel_ret_ctx8
s_sub_u32 s101, s101, 1
s_cbranch_scc0 kf_kernel_spinl_ctx8
s_branch kf_kernel_ret_ctx8
kf_kernel_spin_wf6:
s_mov_b32 s101, 0x40000
kf_kernel_spinl_wf6:
v_lshrrev_b32 v2, 2, v0
v_lshlrev_b32 v2, 8, v2
s_mov_b32 s3, 3145728
buffer_load_dword v30, v2, s[40:43], s3 offen sc1
s_waitcnt vmcnt(0)
v_cmp_gt_u32 vcc, 16, v30
s_cmp_lg_u64 vcc, 0
s_cbranch_scc0 kf_kernel_ret_wf6
s_sub_u32 s101, s101, 1
s_cbranch_scc0 kf_kernel_spinl_wf6
s_branch kf_kernel_ret_wf6
kf_kernel_spin_ctx6:
s_mov_b32 s101, 0x40000
kf_kernel_spinl_ctx6:
buffer_load_dword v30, v44, s[40:43], s39 offen sc1
s_waitcnt vmcnt(0)
v_cmp_gt_u32 vcc, 8, v30
s_cmp_lg_u64 vcc, 0
s_cbranch_scc0 kf_kernel_ret_ctx6
s_sub_u32 s101, s101, 1
s_cbranch_scc0 kf_kernel_spinl_ctx6
s_branch kf_kernel_ret_ctx6
kf_kernel_spin_u:
s_mov_b32 s101, 0x40000
kf_kernel_spinl_u:
buffer_load_dword v30, v46, s[40:43], s54 offen sc1
s_waitcnt vmcnt(0)
v_cmp_gt_u32 vcc, 16, v30
s_cmp_lg_u64 vcc, 0
s_cbranch_scc0 kf_kernel_ret_u
s_sub_u32 s101, s101, 1
s_cbranch_scc0 kf_kernel_spinl_u
s_branch kf_kernel_ret_u
kf_kernel_pd18:
s_branch kf_kernel_pd25
kf_kernel_sw_loopB1:
s_cmp_eq_u32 s61, 128
s_cbranch_scc1 kf_kernel_drain
kf_kernel_sv_loopB1:
s_sub_u32 s59, s35, 640
s_add_u32 s8, s44, s59
s_addc_u32 s9, s45, 0
s_sub_u32 s10, s46, s59
s_cselect_b32 s10, 0, s10
s_mov_b32 s61, 128
s_mov_b32 s36, 640
v_mov_b32 v6, v21
v_mov_b32 v7, v22
v_mov_b32 v28, v23
v_mov_b32 v31, v24
s_branch kf_kernel_loopB1
kf_kernel_pd19:
s_branch kf_kernel_pd26
kf_kernel_sw_preA0:
s_cmp_eq_u32 s61, 128
s_cbranch_scc1 kf_kernel_drain
kf_kernel_sv_preA0:
s_sub_u32 s59, s35, 640
s_add_u32 s8, s44, s59
s_addc_u32 s9, s45, 0
s_sub_u32 s10, s46, s59
s_cselect_b32 s10, 0, s10
s_mov_b32 s61, 128
s_mov_b32 s36, 640
v_mov_b32 v6, v21
v_mov_b32 v7, v22
v_mov_b32 v28, v23
v_mov_b32 v31, v24
s_branch kf_kernel_preA0
kf_kernel_sw_enA0:
s_cmp_eq_u32 s61, 128
s_cbranch_scc1 kf_kernel_drain
kf_kernel_sv_enA0:
s_sub_u32 s59, s35, 640
s_add_u32 s8, s44, s59
s_addc_u32 s9, s45, 0
s_sub_u32 s10, s46, s59
s_cselect_b32 s10, 0, s10
s_mov_b32 s61, 128
s_mov_b32 s36, 640
v_mov_b32 v6, v21
v_mov_b32 v7, v22
v_mov_b32 v28, v23
v_mov_b32 v31, v24
s_branch kf_kernel_enA0
kf_kernel_sw_diagA1:
s_cmp_eq_u32 s61, 128
s_cbranch_scc1 kf_kernel_drain
kf_kernel_sv_diagA1:
s_sub_u32 s59, s35, 640
s_add_u32 s8, s44, s59
s_addc_u32 s9, s45, 0
s_sub_u32 s10, s46, s59
s_cselect_b32 s10, 0, s10
s_mov_b32 s61, 128
s_mov_b32 s36, 640
v_mov_b32 v6, v21
v_mov_b32 v7, v22
v_mov_b32 v28, v23
v_mov_b32 v31, v24
s_branch kf_kernel_diagA1
kf_kernel_pd20:
s_branch kf_kernel_pd31
kf_kernel_sw_loopAB1:
s_cmp_eq_u32 s61, 128
s_cbranch_scc1 kf_kernel_drain
kf_kernel_sv_loopAB1:
s_sub_u32 s59, s35, 640
s_add_u32 s8, s44, s59
s_addc_u32 s9, s45, 0
s_sub_u32 s10, s46, s59
s_cselect_b32 s10, 0, s10
s_mov_b32 s61, 128
s_mov_b32 s36, 640
v_mov_b32 v6, v21
v_mov_b32 v7, v22
v_mov_b32 v28, v23
v_mov_b32 v31, v24
s_branch kf_kernel_loopAB1
kf_kernel_pd21:
s_branch kf_kernel_pd27
kf_kernel_hB:
s_cmp_gt_u32 s27, 4
s_cbranch_scc1 kf_kernel_hBw
kf_kernel_hBv:
s_cmp_eq_u32 s27, 1
s_cbranch_scc1 kf_kernel_hB1
s_cmp_eq_u32 s27, 2
s_cbranch_scc1 kf_kernel_hB2
s_cmp_eq_u32 s27, 3
s_cbranch_scc1 kf_kernel_hB3
s_cmp_eq_u32 s27, 4
s_cbranch_scc1 kf_kernel_hB4
kf_kernel_hB0:
v_mfma_f32_16x16x32_bf16 v[88:91], a[64:67], a[16:19], v[36:39]
s_waitcnt vmcnt(16) lgkmcnt(0)
s_barrier
v_mfma_f32_16x16x32_bf16 v[88:91], a[68:71], a[20:23], v[88:91]
s_add_u32 s27, s27, 1
v_exp_f32 v83, v83
v_mfma_f32_16x16x32_bf16 v[88:91], a[72:75], a[24:27], v[88:91]
s_lshl2_add_u32 s15, s2, s20
ds_read_b128 a[64:67], v5 offset:0
ds_read_b128 a[68:71], v5 offset:1024
buffer_load_dwordx4 v6, s[8:11], s36 offen offset:0 sc1 lds
v_mfma_f32_16x16x32_bf16 v[88:91], a[76:79], a[28:31], v[88:91]
s_sub_u32 s15, 1023, s15
s_add_u32 s26, s39, 65536
ds_read_b128 a[72:75], v5 offset:2048
ds_read_b128 a[76:79], v5 offset:3072
v_exp_f32 v84, v84
v_mfma_f32_16x16x32_bf16 v[92:95], a[80:83], a[16:19], v[36:39]
s_min_u32 s59, s26, s32
s_sub_u32 s59, s59, s39
ds_read_b128 a[80:83], v5 offset:4096
v_mfma_f32_16x16x32_bf16 v[92:95], a[84:87], a[20:23], v[92:95]
s_lshl_b32 s59, s59, 9
v_exp_f32 v82, v82
v_mfma_f32_16x16x32_bf16 v[92:95], a[88:91], a[24:27], v[92:95]
s_mul_i32 s14, s15, 52429
ds_read_b128 a[84:87], v5 offset:5120
buffer_load_dwordx4 v7, s[8:11], s36 offen offset:1024 sc1 lds
v_mfma_f32_16x16x32_bf16 v[92:95], a[92:95], a[28:31], v[92:95]
s_lshr_b32 s14, s14, 18
ds_read_b128 a[88:91], v5 offset:6144
v_exp_f32 v86, v86
v_mfma_f32_16x16x32_bf16 v[160:163], a[112:115], v[60:63], v[160:163]
s_lshl_b32 s15, s15, 8
ds_read_b128 a[92:95], v5 offset:7168
ds_read_b128 a[112:115], v5 offset:12288
buffer_load_dwordx4 v28, s[8:11], s36 offen offset:2048 sc1 lds
v_mfma_f32_16x16x32_bf16 v[160:163], a[96:99], v[56:59], v[160:163]
s_mul_i32 s18, s14, 24576
v_accvgpr_write_b32 a163, -1
v_exp_f32 v85, v85
v_mfma_f32_16x16x32_bf16 v[164:167], a[116:119], v[60:63], v[164:167]
s_mul_i32 s14, s14, 39680
v_exp_f32 v81, v81
v_mfma_f32_16x16x32_bf16 v[164:167], a[100:103], v[56:59], v[164:167]
s_add_u32 s14, s14, s15
v_exp_f32 v90, v90
v_mfma_f32_16x16x32_bf16 v[168:171], a[120:123], v[60:63], v[168:171]
s_lshl2_add_u32 s34, s2, s20
ds_read_b128 a[96:99], v5 offset:8192
v_exp_f32 v80, v80
v_mfma_f32_16x16x32_bf16 v[168:171], a[104:107], v[56:59], v[168:171]
s_sub_u32 s39, s39, s59
ds_read_b128 a[116:119], v5 offset:13312
ds_read_b128 a[100:103], v5 offset:9216
v_mfma_f32_16x16x32_bf16 v[172:175], a[124:127], v[60:63], v[172:175]
s_lshl_b32 s15, s15, 5
ds_read_b128 a[120:123], v5 offset:14336
ds_read_b128 a[104:107], v5 offset:10240
v_mfma_f32_16x16x32_bf16 v[172:175], a[108:111], v[56:59], v[172:175]
s_waitcnt lgkmcnt(10)
v_accvgpr_write_b32 a161, -1
v_exp_f32 v87, v87
v_cvt_pk_bf16_f32 v53, v82, v83
v_cvt_pk_bf16_f32 v52, v80, v81
v_mfma_f32_16x16x32_bf16 v[80:83], a[64:67], a[0:3], v[32:35]
s_waitcnt lgkmcnt(6)
buffer_load_dwordx4 v31, s[8:11], s36 offen offset:3072 sc1 lds
v_mfma_f32_16x16x32_bf16 v[80:83], a[68:71], a[4:7], v[80:83]
s_add_u32 s15, s15, s18
v_accvgpr_write_b32 a162, -1
v_cvt_pk_bf16_f32 v55, v86, v87
v_mfma_f32_16x16x32_bf16 v[80:83], a[72:75], a[8:11], v[80:83]
s_sub_u32 s36, s36, s61
v_exp_f32 v91, v91
v_mfma_f32_16x16x32_bf16 v[80:83], a[76:79], a[12:15], v[80:83]
s_bitset1_b32 m0, 14
v_cvt_pk_bf16_f32 v54, v84, v85
v_accvgpr_write_b32 a160, -1
v_mfma_f32_16x16x32_bf16 v[84:87], a[80:83], a[0:3], v[32:35]
s_mul_i32 s34, s34, 13312
v_exp_f32 v95, v95
v_mfma_f32_16x16x32_bf16 v[84:87], a[84:87], a[4:7], v[84:87]
s_cmp_ge_u32 s15, 8388608
ds_read_b128 a[124:127], v5 offset:15360
ds_read_b128 a[108:111], v5 offset:11264
v_mfma_f32_16x16x32_bf16 v[84:87], a[88:91], a[8:11], v[84:87]
s_waitcnt lgkmcnt(4)
buffer_load_dwordx4 v6, s[8:11], s36 offen offset:0 sc1 lds
v_mfma_f32_16x16x32_bf16 v[84:87], a[92:95], a[12:15], v[84:87]
s_mov_b32 s18, 5242880
v_exp_f32 v93, v93
v_bfe_u32 v1, v0, 1, 5
v_smfmac_f32_16x16x64_bf16 a[240:243], v[112:115], v[48:55], v19
s_cselect_b32 s18, 1105920, s18
v_exp_f32 v92, v92
v_mfma_f32_16x16x32_bf16 v[144:147], a[96:99], v[48:51], v[144:147]
s_cselect_b32 s17, s13, s17
v_exp_f32 v89, v89
v_mfma_f32_16x16x32_bf16 v[144:147], a[112:115], v[52:55], v[144:147]
s_cselect_b32 s16, s12, s16
v_exp_f32 v94, v94
v_mfma_f32_16x16x32_bf16 v[148:151], a[100:103], v[48:51], v[148:151]
s_cselect_b32 s12, 5242880, 0
v_exp_f32 v84, v84
v_mfma_f32_16x16x32_bf16 v[148:151], a[116:119], v[52:55], v[148:151]
s_waitcnt lgkmcnt(0)
v_exp_f32 v82, v82
v_mfma_f32_16x16x32_bf16 v[152:155], a[104:107], v[48:51], v[152:155]
s_add_u32 s34, s34, 83886080
v_exp_f32 v88, v88
v_mfma_f32_16x16x32_bf16 v[152:155], a[120:123], v[52:55], v[152:155]
buffer_store_dwordx4 a[160:163], v4, s[40:43], s34 offen offset:0 sc1
buffer_load_dwordx4 v7, s[8:11], s36 offen offset:1024 sc1 lds
v_mfma_f32_16x16x32_bf16 v[156:159], a[108:111], v[48:51], v[156:159]
s_mov_b32 s19, 0x20000
v_exp_f32 v81, v81
v_cvt_pk_bf16_f32 v60, v88, v89
v_mfma_f32_16x16x32_bf16 v[156:159], a[124:127], v[52:55], v[156:159]
s_lshr_b32 s60, s37, 4
v_exp_f32 v83, v83
v_cvt_pk_bf16_f32 v61, v90, v91
v_mfma_f32_16x16x32_bf16 v[88:91], a[64:67], a[16:19], v[36:39]
s_sub_u32 s3, 15, s60
v_cvt_pk_bf16_f32 v62, v92, v93
v_cvt_pk_bf16_f32 v63, v94, v95
v_mfma_f32_16x16x32_bf16 v[88:91], a[68:71], a[20:23], v[88:91]
s_min_u32 s60, s60, s3
ds_read_b128 a[64:67], v5 offset:16384
ds_read_b128 a[68:71], v5 offset:17408
buffer_store_dwordx4 a[160:163], v4, s[40:43], s34 offen offset:1024 sc1
v_mfma_f32_16x16x32_bf16 v[88:91], a[72:75], a[24:27], v[88:91]
s_bfe_u32 s3, s37, 0x20002
ds_read_b128 a[72:75], v5 offset:18432
v_cvt_pk_bf16_f32 v49, v82, v83
v_mfma_f32_16x16x32_bf16 v[88:91], a[76:79], a[28:31], v[88:91]
s_lshl_b32 s60, s60, 2
v_exp_f32 v86, v86
v_mfma_f32_16x16x32_bf16 v[92:95], a[80:83], a[16:19], v[36:39]
s_add_u32 s60, s60, s3
ds_read_b128 a[76:79], v5 offset:19456
ds_read_b128 a[80:83], v5 offset:20480
v_mfma_f32_16x16x32_bf16 v[92:95], a[84:87], a[20:23], v[92:95]
ds_read_b128 a[84:87], v5 offset:21504
buffer_load_dwordx4 v28, s[8:11], s36 offen offset:2048 sc1 lds
v_mfma_f32_16x16x32_bf16 v[92:95], a[88:91], a[24:27], v[92:95]
buffer_store_dwordx4 a[160:163], v4, s[40:43], s34 offen offset:2048 sc1
ds_read_b128 a[88:91], v5 offset:22528
v_mfma_f32_16x16x32_bf16 v[92:95], a[92:95], a[28:31], v[92:95]
ds_read_b128 a[92:95], v5 offset:23552
v_and_b32 v3, 1, v0
v_smfmac_f32_16x16x64_bf16 a[244:247], v[112:115], v[56:63], v19
s_sub_u32 s14, s14, s12
v_exp_f32 v85, v85
v_mfma_f32_16x16x32_bf16 v[176:179], a[96:99], v[56:59], v[176:179]
v_exp_f32 v87, v87
v_mfma_f32_16x16x32_bf16 v[176:179], a[112:115], v[60:63], v[176:179]
s_lshl_b32 s60, s60, 8
ds_read_b128 a[96:99], v5 offset:24576
ds_read_b128 a[112:115], v5 offset:28672
v_mfma_f32_16x16x32_bf16 v[180:183], a[100:103], v[56:59], v[180:183]
v_exp_f32 v80, v80
v_mfma_f32_16x16x32_bf16 v[180:183], a[116:119], v[60:63], v[180:183]
s_waitcnt lgkmcnt(6)
ds_read_b128 a[100:103], v5 offset:25600
ds_read_b128 a[116:119], v5 offset:29696
v_mfma_f32_16x16x32_bf16 v[184:187], a[104:107], v[56:59], v[184:187]
ds_read_b128 a[104:107], v5 offset:26624
v_exp_f32 v88, v88
v_mfma_f32_16x16x32_bf16 v[184:187], a[120:123], v[60:63], v[184:187]
s_add_u32 s60, s60, 3194880
ds_read_b128 a[120:123], v5 offset:30720
buffer_load_dwordx4 v31, s[8:11], s36 offen offset:3072 sc1 lds
v_mfma_f32_16x16x32_bf16 v[188:191], a[108:111], v[56:59], v[188:191]
v_mul_u32_u24 v1, 1280, v1
v_lshl_add_u32 v1, v3, 7, v1
v_mfma_f32_16x16x32_bf16 v[188:191], a[124:127], v[60:63], v[188:191]
s_waitcnt lgkmcnt(6)
ds_read_b128 a[108:111], v5 offset:27648
v_cvt_pk_bf16_f32 v48, v80, v81
v_mfma_f32_16x16x32_bf16 v[80:83], a[64:67], a[0:3], v[32:35]
s_sub_u32 s36, s36, s61
ds_read_b128 a[124:127], v5 offset:31744
buffer_store_dwordx4 a[160:163], v4, s[40:43], s34 offen offset:3072 sc1
v_mfma_f32_16x16x32_bf16 v[80:83], a[68:71], a[4:7], v[80:83]
v_exp_f32 v94, v94
v_mfma_f32_16x16x32_bf16 v[80:83], a[72:75], a[8:11], v[80:83]
s_waitcnt lgkmcnt(4)
v_exp_f32 v90, v90
v_mfma_f32_16x16x32_bf16 v[80:83], a[76:79], a[12:15], v[80:83]
v_cvt_pk_bf16_f32 v51, v86, v87
v_cvt_pk_bf16_f32 v50, v84, v85
v_mfma_f32_16x16x32_bf16 v[84:87], a[80:83], a[0:3], v[32:35]
buffer_load_dword v30, off, s[40:43], s60 sc1
v_mfma_f32_16x16x32_bf16 v[84:87], a[84:87], a[4:7], v[84:87]
v_exp_f32 v93, v93
v_mfma_f32_16x16x32_bf16 v[84:87], a[88:91], a[8:11], v[84:87]
v_exp_f32 v91, v91
v_mfma_f32_16x16x32_bf16 v[84:87], a[92:95], a[12:15], v[84:87]
v_lshrrev_b32 v3, 6, v0
v_exp_f32 v92, v92
v_mfma_f32_16x16x32_bf16 v[128:131], a[112:115], v[52:55], v[128:131]
buffer_load_dword a238, v1, s[16:19], s14 offen
v_mfma_f32_16x16x32_bf16 v[128:131], a[96:99], v[48:51], v[128:131]
s_waitcnt lgkmcnt(0)
v_exp_f32 v89, v89
v_mfma_f32_16x16x32_bf16 v[132:135], a[116:119], v[52:55], v[132:135]
v_exp_f32 v95, v95
v_mfma_f32_16x16x32_bf16 v[132:135], a[100:103], v[48:51], v[132:135]
v_cvt_pk_bf16_f32 v57, v90, v91
v_cvt_pk_bf16_f32 v58, v92, v93
v_cvt_pk_bf16_f32 v59, v94, v95
v_mfma_f32_16x16x32_bf16 v[136:139], a[120:123], v[52:55], v[136:139]
s_and_b32 m0, s39, 0x1ffff
v_lshl_add_u32 v3, v3, 8, s2
v_mul_u32_u24 v3, 2560, v3
v_mfma_f32_16x16x32_bf16 v[136:139], a[104:107], v[48:51], v[136:139]
global_load_dword a237, v3, s[86:87]
v_mfma_f32_16x16x32_bf16 v[140:143], a[124:127], v[52:55], v[140:143]
s_add_u32 s39, s39, 0x1008000
v_and_or_b32 v5, s39, v20, v4
v_cvt_pk_bf16_f32 v56, v88, v89
v_mfma_f32_16x16x32_bf16 v[140:143], a[108:111], v[48:51], v[140:143]
s_cbranch_scc0 kf_kernel_loopB
s_branch kf_kernel_loopBx
kf_kernel_hB1:
v_and_b32 v3, 31, v0
v_cmp_gt_u32 vcc, 12, v3
v_mfma_f32_16x16x32_bf16 v[88:91], a[64:67], a[16:19], v[36:39]
s_waitcnt vmcnt(16) lgkmcnt(0)
s_barrier
ds_read_b128 a[64:67], v5 offset:0
v_lshrrev_b32 v1, 5, v0
v_mfma_f32_16x16x32_bf16 v[88:91], a[68:71], a[20:23], v[88:91]
s_mul_i32 s3, s37, 13824
ds_read_b128 a[68:71], v5 offset:1024
v_mul_u32_u24 v1, 1728, v1
v_lshl_add_u32 v21, v3, 4, v1
v_mfma_f32_16x16x32_bf16 v[88:91], a[72:75], a[24:27], v[88:91]
s_add_u32 s3, s3, 46137344
ds_read_b128 a[72:75], v5 offset:2048
v_mov_b32 v1, 1073741824
v_cndmask_b32 v22, v1, v21, vcc
s_waitcnt vmcnt(10)
v_cmp_gt_u32 vcc, 27, v30
v_mfma_f32_16x16x32_bf16 v[88:91], a[76:79], a[28:31], v[88:91]
s_cmp_lg_u64 vcc, 0
ds_read_b128 a[76:79], v5 offset:3072
s_cbranch_scc1 kf_kernel_spin_zB
kf_kernel_ret_zB:
v_exp_f32 v80, v80
v_mfma_f32_16x16x32_bf16 v[92:95], a[80:83], a[16:19], v[36:39]
buffer_load_dwordx4 v[116:119], v21, s[40:43], s3 offen offset:0 sc1
ds_read_b128 a[80:83], v5 offset:4096
v_mfma_f32_16x16x32_bf16 v[92:95], a[84:87], a[20:23], v[92:95]
v_exp_f32 v83, v83
v_mfma_f32_16x16x32_bf16 v[92:95], a[88:91], a[24:27], v[92:95]
ds_read_b128 a[84:87], v5 offset:5120
ds_read_b128 a[88:91], v5 offset:6144
v_mfma_f32_16x16x32_bf16 v[92:95], a[92:95], a[28:31], v[92:95]
ds_read_b128 a[92:95], v5 offset:7168
buffer_load_dwordx4 v[120:123], v21, s[40:43], s3 offen offset:512 sc1
v_mfma_f32_16x16x32_bf16 v[160:163], a[112:115], v[60:63], v[160:163]
v_exp_f32 v82, v82
v_exp_f32 v85, v85
v_and_b32 v3, 15, v0
v_mfma_f32_16x16x32_bf16 v[160:163], a[96:99], v[56:59], v[160:163]
ds_read_b128 a[112:115], v5 offset:12288
ds_read_b128 a[96:99], v5 offset:8192
v_exp_f32 v94, v94
v_mfma_f32_16x16x32_bf16 v[164:167], a[116:119], v[60:63], v[164:167]
ds_read_b128 a[116:119], v5 offset:13312
buffer_load_dwordx4 v[124:127], v21, s[40:43], s3 offen offset:1024 sc1
v_cvt_pk_bf16_f32 v53, v82, v83
v_exp_f32 v81, v81
v_mfma_f32_16x16x32_bf16 v[164:167], a[100:103], v[56:59], v[164:167]
s_waitcnt lgkmcnt(7)
v_cvt_pk_bf16_f32 v52, v80, v81
v_exp_f32 v86, v86
v_mfma_f32_16x16x32_bf16 v[168:171], a[120:123], v[60:63], v[168:171]
buffer_load_dwordx4 v[24:27], v22, s[40:43], s3 offen offset:1536 sc1
ds_read_b128 a[100:103], v5 offset:9216
v_mfma_f32_16x16x32_bf16 v[168:171], a[104:107], v[56:59], v[168:171]
s_lshr_b32 s3, s23, 1
v_exp_f32 v84, v84
v_mfma_f32_16x16x32_bf16 v[172:175], a[124:127], v[60:63], v[172:175]
ds_read_b128 a[120:123], v5 offset:14336
ds_read_b128 a[104:107], v5 offset:10240
ds_read_b128 a[124:127], v5 offset:15360
v_mfma_f32_16x16x32_bf16 v[172:175], a[108:111], v[56:59], v[172:175]
buffer_load_dwordx4 v6, s[8:11], s36 offen offset:0 sc1 lds
ds_read_b128 a[108:111], v5 offset:11264
v_mfma_f32_16x16x32_bf16 v[80:83], a[64:67], a[0:3], v[32:35]
v_exp_f32 v92, v92
v_mfma_f32_16x16x32_bf16 v[80:83], a[68:71], a[4:7], v[80:83]
s_and_b32 s29, s23, 1
v_exp_f32 v89, v89
v_mfma_f32_16x16x32_bf16 v[80:83], a[72:75], a[8:11], v[80:83]
v_exp_f32 v87, v87
v_mfma_f32_16x16x32_bf16 v[80:83], a[76:79], a[12:15], v[80:83]
s_waitcnt lgkmcnt(8)
v_cvt_pk_bf16_f32 v55, v86, v87
v_cvt_pk_bf16_f32 v54, v84, v85
v_mfma_f32_16x16x32_bf16 v[84:87], a[80:83], a[0:3], v[32:35]
v_exp_f32 v93, v93
v_mfma_f32_16x16x32_bf16 v[84:87], a[84:87], a[4:7], v[84:87]
buffer_load_dwordx4 v7, s[8:11], s36 offen offset:1024 sc1 lds
v_mfma_f32_16x16x32_bf16 v[84:87], a[88:91], a[8:11], v[84:87]
s_waitcnt lgkmcnt(4)
buffer_load_dwordx4 v28, s[8:11], s36 offen offset:2048 sc1 lds
v_mfma_f32_16x16x32_bf16 v[84:87], a[92:95], a[12:15], v[84:87]
v_exp_f32 v95, v95
v_smfmac_f32_16x16x64_bf16 a[240:243], v[112:115], v[48:55], v19
s_waitcnt lgkmcnt(0)
v_exp_f32 v88, v88
v_mfma_f32_16x16x32_bf16 v[144:147], a[96:99], v[48:51], v[144:147]
buffer_load_dwordx4 v31, s[8:11], s36 offen offset:3072 sc1 lds
v_mfma_f32_16x16x32_bf16 v[144:147], a[112:115], v[52:55], v[144:147]
s_lshl_b32 s3, s3, 5
v_bfe_u32 v2, v0, 4, 4
v_exp_f32 v91, v91
v_mfma_f32_16x16x32_bf16 v[148:151], a[100:103], v[48:51], v[148:151]
v_cvt_pk_bf16_f32 v60, v88, v89
v_cvt_pk_bf16_f32 v63, v94, v95
v_mfma_f32_16x16x32_bf16 v[148:151], a[116:119], v[52:55], v[148:151]
v_lshlrev_b32 v2, 12, v2
v_exp_f32 v90, v90
v_mfma_f32_16x16x32_bf16 v[152:155], a[104:107], v[48:51], v[152:155]
s_sub_u32 s36, s36, s61
v_cvt_pk_bf16_f32 v61, v90, v91
v_cvt_pk_bf16_f32 v62, v92, v93
v_mfma_f32_16x16x32_bf16 v[152:155], a[120:123], v[52:55], v[152:155]
s_bitset1_b32 m0, 14
v_exp_f32 v80, v80
v_mfma_f32_16x16x32_bf16 v[156:159], a[108:111], v[48:51], v[156:159]
s_add_u32 s3, s3, s24
v_exp_f32 v84, v84
v_mfma_f32_16x16x32_bf16 v[156:159], a[124:127], v[52:55], v[156:159]
buffer_load_dwordx4 v6, s[8:11], s36 offen offset:0 sc1 lds
v_mfma_f32_16x16x32_bf16 v[88:91], a[64:67], a[16:19], v[36:39]
buffer_load_dwordx4 v7, s[8:11], s36 offen offset:1024 sc1 lds
v_mfma_f32_16x16x32_bf16 v[88:91], a[68:71], a[20:23], v[88:91]
s_add_u32 s27, s27, 1
ds_read_b128 a[64:67], v5 offset:16384
ds_read_b128 a[68:71], v5 offset:17408
v_mfma_f32_16x16x32_bf16 v[88:91], a[72:75], a[24:27], v[88:91]
s_lshl_b32 s3, s3, 5
ds_read_b128 a[72:75], v5 offset:18432
v_exp_f32 v85, v85
v_mfma_f32_16x16x32_bf16 v[88:91], a[76:79], a[28:31], v[88:91]
buffer_load_dwordx4 v28, s[8:11], s36 offen offset:2048 sc1 lds
v_mfma_f32_16x16x32_bf16 v[92:95], a[80:83], a[16:19], v[36:39]
ds_read_b128 a[76:79], v5 offset:19456
ds_read_b128 a[80:83], v5 offset:20480
v_mfma_f32_16x16x32_bf16 v[92:95], a[84:87], a[20:23], v[92:95]
buffer_load_dwordx4 v31, s[8:11], s36 offen offset:3072 sc1 lds
v_mfma_f32_16x16x32_bf16 v[92:95], a[88:91], a[24:27], v[92:95]
ds_read_b128 a[84:87], v5 offset:21504
ds_read_b128 a[88:91], v5 offset:22528
v_mfma_f32_16x16x32_bf16 v[92:95], a[92:95], a[28:31], v[92:95]
ds_read_b128 a[92:95], v5 offset:23552
v_lshl_add_u32 v2, v3, 7, v2
v_smfmac_f32_16x16x64_bf16 a[244:247], v[112:115], v[56:63], v19
v_exp_f32 v83, v83
v_mfma_f32_16x16x32_bf16 v[176:179], a[96:99], v[56:59], v[176:179]
s_add_u32 s3, s3, s29
v_exp_f32 v82, v82
v_mfma_f32_16x16x32_bf16 v[176:179], a[112:115], v[60:63], v[176:179]
s_lshl_b32 s3, s3, 11
ds_read_b128 a[96:99], v5 offset:24576
ds_read_b128 a[112:115], v5 offset:28672
v_mfma_f32_16x16x32_bf16 v[180:183], a[100:103], v[56:59], v[180:183]
v_exp_f32 v81, v81
v_mfma_f32_16x16x32_bf16 v[180:183], a[116:119], v[60:63], v[180:183]
buffer_load_dword a239, v2, s[44:47], s3 offen
v_mfma_f32_16x16x32_bf16 v[184:187], a[104:107], v[56:59], v[184:187]
ds_read_b128 a[100:103], v5 offset:25600
ds_read_b128 a[116:119], v5 offset:29696
v_mfma_f32_16x16x32_bf16 v[184:187], a[120:123], v[60:63], v[184:187]
v_exp_f32 v88, v88
v_mfma_f32_16x16x32_bf16 v[188:191], a[108:111], v[56:59], v[188:191]
s_waitcnt lgkmcnt(8)
ds_read_b128 a[104:107], v5 offset:26624
ds_read_b128 a[120:123], v5 offset:30720
v_mfma_f32_16x16x32_bf16 v[188:191], a[124:127], v[60:63], v[188:191]
s_add_u32 s26, s39, 32768
v_cvt_pk_bf16_f32 v49, v82, v83
v_cvt_pk_bf16_f32 v48, v80, v81
v_mfma_f32_16x16x32_bf16 v[80:83], a[64:67], a[0:3], v[32:35]
ds_read_b128 a[108:111], v5 offset:27648
ds_read_b128 a[124:127], v5 offset:31744
v_mfma_f32_16x16x32_bf16 v[80:83], a[68:71], a[4:7], v[80:83]
s_waitcnt lgkmcnt(8)
v_exp_f32 v86, v86
v_mfma_f32_16x16x32_bf16 v[80:83], a[72:75], a[8:11], v[80:83]
v_exp_f32 v87, v87
v_mfma_f32_16x16x32_bf16 v[80:83], a[76:79], a[12:15], v[80:83]
v_cvt_pk_bf16_f32 v50, v84, v85
v_cvt_pk_bf16_f32 v51, v86, v87
v_mfma_f32_16x16x32_bf16 v[84:87], a[80:83], a[0:3], v[32:35]
v_exp_f32 v91, v91
v_mfma_f32_16x16x32_bf16 v[84:87], a[84:87], a[4:7], v[84:87]
s_waitcnt lgkmcnt(4)
v_exp_f32 v95, v95
v_mfma_f32_16x16x32_bf16 v[84:87], a[88:91], a[8:11], v[84:87]
s_min_u32 s59, s26, s32
s_sub_u32 s59, s59, s39
s_sub_u32 s36, s36, s61
v_mfma_f32_16x16x32_bf16 v[84:87], a[92:95], a[12:15], v[84:87]
s_lshl_b32 s59, s59, 9
v_exp_f32 v89, v89
v_mfma_f32_16x16x32_bf16 v[128:131], a[112:115], v[52:55], v[128:131]
s_waitcnt lgkmcnt(0)
v_exp_f32 v94, v94
v_mfma_f32_16x16x32_bf16 v[128:131], a[96:99], v[48:51], v[128:131]
v_exp_f32 v90, v90
v_mfma_f32_16x16x32_bf16 v[132:135], a[116:119], v[52:55], v[132:135]
s_sub_u32 s39, s39, s59
s_and_b32 m0, s39, 0x1ffff
v_cvt_pk_bf16_f32 v59, v94, v95
v_mfma_f32_16x16x32_bf16 v[132:135], a[100:103], v[48:51], v[132:135]
v_exp_f32 v92, v92
v_mfma_f32_16x16x32_bf16 v[136:139], a[120:123], v[52:55], v[136:139]
s_add_u32 s39, s39, 0x1008000
v_exp_f32 v93, v93
v_mfma_f32_16x16x32_bf16 v[136:139], a[104:107], v[48:51], v[136:139]
v_cvt_pk_bf16_f32 v56, v88, v89
v_and_or_b32 v5, s39, v20, v4
v_mfma_f32_16x16x32_bf16 v[140:143], a[124:127], v[52:55], v[140:143]
v_cvt_pk_bf16_f32 v57, v90, v91
v_cvt_pk_bf16_f32 v58, v92, v93
v_mfma_f32_16x16x32_bf16 v[140:143], a[108:111], v[48:51], v[140:143]
s_cbranch_scc0 kf_kernel_loopB
s_branch kf_kernel_loopBx
kf_kernel_hB2:
v_and_b32 v3, 31, v0
v_mfma_f32_16x16x32_bf16 v[88:91], a[64:67], a[16:19], v[36:39]
s_waitcnt vmcnt(16) lgkmcnt(0)
s_barrier
v_lshrrev_b32 v1, 5, v0
v_mfma_f32_16x16x32_bf16 v[88:91], a[68:71], a[20:23], v[88:91]
s_add_u32 s26, s39, 32768
ds_read_b128 a[64:67], v5 offset:0
ds_read_b128 a[68:71], v5 offset:1024
v_mfma_f32_16x16x32_bf16 v[88:91], a[72:75], a[24:27], v[88:91]
ds_read_b128 a[72:75], v5 offset:2048
s_waitcnt vmcnt(9)
v_mfma_f32_16x16x32_bf16 v[88:91], a[76:79], a[28:31], v[88:91]
v_exp_f32 v82, v82
v_mfma_f32_16x16x32_bf16 v[92:95], a[80:83], a[16:19], v[36:39]
s_min_u32 s59, s26, s32
v_exp_f32 v80, v80
v_mfma_f32_16x16x32_bf16 v[92:95], a[84:87], a[20:23], v[92:95]
s_sub_u32 s59, s59, s39
ds_read_b128 a[76:79], v5 offset:3072
ds_read_b128 a[80:83], v5 offset:4096
v_mfma_f32_16x16x32_bf16 v[92:95], a[88:91], a[24:27], v[92:95]
s_mov_b32 s3, 0x3f803f80
ds_read_b128 a[84:87], v5 offset:5120
ds_read_b128 a[88:91], v5 offset:6144
v_mfma_f32_16x16x32_bf16 v[92:95], a[92:95], a[28:31], v[92:95]
s_lshl_b32 s59, s59, 9
ds_read_b128 a[92:95], v5 offset:7168
v_exp_f32 v87, v87
v_exp_f32 v85, v85
v_dot2_f32_bf16 v9, v116, v116, 0
v_exp_f32 v83, v83
v_dot2_f32_bf16 v8, v116, s3, 0
v_dot2_f32_bf16 v11, v117, v117, 0
v_dot2c_f32_bf16 v9, v118, v118
v_dot2_f32_bf16 v10, v117, s3, 0
v_dot2c_f32_bf16 v8, s3, v118
v_dot2c_f32_bf16 v11, v119, v119
v_dot2c_f32_bf16 v9, v120, v120
v_dot2c_f32_bf16 v9, v122, v122
v_dot2c_f32_bf16 v9, v124, v124
v_dot2c_f32_bf16 v8, s3, v120
v_dot2c_f32_bf16 v8, s3, v122
v_dot2c_f32_bf16 v11, v121, v121
v_dot2c_f32_bf16 v11, v123, v123
v_dot2c_f32_bf16 v9, v126, v126
v_cvt_pk_bf16_f32 v53, v82, v83
v_dot2c_f32_bf16 v8, s3, v124
v_dot2c_f32_bf16 v10, s3, v119
v_dot2c_f32_bf16 v11, v125, v125
v_dot2c_f32_bf16 v9, v24, v24
v_dot2c_f32_bf16 v10, s3, v121
v_dot2c_f32_bf16 v10, s3, v123
v_dot2c_f32_bf16 v11, v127, v127
v_dot2c_f32_bf16 v11, v25, v25
v_dot2c_f32_bf16 v9, v26, v26
v_dot2c_f32_bf16 v11, v27, v27
v_exp_f32 v84, v84
v_dot2c_f32_bf16 v10, s3, v125
v_mul_u32_u24 v1, 2112, v1
v_dot2c_f32_bf16 v10, s3, v127
v_dot2c_f32_bf16 v10, s3, v25
v_dot2c_f32_bf16 v8, s3, v126
v_dot2c_f32_bf16 v8, s3, v24
v_exp_f32 v86, v86
v_dot2c_f32_bf16 v10, s3, v27
v_dot2c_f32_bf16 v8, s3, v26
v_mfma_f32_16x16x32_bf16 v[160:163], a[112:115], v[60:63], v[160:163]
v_add_f32 v9, v9, v11
v_cvt_pk_bf16_f32 v55, v86, v87
v_add_f32 v8, v8, v10
v_mfma_f32_16x16x32_bf16 v[160:163], a[96:99], v[56:59], v[160:163]
ds_read_b128 a[112:115], v5 offset:12288
v_exp_f32 v81, v81
v_add_f32_dpp v8, v8, v8 quad_perm:[1,0,3,2] row_mask:0xf bank_mask:0xf
v_mfma_f32_16x16x32_bf16 v[164:167], a[116:119], v[60:63], v[164:167]
ds_read_b128 a[96:99], v5 offset:8192
ds_read_b128 a[116:119], v5 offset:13312
v_lshl_add_u32 v1, v3, 4, v1
v_mfma_f32_16x16x32_bf16 v[164:167], a[100:103], v[56:59], v[164:167]
s_add_u32 s27, s27, 1
ds_read_b128 a[100:103], v5 offset:9216
v_add_f32_dpp v8, v8, v8 quad_perm:[2,3,0,1] row_mask:0xf bank_mask:0xf
v_mfma_f32_16x16x32_bf16 v[168:171], a[120:123], v[60:63], v[168:171]
ds_read_b128 a[120:123], v5 offset:14336
v_add_f32_dpp v8, v8, v8 row_half_mirror row_mask:0xf bank_mask:0xf
v_add_u32 v1, 0x20000, v1
v_add_f32_dpp v9, v9, v9 quad_perm:[1,0,3,2] row_mask:0xf bank_mask:0xf
v_mfma_f32_16x16x32_bf16 v[168:171], a[104:107], v[56:59], v[168:171]
s_sub_u32 s39, s39, s59
ds_read_b128 a[104:107], v5 offset:10240
v_cvt_pk_bf16_f32 v52, v80, v81
v_add_f32_dpp v9, v9, v9 quad_perm:[2,3,0,1] row_mask:0xf bank_mask:0xf
v_add_f32_dpp v8, v8, v8 row_mirror row_mask:0xf bank_mask:0xf
v_mov_b32 v10, v8
v_add_f32_dpp v9, v9, v9 row_half_mirror row_mask:0xf bank_mask:0xf
v_cvt_pk_bf16_f32 v54, v84, v85
v_mfma_f32_16x16x32_bf16 v[172:175], a[124:127], v[60:63], v[172:175]
s_waitcnt lgkmcnt(10)
v_permlane16_swap_b32 v10, v8
v_add_f32 v8, v8, v10
v_add_f32_dpp v9, v9, v9 row_mirror row_mask:0xf bank_mask:0xf
v_mov_b32 v11, v9
v_mfma_f32_16x16x32_bf16 v[172:175], a[108:111], v[56:59], v[172:175]
s_waitcnt lgkmcnt(6)
v_permlane16_swap_b32 v11, v9
v_add_f32 v9, v9, v11
v_mul_f32 v9, 0x3a97b426, v9
v_mfma_f32_16x16x32_bf16 v[80:83], a[64:67], a[0:3], v[32:35]
ds_read_b128 a[124:127], v5 offset:15360
ds_read_b128 a[108:111], v5 offset:11264
v_mfma_f32_16x16x32_bf16 v[80:83], a[68:71], a[4:7], v[80:83]
v_mul_f32 v8, 0x3a97b426, v8
v_exp_f32 v93, v93
v_fma_f32 v9, -v8, v8, v9
v_max_f32 v9, 0, v9
v_cvt_pk_bf16_f32 v9, v9, v9
v_and_b32 v11, 0xffff0000, v116
v_mfma_f32_16x16x32_bf16 v[80:83], a[72:75], a[8:11], v[80:83]
s_waitcnt lgkmcnt(4)
v_and_b32 v17, 0xffff0000, v119
v_and_b32 v9, 0xffff0000, v9
v_add_f32 v9, 0x3727c5ac, v9
v_mfma_f32_16x16x32_bf16 v[80:83], a[76:79], a[12:15], v[80:83]
v_cvt_pk_bf16_f32 v9, v9, v9
v_and_b32 v9, 0xffff0000, v9
v_sqrt_f32 v9, v9
v_mfma_f32_16x16x32_bf16 v[84:87], a[80:83], a[0:3], v[32:35]
v_and_b32 v13, 0xffff0000, v117
v_and_b32 v15, 0xffff0000, v118
v_cvt_pk_bf16_f32 v9, v9, v9
v_mfma_f32_16x16x32_bf16 v[84:87], a[84:87], a[4:7], v[84:87]
v_lshlrev_b32 v16, 16, v119
v_and_b32 v9, 0xffff0000, v9
v_rcp_f32 v9, v9
v_cvt_pk_bf16_f32 v12, v8, v8
v_and_b32 v12, 0xffff0000, v12
v_mul_f32 v8, -v12, v9
s_branch kf_kernel_pl22
kf_kernel_pd22:
s_branch kf_kernel_pd28
kf_kernel_pl22:
v_pk_fma_f32 v[16:17], v[8:9], v[16:17], v[8:9] op_sel:[1,0,0] op_sel_hi:[1,1,0]
v_lshlrev_b32 v10, 16, v116
v_lshlrev_b32 v14, 16, v118
v_pk_fma_f32 v[14:15], v[8:9], v[14:15], v[8:9] op_sel:[1,0,0] op_sel_hi:[1,1,0]
v_cvt_pk_bf16_f32 v118, v14, v15
v_and_b32 v15, 0xffff0000, v122
v_lshlrev_b32 v12, 16, v117
v_pk_fma_f32 v[12:13], v[8:9], v[12:13], v[8:9] op_sel:[1,0,0] op_sel_hi:[1,1,0]
v_cvt_pk_bf16_f32 v119, v16, v17
v_and_b32 v17, 0xffff0000, v123
v_pk_fma_f32 v[10:11], v[8:9], v[10:11], v[8:9] op_sel:[1,0,0] op_sel_hi:[1,1,0]
v_cvt_pk_bf16_f32 v116, v10, v11
v_lshlrev_b32 v10, 16, v120
v_and_b32 v11, 0xffff0000, v120
v_mfma_f32_16x16x32_bf16 v[84:87], a[88:91], a[8:11], v[84:87]
v_exp_f32 v88, v88
v_mfma_f32_16x16x32_bf16 v[84:87], a[92:95], a[12:15], v[84:87]
v_exp_f32 v90, v90
v_smfmac_f32_16x16x64_bf16 a[240:243], v[112:115], v[48:55], v19
v_exp_f32 v80, v80
v_lshlrev_b32 v14, 16, v122
v_exp_f32 v91, v91
v_lshlrev_b32 v16, 16, v123
v_pk_fma_f32 v[16:17], v[8:9], v[16:17], v[8:9] op_sel:[1,0,0] op_sel_hi:[1,1,0]
v_cvt_pk_bf16_f32 v117, v12, v13
v_and_b32 v13, 0xffff0000, v121
v_pk_fma_f32 v[14:15], v[8:9], v[14:15], v[8:9] op_sel:[1,0,0] op_sel_hi:[1,1,0]
v_lshlrev_b32 v12, 16, v121
v_pk_fma_f32 v[12:13], v[8:9], v[12:13], v[8:9] op_sel:[1,0,0] op_sel_hi:[1,1,0]
v_cvt_pk_bf16_f32 v123, v16, v17
v_cvt_pk_bf16_f32 v122, v14, v15
v_pk_fma_f32 v[10:11], v[8:9], v[10:11], v[8:9] op_sel:[1,0,0] op_sel_hi:[1,1,0]
v_mfma_f32_16x16x32_bf16 v[144:147], a[96:99], v[48:51], v[144:147]
v_and_b32 v15, 0xffff0000, v126
v_lshlrev_b32 v14, 16, v126
v_cvt_pk_bf16_f32 v61, v90, v91
v_mfma_f32_16x16x32_bf16 v[144:147], a[112:115], v[52:55], v[144:147]
s_waitcnt lgkmcnt(0)
v_lshlrev_b32 v16, 16, v127
v_exp_f32 v81, v81
v_mfma_f32_16x16x32_bf16 v[148:151], a[100:103], v[48:51], v[148:151]
v_exp_f32 v95, v95
v_mfma_f32_16x16x32_bf16 v[148:151], a[116:119], v[52:55], v[148:151]
v_exp_f32 v94, v94
v_mfma_f32_16x16x32_bf16 v[152:155], a[104:107], v[48:51], v[152:155]
v_exp_f32 v89, v89
v_exp_f32 v82, v82
v_mfma_f32_16x16x32_bf16 v[152:155], a[120:123], v[52:55], v[152:155]
buffer_load_dwordx4 v6, s[8:11], s36 offen offset:0 sc1 lds
v_mfma_f32_16x16x32_bf16 v[156:159], a[108:111], v[48:51], v[156:159]
v_exp_f32 v85, v85
v_mfma_f32_16x16x32_bf16 v[156:159], a[124:127], v[52:55], v[156:159]
v_cvt_pk_bf16_f32 v60, v88, v89
v_cvt_pk_bf16_f32 v121, v12, v13
v_cvt_pk_bf16_f32 v120, v10, v11
v_mfma_f32_16x16x32_bf16 v[88:91], a[64:67], a[16:19], v[36:39]
v_and_b32 v11, 0xffff0000, v124
v_and_b32 v13, 0xffff0000, v125
v_cvt_pk_bf16_f32 v48, v80, v81
v_exp_f32 v92, v92
v_and_b32 v17, 0xffff0000, v127
v_pk_fma_f32 v[14:15], v[8:9], v[14:15], v[8:9] op_sel:[1,0,0] op_sel_hi:[1,1,0]
v_mfma_f32_16x16x32_bf16 v[88:91], a[68:71], a[20:23], v[88:91]
ds_read_b128 a[64:67], v5 offset:16384
ds_read_b128 a[68:71], v5 offset:17408
v_cvt_pk_bf16_f32 v62, v92, v93
v_lshlrev_b32 v10, 16, v124
v_lshlrev_b32 v12, 16, v125
v_pk_fma_f32 v[12:13], v[8:9], v[12:13], v[8:9] op_sel:[1,0,0] op_sel_hi:[1,1,0]
v_exp_f32 v83, v83
v_pk_fma_f32 v[10:11], v[8:9], v[10:11], v[8:9] op_sel:[1,0,0] op_sel_hi:[1,1,0]
v_cvt_pk_bf16_f32 v124, v10, v11
v_pk_fma_f32 v[16:17], v[8:9], v[16:17], v[8:9] op_sel:[1,0,0] op_sel_hi:[1,1,0]
v_cvt_pk_bf16_f32 v49, v82, v83
v_mfma_f32_16x16x32_bf16 v[88:91], a[72:75], a[24:27], v[88:91]
ds_read_b128 a[72:75], v5 offset:18432
buffer_load_dwordx4 v7, s[8:11], s36 offen offset:1024 sc1 lds
v_cvt_pk_bf16_f32 v126, v14, v15
v_mfma_f32_16x16x32_bf16 v[88:91], a[76:79], a[28:31], v[88:91]
ds_read_b128 a[76:79], v5 offset:19456
v_cvt_pk_bf16_f32 v63, v94, v95
v_cvt_pk_bf16_f32 v125, v12, v13
v_mfma_f32_16x16x32_bf16 v[92:95], a[80:83], a[16:19], v[36:39]
ds_read_b128 a[80:83], v5 offset:20480
buffer_load_dwordx4 v28, s[8:11], s36 offen offset:2048 sc1 lds
v_mfma_f32_16x16x32_bf16 v[92:95], a[84:87], a[20:23], v[92:95]
v_and_b32 v13, 0xffff0000, v25
v_cvt_pk_bf16_f32 v127, v16, v17
v_mfma_f32_16x16x32_bf16 v[92:95], a[88:91], a[24:27], v[92:95]
ds_read_b128 a[84:87], v5 offset:21504
ds_read_b128 a[88:91], v5 offset:22528
v_mfma_f32_16x16x32_bf16 v[92:95], a[92:95], a[28:31], v[92:95]
ds_read_b128 a[92:95], v5 offset:23552
v_exp_f32 v86, v86
v_exp_f32 v91, v91
v_smfmac_f32_16x16x64_bf16 a[244:247], v[112:115], v[56:63], v19
v_exp_f32 v88, v88
v_mfma_f32_16x16x32_bf16 v[176:179], a[96:99], v[56:59], v[176:179]
buffer_load_dwordx4 v31, s[8:11], s36 offen offset:3072 sc1 lds
v_mfma_f32_16x16x32_bf16 v[176:179], a[112:115], v[60:63], v[176:179]
s_sub_u32 s36, s36, s61
ds_read_b128 a[96:99], v5 offset:24576
ds_read_b128 a[112:115], v5 offset:28672
v_mfma_f32_16x16x32_bf16 v[180:183], a[100:103], v[56:59], v[180:183]
s_bitset1_b32 m0, 14
v_and_b32 v15, 0xffff0000, v26
v_and_b32 v11, 0xffff0000, v24
v_mfma_f32_16x16x32_bf16 v[180:183], a[116:119], v[60:63], v[180:183]
s_waitcnt lgkmcnt(6)
ds_read_b128 a[100:103], v5 offset:25600
v_lshlrev_b32 v12, 16, v25
v_mfma_f32_16x16x32_bf16 v[184:187], a[104:107], v[56:59], v[184:187]
ds_read_b128 a[116:119], v5 offset:29696
ds_read_b128 a[104:107], v5 offset:26624
v_mfma_f32_16x16x32_bf16 v[184:187], a[120:123], v[60:63], v[184:187]
v_exp_f32 v94, v94
v_mfma_f32_16x16x32_bf16 v[188:191], a[108:111], v[56:59], v[188:191]
ds_read_b128 a[120:123], v5 offset:30720
ds_read_b128 a[108:111], v5 offset:27648
v_mfma_f32_16x16x32_bf16 v[188:191], a[124:127], v[60:63], v[188:191]
s_waitcnt lgkmcnt(7)
buffer_load_dwordx4 v6, s[8:11], s36 offen offset:0 sc1 lds
v_lshlrev_b32 v16, 16, v27
v_mfma_f32_16x16x32_bf16 v[80:83], a[64:67], a[0:3], v[32:35]
ds_read_b128 a[124:127], v5 offset:31744
v_lshlrev_b32 v10, 16, v24
v_mfma_f32_16x16x32_bf16 v[80:83], a[68:71], a[4:7], v[80:83]
v_exp_f32 v89, v89
v_mfma_f32_16x16x32_bf16 v[80:83], a[72:75], a[8:11], v[80:83]
v_exp_f32 v84, v84
v_exp_f32 v87, v87
v_and_b32 v17, 0xffff0000, v27
v_pk_fma_f32 v[16:17], v[8:9], v[16:17], v[8:9] op_sel:[1,0,0] op_sel_hi:[1,1,0]
v_pk_fma_f32 v[10:11], v[8:9], v[10:11], v[8:9] op_sel:[1,0,0] op_sel_hi:[1,1,0]
v_lshlrev_b32 v14, 16, v26
v_cvt_pk_bf16_f32 v27, v16, v17
v_cvt_pk_bf16_f32 v51, v86, v87
v_pk_fma_f32 v[12:13], v[8:9], v[12:13], v[8:9] op_sel:[1,0,0] op_sel_hi:[1,1,0]
v_cvt_pk_bf16_f32 v50, v84, v85
v_pk_fma_f32 v[14:15], v[8:9], v[14:15], v[8:9] op_sel:[1,0,0] op_sel_hi:[1,1,0]
v_mfma_f32_16x16x32_bf16 v[80:83], a[76:79], a[12:15], v[80:83]
s_waitcnt lgkmcnt(4)
ds_write_b128 v1, v[116:119] offset:0
ds_write_b128 v1, v[120:123] offset:512
v_mfma_f32_16x16x32_bf16 v[84:87], a[80:83], a[0:3], v[32:35]
buffer_load_dwordx4 v7, s[8:11], s36 offen offset:1024 sc1 lds
v_mfma_f32_16x16x32_bf16 v[84:87], a[84:87], a[4:7], v[84:87]
s_waitcnt lgkmcnt(2)
v_exp_f32 v93, v93
v_mfma_f32_16x16x32_bf16 v[84:87], a[88:91], a[8:11], v[84:87]
buffer_load_dwordx4 v28, s[8:11], s36 offen offset:2048 sc1 lds
v_mfma_f32_16x16x32_bf16 v[84:87], a[92:95], a[12:15], v[84:87]
v_cvt_pk_bf16_f32 v24, v10, v11
v_cvt_pk_bf16_f32 v25, v12, v13
v_exp_f32 v92, v92
v_mfma_f32_16x16x32_bf16 v[128:131], a[112:115], v[52:55], v[128:131]
v_cvt_pk_bf16_f32 v26, v14, v15
v_cvt_pk_bf16_f32 v56, v88, v89
v_mfma_f32_16x16x32_bf16 v[128:131], a[96:99], v[48:51], v[128:131]
v_exp_f32 v95, v95
v_mfma_f32_16x16x32_bf16 v[132:135], a[116:119], v[52:55], v[132:135]
buffer_load_dwordx4 v31, s[8:11], s36 offen offset:3072 sc1 lds
v_mfma_f32_16x16x32_bf16 v[132:135], a[100:103], v[48:51], v[132:135]
s_sub_u32 s36, s36, s61
ds_write_b128 v1, v[124:127] offset:1024
ds_write_b128 v1, v[24:27] offset:1536
v_mfma_f32_16x16x32_bf16 v[136:139], a[120:123], v[52:55], v[136:139]
v_exp_f32 v90, v90
v_mfma_f32_16x16x32_bf16 v[136:139], a[104:107], v[48:51], v[136:139]
s_and_b32 m0, s39, 0x1ffff
v_cvt_pk_bf16_f32 v57, v90, v91
v_cvt_pk_bf16_f32 v59, v94, v95
v_mfma_f32_16x16x32_bf16 v[140:143], a[124:127], v[52:55], v[140:143]
s_add_u32 s39, s39, 0x1008000
v_and_or_b32 v5, s39, v20, v4
v_cvt_pk_bf16_f32 v58, v92, v93
v_mfma_f32_16x16x32_bf16 v[140:143], a[108:111], v[48:51], v[140:143]
s_cbranch_scc0 kf_kernel_loopB
s_branch kf_kernel_loopBx
kf_kernel_hB3:
v_mfma_f32_16x16x32_bf16 v[88:91], a[64:67], a[16:19], v[36:39]
s_waitcnt vmcnt(16) lgkmcnt(0)
v_exp_f32 v85, v85
s_barrier
ds_read_b128 a[64:67], v5 offset:0
v_mfma_f32_16x16x32_bf16 v[88:91], a[68:71], a[20:23], v[88:91]
v_lshrrev_b32 v2, 4, v0
v_exp_f32 v82, v82
v_mfma_f32_16x16x32_bf16 v[88:91], a[72:75], a[24:27], v[88:91]
buffer_load_dwordx4 v6, s[8:11], s36 offen offset:0 sc1 lds
ds_read_b128 a[68:71], v5 offset:1024
v_and_b32 v3, 3, v0
v_mfma_f32_16x16x32_bf16 v[88:91], a[76:79], a[28:31], v[88:91]
ds_read_b128 a[72:75], v5 offset:2048
ds_read_b128 a[76:79], v5 offset:3072
v_bfe_u32 v1, v0, 2, 2
v_mfma_f32_16x16x32_bf16 v[92:95], a[80:83], a[16:19], v[36:39]
ds_read_b128 a[80:83], v5 offset:4096
v_mul_u32_u24 v1, 2112, v1
v_lshl_add_u32 v1, v2, 5, v1
v_lshl_add_u32 v1, v3, 3, v1
v_bfe_u32 v3, v0, 4, 1
v_mfma_f32_16x16x32_bf16 v[92:95], a[84:87], a[20:23], v[92:95]
v_exp_f32 v80, v80
v_add_u32 v1, 0x20000, v1
v_mfma_f32_16x16x32_bf16 v[92:95], a[88:91], a[24:27], v[92:95]
ds_read_b128 a[84:87], v5 offset:5120
ds_read_b128 a[88:91], v5 offset:6144
v_mfma_f32_16x16x32_bf16 v[92:95], a[92:95], a[28:31], v[92:95]
v_exp_f32 v83, v83
v_mfma_f32_16x16x32_bf16 v[160:163], a[112:115], v[60:63], v[160:163]
buffer_load_dwordx4 v7, s[8:11], s36 offen offset:1024 sc1 lds
ds_read_b128 a[92:95], v5 offset:7168
ds_read_b128 a[112:115], v5 offset:12288
v_mfma_f32_16x16x32_bf16 v[160:163], a[96:99], v[56:59], v[160:163]
s_waitcnt lgkmcnt(4)
v_exp_f32 v86, v86
v_mfma_f32_16x16x32_bf16 v[164:167], a[116:119], v[60:63], v[164:167]
s_lshr_b32 s3, s37, 2
ds_read_b128 a[96:99], v5 offset:8192
ds_read_b128 a[116:119], v5 offset:13312
ds_read_b64_tr_b16 v[116:117], v1 offset:0
ds_read_b64_tr_b16 v[118:119], v1 offset:8448
v_exp_f32 v81, v81
v_mfma_f32_16x16x32_bf16 v[164:167], a[100:103], v[56:59], v[164:167]
ds_read_b128 a[100:103], v5 offset:9216
ds_read_b64_tr_b16 v[120:121], v1 offset:512
v_mfma_f32_16x16x32_bf16 v[168:171], a[120:123], v[60:63], v[168:171]
ds_read_b128 a[120:123], v5 offset:14336
ds_read_b64_tr_b16 v[122:123], v1 offset:8960
v_cvt_pk_bf16_f32 v53, v82, v83
v_mfma_f32_16x16x32_bf16 v[168:171], a[104:107], v[56:59], v[168:171]
v_exp_f32 v91, v91
v_mfma_f32_16x16x32_bf16 v[172:175], a[124:127], v[60:63], v[172:175]
buffer_load_dwordx4 v28, s[8:11], s36 offen offset:2048 sc1 lds
ds_read_b128 a[104:107], v5 offset:10240
ds_read_b128 a[124:127], v5 offset:15360
v_mfma_f32_16x16x32_bf16 v[172:175], a[108:111], v[56:59], v[172:175]
ds_read_b128 a[108:111], v5 offset:11264
ds_read_b64_tr_b16 v[124:125], v1 offset:1024
ds_read_b64_tr_b16 v[126:127], v1 offset:9472
v_cvt_pk_bf16_f32 v52, v80, v81
v_mfma_f32_16x16x32_bf16 v[80:83], a[64:67], a[0:3], v[32:35]
v_exp_f32 v89, v89
v_mfma_f32_16x16x32_bf16 v[80:83], a[68:71], a[4:7], v[80:83]
s_and_b32 s29, s37, 3
v_exp_f32 v84, v84
v_mfma_f32_16x16x32_bf16 v[80:83], a[72:75], a[8:11], v[80:83]
v_exp_f32 v90, v90
v_cvt_pk_bf16_f32 v54, v84, v85
v_exp_f32 v87, v87
v_mfma_f32_16x16x32_bf16 v[80:83], a[76:79], a[12:15], v[80:83]
s_waitcnt lgkmcnt(13)
buffer_load_dwordx4 v31, s[8:11], s36 offen offset:3072 sc1 lds
v_cvt_pk_bf16_f32 v55, v86, v87
v_mfma_f32_16x16x32_bf16 v[84:87], a[80:83], a[0:3], v[32:35]
v_exp_f32 v93, v93
v_mfma_f32_16x16x32_bf16 v[84:87], a[84:87], a[4:7], v[84:87]
s_bitset1_b32 m0, 14
v_exp_f32 v95, v95
v_mfma_f32_16x16x32_bf16 v[84:87], a[88:91], a[8:11], v[84:87]
s_waitcnt lgkmcnt(8)
v_exp_f32 v88, v88
v_mfma_f32_16x16x32_bf16 v[84:87], a[92:95], a[12:15], v[84:87]
s_sub_u32 s36, s36, s61
ds_read_b64_tr_b16 v[24:25], v1 offset:1536
ds_read_b64_tr_b16 v[26:27], v1 offset:9984
v_smfmac_f32_16x16x64_bf16 a[240:243], v[112:115], v[48:55], v19
s_lshl_b32 s3, s3, 3
v_exp_f32 v94, v94
v_mfma_f32_16x16x32_bf16 v[144:147], a[96:99], v[48:51], v[144:147]
s_waitcnt lgkmcnt(4)
v_exp_f32 v80, v80
v_mfma_f32_16x16x32_bf16 v[144:147], a[112:115], v[52:55], v[144:147]
s_add_u32 s3, s3, s29
v_exp_f32 v82, v82
v_mfma_f32_16x16x32_bf16 v[148:151], a[100:103], v[48:51], v[148:151]
v_exp_f32 v92, v92
v_mfma_f32_16x16x32_bf16 v[148:151], a[116:119], v[52:55], v[148:151]
buffer_load_dwordx4 v6, s[8:11], s36 offen offset:0 sc1 lds
v_mfma_f32_16x16x32_bf16 v[152:155], a[104:107], v[48:51], v[152:155]
v_cvt_pk_bf16_f32 v62, v92, v93
v_and_b32 v2, 0xf0, v4
v_mfma_f32_16x16x32_bf16 v[152:155], a[120:123], v[52:55], v[152:155]
v_cvt_pk_bf16_f32 v61, v90, v91
v_exp_f32 v85, v85
v_mfma_f32_16x16x32_bf16 v[156:159], a[108:111], v[48:51], v[156:159]
v_exp_f32 v83, v83
v_mfma_f32_16x16x32_bf16 v[156:159], a[124:127], v[52:55], v[156:159]
v_cvt_pk_bf16_f32 v63, v94, v95
v_cvt_pk_bf16_f32 v60, v88, v89
v_mfma_f32_16x16x32_bf16 v[88:91], a[64:67], a[16:19], v[36:39]
ds_read_b128 a[64:67], v5 offset:16384
v_lshl_add_u32 v2, v3, 10, v2
v_mfma_f32_16x16x32_bf16 v[88:91], a[68:71], a[20:23], v[88:91]
ds_read_b128 a[68:71], v5 offset:17408
v_lshrrev_b32 v3, 5, v0
v_mfma_f32_16x16x32_bf16 v[88:91], a[72:75], a[24:27], v[88:91]
v_exp_f32 v81, v81
v_mfma_f32_16x16x32_bf16 v[88:91], a[76:79], a[28:31], v[88:91]
s_waitcnt lgkmcnt(2)
buffer_load_dwordx4 v7, s[8:11], s36 offen offset:1024 sc1 lds
v_mfma_f32_16x16x32_bf16 v[92:95], a[80:83], a[16:19], v[36:39]
s_lshl_b32 s3, s3, 8
ds_read_b128 a[72:75], v5 offset:18432
v_cvt_pk_bf16_f32 v48, v80, v81
v_mfma_f32_16x16x32_bf16 v[92:95], a[84:87], a[20:23], v[92:95]
ds_read_b128 a[76:79], v5 offset:19456
ds_read_b128 a[80:83], v5 offset:20480
v_mfma_f32_16x16x32_bf16 v[92:95], a[88:91], a[24:27], v[92:95]
s_add_u32 s3, s3, 50331648
ds_read_b128 a[84:87], v5 offset:21504
ds_read_b128 a[88:91], v5 offset:22528
v_mfma_f32_16x16x32_bf16 v[92:95], a[92:95], a[28:31], v[92:95]
ds_read_b128 a[92:95], v5 offset:23552
v_lshl_add_u32 v2, v3, 17, v2
v_smfmac_f32_16x16x64_bf16 a[244:247], v[112:115], v[56:63], v19
buffer_store_dwordx4 v[116:119], v2, s[40:43], s3 offen sc1
v_mfma_f32_16x16x32_bf16 v[176:179], a[96:99], v[56:59], v[176:179]
s_add_u32 s27, s27, 1
v_exp_f32 v86, v86
v_exp_f32 v87, v87
v_mfma_f32_16x16x32_bf16 v[176:179], a[112:115], v[60:63], v[176:179]
s_add_u32 s3, s3, 1048576
ds_read_b128 a[96:99], v5 offset:24576
ds_read_b128 a[112:115], v5 offset:28672
v_mfma_f32_16x16x32_bf16 v[180:183], a[100:103], v[56:59], v[180:183]
buffer_store_dwordx4 v[120:123], v2, s[40:43], s3 offen sc1
v_mfma_f32_16x16x32_bf16 v[180:183], a[116:119], v[60:63], v[180:183]
s_add_u32 s3, s3, 1048576
v_cvt_pk_bf16_f32 v49, v82, v83
v_exp_f32 v95, v95
v_mfma_f32_16x16x32_bf16 v[184:187], a[104:107], v[56:59], v[184:187]
s_waitcnt lgkmcnt(6)
ds_read_b128 a[100:103], v5 offset:25600
ds_read_b128 a[116:119], v5 offset:29696
v_mfma_f32_16x16x32_bf16 v[184:187], a[120:123], v[60:63], v[184:187]
ds_read_b128 a[104:107], v5 offset:26624
ds_read_b128 a[120:123], v5 offset:30720
v_mfma_f32_16x16x32_bf16 v[188:191], a[108:111], v[56:59], v[188:191]
s_waitcnt lgkmcnt(6)
buffer_store_dwordx4 v[124:127], v2, s[40:43], s3 offen sc1
v_mfma_f32_16x16x32_bf16 v[188:191], a[124:127], v[60:63], v[188:191]
v_exp_f32 v88, v88
v_mfma_f32_16x16x32_bf16 v[80:83], a[64:67], a[0:3], v[32:35]
v_exp_f32 v84, v84
v_mfma_f32_16x16x32_bf16 v[80:83], a[68:71], a[4:7], v[80:83]
buffer_load_dwordx4 v28, s[8:11], s36 offen offset:2048 sc1 lds
v_mfma_f32_16x16x32_bf16 v[80:83], a[72:75], a[8:11], v[80:83]
s_add_u32 s3, s3, 1048576
ds_read_b128 a[108:111], v5 offset:27648
ds_read_b128 a[124:127], v5 offset:31744
v_mfma_f32_16x16x32_bf16 v[80:83], a[76:79], a[12:15], v[80:83]
v_cvt_pk_bf16_f32 v51, v86, v87
v_cvt_pk_bf16_f32 v50, v84, v85
v_mfma_f32_16x16x32_bf16 v[84:87], a[80:83], a[0:3], v[32:35]
s_add_u32 s26, s39, 65536
v_exp_f32 v89, v89
v_mfma_f32_16x16x32_bf16 v[84:87], a[84:87], a[4:7], v[84:87]
s_waitcnt lgkmcnt(4)
buffer_store_dwordx4 v[24:27], v2, s[40:43], s3 offen sc1
v_mfma_f32_16x16x32_bf16 v[84:87], a[88:91], a[8:11], v[84:87]
s_min_u32 s59, s26, s32
v_exp_f32 v90, v90
v_mfma_f32_16x16x32_bf16 v[84:87], a[92:95], a[12:15], v[84:87]
buffer_load_dwordx4 v31, s[8:11], s36 offen offset:3072 sc1 lds
v_mfma_f32_16x16x32_bf16 v[128:131], a[112:115], v[52:55], v[128:131]
v_exp_f32 v92, v92
v_mfma_f32_16x16x32_bf16 v[128:131], a[96:99], v[48:51], v[128:131]
s_waitcnt lgkmcnt(0)
v_exp_f32 v91, v91
v_mfma_f32_16x16x32_bf16 v[132:135], a[116:119], v[52:55], v[132:135]
s_sub_u32 s36, s36, s61
v_exp_f32 v93, v93
v_mfma_f32_16x16x32_bf16 v[132:135], a[100:103], v[48:51], v[132:135]
s_sub_u32 s59, s59, s39
s_lshl_b32 s59, s59, 9
v_cvt_pk_bf16_f32 v56, v88, v89
v_mfma_f32_16x16x32_bf16 v[136:139], a[120:123], v[52:55], v[136:139]
s_sub_u32 s39, s39, s59
v_exp_f32 v94, v94
v_mfma_f32_16x16x32_bf16 v[136:139], a[104:107], v[48:51], v[136:139]
s_and_b32 m0, s39, 0x1ffff
v_cvt_pk_bf16_f32 v59, v94, v95
v_cvt_pk_bf16_f32 v57, v90, v91
v_mfma_f32_16x16x32_bf16 v[140:143], a[124:127], v[52:55], v[140:143]
s_add_u32 s39, s39, 0x1008000
v_and_or_b32 v5, s39, v20, v4
v_cvt_pk_bf16_f32 v58, v92, v93
v_mfma_f32_16x16x32_bf16 v[140:143], a[108:111], v[48:51], v[140:143]
s_cbranch_scc0 kf_kernel_loopB
s_branch kf_kernel_loopBx
kf_kernel_hB4:
s_cmp_ge_u32 s15, 10158080
s_cbranch_scc1 kf_kernel_hB4n
kf_kernel_hB4f:
v_bfe_u32 v1, v0, 4, 2
v_mfma_f32_16x16x32_bf16 v[88:91], a[64:67], a[16:19], v[36:39]
s_waitcnt vmcnt(16) lgkmcnt(0)
s_barrier
buffer_load_dwordx4 v6, s[8:11], s36 offen offset:0 sc1 lds
v_mfma_f32_16x16x32_bf16 v[88:91], a[68:71], a[20:23], v[88:91]
s_lshr_b32 s3, s2, 2
ds_read_b128 a[64:67], v5 offset:0
ds_read_b128 a[68:71], v5 offset:1024
v_exp_f32 v86, v86
v_and_b32 v3, 15, v0
v_exp_f32 v85, v85
v_lshlrev_b32 v2, 1, v1
v_mfma_f32_16x16x32_bf16 v[88:91], a[72:75], a[24:27], v[88:91]
ds_read_b128 a[72:75], v5 offset:2048
v_xor_b32 v2, v2, v3
v_mfma_f32_16x16x32_bf16 v[88:91], a[76:79], a[28:31], v[88:91]
v_exp_f32 v80, v80
v_mfma_f32_16x16x32_bf16 v[92:95], a[80:83], a[16:19], v[36:39]
buffer_load_dwordx4 v7, s[8:11], s36 offen offset:1024 sc1 lds
v_mfma_f32_16x16x32_bf16 v[92:95], a[84:87], a[20:23], v[92:95]
s_lshl_b32 s3, s3, 8
ds_read_b128 a[76:79], v5 offset:3072
ds_read_b128 a[80:83], v5 offset:4096
v_mfma_f32_16x16x32_bf16 v[92:95], a[88:91], a[24:27], v[92:95]
buffer_load_dwordx4 v28, s[8:11], s36 offen offset:2048 sc1 lds
v_exp_f32 v87, v87
v_mfma_f32_16x16x32_bf16 v[92:95], a[92:95], a[28:31], v[92:95]
ds_read_b128 a[84:87], v5 offset:5120
ds_read_b128 a[88:91], v5 offset:6144
ds_read_b128 a[92:95], v5 offset:7168
v_mfma_f32_16x16x32_bf16 v[160:163], a[112:115], v[60:63], v[160:163]
ds_read_b128 a[112:115], v5 offset:12288
v_mul_u32_u24 v1, 1280, v1
v_mfma_f32_16x16x32_bf16 v[160:163], a[96:99], v[56:59], v[160:163]
ds_read_b128 a[96:99], v5 offset:8192
v_lshl_add_u32 v8, v2, 4, v1
v_mfma_f32_16x16x32_bf16 v[164:167], a[116:119], v[60:63], v[164:167]
buffer_load_dwordx4 v31, s[8:11], s36 offen offset:3072 sc1 lds
ds_read_b128 a[116:119], v5 offset:13312
v_xor_b32 v2, 8, v2
v_mfma_f32_16x16x32_bf16 v[164:167], a[100:103], v[56:59], v[164:167]
s_sub_u32 s36, s36, s61
ds_read_b128 a[100:103], v5 offset:9216
v_exp_f32 v83, v83
v_cvt_pk_bf16_f32 v55, v86, v87
v_mfma_f32_16x16x32_bf16 v[168:171], a[120:123], v[60:63], v[168:171]
s_waitcnt lgkmcnt(8)
v_exp_f32 v82, v82
v_mfma_f32_16x16x32_bf16 v[168:171], a[104:107], v[56:59], v[168:171]
s_bitset1_b32 m0, 14
ds_read_b128 a[120:123], v5 offset:14336
v_exp_f32 v84, v84
v_lshl_add_u32 v9, v2, 4, v1
v_mov_b32 v2, 1073741824
v_exp_f32 v81, v81
v_mfma_f32_16x16x32_bf16 v[172:175], a[124:127], v[60:63], v[172:175]
ds_read_b128 a[104:107], v5 offset:10240
buffer_load_dwordx4 v6, s[8:11], s36 offen offset:0 sc1 lds
ds_read_b128 a[124:127], v5 offset:15360
v_mfma_f32_16x16x32_bf16 v[172:175], a[108:111], v[56:59], v[172:175]
s_add_u32 s29, s14, 0
v_cvt_pk_bf16_f32 v53, v82, v83
v_cvt_pk_bf16_f32 v52, v80, v81
v_mfma_f32_16x16x32_bf16 v[80:83], a[64:67], a[0:3], v[32:35]
ds_read_b128 a[108:111], v5 offset:11264
buffer_load_dwordx4 v7, s[8:11], s36 offen offset:1024 sc1 lds
v_mfma_f32_16x16x32_bf16 v[80:83], a[68:71], a[4:7], v[80:83]
s_waitcnt lgkmcnt(8)
v_exp_f32 v89, v89
v_mfma_f32_16x16x32_bf16 v[80:83], a[72:75], a[8:11], v[80:83]
s_waitcnt lgkmcnt(4)
v_cmp_eq_u32 vcc, 0, v4
v_mov_b32 v1, 1
v_mfma_f32_16x16x32_bf16 v[80:83], a[76:79], a[12:15], v[80:83]
s_add_u32 s3, s3, 3178496
v_cndmask_b32 v2, v2, 0, vcc
v_cvt_pk_bf16_f32 v54, v84, v85
v_mfma_f32_16x16x32_bf16 v[84:87], a[80:83], a[0:3], v[32:35]
buffer_load_dwordx4 v28, s[8:11], s36 offen offset:2048 sc1 lds
v_add_u32 v9, 4096, v9
v_mfma_f32_16x16x32_bf16 v[84:87], a[84:87], a[4:7], v[84:87]
v_exp_f32 v90, v90
v_mfma_f32_16x16x32_bf16 v[84:87], a[88:91], a[8:11], v[84:87]
buffer_load_dwordx4 v31, s[8:11], s36 offen offset:3072 sc1 lds
v_mfma_f32_16x16x32_bf16 v[84:87], a[92:95], a[12:15], v[84:87]
s_add_u32 m0, s25, 131072
v_exp_f32 v88, v88
v_smfmac_f32_16x16x64_bf16 a[240:243], v[112:115], v[48:55], v19
v_exp_f32 v91, v91
v_mfma_f32_16x16x32_bf16 v[144:147], a[96:99], v[48:51], v[144:147]
s_waitcnt vmcnt(17)
buffer_atomic_add v1, v2, s[40:43], s3 offen sc1
v_mfma_f32_16x16x32_bf16 v[144:147], a[112:115], v[52:55], v[144:147]
v_exp_f32 v92, v92
v_exp_f32 v94, v94
v_mfma_f32_16x16x32_bf16 v[148:151], a[100:103], v[48:51], v[148:151]
v_exp_f32 v95, v95
v_mfma_f32_16x16x32_bf16 v[148:151], a[116:119], v[52:55], v[148:151]
s_waitcnt lgkmcnt(0)
v_exp_f32 v93, v93
v_mfma_f32_16x16x32_bf16 v[152:155], a[104:107], v[48:51], v[152:155]
v_exp_f32 v84, v84
v_add_u32 v11, 8192, v9
v_mfma_f32_16x16x32_bf16 v[152:155], a[120:123], v[52:55], v[152:155]
buffer_load_dwordx4 v8, s[16:19], s29 offen offset:0 lds
v_mfma_f32_16x16x32_bf16 v[156:159], a[108:111], v[48:51], v[156:159]
buffer_load_dwordx4 v9, s[16:19], s29 offen offset:1024 lds
v_mfma_f32_16x16x32_bf16 v[156:159], a[124:127], v[52:55], v[156:159]
v_cvt_pk_bf16_f32 v60, v88, v89
v_cvt_pk_bf16_f32 v61, v90, v91
v_mfma_f32_16x16x32_bf16 v[88:91], a[64:67], a[16:19], v[36:39]
ds_read_b128 a[64:67], v5 offset:16384
v_cvt_pk_bf16_f32 v62, v92, v93
v_mfma_f32_16x16x32_bf16 v[88:91], a[68:71], a[20:23], v[88:91]
ds_read_b128 a[68:71], v5 offset:17408
v_cvt_pk_bf16_f32 v63, v94, v95
v_mfma_f32_16x16x32_bf16 v[88:91], a[72:75], a[24:27], v[88:91]
ds_read_b128 a[72:75], v5 offset:18432
v_add_u32 v10, 8192, v8
v_mfma_f32_16x16x32_bf16 v[88:91], a[76:79], a[28:31], v[88:91]
v_exp_f32 v80, v80
v_mfma_f32_16x16x32_bf16 v[92:95], a[80:83], a[16:19], v[36:39]
ds_read_b128 a[76:79], v5 offset:19456
ds_read_b128 a[80:83], v5 offset:20480
buffer_load_dwordx4 v10, s[16:19], s29 offen offset:2048 lds
v_mfma_f32_16x16x32_bf16 v[92:95], a[84:87], a[20:23], v[92:95]
ds_read_b128 a[84:87], v5 offset:21504
buffer_load_dwordx4 v11, s[16:19], s29 offen offset:3072 lds
v_mfma_f32_16x16x32_bf16 v[92:95], a[88:91], a[24:27], v[92:95]
s_sub_u32 s36, s36, s61
v_exp_f32 v86, v86
v_mfma_f32_16x16x32_bf16 v[92:95], a[92:95], a[28:31], v[92:95]
s_add_u32 s29, s14, 20480
ds_read_b128 a[88:91], v5 offset:22528
ds_read_b128 a[92:95], v5 offset:23552
v_smfmac_f32_16x16x64_bf16 a[244:247], v[112:115], v[56:63], v19
s_add_u32 s27, s27, 1
v_exp_f32 v90, v90
v_mfma_f32_16x16x32_bf16 v[176:179], a[96:99], v[56:59], v[176:179]
s_add_u32 m0, s25, 135168
ds_read_b128 a[96:99], v5 offset:24576
buffer_load_dwordx4 v8, s[16:19], s29 offen offset:0 lds
v_mfma_f32_16x16x32_bf16 v[176:179], a[112:115], v[60:63], v[176:179]
s_waitcnt lgkmcnt(5)
v_exp_f32 v83, v83
v_mfma_f32_16x16x32_bf16 v[180:183], a[100:103], v[56:59], v[180:183]
ds_read_b128 a[112:115], v5 offset:28672
v_exp_f32 v81, v81
v_exp_f32 v82, v82
v_mfma_f32_16x16x32_bf16 v[180:183], a[116:119], v[60:63], v[180:183]
ds_read_b128 a[100:103], v5 offset:25600
ds_read_b128 a[116:119], v5 offset:29696
v_mfma_f32_16x16x32_bf16 v[184:187], a[104:107], v[56:59], v[184:187]
buffer_load_dwordx4 v9, s[16:19], s29 offen offset:1024 lds
ds_read_b128 a[104:107], v5 offset:26624
v_mfma_f32_16x16x32_bf16 v[184:187], a[120:123], v[60:63], v[184:187]
buffer_load_dwordx4 v10, s[16:19], s29 offen offset:2048 lds
v_mfma_f32_16x16x32_bf16 v[188:191], a[108:111], v[56:59], v[188:191]
ds_read_b128 a[120:123], v5 offset:30720
v_exp_f32 v85, v85
v_mfma_f32_16x16x32_bf16 v[188:191], a[124:127], v[60:63], v[188:191]
v_cvt_pk_bf16_f32 v48, v80, v81
v_cvt_pk_bf16_f32 v49, v82, v83
v_mfma_f32_16x16x32_bf16 v[80:83], a[64:67], a[0:3], v[32:35]
v_exp_f32 v87, v87
v_mfma_f32_16x16x32_bf16 v[80:83], a[68:71], a[4:7], v[80:83]
s_waitcnt lgkmcnt(6)
ds_read_b128 a[108:111], v5 offset:27648
ds_read_b128 a[124:127], v5 offset:31744
v_mfma_f32_16x16x32_bf16 v[80:83], a[72:75], a[8:11], v[80:83]
s_add_u32 s26, s39, 32768
v_exp_f32 v88, v88
v_mfma_f32_16x16x32_bf16 v[80:83], a[76:79], a[12:15], v[80:83]
v_cvt_pk_bf16_f32 v50, v84, v85
v_cvt_pk_bf16_f32 v51, v86, v87
v_mfma_f32_16x16x32_bf16 v[84:87], a[80:83], a[0:3], v[32:35]
buffer_load_dwordx4 v11, s[16:19], s29 offen offset:3072 lds
v_mfma_f32_16x16x32_bf16 v[84:87], a[84:87], a[4:7], v[84:87]
s_waitcnt lgkmcnt(4)
v_exp_f32 v95, v95
v_mfma_f32_16x16x32_bf16 v[84:87], a[88:91], a[8:11], v[84:87]
v_exp_f32 v93, v93
v_mfma_f32_16x16x32_bf16 v[84:87], a[92:95], a[12:15], v[84:87]
s_min_u32 s59, s26, s32
v_exp_f32 v94, v94
v_mfma_f32_16x16x32_bf16 v[128:131], a[112:115], v[52:55], v[128:131]
s_waitcnt lgkmcnt(0)
v_exp_f32 v89, v89
v_mfma_f32_16x16x32_bf16 v[128:131], a[96:99], v[48:51], v[128:131]
v_exp_f32 v92, v92
v_mfma_f32_16x16x32_bf16 v[132:135], a[116:119], v[52:55], v[132:135]
s_sub_u32 s59, s59, s39
v_exp_f32 v91, v91
v_mfma_f32_16x16x32_bf16 v[132:135], a[100:103], v[48:51], v[132:135]
s_lshl_b32 s59, s59, 9
s_sub_u32 s39, s39, s59
s_and_b32 m0, s39, 0x1ffff
v_mfma_f32_16x16x32_bf16 v[136:139], a[120:123], v[52:55], v[136:139]
v_cvt_pk_bf16_f32 v58, v92, v93
v_cvt_pk_bf16_f32 v59, v94, v95
v_mfma_f32_16x16x32_bf16 v[136:139], a[104:107], v[48:51], v[136:139]
v_cvt_pk_bf16_f32 v57, v90, v91
v_mfma_f32_16x16x32_bf16 v[140:143], a[124:127], v[52:55], v[140:143]
s_add_u32 s39, s39, 0x1008000
v_and_or_b32 v5, s39, v20, v4
v_cvt_pk_bf16_f32 v56, v88, v89
v_mfma_f32_16x16x32_bf16 v[140:143], a[108:111], v[48:51], v[140:143]
s_cbranch_scc0 kf_kernel_loopB
s_branch kf_kernel_loopBx
kf_kernel_pd23:
s_branch kf_kernel_idle
kf_kernel_hB4n:
v_mfma_f32_16x16x32_bf16 v[88:91], a[64:67], a[16:19], v[36:39]
s_waitcnt vmcnt(16) lgkmcnt(0)
v_exp_f32 v86, v86
s_barrier
v_exp_f32 v81, v81
v_mfma_f32_16x16x32_bf16 v[88:91], a[68:71], a[20:23], v[88:91]
v_exp_f32 v82, v82
v_mfma_f32_16x16x32_bf16 v[88:91], a[72:75], a[24:27], v[88:91]
buffer_load_dwordx4 v6, s[8:11], s36 offen offset:0 sc1 lds
ds_read_b128 a[64:67], v5 offset:0
v_mfma_f32_16x16x32_bf16 v[88:91], a[76:79], a[28:31], v[88:91]
ds_read_b128 a[68:71], v5 offset:1024
ds_read_b128 a[72:75], v5 offset:2048
v_mfma_f32_16x16x32_bf16 v[92:95], a[80:83], a[16:19], v[36:39]
ds_read_b128 a[76:79], v5 offset:3072
v_exp_f32 v84, v84
v_mfma_f32_16x16x32_bf16 v[92:95], a[84:87], a[20:23], v[92:95]
ds_read_b128 a[80:83], v5 offset:4096
ds_read_b128 a[84:87], v5 offset:5120
v_mfma_f32_16x16x32_bf16 v[92:95], a[88:91], a[24:27], v[92:95]
buffer_load_dwordx4 v7, s[8:11], s36 offen offset:1024 sc1 lds
v_mfma_f32_16x16x32_bf16 v[92:95], a[92:95], a[28:31], v[92:95]
ds_read_b128 a[88:91], v5 offset:6144
ds_read_b128 a[92:95], v5 offset:7168
v_mfma_f32_16x16x32_bf16 v[160:163], a[112:115], v[60:63], v[160:163]
v_exp_f32 v80, v80
v_mfma_f32_16x16x32_bf16 v[160:163], a[96:99], v[56:59], v[160:163]
ds_read_b128 a[112:115], v5 offset:12288
ds_read_b128 a[96:99], v5 offset:8192
v_mfma_f32_16x16x32_bf16 v[164:167], a[116:119], v[60:63], v[164:167]
ds_read_b128 a[116:119], v5 offset:13312
s_lshr_b32 s3, s2, 2
v_mfma_f32_16x16x32_bf16 v[164:167], a[100:103], v[56:59], v[164:167]
ds_read_b128 a[100:103], v5 offset:9216
v_cvt_pk_bf16_f32 v52, v80, v81
v_mfma_f32_16x16x32_bf16 v[168:171], a[120:123], v[60:63], v[168:171]
s_waitcnt lgkmcnt(8)
ds_read_b128 a[120:123], v5 offset:14336
v_exp_f32 v83, v83
v_mfma_f32_16x16x32_bf16 v[168:171], a[104:107], v[56:59], v[168:171]
ds_read_b128 a[104:107], v5 offset:10240
v_cvt_pk_bf16_f32 v53, v82, v83
v_mfma_f32_16x16x32_bf16 v[172:175], a[124:127], v[60:63], v[172:175]
v_exp_f32 v85, v85
v_mfma_f32_16x16x32_bf16 v[172:175], a[108:111], v[56:59], v[172:175]
buffer_load_dwordx4 v28, s[8:11], s36 offen offset:2048 sc1 lds
v_mfma_f32_16x16x32_bf16 v[80:83], a[64:67], a[0:3], v[32:35]
v_cvt_pk_bf16_f32 v54, v84, v85
v_exp_f32 v87, v87
v_mfma_f32_16x16x32_bf16 v[80:83], a[68:71], a[4:7], v[80:83]
s_waitcnt lgkmcnt(6)
ds_read_b128 a[124:127], v5 offset:15360
ds_read_b128 a[108:111], v5 offset:11264
v_mfma_f32_16x16x32_bf16 v[80:83], a[72:75], a[8:11], v[80:83]
v_cmp_eq_u32 vcc, 0, v4
v_cvt_pk_bf16_f32 v55, v86, v87
v_mfma_f32_16x16x32_bf16 v[80:83], a[76:79], a[12:15], v[80:83]
s_waitcnt lgkmcnt(4)
v_exp_f32 v91, v91
v_mfma_f32_16x16x32_bf16 v[84:87], a[80:83], a[0:3], v[32:35]
v_exp_f32 v89, v89
v_mfma_f32_16x16x32_bf16 v[84:87], a[84:87], a[4:7], v[84:87]
buffer_load_dwordx4 v31, s[8:11], s36 offen offset:3072 sc1 lds
v_mfma_f32_16x16x32_bf16 v[84:87], a[88:91], a[8:11], v[84:87]
v_exp_f32 v88, v88
v_mfma_f32_16x16x32_bf16 v[84:87], a[92:95], a[12:15], v[84:87]
s_sub_u32 s36, s36, s61
v_exp_f32 v94, v94
v_smfmac_f32_16x16x64_bf16 a[240:243], v[112:115], v[48:55], v19
v_exp_f32 v80, v80
v_mfma_f32_16x16x32_bf16 v[144:147], a[96:99], v[48:51], v[144:147]
s_bitset1_b32 m0, 14
v_exp_f32 v93, v93
v_mfma_f32_16x16x32_bf16 v[144:147], a[112:115], v[52:55], v[144:147]
v_exp_f32 v90, v90
v_mfma_f32_16x16x32_bf16 v[148:151], a[100:103], v[48:51], v[148:151]
v_exp_f32 v92, v92
v_mfma_f32_16x16x32_bf16 v[148:151], a[116:119], v[52:55], v[148:151]
s_waitcnt lgkmcnt(0)
buffer_load_dwordx4 v6, s[8:11], s36 offen offset:0 sc1 lds
v_mfma_f32_16x16x32_bf16 v[152:155], a[104:107], v[48:51], v[152:155]
v_exp_f32 v95, v95
v_mfma_f32_16x16x32_bf16 v[152:155], a[120:123], v[52:55], v[152:155]
v_cvt_pk_bf16_f32 v61, v90, v91
v_cvt_pk_bf16_f32 v63, v94, v95
v_cvt_pk_bf16_f32 v60, v88, v89
v_mfma_f32_16x16x32_bf16 v[156:159], a[108:111], v[48:51], v[156:159]
buffer_load_dwordx4 v7, s[8:11], s36 offen offset:1024 sc1 lds
v_mfma_f32_16x16x32_bf16 v[156:159], a[124:127], v[52:55], v[156:159]
v_exp_f32 v82, v82
v_mfma_f32_16x16x32_bf16 v[88:91], a[64:67], a[16:19], v[36:39]
ds_read_b128 a[64:67], v5 offset:16384
v_exp_f32 v85, v85
v_mfma_f32_16x16x32_bf16 v[88:91], a[68:71], a[20:23], v[88:91]
v_cvt_pk_bf16_f32 v62, v92, v93
v_mov_b32 v2, 1073741824
v_mfma_f32_16x16x32_bf16 v[88:91], a[72:75], a[24:27], v[88:91]
s_add_u32 s27, s27, 1
ds_read_b128 a[68:71], v5 offset:17408
ds_read_b128 a[72:75], v5 offset:18432
v_mfma_f32_16x16x32_bf16 v[88:91], a[76:79], a[28:31], v[88:91]
s_lshl_b32 s3, s3, 8
ds_read_b128 a[76:79], v5 offset:19456
v_exp_f32 v81, v81
v_mfma_f32_16x16x32_bf16 v[92:95], a[80:83], a[16:19], v[36:39]
s_add_u32 s26, s39, 32768
v_exp_f32 v84, v84
v_mfma_f32_16x16x32_bf16 v[92:95], a[84:87], a[20:23], v[92:95]
v_exp_f32 v83, v83
v_mfma_f32_16x16x32_bf16 v[92:95], a[88:91], a[24:27], v[92:95]
ds_read_b128 a[80:83], v5 offset:20480
ds_read_b128 a[84:87], v5 offset:21504
v_mfma_f32_16x16x32_bf16 v[92:95], a[92:95], a[28:31], v[92:95]
v_exp_f32 v86, v86
v_smfmac_f32_16x16x64_bf16 a[244:247], v[112:115], v[56:63], v19
ds_read_b128 a[88:91], v5 offset:22528
ds_read_b128 a[92:95], v5 offset:23552
v_mfma_f32_16x16x32_bf16 v[176:179], a[96:99], v[56:59], v[176:179]
buffer_load_dwordx4 v28, s[8:11], s36 offen offset:2048 sc1 lds
v_mfma_f32_16x16x32_bf16 v[176:179], a[112:115], v[60:63], v[176:179]
v_cvt_pk_bf16_f32 v48, v80, v81
v_cndmask_b32 v2, v2, 0, vcc
v_mfma_f32_16x16x32_bf16 v[180:183], a[100:103], v[56:59], v[180:183]
s_add_u32 s3, s3, 3178496
ds_read_b128 a[96:99], v5 offset:24576
v_cvt_pk_bf16_f32 v49, v82, v83
v_mfma_f32_16x16x32_bf16 v[180:183], a[116:119], v[60:63], v[180:183]
ds_read_b128 a[112:115], v5 offset:28672
ds_read_b128 a[100:103], v5 offset:25600
v_mfma_f32_16x16x32_bf16 v[184:187], a[104:107], v[56:59], v[184:187]
buffer_load_dwordx4 v31, s[8:11], s36 offen offset:3072 sc1 lds
v_mfma_f32_16x16x32_bf16 v[184:187], a[120:123], v[60:63], v[184:187]
s_waitcnt lgkmcnt(7)
ds_read_b128 a[116:119], v5 offset:29696
ds_read_b128 a[104:107], v5 offset:26624
v_mfma_f32_16x16x32_bf16 v[188:191], a[108:111], v[56:59], v[188:191]
v_cvt_pk_bf16_f32 v50, v84, v85
v_mov_b32 v1, 1
v_mfma_f32_16x16x32_bf16 v[188:191], a[124:127], v[60:63], v[188:191]
v_exp_f32 v88, v88
v_mfma_f32_16x16x32_bf16 v[80:83], a[64:67], a[0:3], v[32:35]
v_exp_f32 v87, v87
v_mfma_f32_16x16x32_bf16 v[80:83], a[68:71], a[4:7], v[80:83]
ds_read_b128 a[120:123], v5 offset:30720
ds_read_b128 a[108:111], v5 offset:27648
v_mfma_f32_16x16x32_bf16 v[80:83], a[72:75], a[8:11], v[80:83]
s_waitcnt lgkmcnt(7)
ds_read_b128 a[124:127], v5 offset:31744
v_cvt_pk_bf16_f32 v51, v86, v87
v_mfma_f32_16x16x32_bf16 v[80:83], a[76:79], a[12:15], v[80:83]
v_exp_f32 v90, v90
v_mfma_f32_16x16x32_bf16 v[84:87], a[80:83], a[0:3], v[32:35]
s_waitcnt vmcnt(17)
v_exp_f32 v93, v93
v_mfma_f32_16x16x32_bf16 v[84:87], a[84:87], a[4:7], v[84:87]
buffer_atomic_add v1, v2, s[40:43], s3 offen sc1
v_mfma_f32_16x16x32_bf16 v[84:87], a[88:91], a[8:11], v[84:87]
v_exp_f32 v89, v89
v_mfma_f32_16x16x32_bf16 v[84:87], a[92:95], a[12:15], v[84:87]
s_waitcnt lgkmcnt(4)
v_exp_f32 v91, v91
v_mfma_f32_16x16x32_bf16 v[128:131], a[112:115], v[52:55], v[128:131]
v_exp_f32 v95, v95
v_mfma_f32_16x16x32_bf16 v[128:131], a[96:99], v[48:51], v[128:131]
s_waitcnt lgkmcnt(0)
v_cvt_pk_bf16_f32 v56, v88, v89
s_min_u32 s59, s26, s32
v_mfma_f32_16x16x32_bf16 v[132:135], a[116:119], v[52:55], v[132:135]
s_sub_u32 s59, s59, s39
v_exp_f32 v94, v94
v_mfma_f32_16x16x32_bf16 v[132:135], a[100:103], v[48:51], v[132:135]
s_lshl_b32 s59, s59, 9
v_exp_f32 v92, v92
v_mfma_f32_16x16x32_bf16 v[136:139], a[120:123], v[52:55], v[136:139]
v_cvt_pk_bf16_f32 v57, v90, v91
v_cvt_pk_bf16_f32 v59, v94, v95
v_mfma_f32_16x16x32_bf16 v[136:139], a[104:107], v[48:51], v[136:139]
s_sub_u32 s36, s36, s61
s_sub_u32 s39, s39, s59
s_and_b32 m0, s39, 0x1ffff
v_mfma_f32_16x16x32_bf16 v[140:143], a[124:127], v[52:55], v[140:143]
s_add_u32 s39, s39, 0x1008000
v_cvt_pk_bf16_f32 v58, v92, v93
v_and_or_b32 v5, s39, v20, v4
v_mfma_f32_16x16x32_bf16 v[140:143], a[108:111], v[48:51], v[140:143]
s_cbranch_scc0 kf_kernel_loopB
s_branch kf_kernel_loopBx
kf_kernel_pd24:
s_branch kf_kernel_idle
kf_kernel_hBw:
s_cmp_eq_u32 s27, 6
s_cbranch_scc1 kf_kernel_hB6
s_cmp_eq_u32 s27, 7
s_cbranch_scc1 kf_kernel_hB7
s_cmp_eq_u32 s27, 8
s_cbranch_scc1 kf_kernel_hB8
s_cmp_eq_u32 s27, 9
s_cbranch_scc1 kf_kernel_hB9
s_cmp_eq_u32 s27, 10
s_cbranch_scc1 kf_kernel_hB10
kf_kernel_hB5:
v_and_b32 v1, 63, v0
v_lshrrev_b32 v2, 3, v1
v_mfma_f32_16x16x32_bf16 v[88:91], a[64:67], a[16:19], v[36:39]
s_waitcnt vmcnt(16) lgkmcnt(0)
s_barrier
ds_read_b128 a[64:67], v5 offset:0
v_exp_f32 v80, v80
v_mfma_f32_16x16x32_bf16 v[88:91], a[68:71], a[20:23], v[88:91]
s_load_dwordx2 s[16:17], s[0:1], 0
v_lshrrev_b32 v3, 4, v1
v_mul_u32_u24 v2, 4096, v2
v_and_b32 v1, 7, v1
v_exp_f32 v84, v84
v_xor_b32 v1, v1, v3
v_mfma_f32_16x16x32_bf16 v[88:91], a[72:75], a[24:27], v[88:91]
s_and_b32 s60, s23, 1
ds_read_b128 a[68:71], v5 offset:1024
v_lshl_add_u32 v2, v1, 4, v2
v_and_b32 v1, 15, v0
v_exp_f32 v82, v82
v_exp_f32 v85, v85
v_exp_f32 v87, v87
v_mov_b32 v21, v2
v_xor_b32 v22, 64, v2
v_mfma_f32_16x16x32_bf16 v[88:91], a[76:79], a[28:31], v[88:91]
s_lshl_b32 s26, s22, 2
ds_read_b128 a[72:75], v5 offset:2048
v_mov_b32 v23, v2
v_mfma_f32_16x16x32_bf16 v[92:95], a[80:83], a[16:19], v[36:39]
s_sub_u32 s26, 50, s26
ds_read_b128 a[76:79], v5 offset:3072
ds_read_b128 a[80:83], v5 offset:4096
v_mfma_f32_16x16x32_bf16 v[92:95], a[84:87], a[20:23], v[92:95]
s_mul_i32 s3, s60, 67584
ds_read_b128 a[84:87], v5 offset:5120
v_exp_f32 v83, v83
v_exp_f32 v81, v81
v_add_u32 v22, 31744, v22
v_exp_f32 v86, v86
v_mfma_f32_16x16x32_bf16 v[92:95], a[88:91], a[24:27], v[92:95]
ds_read_b128 a[88:91], v5 offset:6144
v_add_u32 v21, s3, v21
v_mfma_f32_16x16x32_bf16 v[92:95], a[92:95], a[28:31], v[92:95]
s_min_u32 s26, s26, 36
v_xor_b32 v24, 64, v2
v_cvt_pk_bf16_f32 v53, v82, v83
v_cvt_pk_bf16_f32 v52, v80, v81
v_lshrrev_b32 v3, 1, v1
v_mfma_f32_16x16x32_bf16 v[160:163], a[112:115], v[60:63], v[160:163]
ds_read_b128 a[92:95], v5 offset:7168
v_add_u32 v22, s3, v22
v_cvt_pk_bf16_f32 v54, v84, v85
v_mfma_f32_16x16x32_bf16 v[160:163], a[96:99], v[56:59], v[160:163]
ds_read_b128 a[112:115], v5 offset:12288
ds_read_b128 a[96:99], v5 offset:8192
v_mfma_f32_16x16x32_bf16 v[164:167], a[116:119], v[60:63], v[164:167]
s_lshl_b32 s26, s26, 14
ds_read_b128 a[116:119], v5 offset:13312
v_add_u32 v23, 63488, v23
v_mfma_f32_16x16x32_bf16 v[164:167], a[100:103], v[56:59], v[164:167]
s_mul_i32 s3, s60, 63488
v_add_u32 v24, 95232, v24
v_subrev_u32 v23, s3, v23
v_mfma_f32_16x16x32_bf16 v[168:171], a[120:123], v[60:63], v[168:171]
s_waitcnt lgkmcnt(7)
ds_read_b128 a[100:103], v5 offset:9216
v_cvt_pk_bf16_f32 v55, v86, v87
v_exp_f32 v94, v94
v_mfma_f32_16x16x32_bf16 v[168:171], a[104:107], v[56:59], v[168:171]
v_subrev_u32 v24, s3, v24
v_bfe_u32 v2, v0, 4, 2
v_mfma_f32_16x16x32_bf16 v[172:175], a[124:127], v[60:63], v[172:175]
s_add_u32 s26, s26, s28
ds_read_b128 a[120:123], v5 offset:14336
ds_read_b128 a[104:107], v5 offset:10240
v_mfma_f32_16x16x32_bf16 v[172:175], a[108:111], v[56:59], v[172:175]
s_waitcnt lgkmcnt(6)
ds_read_b128 a[124:127], v5 offset:15360
ds_read_b128 a[108:111], v5 offset:11264
v_mfma_f32_16x16x32_bf16 v[80:83], a[64:67], a[0:3], v[32:35]
v_exp_f32 v93, v93
v_mfma_f32_16x16x32_bf16 v[80:83], a[68:71], a[4:7], v[80:83]
s_and_b32 s3, s22, 1
v_xor_b32 v2, v2, v3
v_lshlrev_b32 v2, 4, v2
v_mfma_f32_16x16x32_bf16 v[80:83], a[72:75], a[8:11], v[80:83]
s_lshl_b32 s3, s3, 16
v_lshl_add_u32 v2, v1, 7, v2
v_add_u32 v8, s3, v2
v_xor_b32 v10, 0x10000, v8
v_mfma_f32_16x16x32_bf16 v[80:83], a[76:79], a[12:15], v[80:83]
s_min_u32 s59, s26, s32
v_exp_f32 v90, v90
v_mfma_f32_16x16x32_bf16 v[84:87], a[80:83], a[0:3], v[32:35]
s_waitcnt lgkmcnt(4)
v_exp_f32 v91, v91
v_mfma_f32_16x16x32_bf16 v[84:87], a[84:87], a[4:7], v[84:87]
s_sub_u32 s59, s59, s39
v_exp_f32 v89, v89
v_mfma_f32_16x16x32_bf16 v[84:87], a[88:91], a[8:11], v[84:87]
s_max_i32 s59, s59, 0x8000
v_xor_b32 v9, 64, v8
v_exp_f32 v95, v95
v_mfma_f32_16x16x32_bf16 v[84:87], a[92:95], a[12:15], v[84:87]
s_sub_u32 s3, 0x20000, s3
v_exp_f32 v82, v82
v_add_u32 v13, s3, v9
v_smfmac_f32_16x16x64_bf16 a[240:243], v[112:115], v[48:55], v19
buffer_load_dwordx4 v6, s[8:11], s36 offen offset:0 sc1 lds
v_mfma_f32_16x16x32_bf16 v[144:147], a[96:99], v[48:51], v[144:147]
s_lshl2_add_u32 s34, s2, s20
v_exp_f32 v81, v81
v_cvt_pk_bf16_f32 v61, v90, v91
v_mfma_f32_16x16x32_bf16 v[144:147], a[112:115], v[52:55], v[144:147]
s_lshl_b32 s59, s59, 9
v_exp_f32 v92, v92
v_mfma_f32_16x16x32_bf16 v[148:151], a[100:103], v[48:51], v[148:151]
s_mul_i32 s34, s34, 13312
v_exp_f32 v88, v88
v_mfma_f32_16x16x32_bf16 v[148:151], a[116:119], v[52:55], v[148:151]
s_waitcnt lgkmcnt(0)
buffer_load_dwordx4 v7, s[8:11], s36 offen offset:1024 sc1 lds
v_mfma_f32_16x16x32_bf16 v[152:155], a[104:107], v[48:51], v[152:155]
s_sub_u32 s39, s39, s59
v_cvt_pk_bf16_f32 v63, v94, v95
v_add_u32 v12, s3, v8
v_mfma_f32_16x16x32_bf16 v[152:155], a[120:123], v[52:55], v[152:155]
buffer_load_dwordx4 v28, s[8:11], s36 offen offset:2048 sc1 lds
buffer_load_dwordx4 v31, s[8:11], s36 offen offset:3072 sc1 lds
v_mfma_f32_16x16x32_bf16 v[156:159], a[108:111], v[48:51], v[156:159]
s_min_u32 s3, s38, 120
v_cvt_pk_bf16_f32 v60, v88, v89
v_exp_f32 v83, v83
v_mfma_f32_16x16x32_bf16 v[156:159], a[124:127], v[52:55], v[156:159]
s_sub_u32 s59, s38, s3
v_cvt_pk_bf16_f32 v62, v92, v93
v_exp_f32 v80, v80
v_mfma_f32_16x16x32_bf16 v[88:91], a[64:67], a[16:19], v[36:39]
s_bitset1_b32 m0, 14
v_and_b32 v1, 15, v0
v_cvt_pk_bf16_f32 v48, v80, v81
v_mfma_f32_16x16x32_bf16 v[88:91], a[68:71], a[20:23], v[88:91]
s_add_u32 s34, s34, 83890176
ds_read_b128 a[64:67], v5 offset:16384
ds_read_b128 a[68:71], v5 offset:17408
v_xor_b32 v11, 0x10000, v9
v_mfma_f32_16x16x32_bf16 v[88:91], a[72:75], a[24:27], v[88:91]
buffer_store_dwordx4 a[160:163], v4, s[40:43], s34 offen offset:0 sc1
v_mfma_f32_16x16x32_bf16 v[88:91], a[76:79], a[28:31], v[88:91]
s_add_u32 s27, s27, 1
ds_read_b128 a[72:75], v5 offset:18432
ds_read_b128 a[76:79], v5 offset:19456
v_mfma_f32_16x16x32_bf16 v[92:95], a[80:83], a[16:19], v[36:39]
s_add_u32 s3, s38, s60
v_exp_f32 v86, v86
v_mfma_f32_16x16x32_bf16 v[92:95], a[84:87], a[20:23], v[92:95]
ds_read_b128 a[80:83], v5 offset:20480
ds_read_b128 a[84:87], v5 offset:21504
v_mfma_f32_16x16x32_bf16 v[92:95], a[88:91], a[24:27], v[92:95]
s_sub_u32 s36, s36, s61
ds_read_b128 a[88:91], v5 offset:22528
buffer_load_dwordx4 v6, s[8:11], s36 offen offset:0 sc1 lds
v_mfma_f32_16x16x32_bf16 v[92:95], a[92:95], a[28:31], v[92:95]
ds_read_b128 a[92:95], v5 offset:23552
v_exp_f32 v87, v87
v_smfmac_f32_16x16x64_bf16 a[244:247], v[112:115], v[56:63], v19
s_lshl_b32 s3, s3, 5
v_exp_f32 v84, v84
v_mfma_f32_16x16x32_bf16 v[176:179], a[96:99], v[56:59], v[176:179]
ds_read_b128 a[96:99], v5 offset:24576
buffer_store_dwordx4 a[160:163], v4, s[40:43], s34 offen offset:1024 sc1
v_mfma_f32_16x16x32_bf16 v[176:179], a[112:115], v[60:63], v[176:179]
ds_read_b128 a[112:115], v5 offset:28672
v_exp_f32 v89, v89
v_mfma_f32_16x16x32_bf16 v[180:183], a[100:103], v[56:59], v[180:183]
s_lshl_b32 s59, s59, 5
ds_read_b128 a[100:103], v5 offset:25600
buffer_load_dwordx4 v7, s[8:11], s36 offen offset:1024 sc1 lds
v_mfma_f32_16x16x32_bf16 v[180:183], a[116:119], v[60:63], v[180:183]
v_cvt_pk_bf16_f32 v49, v82, v83
v_lshl_add_u32 v1, v1, 1, s3
v_mfma_f32_16x16x32_bf16 v[184:187], a[104:107], v[56:59], v[184:187]
s_waitcnt lgkmcnt(7)
buffer_store_dwordx4 a[160:163], v4, s[40:43], s34 offen offset:2048 sc1
v_mfma_f32_16x16x32_bf16 v[184:187], a[120:123], v[60:63], v[184:187]
ds_read_b128 a[116:119], v5 offset:29696
ds_read_b128 a[104:107], v5 offset:26624
v_mfma_f32_16x16x32_bf16 v[188:191], a[108:111], v[56:59], v[188:191]
v_exp_f32 v91, v91
v_mfma_f32_16x16x32_bf16 v[188:191], a[124:127], v[60:63], v[188:191]
ds_read_b128 a[120:123], v5 offset:30720
ds_read_b128 a[108:111], v5 offset:27648
buffer_load_dwordx4 v28, s[8:11], s36 offen offset:2048 sc1 lds
v_mfma_f32_16x16x32_bf16 v[80:83], a[64:67], a[0:3], v[32:35]
ds_read_b128 a[124:127], v5 offset:31744
v_exp_f32 v85, v85
v_mfma_f32_16x16x32_bf16 v[80:83], a[68:71], a[4:7], v[80:83]
buffer_store_dwordx4 a[160:163], v4, s[40:43], s34 offen offset:3072 sc1
v_mfma_f32_16x16x32_bf16 v[80:83], a[72:75], a[8:11], v[80:83]
v_exp_f32 v90, v90
v_cvt_pk_bf16_f32 v51, v86, v87
v_cvt_pk_bf16_f32 v50, v84, v85
v_subrev_u32 v2, s59, v1
v_mfma_f32_16x16x32_bf16 v[80:83], a[76:79], a[12:15], v[80:83]
s_waitcnt lgkmcnt(8)
buffer_load_dwordx4 v31, s[8:11], s36 offen offset:3072 sc1 lds
v_mfma_f32_16x16x32_bf16 v[84:87], a[80:83], a[0:3], v[32:35]
s_waitcnt lgkmcnt(4)
v_exp_f32 v93, v93
v_mfma_f32_16x16x32_bf16 v[84:87], a[84:87], a[4:7], v[84:87]
s_waitcnt lgkmcnt(0)
v_exp_f32 v95, v95
v_mfma_f32_16x16x32_bf16 v[84:87], a[88:91], a[8:11], v[84:87]
s_and_b32 m0, s39, 0x1ffff
v_exp_f32 v94, v94
v_mfma_f32_16x16x32_bf16 v[84:87], a[92:95], a[12:15], v[84:87]
global_load_ushort v116, v1, s[4:5] offset:0
v_mfma_f32_16x16x32_bf16 v[128:131], a[112:115], v[52:55], v[128:131]
global_load_ushort v117, v1, s[4:5] offset:64
v_mfma_f32_16x16x32_bf16 v[128:131], a[96:99], v[48:51], v[128:131]
global_load_ushort v118, v1, s[4:5] offset:128
v_mfma_f32_16x16x32_bf16 v[132:135], a[116:119], v[52:55], v[132:135]
global_load_ushort v119, v2, s[4:5] offset:192
v_mfma_f32_16x16x32_bf16 v[132:135], a[100:103], v[48:51], v[132:135]
v_exp_f32 v88, v88
v_mfma_f32_16x16x32_bf16 v[136:139], a[120:123], v[52:55], v[136:139]
s_sub_u32 s36, s36, s61
v_cvt_pk_bf16_f32 v59, v94, v95
v_exp_f32 v92, v92
v_mfma_f32_16x16x32_bf16 v[136:139], a[104:107], v[48:51], v[136:139]
v_cvt_pk_bf16_f32 v56, v88, v89
v_cvt_pk_bf16_f32 v57, v90, v91
v_mfma_f32_16x16x32_bf16 v[140:143], a[124:127], v[52:55], v[140:143]
s_add_u32 s39, s39, 0x1008000
v_cvt_pk_bf16_f32 v58, v92, v93
v_and_or_b32 v5, s39, v20, v4
v_mfma_f32_16x16x32_bf16 v[140:143], a[108:111], v[48:51], v[140:143]
s_cbranch_scc0 kf_kernel_loopB
s_branch kf_kernel_loopBx
kf_kernel_hB6:
s_cmp_ge_u32 s15, 10158080
s_cbranch_scc1 kf_kernel_hB6n
kf_kernel_hB6f:
v_bfe_u32 v1, v0, 2, 4
v_mfma_f32_16x16x32_bf16 v[88:91], a[64:67], a[16:19], v[36:39]
s_waitcnt vmcnt(16) lgkmcnt(0)
v_lshlrev_b32 v2, 8, v1
s_barrier
v_and_b32 v1, 7, v1
v_mfma_f32_16x16x32_bf16 v[88:91], a[68:71], a[20:23], v[88:91]
ds_read_b128 a[64:67], v5 offset:0
buffer_load_dwordx4 v6, s[8:11], s36 offen offset:0 sc1 lds
v_mfma_f32_16x16x32_bf16 v[88:91], a[72:75], a[24:27], v[88:91]
s_add_u32 s29, s25, 0x20000
v_exp_f32 v80, v80
v_lshl_add_u32 v2, v1, 5, v2
v_and_b32 v1, 3, v0
v_lshl_add_u32 v2, v1, 3, v2
v_add_u32 v120, s29, v2
v_exp_f32 v81, v81
v_mfma_f32_16x16x32_bf16 v[88:91], a[76:79], a[28:31], v[88:91]
s_lshl2_add_u32 s34, s2, s20
ds_read_b128 a[68:71], v5 offset:1024
ds_read_b128 a[72:75], v5 offset:2048
v_exp_f32 v82, v82
v_mfma_f32_16x16x32_bf16 v[92:95], a[80:83], a[16:19], v[36:39]
s_mul_i32 s34, s34, 13312
ds_read_b128 a[76:79], v5 offset:3072
ds_read_b128 a[80:83], v5 offset:4096
v_mfma_f32_16x16x32_bf16 v[92:95], a[84:87], a[20:23], v[92:95]
buffer_load_dwordx4 v7, s[8:11], s36 offen offset:1024 sc1 lds
v_mfma_f32_16x16x32_bf16 v[92:95], a[88:91], a[24:27], v[92:95]
ds_read_b128 a[84:87], v5 offset:5120
v_xor_b32 v121, 32, v120
v_xor_b32 v127, 224, v120
v_exp_f32 v83, v83
v_mfma_f32_16x16x32_bf16 v[92:95], a[92:95], a[28:31], v[92:95]
v_xor_b32 v123, 96, v120
v_cvt_pk_bf16_f32 v52, v80, v81
v_mfma_f32_16x16x32_bf16 v[160:163], a[112:115], v[60:63], v[160:163]
buffer_load_dwordx4 v28, s[8:11], s36 offen offset:2048 sc1 lds
ds_read_b128 a[88:91], v5 offset:6144
ds_read_b128 a[92:95], v5 offset:7168
ds_read_b128 a[112:115], v5 offset:12288
v_mfma_f32_16x16x32_bf16 v[160:163], a[96:99], v[56:59], v[160:163]
s_add_u32 s34, s34, 83894272
ds_read_b128 a[96:99], v5 offset:8192
s_waitcnt vmcnt(18)
v_exp_f32 v84, v84
v_mfma_f32_16x16x32_bf16 v[164:167], a[116:119], v[60:63], v[164:167]
ds_read_b128 a[116:119], v5 offset:13312
buffer_store_dwordx4 a[160:163], v4, s[40:43], s34 offen offset:0 sc1
ds_read_b64_tr_b16 a[128:129], v120 offset:0
ds_read_b64_tr_b16 a[130:131], v120 offset:4096
v_xor_b32 v122, 64, v120
v_mfma_f32_16x16x32_bf16 v[164:167], a[100:103], v[56:59], v[164:167]
ds_read_b128 a[100:103], v5 offset:9216
ds_read_b64_tr_b16 a[132:133], v121 offset:0
v_exp_f32 v88, v88
v_exp_f32 v87, v87
v_mfma_f32_16x16x32_bf16 v[168:171], a[120:123], v[60:63], v[168:171]
s_waitcnt lgkmcnt(9)
ds_read_b64_tr_b16 a[134:135], v121 offset:4096
ds_read_b128 a[120:123], v5 offset:14336
v_cvt_pk_bf16_f32 v53, v82, v83
v_mfma_f32_16x16x32_bf16 v[168:171], a[104:107], v[56:59], v[168:171]
v_exp_f32 v86, v86
v_xor_b32 v124, 128, v120
v_mfma_f32_16x16x32_bf16 v[172:175], a[124:127], v[60:63], v[172:175]
s_add_u32 s27, s27, 1
ds_read_b128 a[104:107], v5 offset:10240
ds_read_b128 a[124:127], v5 offset:15360
ds_read_b64_tr_b16 a[136:137], v122 offset:0
v_mfma_f32_16x16x32_bf16 v[172:175], a[108:111], v[56:59], v[172:175]
ds_read_b128 a[108:111], v5 offset:11264
buffer_load_dwordx4 v31, s[8:11], s36 offen offset:3072 sc1 lds
v_exp_f32 v91, v91
v_mfma_f32_16x16x32_bf16 v[80:83], a[64:67], a[0:3], v[32:35]
s_sub_u32 s36, s36, s61
ds_read_b64_tr_b16 a[138:139], v122 offset:4096
ds_read_b64_tr_b16 a[140:141], v123 offset:0
ds_read_b64_tr_b16 a[142:143], v123 offset:4096
ds_read_b64_tr_b16 a[144:145], v124 offset:0
ds_read_b64_tr_b16 a[146:147], v124 offset:4096
v_xor_b32 v125, 160, v120
v_mfma_f32_16x16x32_bf16 v[80:83], a[68:71], a[4:7], v[80:83]
s_waitcnt lgkmcnt(14)
ds_read_b64_tr_b16 a[148:149], v125 offset:0
ds_read_b64_tr_b16 a[150:151], v125 offset:4096
v_exp_f32 v85, v85
v_mfma_f32_16x16x32_bf16 v[80:83], a[72:75], a[8:11], v[80:83]
s_bitset1_b32 m0, 14
v_cvt_pk_bf16_f32 v55, v86, v87
v_exp_f32 v94, v94
v_exp_f32 v90, v90
v_mfma_f32_16x16x32_bf16 v[80:83], a[76:79], a[12:15], v[80:83]
s_waitcnt lgkmcnt(14)
v_xor_b32 v126, 192, v120
v_cvt_pk_bf16_f32 v54, v84, v85
v_mfma_f32_16x16x32_bf16 v[84:87], a[80:83], a[0:3], v[32:35]
buffer_load_dwordx4 v6, s[8:11], s36 offen offset:0 sc1 lds
v_mfma_f32_16x16x32_bf16 v[84:87], a[84:87], a[4:7], v[84:87]
s_waitcnt lgkmcnt(4)
ds_read_b64_tr_b16 a[152:153], v126 offset:0
ds_read_b64_tr_b16 a[154:155], v126 offset:4096
ds_read_b64_tr_b16 a[156:157], v127 offset:0
ds_read_b64_tr_b16 a[158:159], v127 offset:4096
v_exp_f32 v81, v81
v_mfma_f32_16x16x32_bf16 v[84:87], a[88:91], a[8:11], v[84:87]
buffer_store_dwordx4 a[160:163], v4, s[40:43], s34 offen offset:1024 sc1
v_mfma_f32_16x16x32_bf16 v[84:87], a[92:95], a[12:15], v[84:87]
s_add_u32 s15, s15, 104857600
v_exp_f32 v95, v95
v_smfmac_f32_16x16x64_bf16 a[240:243], v[112:115], v[48:55], v19
v_exp_f32 v89, v89
v_mfma_f32_16x16x32_bf16 v[144:147], a[96:99], v[48:51], v[144:147]
s_waitcnt lgkmcnt(11)
v_exp_f32 v92, v92
v_mfma_f32_16x16x32_bf16 v[144:147], a[112:115], v[52:55], v[144:147]
v_exp_f32 v87, v87
v_mfma_f32_16x16x32_bf16 v[148:151], a[100:103], v[48:51], v[148:151]
buffer_load_dwordx4 v7, s[8:11], s36 offen offset:1024 sc1 lds
v_mfma_f32_16x16x32_bf16 v[148:151], a[116:119], v[52:55], v[148:151]
s_add_u32 s26, s39, 65536
v_exp_f32 v86, v86
v_mfma_f32_16x16x32_bf16 v[152:155], a[104:107], v[48:51], v[152:155]
buffer_store_dwordx4 a[128:131], v4, s[40:43], s15 offen offset:0 sc1
v_cvt_pk_bf16_f32 v60, v88, v89
v_mfma_f32_16x16x32_bf16 v[152:155], a[120:123], v[52:55], v[152:155]
s_waitcnt lgkmcnt(0)
v_exp_f32 v93, v93
v_mfma_f32_16x16x32_bf16 v[156:159], a[108:111], v[48:51], v[156:159]
s_min_u32 s59, s26, s32
v_cvt_pk_bf16_f32 v62, v92, v93
v_cvt_pk_bf16_f32 v61, v90, v91
v_mfma_f32_16x16x32_bf16 v[156:159], a[124:127], v[52:55], v[156:159]
buffer_store_dwordx4 a[132:135], v4, s[40:43], s15 offen offset:1024 sc1
v_mfma_f32_16x16x32_bf16 v[88:91], a[64:67], a[16:19], v[36:39]
v_exp_f32 v85, v85
v_mfma_f32_16x16x32_bf16 v[88:91], a[68:71], a[20:23], v[88:91]
ds_read_b128 a[64:67], v5 offset:16384
ds_read_b128 a[68:71], v5 offset:17408
v_mfma_f32_16x16x32_bf16 v[88:91], a[72:75], a[24:27], v[88:91]
ds_read_b128 a[72:75], v5 offset:18432
v_exp_f32 v84, v84
v_mfma_f32_16x16x32_bf16 v[88:91], a[76:79], a[28:31], v[88:91]
buffer_store_dwordx4 a[160:163], v4, s[40:43], s34 offen offset:2048 sc1
v_cvt_pk_bf16_f32 v63, v94, v95
v_mfma_f32_16x16x32_bf16 v[92:95], a[80:83], a[16:19], v[36:39]
s_mov_b32 s3, 3178496
v_exp_f32 v80, v80
v_mfma_f32_16x16x32_bf16 v[92:95], a[84:87], a[20:23], v[92:95]
buffer_store_dwordx4 a[136:139], v4, s[40:43], s15 offen offset:2048 sc1
v_mfma_f32_16x16x32_bf16 v[92:95], a[88:91], a[24:27], v[92:95]
ds_read_b128 a[76:79], v5 offset:19456
ds_read_b128 a[80:83], v5 offset:20480
ds_read_b128 a[84:87], v5 offset:21504
ds_read_b128 a[88:91], v5 offset:22528
v_mfma_f32_16x16x32_bf16 v[92:95], a[92:95], a[28:31], v[92:95]
buffer_load_dwordx4 v28, s[8:11], s36 offen offset:2048 sc1 lds
v_smfmac_f32_16x16x64_bf16 a[244:247], v[112:115], v[56:63], v19
s_sub_u32 s59, s59, s39
v_cvt_pk_bf16_f32 v50, v84, v85
v_lshlrev_b32 v2, 4, v4
v_mfma_f32_16x16x32_bf16 v[176:179], a[96:99], v[56:59], v[176:179]
ds_read_b128 a[92:95], v5 offset:23552
v_exp_f32 v83, v83
v_mfma_f32_16x16x32_bf16 v[176:179], a[112:115], v[60:63], v[176:179]
ds_read_b128 a[96:99], v5 offset:24576
ds_read_b128 a[112:115], v5 offset:28672
v_mfma_f32_16x16x32_bf16 v[180:183], a[100:103], v[56:59], v[180:183]
s_waitcnt lgkmcnt(6)
ds_read_b128 a[100:103], v5 offset:25600
buffer_store_dwordx4 a[140:143], v4, s[40:43], s15 offen offset:3072 sc1
v_mfma_f32_16x16x32_bf16 v[180:183], a[116:119], v[60:63], v[180:183]
s_branch kf_kernel_pl25
kf_kernel_pd25:
s_branch kf_kernel_idle
kf_kernel_pl25:
v_exp_f32 v82, v82
v_mfma_f32_16x16x32_bf16 v[184:187], a[104:107], v[56:59], v[184:187]
ds_read_b128 a[116:119], v5 offset:29696
ds_read_b128 a[104:107], v5 offset:26624
v_mfma_f32_16x16x32_bf16 v[184:187], a[120:123], v[60:63], v[184:187]
s_add_u32 s15, s15, 4096
ds_read_b128 a[120:123], v5 offset:30720
buffer_store_dwordx4 a[144:147], v4, s[40:43], s15 offen offset:0 sc1
v_mfma_f32_16x16x32_bf16 v[188:191], a[108:111], v[56:59], v[188:191]
ds_read_b128 a[108:111], v5 offset:27648
v_cvt_pk_bf16_f32 v51, v86, v87
v_cvt_pk_bf16_f32 v49, v82, v83
v_exp_f32 v90, v90
v_mfma_f32_16x16x32_bf16 v[188:191], a[124:127], v[60:63], v[188:191]
ds_read_b128 a[124:127], v5 offset:31744
v_cvt_pk_bf16_f32 v48, v80, v81
v_mfma_f32_16x16x32_bf16 v[80:83], a[64:67], a[0:3], v[32:35]
s_waitcnt lgkmcnt(8)
buffer_store_dwordx4 a[148:151], v4, s[40:43], s15 offen offset:1024 sc1
v_mfma_f32_16x16x32_bf16 v[80:83], a[68:71], a[4:7], v[80:83]
s_lshl_b32 s59, s59, 9
v_exp_f32 v89, v89
v_mfma_f32_16x16x32_bf16 v[80:83], a[72:75], a[8:11], v[80:83]
buffer_store_dwordx4 a[160:163], v4, s[40:43], s34 offen offset:3072 sc1
v_mfma_f32_16x16x32_bf16 v[80:83], a[76:79], a[12:15], v[80:83]
v_exp_f32 v92, v92
v_mfma_f32_16x16x32_bf16 v[84:87], a[80:83], a[0:3], v[32:35]
s_waitcnt lgkmcnt(4)
v_exp_f32 v91, v91
v_mfma_f32_16x16x32_bf16 v[84:87], a[84:87], a[4:7], v[84:87]
buffer_load_dwordx4 v31, s[8:11], s36 offen offset:3072 sc1 lds
v_mfma_f32_16x16x32_bf16 v[84:87], a[88:91], a[8:11], v[84:87]
s_sub_u32 s39, s39, s59
v_exp_f32 v93, v93
v_mfma_f32_16x16x32_bf16 v[84:87], a[92:95], a[12:15], v[84:87]
s_sub_u32 s36, s36, s61
v_exp_f32 v95, v95
v_mfma_f32_16x16x32_bf16 v[128:131], a[112:115], v[52:55], v[128:131]
buffer_store_dwordx4 a[152:155], v4, s[40:43], s15 offen offset:2048 sc1
v_mfma_f32_16x16x32_bf16 v[128:131], a[96:99], v[48:51], v[128:131]
s_waitcnt lgkmcnt(0)
buffer_store_dwordx4 a[156:159], v4, s[40:43], s15 offen offset:3072 sc1
v_mfma_f32_16x16x32_bf16 v[132:135], a[116:119], v[52:55], v[132:135]
s_and_b32 m0, s39, 0x1ffff
v_exp_f32 v94, v94
v_mfma_f32_16x16x32_bf16 v[132:135], a[100:103], v[48:51], v[132:135]
v_exp_f32 v88, v88
v_mfma_f32_16x16x32_bf16 v[136:139], a[120:123], v[52:55], v[136:139]
v_cvt_pk_bf16_f32 v59, v94, v95
v_cvt_pk_bf16_f32 v57, v90, v91
v_mfma_f32_16x16x32_bf16 v[136:139], a[104:107], v[48:51], v[136:139]
s_add_u32 s39, s39, 0x1008000
v_and_or_b32 v5, s39, v20, v4
v_cvt_pk_bf16_f32 v58, v92, v93
v_mfma_f32_16x16x32_bf16 v[140:143], a[124:127], v[52:55], v[140:143]
buffer_load_dword v30, v2, s[40:43], s3 offen sc1
v_cvt_pk_bf16_f32 v56, v88, v89
v_mfma_f32_16x16x32_bf16 v[140:143], a[108:111], v[48:51], v[140:143]
s_cbranch_scc0 kf_kernel_loopB
s_branch kf_kernel_loopBx
kf_kernel_pd26:
s_branch kf_kernel_idle
kf_kernel_hB6n:
v_mfma_f32_16x16x32_bf16 v[88:91], a[64:67], a[16:19], v[36:39]
s_waitcnt vmcnt(16) lgkmcnt(0)
s_barrier
v_exp_f32 v82, v82
v_mfma_f32_16x16x32_bf16 v[88:91], a[68:71], a[20:23], v[88:91]
buffer_load_dwordx4 v6, s[8:11], s36 offen offset:0 sc1 lds
v_mfma_f32_16x16x32_bf16 v[88:91], a[72:75], a[24:27], v[88:91]
s_add_u32 s26, s39, 65536
ds_read_b128 a[64:67], v5 offset:0
v_exp_f32 v83, v83
v_mfma_f32_16x16x32_bf16 v[88:91], a[76:79], a[28:31], v[88:91]
ds_read_b128 a[68:71], v5 offset:1024
ds_read_b128 a[72:75], v5 offset:2048
v_mfma_f32_16x16x32_bf16 v[92:95], a[80:83], a[16:19], v[36:39]
ds_read_b128 a[76:79], v5 offset:3072
v_exp_f32 v86, v86
v_mfma_f32_16x16x32_bf16 v[92:95], a[84:87], a[20:23], v[92:95]
ds_read_b128 a[80:83], v5 offset:4096
ds_read_b128 a[84:87], v5 offset:5120
v_mfma_f32_16x16x32_bf16 v[92:95], a[88:91], a[24:27], v[92:95]
s_lshl2_add_u32 s34, s2, s20
ds_read_b128 a[88:91], v5 offset:6144
buffer_load_dwordx4 v7, s[8:11], s36 offen offset:1024 sc1 lds
v_exp_f32 v80, v80
v_mfma_f32_16x16x32_bf16 v[92:95], a[92:95], a[28:31], v[92:95]
s_add_u32 s27, s27, 1
v_exp_f32 v88, v88
v_mfma_f32_16x16x32_bf16 v[160:163], a[112:115], v[60:63], v[160:163]
s_mul_i32 s34, s34, 13312
ds_read_b128 a[92:95], v5 offset:7168
ds_read_b128 a[112:115], v5 offset:12288
v_mfma_f32_16x16x32_bf16 v[160:163], a[96:99], v[56:59], v[160:163]
s_add_u32 s34, s34, 83894272
v_exp_f32 v81, v81
v_mfma_f32_16x16x32_bf16 v[164:167], a[116:119], v[60:63], v[164:167]
s_waitcnt lgkmcnt(5)
ds_read_b128 a[96:99], v5 offset:8192
ds_read_b128 a[116:119], v5 offset:13312
v_cvt_pk_bf16_f32 v52, v80, v81
v_mfma_f32_16x16x32_bf16 v[164:167], a[100:103], v[56:59], v[164:167]
buffer_load_dwordx4 v28, s[8:11], s36 offen offset:2048 sc1 lds
v_mfma_f32_16x16x32_bf16 v[168:171], a[120:123], v[60:63], v[168:171]
ds_read_b128 a[100:103], v5 offset:9216
ds_read_b128 a[120:123], v5 offset:14336
v_mfma_f32_16x16x32_bf16 v[168:171], a[104:107], v[56:59], v[168:171]
ds_read_b128 a[104:107], v5 offset:10240
v_exp_f32 v84, v84
v_cvt_pk_bf16_f32 v53, v82, v83
v_mfma_f32_16x16x32_bf16 v[172:175], a[124:127], v[60:63], v[172:175]
buffer_store_dwordx4 a[160:163], v4, s[40:43], s34 offen offset:0 sc1
v_mfma_f32_16x16x32_bf16 v[172:175], a[108:111], v[56:59], v[172:175]
ds_read_b128 a[124:127], v5 offset:15360
ds_read_b128 a[108:111], v5 offset:11264
v_exp_f32 v87, v87
v_mfma_f32_16x16x32_bf16 v[80:83], a[64:67], a[0:3], v[32:35]
s_waitcnt lgkmcnt(8)
v_exp_f32 v89, v89
v_mfma_f32_16x16x32_bf16 v[80:83], a[68:71], a[4:7], v[80:83]
v_exp_f32 v85, v85
v_mfma_f32_16x16x32_bf16 v[80:83], a[72:75], a[8:11], v[80:83]
v_cvt_pk_bf16_f32 v55, v86, v87
v_cvt_pk_bf16_f32 v54, v84, v85
v_mfma_f32_16x16x32_bf16 v[80:83], a[76:79], a[12:15], v[80:83]
buffer_load_dwordx4 v31, s[8:11], s36 offen offset:3072 sc1 lds
v_mfma_f32_16x16x32_bf16 v[84:87], a[80:83], a[0:3], v[32:35]
v_exp_f32 v94, v94
v_cvt_pk_bf16_f32 v60, v88, v89
v_mfma_f32_16x16x32_bf16 v[84:87], a[84:87], a[4:7], v[84:87]
s_sub_u32 s36, s36, s61
v_exp_f32 v91, v91
v_mfma_f32_16x16x32_bf16 v[84:87], a[88:91], a[8:11], v[84:87]
s_waitcnt lgkmcnt(4)
v_exp_f32 v90, v90
v_mfma_f32_16x16x32_bf16 v[84:87], a[92:95], a[12:15], v[84:87]
v_exp_f32 v80, v80
v_smfmac_f32_16x16x64_bf16 a[240:243], v[112:115], v[48:55], v19
s_bitset1_b32 m0, 14
v_exp_f32 v83, v83
v_mfma_f32_16x16x32_bf16 v[144:147], a[96:99], v[48:51], v[144:147]
buffer_load_dwordx4 v6, s[8:11], s36 offen offset:0 sc1 lds
v_mfma_f32_16x16x32_bf16 v[144:147], a[112:115], v[52:55], v[144:147]
v_exp_f32 v92, v92
v_mfma_f32_16x16x32_bf16 v[148:151], a[100:103], v[48:51], v[148:151]
s_waitcnt lgkmcnt(0)
v_exp_f32 v93, v93
v_mfma_f32_16x16x32_bf16 v[148:151], a[116:119], v[52:55], v[148:151]
v_exp_f32 v95, v95
v_mfma_f32_16x16x32_bf16 v[152:155], a[104:107], v[48:51], v[152:155]
v_cvt_pk_bf16_f32 v63, v94, v95
v_cvt_pk_bf16_f32 v61, v90, v91
v_mfma_f32_16x16x32_bf16 v[152:155], a[120:123], v[52:55], v[152:155]
v_exp_f32 v82, v82
v_mfma_f32_16x16x32_bf16 v[156:159], a[108:111], v[48:51], v[156:159]
s_min_u32 s59, s26, s32
v_exp_f32 v85, v85
v_cvt_pk_bf16_f32 v62, v92, v93
v_mfma_f32_16x16x32_bf16 v[156:159], a[124:127], v[52:55], v[156:159]
buffer_store_dwordx4 a[160:163], v4, s[40:43], s34 offen offset:1024 sc1
v_mfma_f32_16x16x32_bf16 v[88:91], a[64:67], a[16:19], v[36:39]
v_exp_f32 v81, v81
v_mfma_f32_16x16x32_bf16 v[88:91], a[68:71], a[20:23], v[88:91]
s_sub_u32 s59, s59, s39
ds_read_b128 a[64:67], v5 offset:16384
ds_read_b128 a[68:71], v5 offset:17408
v_mfma_f32_16x16x32_bf16 v[88:91], a[72:75], a[24:27], v[88:91]
buffer_load_dwordx4 v7, s[8:11], s36 offen offset:1024 sc1 lds
v_mfma_f32_16x16x32_bf16 v[88:91], a[76:79], a[28:31], v[88:91]
s_lshl_b32 s59, s59, 9
ds_read_b128 a[72:75], v5 offset:18432
ds_read_b128 a[76:79], v5 offset:19456
v_mfma_f32_16x16x32_bf16 v[92:95], a[80:83], a[16:19], v[36:39]
buffer_store_dwordx4 a[160:163], v4, s[40:43], s34 offen offset:2048 sc1
v_mfma_f32_16x16x32_bf16 v[92:95], a[84:87], a[20:23], v[92:95]
s_mov_b32 s3, 3178496
ds_read_b128 a[80:83], v5 offset:20480
ds_read_b128 a[84:87], v5 offset:21504
v_mfma_f32_16x16x32_bf16 v[92:95], a[88:91], a[24:27], v[92:95]
v_cvt_pk_bf16_f32 v49, v82, v83
v_exp_f32 v84, v84
v_mfma_f32_16x16x32_bf16 v[92:95], a[92:95], a[28:31], v[92:95]
ds_read_b128 a[88:91], v5 offset:22528
ds_read_b128 a[92:95], v5 offset:23552
v_smfmac_f32_16x16x64_bf16 a[244:247], v[112:115], v[56:63], v19
v_exp_f32 v89, v89
v_mfma_f32_16x16x32_bf16 v[176:179], a[96:99], v[56:59], v[176:179]
buffer_load_dwordx4 v28, s[8:11], s36 offen offset:2048 sc1 lds
v_mfma_f32_16x16x32_bf16 v[176:179], a[112:115], v[60:63], v[176:179]
ds_read_b128 a[96:99], v5 offset:24576
ds_read_b128 a[112:115], v5 offset:28672
v_mfma_f32_16x16x32_bf16 v[180:183], a[100:103], v[56:59], v[180:183]
s_waitcnt lgkmcnt(6)
buffer_store_dwordx4 a[160:163], v4, s[40:43], s34 offen offset:3072 sc1
v_mfma_f32_16x16x32_bf16 v[180:183], a[116:119], v[60:63], v[180:183]
ds_read_b128 a[100:103], v5 offset:25600
ds_read_b128 a[116:119], v5 offset:29696
v_mfma_f32_16x16x32_bf16 v[184:187], a[104:107], v[56:59], v[184:187]
v_exp_f32 v87, v87
v_mfma_f32_16x16x32_bf16 v[184:187], a[120:123], v[60:63], v[184:187]
ds_read_b128 a[104:107], v5 offset:26624
ds_read_b128 a[120:123], v5 offset:30720
v_mfma_f32_16x16x32_bf16 v[188:191], a[108:111], v[56:59], v[188:191]
v_exp_f32 v86, v86
v_mfma_f32_16x16x32_bf16 v[188:191], a[124:127], v[60:63], v[188:191]
ds_read_b128 a[108:111], v5 offset:27648
v_cvt_pk_bf16_f32 v48, v80, v81
v_mfma_f32_16x16x32_bf16 v[80:83], a[64:67], a[0:3], v[32:35]
s_waitcnt lgkmcnt(7)
v_exp_f32 v88, v88
v_mfma_f32_16x16x32_bf16 v[80:83], a[68:71], a[4:7], v[80:83]
v_exp_f32 v93, v93
v_mfma_f32_16x16x32_bf16 v[80:83], a[72:75], a[8:11], v[80:83]
v_exp_f32 v90, v90
v_mfma_f32_16x16x32_bf16 v[80:83], a[76:79], a[12:15], v[80:83]
v_cvt_pk_bf16_f32 v51, v86, v87
v_cvt_pk_bf16_f32 v50, v84, v85
v_mfma_f32_16x16x32_bf16 v[84:87], a[80:83], a[0:3], v[32:35]
s_waitcnt lgkmcnt(3)
buffer_load_dwordx4 v31, s[8:11], s36 offen offset:3072 sc1 lds
v_mfma_f32_16x16x32_bf16 v[84:87], a[84:87], a[4:7], v[84:87]
ds_read_b128 a[124:127], v5 offset:31744
v_lshlrev_b32 v2, 4, v4
v_mfma_f32_16x16x32_bf16 v[84:87], a[88:91], a[8:11], v[84:87]
s_sub_u32 s36, s36, s61
v_exp_f32 v94, v94
v_mfma_f32_16x16x32_bf16 v[84:87], a[92:95], a[12:15], v[84:87]
v_exp_f32 v91, v91
v_mfma_f32_16x16x32_bf16 v[128:131], a[112:115], v[52:55], v[128:131]
v_exp_f32 v92, v92
v_mfma_f32_16x16x32_bf16 v[128:131], a[96:99], v[48:51], v[128:131]
s_sub_u32 s39, s39, s59
v_cvt_pk_bf16_f32 v57, v90, v91
s_and_b32 m0, s39, 0x1ffff
v_mfma_f32_16x16x32_bf16 v[132:135], a[116:119], v[52:55], v[132:135]
s_add_u32 s39, s39, 0x1008000
v_and_or_b32 v5, s39, v20, v4
v_mfma_f32_16x16x32_bf16 v[132:135], a[100:103], v[48:51], v[132:135]
s_waitcnt lgkmcnt(0)
buffer_load_dword v30, v2, s[40:43], s3 offen sc1
v_mfma_f32_16x16x32_bf16 v[136:139], a[120:123], v[52:55], v[136:139]
v_exp_f32 v95, v95
v_mfma_f32_16x16x32_bf16 v[136:139], a[104:107], v[48:51], v[136:139]
v_cvt_pk_bf16_f32 v56, v88, v89
v_mfma_f32_16x16x32_bf16 v[140:143], a[124:127], v[52:55], v[140:143]
v_cvt_pk_bf16_f32 v59, v94, v95
v_cvt_pk_bf16_f32 v58, v92, v93
v_mfma_f32_16x16x32_bf16 v[140:143], a[108:111], v[48:51], v[140:143]
s_cbranch_scc0 kf_kernel_loopB
s_branch kf_kernel_loopBx
kf_kernel_pd27:
s_branch kf_kernel_idle
kf_kernel_hB7:
v_mfma_f32_16x16x32_bf16 v[88:91], a[64:67], a[16:19], v[36:39]
s_waitcnt vmcnt(16) lgkmcnt(0)
s_barrier
ds_read_b128 a[64:67], v5 offset:0
v_mfma_f32_16x16x32_bf16 v[88:91], a[68:71], a[20:23], v[88:91]
s_sub_u32 s98, s98, kf_kernel_last-65536-kf_kernel_drain
v_exp_f32 v84, v84
v_mfma_f32_16x16x32_bf16 v[88:91], a[72:75], a[24:27], v[88:91]
s_subb_u32 s99, s99, 0
ds_read_b128 a[68:71], v5 offset:1024
ds_read_b128 a[72:75], v5 offset:2048
v_exp_f32 v86, v86
v_mfma_f32_16x16x32_bf16 v[88:91], a[76:79], a[28:31], v[88:91]
s_add_u32 s26, s39, 32768
ds_read_b128 a[76:79], v5 offset:3072
global_load_dword a236, v4, s[98:99]
v_mfma_f32_16x16x32_bf16 v[92:95], a[80:83], a[16:19], v[36:39]
s_add_u32 s27, s27, 1
v_exp_f32 v85, v85
v_mfma_f32_16x16x32_bf16 v[92:95], a[84:87], a[20:23], v[92:95]
ds_read_b128 a[80:83], v5 offset:4096
ds_read_b128 a[84:87], v5 offset:5120
buffer_load_dwordx4 v6, s[8:11], s36 offen offset:0 sc1 lds
v_mfma_f32_16x16x32_bf16 v[92:95], a[88:91], a[24:27], v[92:95]
s_min_u32 s59, s26, s32
v_exp_f32 v80, v80
v_mfma_f32_16x16x32_bf16 v[92:95], a[92:95], a[28:31], v[92:95]
s_lshr_b32 s3, s2, 2
ds_read_b128 a[88:91], v5 offset:6144
ds_read_b128 a[92:95], v5 offset:7168
v_mfma_f32_16x16x32_bf16 v[160:163], a[112:115], v[60:63], v[160:163]
s_sub_u32 s59, s59, s39
v_cvt_pk_bf16_f32 v54, v84, v85
v_mov_b32 v1, 1
v_mov_b32 v2, 1073741824
v_exp_f32 v83, v83
v_mfma_f32_16x16x32_bf16 v[160:163], a[96:99], v[56:59], v[160:163]
buffer_load_dwordx4 v7, s[8:11], s36 offen offset:1024 sc1 lds
v_mfma_f32_16x16x32_bf16 v[164:167], a[116:119], v[60:63], v[164:167]
s_lshl_b32 s59, s59, 9
ds_read_b128 a[112:115], v5 offset:12288
ds_read_b128 a[96:99], v5 offset:8192
ds_read_b128 a[116:119], v5 offset:13312
v_mfma_f32_16x16x32_bf16 v[164:167], a[100:103], v[56:59], v[164:167]
v_exp_f32 v82, v82
v_exp_f32 v81, v81
v_mfma_f32_16x16x32_bf16 v[168:171], a[120:123], v[60:63], v[168:171]
s_waitcnt lgkmcnt(7)
ds_read_b128 a[100:103], v5 offset:9216
ds_read_b128 a[120:123], v5 offset:14336
v_mfma_f32_16x16x32_bf16 v[168:171], a[104:107], v[56:59], v[168:171]
buffer_load_dwordx4 v28, s[8:11], s36 offen offset:2048 sc1 lds
v_mfma_f32_16x16x32_bf16 v[172:175], a[124:127], v[60:63], v[172:175]
s_lshl_b32 s3, s3, 8
v_exp_f32 v87, v87
v_cvt_pk_bf16_f32 v53, v82, v83
v_mfma_f32_16x16x32_bf16 v[172:175], a[108:111], v[56:59], v[172:175]
s_waitcnt lgkmcnt(5)
ds_read_b128 a[104:107], v5 offset:10240
v_cvt_pk_bf16_f32 v52, v80, v81
v_mfma_f32_16x16x32_bf16 v[80:83], a[64:67], a[0:3], v[32:35]
buffer_load_dwordx4 v31, s[8:11], s36 offen offset:3072 sc1 lds
v_mfma_f32_16x16x32_bf16 v[80:83], a[68:71], a[4:7], v[80:83]
s_add_u32 s3, s3, 3145728
ds_read_b128 a[124:127], v5 offset:15360
ds_read_b128 a[108:111], v5 offset:11264
v_mfma_f32_16x16x32_bf16 v[80:83], a[72:75], a[8:11], v[80:83]
s_sub_u32 s39, s39, s59
v_exp_f32 v89, v89
v_cmp_eq_u32 vcc, 0, v4
v_mfma_f32_16x16x32_bf16 v[80:83], a[76:79], a[12:15], v[80:83]
s_sub_u32 s36, s36, s61
v_cndmask_b32 v2, v2, 0, vcc
v_cvt_pk_bf16_f32 v55, v86, v87
v_mfma_f32_16x16x32_bf16 v[84:87], a[80:83], a[0:3], v[32:35]
s_waitcnt vmcnt(13)
buffer_atomic_add v1, v2, s[40:43], s3 offen sc1
v_mfma_f32_16x16x32_bf16 v[84:87], a[84:87], a[4:7], v[84:87]
s_bitset1_b32 m0, 14
v_exp_f32 v88, v88
v_mfma_f32_16x16x32_bf16 v[84:87], a[88:91], a[8:11], v[84:87]
v_cmp_gt_u32 vcc, 16, v30
v_cvt_pk_bf16_f32 v60, v88, v89
v_mfma_f32_16x16x32_bf16 v[84:87], a[92:95], a[12:15], v[84:87]
s_cmp_lg_u64 vcc, 0
v_exp_f32 v90, v90
v_smfmac_f32_16x16x64_bf16 a[240:243], v[112:115], v[48:55], v19
s_cbranch_scc1 kf_kernel_spin_znB
kf_kernel_ret_znB:
s_waitcnt lgkmcnt(4)
v_mfma_f32_16x16x32_bf16 v[144:147], a[96:99], v[48:51], v[144:147]
s_sub_u32 s34, s33, 0
v_exp_f32 v94, v94
v_mfma_f32_16x16x32_bf16 v[144:147], a[112:115], v[52:55], v[144:147]
v_exp_f32 v81, v81
v_mfma_f32_16x16x32_bf16 v[148:151], a[100:103], v[48:51], v[148:151]
buffer_load_dwordx4 a[128:131], v4, s[40:43], s34 offen offset:0 sc1
v_mfma_f32_16x16x32_bf16 v[148:151], a[116:119], v[52:55], v[148:151]
s_waitcnt lgkmcnt(0)
v_exp_f32 v92, v92
v_mfma_f32_16x16x32_bf16 v[152:155], a[104:107], v[48:51], v[152:155]
buffer_load_dwordx4 v6, s[8:11], s36 offen offset:0 sc1 lds
v_mfma_f32_16x16x32_bf16 v[152:155], a[120:123], v[52:55], v[152:155]
v_exp_f32 v93, v93
v_mfma_f32_16x16x32_bf16 v[156:159], a[108:111], v[48:51], v[156:159]
v_exp_f32 v91, v91
v_mfma_f32_16x16x32_bf16 v[156:159], a[124:127], v[52:55], v[156:159]
buffer_load_dwordx4 a[132:135], v4, s[40:43], s34 offen offset:1024 sc1
v_cvt_pk_bf16_f32 v61, v90, v91
v_mfma_f32_16x16x32_bf16 v[88:91], a[64:67], a[16:19], v[36:39]
v_exp_f32 v95, v95
v_mfma_f32_16x16x32_bf16 v[88:91], a[68:71], a[20:23], v[88:91]
ds_read_b128 a[64:67], v5 offset:16384
ds_read_b128 a[68:71], v5 offset:17408
v_mfma_f32_16x16x32_bf16 v[88:91], a[72:75], a[24:27], v[88:91]
v_cvt_pk_bf16_f32 v62, v92, v93
v_cvt_pk_bf16_f32 v63, v94, v95
v_mfma_f32_16x16x32_bf16 v[88:91], a[76:79], a[28:31], v[88:91]
ds_read_b128 a[72:75], v5 offset:18432
ds_read_b128 a[76:79], v5 offset:19456
v_mfma_f32_16x16x32_bf16 v[92:95], a[80:83], a[16:19], v[36:39]
buffer_load_dwordx4 a[136:139], v4, s[40:43], s34 offen offset:2048 sc1
ds_read_b128 a[80:83], v5 offset:20480
v_mfma_f32_16x16x32_bf16 v[92:95], a[84:87], a[20:23], v[92:95]
ds_read_b128 a[84:87], v5 offset:21504
v_exp_f32 v82, v82
v_mfma_f32_16x16x32_bf16 v[92:95], a[88:91], a[24:27], v[92:95]
buffer_load_dwordx4 v7, s[8:11], s36 offen offset:1024 sc1 lds
v_mfma_f32_16x16x32_bf16 v[92:95], a[92:95], a[28:31], v[92:95]
ds_read_b128 a[88:91], v5 offset:22528
ds_read_b128 a[92:95], v5 offset:23552
v_smfmac_f32_16x16x64_bf16 a[244:247], v[112:115], v[56:63], v19
v_exp_f32 v80, v80
v_mfma_f32_16x16x32_bf16 v[176:179], a[96:99], v[56:59], v[176:179]
s_waitcnt lgkmcnt(4)
ds_read_b128 a[96:99], v5 offset:24576
v_exp_f32 v83, v83
v_mfma_f32_16x16x32_bf16 v[176:179], a[112:115], v[60:63], v[176:179]
v_exp_f32 v87, v87
v_cvt_pk_bf16_f32 v48, v80, v81
v_mfma_f32_16x16x32_bf16 v[180:183], a[100:103], v[56:59], v[180:183]
buffer_load_dwordx4 a[140:143], v4, s[40:43], s34 offen offset:3072 sc1
v_mfma_f32_16x16x32_bf16 v[180:183], a[116:119], v[60:63], v[180:183]
ds_read_b128 a[112:115], v5 offset:28672
ds_read_b128 a[100:103], v5 offset:25600
v_mfma_f32_16x16x32_bf16 v[184:187], a[104:107], v[56:59], v[184:187]
s_sub_u32 s34, s33, 4096
v_exp_f32 v85, v85
v_mfma_f32_16x16x32_bf16 v[184:187], a[120:123], v[60:63], v[184:187]
s_waitcnt lgkmcnt(3)
buffer_load_dwordx4 a[144:147], v4, s[40:43], s34 offen offset:0 sc1
ds_read_b128 a[116:119], v5 offset:29696
ds_read_b128 a[104:107], v5 offset:26624
v_mfma_f32_16x16x32_bf16 v[188:191], a[108:111], v[56:59], v[188:191]
ds_read_b128 a[120:123], v5 offset:30720
v_exp_f32 v86, v86
v_exp_f32 v89, v89
v_mfma_f32_16x16x32_bf16 v[188:191], a[124:127], v[60:63], v[188:191]
ds_read_b128 a[108:111], v5 offset:27648
ds_read_b128 a[124:127], v5 offset:31744
v_exp_f32 v84, v84
v_cvt_pk_bf16_f32 v49, v82, v83
v_mfma_f32_16x16x32_bf16 v[80:83], a[64:67], a[0:3], v[32:35]
buffer_load_dwordx4 v28, s[8:11], s36 offen offset:2048 sc1 lds
v_mfma_f32_16x16x32_bf16 v[80:83], a[68:71], a[4:7], v[80:83]
v_exp_f32 v92, v92
v_mfma_f32_16x16x32_bf16 v[80:83], a[72:75], a[8:11], v[80:83]
v_cvt_pk_bf16_f32 v51, v86, v87
v_cvt_pk_bf16_f32 v50, v84, v85
v_mfma_f32_16x16x32_bf16 v[80:83], a[76:79], a[12:15], v[80:83]
buffer_load_dwordx4 a[148:151], v4, s[40:43], s34 offen offset:1024 sc1
v_mfma_f32_16x16x32_bf16 v[84:87], a[80:83], a[0:3], v[32:35]
buffer_load_dwordx4 a[152:155], v4, s[40:43], s34 offen offset:2048 sc1
v_mfma_f32_16x16x32_bf16 v[84:87], a[84:87], a[4:7], v[84:87]
s_waitcnt lgkmcnt(4)
buffer_load_dwordx4 v31, s[8:11], s36 offen offset:3072 sc1 lds
v_mfma_f32_16x16x32_bf16 v[84:87], a[88:91], a[8:11], v[84:87]
v_exp_f32 v93, v93
v_mfma_f32_16x16x32_bf16 v[84:87], a[92:95], a[12:15], v[84:87]
s_and_b32 m0, s39, 0x1ffff
v_exp_f32 v94, v94
v_mfma_f32_16x16x32_bf16 v[128:131], a[112:115], v[52:55], v[128:131]
s_waitcnt lgkmcnt(0)
buffer_load_dwordx4 a[156:159], v4, s[40:43], s34 offen offset:3072 sc1
v_mfma_f32_16x16x32_bf16 v[128:131], a[96:99], v[48:51], v[128:131]
v_exp_f32 v95, v95
v_mfma_f32_16x16x32_bf16 v[132:135], a[116:119], v[52:55], v[132:135]
v_exp_f32 v90, v90
v_mfma_f32_16x16x32_bf16 v[132:135], a[100:103], v[48:51], v[132:135]
v_exp_f32 v88, v88
v_mfma_f32_16x16x32_bf16 v[136:139], a[120:123], v[52:55], v[136:139]
s_sub_u32 s36, s36, s61
v_cvt_pk_bf16_f32 v56, v88, v89
v_exp_f32 v91, v91
v_mfma_f32_16x16x32_bf16 v[136:139], a[104:107], v[48:51], v[136:139]
s_add_u32 s39, s39, 0x1008000
v_and_or_b32 v5, s39, v20, v4
v_cvt_pk_bf16_f32 v58, v92, v93
v_mfma_f32_16x16x32_bf16 v[140:143], a[124:127], v[52:55], v[140:143]
v_cvt_pk_bf16_f32 v57, v90, v91
v_cvt_pk_bf16_f32 v59, v94, v95
v_mfma_f32_16x16x32_bf16 v[140:143], a[108:111], v[48:51], v[140:143]
s_cbranch_scc0 kf_kernel_loopB
s_branch kf_kernel_loopBx
kf_kernel_hB8:
v_mfma_f32_16x16x32_bf16 v[88:91], a[64:67], a[16:19], v[36:39]
s_waitcnt vmcnt(16) lgkmcnt(0)
s_barrier
buffer_load_dwordx4 v6, s[8:11], s36 offen offset:0 sc1 lds
v_mfma_f32_16x16x32_bf16 v[88:91], a[68:71], a[20:23], v[88:91]
s_add_u32 s27, s27, 1
v_exp_f32 v85, v85
v_mfma_f32_16x16x32_bf16 v[88:91], a[72:75], a[24:27], v[88:91]
s_sub_u32 s34, s33, 8192
ds_read_b128 a[64:67], v5 offset:0
ds_read_b128 a[68:71], v5 offset:1024
v_mfma_f32_16x16x32_bf16 v[88:91], a[76:79], a[28:31], v[88:91]
s_add_u32 s26, s39, 32768
ds_read_b128 a[72:75], v5 offset:2048
buffer_load_dwordx4 a[160:163], v4, s[40:43], s34 offen offset:0 sc1
ds_read_b128 a[76:79], v5 offset:3072
v_mfma_f32_16x16x32_bf16 v[92:95], a[80:83], a[16:19], v[36:39]
s_min_u32 s59, s26, s32
ds_read_b128 a[80:83], v5 offset:4096
v_exp_f32 v84, v84
v_exp_f32 v86, v86
v_mfma_f32_16x16x32_bf16 v[92:95], a[84:87], a[20:23], v[92:95]
ds_read_b128 a[84:87], v5 offset:5120
v_exp_f32 v81, v81
v_mfma_f32_16x16x32_bf16 v[92:95], a[88:91], a[24:27], v[92:95]
s_sub_u32 s59, s59, s39
ds_read_b128 a[88:91], v5 offset:6144
v_exp_f32 v83, v83
v_mfma_f32_16x16x32_bf16 v[92:95], a[92:95], a[28:31], v[92:95]
buffer_load_dwordx4 v7, s[8:11], s36 offen offset:1024 sc1 lds
ds_read_b128 a[92:95], v5 offset:7168
v_mfma_f32_16x16x32_bf16 v[160:163], a[112:115], v[60:63], v[160:163]
v_exp_f32 v82, v82
v_mfma_f32_16x16x32_bf16 v[160:163], a[96:99], v[56:59], v[160:163]
s_lshl_b32 s59, s59, 9
v_cvt_pk_bf16_f32 v53, v82, v83
v_exp_f32 v80, v80
v_mfma_f32_16x16x32_bf16 v[164:167], a[116:119], v[60:63], v[164:167]
ds_read_b128 a[112:115], v5 offset:12288
ds_read_b128 a[96:99], v5 offset:8192
ds_read_b128 a[116:119], v5 offset:13312
buffer_load_dwordx4 a[164:167], v4, s[40:43], s34 offen offset:1024 sc1
v_mfma_f32_16x16x32_bf16 v[164:167], a[100:103], v[56:59], v[164:167]
ds_read_b128 a[100:103], v5 offset:9216
v_exp_f32 v87, v87
v_mfma_f32_16x16x32_bf16 v[168:171], a[120:123], v[60:63], v[168:171]
ds_read_b128 a[120:123], v5 offset:14336
buffer_load_dwordx4 v28, s[8:11], s36 offen offset:2048 sc1 lds
v_mfma_f32_16x16x32_bf16 v[168:171], a[104:107], v[56:59], v[168:171]
v_exp_f32 v90, v90
v_mfma_f32_16x16x32_bf16 v[172:175], a[124:127], v[60:63], v[172:175]
s_waitcnt lgkmcnt(9)
ds_read_b128 a[104:107], v5 offset:10240
v_cvt_pk_bf16_f32 v52, v80, v81
v_mfma_f32_16x16x32_bf16 v[172:175], a[108:111], v[56:59], v[172:175]
buffer_load_dwordx4 v31, s[8:11], s36 offen offset:3072 sc1 lds
v_mfma_f32_16x16x32_bf16 v[80:83], a[64:67], a[0:3], v[32:35]
s_bitset1_b32 m0, 14
v_exp_f32 v89, v89
v_mfma_f32_16x16x32_bf16 v[80:83], a[68:71], a[4:7], v[80:83]
s_sub_u32 s3, 15, s22
v_cvt_pk_bf16_f32 v54, v84, v85
v_cvt_pk_bf16_f32 v55, v86, v87
v_mfma_f32_16x16x32_bf16 v[80:83], a[72:75], a[8:11], v[80:83]
s_waitcnt lgkmcnt(6)
buffer_load_dwordx4 a[168:171], v4, s[40:43], s34 offen offset:2048 sc1
v_mfma_f32_16x16x32_bf16 v[80:83], a[76:79], a[12:15], v[80:83]
v_exp_f32 v88, v88
v_mfma_f32_16x16x32_bf16 v[84:87], a[80:83], a[0:3], v[32:35]
s_sub_u32 s39, s39, s59
v_exp_f32 v92, v92
v_mfma_f32_16x16x32_bf16 v[84:87], a[84:87], a[4:7], v[84:87]
s_sub_u32 s36, s36, s61
ds_read_b128 a[124:127], v5 offset:15360
ds_read_b128 a[108:111], v5 offset:11264
v_mfma_f32_16x16x32_bf16 v[84:87], a[88:91], a[8:11], v[84:87]
s_bitcmp1_b32 s23, 0
v_exp_f32 v91, v91
v_mfma_f32_16x16x32_bf16 v[84:87], a[92:95], a[12:15], v[84:87]
buffer_load_dwordx4 v6, s[8:11], s36 offen offset:0 sc1 lds
v_smfmac_f32_16x16x64_bf16 a[240:243], v[112:115], v[48:55], v19
s_waitcnt lgkmcnt(4)
buffer_load_dwordx4 a[172:175], v4, s[40:43], s34 offen offset:3072 sc1
v_mfma_f32_16x16x32_bf16 v[144:147], a[96:99], v[48:51], v[144:147]
buffer_load_dwordx4 v7, s[8:11], s36 offen offset:1024 sc1 lds
v_mfma_f32_16x16x32_bf16 v[144:147], a[112:115], v[52:55], v[144:147]
s_cselect_b32 s5, s3, s22
v_cvt_pk_bf16_f32 v61, v90, v91
v_exp_f32 v80, v80
v_mfma_f32_16x16x32_bf16 v[148:151], a[100:103], v[48:51], v[148:151]
s_lshl2_add_u32 s3, s5, s20
v_exp_f32 v93, v93
v_mfma_f32_16x16x32_bf16 v[148:151], a[116:119], v[52:55], v[148:151]
s_waitcnt lgkmcnt(0)
v_exp_f32 v81, v81
v_mfma_f32_16x16x32_bf16 v[152:155], a[104:107], v[48:51], v[152:155]
s_sub_u32 s34, s33, 12288
v_exp_f32 v82, v82
v_mfma_f32_16x16x32_bf16 v[152:155], a[120:123], v[52:55], v[152:155]
s_bfe_u32 s60, s23, 0x10001
v_exp_f32 v95, v95
v_mfma_f32_16x16x32_bf16 v[156:159], a[108:111], v[48:51], v[156:159]
v_exp_f32 v94, v94
v_mfma_f32_16x16x32_bf16 v[156:159], a[124:127], v[52:55], v[156:159]
s_lshr_b32 s4, s23, 2
v_exp_f32 v83, v83
v_cvt_pk_bf16_f32 v60, v88, v89
v_mfma_f32_16x16x32_bf16 v[88:91], a[64:67], a[16:19], v[36:39]
s_lshl1_add_u32 s4, s3, s4
ds_read_b128 a[64:67], v5 offset:16384
v_cvt_pk_bf16_f32 v48, v80, v81
v_mfma_f32_16x16x32_bf16 v[88:91], a[68:71], a[20:23], v[88:91]
buffer_load_dwordx4 v28, s[8:11], s36 offen offset:2048 sc1 lds
v_mfma_f32_16x16x32_bf16 v[88:91], a[72:75], a[24:27], v[88:91]
s_and_b32 s3, s24, 3
ds_read_b128 a[68:71], v5 offset:17408
ds_read_b128 a[72:75], v5 offset:18432
v_mfma_f32_16x16x32_bf16 v[88:91], a[76:79], a[28:31], v[88:91]
s_lshl2_add_u32 s3, s60, s3
v_cvt_pk_bf16_f32 v49, v82, v83
v_cvt_pk_bf16_f32 v63, v94, v95
v_cvt_pk_bf16_f32 v62, v92, v93
v_mfma_f32_16x16x32_bf16 v[92:95], a[80:83], a[16:19], v[36:39]
s_lshl_b32 s60, s4, 7
ds_read_b128 a[76:79], v5 offset:19456
buffer_load_dwordx4 a[176:179], v4, s[40:43], s34 offen offset:0 sc1
ds_read_b128 a[80:83], v5 offset:20480
v_mfma_f32_16x16x32_bf16 v[92:95], a[84:87], a[20:23], v[92:95]
buffer_load_dwordx4 v31, s[8:11], s36 offen offset:3072 sc1 lds
ds_read_b128 a[84:87], v5 offset:21504
v_mfma_f32_16x16x32_bf16 v[92:95], a[88:91], a[24:27], v[92:95]
s_add_u32 s29, s35, 0xfffffd00
v_exp_f32 v85, v85
v_mfma_f32_16x16x32_bf16 v[92:95], a[92:95], a[28:31], v[92:95]
ds_read_b128 a[88:91], v5 offset:22528
v_exp_f32 v84, v84
v_smfmac_f32_16x16x64_bf16 a[244:247], v[112:115], v[56:63], v19
v_exp_f32 v91, v91
v_mfma_f32_16x16x32_bf16 v[176:179], a[96:99], v[56:59], v[176:179]
s_add_u32 s3, s3, s60
ds_read_b128 a[92:95], v5 offset:23552
ds_read_b128 a[96:99], v5 offset:24576
v_mfma_f32_16x16x32_bf16 v[176:179], a[112:115], v[60:63], v[176:179]
buffer_load_dwordx4 a[180:183], v4, s[40:43], s34 offen offset:1024 sc1
v_exp_f32 v94, v94
v_mfma_f32_16x16x32_bf16 v[180:183], a[100:103], v[56:59], v[180:183]
s_waitcnt lgkmcnt(5)
s_branch kf_kernel_pl28
kf_kernel_pd28:
s_branch kf_kernel_idle
kf_kernel_pl28:
ds_read_b128 a[112:115], v5 offset:28672
ds_read_b128 a[100:103], v5 offset:25600
v_mfma_f32_16x16x32_bf16 v[180:183], a[116:119], v[60:63], v[180:183]
s_sub_u32 s36, s36, s61
ds_read_b128 a[116:119], v5 offset:29696
v_exp_f32 v87, v87
v_mfma_f32_16x16x32_bf16 v[184:187], a[104:107], v[56:59], v[184:187]
s_add_u32 m0, s28, 131072
ds_read_b128 a[104:107], v5 offset:26624
v_exp_f32 v95, v95
v_mfma_f32_16x16x32_bf16 v[184:187], a[120:123], v[60:63], v[184:187]
ds_read_b128 a[120:123], v5 offset:30720
v_exp_f32 v86, v86
v_mfma_f32_16x16x32_bf16 v[188:191], a[108:111], v[56:59], v[188:191]
s_mul_i32 s15, s3, 160
ds_read_b128 a[108:111], v5 offset:27648
buffer_load_dwordx4 v21, s[44:47], s29 offen offset:0 lds
v_mfma_f32_16x16x32_bf16 v[188:191], a[124:127], v[60:63], v[188:191]
v_exp_f32 v92, v92
v_mfma_f32_16x16x32_bf16 v[80:83], a[64:67], a[0:3], v[32:35]
ds_read_b128 a[124:127], v5 offset:31744
v_cvt_pk_bf16_f32 v50, v84, v85
v_mfma_f32_16x16x32_bf16 v[80:83], a[68:71], a[4:7], v[80:83]
buffer_load_dwordx4 v22, s[44:47], s29 offen offset:1024 lds
v_mfma_f32_16x16x32_bf16 v[80:83], a[72:75], a[8:11], v[80:83]
v_exp_f32 v89, v89
v_mfma_f32_16x16x32_bf16 v[80:83], a[76:79], a[12:15], v[80:83]
s_waitcnt lgkmcnt(8)
v_cvt_pk_bf16_f32 v51, v86, v87
v_cvt_pk_bf16_f32 v59, v94, v95
v_mfma_f32_16x16x32_bf16 v[84:87], a[80:83], a[0:3], v[32:35]
buffer_load_dwordx4 a[184:187], v4, s[40:43], s34 offen offset:2048 sc1
v_mfma_f32_16x16x32_bf16 v[84:87], a[84:87], a[4:7], v[84:87]
v_exp_f32 v88, v88
v_mfma_f32_16x16x32_bf16 v[84:87], a[88:91], a[8:11], v[84:87]
buffer_load_dwordx4 v23, s[44:47], s29 offen offset:2048 lds
v_mfma_f32_16x16x32_bf16 v[84:87], a[92:95], a[12:15], v[84:87]
s_waitcnt lgkmcnt(4)
buffer_load_dwordx4 a[188:191], v4, s[40:43], s34 offen offset:3072 sc1
v_mfma_f32_16x16x32_bf16 v[128:131], a[112:115], v[52:55], v[128:131]
s_mov_b32 s18, 2621440
v_exp_f32 v90, v90
v_mfma_f32_16x16x32_bf16 v[128:131], a[96:99], v[48:51], v[128:131]
s_waitcnt lgkmcnt(0)
v_cvt_pk_bf16_f32 v56, v88, v89
v_and_b32 v1, 15, v0
v_mfma_f32_16x16x32_bf16 v[132:135], a[116:119], v[52:55], v[132:135]
buffer_load_dwordx4 v24, s[44:47], s29 offen offset:3072 lds
v_mfma_f32_16x16x32_bf16 v[132:135], a[100:103], v[48:51], v[132:135]
v_exp_f32 v93, v93
v_mfma_f32_16x16x32_bf16 v[136:139], a[120:123], v[52:55], v[136:139]
s_and_b32 m0, s39, 0x1ffff
v_cvt_pk_bf16_f32 v57, v90, v91
v_cvt_pk_bf16_f32 v58, v92, v93
v_mfma_f32_16x16x32_bf16 v[136:139], a[104:107], v[48:51], v[136:139]
s_add_u32 s39, s39, 0x1008000
v_and_or_b32 v5, s39, v20, v4
v_mul_u32_u24 v25, 1280, v1
v_mfma_f32_16x16x32_bf16 v[140:143], a[124:127], v[52:55], v[140:143]
v_bfe_u32 v2, v0, 4, 2
v_lshl_add_u32 v25, v2, 3, v25
v_mfma_f32_16x16x32_bf16 v[140:143], a[108:111], v[48:51], v[140:143]
s_cbranch_scc0 kf_kernel_loopB
s_branch kf_kernel_loopBx
kf_kernel_hB9:
v_mfma_f32_16x16x32_bf16 v[88:91], a[64:67], a[16:19], v[36:39]
s_waitcnt vmcnt(16) lgkmcnt(0)
s_barrier
ds_read_b128 a[64:67], v5 offset:0
v_mfma_f32_16x16x32_bf16 v[88:91], a[68:71], a[20:23], v[88:91]
ds_read_b128 a[68:71], v5 offset:1024
global_load_dword v30, v4, s[98:99]
v_mfma_f32_16x16x32_bf16 v[88:91], a[72:75], a[24:27], v[88:91]
ds_read_b128 a[72:75], v5 offset:2048
v_exp_f32 v82, v82
v_mfma_f32_16x16x32_bf16 v[88:91], a[76:79], a[28:31], v[88:91]
ds_read_b128 a[76:79], v5 offset:3072
v_exp_f32 v81, v81
v_mfma_f32_16x16x32_bf16 v[92:95], a[80:83], a[16:19], v[36:39]
s_sub_u32 s34, s33, 16384
ds_read_b128 a[80:83], v5 offset:4096
buffer_load_dwordx4 a[192:195], v4, s[40:43], s34 offen offset:0 sc1
v_mfma_f32_16x16x32_bf16 v[92:95], a[84:87], a[20:23], v[92:95]
v_exp_f32 v86, v86
v_mfma_f32_16x16x32_bf16 v[92:95], a[88:91], a[24:27], v[92:95]
buffer_load_dwordx4 v6, s[8:11], s36 offen offset:0 sc1 lds
v_mfma_f32_16x16x32_bf16 v[92:95], a[92:95], a[28:31], v[92:95]
ds_read_b128 a[84:87], v5 offset:5120
ds_read_b128 a[88:91], v5 offset:6144
v_exp_f32 v83, v83
v_mfma_f32_16x16x32_bf16 v[160:163], a[112:115], v[60:63], v[160:163]
s_waitcnt lgkmcnt(3)
ds_read_b128 a[92:95], v5 offset:7168
ds_read_b128 a[112:115], v5 offset:12288
v_mfma_f32_16x16x32_bf16 v[160:163], a[96:99], v[56:59], v[160:163]
buffer_load_dwordx4 a[196:199], v4, s[40:43], s34 offen offset:1024 sc1
ds_read_b128 a[96:99], v5 offset:8192
v_mfma_f32_16x16x32_bf16 v[164:167], a[116:119], v[60:63], v[164:167]
buffer_load_dwordx4 v7, s[8:11], s36 offen offset:1024 sc1 lds
v_mfma_f32_16x16x32_bf16 v[164:167], a[100:103], v[56:59], v[164:167]
s_add_u32 s26, s39, 32768
ds_read_b128 a[116:119], v5 offset:13312
v_exp_f32 v95, v95
v_mfma_f32_16x16x32_bf16 v[168:171], a[120:123], v[60:63], v[168:171]
ds_read_b128 a[100:103], v5 offset:9216
ds_read_b128 a[120:123], v5 offset:14336
v_mfma_f32_16x16x32_bf16 v[168:171], a[104:107], v[56:59], v[168:171]
buffer_load_dwordx4 a[200:203], v4, s[40:43], s34 offen offset:2048 sc1
v_mfma_f32_16x16x32_bf16 v[172:175], a[124:127], v[60:63], v[172:175]
ds_read_b128 a[104:107], v5 offset:10240
v_exp_f32 v87, v87
v_exp_f32 v84, v84
v_exp_f32 v80, v80
v_exp_f32 v85, v85
v_cvt_pk_bf16_f32 v52, v80, v81
v_mfma_f32_16x16x32_bf16 v[172:175], a[108:111], v[56:59], v[172:175]
v_exp_f32 v90, v90
v_cvt_pk_bf16_f32 v53, v82, v83
v_mfma_f32_16x16x32_bf16 v[80:83], a[64:67], a[0:3], v[32:35]
buffer_load_dwordx4 v28, s[8:11], s36 offen offset:2048 sc1 lds
v_mfma_f32_16x16x32_bf16 v[80:83], a[68:71], a[4:7], v[80:83]
ds_read_b128 a[124:127], v5 offset:15360
ds_read_b128 a[108:111], v5 offset:11264
v_cvt_pk_bf16_f32 v54, v84, v85
v_mfma_f32_16x16x32_bf16 v[80:83], a[72:75], a[8:11], v[80:83]
v_cvt_pk_bf16_f32 v55, v86, v87
v_exp_f32 v94, v94
v_mfma_f32_16x16x32_bf16 v[80:83], a[76:79], a[12:15], v[80:83]
s_waitcnt lgkmcnt(8)
buffer_load_dwordx4 a[204:207], v4, s[40:43], s34 offen offset:3072 sc1
v_mfma_f32_16x16x32_bf16 v[84:87], a[80:83], a[0:3], v[32:35]
v_exp_f32 v93, v93
v_mfma_f32_16x16x32_bf16 v[84:87], a[84:87], a[4:7], v[84:87]
s_waitcnt lgkmcnt(4)
v_exp_f32 v91, v91
v_exp_f32 v92, v92
v_mfma_f32_16x16x32_bf16 v[84:87], a[88:91], a[8:11], v[84:87]
buffer_load_dwordx4 v31, s[8:11], s36 offen offset:3072 sc1 lds
v_mfma_f32_16x16x32_bf16 v[84:87], a[92:95], a[12:15], v[84:87]
s_sub_u32 s34, s33, 20480
v_exp_f32 v89, v89
v_smfmac_f32_16x16x64_bf16 a[240:243], v[112:115], v[48:55], v19
s_sub_u32 s36, s36, s61
v_exp_f32 v81, v81
v_mfma_f32_16x16x32_bf16 v[144:147], a[96:99], v[48:51], v[144:147]
s_bitset1_b32 m0, 14
v_exp_f32 v82, v82
v_mfma_f32_16x16x32_bf16 v[144:147], a[112:115], v[52:55], v[144:147]
s_waitcnt lgkmcnt(0)
v_cvt_pk_bf16_f32 v62, v92, v93
v_exp_f32 v88, v88
v_mfma_f32_16x16x32_bf16 v[148:151], a[100:103], v[48:51], v[148:151]
buffer_load_dwordx4 a[208:211], v4, s[40:43], s34 offen offset:0 sc1
v_mfma_f32_16x16x32_bf16 v[148:151], a[116:119], v[52:55], v[148:151]
s_min_u32 s59, s26, s32
v_exp_f32 v80, v80
v_mfma_f32_16x16x32_bf16 v[152:155], a[104:107], v[48:51], v[152:155]
s_add_u32 s27, s27, 1
v_exp_f32 v86, v86
v_mfma_f32_16x16x32_bf16 v[152:155], a[120:123], v[52:55], v[152:155]
buffer_load_dwordx4 v6, s[8:11], s36 offen offset:0 sc1 lds
v_mfma_f32_16x16x32_bf16 v[156:159], a[108:111], v[48:51], v[156:159]
v_exp_f32 v84, v84
v_mfma_f32_16x16x32_bf16 v[156:159], a[124:127], v[52:55], v[156:159]
v_cvt_pk_bf16_f32 v60, v88, v89
v_cvt_pk_bf16_f32 v61, v90, v91
v_mfma_f32_16x16x32_bf16 v[88:91], a[64:67], a[16:19], v[36:39]
buffer_load_dwordx4 a[212:215], v4, s[40:43], s34 offen offset:1024 sc1
v_mfma_f32_16x16x32_bf16 v[88:91], a[68:71], a[20:23], v[88:91]
ds_read_b128 a[64:67], v5 offset:16384
v_cvt_pk_bf16_f32 v63, v94, v95
v_mfma_f32_16x16x32_bf16 v[88:91], a[72:75], a[24:27], v[88:91]
ds_read_b128 a[68:71], v5 offset:17408
ds_read_b128 a[72:75], v5 offset:18432
v_mfma_f32_16x16x32_bf16 v[88:91], a[76:79], a[28:31], v[88:91]
ds_read_b128 a[76:79], v5 offset:19456
v_exp_f32 v83, v83
v_mfma_f32_16x16x32_bf16 v[92:95], a[80:83], a[16:19], v[36:39]
buffer_load_dwordx4 v7, s[8:11], s36 offen offset:1024 sc1 lds
v_mfma_f32_16x16x32_bf16 v[92:95], a[84:87], a[20:23], v[92:95]
ds_read_b128 a[80:83], v5 offset:20480
ds_read_b128 a[84:87], v5 offset:21504
v_mfma_f32_16x16x32_bf16 v[92:95], a[88:91], a[24:27], v[92:95]
ds_read_b128 a[88:91], v5 offset:22528
buffer_load_dwordx4 a[216:219], v4, s[40:43], s34 offen offset:2048 sc1
v_mfma_f32_16x16x32_bf16 v[92:95], a[92:95], a[28:31], v[92:95]
v_exp_f32 v85, v85
v_smfmac_f32_16x16x64_bf16 a[244:247], v[112:115], v[56:63], v19
v_exp_f32 v87, v87
v_mfma_f32_16x16x32_bf16 v[176:179], a[96:99], v[56:59], v[176:179]
ds_read_b128 a[92:95], v5 offset:23552
ds_read_b128 a[96:99], v5 offset:24576
v_mfma_f32_16x16x32_bf16 v[176:179], a[112:115], v[60:63], v[176:179]
s_sub_u32 s59, s59, s39
ds_read_b128 a[112:115], v5 offset:28672
buffer_load_dwordx4 v28, s[8:11], s36 offen offset:2048 sc1 lds
v_mfma_f32_16x16x32_bf16 v[180:183], a[100:103], v[56:59], v[180:183]
v_exp_f32 v93, v93
v_mfma_f32_16x16x32_bf16 v[180:183], a[116:119], v[60:63], v[180:183]
s_lshl_b32 s59, s59, 9
ds_read_b128 a[100:103], v5 offset:25600
ds_read_b128 a[116:119], v5 offset:29696
v_mfma_f32_16x16x32_bf16 v[184:187], a[104:107], v[56:59], v[184:187]
v_exp_f32 v92, v92
v_mfma_f32_16x16x32_bf16 v[184:187], a[120:123], v[60:63], v[184:187]
ds_read_b128 a[104:107], v5 offset:26624
ds_read_b128 a[120:123], v5 offset:30720
v_mfma_f32_16x16x32_bf16 v[188:191], a[108:111], v[56:59], v[188:191]
s_waitcnt lgkmcnt(10)
buffer_load_dwordx2 v[14:15], v25, s[16:19], s15 offen offset:0
v_mfma_f32_16x16x32_bf16 v[188:191], a[124:127], v[60:63], v[188:191]
v_cvt_pk_bf16_f32 v58, v92, v93
v_cvt_pk_bf16_f32 v48, v80, v81
v_cvt_pk_bf16_f32 v49, v82, v83
v_mfma_f32_16x16x32_bf16 v[80:83], a[64:67], a[0:3], v[32:35]
s_sub_u32 s39, s39, s59
ds_read_b128 a[108:111], v5 offset:27648
ds_read_b128 a[124:127], v5 offset:31744
v_mfma_f32_16x16x32_bf16 v[80:83], a[68:71], a[4:7], v[80:83]
s_waitcnt lgkmcnt(8)
buffer_load_dwordx2 v[16:17], v25, s[16:19], s15 offen offset:32
v_mfma_f32_16x16x32_bf16 v[80:83], a[72:75], a[8:11], v[80:83]
buffer_load_dwordx2 v[124:125], v25, s[16:19], s15 offen offset:64
buffer_load_dwordx2 v[126:127], v25, s[16:19], s15 offen offset:96
v_mfma_f32_16x16x32_bf16 v[80:83], a[76:79], a[12:15], v[80:83]
v_cvt_pk_bf16_f32 v51, v86, v87
v_cvt_pk_bf16_f32 v50, v84, v85
v_mfma_f32_16x16x32_bf16 v[84:87], a[80:83], a[0:3], v[32:35]
v_exp_f32 v90, v90
v_mfma_f32_16x16x32_bf16 v[84:87], a[84:87], a[4:7], v[84:87]
buffer_load_dwordx2 v[26:27], v25, s[16:19], s15 offen offset:128
v_mfma_f32_16x16x32_bf16 v[84:87], a[88:91], a[8:11], v[84:87]
s_waitcnt lgkmcnt(4)
v_exp_f32 v94, v94
v_mfma_f32_16x16x32_bf16 v[84:87], a[92:95], a[12:15], v[84:87]
s_waitcnt lgkmcnt(0)
buffer_load_dwordx4 a[220:223], v4, s[40:43], s34 offen offset:3072 sc1
v_mfma_f32_16x16x32_bf16 v[128:131], a[112:115], v[52:55], v[128:131]
v_exp_f32 v88, v88
v_mfma_f32_16x16x32_bf16 v[128:131], a[96:99], v[48:51], v[128:131]
buffer_load_dwordx4 v31, s[8:11], s36 offen offset:3072 sc1 lds
v_mfma_f32_16x16x32_bf16 v[132:135], a[116:119], v[52:55], v[132:135]
s_sub_u32 s36, s36, s61
v_exp_f32 v91, v91
v_mfma_f32_16x16x32_bf16 v[132:135], a[100:103], v[48:51], v[132:135]
v_exp_f32 v95, v95
v_mfma_f32_16x16x32_bf16 v[136:139], a[120:123], v[52:55], v[136:139]
s_and_b32 m0, s39, 0x1ffff
v_exp_f32 v89, v89
v_mfma_f32_16x16x32_bf16 v[136:139], a[104:107], v[48:51], v[136:139]
v_cvt_pk_bf16_f32 v56, v88, v89
v_cvt_pk_bf16_f32 v59, v94, v95
v_mfma_f32_16x16x32_bf16 v[140:143], a[124:127], v[52:55], v[140:143]
s_add_u32 s39, s39, 0x1008000
v_and_or_b32 v5, s39, v20, v4
v_cvt_pk_bf16_f32 v57, v90, v91
v_mfma_f32_16x16x32_bf16 v[140:143], a[108:111], v[48:51], v[140:143]
s_cbranch_scc0 kf_kernel_loopB
s_branch kf_kernel_loopBx
kf_kernel_hB10:
v_mfma_f32_16x16x32_bf16 v[88:91], a[64:67], a[16:19], v[36:39]
s_waitcnt vmcnt(16) lgkmcnt(0)
s_barrier
v_mfma_f32_16x16x32_bf16 v[88:91], a[68:71], a[20:23], v[88:91]
s_sub_u32 s34, s33, 24576
ds_read_b128 a[64:67], v5 offset:0
ds_read_b128 a[68:71], v5 offset:1024
buffer_load_dwordx4 v6, s[8:11], s36 offen offset:0 sc1 lds
v_mfma_f32_16x16x32_bf16 v[88:91], a[72:75], a[24:27], v[88:91]
ds_read_b128 a[72:75], v5 offset:2048
v_exp_f32 v86, v86
v_mfma_f32_16x16x32_bf16 v[88:91], a[76:79], a[28:31], v[88:91]
v_exp_f32 v83, v83
v_mfma_f32_16x16x32_bf16 v[92:95], a[80:83], a[16:19], v[36:39]
ds_read_b128 a[76:79], v5 offset:3072
ds_read_b128 a[80:83], v5 offset:4096
v_mfma_f32_16x16x32_bf16 v[92:95], a[84:87], a[20:23], v[92:95]
buffer_load_dwordx4 a[224:227], v4, s[40:43], s34 offen offset:0 sc1
v_exp_f32 v85, v85
v_mfma_f32_16x16x32_bf16 v[92:95], a[88:91], a[24:27], v[92:95]
s_add_u32 s27, s27, 1
ds_read_b128 a[84:87], v5 offset:5120
ds_read_b128 a[88:91], v5 offset:6144
v_mfma_f32_16x16x32_bf16 v[92:95], a[92:95], a[28:31], v[92:95]
ds_read_b128 a[92:95], v5 offset:7168
v_exp_f32 v82, v82
v_mfma_f32_16x16x32_bf16 v[160:163], a[112:115], v[60:63], v[160:163]
buffer_load_dwordx4 v7, s[8:11], s36 offen offset:1024 sc1 lds
v_mfma_f32_16x16x32_bf16 v[160:163], a[96:99], v[56:59], v[160:163]
ds_read_b128 a[112:115], v5 offset:12288
v_cvt_pk_bf16_f32 v53, v82, v83
v_mfma_f32_16x16x32_bf16 v[164:167], a[116:119], v[60:63], v[164:167]
s_waitcnt lgkmcnt(5)
buffer_load_dwordx4 v28, s[8:11], s36 offen offset:2048 sc1 lds
v_mfma_f32_16x16x32_bf16 v[164:167], a[100:103], v[56:59], v[164:167]
ds_read_b128 a[96:99], v5 offset:8192
ds_read_b128 a[116:119], v5 offset:13312
ds_read_b128 a[100:103], v5 offset:9216
v_exp_f32 v81, v81
v_mfma_f32_16x16x32_bf16 v[168:171], a[120:123], v[60:63], v[168:171]
s_add_u32 s26, s39, 2097152
v_exp_f32 v80, v80
v_mfma_f32_16x16x32_bf16 v[168:171], a[104:107], v[56:59], v[168:171]
ds_read_b128 a[120:123], v5 offset:14336
ds_read_b128 a[104:107], v5 offset:10240
v_mfma_f32_16x16x32_bf16 v[172:175], a[124:127], v[60:63], v[172:175]
ds_read_b128 a[124:127], v5 offset:15360
v_cvt_pk_bf16_f32 v52, v80, v81
v_mfma_f32_16x16x32_bf16 v[172:175], a[108:111], v[56:59], v[172:175]
s_waitcnt lgkmcnt(7)
buffer_load_dwordx4 v31, s[8:11], s36 offen offset:3072 sc1 lds
v_mfma_f32_16x16x32_bf16 v[80:83], a[64:67], a[0:3], v[32:35]
s_lshr_b32 s3, s4, 1
v_exp_f32 v94, v94
v_mfma_f32_16x16x32_bf16 v[80:83], a[68:71], a[4:7], v[80:83]
s_bitset1_b32 m0, 14
ds_read_b128 a[108:111], v5 offset:11264
v_exp_f32 v84, v84
v_mfma_f32_16x16x32_bf16 v[80:83], a[72:75], a[8:11], v[80:83]
v_exp_f32 v87, v87
v_mfma_f32_16x16x32_bf16 v[80:83], a[76:79], a[12:15], v[80:83]
s_min_u32 s59, s26, s32
v_cvt_pk_bf16_f32 v55, v86, v87
v_exp_f32 v91, v91
v_cvt_pk_bf16_f32 v54, v84, v85
v_mfma_f32_16x16x32_bf16 v[84:87], a[80:83], a[0:3], v[32:35]
buffer_load_dwordx4 a[228:231], v4, s[40:43], s34 offen offset:1024 sc1
v_mfma_f32_16x16x32_bf16 v[84:87], a[84:87], a[4:7], v[84:87]
s_sub_u32 s36, s36, s61
v_exp_f32 v93, v93
v_mfma_f32_16x16x32_bf16 v[84:87], a[88:91], a[8:11], v[84:87]
buffer_load_dwordx4 v6, s[8:11], s36 offen offset:0 sc1 lds
v_mfma_f32_16x16x32_bf16 v[84:87], a[92:95], a[12:15], v[84:87]
s_waitcnt lgkmcnt(4)
v_exp_f32 v80, v80
v_smfmac_f32_16x16x64_bf16 a[240:243], v[112:115], v[48:55], v19
v_exp_f32 v92, v92
v_mfma_f32_16x16x32_bf16 v[144:147], a[96:99], v[48:51], v[144:147]
s_waitcnt lgkmcnt(0)
v_exp_f32 v95, v95
v_mfma_f32_16x16x32_bf16 v[144:147], a[112:115], v[52:55], v[144:147]
buffer_load_dwordx4 v7, s[8:11], s36 offen offset:1024 sc1 lds
v_mfma_f32_16x16x32_bf16 v[148:151], a[100:103], v[48:51], v[148:151]
v_exp_f32 v82, v82
v_mfma_f32_16x16x32_bf16 v[148:151], a[116:119], v[52:55], v[148:151]
buffer_load_dwordx4 v28, s[8:11], s36 offen offset:2048 sc1 lds
v_mfma_f32_16x16x32_bf16 v[152:155], a[104:107], v[48:51], v[152:155]
s_sub_u32 s59, s59, s39
v_exp_f32 v90, v90
v_mfma_f32_16x16x32_bf16 v[152:155], a[120:123], v[52:55], v[152:155]
s_lshl_b32 s3, s3, 6
v_exp_f32 v88, v88
v_mfma_f32_16x16x32_bf16 v[156:159], a[108:111], v[48:51], v[156:159]
v_exp_f32 v89, v89
v_mfma_f32_16x16x32_bf16 v[156:159], a[124:127], v[52:55], v[156:159]
v_cvt_pk_bf16_f32 v62, v92, v93
v_cvt_pk_bf16_f32 v61, v90, v91
v_cvt_pk_bf16_f32 v60, v88, v89
v_mfma_f32_16x16x32_bf16 v[88:91], a[64:67], a[16:19], v[36:39]
v_exp_f32 v83, v83
v_mfma_f32_16x16x32_bf16 v[88:91], a[68:71], a[20:23], v[88:91]
s_add_u32 s3, s3, s21
ds_read_b128 a[64:67], v5 offset:16384
v_cvt_pk_bf16_f32 v63, v94, v95
v_mfma_f32_16x16x32_bf16 v[88:91], a[72:75], a[24:27], v[88:91]
s_lshl_b32 s59, s59, 9
ds_read_b128 a[68:71], v5 offset:17408
ds_read_b128 a[72:75], v5 offset:18432
buffer_load_dwordx4 a[232:235], v4, s[40:43], s34 offen offset:2048 sc1
v_mfma_f32_16x16x32_bf16 v[88:91], a[76:79], a[28:31], v[88:91]
buffer_load_dwordx4 v31, s[8:11], s36 offen offset:3072 sc1 lds
v_mfma_f32_16x16x32_bf16 v[92:95], a[80:83], a[16:19], v[36:39]
s_add_u32 m0, s28, 147456
v_exp_f32 v87, v87
v_mfma_f32_16x16x32_bf16 v[92:95], a[84:87], a[20:23], v[92:95]
ds_read_b128 a[76:79], v5 offset:19456
v_bfe_u32 v2, v0, 5, 1
v_mfma_f32_16x16x32_bf16 v[92:95], a[88:91], a[24:27], v[92:95]
s_sub_u32 s39, s39, s59
ds_read_b128 a[80:83], v5 offset:20480
ds_read_b128 a[84:87], v5 offset:21504
v_mfma_f32_16x16x32_bf16 v[92:95], a[92:95], a[28:31], v[92:95]
ds_read_b128 a[88:91], v5 offset:22528
ds_read_b128 a[92:95], v5 offset:23552
v_cvt_pk_bf16_f32 v49, v82, v83
v_smfmac_f32_16x16x64_bf16 a[244:247], v[112:115], v[56:63], v19
s_add_u32 s29, s35, 0xfffffc80
v_exp_f32 v89, v89
v_mfma_f32_16x16x32_bf16 v[176:179], a[96:99], v[56:59], v[176:179]
v_exp_f32 v88, v88
v_mfma_f32_16x16x32_bf16 v[176:179], a[112:115], v[60:63], v[176:179]
buffer_load_dwordx4 v21, s[44:47], s29 offen offset:0 lds
ds_read_b128 a[96:99], v5 offset:24576
v_mfma_f32_16x16x32_bf16 v[180:183], a[100:103], v[56:59], v[180:183]
s_sub_u32 s36, s36, s61
ds_read_b128 a[112:115], v5 offset:28672
ds_read_b128 a[100:103], v5 offset:25600
v_mfma_f32_16x16x32_bf16 v[180:183], a[116:119], v[60:63], v[180:183]
ds_read_b128 a[116:119], v5 offset:29696
v_exp_f32 v86, v86
v_mfma_f32_16x16x32_bf16 v[184:187], a[104:107], v[56:59], v[184:187]
buffer_load_dwordx4 v22, s[44:47], s29 offen offset:1024 lds
v_mfma_f32_16x16x32_bf16 v[184:187], a[120:123], v[60:63], v[184:187]
v_exp_f32 v81, v81
v_mfma_f32_16x16x32_bf16 v[188:191], a[108:111], v[56:59], v[188:191]
s_waitcnt lgkmcnt(8)
v_and_b32 v1, 31, v0
v_exp_f32 v85, v85
v_mfma_f32_16x16x32_bf16 v[188:191], a[124:127], v[60:63], v[188:191]
v_exp_f32 v84, v84
v_cvt_pk_bf16_f32 v48, v80, v81
v_mfma_f32_16x16x32_bf16 v[80:83], a[64:67], a[0:3], v[32:35]
s_waitcnt lgkmcnt(4)
ds_read_b128 a[104:107], v5 offset:26624
ds_read_b128 a[120:123], v5 offset:30720
v_mfma_f32_16x16x32_bf16 v[80:83], a[68:71], a[4:7], v[80:83]
v_exp_f32 v93, v93
v_mfma_f32_16x16x32_bf16 v[80:83], a[72:75], a[8:11], v[80:83]
buffer_load_dwordx4 a[236:239], v4, s[40:43], s34 offen offset:3072 sc1
v_mfma_f32_16x16x32_bf16 v[80:83], a[76:79], a[12:15], v[80:83]
s_waitcnt lgkmcnt(2)
v_cvt_pk_bf16_f32 v51, v86, v87
v_cvt_pk_bf16_f32 v50, v84, v85
v_mfma_f32_16x16x32_bf16 v[84:87], a[80:83], a[0:3], v[32:35]
s_lshl_b32 s3, s3, 12
ds_read_b128 a[108:111], v5 offset:27648
ds_read_b128 a[124:127], v5 offset:31744
v_mfma_f32_16x16x32_bf16 v[84:87], a[84:87], a[4:7], v[84:87]
buffer_load_dwordx4 v23, s[44:47], s29 offen offset:2048 lds
v_mfma_f32_16x16x32_bf16 v[84:87], a[88:91], a[8:11], v[84:87]
v_exp_f32 v95, v95
v_exp_f32 v91, v91
v_mfma_f32_16x16x32_bf16 v[84:87], a[92:95], a[12:15], v[84:87]
v_exp_f32 v94, v94
v_mfma_f32_16x16x32_bf16 v[128:131], a[112:115], v[52:55], v[128:131]
s_add_u32 s3, s3, 54525952
v_exp_f32 v90, v90
v_mfma_f32_16x16x32_bf16 v[128:131], a[96:99], v[48:51], v[128:131]
buffer_load_dwordx4 v24, s[44:47], s29 offen offset:3072 lds
v_mfma_f32_16x16x32_bf16 v[132:135], a[116:119], v[52:55], v[132:135]
s_and_b32 m0, s39, 0x1ffff
v_exp_f32 v92, v92
v_mfma_f32_16x16x32_bf16 v[132:135], a[100:103], v[48:51], v[132:135]
s_waitcnt lgkmcnt(0)
v_cvt_pk_bf16_f32 v56, v88, v89
v_cvt_pk_bf16_f32 v57, v90, v91
v_mfma_f32_16x16x32_bf16 v[136:139], a[120:123], v[52:55], v[136:139]
v_lshlrev_b32 v2, 17, v2
v_cvt_pk_bf16_f32 v58, v92, v93
v_cvt_pk_bf16_f32 v59, v94, v95
v_mfma_f32_16x16x32_bf16 v[136:139], a[104:107], v[48:51], v[136:139]
s_add_u32 s39, s39, 0x1008000
v_and_or_b32 v5, s39, v20, v4
v_lshl_add_u32 v1, v1, 7, v2
v_mfma_f32_16x16x32_bf16 v[140:143], a[124:127], v[52:55], v[140:143]
buffer_load_dword v30, v1, s[40:43], s3 offen sc1
v_mfma_f32_16x16x32_bf16 v[140:143], a[108:111], v[48:51], v[140:143]
s_cbranch_scc0 kf_kernel_loopB
s_branch kf_kernel_loopBx
kf_kernel_pd29:
s_branch kf_kernel_pd33
kf_kernel_hA:
s_cmp_gt_u32 s27, 4
s_cbranch_scc1 kf_kernel_hAw
kf_kernel_hAv:
s_cmp_eq_u32 s27, 1
s_cbranch_scc1 kf_kernel_hA1
s_cmp_eq_u32 s27, 2
s_cbranch_scc1 kf_kernel_hA2
s_cmp_eq_u32 s27, 3
s_cbranch_scc1 kf_kernel_hA3
s_cmp_eq_u32 s27, 4
s_cbranch_scc1 kf_kernel_hA4
kf_kernel_hA0:
v_mfma_f32_16x16x32_bf16 v[88:91], a[64:67], a[16:19], v[36:39]
s_waitcnt vmcnt(16) lgkmcnt(0)
s_barrier
v_mfma_f32_16x16x32_bf16 v[88:91], a[68:71], a[20:23], v[88:91]
v_accvgpr_write_b32 a160, -1
v_accvgpr_write_b32 a161, -1
v_mfma_f32_16x16x32_bf16 v[88:91], a[72:75], a[24:27], v[88:91]
buffer_load_dwordx4 v6, s[8:11], s36 offen offset:0 sc1 lds
v_mfma_f32_16x16x32_bf16 v[88:91], a[76:79], a[28:31], v[88:91]
s_add_u32 s27, s27, 1
v_exp_f32 v80, v80
v_mfma_f32_16x16x32_bf16 v[92:95], a[80:83], a[16:19], v[36:39]
s_lshl2_add_u32 s15, s2, s20
v_exp_f32 v81, v81
v_mfma_f32_16x16x32_bf16 v[92:95], a[84:87], a[20:23], v[92:95]
s_sub_u32 s15, 1023, s15
v_accvgpr_write_b32 a163, -1
v_cvt_pk_bf16_f32 v52, v80, v81
v_mfma_f32_16x16x32_bf16 v[92:95], a[88:91], a[24:27], v[92:95]
s_mul_i32 s14, s15, 52429
v_exp_f32 v83, v83
v_mfma_f32_16x16x32_bf16 v[92:95], a[92:95], a[28:31], v[92:95]
s_lshr_b32 s14, s14, 18
v_exp_f32 v82, v82
v_mfma_f32_16x16x32_bf16 v[104:107], a[64:67], a[48:51], v[44:47]
buffer_load_dwordx4 v7, s[8:11], s36 offen offset:1024 sc1 lds
v_mfma_f32_16x16x32_bf16 v[104:107], a[68:71], a[52:55], v[104:107]
s_mul_i32 s18, s14, 24576
ds_read_b128 a[64:67], v5 offset:0
ds_read_b128 a[68:71], v5 offset:1024
v_mfma_f32_16x16x32_bf16 v[104:107], a[72:75], a[56:59], v[104:107]
s_lshl2_add_u32 s34, s2, s20
v_exp_f32 v84, v84
v_mfma_f32_16x16x32_bf16 v[104:107], a[76:79], a[60:63], v[104:107]
s_lshl_b32 s15, s15, 8
v_exp_f32 v85, v85
v_mfma_f32_16x16x32_bf16 v[108:111], a[80:83], a[48:51], v[44:47]
s_mul_i32 s14, s14, 39680
ds_read_b128 a[72:75], v5 offset:2048
v_cvt_pk_bf16_f32 v53, v82, v83
v_mfma_f32_16x16x32_bf16 v[108:111], a[84:87], a[52:55], v[108:111]
s_sub_u32 s39, s39, 16777216
v_exp_f32 v97, v97
v_mfma_f32_16x16x32_bf16 v[108:111], a[88:91], a[56:59], v[108:111]
s_add_u32 s14, s14, s15
ds_read_b128 a[76:79], v5 offset:3072
ds_read_b128 a[80:83], v5 offset:4096
v_mfma_f32_16x16x32_bf16 v[108:111], a[92:95], a[60:63], v[108:111]
s_mul_i32 s34, s34, 13312
v_exp_f32 v98, v98
v_mfma_f32_16x16x32_bf16 v[160:163], a[112:115], v[60:63], v[160:163]
s_lshl_b32 s15, s15, 5
v_accvgpr_write_b32 a162, -1
v_bfe_u32 v1, v0, 1, 5
v_mfma_f32_16x16x32_bf16 v[160:163], a[96:99], v[56:59], v[160:163]
s_add_u32 s15, s15, s18
ds_read_b128 a[84:87], v5 offset:5120
ds_read_b128 a[88:91], v5 offset:6144
v_mfma_f32_16x16x32_bf16 v[164:167], a[116:119], v[60:63], v[164:167]
s_mov_b32 s18, 5242880
v_exp_f32 v100, v100
v_mfma_f32_16x16x32_bf16 v[164:167], a[100:103], v[56:59], v[164:167]
s_cmp_ge_u32 s15, 8388608
v_exp_f32 v87, v87
v_mfma_f32_16x16x32_bf16 v[168:171], a[120:123], v[60:63], v[168:171]
s_cselect_b32 s18, 1105920, s18
v_exp_f32 v96, v96
v_mfma_f32_16x16x32_bf16 v[168:171], a[104:107], v[56:59], v[168:171]
s_cselect_b32 s17, s13, s17
ds_read_b128 a[92:95], v5 offset:7168
v_cvt_pk_bf16_f32 v54, v84, v85
v_mfma_f32_16x16x32_bf16 v[172:175], a[124:127], v[60:63], v[172:175]
buffer_load_dwordx4 v28, s[8:11], s36 offen offset:2048 sc1 lds
v_mfma_f32_16x16x32_bf16 v[172:175], a[108:111], v[56:59], v[172:175]
s_cselect_b32 s16, s12, s16
v_exp_f32 v102, v102
v_mfma_f32_16x16x32_bf16 v[224:227], a[112:115], v[76:79], v[224:227]
s_cselect_b32 s12, 5242880, 0
v_exp_f32 v99, v99
v_mfma_f32_16x16x32_bf16 v[224:227], a[96:99], v[72:75], v[224:227]
s_add_u32 s34, s34, 83886080
ds_read_b128 a[112:115], v5 offset:12288
ds_read_b128 a[96:99], v5 offset:8192
v_mfma_f32_16x16x32_bf16 v[228:231], a[116:119], v[76:79], v[228:231]
buffer_store_dwordx4 a[160:163], v4, s[40:43], s34 offen offset:0 sc1
v_mfma_f32_16x16x32_bf16 v[228:231], a[100:103], v[72:75], v[228:231]
s_lshr_b32 s60, s37, 4
ds_read_b128 a[116:119], v5 offset:13312
ds_read_b128 a[100:103], v5 offset:9216
v_mfma_f32_16x16x32_bf16 v[232:235], a[120:123], v[76:79], v[232:235]
s_sub_u32 s3, 15, s60
v_exp_f32 v88, v88
v_mfma_f32_16x16x32_bf16 v[232:235], a[104:107], v[72:75], v[232:235]
s_mov_b32 s19, 0x20000
ds_read_b128 a[120:123], v5 offset:14336
ds_read_b128 a[104:107], v5 offset:10240
v_mfma_f32_16x16x32_bf16 v[236:239], a[124:127], v[76:79], v[236:239]
s_waitcnt lgkmcnt(10)
buffer_store_dwordx4 a[160:163], v4, s[40:43], s34 offen offset:1024 sc1
v_mfma_f32_16x16x32_bf16 v[236:239], a[108:111], v[72:75], v[236:239]
s_min_u32 s60, s60, s3
v_exp_f32 v101, v101
v_mfma_f32_16x16x32_bf16 v[80:83], a[64:67], a[0:3], v[32:35]
v_mul_u32_u24 v1, 1280, v1
v_exp_f32 v86, v86
v_mfma_f32_16x16x32_bf16 v[80:83], a[68:71], a[4:7], v[80:83]
s_lshl_b32 s60, s60, 2
v_exp_f32 v103, v103
v_mfma_f32_16x16x32_bf16 v[80:83], a[72:75], a[8:11], v[80:83]
s_waitcnt lgkmcnt(6)
buffer_store_dwordx4 a[160:163], v4, s[40:43], s34 offen offset:2048 sc1
v_mfma_f32_16x16x32_bf16 v[80:83], a[76:79], a[12:15], v[80:83]
v_cvt_pk_bf16_f32 v55, v86, v87
v_cvt_pk_bf16_f32 v68, v96, v97
v_mfma_f32_16x16x32_bf16 v[84:87], a[80:83], a[0:3], v[32:35]
s_bfe_u32 s3, s37, 0x20002
v_exp_f32 v89, v89
v_mfma_f32_16x16x32_bf16 v[84:87], a[84:87], a[4:7], v[84:87]
ds_read_b128 a[124:127], v5 offset:15360
ds_read_b128 a[108:111], v5 offset:11264
v_mfma_f32_16x16x32_bf16 v[84:87], a[88:91], a[8:11], v[84:87]
v_exp_f32 v92, v92
v_mfma_f32_16x16x32_bf16 v[84:87], a[92:95], a[12:15], v[84:87]
s_sub_u32 s14, s14, s12
v_cvt_pk_bf16_f32 v69, v98, v99
v_cvt_pk_bf16_f32 v71, v102, v103
v_mfma_f32_16x16x32_bf16 v[96:99], a[64:67], a[32:35], v[40:43]
s_add_u32 s60, s60, s3
v_exp_f32 v93, v93
v_mfma_f32_16x16x32_bf16 v[96:99], a[68:71], a[36:39], v[96:99]
buffer_load_dwordx4 v31, s[8:11], s36 offen offset:3072 sc1 lds
v_mfma_f32_16x16x32_bf16 v[96:99], a[72:75], a[40:43], v[96:99]
s_waitcnt lgkmcnt(4)
s_branch kf_kernel_pl30
kf_kernel_pd30:
s_branch kf_kernel_pd34
kf_kernel_pl30:
buffer_store_dwordx4 a[160:163], v4, s[40:43], s34 offen offset:3072 sc1
v_mfma_f32_16x16x32_bf16 v[96:99], a[76:79], a[44:47], v[96:99]
v_and_b32 v3, 1, v0
v_cvt_pk_bf16_f32 v70, v100, v101
v_mfma_f32_16x16x32_bf16 v[100:103], a[80:83], a[32:35], v[40:43]
s_lshl_b32 s60, s60, 8
v_exp_f32 v91, v91
v_mfma_f32_16x16x32_bf16 v[100:103], a[84:87], a[36:39], v[100:103]
v_exp_f32 v95, v95
v_mfma_f32_16x16x32_bf16 v[100:103], a[88:91], a[40:43], v[100:103]
v_exp_f32 v90, v90
v_mfma_f32_16x16x32_bf16 v[100:103], a[92:95], a[44:47], v[100:103]
v_lshl_add_u32 v1, v3, 7, v1
v_lshrrev_b32 v3, 6, v0
v_smfmac_f32_16x16x64_bf16 a[240:243], v[112:115], v[48:55], v19
s_bitset1_b32 m0, 14
v_exp_f32 v104, v104
v_mfma_f32_16x16x32_bf16 v[144:147], a[96:99], v[48:51], v[144:147]
s_add_u32 s60, s60, 3194880
v_cvt_pk_bf16_f32 v62, v92, v93
v_lshl_add_u32 v3, v3, 8, s2
v_mfma_f32_16x16x32_bf16 v[144:147], a[112:115], v[52:55], v[144:147]
s_waitcnt lgkmcnt(0)
v_mul_u32_u24 v3, 2560, v3
v_cvt_pk_bf16_f32 v60, v88, v89
v_mfma_f32_16x16x32_bf16 v[148:151], a[100:103], v[48:51], v[148:151]
v_exp_f32 v105, v105
v_mfma_f32_16x16x32_bf16 v[148:151], a[116:119], v[52:55], v[148:151]
buffer_load_dword v30, off, s[40:43], s60 sc1
v_mfma_f32_16x16x32_bf16 v[152:155], a[104:107], v[48:51], v[152:155]
v_exp_f32 v107, v107
v_mfma_f32_16x16x32_bf16 v[152:155], a[120:123], v[52:55], v[152:155]
v_exp_f32 v109, v109
v_mfma_f32_16x16x32_bf16 v[156:159], a[108:111], v[48:51], v[156:159]
v_exp_f32 v106, v106
v_mfma_f32_16x16x32_bf16 v[156:159], a[124:127], v[52:55], v[156:159]
buffer_load_dword a238, v1, s[16:19], s14 offen
v_smfmac_f32_16x16x64_bf16 a[248:251], v[112:115], v[64:71], v19
s_sub_u32 s36, s36, s61
v_exp_f32 v94, v94
v_mfma_f32_16x16x32_bf16 v[208:211], a[96:99], v[64:67], v[208:211]
global_load_dword a237, v3, s[86:87]
v_mfma_f32_16x16x32_bf16 v[208:211], a[112:115], v[68:71], v[208:211]
v_cvt_pk_bf16_f32 v77, v106, v107
v_cvt_pk_bf16_f32 v63, v94, v95
v_mfma_f32_16x16x32_bf16 v[212:215], a[100:103], v[64:67], v[212:215]
v_exp_f32 v110, v110
v_mfma_f32_16x16x32_bf16 v[212:215], a[116:119], v[68:71], v[212:215]
v_exp_f32 v108, v108
v_mfma_f32_16x16x32_bf16 v[216:219], a[104:107], v[64:67], v[216:219]
v_cvt_pk_bf16_f32 v76, v104, v105
v_cvt_pk_bf16_f32 v78, v108, v109
v_mfma_f32_16x16x32_bf16 v[216:219], a[120:123], v[68:71], v[216:219]
v_exp_f32 v111, v111
v_mfma_f32_16x16x32_bf16 v[220:223], a[108:111], v[64:67], v[220:223]
v_cvt_pk_bf16_f32 v61, v90, v91
v_cvt_pk_bf16_f32 v79, v110, v111
v_mfma_f32_16x16x32_bf16 v[220:223], a[124:127], v[68:71], v[220:223]
s_cbranch_scc1 kf_kernel_sw_loopAB1
s_branch kf_kernel_loopAB1
kf_kernel_hA1:
v_mfma_f32_16x16x32_bf16 v[88:91], a[64:67], a[16:19], v[36:39]
s_waitcnt vmcnt(16) lgkmcnt(0)
s_barrier
v_and_b32 v3, 31, v0
v_cmp_gt_u32 vcc, 12, v3
v_mfma_f32_16x16x32_bf16 v[88:91], a[68:71], a[20:23], v[88:91]
s_mul_i32 s3, s37, 13824
v_lshrrev_b32 v1, 5, v0
v_mul_u32_u24 v1, 1728, v1
v_mfma_f32_16x16x32_bf16 v[88:91], a[72:75], a[24:27], v[88:91]
s_add_u32 s3, s3, 46137344
v_lshl_add_u32 v21, v3, 4, v1
v_mov_b32 v1, 1073741824
v_mfma_f32_16x16x32_bf16 v[88:91], a[76:79], a[28:31], v[88:91]
s_waitcnt vmcnt(6)
v_cndmask_b32 v22, v1, v21, vcc
v_cmp_gt_u32 vcc, 27, v30
v_mfma_f32_16x16x32_bf16 v[92:95], a[80:83], a[16:19], v[36:39]
s_cmp_lg_u64 vcc, 0
s_cbranch_scc1 kf_kernel_spin_zA
kf_kernel_ret_zA:
v_mfma_f32_16x16x32_bf16 v[92:95], a[84:87], a[20:23], v[92:95]
v_exp_f32 v99, v99
v_mfma_f32_16x16x32_bf16 v[92:95], a[88:91], a[24:27], v[92:95]
buffer_load_dwordx4 v[116:119], v21, s[40:43], s3 offen offset:0 sc1
v_mfma_f32_16x16x32_bf16 v[92:95], a[92:95], a[28:31], v[92:95]
v_exp_f32 v83, v83
v_mfma_f32_16x16x32_bf16 v[104:107], a[64:67], a[48:51], v[44:47]
v_exp_f32 v100, v100
v_mfma_f32_16x16x32_bf16 v[104:107], a[68:71], a[52:55], v[104:107]
ds_read_b128 a[64:67], v5 offset:0
ds_read_b128 a[68:71], v5 offset:1024
v_mfma_f32_16x16x32_bf16 v[104:107], a[72:75], a[56:59], v[104:107]
buffer_load_dwordx4 v[120:123], v21, s[40:43], s3 offen offset:512 sc1
v_mfma_f32_16x16x32_bf16 v[104:107], a[76:79], a[60:63], v[104:107]
ds_read_b128 a[72:75], v5 offset:2048
ds_read_b128 a[76:79], v5 offset:3072
v_mfma_f32_16x16x32_bf16 v[108:111], a[80:83], a[48:51], v[44:47]
ds_read_b128 a[80:83], v5 offset:4096
buffer_load_dwordx4 v[124:127], v21, s[40:43], s3 offen offset:1024 sc1
v_mfma_f32_16x16x32_bf16 v[108:111], a[84:87], a[52:55], v[108:111]
v_exp_f32 v85, v85
v_mfma_f32_16x16x32_bf16 v[108:111], a[88:91], a[56:59], v[108:111]
buffer_load_dwordx4 v[24:27], v22, s[40:43], s3 offen offset:1536 sc1
v_mfma_f32_16x16x32_bf16 v[108:111], a[92:95], a[60:63], v[108:111]
ds_read_b128 a[84:87], v5 offset:5120
ds_read_b128 a[88:91], v5 offset:6144
ds_read_b128 a[92:95], v5 offset:7168
v_mfma_f32_16x16x32_bf16 v[160:163], a[112:115], v[60:63], v[160:163]
v_exp_f32 v81, v81
v_mfma_f32_16x16x32_bf16 v[160:163], a[96:99], v[56:59], v[160:163]
v_exp_f32 v82, v82
v_mfma_f32_16x16x32_bf16 v[164:167], a[116:119], v[60:63], v[164:167]
s_lshr_b32 s3, s23, 1
v_exp_f32 v86, v86
v_mfma_f32_16x16x32_bf16 v[164:167], a[100:103], v[56:59], v[164:167]
buffer_load_dwordx4 v6, s[8:11], s36 offen offset:0 sc1 lds
v_mfma_f32_16x16x32_bf16 v[168:171], a[120:123], v[60:63], v[168:171]
v_exp_f32 v97, v97
v_mfma_f32_16x16x32_bf16 v[168:171], a[104:107], v[56:59], v[168:171]
v_exp_f32 v84, v84
v_mfma_f32_16x16x32_bf16 v[172:175], a[124:127], v[60:63], v[172:175]
s_lshl_b32 s3, s3, 5
v_exp_f32 v96, v96
v_cvt_pk_bf16_f32 v53, v82, v83
v_mfma_f32_16x16x32_bf16 v[172:175], a[108:111], v[56:59], v[172:175]
s_add_u32 s3, s3, s24
v_exp_f32 v98, v98
v_mfma_f32_16x16x32_bf16 v[224:227], a[112:115], v[76:79], v[224:227]
v_exp_f32 v80, v80
v_mfma_f32_16x16x32_bf16 v[224:227], a[96:99], v[72:75], v[224:227]
buffer_load_dwordx4 v7, s[8:11], s36 offen offset:1024 sc1 lds
v_mfma_f32_16x16x32_bf16 v[228:231], a[116:119], v[76:79], v[228:231]
s_and_b32 s29, s23, 1
ds_read_b128 a[112:115], v5 offset:12288
ds_read_b128 a[96:99], v5 offset:8192
ds_read_b128 a[116:119], v5 offset:13312
v_mfma_f32_16x16x32_bf16 v[228:231], a[100:103], v[72:75], v[228:231]
ds_read_b128 a[100:103], v5 offset:9216
v_exp_f32 v87, v87
v_mfma_f32_16x16x32_bf16 v[232:235], a[120:123], v[76:79], v[232:235]
v_exp_f32 v103, v103
v_mfma_f32_16x16x32_bf16 v[232:235], a[104:107], v[72:75], v[232:235]
s_waitcnt lgkmcnt(8)
v_cvt_pk_bf16_f32 v52, v80, v81
v_cvt_pk_bf16_f32 v55, v86, v87
v_mfma_f32_16x16x32_bf16 v[236:239], a[124:127], v[76:79], v[236:239]
v_exp_f32 v90, v90
v_mfma_f32_16x16x32_bf16 v[236:239], a[108:111], v[72:75], v[236:239]
s_add_u32 s27, s27, 1
v_exp_f32 v88, v88
v_mfma_f32_16x16x32_bf16 v[80:83], a[64:67], a[0:3], v[32:35]
ds_read_b128 a[120:123], v5 offset:14336
ds_read_b128 a[104:107], v5 offset:10240
v_mfma_f32_16x16x32_bf16 v[80:83], a[68:71], a[4:7], v[80:83]
v_bfe_u32 v2, v0, 4, 4
v_lshlrev_b32 v2, 12, v2
v_mfma_f32_16x16x32_bf16 v[80:83], a[72:75], a[8:11], v[80:83]
s_waitcnt lgkmcnt(6)
v_exp_f32 v102, v102
v_mfma_f32_16x16x32_bf16 v[80:83], a[76:79], a[12:15], v[80:83]
ds_read_b128 a[124:127], v5 offset:15360
v_cvt_pk_bf16_f32 v54, v84, v85
v_mfma_f32_16x16x32_bf16 v[84:87], a[80:83], a[0:3], v[32:35]
buffer_load_dwordx4 v28, s[8:11], s36 offen offset:2048 sc1 lds
v_mfma_f32_16x16x32_bf16 v[84:87], a[84:87], a[4:7], v[84:87]
buffer_load_dwordx4 v31, s[8:11], s36 offen offset:3072 sc1 lds
v_mfma_f32_16x16x32_bf16 v[84:87], a[88:91], a[8:11], v[84:87]
s_lshl_b32 s3, s3, 5
v_cvt_pk_bf16_f32 v68, v96, v97
v_cvt_pk_bf16_f32 v69, v98, v99
v_mfma_f32_16x16x32_bf16 v[84:87], a[92:95], a[12:15], v[84:87]
s_sub_u32 s39, s39, 16777216
v_exp_f32 v101, v101
v_mfma_f32_16x16x32_bf16 v[96:99], a[64:67], a[32:35], v[40:43]
ds_read_b128 a[108:111], v5 offset:11264
v_mfma_f32_16x16x32_bf16 v[96:99], a[68:71], a[36:39], v[96:99]
v_exp_f32 v95, v95
v_mfma_f32_16x16x32_bf16 v[96:99], a[72:75], a[40:43], v[96:99]
v_and_b32 v3, 15, v0
v_mfma_f32_16x16x32_bf16 v[96:99], a[76:79], a[44:47], v[96:99]
v_cvt_pk_bf16_f32 v70, v100, v101
v_cvt_pk_bf16_f32 v71, v102, v103
v_mfma_f32_16x16x32_bf16 v[100:103], a[80:83], a[32:35], v[40:43]
s_add_u32 s3, s3, s29
s_lshl_b32 s3, s3, 11
v_lshl_add_u32 v2, v3, 7, v2
v_mfma_f32_16x16x32_bf16 v[100:103], a[84:87], a[36:39], v[100:103]
s_waitcnt lgkmcnt(4)
v_exp_f32 v94, v94
v_mfma_f32_16x16x32_bf16 v[100:103], a[88:91], a[40:43], v[100:103]
buffer_load_dword a239, v2, s[44:47], s3 offen
v_mfma_f32_16x16x32_bf16 v[100:103], a[92:95], a[44:47], v[100:103]
s_waitcnt lgkmcnt(0)
v_exp_f32 v110, v110
v_smfmac_f32_16x16x64_bf16 a[240:243], v[112:115], v[48:55], v19
v_exp_f32 v104, v104
v_mfma_f32_16x16x32_bf16 v[144:147], a[96:99], v[48:51], v[144:147]
v_exp_f32 v91, v91
v_mfma_f32_16x16x32_bf16 v[144:147], a[112:115], v[52:55], v[144:147]
v_mfma_f32_16x16x32_bf16 v[148:151], a[100:103], v[48:51], v[148:151]
v_exp_f32 v105, v105
v_mfma_f32_16x16x32_bf16 v[148:151], a[116:119], v[52:55], v[148:151]
v_exp_f32 v111, v111
v_mfma_f32_16x16x32_bf16 v[152:155], a[104:107], v[48:51], v[152:155]
s_sub_u32 s36, s36, s61
v_exp_f32 v93, v93
v_mfma_f32_16x16x32_bf16 v[152:155], a[120:123], v[52:55], v[152:155]
v_exp_f32 v107, v107
v_mfma_f32_16x16x32_bf16 v[156:159], a[108:111], v[48:51], v[156:159]
v_exp_f32 v89, v89
v_mfma_f32_16x16x32_bf16 v[156:159], a[124:127], v[52:55], v[156:159]
v_exp_f32 v92, v92
v_smfmac_f32_16x16x64_bf16 a[248:251], v[112:115], v[64:71], v19
v_cvt_pk_bf16_f32 v63, v94, v95
v_cvt_pk_bf16_f32 v60, v88, v89
v_mfma_f32_16x16x32_bf16 v[208:211], a[96:99], v[64:67], v[208:211]
v_exp_f32 v106, v106
v_mfma_f32_16x16x32_bf16 v[208:211], a[112:115], v[68:71], v[208:211]
v_cvt_pk_bf16_f32 v77, v106, v107
v_mfma_f32_16x16x32_bf16 v[212:215], a[100:103], v[64:67], v[212:215]
v_exp_f32 v108, v108
v_mfma_f32_16x16x32_bf16 v[212:215], a[116:119], v[68:71], v[212:215]
v_cvt_pk_bf16_f32 v76, v104, v105
v_mfma_f32_16x16x32_bf16 v[216:219], a[104:107], v[64:67], v[216:219]
v_exp_f32 v109, v109
v_mfma_f32_16x16x32_bf16 v[216:219], a[120:123], v[68:71], v[216:219]
v_cvt_pk_bf16_f32 v61, v90, v91
v_cvt_pk_bf16_f32 v62, v92, v93
v_mfma_f32_16x16x32_bf16 v[220:223], a[108:111], v[64:67], v[220:223]
s_bitset1_b32 m0, 14
v_cvt_pk_bf16_f32 v78, v108, v109
v_cvt_pk_bf16_f32 v79, v110, v111
v_mfma_f32_16x16x32_bf16 v[220:223], a[124:127], v[68:71], v[220:223]
s_cbranch_scc1 kf_kernel_sw_loopAB1
s_branch kf_kernel_loopAB1
kf_kernel_hA2:
v_mfma_f32_16x16x32_bf16 v[88:91], a[64:67], a[16:19], v[36:39]
s_waitcnt vmcnt(16) lgkmcnt(0)
s_barrier
v_mfma_f32_16x16x32_bf16 v[88:91], a[68:71], a[20:23], v[88:91]
v_exp_f32 v99, v99
v_mfma_f32_16x16x32_bf16 v[88:91], a[72:75], a[24:27], v[88:91]
s_waitcnt vmcnt(9)
v_exp_f32 v97, v97
v_mfma_f32_16x16x32_bf16 v[88:91], a[76:79], a[28:31], v[88:91]
v_exp_f32 v81, v81
v_mfma_f32_16x16x32_bf16 v[92:95], a[80:83], a[16:19], v[36:39]
s_sub_u32 s39, s39, 16777216
v_lshrrev_b32 v1, 5, v0
v_mul_u32_u24 v1, 2112, v1
v_mfma_f32_16x16x32_bf16 v[92:95], a[84:87], a[20:23], v[92:95]
s_add_u32 s27, s27, 1
v_exp_f32 v101, v101
v_mfma_f32_16x16x32_bf16 v[92:95], a[88:91], a[24:27], v[92:95]
v_exp_f32 v100, v100
v_mfma_f32_16x16x32_bf16 v[92:95], a[92:95], a[28:31], v[92:95]
s_mov_b32 s3, 0x3f803f80
v_and_b32 v3, 31, v0
v_lshl_add_u32 v1, v3, 4, v1
v_exp_f32 v82, v82
v_add_u32 v1, 0x20000, v1
v_dot2_f32_bf16 v10, v117, s3, 0
v_dot2_f32_bf16 v11, v117, v117, 0
v_mfma_f32_16x16x32_bf16 v[104:107], a[64:67], a[48:51], v[44:47]
ds_read_b128 a[64:67], v5 offset:0
v_exp_f32 v102, v102
v_exp_f32 v96, v96
v_dot2_f32_bf16 v9, v116, v116, 0
v_dot2c_f32_bf16 v10, s3, v119
v_exp_f32 v80, v80
v_dot2c_f32_bf16 v10, s3, v121
v_dot2c_f32_bf16 v10, s3, v123
v_dot2c_f32_bf16 v11, v119, v119
v_dot2c_f32_bf16 v11, v121, v121
v_dot2_f32_bf16 v8, v116, s3, 0
v_dot2c_f32_bf16 v9, v118, v118
v_dot2c_f32_bf16 v10, s3, v125
v_dot2c_f32_bf16 v9, v120, v120
v_dot2c_f32_bf16 v10, s3, v127
v_exp_f32 v83, v83
v_dot2c_f32_bf16 v8, s3, v118
v_dot2c_f32_bf16 v8, s3, v120
v_dot2c_f32_bf16 v9, v122, v122
v_dot2c_f32_bf16 v9, v124, v124
v_dot2c_f32_bf16 v10, s3, v25
v_dot2c_f32_bf16 v9, v126, v126
v_dot2c_f32_bf16 v9, v24, v24
v_dot2c_f32_bf16 v8, s3, v122
v_dot2c_f32_bf16 v11, v123, v123
v_dot2c_f32_bf16 v11, v125, v125
v_cvt_pk_bf16_f32 v52, v80, v81
v_dot2c_f32_bf16 v11, v127, v127
v_dot2c_f32_bf16 v8, s3, v124
v_exp_f32 v87, v87
v_dot2c_f32_bf16 v11, v25, v25
v_dot2c_f32_bf16 v9, v26, v26
v_dot2c_f32_bf16 v8, s3, v126
v_cvt_pk_bf16_f32 v68, v96, v97
v_dot2c_f32_bf16 v11, v27, v27
v_dot2c_f32_bf16 v8, s3, v24
v_dot2c_f32_bf16 v8, s3, v26
v_dot2c_f32_bf16 v10, s3, v27
v_exp_f32 v85, v85
v_exp_f32 v86, v86
v_mfma_f32_16x16x32_bf16 v[104:107], a[68:71], a[52:55], v[104:107]
ds_read_b128 a[68:71], v5 offset:1024
v_add_f32 v8, v8, v10
v_add_f32 v9, v9, v11
v_mfma_f32_16x16x32_bf16 v[104:107], a[72:75], a[56:59], v[104:107]
ds_read_b128 a[72:75], v5 offset:2048
v_add_f32_dpp v9, v9, v9 quad_perm:[1,0,3,2] row_mask:0xf bank_mask:0xf
v_add_f32_dpp v8, v8, v8 quad_perm:[1,0,3,2] row_mask:0xf bank_mask:0xf
v_mfma_f32_16x16x32_bf16 v[104:107], a[76:79], a[60:63], v[104:107]
ds_read_b128 a[76:79], v5 offset:3072
v_exp_f32 v84, v84
v_cvt_pk_bf16_f32 v53, v82, v83
v_add_f32_dpp v8, v8, v8 quad_perm:[2,3,0,1] row_mask:0xf bank_mask:0xf
v_mfma_f32_16x16x32_bf16 v[108:111], a[80:83], a[48:51], v[44:47]
ds_read_b128 a[80:83], v5 offset:4096
v_lshlrev_b32 v14, 16, v118
v_add_f32_dpp v8, v8, v8 row_half_mirror row_mask:0xf bank_mask:0xf
v_add_f32_dpp v9, v9, v9 quad_perm:[2,3,0,1] row_mask:0xf bank_mask:0xf
v_mfma_f32_16x16x32_bf16 v[108:111], a[84:87], a[52:55], v[108:111]
ds_read_b128 a[84:87], v5 offset:5120
v_add_f32_dpp v9, v9, v9 row_half_mirror row_mask:0xf bank_mask:0xf
v_mfma_f32_16x16x32_bf16 v[108:111], a[88:91], a[56:59], v[108:111]
ds_read_b128 a[88:91], v5 offset:6144
v_cvt_pk_bf16_f32 v55, v86, v87
v_mfma_f32_16x16x32_bf16 v[108:111], a[92:95], a[60:63], v[108:111]
ds_read_b128 a[92:95], v5 offset:7168
v_add_f32_dpp v8, v8, v8 row_mirror row_mask:0xf bank_mask:0xf
v_mfma_f32_16x16x32_bf16 v[160:163], a[112:115], v[60:63], v[160:163]
v_exp_f32 v103, v103
v_mfma_f32_16x16x32_bf16 v[160:163], a[96:99], v[56:59], v[160:163]
v_add_f32_dpp v9, v9, v9 row_mirror row_mask:0xf bank_mask:0xf
v_exp_f32 v98, v98
v_lshlrev_b32 v16, 16, v119
v_cvt_pk_bf16_f32 v54, v84, v85
v_mov_b32 v11, v9
v_mfma_f32_16x16x32_bf16 v[164:167], a[116:119], v[60:63], v[164:167]
v_and_b32 v17, 0xffff0000, v119
v_mov_b32 v10, v8
v_mfma_f32_16x16x32_bf16 v[164:167], a[100:103], v[56:59], v[164:167]
v_cvt_pk_bf16_f32 v71, v102, v103
v_cvt_pk_bf16_f32 v69, v98, v99
v_permlane16_swap_b32 v11, v9
v_mfma_f32_16x16x32_bf16 v[168:171], a[120:123], v[60:63], v[168:171]
s_waitcnt lgkmcnt(4)
v_add_f32 v9, v9, v11
v_cvt_pk_bf16_f32 v70, v100, v101
v_mfma_f32_16x16x32_bf16 v[168:171], a[104:107], v[56:59], v[168:171]
v_permlane16_swap_b32 v10, v8
v_and_b32 v15, 0xffff0000, v118
v_mfma_f32_16x16x32_bf16 v[172:175], a[124:127], v[60:63], v[172:175]
v_add_f32 v8, v8, v10
v_and_b32 v11, 0xffff0000, v116
v_mul_f32 v8, 0x3a97b426, v8
v_mfma_f32_16x16x32_bf16 v[172:175], a[108:111], v[56:59], v[172:175]
v_mul_f32 v9, 0x3a97b426, v9
v_fma_f32 v9, -v8, v8, v9
v_max_f32 v9, 0, v9
v_lshlrev_b32 v10, 16, v116
v_mfma_f32_16x16x32_bf16 v[224:227], a[112:115], v[76:79], v[224:227]
ds_read_b128 a[112:115], v5 offset:12288
v_cvt_pk_bf16_f32 v9, v9, v9
v_cvt_pk_bf16_f32 v12, v8, v8
v_mfma_f32_16x16x32_bf16 v[224:227], a[96:99], v[72:75], v[224:227]
ds_read_b128 a[96:99], v5 offset:8192
v_and_b32 v9, 0xffff0000, v9
v_add_f32 v9, 0x3727c5ac, v9
v_cvt_pk_bf16_f32 v9, v9, v9
v_and_b32 v13, 0xffff0000, v117
v_and_b32 v9, 0xffff0000, v9
v_sqrt_f32 v9, v9
v_mfma_f32_16x16x32_bf16 v[228:231], a[116:119], v[76:79], v[228:231]
v_cvt_pk_bf16_f32 v9, v9, v9
v_and_b32 v9, 0xffff0000, v9
v_rcp_f32 v9, v9
v_and_b32 v12, 0xffff0000, v12
v_mul_f32 v8, -v12, v9
v_pk_fma_f32 v[10:11], v[8:9], v[10:11], v[8:9] op_sel:[1,0,0] op_sel_hi:[1,1,0]
v_pk_fma_f32 v[16:17], v[8:9], v[16:17], v[8:9] op_sel:[1,0,0] op_sel_hi:[1,1,0]
v_pk_fma_f32 v[14:15], v[8:9], v[14:15], v[8:9] op_sel:[1,0,0] op_sel_hi:[1,1,0]
v_lshlrev_b32 v12, 16, v117
v_pk_fma_f32 v[12:13], v[8:9], v[12:13], v[8:9] op_sel:[1,0,0] op_sel_hi:[1,1,0]
v_mfma_f32_16x16x32_bf16 v[228:231], a[100:103], v[72:75], v[228:231]
ds_read_b128 a[116:119], v5 offset:13312
ds_read_b128 a[100:103], v5 offset:9216
v_mfma_f32_16x16x32_bf16 v[232:235], a[120:123], v[76:79], v[232:235]
ds_read_b128 a[120:123], v5 offset:14336
v_cvt_pk_bf16_f32 v118, v14, v15
v_cvt_pk_bf16_f32 v119, v16, v17
v_and_b32 v17, 0xffff0000, v123
v_and_b32 v15, 0xffff0000, v122
v_mfma_f32_16x16x32_bf16 v[232:235], a[104:107], v[72:75], v[232:235]
v_cvt_pk_bf16_f32 v116, v10, v11
v_lshlrev_b32 v10, 16, v120
v_mfma_f32_16x16x32_bf16 v[236:239], a[124:127], v[76:79], v[236:239]
s_waitcnt lgkmcnt(5)
ds_read_b128 a[104:107], v5 offset:10240
ds_read_b128 a[124:127], v5 offset:15360
v_mfma_f32_16x16x32_bf16 v[236:239], a[108:111], v[72:75], v[236:239]
v_exp_f32 v94, v94
v_and_b32 v11, 0xffff0000, v120
v_mfma_f32_16x16x32_bf16 v[80:83], a[64:67], a[0:3], v[32:35]
v_lshlrev_b32 v14, 16, v122
v_cvt_pk_bf16_f32 v117, v12, v13
v_exp_f32 v90, v90
v_lshlrev_b32 v12, 16, v121
v_lshlrev_b32 v16, 16, v123
v_pk_fma_f32 v[14:15], v[8:9], v[14:15], v[8:9] op_sel:[1,0,0] op_sel_hi:[1,1,0]
v_pk_fma_f32 v[10:11], v[8:9], v[10:11], v[8:9] op_sel:[1,0,0] op_sel_hi:[1,1,0]
v_and_b32 v13, 0xffff0000, v121
v_pk_fma_f32 v[12:13], v[8:9], v[12:13], v[8:9] op_sel:[1,0,0] op_sel_hi:[1,1,0]
v_pk_fma_f32 v[16:17], v[8:9], v[16:17], v[8:9] op_sel:[1,0,0] op_sel_hi:[1,1,0]
v_cvt_pk_bf16_f32 v121, v12, v13
v_mfma_f32_16x16x32_bf16 v[80:83], a[68:71], a[4:7], v[80:83]
ds_read_b128 a[108:111], v5 offset:11264
v_cvt_pk_bf16_f32 v123, v16, v17
v_mfma_f32_16x16x32_bf16 v[80:83], a[72:75], a[8:11], v[80:83]
v_exp_f32 v95, v95
v_cvt_pk_bf16_f32 v122, v14, v15
v_mfma_f32_16x16x32_bf16 v[80:83], a[76:79], a[12:15], v[80:83]
s_waitcnt lgkmcnt(4)
v_exp_f32 v89, v89
v_mfma_f32_16x16x32_bf16 v[84:87], a[80:83], a[0:3], v[32:35]
v_cvt_pk_bf16_f32 v120, v10, v11
v_lshlrev_b32 v10, 16, v124
v_mfma_f32_16x16x32_bf16 v[84:87], a[84:87], a[4:7], v[84:87]
v_and_b32 v11, 0xffff0000, v124
v_and_b32 v13, 0xffff0000, v125
v_mfma_f32_16x16x32_bf16 v[84:87], a[88:91], a[8:11], v[84:87]
buffer_load_dwordx4 v6, s[8:11], s36 offen offset:0 sc1 lds
v_and_b32 v17, 0xffff0000, v127
v_lshlrev_b32 v14, 16, v126
v_lshlrev_b32 v16, 16, v127
v_pk_fma_f32 v[10:11], v[8:9], v[10:11], v[8:9] op_sel:[1,0,0] op_sel_hi:[1,1,0]
v_lshlrev_b32 v12, 16, v125
v_pk_fma_f32 v[12:13], v[8:9], v[12:13], v[8:9] op_sel:[1,0,0] op_sel_hi:[1,1,0]
v_pk_fma_f32 v[16:17], v[8:9], v[16:17], v[8:9] op_sel:[1,0,0] op_sel_hi:[1,1,0]
v_and_b32 v15, 0xffff0000, v126
v_pk_fma_f32 v[14:15], v[8:9], v[14:15], v[8:9] op_sel:[1,0,0] op_sel_hi:[1,1,0]
v_mfma_f32_16x16x32_bf16 v[84:87], a[92:95], a[12:15], v[84:87]
s_waitcnt lgkmcnt(0)
ds_write_b128 v1, v[116:119] offset:0
v_cvt_pk_bf16_f32 v124, v10, v11
v_mfma_f32_16x16x32_bf16 v[96:99], a[64:67], a[32:35], v[40:43]
v_cvt_pk_bf16_f32 v127, v16, v17
v_cvt_pk_bf16_f32 v126, v14, v15
v_mfma_f32_16x16x32_bf16 v[96:99], a[68:71], a[36:39], v[96:99]
v_cvt_pk_bf16_f32 v125, v12, v13
v_lshlrev_b32 v12, 16, v25
v_mfma_f32_16x16x32_bf16 v[96:99], a[72:75], a[40:43], v[96:99]
v_exp_f32 v92, v92
v_mfma_f32_16x16x32_bf16 v[96:99], a[76:79], a[44:47], v[96:99]
buffer_load_dwordx4 v7, s[8:11], s36 offen offset:1024 sc1 lds
v_mfma_f32_16x16x32_bf16 v[100:103], a[80:83], a[32:35], v[40:43]
v_exp_f32 v88, v88
v_mfma_f32_16x16x32_bf16 v[100:103], a[84:87], a[36:39], v[100:103]
v_and_b32 v15, 0xffff0000, v26
v_lshlrev_b32 v16, 16, v27
v_mfma_f32_16x16x32_bf16 v[100:103], a[88:91], a[40:43], v[100:103]
v_lshlrev_b32 v14, 16, v26
v_exp_f32 v111, v111
v_and_b32 v11, 0xffff0000, v24
v_mfma_f32_16x16x32_bf16 v[100:103], a[92:95], a[44:47], v[100:103]
v_exp_f32 v107, v107
v_smfmac_f32_16x16x64_bf16 a[240:243], v[112:115], v[48:55], v19
v_exp_f32 v110, v110
v_and_b32 v17, 0xffff0000, v27
v_mfma_f32_16x16x32_bf16 v[144:147], a[96:99], v[48:51], v[144:147]
v_exp_f32 v104, v104
v_mfma_f32_16x16x32_bf16 v[144:147], a[112:115], v[52:55], v[144:147]
v_lshlrev_b32 v10, 16, v24
v_exp_f32 v106, v106
v_cvt_pk_bf16_f32 v63, v94, v95
v_and_b32 v13, 0xffff0000, v25
v_pk_fma_f32 v[12:13], v[8:9], v[12:13], v[8:9] op_sel:[1,0,0] op_sel_hi:[1,1,0]
v_pk_fma_f32 v[14:15], v[8:9], v[14:15], v[8:9] op_sel:[1,0,0] op_sel_hi:[1,1,0]
v_pk_fma_f32 v[16:17], v[8:9], v[16:17], v[8:9] op_sel:[1,0,0] op_sel_hi:[1,1,0]
v_pk_fma_f32 v[10:11], v[8:9], v[10:11], v[8:9] op_sel:[1,0,0] op_sel_hi:[1,1,0]
v_mfma_f32_16x16x32_bf16 v[148:151], a[100:103], v[48:51], v[148:151]
v_exp_f32 v105, v105
v_mfma_f32_16x16x32_bf16 v[148:151], a[116:119], v[52:55], v[148:151]
v_exp_f32 v93, v93
v_mfma_f32_16x16x32_bf16 v[152:155], a[104:107], v[48:51], v[152:155]
buffer_load_dwordx4 v28, s[8:11], s36 offen offset:2048 sc1 lds
v_mfma_f32_16x16x32_bf16 v[152:155], a[120:123], v[52:55], v[152:155]
ds_write_b128 v1, v[120:123] offset:512
ds_write_b128 v1, v[124:127] offset:1024
v_mfma_f32_16x16x32_bf16 v[156:159], a[108:111], v[48:51], v[156:159]
v_cvt_pk_bf16_f32 v79, v110, v111
v_cvt_pk_bf16_f32 v60, v88, v89
v_mfma_f32_16x16x32_bf16 v[156:159], a[124:127], v[52:55], v[156:159]
buffer_load_dwordx4 v31, s[8:11], s36 offen offset:3072 sc1 lds
v_smfmac_f32_16x16x64_bf16 a[248:251], v[112:115], v[64:71], v19
s_sub_u32 s36, s36, s61
v_exp_f32 v109, v109
v_mfma_f32_16x16x32_bf16 v[208:211], a[96:99], v[64:67], v[208:211]
v_cvt_pk_bf16_f32 v26, v14, v15
v_cvt_pk_bf16_f32 v62, v92, v93
v_mfma_f32_16x16x32_bf16 v[208:211], a[112:115], v[68:71], v[208:211]
v_exp_f32 v91, v91
v_mfma_f32_16x16x32_bf16 v[212:215], a[100:103], v[64:67], v[212:215]
s_bitset1_b32 m0, 14
v_exp_f32 v108, v108
v_mfma_f32_16x16x32_bf16 v[212:215], a[116:119], v[68:71], v[212:215]
v_cvt_pk_bf16_f32 v27, v16, v17
v_cvt_pk_bf16_f32 v76, v104, v105
v_mfma_f32_16x16x32_bf16 v[216:219], a[104:107], v[64:67], v[216:219]
v_cvt_pk_bf16_f32 v61, v90, v91
v_cvt_pk_bf16_f32 v78, v108, v109
v_mfma_f32_16x16x32_bf16 v[216:219], a[120:123], v[68:71], v[216:219]
v_cvt_pk_bf16_f32 v24, v10, v11
v_cvt_pk_bf16_f32 v25, v12, v13
v_mfma_f32_16x16x32_bf16 v[220:223], a[108:111], v[64:67], v[220:223]
ds_write_b128 v1, v[24:27] offset:1536
v_cvt_pk_bf16_f32 v77, v106, v107
v_mfma_f32_16x16x32_bf16 v[220:223], a[124:127], v[68:71], v[220:223]
s_cbranch_scc1 kf_kernel_sw_loopAB1
s_branch kf_kernel_loopAB1
kf_kernel_hA3:
v_bfe_u32 v1, v0, 2, 2
v_mfma_f32_16x16x32_bf16 v[88:91], a[64:67], a[16:19], v[36:39]
s_waitcnt vmcnt(16) lgkmcnt(0)
s_barrier
v_mul_u32_u24 v1, 2112, v1
v_mfma_f32_16x16x32_bf16 v[88:91], a[68:71], a[20:23], v[88:91]
v_lshrrev_b32 v2, 4, v0
v_lshl_add_u32 v1, v2, 5, v1
v_and_b32 v3, 3, v0
v_mfma_f32_16x16x32_bf16 v[88:91], a[72:75], a[24:27], v[88:91]
v_exp_f32 v86, v86
v_mfma_f32_16x16x32_bf16 v[88:91], a[76:79], a[28:31], v[88:91]
buffer_load_dwordx4 v6, s[8:11], s36 offen offset:0 sc1 lds
v_mfma_f32_16x16x32_bf16 v[92:95], a[80:83], a[16:19], v[36:39]
s_lshr_b32 s3, s37, 2
v_exp_f32 v82, v82
v_exp_f32 v102, v102
v_mfma_f32_16x16x32_bf16 v[92:95], a[84:87], a[20:23], v[92:95]
v_exp_f32 v83, v83
v_mfma_f32_16x16x32_bf16 v[92:95], a[88:91], a[24:27], v[92:95]
v_exp_f32 v101, v101
v_mfma_f32_16x16x32_bf16 v[92:95], a[92:95], a[28:31], v[92:95]
v_lshl_add_u32 v1, v3, 3, v1
v_add_u32 v1, 0x20000, v1
v_and_b32 v2, 0xf0, v4
v_cvt_pk_bf16_f32 v53, v82, v83
v_mfma_f32_16x16x32_bf16 v[104:107], a[64:67], a[48:51], v[44:47]
s_and_b32 s29, s37, 3
v_exp_f32 v87, v87
v_mfma_f32_16x16x32_bf16 v[104:107], a[68:71], a[52:55], v[104:107]
ds_read_b128 a[64:67], v5 offset:0
ds_read_b128 a[68:71], v5 offset:1024
ds_read_b64_tr_b16 v[116:117], v1 offset:0
v_mfma_f32_16x16x32_bf16 v[104:107], a[72:75], a[56:59], v[104:107]
ds_read_b128 a[72:75], v5 offset:2048
ds_read_b64_tr_b16 v[118:119], v1 offset:8448
v_mfma_f32_16x16x32_bf16 v[104:107], a[76:79], a[60:63], v[104:107]
ds_read_b128 a[76:79], v5 offset:3072
ds_read_b64_tr_b16 v[120:121], v1 offset:512
v_mfma_f32_16x16x32_bf16 v[108:111], a[80:83], a[48:51], v[44:47]
ds_read_b128 a[80:83], v5 offset:4096
ds_read_b64_tr_b16 v[122:123], v1 offset:8960
v_mfma_f32_16x16x32_bf16 v[108:111], a[84:87], a[52:55], v[108:111]
ds_read_b128 a[84:87], v5 offset:5120
ds_read_b64_tr_b16 v[124:125], v1 offset:1024
v_mfma_f32_16x16x32_bf16 v[108:111], a[88:91], a[56:59], v[108:111]
buffer_load_dwordx4 v7, s[8:11], s36 offen offset:1024 sc1 lds
v_mfma_f32_16x16x32_bf16 v[108:111], a[92:95], a[60:63], v[108:111]
s_lshl_b32 s3, s3, 3
ds_read_b128 a[88:91], v5 offset:6144
ds_read_b128 a[92:95], v5 offset:7168
v_mfma_f32_16x16x32_bf16 v[160:163], a[112:115], v[60:63], v[160:163]
v_exp_f32 v99, v99
v_mfma_f32_16x16x32_bf16 v[160:163], a[96:99], v[56:59], v[160:163]
ds_read_b64_tr_b16 v[126:127], v1 offset:9472
ds_read_b64_tr_b16 v[24:25], v1 offset:1536
v_mfma_f32_16x16x32_bf16 v[164:167], a[116:119], v[60:63], v[164:167]
v_exp_f32 v80, v80
v_mfma_f32_16x16x32_bf16 v[164:167], a[100:103], v[56:59], v[164:167]
s_add_u32 s3, s3, s29
v_exp_f32 v96, v96
v_mfma_f32_16x16x32_bf16 v[168:171], a[120:123], v[60:63], v[168:171]
v_exp_f32 v103, v103
v_mfma_f32_16x16x32_bf16 v[168:171], a[104:107], v[56:59], v[168:171]
ds_read_b64_tr_b16 v[26:27], v1 offset:9984
v_bfe_u32 v3, v0, 4, 1
v_mfma_f32_16x16x32_bf16 v[172:175], a[124:127], v[60:63], v[172:175]
v_exp_f32 v100, v100
v_mfma_f32_16x16x32_bf16 v[172:175], a[108:111], v[56:59], v[172:175]
v_exp_f32 v97, v97
v_mfma_f32_16x16x32_bf16 v[224:227], a[112:115], v[76:79], v[224:227]
s_waitcnt lgkmcnt(7)
v_exp_f32 v84, v84
v_mfma_f32_16x16x32_bf16 v[224:227], a[96:99], v[72:75], v[224:227]
v_exp_f32 v81, v81
v_mfma_f32_16x16x32_bf16 v[228:231], a[116:119], v[76:79], v[228:231]
ds_read_b128 a[112:115], v5 offset:12288
ds_read_b128 a[96:99], v5 offset:8192
ds_read_b128 a[116:119], v5 offset:13312
v_mfma_f32_16x16x32_bf16 v[228:231], a[100:103], v[72:75], v[228:231]
ds_read_b128 a[100:103], v5 offset:9216
buffer_load_dwordx4 v28, s[8:11], s36 offen offset:2048 sc1 lds
v_mfma_f32_16x16x32_bf16 v[232:235], a[120:123], v[76:79], v[232:235]
v_lshl_add_u32 v2, v3, 10, v2
v_lshrrev_b32 v3, 5, v0
v_mfma_f32_16x16x32_bf16 v[232:235], a[104:107], v[72:75], v[232:235]
v_exp_f32 v85, v85
v_mfma_f32_16x16x32_bf16 v[236:239], a[124:127], v[76:79], v[236:239]
ds_read_b128 a[120:123], v5 offset:14336
ds_read_b128 a[104:107], v5 offset:10240
v_mfma_f32_16x16x32_bf16 v[236:239], a[108:111], v[72:75], v[236:239]
s_lshl_b32 s3, s3, 8
v_cvt_pk_bf16_f32 v70, v100, v101
v_cvt_pk_bf16_f32 v52, v80, v81
v_mfma_f32_16x16x32_bf16 v[80:83], a[64:67], a[0:3], v[32:35]
s_waitcnt lgkmcnt(6)
v_exp_f32 v98, v98
v_mfma_f32_16x16x32_bf16 v[80:83], a[68:71], a[4:7], v[80:83]
s_branch kf_kernel_pl31
kf_kernel_pd31:
s_branch kf_kernel_pd32
kf_kernel_pl31:
v_cvt_pk_bf16_f32 v54, v84, v85
v_lshl_add_u32 v2, v3, 17, v2
v_mfma_f32_16x16x32_bf16 v[80:83], a[72:75], a[8:11], v[80:83]
s_add_u32 s3, s3, 50331648
ds_read_b128 a[124:127], v5 offset:15360
v_cvt_pk_bf16_f32 v55, v86, v87
v_mfma_f32_16x16x32_bf16 v[80:83], a[76:79], a[12:15], v[80:83]
s_waitcnt lgkmcnt(10)
buffer_store_dwordx4 v[116:119], v2, s[40:43], s3 offen sc1
v_mfma_f32_16x16x32_bf16 v[84:87], a[80:83], a[0:3], v[32:35]
v_cvt_pk_bf16_f32 v69, v98, v99
v_cvt_pk_bf16_f32 v68, v96, v97
v_mfma_f32_16x16x32_bf16 v[84:87], a[84:87], a[4:7], v[84:87]
v_exp_f32 v104, v104
v_mfma_f32_16x16x32_bf16 v[84:87], a[88:91], a[8:11], v[84:87]
v_exp_f32 v108, v108
v_mfma_f32_16x16x32_bf16 v[84:87], a[92:95], a[12:15], v[84:87]
s_add_u32 s3, s3, 1048576
ds_read_b128 a[108:111], v5 offset:11264
s_sub_u32 s39, s39, 16777216
v_mfma_f32_16x16x32_bf16 v[96:99], a[64:67], a[32:35], v[40:43]
v_exp_f32 v94, v94
v_mfma_f32_16x16x32_bf16 v[96:99], a[68:71], a[36:39], v[96:99]
v_exp_f32 v89, v89
v_mfma_f32_16x16x32_bf16 v[96:99], a[72:75], a[40:43], v[96:99]
buffer_store_dwordx4 v[120:123], v2, s[40:43], s3 offen sc1
v_mfma_f32_16x16x32_bf16 v[96:99], a[76:79], a[44:47], v[96:99]
v_cvt_pk_bf16_f32 v71, v102, v103
v_mfma_f32_16x16x32_bf16 v[100:103], a[80:83], a[32:35], v[40:43]
s_waitcnt lgkmcnt(4)
v_exp_f32 v109, v109
v_mfma_f32_16x16x32_bf16 v[100:103], a[84:87], a[36:39], v[100:103]
v_exp_f32 v88, v88
v_mfma_f32_16x16x32_bf16 v[100:103], a[88:91], a[40:43], v[100:103]
v_exp_f32 v107, v107
v_mfma_f32_16x16x32_bf16 v[100:103], a[92:95], a[44:47], v[100:103]
buffer_load_dwordx4 v31, s[8:11], s36 offen offset:3072 sc1 lds
v_smfmac_f32_16x16x64_bf16 a[240:243], v[112:115], v[48:55], v19
v_exp_f32 v93, v93
v_mfma_f32_16x16x32_bf16 v[144:147], a[96:99], v[48:51], v[144:147]
v_exp_f32 v91, v91
v_mfma_f32_16x16x32_bf16 v[144:147], a[112:115], v[52:55], v[144:147]
s_add_u32 s27, s27, 1
v_exp_f32 v90, v90
v_mfma_f32_16x16x32_bf16 v[148:151], a[100:103], v[48:51], v[148:151]
v_exp_f32 v110, v110
v_mfma_f32_16x16x32_bf16 v[148:151], a[116:119], v[52:55], v[148:151]
s_waitcnt lgkmcnt(0)
s_add_u32 s3, s3, 1048576
v_mfma_f32_16x16x32_bf16 v[152:155], a[104:107], v[48:51], v[152:155]
buffer_store_dwordx4 v[124:127], v2, s[40:43], s3 offen sc1
v_mfma_f32_16x16x32_bf16 v[152:155], a[120:123], v[52:55], v[152:155]
v_exp_f32 v105, v105
v_mfma_f32_16x16x32_bf16 v[156:159], a[108:111], v[48:51], v[156:159]
v_exp_f32 v95, v95
v_mfma_f32_16x16x32_bf16 v[156:159], a[124:127], v[52:55], v[156:159]
s_add_u32 s3, s3, 1048576
v_exp_f32 v111, v111
v_smfmac_f32_16x16x64_bf16 a[248:251], v[112:115], v[64:71], v19
v_cvt_pk_bf16_f32 v76, v104, v105
v_cvt_pk_bf16_f32 v63, v94, v95
v_mfma_f32_16x16x32_bf16 v[208:211], a[96:99], v[64:67], v[208:211]
buffer_store_dwordx4 v[24:27], v2, s[40:43], s3 offen sc1
v_mfma_f32_16x16x32_bf16 v[208:211], a[112:115], v[68:71], v[208:211]
s_bitset1_b32 m0, 14
v_exp_f32 v106, v106
v_mfma_f32_16x16x32_bf16 v[212:215], a[100:103], v[64:67], v[212:215]
v_cvt_pk_bf16_f32 v79, v110, v111
v_mfma_f32_16x16x32_bf16 v[212:215], a[116:119], v[68:71], v[212:215]
v_cvt_pk_bf16_f32 v60, v88, v89
v_cvt_pk_bf16_f32 v77, v106, v107
v_mfma_f32_16x16x32_bf16 v[216:219], a[104:107], v[64:67], v[216:219]
v_exp_f32 v92, v92
v_mfma_f32_16x16x32_bf16 v[216:219], a[120:123], v[68:71], v[216:219]
v_cvt_pk_bf16_f32 v61, v90, v91
v_mfma_f32_16x16x32_bf16 v[220:223], a[108:111], v[64:67], v[220:223]
s_sub_u32 s36, s36, s61
v_cvt_pk_bf16_f32 v78, v108, v109
v_cvt_pk_bf16_f32 v62, v92, v93
v_mfma_f32_16x16x32_bf16 v[220:223], a[124:127], v[68:71], v[220:223]
s_cbranch_scc1 kf_kernel_sw_loopAB1
s_branch kf_kernel_loopAB1
kf_kernel_hA4:
v_mfma_f32_16x16x32_bf16 v[88:91], a[64:67], a[16:19], v[36:39]
s_waitcnt vmcnt(16) lgkmcnt(0)
s_barrier
v_mfma_f32_16x16x32_bf16 v[88:91], a[68:71], a[20:23], v[88:91]
buffer_load_dwordx4 v6, s[8:11], s36 offen offset:0 sc1 lds
v_mfma_f32_16x16x32_bf16 v[88:91], a[72:75], a[24:27], v[88:91]
s_mov_b32 s58, m0
v_bfe_u32 v1, v0, 4, 2
v_lshlrev_b32 v2, 1, v1
v_mfma_f32_16x16x32_bf16 v[88:91], a[76:79], a[28:31], v[88:91]
buffer_load_dwordx4 v7, s[8:11], s36 offen offset:1024 sc1 lds
v_mfma_f32_16x16x32_bf16 v[92:95], a[80:83], a[16:19], v[36:39]
s_lshr_b32 s3, s2, 2
v_exp_f32 v81, v81
v_and_b32 v3, 15, v0
v_xor_b32 v2, v2, v3
v_mfma_f32_16x16x32_bf16 v[92:95], a[84:87], a[20:23], v[92:95]
v_cmp_eq_u32 vcc, 0, v4
v_exp_f32 v83, v83
v_mfma_f32_16x16x32_bf16 v[92:95], a[88:91], a[24:27], v[92:95]
s_lshl_b32 s3, s3, 8
v_exp_f32 v80, v80
v_mfma_f32_16x16x32_bf16 v[92:95], a[92:95], a[28:31], v[92:95]
v_exp_f32 v82, v82
v_mul_u32_u24 v1, 1280, v1
v_mfma_f32_16x16x32_bf16 v[104:107], a[64:67], a[48:51], v[44:47]
v_lshl_add_u32 v8, v2, 4, v1
v_xor_b32 v2, 8, v2
v_mfma_f32_16x16x32_bf16 v[104:107], a[68:71], a[52:55], v[104:107]
ds_read_b128 a[64:67], v5 offset:0
ds_read_b128 a[68:71], v5 offset:1024
v_mfma_f32_16x16x32_bf16 v[104:107], a[72:75], a[56:59], v[104:107]
ds_read_b128 a[72:75], v5 offset:2048
v_lshl_add_u32 v9, v2, 4, v1
v_mfma_f32_16x16x32_bf16 v[104:107], a[76:79], a[60:63], v[104:107]
ds_read_b128 a[76:79], v5 offset:3072
buffer_load_dwordx4 v28, s[8:11], s36 offen offset:2048 sc1 lds
v_mfma_f32_16x16x32_bf16 v[108:111], a[80:83], a[48:51], v[44:47]
s_add_u32 s29, s14, 0
ds_read_b128 a[80:83], v5 offset:4096
v_mov_b32 v1, 1
v_mfma_f32_16x16x32_bf16 v[108:111], a[84:87], a[52:55], v[108:111]
buffer_load_dwordx4 v31, s[8:11], s36 offen offset:3072 sc1 lds
v_add_u32 v10, 8192, v8
v_mfma_f32_16x16x32_bf16 v[108:111], a[88:91], a[56:59], v[108:111]
s_add_u32 s3, s3, 3178496
ds_read_b128 a[84:87], v5 offset:5120
v_mov_b32 v2, 1073741824
v_mfma_f32_16x16x32_bf16 v[108:111], a[92:95], a[60:63], v[108:111]
s_add_u32 m0, s25, 131072
ds_read_b128 a[88:91], v5 offset:6144
ds_read_b128 a[92:95], v5 offset:7168
v_cndmask_b32 v2, v2, 0, vcc
v_mfma_f32_16x16x32_bf16 v[160:163], a[112:115], v[60:63], v[160:163]
v_add_u32 v9, 4096, v9
v_exp_f32 v86, v86
v_exp_f32 v99, v99
v_mfma_f32_16x16x32_bf16 v[160:163], a[96:99], v[56:59], v[160:163]
s_waitcnt vmcnt(8)
buffer_atomic_add v1, v2, s[40:43], s3 offen sc1
v_mfma_f32_16x16x32_bf16 v[164:167], a[116:119], v[60:63], v[164:167]
v_exp_f32 v96, v96
v_mfma_f32_16x16x32_bf16 v[164:167], a[100:103], v[56:59], v[164:167]
v_exp_f32 v85, v85
v_mfma_f32_16x16x32_bf16 v[168:171], a[120:123], v[60:63], v[168:171]
v_exp_f32 v87, v87
v_mfma_f32_16x16x32_bf16 v[168:171], a[104:107], v[56:59], v[168:171]
buffer_load_dwordx4 v8, s[16:19], s29 offen offset:0 lds
v_mfma_f32_16x16x32_bf16 v[172:175], a[124:127], v[60:63], v[172:175]
v_exp_f32 v89, v89
v_mfma_f32_16x16x32_bf16 v[172:175], a[108:111], v[56:59], v[172:175]
v_exp_f32 v84, v84
v_mfma_f32_16x16x32_bf16 v[224:227], a[112:115], v[76:79], v[224:227]
ds_read_b128 a[112:115], v5 offset:12288
v_add_u32 v11, 8192, v9
v_mfma_f32_16x16x32_bf16 v[224:227], a[96:99], v[72:75], v[224:227]
s_waitcnt lgkmcnt(5)
ds_read_b128 a[96:99], v5 offset:8192
v_cvt_pk_bf16_f32 v55, v86, v87
v_mfma_f32_16x16x32_bf16 v[228:231], a[116:119], v[76:79], v[228:231]
ds_read_b128 a[116:119], v5 offset:13312
buffer_load_dwordx4 v9, s[16:19], s29 offen offset:1024 lds
v_mfma_f32_16x16x32_bf16 v[228:231], a[100:103], v[72:75], v[228:231]
s_waitcnt lgkmcnt(3)
v_exp_f32 v98, v98
v_mfma_f32_16x16x32_bf16 v[232:235], a[120:123], v[76:79], v[232:235]
buffer_load_dwordx4 v10, s[16:19], s29 offen offset:2048 lds
v_mfma_f32_16x16x32_bf16 v[232:235], a[104:107], v[72:75], v[232:235]
v_exp_f32 v103, v103
v_mfma_f32_16x16x32_bf16 v[236:239], a[124:127], v[76:79], v[236:239]
v_exp_f32 v97, v97
v_mfma_f32_16x16x32_bf16 v[236:239], a[108:111], v[72:75], v[236:239]
v_cvt_pk_bf16_f32 v53, v82, v83
v_cvt_pk_bf16_f32 v52, v80, v81
v_mfma_f32_16x16x32_bf16 v[80:83], a[64:67], a[0:3], v[32:35]
buffer_load_dwordx4 v11, s[16:19], s29 offen offset:3072 lds
v_mfma_f32_16x16x32_bf16 v[80:83], a[68:71], a[4:7], v[80:83]
s_add_u32 s29, s14, 20480
v_exp_f32 v93, v93
v_mfma_f32_16x16x32_bf16 v[80:83], a[72:75], a[8:11], v[80:83]
v_cvt_pk_bf16_f32 v69, v98, v99
v_cvt_pk_bf16_f32 v54, v84, v85
v_mfma_f32_16x16x32_bf16 v[80:83], a[76:79], a[12:15], v[80:83]
v_exp_f32 v101, v101
v_mfma_f32_16x16x32_bf16 v[84:87], a[80:83], a[0:3], v[32:35]
v_exp_f32 v102, v102
v_mfma_f32_16x16x32_bf16 v[84:87], a[84:87], a[4:7], v[84:87]
s_add_u32 m0, s25, 135168
ds_read_b128 a[100:103], v5 offset:9216
v_cvt_pk_bf16_f32 v68, v96, v97
v_mfma_f32_16x16x32_bf16 v[84:87], a[88:91], a[8:11], v[84:87]
buffer_load_dwordx4 v8, s[16:19], s29 offen offset:0 lds
v_mfma_f32_16x16x32_bf16 v[84:87], a[92:95], a[12:15], v[84:87]
v_exp_f32 v100, v100
v_mfma_f32_16x16x32_bf16 v[96:99], a[64:67], a[32:35], v[40:43]
buffer_load_dwordx4 v9, s[16:19], s29 offen offset:1024 lds
v_mfma_f32_16x16x32_bf16 v[96:99], a[68:71], a[36:39], v[96:99]
ds_read_b128 a[120:123], v5 offset:14336
ds_read_b128 a[104:107], v5 offset:10240
v_mfma_f32_16x16x32_bf16 v[96:99], a[72:75], a[40:43], v[96:99]
buffer_load_dwordx4 v10, s[16:19], s29 offen offset:2048 lds
v_mfma_f32_16x16x32_bf16 v[96:99], a[76:79], a[44:47], v[96:99]
v_cvt_pk_bf16_f32 v70, v100, v101
v_cvt_pk_bf16_f32 v71, v102, v103
v_mfma_f32_16x16x32_bf16 v[100:103], a[80:83], a[32:35], v[40:43]
ds_read_b128 a[124:127], v5 offset:15360
ds_read_b128 a[108:111], v5 offset:11264
v_mfma_f32_16x16x32_bf16 v[100:103], a[84:87], a[36:39], v[100:103]
s_waitcnt lgkmcnt(4)
v_exp_f32 v95, v95
v_mfma_f32_16x16x32_bf16 v[100:103], a[88:91], a[40:43], v[100:103]
buffer_load_dwordx4 v11, s[16:19], s29 offen offset:3072 lds
v_mfma_f32_16x16x32_bf16 v[100:103], a[92:95], a[44:47], v[100:103]
v_exp_f32 v92, v92
v_smfmac_f32_16x16x64_bf16 a[240:243], v[112:115], v[48:55], v19
v_exp_f32 v91, v91
v_mfma_f32_16x16x32_bf16 v[144:147], a[96:99], v[48:51], v[144:147]
v_exp_f32 v107, v107
v_mfma_f32_16x16x32_bf16 v[144:147], a[112:115], v[52:55], v[144:147]
v_exp_f32 v90, v90
v_mfma_f32_16x16x32_bf16 v[148:151], a[100:103], v[48:51], v[148:151]
v_exp_f32 v106, v106
v_mfma_f32_16x16x32_bf16 v[148:151], a[116:119], v[52:55], v[148:151]
s_waitcnt lgkmcnt(0)
v_exp_f32 v110, v110
v_mfma_f32_16x16x32_bf16 v[152:155], a[104:107], v[48:51], v[152:155]
v_exp_f32 v88, v88
v_mfma_f32_16x16x32_bf16 v[152:155], a[120:123], v[52:55], v[152:155]
s_mov_b32 m0, s58
v_exp_f32 v105, v105
v_mfma_f32_16x16x32_bf16 v[156:159], a[108:111], v[48:51], v[156:159]
v_exp_f32 v104, v104
v_mfma_f32_16x16x32_bf16 v[156:159], a[124:127], v[52:55], v[156:159]
s_bitset1_b32 m0, 14
v_cvt_pk_bf16_f32 v60, v88, v89
v_cvt_pk_bf16_f32 v62, v92, v93
v_smfmac_f32_16x16x64_bf16 a[248:251], v[112:115], v[64:71], v19
v_exp_f32 v111, v111
v_mfma_f32_16x16x32_bf16 v[208:211], a[96:99], v[64:67], v[208:211]
v_cvt_pk_bf16_f32 v77, v106, v107
v_cvt_pk_bf16_f32 v76, v104, v105
v_mfma_f32_16x16x32_bf16 v[208:211], a[112:115], v[68:71], v[208:211]
s_add_u32 s27, s27, 1
s_sub_u32 s39, s39, 16777216
v_cvt_pk_bf16_f32 v61, v90, v91
v_mfma_f32_16x16x32_bf16 v[212:215], a[100:103], v[64:67], v[212:215]
v_exp_f32 v109, v109
v_mfma_f32_16x16x32_bf16 v[212:215], a[116:119], v[68:71], v[212:215]
s_sub_u32 s36, s36, s61
v_exp_f32 v94, v94
v_mfma_f32_16x16x32_bf16 v[216:219], a[104:107], v[64:67], v[216:219]
v_exp_f32 v108, v108
v_mfma_f32_16x16x32_bf16 v[216:219], a[120:123], v[68:71], v[216:219]
v_cvt_pk_bf16_f32 v78, v108, v109
v_cvt_pk_bf16_f32 v79, v110, v111
v_mfma_f32_16x16x32_bf16 v[220:223], a[108:111], v[64:67], v[220:223]
v_cvt_pk_bf16_f32 v63, v94, v95
v_mfma_f32_16x16x32_bf16 v[220:223], a[124:127], v[68:71], v[220:223]
s_cbranch_scc1 kf_kernel_sw_loopAB1
s_branch kf_kernel_loopAB1
kf_kernel_pd32:
s_branch kf_kernel_r3
kf_kernel_hAw:
s_cmp_eq_u32 s27, 6
s_cbranch_scc1 kf_kernel_hA6
s_cmp_eq_u32 s27, 7
s_cbranch_scc1 kf_kernel_hA7
s_cmp_eq_u32 s27, 8
s_cbranch_scc1 kf_kernel_hA8
s_cmp_eq_u32 s27, 9
s_cbranch_scc1 kf_kernel_hA9
s_cmp_eq_u32 s27, 10
s_cbranch_scc1 kf_kernel_hA10
kf_kernel_hA5:
v_mfma_f32_16x16x32_bf16 v[88:91], a[64:67], a[16:19], v[36:39]
s_waitcnt vmcnt(16) lgkmcnt(0)
v_exp_f32 v81, v81
s_barrier
v_mfma_f32_16x16x32_bf16 v[88:91], a[68:71], a[20:23], v[88:91]
v_and_b32 v1, 63, v0
v_lshrrev_b32 v3, 4, v1
v_mfma_f32_16x16x32_bf16 v[88:91], a[72:75], a[24:27], v[88:91]
s_lshl_b32 s26, s22, 2
v_exp_f32 v84, v84
v_mfma_f32_16x16x32_bf16 v[88:91], a[76:79], a[28:31], v[88:91]
s_and_b32 s60, s23, 1
v_lshrrev_b32 v2, 3, v1
v_mul_u32_u24 v2, 4096, v2
v_and_b32 v1, 7, v1
v_mfma_f32_16x16x32_bf16 v[92:95], a[80:83], a[16:19], v[36:39]
s_mul_i32 s3, s60, 67584
v_xor_b32 v1, v1, v3
v_lshl_add_u32 v2, v1, 4, v2
v_xor_b32 v22, 64, v2
v_mfma_f32_16x16x32_bf16 v[92:95], a[84:87], a[20:23], v[92:95]
s_sub_u32 s26, 50, s26
v_exp_f32 v85, v85
v_mfma_f32_16x16x32_bf16 v[92:95], a[88:91], a[24:27], v[92:95]
v_and_b32 v1, 15, v0
v_mov_b32 v21, v2
v_add_u32 v21, s3, v21
v_mfma_f32_16x16x32_bf16 v[92:95], a[92:95], a[28:31], v[92:95]
v_mov_b32 v23, v2
v_exp_f32 v82, v82
v_exp_f32 v101, v101
v_mfma_f32_16x16x32_bf16 v[104:107], a[64:67], a[48:51], v[44:47]
v_exp_f32 v96, v96
v_add_u32 v22, 31744, v22
v_add_u32 v22, s3, v22
v_mfma_f32_16x16x32_bf16 v[104:107], a[68:71], a[52:55], v[104:107]
s_load_dwordx2 s[16:17], s[0:1], 0
ds_read_b128 a[64:67], v5 offset:0
ds_read_b128 a[68:71], v5 offset:1024
v_mfma_f32_16x16x32_bf16 v[104:107], a[72:75], a[56:59], v[104:107]
v_xor_b32 v24, 64, v2
v_exp_f32 v80, v80
v_mfma_f32_16x16x32_bf16 v[104:107], a[76:79], a[60:63], v[104:107]
s_min_u32 s26, s26, 36
ds_read_b128 a[72:75], v5 offset:2048
ds_read_b128 a[76:79], v5 offset:3072
v_mfma_f32_16x16x32_bf16 v[108:111], a[80:83], a[48:51], v[44:47]
s_mul_i32 s3, s60, 63488
v_exp_f32 v83, v83
v_add_u32 v24, 95232, v24
v_subrev_u32 v24, s3, v24
v_mfma_f32_16x16x32_bf16 v[108:111], a[84:87], a[52:55], v[108:111]
s_lshl_b32 s26, s26, 14
ds_read_b128 a[80:83], v5 offset:4096
ds_read_b128 a[84:87], v5 offset:5120
v_mfma_f32_16x16x32_bf16 v[108:111], a[88:91], a[56:59], v[108:111]
v_lshrrev_b32 v3, 1, v1
v_exp_f32 v100, v100
v_bfe_u32 v2, v0, 4, 2
v_add_u32 v23, 63488, v23
v_mfma_f32_16x16x32_bf16 v[108:111], a[92:95], a[60:63], v[108:111]
ds_read_b128 a[88:91], v5 offset:6144
v_exp_f32 v86, v86
v_mfma_f32_16x16x32_bf16 v[160:163], a[112:115], v[60:63], v[160:163]
v_xor_b32 v2, v2, v3
v_subrev_u32 v23, s3, v23
v_mfma_f32_16x16x32_bf16 v[160:163], a[96:99], v[56:59], v[160:163]
s_and_b32 s3, s22, 1
v_cvt_pk_bf16_f32 v53, v82, v83
v_cvt_pk_bf16_f32 v70, v100, v101
v_mfma_f32_16x16x32_bf16 v[164:167], a[116:119], v[60:63], v[164:167]
s_lshl_b32 s3, s3, 16
v_lshlrev_b32 v2, 4, v2
v_exp_f32 v87, v87
v_lshl_add_u32 v2, v1, 7, v2
v_mfma_f32_16x16x32_bf16 v[164:167], a[100:103], v[56:59], v[164:167]
s_add_u32 s27, s27, 1
v_exp_f32 v97, v97
v_mfma_f32_16x16x32_bf16 v[168:171], a[120:123], v[60:63], v[168:171]
s_add_u32 s26, s26, s28
v_add_u32 v8, s3, v2
v_xor_b32 v9, 64, v8
v_mfma_f32_16x16x32_bf16 v[168:171], a[104:107], v[56:59], v[168:171]
v_exp_f32 v98, v98
v_mfma_f32_16x16x32_bf16 v[172:175], a[124:127], v[60:63], v[172:175]
s_sub_u32 s3, 0x20000, s3
v_add_u32 v12, s3, v8
v_cvt_pk_bf16_f32 v52, v80, v81
v_mfma_f32_16x16x32_bf16 v[172:175], a[108:111], v[56:59], v[172:175]
s_waitcnt lgkmcnt(3)
ds_read_b128 a[92:95], v5 offset:7168
v_add_u32 v13, s3, v9
v_mfma_f32_16x16x32_bf16 v[224:227], a[112:115], v[76:79], v[224:227]
s_sub_u32 s59, s26, s39
v_exp_f32 v103, v103
v_mfma_f32_16x16x32_bf16 v[224:227], a[96:99], v[72:75], v[224:227]
s_max_i32 s59, s59, 0x8000
ds_read_b128 a[112:115], v5 offset:12288
ds_read_b128 a[96:99], v5 offset:8192
v_mfma_f32_16x16x32_bf16 v[228:231], a[116:119], v[76:79], v[228:231]
s_lshl_b32 s59, s59, 9
v_exp_f32 v99, v99
v_mfma_f32_16x16x32_bf16 v[228:231], a[100:103], v[72:75], v[228:231]
s_min_u32 s3, s38, 120
ds_read_b128 a[116:119], v5 offset:13312
ds_read_b128 a[100:103], v5 offset:9216
v_cvt_pk_bf16_f32 v69, v98, v99
v_mfma_f32_16x16x32_bf16 v[232:235], a[120:123], v[76:79], v[232:235]
s_lshl2_add_u32 s34, s2, s20
v_exp_f32 v102, v102
v_mfma_f32_16x16x32_bf16 v[232:235], a[104:107], v[72:75], v[232:235]
s_waitcnt lgkmcnt(4)
ds_read_b128 a[120:123], v5 offset:14336
ds_read_b128 a[104:107], v5 offset:10240
v_mfma_f32_16x16x32_bf16 v[236:239], a[124:127], v[76:79], v[236:239]
buffer_load_dwordx4 v6, s[8:11], s36 offen offset:0 sc1 lds
v_mfma_f32_16x16x32_bf16 v[236:239], a[108:111], v[72:75], v[236:239]
buffer_load_dwordx4 v7, s[8:11], s36 offen offset:1024 sc1 lds
v_mfma_f32_16x16x32_bf16 v[80:83], a[64:67], a[0:3], v[32:35]
v_cvt_pk_bf16_f32 v55, v86, v87
v_cvt_pk_bf16_f32 v54, v84, v85
v_mfma_f32_16x16x32_bf16 v[80:83], a[68:71], a[4:7], v[80:83]
s_sub_u32 s39, s39, s59
ds_read_b128 a[124:127], v5 offset:15360
ds_read_b128 a[108:111], v5 offset:11264
v_mfma_f32_16x16x32_bf16 v[80:83], a[72:75], a[8:11], v[80:83]
s_sub_u32 s59, s38, s3
v_exp_f32 v89, v89
v_mfma_f32_16x16x32_bf16 v[80:83], a[76:79], a[12:15], v[80:83]
s_mul_i32 s34, s34, 13312
v_exp_f32 v88, v88
v_mfma_f32_16x16x32_bf16 v[84:87], a[80:83], a[0:3], v[32:35]
s_add_u32 s3, s38, s60
v_exp_f32 v91, v91
v_mfma_f32_16x16x32_bf16 v[84:87], a[84:87], a[4:7], v[84:87]
s_lshl_b32 s3, s3, 5
v_exp_f32 v93, v93
v_mfma_f32_16x16x32_bf16 v[84:87], a[88:91], a[8:11], v[84:87]
s_add_u32 s34, s34, 83890176
v_cvt_pk_bf16_f32 v71, v102, v103
v_cvt_pk_bf16_f32 v68, v96, v97
v_mfma_f32_16x16x32_bf16 v[84:87], a[92:95], a[12:15], v[84:87]
s_waitcnt lgkmcnt(4)
buffer_store_dwordx4 a[160:163], v4, s[40:43], s34 offen offset:0 sc1
v_mfma_f32_16x16x32_bf16 v[96:99], a[64:67], a[32:35], v[40:43]
buffer_load_dwordx4 v28, s[8:11], s36 offen offset:2048 sc1 lds
v_mfma_f32_16x16x32_bf16 v[96:99], a[68:71], a[36:39], v[96:99]
v_xor_b32 v10, 0x10000, v8
v_xor_b32 v11, 0x10000, v9
v_mfma_f32_16x16x32_bf16 v[96:99], a[72:75], a[40:43], v[96:99]
buffer_store_dwordx4 a[160:163], v4, s[40:43], s34 offen offset:1024 sc1
v_mfma_f32_16x16x32_bf16 v[96:99], a[76:79], a[44:47], v[96:99]
v_exp_f32 v90, v90
v_mfma_f32_16x16x32_bf16 v[100:103], a[80:83], a[32:35], v[40:43]
v_exp_f32 v92, v92
v_mfma_f32_16x16x32_bf16 v[100:103], a[84:87], a[36:39], v[100:103]
buffer_store_dwordx4 a[160:163], v4, s[40:43], s34 offen offset:2048 sc1
v_mfma_f32_16x16x32_bf16 v[100:103], a[88:91], a[40:43], v[100:103]
v_and_b32 v1, 15, v0
v_lshl_add_u32 v1, v1, 1, s3
v_mfma_f32_16x16x32_bf16 v[100:103], a[92:95], a[44:47], v[100:103]
buffer_load_dwordx4 v31, s[8:11], s36 offen offset:3072 sc1 lds
v_smfmac_f32_16x16x64_bf16 a[240:243], v[112:115], v[48:55], v19
buffer_store_dwordx4 a[160:163], v4, s[40:43], s34 offen offset:3072 sc1
v_mfma_f32_16x16x32_bf16 v[144:147], a[96:99], v[48:51], v[144:147]
v_exp_f32 v105, v105
v_mfma_f32_16x16x32_bf16 v[144:147], a[112:115], v[52:55], v[144:147]
s_waitcnt lgkmcnt(0)
v_exp_f32 v109, v109
v_mfma_f32_16x16x32_bf16 v[148:151], a[100:103], v[48:51], v[148:151]
v_exp_f32 v104, v104
v_mfma_f32_16x16x32_bf16 v[148:151], a[116:119], v[52:55], v[148:151]
v_exp_f32 v108, v108
v_mfma_f32_16x16x32_bf16 v[152:155], a[104:107], v[48:51], v[152:155]
v_exp_f32 v94, v94
v_mfma_f32_16x16x32_bf16 v[152:155], a[120:123], v[52:55], v[152:155]
v_exp_f32 v107, v107
v_mfma_f32_16x16x32_bf16 v[156:159], a[108:111], v[48:51], v[156:159]
s_lshl_b32 s59, s59, 5
v_exp_f32 v111, v111
v_mfma_f32_16x16x32_bf16 v[156:159], a[124:127], v[52:55], v[156:159]
v_exp_f32 v110, v110
v_smfmac_f32_16x16x64_bf16 a[248:251], v[112:115], v[64:71], v19
global_load_ushort v116, v1, s[4:5] offset:0
global_load_ushort v117, v1, s[4:5] offset:64
global_load_ushort v118, v1, s[4:5] offset:128
v_cvt_pk_bf16_f32 v78, v108, v109
v_mfma_f32_16x16x32_bf16 v[208:211], a[96:99], v[64:67], v[208:211]
s_sub_u32 s36, s36, s61
v_cvt_pk_bf16_f32 v79, v110, v111
v_subrev_u32 v2, s59, v1
v_mfma_f32_16x16x32_bf16 v[208:211], a[112:115], v[68:71], v[208:211]
v_cvt_pk_bf16_f32 v62, v92, v93
v_cvt_pk_bf16_f32 v60, v88, v89
v_mfma_f32_16x16x32_bf16 v[212:215], a[100:103], v[64:67], v[212:215]
v_exp_f32 v95, v95
v_mfma_f32_16x16x32_bf16 v[212:215], a[116:119], v[68:71], v[212:215]
v_exp_f32 v106, v106
v_mfma_f32_16x16x32_bf16 v[216:219], a[104:107], v[64:67], v[216:219]
global_load_ushort v119, v2, s[4:5] offset:192
v_mfma_f32_16x16x32_bf16 v[216:219], a[120:123], v[68:71], v[216:219]
s_bitset1_b32 m0, 14
v_cvt_pk_bf16_f32 v63, v94, v95
v_cvt_pk_bf16_f32 v77, v106, v107
v_mfma_f32_16x16x32_bf16 v[220:223], a[108:111], v[64:67], v[220:223]
v_cvt_pk_bf16_f32 v61, v90, v91
v_cvt_pk_bf16_f32 v76, v104, v105
v_mfma_f32_16x16x32_bf16 v[220:223], a[124:127], v[68:71], v[220:223]
s_cbranch_scc1 kf_kernel_sw_loopAB1
s_branch kf_kernel_loopAB1
kf_kernel_hA6:
v_bfe_u32 v1, v0, 2, 4
v_mfma_f32_16x16x32_bf16 v[88:91], a[64:67], a[16:19], v[36:39]
s_waitcnt vmcnt(16) lgkmcnt(0)
s_barrier
v_exp_f32 v81, v81
v_mfma_f32_16x16x32_bf16 v[88:91], a[68:71], a[20:23], v[88:91]
buffer_load_dwordx4 v6, s[8:11], s36 offen offset:0 sc1 lds
v_lshlrev_b32 v2, 8, v1
v_mfma_f32_16x16x32_bf16 v[88:91], a[72:75], a[24:27], v[88:91]
v_exp_f32 v100, v100
v_mfma_f32_16x16x32_bf16 v[88:91], a[76:79], a[28:31], v[88:91]
s_add_u32 s29, s25, 0x20000
v_and_b32 v1, 7, v1
v_lshl_add_u32 v2, v1, 5, v2
v_and_b32 v1, 3, v0
v_lshl_add_u32 v2, v1, 3, v2
v_mfma_f32_16x16x32_bf16 v[92:95], a[80:83], a[16:19], v[36:39]
v_exp_f32 v101, v101
v_mfma_f32_16x16x32_bf16 v[92:95], a[84:87], a[20:23], v[92:95]
s_lshl2_add_u32 s34, s2, s20
v_exp_f32 v80, v80
v_mfma_f32_16x16x32_bf16 v[92:95], a[88:91], a[24:27], v[92:95]
s_mul_i32 s34, s34, 13312
v_add_u32 v120, s29, v2
v_xor_b32 v122, 64, v120
v_mfma_f32_16x16x32_bf16 v[92:95], a[92:95], a[28:31], v[92:95]
s_waitcnt vmcnt(16)
ds_read_b64_tr_b16 a[128:129], v120 offset:0
v_cvt_pk_bf16_f32 v52, v80, v81
v_mfma_f32_16x16x32_bf16 v[104:107], a[64:67], a[48:51], v[44:47]
ds_read_b128 a[64:67], v5 offset:0
v_xor_b32 v123, 96, v120
v_mfma_f32_16x16x32_bf16 v[104:107], a[68:71], a[52:55], v[104:107]
ds_read_b128 a[68:71], v5 offset:1024
buffer_load_dwordx4 v7, s[8:11], s36 offen offset:1024 sc1 lds
v_mfma_f32_16x16x32_bf16 v[104:107], a[72:75], a[56:59], v[104:107]
v_exp_f32 v84, v84
v_mfma_f32_16x16x32_bf16 v[104:107], a[76:79], a[60:63], v[104:107]
s_add_u32 s34, s34, 83894272
v_xor_b32 v121, 32, v120
v_xor_b32 v124, 128, v120
v_exp_f32 v85, v85
v_mfma_f32_16x16x32_bf16 v[108:111], a[80:83], a[48:51], v[44:47]
buffer_store_dwordx4 a[160:163], v4, s[40:43], s34 offen offset:0 sc1
ds_read_b128 a[72:75], v5 offset:2048
ds_read_b128 a[76:79], v5 offset:3072
ds_read_b64_tr_b16 a[130:131], v120 offset:4096
ds_read_b128 a[80:83], v5 offset:4096
v_xor_b32 v125, 160, v120
v_mfma_f32_16x16x32_bf16 v[108:111], a[84:87], a[52:55], v[108:111]
ds_read_b128 a[84:87], v5 offset:5120
v_exp_f32 v83, v83
v_mfma_f32_16x16x32_bf16 v[108:111], a[88:91], a[56:59], v[108:111]
ds_read_b128 a[88:91], v5 offset:6144
ds_read_b64_tr_b16 a[132:133], v121 offset:0
v_mfma_f32_16x16x32_bf16 v[108:111], a[92:95], a[60:63], v[108:111]
ds_read_b128 a[92:95], v5 offset:7168
ds_read_b64_tr_b16 a[134:135], v121 offset:4096
ds_read_b64_tr_b16 a[136:137], v122 offset:0
ds_read_b64_tr_b16 a[138:139], v122 offset:4096
ds_read_b64_tr_b16 a[140:141], v123 offset:0
ds_read_b64_tr_b16 a[142:143], v123 offset:4096
ds_read_b64_tr_b16 a[144:145], v124 offset:0
ds_read_b64_tr_b16 a[146:147], v124 offset:4096
ds_read_b64_tr_b16 a[148:149], v125 offset:0
v_mfma_f32_16x16x32_bf16 v[160:163], a[112:115], v[60:63], v[160:163]
v_exp_f32 v86, v86
v_mfma_f32_16x16x32_bf16 v[160:163], a[96:99], v[56:59], v[160:163]
buffer_store_dwordx4 a[160:163], v4, s[40:43], s34 offen offset:1024 sc1
v_mfma_f32_16x16x32_bf16 v[164:167], a[116:119], v[60:63], v[164:167]
ds_read_b64_tr_b16 a[150:151], v125 offset:4096
v_exp_f32 v96, v96
v_mfma_f32_16x16x32_bf16 v[164:167], a[100:103], v[56:59], v[164:167]
buffer_load_dwordx4 v28, s[8:11], s36 offen offset:2048 sc1 lds
v_mfma_f32_16x16x32_bf16 v[168:171], a[120:123], v[60:63], v[168:171]
v_exp_f32 v97, v97
v_mfma_f32_16x16x32_bf16 v[168:171], a[104:107], v[56:59], v[168:171]
v_exp_f32 v87, v87
v_mfma_f32_16x16x32_bf16 v[172:175], a[124:127], v[60:63], v[172:175]
v_cvt_pk_bf16_f32 v54, v84, v85
v_xor_b32 v126, 192, v120
v_mfma_f32_16x16x32_bf16 v[172:175], a[108:111], v[56:59], v[172:175]
s_add_u32 s15, s15, 104857600
v_exp_f32 v98, v98
v_mfma_f32_16x16x32_bf16 v[224:227], a[112:115], v[76:79], v[224:227]
v_exp_f32 v99, v99
v_exp_f32 v82, v82
v_xor_b32 v127, 224, v120
v_cvt_pk_bf16_f32 v55, v86, v87
v_mfma_f32_16x16x32_bf16 v[224:227], a[96:99], v[72:75], v[224:227]
ds_read_b128 a[112:115], v5 offset:12288
ds_read_b128 a[96:99], v5 offset:8192
v_mfma_f32_16x16x32_bf16 v[228:231], a[116:119], v[76:79], v[228:231]
ds_read_b64_tr_b16 a[152:153], v126 offset:0
ds_read_b64_tr_b16 a[154:155], v126 offset:4096
ds_read_b128 a[116:119], v5 offset:13312
ds_read_b64_tr_b16 a[156:157], v127 offset:0
v_mfma_f32_16x16x32_bf16 v[228:231], a[100:103], v[72:75], v[228:231]
s_waitcnt lgkmcnt(10)
buffer_store_dwordx4 a[160:163], v4, s[40:43], s34 offen offset:2048 sc1
ds_read_b64_tr_b16 a[158:159], v127 offset:4096
ds_read_b128 a[100:103], v5 offset:9216
v_mfma_f32_16x16x32_bf16 v[232:235], a[120:123], v[76:79], v[232:235]
v_exp_f32 v95, v95
v_mfma_f32_16x16x32_bf16 v[232:235], a[104:107], v[72:75], v[232:235]
s_waitcnt lgkmcnt(11)
ds_read_b128 a[120:123], v5 offset:14336
ds_read_b128 a[104:107], v5 offset:10240
v_mfma_f32_16x16x32_bf16 v[236:239], a[124:127], v[76:79], v[236:239]
s_waitcnt lgkmcnt(13)
buffer_store_dwordx4 a[128:131], v4, s[40:43], s15 offen offset:0 sc1
v_mfma_f32_16x16x32_bf16 v[236:239], a[108:111], v[72:75], v[236:239]
v_cvt_pk_bf16_f32 v53, v82, v83
v_cvt_pk_bf16_f32 v68, v96, v97
v_mfma_f32_16x16x32_bf16 v[80:83], a[64:67], a[0:3], v[32:35]
buffer_store_dwordx4 a[132:135], v4, s[40:43], s15 offen offset:1024 sc1
v_mfma_f32_16x16x32_bf16 v[80:83], a[68:71], a[4:7], v[80:83]
buffer_store_dwordx4 a[136:139], v4, s[40:43], s15 offen offset:2048 sc1
v_mfma_f32_16x16x32_bf16 v[80:83], a[72:75], a[8:11], v[80:83]
buffer_store_dwordx4 a[140:143], v4, s[40:43], s15 offen offset:3072 sc1
v_mfma_f32_16x16x32_bf16 v[80:83], a[76:79], a[12:15], v[80:83]
v_exp_f32 v92, v92
v_mfma_f32_16x16x32_bf16 v[84:87], a[80:83], a[0:3], v[32:35]
s_add_u32 s15, s15, 4096
ds_read_b128 a[124:127], v5 offset:15360
ds_read_b128 a[108:111], v5 offset:11264
v_mfma_f32_16x16x32_bf16 v[84:87], a[84:87], a[4:7], v[84:87]
s_branch kf_kernel_pl33
kf_kernel_pd33:
s_branch kf_kernel_r3
kf_kernel_pl33:
v_exp_f32 v102, v102
v_mfma_f32_16x16x32_bf16 v[84:87], a[88:91], a[8:11], v[84:87]
v_exp_f32 v103, v103
v_mfma_f32_16x16x32_bf16 v[84:87], a[92:95], a[12:15], v[84:87]
v_cvt_pk_bf16_f32 v71, v102, v103
v_cvt_pk_bf16_f32 v69, v98, v99
v_mfma_f32_16x16x32_bf16 v[96:99], a[64:67], a[32:35], v[40:43]
s_waitcnt lgkmcnt(5)
v_exp_f32 v90, v90
v_mfma_f32_16x16x32_bf16 v[96:99], a[68:71], a[36:39], v[96:99]
buffer_load_dwordx4 v31, s[8:11], s36 offen offset:3072 sc1 lds
v_mfma_f32_16x16x32_bf16 v[96:99], a[72:75], a[40:43], v[96:99]
s_waitcnt lgkmcnt(4)
buffer_store_dwordx4 a[144:147], v4, s[40:43], s15 offen offset:0 sc1
v_cvt_pk_bf16_f32 v70, v100, v101
v_mfma_f32_16x16x32_bf16 v[96:99], a[76:79], a[44:47], v[96:99]
v_exp_f32 v88, v88
v_mfma_f32_16x16x32_bf16 v[100:103], a[80:83], a[32:35], v[40:43]
v_exp_f32 v89, v89
v_mfma_f32_16x16x32_bf16 v[100:103], a[84:87], a[36:39], v[100:103]
v_exp_f32 v105, v105
v_mfma_f32_16x16x32_bf16 v[100:103], a[88:91], a[40:43], v[100:103]
v_exp_f32 v104, v104
v_mfma_f32_16x16x32_bf16 v[100:103], a[92:95], a[44:47], v[100:103]
s_add_u32 s27, s27, 1
v_exp_f32 v107, v107
v_smfmac_f32_16x16x64_bf16 a[240:243], v[112:115], v[48:55], v19
v_exp_f32 v94, v94
v_mfma_f32_16x16x32_bf16 v[144:147], a[96:99], v[48:51], v[144:147]
buffer_store_dwordx4 a[160:163], v4, s[40:43], s34 offen offset:3072 sc1
v_mfma_f32_16x16x32_bf16 v[144:147], a[112:115], v[52:55], v[144:147]
v_exp_f32 v93, v93
v_mfma_f32_16x16x32_bf16 v[148:151], a[100:103], v[48:51], v[148:151]
s_waitcnt lgkmcnt(0)
buffer_store_dwordx4 a[148:151], v4, s[40:43], s15 offen offset:1024 sc1
v_mfma_f32_16x16x32_bf16 v[148:151], a[116:119], v[52:55], v[148:151]
s_sub_u32 s39, s39, 16777216
v_exp_f32 v106, v106
v_mfma_f32_16x16x32_bf16 v[152:155], a[104:107], v[48:51], v[152:155]
v_cvt_pk_bf16_f32 v62, v92, v93
v_cvt_pk_bf16_f32 v60, v88, v89
v_mfma_f32_16x16x32_bf16 v[152:155], a[120:123], v[52:55], v[152:155]
v_exp_f32 v110, v110
v_mfma_f32_16x16x32_bf16 v[156:159], a[108:111], v[48:51], v[156:159]
s_mov_b32 s3, 3178496
v_exp_f32 v108, v108
v_mfma_f32_16x16x32_bf16 v[156:159], a[124:127], v[52:55], v[156:159]
s_bitset1_b32 m0, 14
v_exp_f32 v91, v91
v_smfmac_f32_16x16x64_bf16 a[248:251], v[112:115], v[64:71], v19
v_lshlrev_b32 v2, 4, v4
v_exp_f32 v111, v111
v_mfma_f32_16x16x32_bf16 v[208:211], a[96:99], v[64:67], v[208:211]
buffer_store_dwordx4 a[152:155], v4, s[40:43], s15 offen offset:2048 sc1
v_mfma_f32_16x16x32_bf16 v[208:211], a[112:115], v[68:71], v[208:211]
v_exp_f32 v109, v109
v_mfma_f32_16x16x32_bf16 v[212:215], a[100:103], v[64:67], v[212:215]
v_cvt_pk_bf16_f32 v78, v108, v109
v_cvt_pk_bf16_f32 v63, v94, v95
v_mfma_f32_16x16x32_bf16 v[212:215], a[116:119], v[68:71], v[212:215]
buffer_store_dwordx4 a[156:159], v4, s[40:43], s15 offen offset:3072 sc1
v_mfma_f32_16x16x32_bf16 v[216:219], a[104:107], v[64:67], v[216:219]
s_sub_u32 s36, s36, s61
v_cvt_pk_bf16_f32 v77, v106, v107
v_cvt_pk_bf16_f32 v76, v104, v105
v_mfma_f32_16x16x32_bf16 v[216:219], a[120:123], v[68:71], v[216:219]
v_cvt_pk_bf16_f32 v61, v90, v91
v_cvt_pk_bf16_f32 v79, v110, v111
v_mfma_f32_16x16x32_bf16 v[220:223], a[108:111], v[64:67], v[220:223]
buffer_load_dword v30, v2, s[40:43], s3 offen sc1
v_mfma_f32_16x16x32_bf16 v[220:223], a[124:127], v[68:71], v[220:223]
s_cbranch_scc1 kf_kernel_sw_loopAB1
s_branch kf_kernel_loopAB1
kf_kernel_hA7:
v_cmp_eq_u32 vcc, 0, v4
v_exp_f32 v98, v98
v_mfma_f32_16x16x32_bf16 v[88:91], a[64:67], a[16:19], v[36:39]
s_waitcnt vmcnt(16) lgkmcnt(0)
s_barrier
v_mfma_f32_16x16x32_bf16 v[88:91], a[68:71], a[20:23], v[88:91]
s_sub_u32 s98, s98, kf_kernel_last-65536-kf_kernel_drain
v_exp_f32 v87, v87
v_mfma_f32_16x16x32_bf16 v[88:91], a[72:75], a[24:27], v[88:91]
s_subb_u32 s99, s99, 0
v_exp_f32 v84, v84
v_mfma_f32_16x16x32_bf16 v[88:91], a[76:79], a[28:31], v[88:91]
global_load_dword a236, v4, s[98:99]
v_mfma_f32_16x16x32_bf16 v[92:95], a[80:83], a[16:19], v[36:39]
v_exp_f32 v86, v86
v_mfma_f32_16x16x32_bf16 v[92:95], a[84:87], a[20:23], v[92:95]
buffer_load_dwordx4 v6, s[8:11], s36 offen offset:0 sc1 lds
v_mfma_f32_16x16x32_bf16 v[92:95], a[88:91], a[24:27], v[92:95]
v_exp_f32 v80, v80
v_mfma_f32_16x16x32_bf16 v[92:95], a[92:95], a[28:31], v[92:95]
v_exp_f32 v96, v96
v_mfma_f32_16x16x32_bf16 v[104:107], a[64:67], a[48:51], v[44:47]
s_lshr_b32 s3, s2, 2
v_exp_f32 v82, v82
v_mfma_f32_16x16x32_bf16 v[104:107], a[68:71], a[52:55], v[104:107]
ds_read_b128 a[64:67], v5 offset:0
ds_read_b128 a[68:71], v5 offset:1024
v_mfma_f32_16x16x32_bf16 v[104:107], a[72:75], a[56:59], v[104:107]
s_lshl_b32 s3, s3, 8
ds_read_b128 a[72:75], v5 offset:2048
buffer_load_dwordx4 v7, s[8:11], s36 offen offset:1024 sc1 lds
v_mfma_f32_16x16x32_bf16 v[104:107], a[76:79], a[60:63], v[104:107]
s_add_u32 s3, s3, 3145728
v_exp_f32 v102, v102
v_mfma_f32_16x16x32_bf16 v[108:111], a[80:83], a[48:51], v[44:47]
ds_read_b128 a[76:79], v5 offset:3072
ds_read_b128 a[80:83], v5 offset:4096
v_mfma_f32_16x16x32_bf16 v[108:111], a[84:87], a[52:55], v[108:111]
v_exp_f32 v97, v97
v_mfma_f32_16x16x32_bf16 v[108:111], a[88:91], a[56:59], v[108:111]
ds_read_b128 a[84:87], v5 offset:5120
ds_read_b128 a[88:91], v5 offset:6144
v_mfma_f32_16x16x32_bf16 v[108:111], a[92:95], a[60:63], v[108:111]
ds_read_b128 a[92:95], v5 offset:7168
buffer_load_dwordx4 v28, s[8:11], s36 offen offset:2048 sc1 lds
v_mfma_f32_16x16x32_bf16 v[160:163], a[112:115], v[60:63], v[160:163]
v_exp_f32 v81, v81
v_mfma_f32_16x16x32_bf16 v[160:163], a[96:99], v[56:59], v[160:163]
v_exp_f32 v99, v99
v_mfma_f32_16x16x32_bf16 v[164:167], a[116:119], v[60:63], v[164:167]
buffer_load_dwordx4 v31, s[8:11], s36 offen offset:3072 sc1 lds
v_mfma_f32_16x16x32_bf16 v[164:167], a[100:103], v[56:59], v[164:167]
v_mov_b32 v2, 1073741824
v_mov_b32 v1, 1
v_mfma_f32_16x16x32_bf16 v[168:171], a[120:123], v[60:63], v[168:171]
s_sub_u32 s39, s39, 16777216
v_exp_f32 v100, v100
v_mfma_f32_16x16x32_bf16 v[168:171], a[104:107], v[56:59], v[168:171]
v_exp_f32 v85, v85
v_exp_f32 v101, v101
v_mfma_f32_16x16x32_bf16 v[172:175], a[124:127], v[60:63], v[172:175]
v_cndmask_b32 v2, v2, 0, vcc
v_cvt_pk_bf16_f32 v69, v98, v99
v_mfma_f32_16x16x32_bf16 v[172:175], a[108:111], v[56:59], v[172:175]
s_waitcnt vmcnt(9)
v_exp_f32 v83, v83
v_mfma_f32_16x16x32_bf16 v[224:227], a[112:115], v[76:79], v[224:227]
v_cmp_gt_u32 vcc, 16, v30
v_cvt_pk_bf16_f32 v52, v80, v81
v_exp_f32 v103, v103
v_mfma_f32_16x16x32_bf16 v[224:227], a[96:99], v[72:75], v[224:227]
ds_read_b128 a[112:115], v5 offset:12288
ds_read_b128 a[96:99], v5 offset:8192
v_mfma_f32_16x16x32_bf16 v[228:231], a[116:119], v[76:79], v[228:231]
s_add_u32 s27, s27, 1
ds_read_b128 a[116:119], v5 offset:13312
buffer_atomic_add v1, v2, s[40:43], s3 offen sc1
v_cvt_pk_bf16_f32 v68, v96, v97
v_mfma_f32_16x16x32_bf16 v[228:231], a[100:103], v[72:75], v[228:231]
s_cmp_lg_u64 vcc, 0
ds_read_b128 a[100:103], v5 offset:9216
v_cvt_pk_bf16_f32 v55, v86, v87
v_mfma_f32_16x16x32_bf16 v[232:235], a[120:123], v[76:79], v[232:235]
ds_read_b128 a[120:123], v5 offset:14336
v_cvt_pk_bf16_f32 v53, v82, v83
v_cvt_pk_bf16_f32 v54, v84, v85
s_cbranch_scc1 kf_kernel_spin_znA
kf_kernel_ret_znA:
v_mfma_f32_16x16x32_bf16 v[232:235], a[104:107], v[72:75], v[232:235]
v_exp_f32 v93, v93
v_mfma_f32_16x16x32_bf16 v[236:239], a[124:127], v[76:79], v[236:239]
s_sub_u32 s34, s33, 0
v_exp_f32 v89, v89
v_mfma_f32_16x16x32_bf16 v[236:239], a[108:111], v[72:75], v[236:239]
s_waitcnt lgkmcnt(9)
buffer_load_dwordx4 a[128:131], v4, s[40:43], s34 offen offset:0 sc1
v_mfma_f32_16x16x32_bf16 v[80:83], a[64:67], a[0:3], v[32:35]
ds_read_b128 a[104:107], v5 offset:10240
ds_read_b128 a[124:127], v5 offset:15360
v_mfma_f32_16x16x32_bf16 v[80:83], a[68:71], a[4:7], v[80:83]
v_exp_f32 v92, v92
v_mfma_f32_16x16x32_bf16 v[80:83], a[72:75], a[8:11], v[80:83]
s_waitcnt lgkmcnt(7)
ds_read_b128 a[108:111], v5 offset:11264
v_mfma_f32_16x16x32_bf16 v[80:83], a[76:79], a[12:15], v[80:83]
buffer_load_dwordx4 a[132:135], v4, s[40:43], s34 offen offset:1024 sc1
v_mfma_f32_16x16x32_bf16 v[84:87], a[80:83], a[0:3], v[32:35]
s_waitcnt lgkmcnt(4)
v_exp_f32 v108, v108
v_mfma_f32_16x16x32_bf16 v[84:87], a[84:87], a[4:7], v[84:87]
v_exp_f32 v105, v105
v_mfma_f32_16x16x32_bf16 v[84:87], a[88:91], a[8:11], v[84:87]
buffer_load_dwordx4 a[136:139], v4, s[40:43], s34 offen offset:2048 sc1
v_mfma_f32_16x16x32_bf16 v[84:87], a[92:95], a[12:15], v[84:87]
v_mfma_f32_16x16x32_bf16 v[96:99], a[64:67], a[32:35], v[40:43]
v_cvt_pk_bf16_f32 v71, v102, v103
v_mfma_f32_16x16x32_bf16 v[96:99], a[68:71], a[36:39], v[96:99]
v_exp_f32 v90, v90
v_mfma_f32_16x16x32_bf16 v[96:99], a[72:75], a[40:43], v[96:99]
buffer_load_dwordx4 a[140:143], v4, s[40:43], s34 offen offset:3072 sc1
v_mfma_f32_16x16x32_bf16 v[96:99], a[76:79], a[44:47], v[96:99]
v_cvt_pk_bf16_f32 v70, v100, v101
v_mfma_f32_16x16x32_bf16 v[100:103], a[80:83], a[32:35], v[40:43]
s_sub_u32 s34, s33, 4096
v_exp_f32 v111, v111
v_mfma_f32_16x16x32_bf16 v[100:103], a[84:87], a[36:39], v[100:103]
v_mfma_f32_16x16x32_bf16 v[100:103], a[88:91], a[40:43], v[100:103]
v_exp_f32 v109, v109
v_mfma_f32_16x16x32_bf16 v[100:103], a[92:95], a[44:47], v[100:103]
buffer_load_dwordx4 a[144:147], v4, s[40:43], s34 offen offset:0 sc1
v_smfmac_f32_16x16x64_bf16 a[240:243], v[112:115], v[48:55], v19
s_bitset1_b32 m0, 14
v_exp_f32 v110, v110
v_mfma_f32_16x16x32_bf16 v[144:147], a[96:99], v[48:51], v[144:147]
v_mfma_f32_16x16x32_bf16 v[144:147], a[112:115], v[52:55], v[144:147]
v_exp_f32 v95, v95
v_mfma_f32_16x16x32_bf16 v[148:151], a[100:103], v[48:51], v[148:151]
s_waitcnt lgkmcnt(0)
v_exp_f32 v94, v94
v_mfma_f32_16x16x32_bf16 v[148:151], a[116:119], v[52:55], v[148:151]
buffer_load_dwordx4 a[148:151], v4, s[40:43], s34 offen offset:1024 sc1
v_mfma_f32_16x16x32_bf16 v[152:155], a[104:107], v[48:51], v[152:155]
v_exp_f32 v104, v104
v_mfma_f32_16x16x32_bf16 v[152:155], a[120:123], v[52:55], v[152:155]
v_cvt_pk_bf16_f32 v76, v104, v105
v_mfma_f32_16x16x32_bf16 v[156:159], a[108:111], v[48:51], v[156:159]
s_sub_u32 s36, s36, s61
v_exp_f32 v88, v88
v_mfma_f32_16x16x32_bf16 v[156:159], a[124:127], v[52:55], v[156:159]
v_exp_f32 v106, v106
v_smfmac_f32_16x16x64_bf16 a[248:251], v[112:115], v[64:71], v19
buffer_load_dwordx4 a[152:155], v4, s[40:43], s34 offen offset:2048 sc1
v_mfma_f32_16x16x32_bf16 v[208:211], a[96:99], v[64:67], v[208:211]
v_exp_f32 v91, v91
v_mfma_f32_16x16x32_bf16 v[208:211], a[112:115], v[68:71], v[208:211]
v_exp_f32 v107, v107
v_mfma_f32_16x16x32_bf16 v[212:215], a[100:103], v[64:67], v[212:215]
v_cvt_pk_bf16_f32 v60, v88, v89
v_cvt_pk_bf16_f32 v78, v108, v109
v_mfma_f32_16x16x32_bf16 v[212:215], a[116:119], v[68:71], v[212:215]
buffer_load_dwordx4 a[156:159], v4, s[40:43], s34 offen offset:3072 sc1
v_mfma_f32_16x16x32_bf16 v[216:219], a[104:107], v[64:67], v[216:219]
v_cvt_pk_bf16_f32 v61, v90, v91
v_cvt_pk_bf16_f32 v77, v106, v107
v_mfma_f32_16x16x32_bf16 v[216:219], a[120:123], v[68:71], v[216:219]
v_cvt_pk_bf16_f32 v63, v94, v95
v_cvt_pk_bf16_f32 v79, v110, v111
v_mfma_f32_16x16x32_bf16 v[220:223], a[108:111], v[64:67], v[220:223]
v_cvt_pk_bf16_f32 v62, v92, v93
v_mfma_f32_16x16x32_bf16 v[220:223], a[124:127], v[68:71], v[220:223]
s_cbranch_scc1 kf_kernel_sw_loopAB1
s_branch kf_kernel_loopAB1
kf_kernel_hA8:
v_mfma_f32_16x16x32_bf16 v[88:91], a[64:67], a[16:19], v[36:39]
s_waitcnt vmcnt(16) lgkmcnt(0)
s_barrier
v_mfma_f32_16x16x32_bf16 v[88:91], a[68:71], a[20:23], v[88:91]
s_sub_u32 s34, s33, 8192
v_exp_f32 v82, v82
v_mfma_f32_16x16x32_bf16 v[88:91], a[72:75], a[24:27], v[88:91]
buffer_load_dwordx4 v6, s[8:11], s36 offen offset:0 sc1 lds
v_mfma_f32_16x16x32_bf16 v[88:91], a[76:79], a[28:31], v[88:91]
buffer_load_dwordx4 a[160:163], v4, s[40:43], s34 offen offset:0 sc1
v_mfma_f32_16x16x32_bf16 v[92:95], a[80:83], a[16:19], v[36:39]
buffer_load_dwordx4 v7, s[8:11], s36 offen offset:1024 sc1 lds
v_mfma_f32_16x16x32_bf16 v[92:95], a[84:87], a[20:23], v[92:95]
s_sub_u32 s3, 15, s22
v_exp_f32 v96, v96
v_mfma_f32_16x16x32_bf16 v[92:95], a[88:91], a[24:27], v[92:95]
v_exp_f32 v98, v98
v_mfma_f32_16x16x32_bf16 v[92:95], a[92:95], a[28:31], v[92:95]
s_add_u32 s27, s27, 1
v_exp_f32 v84, v84
v_mfma_f32_16x16x32_bf16 v[104:107], a[64:67], a[48:51], v[44:47]
ds_read_b128 a[64:67], v5 offset:0
v_exp_f32 v81, v81
v_mfma_f32_16x16x32_bf16 v[104:107], a[68:71], a[52:55], v[104:107]
v_exp_f32 v80, v80
v_mfma_f32_16x16x32_bf16 v[104:107], a[72:75], a[56:59], v[104:107]
buffer_load_dwordx4 a[164:167], v4, s[40:43], s34 offen offset:1024 sc1
v_mfma_f32_16x16x32_bf16 v[104:107], a[76:79], a[60:63], v[104:107]
s_sub_u32 s39, s39, 16777216
v_exp_f32 v87, v87
v_mfma_f32_16x16x32_bf16 v[108:111], a[80:83], a[48:51], v[44:47]
s_bitcmp1_b32 s23, 0
ds_read_b128 a[68:71], v5 offset:1024
ds_read_b128 a[72:75], v5 offset:2048
ds_read_b128 a[76:79], v5 offset:3072
v_mfma_f32_16x16x32_bf16 v[108:111], a[84:87], a[52:55], v[108:111]
ds_read_b128 a[80:83], v5 offset:4096
ds_read_b128 a[84:87], v5 offset:5120
v_mfma_f32_16x16x32_bf16 v[108:111], a[88:91], a[56:59], v[108:111]
buffer_load_dwordx4 v28, s[8:11], s36 offen offset:2048 sc1 lds
v_mfma_f32_16x16x32_bf16 v[108:111], a[92:95], a[60:63], v[108:111]
s_cselect_b32 s5, s3, s22
v_exp_f32 v97, v97
v_mfma_f32_16x16x32_bf16 v[160:163], a[112:115], v[60:63], v[160:163]
v_exp_f32 v101, v101
v_mfma_f32_16x16x32_bf16 v[160:163], a[96:99], v[56:59], v[160:163]
s_lshr_b32 s4, s23, 2
v_exp_f32 v86, v86
v_mfma_f32_16x16x32_bf16 v[164:167], a[116:119], v[60:63], v[164:167]
s_mov_b32 s58, m0
ds_read_b128 a[88:91], v5 offset:6144
v_exp_f32 v85, v85
v_mfma_f32_16x16x32_bf16 v[164:167], a[100:103], v[56:59], v[164:167]
buffer_load_dwordx4 a[168:171], v4, s[40:43], s34 offen offset:2048 sc1
v_mfma_f32_16x16x32_bf16 v[168:171], a[120:123], v[60:63], v[168:171]
s_lshl2_add_u32 s3, s5, s20
v_exp_f32 v103, v103
v_mfma_f32_16x16x32_bf16 v[168:171], a[104:107], v[56:59], v[168:171]
s_add_u32 s29, s35, 0xfffffd00
v_exp_f32 v102, v102
v_mfma_f32_16x16x32_bf16 v[172:175], a[124:127], v[60:63], v[172:175]
s_lshl1_add_u32 s4, s3, s4
v_exp_f32 v83, v83
v_mfma_f32_16x16x32_bf16 v[172:175], a[108:111], v[56:59], v[172:175]
ds_read_b128 a[92:95], v5 offset:7168
v_cvt_pk_bf16_f32 v52, v80, v81
v_mfma_f32_16x16x32_bf16 v[224:227], a[112:115], v[76:79], v[224:227]
buffer_load_dwordx4 v31, s[8:11], s36 offen offset:3072 sc1 lds
ds_read_b128 a[112:115], v5 offset:12288
v_mfma_f32_16x16x32_bf16 v[224:227], a[96:99], v[72:75], v[224:227]
v_exp_f32 v99, v99
v_mfma_f32_16x16x32_bf16 v[228:231], a[116:119], v[76:79], v[228:231]
s_waitcnt lgkmcnt(5)
ds_read_b128 a[96:99], v5 offset:8192
ds_read_b128 a[116:119], v5 offset:13312
v_mfma_f32_16x16x32_bf16 v[228:231], a[100:103], v[72:75], v[228:231]
buffer_load_dwordx4 a[172:175], v4, s[40:43], s34 offen offset:3072 sc1
v_mfma_f32_16x16x32_bf16 v[232:235], a[120:123], v[76:79], v[232:235]
ds_read_b128 a[100:103], v5 offset:9216
v_exp_f32 v90, v90
v_mfma_f32_16x16x32_bf16 v[232:235], a[104:107], v[72:75], v[232:235]
ds_read_b128 a[120:123], v5 offset:14336
v_cvt_pk_bf16_f32 v55, v86, v87
v_mfma_f32_16x16x32_bf16 v[236:239], a[124:127], v[76:79], v[236:239]
ds_read_b128 a[104:107], v5 offset:10240
v_cvt_pk_bf16_f32 v54, v84, v85
v_mfma_f32_16x16x32_bf16 v[236:239], a[108:111], v[72:75], v[236:239]
s_add_u32 m0, s28, 131072
v_cvt_pk_bf16_f32 v69, v98, v99
v_cvt_pk_bf16_f32 v53, v82, v83
v_mfma_f32_16x16x32_bf16 v[80:83], a[64:67], a[0:3], v[32:35]
s_bfe_u32 s60, s23, 0x10001
v_exp_f32 v89, v89
v_mfma_f32_16x16x32_bf16 v[80:83], a[68:71], a[4:7], v[80:83]
s_sub_u32 s34, s33, 12288
v_exp_f32 v92, v92
v_mfma_f32_16x16x32_bf16 v[80:83], a[72:75], a[8:11], v[80:83]
buffer_load_dwordx4 v21, s[44:47], s29 offen offset:0 lds
v_mfma_f32_16x16x32_bf16 v[80:83], a[76:79], a[12:15], v[80:83]
s_waitcnt lgkmcnt(6)
buffer_load_dwordx4 a[176:179], v4, s[40:43], s34 offen offset:0 sc1
v_mfma_f32_16x16x32_bf16 v[84:87], a[80:83], a[0:3], v[32:35]
v_exp_f32 v88, v88
v_mfma_f32_16x16x32_bf16 v[84:87], a[84:87], a[4:7], v[84:87]
v_exp_f32 v100, v100
v_mfma_f32_16x16x32_bf16 v[84:87], a[88:91], a[8:11], v[84:87]
v_exp_f32 v94, v94
v_mfma_f32_16x16x32_bf16 v[84:87], a[92:95], a[12:15], v[84:87]
ds_read_b128 a[124:127], v5 offset:15360
v_cvt_pk_bf16_f32 v68, v96, v97
v_mfma_f32_16x16x32_bf16 v[96:99], a[64:67], a[32:35], v[40:43]
v_exp_f32 v91, v91
v_mfma_f32_16x16x32_bf16 v[96:99], a[68:71], a[36:39], v[96:99]
buffer_load_dwordx4 v22, s[44:47], s29 offen offset:1024 lds
v_mfma_f32_16x16x32_bf16 v[96:99], a[72:75], a[40:43], v[96:99]
s_mov_b32 s18, 2621440
ds_read_b128 a[108:111], v5 offset:11264
v_cvt_pk_bf16_f32 v70, v100, v101
v_mfma_f32_16x16x32_bf16 v[96:99], a[76:79], a[44:47], v[96:99]
buffer_load_dwordx4 a[180:183], v4, s[40:43], s34 offen offset:1024 sc1
v_cvt_pk_bf16_f32 v71, v102, v103
v_mfma_f32_16x16x32_bf16 v[100:103], a[80:83], a[32:35], v[40:43]
v_exp_f32 v105, v105
v_mfma_f32_16x16x32_bf16 v[100:103], a[84:87], a[36:39], v[100:103]
s_and_b32 s3, s24, 3
v_exp_f32 v104, v104
v_mfma_f32_16x16x32_bf16 v[100:103], a[88:91], a[40:43], v[100:103]
buffer_load_dwordx4 v23, s[44:47], s29 offen offset:2048 lds
v_mfma_f32_16x16x32_bf16 v[100:103], a[92:95], a[44:47], v[100:103]
v_exp_f32 v93, v93
v_smfmac_f32_16x16x64_bf16 a[240:243], v[112:115], v[48:55], v19
s_waitcnt lgkmcnt(4)
v_exp_f32 v107, v107
v_mfma_f32_16x16x32_bf16 v[144:147], a[96:99], v[48:51], v[144:147]
v_exp_f32 v95, v95
v_mfma_f32_16x16x32_bf16 v[144:147], a[112:115], v[52:55], v[144:147]
s_waitcnt lgkmcnt(0)
buffer_load_dwordx4 a[184:187], v4, s[40:43], s34 offen offset:2048 sc1
v_mfma_f32_16x16x32_bf16 v[148:151], a[100:103], v[48:51], v[148:151]
buffer_load_dwordx4 v24, s[44:47], s29 offen offset:3072 lds
v_mfma_f32_16x16x32_bf16 v[148:151], a[116:119], v[52:55], v[148:151]
v_cvt_pk_bf16_f32 v60, v88, v89
v_and_b32 v1, 15, v0
v_mfma_f32_16x16x32_bf16 v[152:155], a[104:107], v[48:51], v[152:155]
s_lshl2_add_u32 s3, s60, s3
v_exp_f32 v111, v111
v_mfma_f32_16x16x32_bf16 v[152:155], a[120:123], v[52:55], v[152:155]
v_exp_f32 v109, v109
v_mfma_f32_16x16x32_bf16 v[156:159], a[108:111], v[48:51], v[156:159]
buffer_load_dwordx4 a[188:191], v4, s[40:43], s34 offen offset:3072 sc1
v_mfma_f32_16x16x32_bf16 v[156:159], a[124:127], v[52:55], v[156:159]
s_mov_b32 m0, s58
v_cvt_pk_bf16_f32 v76, v104, v105
s_bitset1_b32 m0, 14
v_smfmac_f32_16x16x64_bf16 a[248:251], v[112:115], v[64:71], v19
v_exp_f32 v106, v106
v_mfma_f32_16x16x32_bf16 v[208:211], a[96:99], v[64:67], v[208:211]
s_lshl_b32 s60, s4, 7
s_add_u32 s3, s3, s60
v_cvt_pk_bf16_f32 v62, v92, v93
v_mfma_f32_16x16x32_bf16 v[208:211], a[112:115], v[68:71], v[208:211]
v_exp_f32 v110, v110
v_mfma_f32_16x16x32_bf16 v[212:215], a[100:103], v[64:67], v[212:215]
v_cvt_pk_bf16_f32 v61, v90, v91
v_bfe_u32 v2, v0, 4, 2
v_mfma_f32_16x16x32_bf16 v[212:215], a[116:119], v[68:71], v[212:215]
v_exp_f32 v108, v108
v_mfma_f32_16x16x32_bf16 v[216:219], a[104:107], v[64:67], v[216:219]
s_sub_u32 s36, s36, s61
v_cvt_pk_bf16_f32 v63, v94, v95
v_cvt_pk_bf16_f32 v78, v108, v109
v_mfma_f32_16x16x32_bf16 v[216:219], a[120:123], v[68:71], v[216:219]
s_mul_i32 s15, s3, 160
v_mul_u32_u24 v25, 1280, v1
v_lshl_add_u32 v25, v2, 3, v25
v_mfma_f32_16x16x32_bf16 v[220:223], a[108:111], v[64:67], v[220:223]
v_cvt_pk_bf16_f32 v77, v106, v107
v_cvt_pk_bf16_f32 v79, v110, v111
v_mfma_f32_16x16x32_bf16 v[220:223], a[124:127], v[68:71], v[220:223]
s_cbranch_scc1 kf_kernel_sw_loopAB1
s_branch kf_kernel_loopAB1
kf_kernel_hA9:
v_mfma_f32_16x16x32_bf16 v[88:91], a[64:67], a[16:19], v[36:39]
s_waitcnt vmcnt(16) lgkmcnt(0)
s_barrier
v_mfma_f32_16x16x32_bf16 v[88:91], a[68:71], a[20:23], v[88:91]
global_load_dword v30, v4, s[98:99]
v_mfma_f32_16x16x32_bf16 v[88:91], a[72:75], a[24:27], v[88:91]
s_sub_u32 s34, s33, 16384
v_exp_f32 v81, v81
v_mfma_f32_16x16x32_bf16 v[88:91], a[76:79], a[28:31], v[88:91]
v_exp_f32 v97, v97
v_mfma_f32_16x16x32_bf16 v[92:95], a[80:83], a[16:19], v[36:39]
v_exp_f32 v85, v85
v_mfma_f32_16x16x32_bf16 v[92:95], a[84:87], a[20:23], v[92:95]
buffer_load_dwordx4 a[192:195], v4, s[40:43], s34 offen offset:0 sc1
v_mfma_f32_16x16x32_bf16 v[92:95], a[88:91], a[24:27], v[92:95]
v_exp_f32 v86, v86
v_mfma_f32_16x16x32_bf16 v[92:95], a[92:95], a[28:31], v[92:95]
v_exp_f32 v101, v101
v_mfma_f32_16x16x32_bf16 v[104:107], a[64:67], a[48:51], v[44:47]
ds_read_b128 a[64:67], v5 offset:0
buffer_load_dwordx4 v6, s[8:11], s36 offen offset:0 sc1 lds
v_mfma_f32_16x16x32_bf16 v[104:107], a[68:71], a[52:55], v[104:107]
v_exp_f32 v84, v84
v_mfma_f32_16x16x32_bf16 v[104:107], a[72:75], a[56:59], v[104:107]
ds_read_b128 a[68:71], v5 offset:1024
ds_read_b128 a[72:75], v5 offset:2048
v_mfma_f32_16x16x32_bf16 v[104:107], a[76:79], a[60:63], v[104:107]
buffer_load_dwordx4 a[196:199], v4, s[40:43], s34 offen offset:1024 sc1
v_mfma_f32_16x16x32_bf16 v[108:111], a[80:83], a[48:51], v[44:47]
ds_read_b128 a[76:79], v5 offset:3072
v_exp_f32 v80, v80
v_exp_f32 v82, v82
v_mfma_f32_16x16x32_bf16 v[108:111], a[84:87], a[52:55], v[108:111]
ds_read_b128 a[80:83], v5 offset:4096
ds_read_b128 a[84:87], v5 offset:5120
v_cvt_pk_bf16_f32 v52, v80, v81
v_mfma_f32_16x16x32_bf16 v[108:111], a[88:91], a[56:59], v[108:111]
s_sub_u32 s39, s39, 16777216
v_exp_f32 v99, v99
v_mfma_f32_16x16x32_bf16 v[108:111], a[92:95], a[60:63], v[108:111]
ds_read_b128 a[88:91], v5 offset:6144
ds_read_b128 a[92:95], v5 offset:7168
v_mfma_f32_16x16x32_bf16 v[160:163], a[112:115], v[60:63], v[160:163]
buffer_load_dwordx4 a[200:203], v4, s[40:43], s34 offen offset:2048 sc1
v_mfma_f32_16x16x32_bf16 v[160:163], a[96:99], v[56:59], v[160:163]
v_exp_f32 v83, v83
v_mfma_f32_16x16x32_bf16 v[164:167], a[116:119], v[60:63], v[164:167]
v_exp_f32 v96, v96
v_mfma_f32_16x16x32_bf16 v[164:167], a[100:103], v[56:59], v[164:167]
buffer_load_dwordx4 v7, s[8:11], s36 offen offset:1024 sc1 lds
v_mfma_f32_16x16x32_bf16 v[168:171], a[120:123], v[60:63], v[168:171]
v_cvt_pk_bf16_f32 v54, v84, v85
v_cvt_pk_bf16_f32 v68, v96, v97
v_mfma_f32_16x16x32_bf16 v[168:171], a[104:107], v[56:59], v[168:171]
v_exp_f32 v87, v87
v_mfma_f32_16x16x32_bf16 v[172:175], a[124:127], v[60:63], v[172:175]
buffer_load_dwordx4 a[204:207], v4, s[40:43], s34 offen offset:3072 sc1
v_mfma_f32_16x16x32_bf16 v[172:175], a[108:111], v[56:59], v[172:175]
s_sub_u32 s34, s33, 20480
v_exp_f32 v100, v100
v_mfma_f32_16x16x32_bf16 v[224:227], a[112:115], v[76:79], v[224:227]
s_waitcnt lgkmcnt(4)
v_exp_f32 v102, v102
v_mfma_f32_16x16x32_bf16 v[224:227], a[96:99], v[72:75], v[224:227]
ds_read_b128 a[112:115], v5 offset:12288
ds_read_b128 a[96:99], v5 offset:8192
v_mfma_f32_16x16x32_bf16 v[228:231], a[116:119], v[76:79], v[228:231]
s_waitcnt lgkmcnt(2)
buffer_load_dwordx4 a[208:211], v4, s[40:43], s34 offen offset:0 sc1
v_mfma_f32_16x16x32_bf16 v[228:231], a[100:103], v[72:75], v[228:231]
s_add_u32 s27, s27, 1
ds_read_b128 a[116:119], v5 offset:13312
ds_read_b128 a[100:103], v5 offset:9216
v_mfma_f32_16x16x32_bf16 v[232:235], a[120:123], v[76:79], v[232:235]
v_exp_f32 v98, v98
v_cvt_pk_bf16_f32 v53, v82, v83
v_mfma_f32_16x16x32_bf16 v[232:235], a[104:107], v[72:75], v[232:235]
buffer_load_dwordx4 v28, s[8:11], s36 offen offset:2048 sc1 lds
v_cvt_pk_bf16_f32 v69, v98, v99
v_mfma_f32_16x16x32_bf16 v[236:239], a[124:127], v[76:79], v[236:239]
ds_read_b128 a[120:123], v5 offset:14336
ds_read_b128 a[104:107], v5 offset:10240
ds_read_b128 a[124:127], v5 offset:15360
v_mfma_f32_16x16x32_bf16 v[236:239], a[108:111], v[72:75], v[236:239]
v_exp_f32 v94, v94
v_cvt_pk_bf16_f32 v70, v100, v101
v_mfma_f32_16x16x32_bf16 v[80:83], a[64:67], a[0:3], v[32:35]
v_exp_f32 v103, v103
v_mfma_f32_16x16x32_bf16 v[80:83], a[68:71], a[4:7], v[80:83]
buffer_load_dwordx4 a[212:215], v4, s[40:43], s34 offen offset:1024 sc1
v_mfma_f32_16x16x32_bf16 v[80:83], a[72:75], a[8:11], v[80:83]
v_exp_f32 v90, v90
v_mfma_f32_16x16x32_bf16 v[80:83], a[76:79], a[12:15], v[80:83]
ds_read_b128 a[108:111], v5 offset:11264
v_cvt_pk_bf16_f32 v55, v86, v87
v_mfma_f32_16x16x32_bf16 v[84:87], a[80:83], a[0:3], v[32:35]
s_waitcnt lgkmcnt(4)
buffer_load_dwordx4 a[216:219], v4, s[40:43], s34 offen offset:2048 sc1
v_mfma_f32_16x16x32_bf16 v[84:87], a[84:87], a[4:7], v[84:87]
v_exp_f32 v109, v109
v_mfma_f32_16x16x32_bf16 v[84:87], a[88:91], a[8:11], v[84:87]
v_exp_f32 v88, v88
v_mfma_f32_16x16x32_bf16 v[84:87], a[92:95], a[12:15], v[84:87]
v_exp_f32 v111, v111
v_mfma_f32_16x16x32_bf16 v[96:99], a[64:67], a[32:35], v[40:43]
v_exp_f32 v106, v106
v_mfma_f32_16x16x32_bf16 v[96:99], a[68:71], a[36:39], v[96:99]
v_exp_f32 v89, v89
v_mfma_f32_16x16x32_bf16 v[96:99], a[72:75], a[40:43], v[96:99]
buffer_load_dwordx2 v[14:15], v25, s[16:19], s15 offen offset:0
v_cvt_pk_bf16_f32 v71, v102, v103
v_mfma_f32_16x16x32_bf16 v[96:99], a[76:79], a[44:47], v[96:99]
v_exp_f32 v93, v93
v_mfma_f32_16x16x32_bf16 v[100:103], a[80:83], a[32:35], v[40:43]
v_exp_f32 v92, v92
v_mfma_f32_16x16x32_bf16 v[100:103], a[84:87], a[36:39], v[100:103]
buffer_load_dwordx2 v[16:17], v25, s[16:19], s15 offen offset:32
v_mfma_f32_16x16x32_bf16 v[100:103], a[88:91], a[40:43], v[100:103]
buffer_load_dwordx2 v[124:125], v25, s[16:19], s15 offen offset:64
v_mfma_f32_16x16x32_bf16 v[100:103], a[92:95], a[44:47], v[100:103]
v_exp_f32 v105, v105
v_smfmac_f32_16x16x64_bf16 a[240:243], v[112:115], v[48:55], v19
buffer_load_dwordx2 v[126:127], v25, s[16:19], s15 offen offset:96
v_mfma_f32_16x16x32_bf16 v[144:147], a[96:99], v[48:51], v[144:147]
buffer_load_dwordx2 v[26:27], v25, s[16:19], s15 offen offset:128
v_mfma_f32_16x16x32_bf16 v[144:147], a[112:115], v[52:55], v[144:147]
v_exp_f32 v104, v104
v_mfma_f32_16x16x32_bf16 v[148:151], a[100:103], v[48:51], v[148:151]
v_exp_f32 v91, v91
v_mfma_f32_16x16x32_bf16 v[148:151], a[116:119], v[52:55], v[148:151]
s_waitcnt lgkmcnt(0)
buffer_load_dwordx4 v31, s[8:11], s36 offen offset:3072 sc1 lds
v_mfma_f32_16x16x32_bf16 v[152:155], a[104:107], v[48:51], v[152:155]
s_bitset1_b32 m0, 14
v_cvt_pk_bf16_f32 v60, v88, v89
v_cvt_pk_bf16_f32 v62, v92, v93
v_mfma_f32_16x16x32_bf16 v[152:155], a[120:123], v[52:55], v[152:155]
v_exp_f32 v107, v107
v_mfma_f32_16x16x32_bf16 v[156:159], a[108:111], v[48:51], v[156:159]
v_exp_f32 v110, v110
v_mfma_f32_16x16x32_bf16 v[156:159], a[124:127], v[52:55], v[156:159]
v_cvt_pk_bf16_f32 v77, v106, v107
v_smfmac_f32_16x16x64_bf16 a[248:251], v[112:115], v[64:71], v19
v_exp_f32 v95, v95
v_mfma_f32_16x16x32_bf16 v[208:211], a[96:99], v[64:67], v[208:211]
v_cvt_pk_bf16_f32 v63, v94, v95
v_mfma_f32_16x16x32_bf16 v[208:211], a[112:115], v[68:71], v[208:211]
s_sub_u32 s36, s36, s61
v_cvt_pk_bf16_f32 v79, v110, v111
v_mfma_f32_16x16x32_bf16 v[212:215], a[100:103], v[64:67], v[212:215]
v_cvt_pk_bf16_f32 v76, v104, v105
v_cvt_pk_bf16_f32 v61, v90, v91
v_mfma_f32_16x16x32_bf16 v[212:215], a[116:119], v[68:71], v[212:215]
buffer_load_dwordx4 a[220:223], v4, s[40:43], s34 offen offset:3072 sc1
v_mfma_f32_16x16x32_bf16 v[216:219], a[104:107], v[64:67], v[216:219]
v_mfma_f32_16x16x32_bf16 v[216:219], a[120:123], v[68:71], v[216:219]
v_exp_f32 v108, v108
v_mfma_f32_16x16x32_bf16 v[220:223], a[108:111], v[64:67], v[220:223]
v_cvt_pk_bf16_f32 v78, v108, v109
v_mfma_f32_16x16x32_bf16 v[220:223], a[124:127], v[68:71], v[220:223]
s_cbranch_scc1 kf_kernel_sw_loopAB1
s_branch kf_kernel_loopAB1
kf_kernel_hA10:
v_mfma_f32_16x16x32_bf16 v[88:91], a[64:67], a[16:19], v[36:39]
s_waitcnt vmcnt(16) lgkmcnt(0)
s_barrier
v_mfma_f32_16x16x32_bf16 v[88:91], a[68:71], a[20:23], v[88:91]
v_exp_f32 v80, v80
v_mfma_f32_16x16x32_bf16 v[88:91], a[72:75], a[24:27], v[88:91]
buffer_load_dwordx4 v6, s[8:11], s36 offen offset:0 sc1 lds
v_mfma_f32_16x16x32_bf16 v[88:91], a[76:79], a[28:31], v[88:91]
s_sub_u32 s34, s33, 24576
v_exp_f32 v98, v98
v_mfma_f32_16x16x32_bf16 v[92:95], a[80:83], a[16:19], v[36:39]
v_exp_f32 v97, v97
v_mfma_f32_16x16x32_bf16 v[92:95], a[84:87], a[20:23], v[92:95]
v_exp_f32 v81, v81
v_mfma_f32_16x16x32_bf16 v[92:95], a[88:91], a[24:27], v[92:95]
s_branch kf_kernel_pl34
kf_kernel_pd34:
s_branch kf_kernel_r3
kf_kernel_pl34:
buffer_load_dwordx4 a[224:227], v4, s[40:43], s34 offen offset:0 sc1
v_mfma_f32_16x16x32_bf16 v[92:95], a[92:95], a[28:31], v[92:95]
v_exp_f32 v96, v96
v_mfma_f32_16x16x32_bf16 v[104:107], a[64:67], a[48:51], v[44:47]
buffer_load_dwordx4 v7, s[8:11], s36 offen offset:1024 sc1 lds
v_mfma_f32_16x16x32_bf16 v[104:107], a[68:71], a[52:55], v[104:107]
ds_read_b128 a[64:67], v5 offset:0
v_exp_f32 v100, v100
v_mfma_f32_16x16x32_bf16 v[104:107], a[72:75], a[56:59], v[104:107]
v_exp_f32 v99, v99
v_mfma_f32_16x16x32_bf16 v[104:107], a[76:79], a[60:63], v[104:107]
s_mov_b32 s58, m0
v_exp_f32 v85, v85
v_mfma_f32_16x16x32_bf16 v[108:111], a[80:83], a[48:51], v[44:47]
ds_read_b128 a[68:71], v5 offset:1024
ds_read_b128 a[72:75], v5 offset:2048
v_mfma_f32_16x16x32_bf16 v[108:111], a[84:87], a[52:55], v[108:111]
s_lshr_b32 s3, s4, 1
ds_read_b128 a[76:79], v5 offset:3072
ds_read_b128 a[80:83], v5 offset:4096
v_mfma_f32_16x16x32_bf16 v[108:111], a[88:91], a[56:59], v[108:111]
ds_read_b128 a[84:87], v5 offset:5120
ds_read_b128 a[88:91], v5 offset:6144
v_mfma_f32_16x16x32_bf16 v[108:111], a[92:95], a[60:63], v[108:111]
s_add_u32 s29, s35, 0xfffffc80
v_exp_f32 v82, v82
v_mfma_f32_16x16x32_bf16 v[160:163], a[112:115], v[60:63], v[160:163]
buffer_load_dwordx4 v28, s[8:11], s36 offen offset:2048 sc1 lds
v_mfma_f32_16x16x32_bf16 v[160:163], a[96:99], v[56:59], v[160:163]
v_exp_f32 v84, v84
v_mfma_f32_16x16x32_bf16 v[164:167], a[116:119], v[60:63], v[164:167]
ds_read_b128 a[92:95], v5 offset:7168
v_exp_f32 v87, v87
v_mfma_f32_16x16x32_bf16 v[164:167], a[100:103], v[56:59], v[164:167]
buffer_load_dwordx4 v31, s[8:11], s36 offen offset:3072 sc1 lds
v_mfma_f32_16x16x32_bf16 v[168:171], a[120:123], v[60:63], v[168:171]
v_exp_f32 v83, v83
v_mfma_f32_16x16x32_bf16 v[168:171], a[104:107], v[56:59], v[168:171]
s_add_u32 m0, s28, 147456
v_exp_f32 v102, v102
v_mfma_f32_16x16x32_bf16 v[172:175], a[124:127], v[60:63], v[172:175]
s_waitcnt lgkmcnt(4)
v_exp_f32 v103, v103
v_mfma_f32_16x16x32_bf16 v[172:175], a[108:111], v[56:59], v[172:175]
s_add_u32 s27, s27, 1
v_exp_f32 v86, v86
v_mfma_f32_16x16x32_bf16 v[224:227], a[112:115], v[76:79], v[224:227]
s_lshl_b32 s3, s3, 6
ds_read_b128 a[112:115], v5 offset:12288
v_cvt_pk_bf16_f32 v52, v80, v81
v_mfma_f32_16x16x32_bf16 v[224:227], a[96:99], v[72:75], v[224:227]
s_add_u32 s3, s3, s21
ds_read_b128 a[96:99], v5 offset:8192
v_cvt_pk_bf16_f32 v71, v102, v103
v_mfma_f32_16x16x32_bf16 v[228:231], a[116:119], v[76:79], v[228:231]
ds_read_b128 a[116:119], v5 offset:13312
buffer_load_dwordx4 a[228:231], v4, s[40:43], s34 offen offset:1024 sc1
v_mfma_f32_16x16x32_bf16 v[228:231], a[100:103], v[72:75], v[228:231]
s_lshl_b32 s3, s3, 12
v_exp_f32 v89, v89
v_mfma_f32_16x16x32_bf16 v[232:235], a[120:123], v[76:79], v[232:235]
ds_read_b128 a[100:103], v5 offset:9216
v_and_b32 v1, 31, v0
v_mfma_f32_16x16x32_bf16 v[232:235], a[104:107], v[72:75], v[232:235]
v_cvt_pk_bf16_f32 v68, v96, v97
v_cvt_pk_bf16_f32 v53, v82, v83
v_mfma_f32_16x16x32_bf16 v[236:239], a[124:127], v[76:79], v[236:239]
v_exp_f32 v101, v101
v_mfma_f32_16x16x32_bf16 v[236:239], a[108:111], v[72:75], v[236:239]
v_exp_f32 v94, v94
v_mfma_f32_16x16x32_bf16 v[80:83], a[64:67], a[0:3], v[32:35]
s_sub_u32 s39, s39, 1073741824
ds_read_b128 a[120:123], v5 offset:14336
ds_read_b128 a[104:107], v5 offset:10240
v_mfma_f32_16x16x32_bf16 v[80:83], a[68:71], a[4:7], v[80:83]
v_exp_f32 v93, v93
v_mfma_f32_16x16x32_bf16 v[80:83], a[72:75], a[8:11], v[80:83]
v_cvt_pk_bf16_f32 v70, v100, v101
s_waitcnt lgkmcnt(6)
v_mfma_f32_16x16x32_bf16 v[80:83], a[76:79], a[12:15], v[80:83]
v_cvt_pk_bf16_f32 v54, v84, v85
v_cvt_pk_bf16_f32 v55, v86, v87
v_mfma_f32_16x16x32_bf16 v[84:87], a[80:83], a[0:3], v[32:35]
ds_read_b128 a[124:127], v5 offset:15360
ds_read_b128 a[108:111], v5 offset:11264
v_mfma_f32_16x16x32_bf16 v[84:87], a[84:87], a[4:7], v[84:87]
buffer_load_dwordx4 v21, s[44:47], s29 offen offset:0 lds
v_mfma_f32_16x16x32_bf16 v[84:87], a[88:91], a[8:11], v[84:87]
v_bfe_u32 v2, v0, 5, 1
v_cvt_pk_bf16_f32 v69, v98, v99
v_mfma_f32_16x16x32_bf16 v[84:87], a[92:95], a[12:15], v[84:87]
buffer_load_dwordx4 a[232:235], v4, s[40:43], s34 offen offset:2048 sc1
v_mfma_f32_16x16x32_bf16 v[96:99], a[64:67], a[32:35], v[40:43]
buffer_load_dwordx4 v22, s[44:47], s29 offen offset:1024 lds
v_mfma_f32_16x16x32_bf16 v[96:99], a[68:71], a[36:39], v[96:99]
s_waitcnt lgkmcnt(4)
v_exp_f32 v107, v107
v_mfma_f32_16x16x32_bf16 v[96:99], a[72:75], a[40:43], v[96:99]
v_exp_f32 v90, v90
v_mfma_f32_16x16x32_bf16 v[96:99], a[76:79], a[44:47], v[96:99]
s_add_u32 s3, s3, 54525952
v_exp_f32 v95, v95
v_mfma_f32_16x16x32_bf16 v[100:103], a[80:83], a[32:35], v[40:43]
v_lshlrev_b32 v2, 17, v2
v_lshl_add_u32 v1, v1, 7, v2
v_mfma_f32_16x16x32_bf16 v[100:103], a[84:87], a[36:39], v[100:103]
v_exp_f32 v106, v106
v_mfma_f32_16x16x32_bf16 v[100:103], a[88:91], a[40:43], v[100:103]
buffer_load_dwordx4 v23, s[44:47], s29 offen offset:2048 lds
v_mfma_f32_16x16x32_bf16 v[100:103], a[92:95], a[44:47], v[100:103]
v_exp_f32 v92, v92
v_smfmac_f32_16x16x64_bf16 a[240:243], v[112:115], v[48:55], v19
v_exp_f32 v104, v104
v_mfma_f32_16x16x32_bf16 v[144:147], a[96:99], v[48:51], v[144:147]
s_waitcnt lgkmcnt(0)
v_exp_f32 v91, v91
v_mfma_f32_16x16x32_bf16 v[144:147], a[112:115], v[52:55], v[144:147]
v_exp_f32 v108, v108
v_mfma_f32_16x16x32_bf16 v[148:151], a[100:103], v[48:51], v[148:151]
buffer_load_dwordx4 v24, s[44:47], s29 offen offset:3072 lds
v_mfma_f32_16x16x32_bf16 v[148:151], a[116:119], v[52:55], v[148:151]
v_exp_f32 v88, v88
v_mfma_f32_16x16x32_bf16 v[152:155], a[104:107], v[48:51], v[152:155]
buffer_load_dwordx4 a[236:239], v4, s[40:43], s34 offen offset:3072 sc1
v_mfma_f32_16x16x32_bf16 v[152:155], a[120:123], v[52:55], v[152:155]
s_mov_b32 m0, s58
v_exp_f32 v105, v105
v_mfma_f32_16x16x32_bf16 v[156:159], a[108:111], v[48:51], v[156:159]
v_exp_f32 v111, v111
v_mfma_f32_16x16x32_bf16 v[156:159], a[124:127], v[52:55], v[156:159]
v_cvt_pk_bf16_f32 v77, v106, v107
v_smfmac_f32_16x16x64_bf16 a[248:251], v[112:115], v[64:71], v19
v_exp_f32 v110, v110
v_mfma_f32_16x16x32_bf16 v[208:211], a[96:99], v[64:67], v[208:211]
v_exp_f32 v109, v109
v_mfma_f32_16x16x32_bf16 v[208:211], a[112:115], v[68:71], v[208:211]
v_cvt_pk_bf16_f32 v79, v110, v111
v_mfma_f32_16x16x32_bf16 v[212:215], a[100:103], v[64:67], v[212:215]
v_cvt_pk_bf16_f32 v76, v104, v105
s_bitset1_b32 m0, 14
v_mfma_f32_16x16x32_bf16 v[212:215], a[116:119], v[68:71], v[212:215]
buffer_load_dword v30, v1, s[40:43], s3 offen sc1
v_mfma_f32_16x16x32_bf16 v[216:219], a[104:107], v[64:67], v[216:219]
v_cvt_pk_bf16_f32 v78, v108, v109
v_cvt_pk_bf16_f32 v60, v88, v89
v_mfma_f32_16x16x32_bf16 v[216:219], a[120:123], v[68:71], v[216:219]
v_cvt_pk_bf16_f32 v63, v94, v95
v_cvt_pk_bf16_f32 v61, v90, v91
v_mfma_f32_16x16x32_bf16 v[220:223], a[108:111], v[64:67], v[220:223]
v_cvt_pk_bf16_f32 v62, v92, v93
s_sub_u32 s36, s36, s61
v_mfma_f32_16x16x32_bf16 v[220:223], a[124:127], v[68:71], v[220:223]
s_cbranch_scc1 kf_kernel_sw_loopAB1
s_branch kf_kernel_loopAB1
kf_kernel_hend:
kf_kernel_spin_zB:
s_mov_b32 s101, 0x40000
kf_kernel_spinl_zB:
buffer_load_dword v30, off, s[40:43], s60 sc1
s_waitcnt vmcnt(0)
v_cmp_gt_u32 vcc, 27, v30
s_cmp_lg_u64 vcc, 0
s_cbranch_scc0 kf_kernel_ret_zB
s_sub_u32 s101, s101, 1
s_cbranch_scc0 kf_kernel_spinl_zB
s_branch kf_kernel_ret_zB
kf_kernel_spin_znB:
s_mov_b32 s101, 0x40000
kf_kernel_spinl_znB:
v_lshlrev_b32 v2, 4, v4
s_mov_b32 s3, 3178496
buffer_load_dword v30, v2, s[40:43], s3 offen sc1
s_waitcnt vmcnt(0)
v_cmp_gt_u32 vcc, 16, v30
s_cmp_lg_u64 vcc, 0
s_cbranch_scc0 kf_kernel_ret_znB
s_sub_u32 s101, s101, 1
s_cbranch_scc0 kf_kernel_spinl_znB
s_branch kf_kernel_ret_znB
kf_kernel_spin_zA:
s_mov_b32 s101, 0x40000
kf_kernel_spinl_zA:
buffer_load_dword v30, off, s[40:43], s60 sc1
s_waitcnt vmcnt(0)
v_cmp_gt_u32 vcc, 27, v30
s_cmp_lg_u64 vcc, 0
s_cbranch_scc0 kf_kernel_ret_zA
s_sub_u32 s101, s101, 1
s_cbranch_scc0 kf_kernel_spinl_zA
s_branch kf_kernel_ret_zA
kf_kernel_spin_znA:
s_mov_b32 s101, 0x40000
kf_kernel_spinl_znA:
v_lshlrev_b32 v2, 4, v4
s_mov_b32 s3, 3178496
buffer_load_dword v30, v2, s[40:43], s3 offen sc1
s_waitcnt vmcnt(0)
v_cmp_gt_u32 vcc, 16, v30
s_cmp_lg_u64 vcc, 0
s_cbranch_scc0 kf_kernel_ret_znA
s_sub_u32 s101, s101, 1
s_cbranch_scc0 kf_kernel_spinl_znA
s_branch kf_kernel_ret_znA
kf_kernel_slow:
s_mul_i32 s29, s21, 1064960
s_add_u32 s29, s29, 4194304
s_add_u32 s8, s6, s29
s_addc_u32 s9, s7, 0
s_mov_b32 s10, 1064960
s_mov_b32 s11, 0x20000
s_nop 7
s_lshr_b32 s34, s30, 1
s_lshl_b32 s34, s34, 14
s_mov_b32 s29, s34
v_mov_b32 v128, 0
v_mov_b32 v129, 0
v_mov_b32 v130, 0
v_mov_b32 v131, 0
v_mov_b32 v132, 0
v_mov_b32 v133, 0
v_mov_b32 v134, 0
v_mov_b32 v135, 0
v_mov_b32 v136, 0
v_mov_b32 v137, 0
v_mov_b32 v138, 0
v_mov_b32 v139, 0
v_mov_b32 v140, 0
v_mov_b32 v141, 0
v_mov_b32 v142, 0
v_mov_b32 v143, 0
v_mov_b32 v144, 0
v_mov_b32 v145, 0
v_mov_b32 v146, 0
v_mov_b32 v147, 0
v_mov_b32 v148, 0
v_mov_b32 v149, 0
v_mov_b32 v150, 0
v_mov_b32 v151, 0
v_mov_b32 v152, 0
v_mov_b32 v153, 0
v_mov_b32 v154, 0
v_mov_b32 v155, 0
v_mov_b32 v156, 0
v_mov_b32 v157, 0
v_mov_b32 v158, 0
v_mov_b32 v159, 0
v_mov_b32 v32, 0
v_mov_b32 v33, 0
v_mov_b32 v34, 0
v_mov_b32 v35, 0
v_mov_b32 v18, s57
kf_kernel_sl0:
s_add_u32 s59, s29, 16384
buffer_load_dwordx4 a[64:67], v4, s[8:11], s59 offen offset:0 sc1
buffer_load_dwordx4 a[68:71], v4, s[8:11], s59 offen offset:1024 sc1
buffer_load_dwordx4 a[72:75], v4, s[8:11], s59 offen offset:2048 sc1
buffer_load_dwordx4 a[76:79], v4, s[8:11], s59 offen offset:3072 sc1
s_add_u32 s59, s29, 20480
buffer_load_dwordx4 a[80:83], v4, s[8:11], s59 offen offset:0 sc1
buffer_load_dwordx4 a[84:87], v4, s[8:11], s59 offen offset:1024 sc1
buffer_load_dwordx4 a[88:91], v4, s[8:11], s59 offen offset:2048 sc1
buffer_load_dwordx4 a[92:95], v4, s[8:11], s59 offen offset:3072 sc1
s_bitcmp1_b32 s29, 14
s_cselect_b32 s59, 2, -1
s_lshl_b32 s59, s59, 12
s_add_u32 s59, s59, s29
s_max_i32 s59, s59, 0
buffer_load_dwordx4 a[96:99], v4, s[8:11], s59 offen offset:0 sc1
buffer_load_dwordx4 a[100:103], v4, s[8:11], s59 offen offset:1024 sc1
buffer_load_dwordx4 a[104:107], v4, s[8:11], s59 offen offset:2048 sc1
buffer_load_dwordx4 a[108:111], v4, s[8:11], s59 offen offset:3072 sc1
s_bitcmp1_b32 s29, 14
s_cselect_b32 s59, -2, 3
s_lshl_b32 s59, s59, 12
s_add_u32 s59, s59, s29
s_max_i32 s59, s59, 0
buffer_load_dwordx4 a[112:115], v4, s[8:11], s59 offen offset:0 sc1
buffer_load_dwordx4 a[116:119], v4, s[8:11], s59 offen offset:1024 sc1
buffer_load_dwordx4 a[120:123], v4, s[8:11], s59 offen offset:2048 sc1
buffer_load_dwordx4 a[124:127], v4, s[8:11], s59 offen offset:3072 sc1
s_waitcnt vmcnt(0)
v_mfma_f32_16x16x32_bf16 v[80:83], a[64:67], a[0:3], 0
v_mfma_f32_16x16x32_bf16 v[80:83], a[68:71], a[4:7], v[80:83]
v_mfma_f32_16x16x32_bf16 v[80:83], a[72:75], a[8:11], v[80:83]
v_mfma_f32_16x16x32_bf16 v[80:83], a[76:79], a[12:15], v[80:83]
v_mfma_f32_16x16x32_bf16 v[84:87], a[80:83], a[0:3], 0
v_mfma_f32_16x16x32_bf16 v[84:87], a[84:87], a[4:7], v[84:87]
v_mfma_f32_16x16x32_bf16 v[84:87], a[88:91], a[8:11], v[84:87]
v_mfma_f32_16x16x32_bf16 v[84:87], a[92:95], a[12:15], v[84:87]
s_nop 7
s_cmp_lg_u32 s29, s34
s_cbranch_scc1 kf_kernel_sn0
kf_kernel_sm0:
v_mov_b32 v20, s57
v_cndmask_b32 v80, v20, v80, s[48:49]
v_cndmask_b32 v81, v20, v81, s[50:51]
v_cndmask_b32 v82, v20, v82, s[52:53]
v_cndmask_b32 v83, v20, v83, s[54:55]
v_mov_b32 v84, s57
v_mov_b32 v85, s57
v_mov_b32 v86, s57
v_mov_b32 v87, s57
kf_kernel_sn0:
v_max3_f32 v19, v80, v81, v82
v_max3_f32 v19, v19, v83, v84
v_max3_f32 v19, v19, v85, v86
v_max_f32 v19, v19, v87
v_mov_b32 v20, v19
s_nop 1
v_permlane16_swap_b32 v20, v19
v_max_f32 v19, v19, v20
v_mov_b32 v20, v19
s_nop 1
v_permlane32_swap_b32 v20, v19
v_max_f32 v19, v19, v20
v_max_f32 v19, v19, v18
v_sub_f32 v20, v18, v19
v_exp_f32 v20, v20
v_mov_b32 v18, v19
v_sub_f32 v80, v80, v19
v_sub_f32 v81, v81, v19
v_sub_f32 v82, v82, v19
v_sub_f32 v83, v83, v19
v_sub_f32 v84, v84, v19
v_sub_f32 v85, v85, v19
v_sub_f32 v86, v86, v19
v_sub_f32 v87, v87, v19
v_exp_f32 v80, v80
v_exp_f32 v81, v81
v_exp_f32 v82, v82
v_exp_f32 v83, v83
v_exp_f32 v84, v84
v_exp_f32 v85, v85
v_exp_f32 v86, v86
v_exp_f32 v87, v87
v_mul_f32 v128, v128, v20
v_mul_f32 v129, v129, v20
v_mul_f32 v130, v130, v20
v_mul_f32 v131, v131, v20
v_mul_f32 v132, v132, v20
v_mul_f32 v133, v133, v20
v_mul_f32 v134, v134, v20
v_mul_f32 v135, v135, v20
v_mul_f32 v136, v136, v20
v_mul_f32 v137, v137, v20
v_mul_f32 v138, v138, v20
v_mul_f32 v139, v139, v20
v_mul_f32 v140, v140, v20
v_mul_f32 v141, v141, v20
v_mul_f32 v142, v142, v20
v_mul_f32 v143, v143, v20
v_mul_f32 v144, v144, v20
v_mul_f32 v145, v145, v20
v_mul_f32 v146, v146, v20
v_mul_f32 v147, v147, v20
v_mul_f32 v148, v148, v20
v_mul_f32 v149, v149, v20
v_mul_f32 v150, v150, v20
v_mul_f32 v151, v151, v20
v_mul_f32 v152, v152, v20
v_mul_f32 v153, v153, v20
v_mul_f32 v154, v154, v20
v_mul_f32 v155, v155, v20
v_mul_f32 v156, v156, v20
v_mul_f32 v157, v157, v20
v_mul_f32 v158, v158, v20
v_mul_f32 v159, v159, v20
v_mul_f32 v32, v32, v20
v_mul_f32 v33, v33, v20
v_mul_f32 v34, v34, v20
v_mul_f32 v35, v35, v20
v_cvt_pk_bf16_f32 v48, v80, v81
v_cvt_pk_bf16_f32 v49, v82, v83
v_cvt_pk_bf16_f32 v50, v84, v85
v_cvt_pk_bf16_f32 v51, v86, v87
s_nop 1
v_mfma_f32_16x16x32_bf16 v[32:35], v[112:115], v[48:51], v[32:35]
v_mfma_f32_16x16x32_bf16 v[128:131], a[96:99], v[48:51], v[128:131]
v_mfma_f32_16x16x32_bf16 v[132:135], a[100:103], v[48:51], v[132:135]
v_mfma_f32_16x16x32_bf16 v[136:139], a[104:107], v[48:51], v[136:139]
v_mfma_f32_16x16x32_bf16 v[140:143], a[108:111], v[48:51], v[140:143]
v_mfma_f32_16x16x32_bf16 v[144:147], a[112:115], v[48:51], v[144:147]
v_mfma_f32_16x16x32_bf16 v[148:151], a[116:119], v[48:51], v[148:151]
v_mfma_f32_16x16x32_bf16 v[152:155], a[120:123], v[48:51], v[152:155]
v_mfma_f32_16x16x32_bf16 v[156:159], a[124:127], v[48:51], v[156:159]
s_nop 7
s_sub_u32 s29, s29, 16384
s_cbranch_scc0 kf_kernel_sl0
kf_kernel_sx0:
s_lshr_b32 s34, s30, 1
s_lshl_b32 s34, s34, 14
s_mov_b32 s29, s34
v_mov_b32 v160, 0
v_mov_b32 v161, 0
v_mov_b32 v162, 0
v_mov_b32 v163, 0
v_mov_b32 v164, 0
v_mov_b32 v165, 0
v_mov_b32 v166, 0
v_mov_b32 v167, 0
v_mov_b32 v168, 0
v_mov_b32 v169, 0
v_mov_b32 v170, 0
v_mov_b32 v171, 0
v_mov_b32 v172, 0
v_mov_b32 v173, 0
v_mov_b32 v174, 0
v_mov_b32 v175, 0
v_mov_b32 v176, 0
v_mov_b32 v177, 0
v_mov_b32 v178, 0
v_mov_b32 v179, 0
v_mov_b32 v180, 0
v_mov_b32 v181, 0
v_mov_b32 v182, 0
v_mov_b32 v183, 0
v_mov_b32 v184, 0
v_mov_b32 v185, 0
v_mov_b32 v186, 0
v_mov_b32 v187, 0
v_mov_b32 v188, 0
v_mov_b32 v189, 0
v_mov_b32 v190, 0
v_mov_b32 v191, 0
v_mov_b32 v36, 0
v_mov_b32 v37, 0
v_mov_b32 v38, 0
v_mov_b32 v39, 0
v_mov_b32 v18, s57
kf_kernel_sl1:
s_add_u32 s59, s29, 16384
buffer_load_dwordx4 a[64:67], v4, s[8:11], s59 offen offset:0 sc1
buffer_load_dwordx4 a[68:71], v4, s[8:11], s59 offen offset:1024 sc1
buffer_load_dwordx4 a[72:75], v4, s[8:11], s59 offen offset:2048 sc1
buffer_load_dwordx4 a[76:79], v4, s[8:11], s59 offen offset:3072 sc1
s_add_u32 s59, s29, 20480
buffer_load_dwordx4 a[80:83], v4, s[8:11], s59 offen offset:0 sc1
buffer_load_dwordx4 a[84:87], v4, s[8:11], s59 offen offset:1024 sc1
buffer_load_dwordx4 a[88:91], v4, s[8:11], s59 offen offset:2048 sc1
buffer_load_dwordx4 a[92:95], v4, s[8:11], s59 offen offset:3072 sc1
s_bitcmp1_b32 s29, 14
s_cselect_b32 s59, 2, -1
s_lshl_b32 s59, s59, 12
s_add_u32 s59, s59, s29
s_max_i32 s59, s59, 0
buffer_load_dwordx4 a[96:99], v4, s[8:11], s59 offen offset:0 sc1
buffer_load_dwordx4 a[100:103], v4, s[8:11], s59 offen offset:1024 sc1
buffer_load_dwordx4 a[104:107], v4, s[8:11], s59 offen offset:2048 sc1
buffer_load_dwordx4 a[108:111], v4, s[8:11], s59 offen offset:3072 sc1
s_bitcmp1_b32 s29, 14
s_cselect_b32 s59, -2, 3
s_lshl_b32 s59, s59, 12
s_add_u32 s59, s59, s29
s_max_i32 s59, s59, 0
buffer_load_dwordx4 a[112:115], v4, s[8:11], s59 offen offset:0 sc1
buffer_load_dwordx4 a[116:119], v4, s[8:11], s59 offen offset:1024 sc1
buffer_load_dwordx4 a[120:123], v4, s[8:11], s59 offen offset:2048 sc1
buffer_load_dwordx4 a[124:127], v4, s[8:11], s59 offen offset:3072 sc1
s_waitcnt vmcnt(0)
v_mfma_f32_16x16x32_bf16 v[88:91], a[64:67], a[16:19], 0
v_mfma_f32_16x16x32_bf16 v[88:91], a[68:71], a[20:23], v[88:91]
v_mfma_f32_16x16x32_bf16 v[88:91], a[72:75], a[24:27], v[88:91]
v_mfma_f32_16x16x32_bf16 v[88:91], a[76:79], a[28:31], v[88:91]
v_mfma_f32_16x16x32_bf16 v[92:95], a[80:83], a[16:19], 0
v_mfma_f32_16x16x32_bf16 v[92:95], a[84:87], a[20:23], v[92:95]
v_mfma_f32_16x16x32_bf16 v[92:95], a[88:91], a[24:27], v[92:95]
v_mfma_f32_16x16x32_bf16 v[92:95], a[92:95], a[28:31], v[92:95]
s_nop 7
s_cmp_lg_u32 s29, s34
s_cbranch_scc1 kf_kernel_sn1
kf_kernel_sm1:
v_mov_b32 v20, s57
v_cndmask_b32 v92, v20, v92, s[48:49]
v_cndmask_b32 v93, v20, v93, s[50:51]
v_cndmask_b32 v94, v20, v94, s[52:53]
v_cndmask_b32 v95, v20, v95, s[54:55]
kf_kernel_sn1:
v_max3_f32 v19, v88, v89, v90
v_max3_f32 v19, v19, v91, v92
v_max3_f32 v19, v19, v93, v94
v_max_f32 v19, v19, v95
v_mov_b32 v20, v19
s_nop 1
v_permlane16_swap_b32 v20, v19
v_max_f32 v19, v19, v20
v_mov_b32 v20, v19
s_nop 1
v_permlane32_swap_b32 v20, v19
v_max_f32 v19, v19, v20
v_max_f32 v19, v19, v18
v_sub_f32 v20, v18, v19
v_exp_f32 v20, v20
v_mov_b32 v18, v19
v_sub_f32 v88, v88, v19
v_sub_f32 v89, v89, v19
v_sub_f32 v90, v90, v19
v_sub_f32 v91, v91, v19
v_sub_f32 v92, v92, v19
v_sub_f32 v93, v93, v19
v_sub_f32 v94, v94, v19
v_sub_f32 v95, v95, v19
v_exp_f32 v88, v88
v_exp_f32 v89, v89
v_exp_f32 v90, v90
v_exp_f32 v91, v91
v_exp_f32 v92, v92
v_exp_f32 v93, v93
v_exp_f32 v94, v94
v_exp_f32 v95, v95
v_mul_f32 v160, v160, v20
v_mul_f32 v161, v161, v20
v_mul_f32 v162, v162, v20
v_mul_f32 v163, v163, v20
v_mul_f32 v164, v164, v20
v_mul_f32 v165, v165, v20
v_mul_f32 v166, v166, v20
v_mul_f32 v167, v167, v20
v_mul_f32 v168, v168, v20
v_mul_f32 v169, v169, v20
v_mul_f32 v170, v170, v20
v_mul_f32 v171, v171, v20
v_mul_f32 v172, v172, v20
v_mul_f32 v173, v173, v20
v_mul_f32 v174, v174, v20
v_mul_f32 v175, v175, v20
v_mul_f32 v176, v176, v20
v_mul_f32 v177, v177, v20
v_mul_f32 v178, v178, v20
v_mul_f32 v179, v179, v20
v_mul_f32 v180, v180, v20
v_mul_f32 v181, v181, v20
v_mul_f32 v182, v182, v20
v_mul_f32 v183, v183, v20
v_mul_f32 v184, v184, v20
v_mul_f32 v185, v185, v20
v_mul_f32 v186, v186, v20
v_mul_f32 v187, v187, v20
v_mul_f32 v188, v188, v20
v_mul_f32 v189, v189, v20
v_mul_f32 v190, v190, v20
v_mul_f32 v191, v191, v20
v_mul_f32 v36, v36, v20
v_mul_f32 v37, v37, v20
v_mul_f32 v38, v38, v20
v_mul_f32 v39, v39, v20
v_cvt_pk_bf16_f32 v56, v88, v89
v_cvt_pk_bf16_f32 v57, v90, v91
v_cvt_pk_bf16_f32 v58, v92, v93
v_cvt_pk_bf16_f32 v59, v94, v95
s_nop 1
v_mfma_f32_16x16x32_bf16 v[36:39], v[112:115], v[56:59], v[36:39]
v_mfma_f32_16x16x32_bf16 v[160:163], a[96:99], v[56:59], v[160:163]
v_mfma_f32_16x16x32_bf16 v[164:167], a[100:103], v[56:59], v[164:167]
v_mfma_f32_16x16x32_bf16 v[168:171], a[104:107], v[56:59], v[168:171]
v_mfma_f32_16x16x32_bf16 v[172:175], a[108:111], v[56:59], v[172:175]
v_mfma_f32_16x16x32_bf16 v[176:179], a[112:115], v[56:59], v[176:179]
v_mfma_f32_16x16x32_bf16 v[180:183], a[116:119], v[56:59], v[180:183]
v_mfma_f32_16x16x32_bf16 v[184:187], a[120:123], v[56:59], v[184:187]
v_mfma_f32_16x16x32_bf16 v[188:191], a[124:127], v[56:59], v[188:191]
s_nop 7
s_sub_u32 s29, s29, 16384
s_cbranch_scc0 kf_kernel_sl1
kf_kernel_sx1:
s_lshr_b32 s34, s31, 1
s_lshl_b32 s34, s34, 14
s_mov_b32 s29, s34
v_mov_b32 v192, 0
v_mov_b32 v193, 0
v_mov_b32 v194, 0
v_mov_b32 v195, 0
v_mov_b32 v196, 0
v_mov_b32 v197, 0
v_mov_b32 v198, 0
v_mov_b32 v199, 0
v_mov_b32 v200, 0
v_mov_b32 v201, 0
v_mov_b32 v202, 0
v_mov_b32 v203, 0
v_mov_b32 v204, 0
v_mov_b32 v205, 0
v_mov_b32 v206, 0
v_mov_b32 v207, 0
v_mov_b32 v208, 0
v_mov_b32 v209, 0
v_mov_b32 v210, 0
v_mov_b32 v211, 0
v_mov_b32 v212, 0
v_mov_b32 v213, 0
v_mov_b32 v214, 0
v_mov_b32 v215, 0
v_mov_b32 v216, 0
v_mov_b32 v217, 0
v_mov_b32 v218, 0
v_mov_b32 v219, 0
v_mov_b32 v220, 0
v_mov_b32 v221, 0
v_mov_b32 v222, 0
v_mov_b32 v223, 0
v_mov_b32 v40, 0
v_mov_b32 v41, 0
v_mov_b32 v42, 0
v_mov_b32 v43, 0
v_mov_b32 v18, s57
kf_kernel_sl2:
s_add_u32 s59, s29, 16384
buffer_load_dwordx4 a[64:67], v4, s[8:11], s59 offen offset:0 sc1
buffer_load_dwordx4 a[68:71], v4, s[8:11], s59 offen offset:1024 sc1
buffer_load_dwordx4 a[72:75], v4, s[8:11], s59 offen offset:2048 sc1
buffer_load_dwordx4 a[76:79], v4, s[8:11], s59 offen offset:3072 sc1
s_add_u32 s59, s29, 20480
buffer_load_dwordx4 a[80:83], v4, s[8:11], s59 offen offset:0 sc1
buffer_load_dwordx4 a[84:87], v4, s[8:11], s59 offen offset:1024 sc1
buffer_load_dwordx4 a[88:91], v4, s[8:11], s59 offen offset:2048 sc1
buffer_load_dwordx4 a[92:95], v4, s[8:11], s59 offen offset:3072 sc1
s_bitcmp1_b32 s29, 14
s_cselect_b32 s59, 2, -1
s_lshl_b32 s59, s59, 12
s_add_u32 s59, s59, s29
s_max_i32 s59, s59, 0
buffer_load_dwordx4 a[96:99], v4, s[8:11], s59 offen offset:0 sc1
buffer_load_dwordx4 a[100:103], v4, s[8:11], s59 offen offset:1024 sc1
buffer_load_dwordx4 a[104:107], v4, s[8:11], s59 offen offset:2048 sc1
buffer_load_dwordx4 a[108:111], v4, s[8:11], s59 offen offset:3072 sc1
s_bitcmp1_b32 s29, 14
s_cselect_b32 s59, -2, 3
s_lshl_b32 s59, s59, 12
s_add_u32 s59, s59, s29
s_max_i32 s59, s59, 0
buffer_load_dwordx4 a[112:115], v4, s[8:11], s59 offen offset:0 sc1
buffer_load_dwordx4 a[116:119], v4, s[8:11], s59 offen offset:1024 sc1
buffer_load_dwordx4 a[120:123], v4, s[8:11], s59 offen offset:2048 sc1
buffer_load_dwordx4 a[124:127], v4, s[8:11], s59 offen offset:3072 sc1
s_waitcnt vmcnt(0)
v_mfma_f32_16x16x32_bf16 v[96:99], a[64:67], a[32:35], 0
v_mfma_f32_16x16x32_bf16 v[96:99], a[68:71], a[36:39], v[96:99]
v_mfma_f32_16x16x32_bf16 v[96:99], a[72:75], a[40:43], v[96:99]
v_mfma_f32_16x16x32_bf16 v[96:99], a[76:79], a[44:47], v[96:99]
v_mfma_f32_16x16x32_bf16 v[100:103], a[80:83], a[32:35], 0
v_mfma_f32_16x16x32_bf16 v[100:103], a[84:87], a[36:39], v[100:103]
v_mfma_f32_16x16x32_bf16 v[100:103], a[88:91], a[40:43], v[100:103]
v_mfma_f32_16x16x32_bf16 v[100:103], a[92:95], a[44:47], v[100:103]
s_nop 7
s_cmp_lg_u32 s29, s34
s_cbranch_scc1 kf_kernel_sn2
kf_kernel_sm2:
v_mov_b32 v20, s57
v_cndmask_b32 v96, v20, v96, s[48:49]
v_cndmask_b32 v97, v20, v97, s[50:51]
v_cndmask_b32 v98, v20, v98, s[52:53]
v_cndmask_b32 v99, v20, v99, s[54:55]
v_mov_b32 v100, s57
v_mov_b32 v101, s57
v_mov_b32 v102, s57
v_mov_b32 v103, s57
kf_kernel_sn2:
v_max3_f32 v19, v96, v97, v98
v_max3_f32 v19, v19, v99, v100
v_max3_f32 v19, v19, v101, v102
v_max_f32 v19, v19, v103
v_mov_b32 v20, v19
s_nop 1
v_permlane16_swap_b32 v20, v19
v_max_f32 v19, v19, v20
v_mov_b32 v20, v19
s_nop 1
v_permlane32_swap_b32 v20, v19
v_max_f32 v19, v19, v20
v_max_f32 v19, v19, v18
v_sub_f32 v20, v18, v19
v_exp_f32 v20, v20
v_mov_b32 v18, v19
v_sub_f32 v96, v96, v19
v_sub_f32 v97, v97, v19
v_sub_f32 v98, v98, v19
v_sub_f32 v99, v99, v19
v_sub_f32 v100, v100, v19
v_sub_f32 v101, v101, v19
v_sub_f32 v102, v102, v19
v_sub_f32 v103, v103, v19
v_exp_f32 v96, v96
v_exp_f32 v97, v97
v_exp_f32 v98, v98
v_exp_f32 v99, v99
v_exp_f32 v100, v100
v_exp_f32 v101, v101
v_exp_f32 v102, v102
v_exp_f32 v103, v103
v_mul_f32 v192, v192, v20
v_mul_f32 v193, v193, v20
v_mul_f32 v194, v194, v20
v_mul_f32 v195, v195, v20
v_mul_f32 v196, v196, v20
v_mul_f32 v197, v197, v20
v_mul_f32 v198, v198, v20
v_mul_f32 v199, v199, v20
v_mul_f32 v200, v200, v20
v_mul_f32 v201, v201, v20
v_mul_f32 v202, v202, v20
v_mul_f32 v203, v203, v20
v_mul_f32 v204, v204, v20
v_mul_f32 v205, v205, v20
v_mul_f32 v206, v206, v20
v_mul_f32 v207, v207, v20
v_mul_f32 v208, v208, v20
v_mul_f32 v209, v209, v20
v_mul_f32 v210, v210, v20
v_mul_f32 v211, v211, v20
v_mul_f32 v212, v212, v20
v_mul_f32 v213, v213, v20
v_mul_f32 v214, v214, v20
v_mul_f32 v215, v215, v20
v_mul_f32 v216, v216, v20
v_mul_f32 v217, v217, v20
v_mul_f32 v218, v218, v20
v_mul_f32 v219, v219, v20
v_mul_f32 v220, v220, v20
v_mul_f32 v221, v221, v20
v_mul_f32 v222, v222, v20
v_mul_f32 v223, v223, v20
v_mul_f32 v40, v40, v20
v_mul_f32 v41, v41, v20
v_mul_f32 v42, v42, v20
v_mul_f32 v43, v43, v20
v_cvt_pk_bf16_f32 v64, v96, v97
v_cvt_pk_bf16_f32 v65, v98, v99
v_cvt_pk_bf16_f32 v66, v100, v101
v_cvt_pk_bf16_f32 v67, v102, v103
s_nop 1
v_mfma_f32_16x16x32_bf16 v[40:43], v[112:115], v[64:67], v[40:43]
v_mfma_f32_16x16x32_bf16 v[192:195], a[96:99], v[64:67], v[192:195]
v_mfma_f32_16x16x32_bf16 v[196:199], a[100:103], v[64:67], v[196:199]
v_mfma_f32_16x16x32_bf16 v[200:203], a[104:107], v[64:67], v[200:203]
v_mfma_f32_16x16x32_bf16 v[204:207], a[108:111], v[64:67], v[204:207]
v_mfma_f32_16x16x32_bf16 v[208:211], a[112:115], v[64:67], v[208:211]
v_mfma_f32_16x16x32_bf16 v[212:215], a[116:119], v[64:67], v[212:215]
v_mfma_f32_16x16x32_bf16 v[216:219], a[120:123], v[64:67], v[216:219]
v_mfma_f32_16x16x32_bf16 v[220:223], a[124:127], v[64:67], v[220:223]
s_nop 7
s_sub_u32 s29, s29, 16384
s_cbranch_scc0 kf_kernel_sl2
kf_kernel_sx2:
s_lshr_b32 s34, s31, 1
s_lshl_b32 s34, s34, 14
s_mov_b32 s29, s34
v_mov_b32 v224, 0
v_mov_b32 v225, 0
v_mov_b32 v226, 0
v_mov_b32 v227, 0
v_mov_b32 v228, 0
v_mov_b32 v229, 0
v_mov_b32 v230, 0
v_mov_b32 v231, 0
v_mov_b32 v232, 0
v_mov_b32 v233, 0
v_mov_b32 v234, 0
v_mov_b32 v235, 0
v_mov_b32 v236, 0
v_mov_b32 v237, 0
v_mov_b32 v238, 0
v_mov_b32 v239, 0
v_mov_b32 v240, 0
v_mov_b32 v241, 0
v_mov_b32 v242, 0
v_mov_b32 v243, 0
v_mov_b32 v244, 0
v_mov_b32 v245, 0
v_mov_b32 v246, 0
v_mov_b32 v247, 0
v_mov_b32 v248, 0
v_mov_b32 v249, 0
v_mov_b32 v250, 0
v_mov_b32 v251, 0
v_mov_b32 v252, 0
v_mov_b32 v253, 0
v_mov_b32 v254, 0
v_mov_b32 v255, 0
v_mov_b32 v44, 0
v_mov_b32 v45, 0
v_mov_b32 v46, 0
v_mov_b32 v47, 0
v_mov_b32 v18, s57
kf_kernel_sl3:
s_add_u32 s59, s29, 16384
buffer_load_dwordx4 a[64:67], v4, s[8:11], s59 offen offset:0 sc1
buffer_load_dwordx4 a[68:71], v4, s[8:11], s59 offen offset:1024 sc1
buffer_load_dwordx4 a[72:75], v4, s[8:11], s59 offen offset:2048 sc1
buffer_load_dwordx4 a[76:79], v4, s[8:11], s59 offen offset:3072 sc1
s_add_u32 s59, s29, 20480
buffer_load_dwordx4 a[80:83], v4, s[8:11], s59 offen offset:0 sc1
buffer_load_dwordx4 a[84:87], v4, s[8:11], s59 offen offset:1024 sc1
buffer_load_dwordx4 a[88:91], v4, s[8:11], s59 offen offset:2048 sc1
buffer_load_dwordx4 a[92:95], v4, s[8:11], s59 offen offset:3072 sc1
s_bitcmp1_b32 s29, 14
s_cselect_b32 s59, 2, -1
s_lshl_b32 s59, s59, 12
s_add_u32 s59, s59, s29
s_max_i32 s59, s59, 0
buffer_load_dwordx4 a[96:99], v4, s[8:11], s59 offen offset:0 sc1
buffer_load_dwordx4 a[100:103], v4, s[8:11], s59 offen offset:1024 sc1
buffer_load_dwordx4 a[104:107], v4, s[8:11], s59 offen offset:2048 sc1
buffer_load_dwordx4 a[108:111], v4, s[8:11], s59 offen offset:3072 sc1
s_bitcmp1_b32 s29, 14
s_cselect_b32 s59, -2, 3
s_lshl_b32 s59, s59, 12
s_add_u32 s59, s59, s29
s_max_i32 s59, s59, 0
buffer_load_dwordx4 a[112:115], v4, s[8:11], s59 offen offset:0 sc1
buffer_load_dwordx4 a[116:119], v4, s[8:11], s59 offen offset:1024 sc1
buffer_load_dwordx4 a[120:123], v4, s[8:11], s59 offen offset:2048 sc1
buffer_load_dwordx4 a[124:127], v4, s[8:11], s59 offen offset:3072 sc1
s_waitcnt vmcnt(0)
v_mfma_f32_16x16x32_bf16 v[104:107], a[64:67], a[48:51], 0
v_mfma_f32_16x16x32_bf16 v[104:107], a[68:71], a[52:55], v[104:107]
v_mfma_f32_16x16x32_bf16 v[104:107], a[72:75], a[56:59], v[104:107]
v_mfma_f32_16x16x32_bf16 v[104:107], a[76:79], a[60:63], v[104:107]
v_mfma_f32_16x16x32_bf16 v[108:111], a[80:83], a[48:51], 0
v_mfma_f32_16x16x32_bf16 v[108:111], a[84:87], a[52:55], v[108:111]
v_mfma_f32_16x16x32_bf16 v[108:111], a[88:91], a[56:59], v[108:111]
v_mfma_f32_16x16x32_bf16 v[108:111], a[92:95], a[60:63], v[108:111]
s_nop 7
s_cmp_lg_u32 s29, s34
s_cbranch_scc1 kf_kernel_sn3
kf_kernel_sm3:
v_mov_b32 v20, s57
v_cndmask_b32 v108, v20, v108, s[48:49]
v_cndmask_b32 v109, v20, v109, s[50:51]
v_cndmask_b32 v110, v20, v110, s[52:53]
v_cndmask_b32 v111, v20, v111, s[54:55]
kf_kernel_sn3:
v_max3_f32 v19, v104, v105, v106
v_max3_f32 v19, v19, v107, v108
v_max3_f32 v19, v19, v109, v110
v_max_f32 v19, v19, v111
v_mov_b32 v20, v19
s_nop 1
v_permlane16_swap_b32 v20, v19
v_max_f32 v19, v19, v20
v_mov_b32 v20, v19
s_nop 1
v_permlane32_swap_b32 v20, v19
v_max_f32 v19, v19, v20
v_max_f32 v19, v19, v18
v_sub_f32 v20, v18, v19
v_exp_f32 v20, v20
v_mov_b32 v18, v19
v_sub_f32 v104, v104, v19
v_sub_f32 v105, v105, v19
v_sub_f32 v106, v106, v19
v_sub_f32 v107, v107, v19
v_sub_f32 v108, v108, v19
v_sub_f32 v109, v109, v19
v_sub_f32 v110, v110, v19
v_sub_f32 v111, v111, v19
v_exp_f32 v104, v104
v_exp_f32 v105, v105
v_exp_f32 v106, v106
v_exp_f32 v107, v107
v_exp_f32 v108, v108
v_exp_f32 v109, v109
v_exp_f32 v110, v110
v_exp_f32 v111, v111
v_mul_f32 v224, v224, v20
v_mul_f32 v225, v225, v20
v_mul_f32 v226, v226, v20
v_mul_f32 v227, v227, v20
v_mul_f32 v228, v228, v20
v_mul_f32 v229, v229, v20
v_mul_f32 v230, v230, v20
v_mul_f32 v231, v231, v20
v_mul_f32 v232, v232, v20
v_mul_f32 v233, v233, v20
v_mul_f32 v234, v234, v20
v_mul_f32 v235, v235, v20
v_mul_f32 v236, v236, v20
v_mul_f32 v237, v237, v20
v_mul_f32 v238, v238, v20
v_mul_f32 v239, v239, v20
v_mul_f32 v240, v240, v20
v_mul_f32 v241, v241, v20
v_mul_f32 v242, v242, v20
v_mul_f32 v243, v243, v20
v_mul_f32 v244, v244, v20
v_mul_f32 v245, v245, v20
v_mul_f32 v246, v246, v20
v_mul_f32 v247, v247, v20
v_mul_f32 v248, v248, v20
v_mul_f32 v249, v249, v20
v_mul_f32 v250, v250, v20
v_mul_f32 v251, v251, v20
v_mul_f32 v252, v252, v20
v_mul_f32 v253, v253, v20
v_mul_f32 v254, v254, v20
v_mul_f32 v255, v255, v20
v_mul_f32 v44, v44, v20
v_mul_f32 v45, v45, v20
v_mul_f32 v46, v46, v20
v_mul_f32 v47, v47, v20
v_cvt_pk_bf16_f32 v72, v104, v105
v_cvt_pk_bf16_f32 v73, v106, v107
v_cvt_pk_bf16_f32 v74, v108, v109
v_cvt_pk_bf16_f32 v75, v110, v111
s_nop 1
v_mfma_f32_16x16x32_bf16 v[44:47], v[112:115], v[72:75], v[44:47]
v_mfma_f32_16x16x32_bf16 v[224:227], a[96:99], v[72:75], v[224:227]
v_mfma_f32_16x16x32_bf16 v[228:231], a[100:103], v[72:75], v[228:231]
v_mfma_f32_16x16x32_bf16 v[232:235], a[104:107], v[72:75], v[232:235]
v_mfma_f32_16x16x32_bf16 v[236:239], a[108:111], v[72:75], v[236:239]
v_mfma_f32_16x16x32_bf16 v[240:243], a[112:115], v[72:75], v[240:243]
v_mfma_f32_16x16x32_bf16 v[244:247], a[116:119], v[72:75], v[244:247]
v_mfma_f32_16x16x32_bf16 v[248:251], a[120:123], v[72:75], v[248:251]
v_mfma_f32_16x16x32_bf16 v[252:255], a[124:127], v[72:75], v[252:255]
s_nop 7
s_sub_u32 s29, s29, 16384
s_cbranch_scc0 kf_kernel_sl3
kf_kernel_sx3:
kf_kernel_last:
s_branch kf_kernel_fin

.section .rodata,"a"
.p2align 6
.amdhsa_kernel kf_kernel
  .amdhsa_next_free_vgpr 512
  .amdhsa_next_free_sgpr 102
  .amdhsa_accum_offset 256
  .amdhsa_group_segment_fixed_size 0
  .amdhsa_kernarg_size 112
  .amdhsa_user_sgpr_count 2
  .amdhsa_user_sgpr_kernarg_segment_ptr 1
  .amdhsa_system_sgpr_workgroup_id_x 1

.end_amdhsa_kernel
```
